```python
import torch

def _softmax(x, axis=-1):
    return torch.softmax(x, dim=axis)
def _gelu(x):
    return torch.nn.functional.gelu(x, approximate="tanh")
def _silu(x):
    return torch.nn.functional.silu(x)
def _sigmoid(x):
    return torch.sigmoid(x)
def _layernorm(x, axis=-1, eps=1e-5):
    m = x.mean(dim=axis, keepdim=True)
    v = x.var(dim=axis, keepdim=True, unbiased=False)
    return (x - m) / torch.sqrt(v + eps)
def _scatter_add(tgt, idx, src, axis=0):
    return tgt.clone().index_add_(axis, idx, src)
def _segment_sum(src, seg, n):
    out = torch.zeros((n,) + src.shape[1:], dtype=src.dtype)
    return out.index_add_(0, seg, src)
def _pad(x, pw):
    flat = tuple(v for pair in reversed(pw) for v in pair)
    return torch.nn.functional.pad(x, flat)

kernel_name = 'recurrent_scan__ssm_conv_h3__dense_activation_gelu__prompt'

def setup_inputs():

    _w = (lambda a: (lambda t: t.to(torch.bfloat16) if t.is_floating_point() else t)(torch.as_tensor(a)))
    def _A_setup():
        B, S, D = 1, 2048, 640
        ks = 4
        return {
            "q": _w((lambda *s: torch.randn(*s, dtype=torch.bfloat16) * 0.05)(B, S, D)),
            "k": _w((lambda *s: torch.randn(*s, dtype=torch.bfloat16) * 0.8)(B, S, D)),
            "v": _w((lambda *s: torch.randn(*s, dtype=torch.bfloat16) * 0.8)(B, S, D)),
            "shift_k": _w((lambda *s: torch.randn(*s, dtype=torch.bfloat16) * 0.8)(D, ks) * 0.5),
            "ssm_k": _w((lambda *s: torch.randn(*s, dtype=torch.bfloat16) * 0.8)(D, S) * (1.0 / S ** 0.5)),
            "ssm_D": _w((lambda *s: torch.randn(*s, dtype=torch.bfloat16) * 0.8)(D)),
        }
    _A_in = _A_setup()

    def _B_setup():
        B, S, D, F = 1, 2048, 640, 1728
        return {
            "x": _w((lambda *s: torch.randn(*s, dtype=torch.bfloat16) * 0.05)(B, S, D)),
            "w1": _w((lambda *s: torch.randn(*s, dtype=torch.bfloat16) * 0.2)(D, F) * (D ** -0.5)),
            "b1": _w((lambda *s: torch.randn(*s, dtype=torch.bfloat16) * 0.2)(F) * 0.01),
            "w2": _w((lambda *s: torch.randn(*s, dtype=torch.bfloat16) * 0.2)(F, D) * (F ** -0.5)),
            "b2": _w((lambda *s: torch.randn(*s, dtype=torch.bfloat16) * 0.2)(D) * 0.01),
        }
    _B_in = _B_setup()

    return {
        "A_q": _A_in["q"],
        "A_k": _A_in["k"],
        "A_v": _A_in["v"],
        "A_shift_k": _A_in["shift_k"],
        "A_ssm_k": _A_in["ssm_k"],
        "A_ssm_D": _A_in["ssm_D"],
        "B_x": _B_in["x"],
        "B_w1": _B_in["w1"],
        "B_b1": _B_in["b1"],
        "B_w2": _B_in["w2"],
        "B_b2": _B_in["b2"],
    }

def reference(A_q, A_k, A_v, A_shift_k, A_ssm_k, A_ssm_D, B_x, B_w1, B_b1, B_w2, B_b2):
    def _A_ref(q, k, v, shift_k, ssm_k, ssm_D):
        B, S, D = q.shape
        ks = shift_k.shape[-1]
        k_pad = _pad(k, ((0, 0), (ks - 1, 0), (0, 0)))
        k_shift = torch.zeros_like(k)
        for t in range(ks):
            k_shift = k_shift + k_pad[:, t:t + S, :] * shift_k[:, ks - 1 - t][None, None, :]
        kv = k_shift * v
        L = 2 * S
        kv_pad = _pad(kv, ((0, 0), (0, S), (0, 0)))
        kf_pad = _pad(ssm_k, ((0, 0), (0, S)))
        kv_f = (lambda x, axes=(-2,-1): torch.fft.rfft2(x.float(), dim=axes))(kv_pad[:, None, :, :], axes=(1, 2))
        kf_f = (lambda x, axes=(-2,-1): torch.fft.rfft2(x.float(), dim=axes))(kf_pad[:, None, :], axes=(1, 2))
        kf_f = (lambda x, *d: x.permute(*d))(kf_f, 1, 2, 0)
        y_f = kv_f * kf_f[None, :, :, :]
        y = (lambda x, s, axes=(-2,-1): torch.fft.irfft2(x, s=s, dim=axes).to(torch.bfloat16))(y_f, (1, L), axes=(1, 2))[:, 0, :S, :]
        y = y + kv * ssm_D[None, None, :]
        return q * y

    def _B_ref(x, w1, b1, w2, b2):
        h = torch.einsum("bsd,df->bsf", x, w1) + b1
        h = _gelu(h)
        return torch.einsum("bsf,fd->bsd", h, w2) + b2

    x = A_q
    xn = _layernorm(x, axis=-1)
    s = _A_ref(xn, A_k, A_v, A_shift_k, A_ssm_k, A_ssm_D)
    g = _silu(_B_ref(xn, B_w1, B_b1, B_w2, B_b2))
    return x + s * g
```

```asm
; @launch kernel=k0_kernel grid=(256,1,1) block=(256,1,1) lds=163840
; @launch kernel=k1_kernel grid=(256,1,1) block=(256,1,1) lds=163840
; @launch kernel=k2_kernel grid=(256,1,1) block=(256,1,1) lds=163840
; @launch kernel=k3_kernel grid=(256,1,1) block=(256,1,1) lds=163840
.amdgcn_target "amdgcn-amd-amdhsa--gfx950"
.text
.globl k0_kernel
.p2align 8
.type k0_kernel,@function
k0_kernel:
s_cmp_ge_u32 s2, 256
s_cbranch_scc1 L_end_1
s_load_dwordx16 s[40:55], s[0:1], 0
s_load_dwordx8 s[56:63], s[0:1], 64
s_load_dwordx4 s[64:67], s[0:1], 96
s_and_b32 s3, s2, 7
s_lshr_b32 s4, s2, 3
v_lshrrev_b32 v1, 6, v0
v_and_b32 v0, 0xff, v0
s_nop 0
v_readfirstlane_b32 s5, v1
v_and_b32 v1, 63, v0
s_waitcnt lgkmcnt(0)
s_mov_b32 s8, s40
s_and_b32 s9, s41, 0xffff
s_mov_b32 s10, 2621440
s_mov_b32 s11, 0x20000
s_mov_b32 s12, s42
s_and_b32 s13, s43, 0xffff
s_mov_b32 s14, 2621440
s_mov_b32 s15, 0x20000
s_mov_b32 s16, s44
s_and_b32 s17, s45, 0xffff
s_mov_b32 s18, 2621440
s_mov_b32 s19, 0x20000
s_mov_b32 s20, s54
s_and_b32 s21, s55, 0xffff
s_mov_b32 s22, 2211840
s_mov_b32 s23, 0x20000
s_mov_b32 s24, s66
s_and_b32 s25, s67, 0xffff
s_mov_b32 s26, 17825792
s_mov_b32 s27, 0x20000
s_mov_b32 s28, s62
s_and_b32 s29, s63, 0xffff
s_mov_b32 s30, 2621440
s_mov_b32 s31, 0x20000
s_mov_b32 s32, s46
s_and_b32 s33, s47, 0xffff
s_mov_b32 s34, 5120
s_mov_b32 s35, 0x20000
s_lshr_b32 s6, s4, 3
s_lshl_b32 s7, s3, 2
s_add_u32 s68, s6, s7
s_and_b32 s69, s4, 7
v_mul_u32_u24 v2, 26, v1
v_lshrrev_b32 v2, 8, v2
v_mul_u32_u24 v3, 10, v2
v_sub_u32 v3, v1, v3
s_lshl_b32 s6, s68, 6
s_lshl_b32 s7, s5, 4
s_add_u32 s6, s6, s7
s_mul_i32 s6, s6, 1280
s_mul_i32 s7, s69, 160
s_add_u32 s6, s6, s7
v_mul_u32_u24 v4, 5120, v2
v_lshl_add_u32 v4, v3, 4, v4
v_add_u32 v4, s6, v4
v_subrev_u32 v5, 3840, v4
s_mul_i32 s7, s69, 640
v_lshlrev_b32 v6, 6, v3
v_add_u32 v6, s7, v6
s_mov_b32 exec_lo, -1
s_mov_b32 exec_hi, 0xff
buffer_load_dwordx4 v[8:11], v5, s[12:15], 0 offen offset:0
buffer_load_dwordx4 v[12:15], v5, s[12:15], 0 offen offset:1280
buffer_load_dwordx4 v[16:19], v5, s[12:15], 0 offen offset:2560
buffer_load_dwordx4 v[20:23], v4, s[12:15], 0 offen offset:0
buffer_load_dwordx4 v[24:27], v4, s[12:15], 0 offen offset:1280
buffer_load_dwordx4 v[28:31], v4, s[12:15], 0 offen offset:2560
buffer_load_dwordx4 v[32:35], v4, s[12:15], 0 offen offset:3840
buffer_load_dwordx4 v[52:55], v6, s[32:35], 0 offen offset:0
buffer_load_dwordx4 v[56:59], v6, s[32:35], 0 offen offset:16
buffer_load_dwordx4 v[60:63], v6, s[32:35], 0 offen offset:32
buffer_load_dwordx4 v[64:67], v6, s[32:35], 0 offen offset:48
buffer_load_dwordx4 v[36:39], v4, s[16:19], 0 offen offset:0
buffer_load_dwordx4 v[40:43], v4, s[16:19], 0 offen offset:1280
buffer_load_dwordx4 v[44:47], v4, s[16:19], 0 offen offset:2560
buffer_load_dwordx4 v[48:51], v4, s[16:19], 0 offen offset:3840
s_lshl_b32 s7, s5, 5
s_sub_u32 s7, 120, s7
v_mul_u32_u24 v7, 1152, v3
v_lshlrev_b32 v2, 3, v2
v_sub_u32 v7, v7, v2
v_add_u32 v7, s7, v7
s_waitcnt vmcnt(4)
v_lshlrev_b32 v68, 16, v52
v_lshlrev_b32 v69, 16, v54
v_and_b32 v76, 0xffff0000, v52
v_and_b32 v77, 0xffff0000, v54
v_lshlrev_b32 v84, 16, v53
v_lshlrev_b32 v85, 16, v55
v_and_b32 v92, 0xffff0000, v53
v_and_b32 v93, 0xffff0000, v55
v_lshlrev_b32 v70, 16, v56
v_lshlrev_b32 v71, 16, v58
v_and_b32 v78, 0xffff0000, v56
v_and_b32 v79, 0xffff0000, v58
v_lshlrev_b32 v86, 16, v57
v_lshlrev_b32 v87, 16, v59
v_and_b32 v94, 0xffff0000, v57
v_and_b32 v95, 0xffff0000, v59
v_lshlrev_b32 v72, 16, v60
v_lshlrev_b32 v73, 16, v62
v_and_b32 v80, 0xffff0000, v60
v_and_b32 v81, 0xffff0000, v62
v_lshlrev_b32 v88, 16, v61
v_lshlrev_b32 v89, 16, v63
v_and_b32 v96, 0xffff0000, v61
v_and_b32 v97, 0xffff0000, v63
v_lshlrev_b32 v74, 16, v64
v_lshlrev_b32 v75, 16, v66
v_and_b32 v82, 0xffff0000, v64
v_and_b32 v83, 0xffff0000, v66
v_lshlrev_b32 v90, 16, v65
v_lshlrev_b32 v91, 16, v67
v_and_b32 v98, 0xffff0000, v65
v_and_b32 v99, 0xffff0000, v67
s_waitcnt vmcnt(0)
v_lshlrev_b32 v100, 16, v8
v_and_b32 v101, 0xffff0000, v8
v_lshlrev_b32 v102, 16, v12
v_and_b32 v103, 0xffff0000, v12
v_lshlrev_b32 v104, 16, v16
v_and_b32 v105, 0xffff0000, v16
v_lshlrev_b32 v106, 16, v20
v_and_b32 v107, 0xffff0000, v20
v_lshlrev_b32 v108, 16, v24
v_and_b32 v109, 0xffff0000, v24
v_lshlrev_b32 v110, 16, v28
v_and_b32 v111, 0xffff0000, v28
v_lshlrev_b32 v112, 16, v32
v_and_b32 v113, 0xffff0000, v32
v_lshlrev_b32 v114, 16, v36
v_and_b32 v115, 0xffff0000, v36
v_lshlrev_b32 v116, 16, v40
v_and_b32 v117, 0xffff0000, v40
v_lshlrev_b32 v118, 16, v44
v_and_b32 v119, 0xffff0000, v44
v_lshlrev_b32 v120, 16, v48
v_and_b32 v121, 0xffff0000, v48
v_pk_mul_f32 v[122:123], v[106:107], v[68:69]
v_pk_mul_f32 v[124:125], v[108:109], v[68:69]
v_pk_mul_f32 v[126:127], v[110:111], v[68:69]
v_pk_mul_f32 v[128:129], v[112:113], v[68:69]
v_pk_fma_f32 v[122:123], v[104:105], v[76:77], v[122:123]
v_pk_fma_f32 v[124:125], v[106:107], v[76:77], v[124:125]
v_pk_fma_f32 v[126:127], v[108:109], v[76:77], v[126:127]
v_pk_fma_f32 v[128:129], v[110:111], v[76:77], v[128:129]
v_pk_fma_f32 v[122:123], v[102:103], v[84:85], v[122:123]
v_pk_fma_f32 v[124:125], v[104:105], v[84:85], v[124:125]
v_pk_fma_f32 v[126:127], v[106:107], v[84:85], v[126:127]
v_pk_fma_f32 v[128:129], v[108:109], v[84:85], v[128:129]
v_pk_fma_f32 v[122:123], v[100:101], v[92:93], v[122:123]
v_pk_fma_f32 v[124:125], v[102:103], v[92:93], v[124:125]
v_pk_fma_f32 v[126:127], v[104:105], v[92:93], v[126:127]
v_pk_fma_f32 v[128:129], v[106:107], v[92:93], v[128:129]
v_pk_mul_f32 v[122:123], v[122:123], v[114:115]
v_pk_mul_f32 v[124:125], v[124:125], v[116:117]
v_pk_mul_f32 v[126:127], v[126:127], v[118:119]
v_pk_mul_f32 v[128:129], v[128:129], v[120:121]
v_cvt_pk_bf16_f32 v100, v128, v126
v_cvt_pk_bf16_f32 v101, v124, v122
ds_write_b64 v7, v[100:101] offset:0
v_cvt_pk_bf16_f32 v102, v129, v127
v_cvt_pk_bf16_f32 v103, v125, v123
ds_write_b64 v7, v[102:103] offset:144
v_lshlrev_b32 v100, 16, v9
v_and_b32 v101, 0xffff0000, v9
v_lshlrev_b32 v102, 16, v13
v_and_b32 v103, 0xffff0000, v13
v_lshlrev_b32 v104, 16, v17
v_and_b32 v105, 0xffff0000, v17
v_lshlrev_b32 v106, 16, v21
v_and_b32 v107, 0xffff0000, v21
v_lshlrev_b32 v108, 16, v25
v_and_b32 v109, 0xffff0000, v25
v_lshlrev_b32 v110, 16, v29
v_and_b32 v111, 0xffff0000, v29
v_lshlrev_b32 v112, 16, v33
v_and_b32 v113, 0xffff0000, v33
v_lshlrev_b32 v114, 16, v37
v_and_b32 v115, 0xffff0000, v37
v_lshlrev_b32 v116, 16, v41
v_and_b32 v117, 0xffff0000, v41
v_lshlrev_b32 v118, 16, v45
v_and_b32 v119, 0xffff0000, v45
v_lshlrev_b32 v120, 16, v49
v_and_b32 v121, 0xffff0000, v49
v_pk_mul_f32 v[122:123], v[106:107], v[70:71]
v_pk_mul_f32 v[124:125], v[108:109], v[70:71]
v_pk_mul_f32 v[126:127], v[110:111], v[70:71]
v_pk_mul_f32 v[128:129], v[112:113], v[70:71]
v_pk_fma_f32 v[122:123], v[104:105], v[78:79], v[122:123]
v_pk_fma_f32 v[124:125], v[106:107], v[78:79], v[124:125]
v_pk_fma_f32 v[126:127], v[108:109], v[78:79], v[126:127]
v_pk_fma_f32 v[128:129], v[110:111], v[78:79], v[128:129]
v_pk_fma_f32 v[122:123], v[102:103], v[86:87], v[122:123]
v_pk_fma_f32 v[124:125], v[104:105], v[86:87], v[124:125]
v_pk_fma_f32 v[126:127], v[106:107], v[86:87], v[126:127]
v_pk_fma_f32 v[128:129], v[108:109], v[86:87], v[128:129]
v_pk_fma_f32 v[122:123], v[100:101], v[94:95], v[122:123]
v_pk_fma_f32 v[124:125], v[102:103], v[94:95], v[124:125]
v_pk_fma_f32 v[126:127], v[104:105], v[94:95], v[126:127]
v_pk_fma_f32 v[128:129], v[106:107], v[94:95], v[128:129]
v_pk_mul_f32 v[122:123], v[122:123], v[114:115]
v_pk_mul_f32 v[124:125], v[124:125], v[116:117]
v_pk_mul_f32 v[126:127], v[126:127], v[118:119]
v_pk_mul_f32 v[128:129], v[128:129], v[120:121]
v_cvt_pk_bf16_f32 v100, v128, v126
v_cvt_pk_bf16_f32 v101, v124, v122
ds_write_b64 v7, v[100:101] offset:288
v_cvt_pk_bf16_f32 v102, v129, v127
v_cvt_pk_bf16_f32 v103, v125, v123
ds_write_b64 v7, v[102:103] offset:432
v_lshlrev_b32 v100, 16, v10
v_and_b32 v101, 0xffff0000, v10
v_lshlrev_b32 v102, 16, v14
v_and_b32 v103, 0xffff0000, v14
v_lshlrev_b32 v104, 16, v18
v_and_b32 v105, 0xffff0000, v18
v_lshlrev_b32 v106, 16, v22
v_and_b32 v107, 0xffff0000, v22
v_lshlrev_b32 v108, 16, v26
v_and_b32 v109, 0xffff0000, v26
v_lshlrev_b32 v110, 16, v30
v_and_b32 v111, 0xffff0000, v30
v_lshlrev_b32 v112, 16, v34
v_and_b32 v113, 0xffff0000, v34
v_lshlrev_b32 v114, 16, v38
v_and_b32 v115, 0xffff0000, v38
v_lshlrev_b32 v116, 16, v42
v_and_b32 v117, 0xffff0000, v42
v_lshlrev_b32 v118, 16, v46
v_and_b32 v119, 0xffff0000, v46
v_lshlrev_b32 v120, 16, v50
v_and_b32 v121, 0xffff0000, v50
v_pk_mul_f32 v[122:123], v[106:107], v[72:73]
v_pk_mul_f32 v[124:125], v[108:109], v[72:73]
v_pk_mul_f32 v[126:127], v[110:111], v[72:73]
v_pk_mul_f32 v[128:129], v[112:113], v[72:73]
v_pk_fma_f32 v[122:123], v[104:105], v[80:81], v[122:123]
v_pk_fma_f32 v[124:125], v[106:107], v[80:81], v[124:125]
v_pk_fma_f32 v[126:127], v[108:109], v[80:81], v[126:127]
v_pk_fma_f32 v[128:129], v[110:111], v[80:81], v[128:129]
v_pk_fma_f32 v[122:123], v[102:103], v[88:89], v[122:123]
v_pk_fma_f32 v[124:125], v[104:105], v[88:89], v[124:125]
v_pk_fma_f32 v[126:127], v[106:107], v[88:89], v[126:127]
v_pk_fma_f32 v[128:129], v[108:109], v[88:89], v[128:129]
v_pk_fma_f32 v[122:123], v[100:101], v[96:97], v[122:123]
v_pk_fma_f32 v[124:125], v[102:103], v[96:97], v[124:125]
v_pk_fma_f32 v[126:127], v[104:105], v[96:97], v[126:127]
v_pk_fma_f32 v[128:129], v[106:107], v[96:97], v[128:129]
v_pk_mul_f32 v[122:123], v[122:123], v[114:115]
v_pk_mul_f32 v[124:125], v[124:125], v[116:117]
v_pk_mul_f32 v[126:127], v[126:127], v[118:119]
v_pk_mul_f32 v[128:129], v[128:129], v[120:121]
v_cvt_pk_bf16_f32 v100, v128, v126
v_cvt_pk_bf16_f32 v101, v124, v122
ds_write_b64 v7, v[100:101] offset:576
v_cvt_pk_bf16_f32 v102, v129, v127
v_cvt_pk_bf16_f32 v103, v125, v123
ds_write_b64 v7, v[102:103] offset:720
v_lshlrev_b32 v100, 16, v11
v_and_b32 v101, 0xffff0000, v11
v_lshlrev_b32 v102, 16, v15
v_and_b32 v103, 0xffff0000, v15
v_lshlrev_b32 v104, 16, v19
v_and_b32 v105, 0xffff0000, v19
v_lshlrev_b32 v106, 16, v23
v_and_b32 v107, 0xffff0000, v23
v_lshlrev_b32 v108, 16, v27
v_and_b32 v109, 0xffff0000, v27
v_lshlrev_b32 v110, 16, v31
v_and_b32 v111, 0xffff0000, v31
v_lshlrev_b32 v112, 16, v35
v_and_b32 v113, 0xffff0000, v35
v_lshlrev_b32 v114, 16, v39
v_and_b32 v115, 0xffff0000, v39
v_lshlrev_b32 v116, 16, v43
v_and_b32 v117, 0xffff0000, v43
v_lshlrev_b32 v118, 16, v47
v_and_b32 v119, 0xffff0000, v47
v_lshlrev_b32 v120, 16, v51
v_and_b32 v121, 0xffff0000, v51
v_pk_mul_f32 v[122:123], v[106:107], v[74:75]
v_pk_mul_f32 v[124:125], v[108:109], v[74:75]
v_pk_mul_f32 v[126:127], v[110:111], v[74:75]
v_pk_mul_f32 v[128:129], v[112:113], v[74:75]
v_pk_fma_f32 v[122:123], v[104:105], v[82:83], v[122:123]
v_pk_fma_f32 v[124:125], v[106:107], v[82:83], v[124:125]
v_pk_fma_f32 v[126:127], v[108:109], v[82:83], v[126:127]
v_pk_fma_f32 v[128:129], v[110:111], v[82:83], v[128:129]
v_pk_fma_f32 v[122:123], v[102:103], v[90:91], v[122:123]
v_pk_fma_f32 v[124:125], v[104:105], v[90:91], v[124:125]
v_pk_fma_f32 v[126:127], v[106:107], v[90:91], v[126:127]
v_pk_fma_f32 v[128:129], v[108:109], v[90:91], v[128:129]
v_pk_fma_f32 v[122:123], v[100:101], v[98:99], v[122:123]
v_pk_fma_f32 v[124:125], v[102:103], v[98:99], v[124:125]
v_pk_fma_f32 v[126:127], v[104:105], v[98:99], v[126:127]
v_pk_fma_f32 v[128:129], v[106:107], v[98:99], v[128:129]
v_pk_mul_f32 v[122:123], v[122:123], v[114:115]
v_pk_mul_f32 v[124:125], v[124:125], v[116:117]
v_pk_mul_f32 v[126:127], v[126:127], v[118:119]
v_pk_mul_f32 v[128:129], v[128:129], v[120:121]
v_cvt_pk_bf16_f32 v100, v128, v126
v_cvt_pk_bf16_f32 v101, v124, v122
ds_write_b64 v7, v[100:101] offset:864
v_cvt_pk_bf16_f32 v102, v129, v127
v_cvt_pk_bf16_f32 v103, v125, v123
ds_write_b64 v7, v[102:103] offset:1008
s_mov_b64 exec, -1
v_lshrrev_b32 v2, 3, v0
v_and_b32 v3, 7, v0
v_lshlrev_b32 v3, 4, v3
v_mul_u32_u24 v4, 144, v2
v_add_u32 v4, v4, v3
v_add_u32 v4, 0, v4
v_lshl_add_u32 v5, v2, 12, v3
s_mul_i32 s6, s69, 327680
s_lshl_b32 s7, s68, 7
s_sub_u32 s6, s6, s7
s_add_u32 s70, s6, 1052544
s_add_u32 s71, s70, 131072
s_add_u32 s72, s70, 262144
s_waitcnt lgkmcnt(0)
s_barrier
ds_read_b128 v[8:11], v4
ds_read_b128 v[12:15], v4 offset:4608
s_waitcnt lgkmcnt(1)
buffer_store_dwordx4 v[8:11], v5, s[24:27], s70 offen sc1
s_waitcnt lgkmcnt(0)
buffer_store_dwordx4 v[12:15], v5, s[24:27], s71 offen sc1
s_cmp_ge_u32 s5, 2
s_cbranch_scc1 L_p0skip_2
ds_read_b128 v[16:19], v4 offset:9216
s_waitcnt lgkmcnt(0)
buffer_store_dwordx4 v[16:19], v5, s[24:27], s72 offen sc1
L_p0skip_2:
s_cmp_lt_u32 s4, 28
s_cbranch_scc1 L_end_1
s_lshl_b32 s73, s3, 2
s_add_u32 s73, s73, s4
s_sub_u32 s73, s73, 28
s_lshl_b32 s6, s73, 6
s_lshl_b32 s7, s5, 4
s_add_u32 s74, s6, s7
v_and_b32 v2, 15, v1
v_lshrrev_b32 v3, 4, v1
v_add_u32 v4, s74, v2
v_mul_u32_u24 v4, 1280, v4
v_lshl_add_u32 v4, v3, 4, v4
buffer_load_dwordx4 v[8:11], v4, s[8:11], 0 offen offset:0
buffer_load_dwordx4 v[12:15], v4, s[8:11], 0 offen offset:64
buffer_load_dwordx4 v[16:19], v4, s[8:11], 0 offen offset:128
buffer_load_dwordx4 v[20:23], v4, s[8:11], 0 offen offset:192
buffer_load_dwordx4 v[24:27], v4, s[8:11], 0 offen offset:256
buffer_load_dwordx4 v[28:31], v4, s[8:11], 0 offen offset:320
buffer_load_dwordx4 v[32:35], v4, s[8:11], 0 offen offset:384
buffer_load_dwordx4 v[36:39], v4, s[8:11], 0 offen offset:448
buffer_load_dwordx4 v[40:43], v4, s[8:11], 0 offen offset:512
buffer_load_dwordx4 v[44:47], v4, s[8:11], 0 offen offset:576
buffer_load_dwordx4 v[48:51], v4, s[8:11], 0 offen offset:640
buffer_load_dwordx4 v[52:55], v4, s[8:11], 0 offen offset:704
buffer_load_dwordx4 v[56:59], v4, s[8:11], 0 offen offset:768
buffer_load_dwordx4 v[60:63], v4, s[8:11], 0 offen offset:832
buffer_load_dwordx4 v[64:67], v4, s[8:11], 0 offen offset:896
buffer_load_dwordx4 v[68:71], v4, s[8:11], 0 offen offset:960
buffer_load_dwordx4 v[72:75], v4, s[8:11], 0 offen offset:1024
buffer_load_dwordx4 v[76:79], v4, s[8:11], 0 offen offset:1088
buffer_load_dwordx4 v[80:83], v4, s[8:11], 0 offen offset:1152
buffer_load_dwordx4 v[84:87], v4, s[8:11], 0 offen offset:1216
v_mov_b32 v88, 0x3f803f80
v_mov_b32 v89, 0x3f803f80
v_mov_b32 v90, 0x3f803f80
v_mov_b32 v91, 0x3f803f80
v_mov_b32 v92, 0
v_mov_b32 v93, 0
v_mov_b32 v94, 0
v_mov_b32 v95, 0
v_mov_b32 v96, 0
v_mov_b32 v97, 0
v_mov_b32 v98, 0
v_mov_b32 v99, 0
s_waitcnt vmcnt(19)
v_mfma_f32_16x16x32_bf16 v[92:95], v[8:11], v[8:11], v[92:95]
v_mfma_f32_16x16x32_bf16 v[96:99], v[8:11], v[88:91], v[96:99]
s_waitcnt vmcnt(18)
v_mfma_f32_16x16x32_bf16 v[92:95], v[12:15], v[12:15], v[92:95]
v_mfma_f32_16x16x32_bf16 v[96:99], v[12:15], v[88:91], v[96:99]
s_waitcnt vmcnt(17)
v_mfma_f32_16x16x32_bf16 v[92:95], v[16:19], v[16:19], v[92:95]
v_mfma_f32_16x16x32_bf16 v[96:99], v[16:19], v[88:91], v[96:99]
s_waitcnt vmcnt(16)
v_mfma_f32_16x16x32_bf16 v[92:95], v[20:23], v[20:23], v[92:95]
v_mfma_f32_16x16x32_bf16 v[96:99], v[20:23], v[88:91], v[96:99]
s_waitcnt vmcnt(15)
v_mfma_f32_16x16x32_bf16 v[92:95], v[24:27], v[24:27], v[92:95]
v_mfma_f32_16x16x32_bf16 v[96:99], v[24:27], v[88:91], v[96:99]
s_waitcnt vmcnt(14)
v_mfma_f32_16x16x32_bf16 v[92:95], v[28:31], v[28:31], v[92:95]
v_mfma_f32_16x16x32_bf16 v[96:99], v[28:31], v[88:91], v[96:99]
s_waitcnt vmcnt(13)
v_mfma_f32_16x16x32_bf16 v[92:95], v[32:35], v[32:35], v[92:95]
v_mfma_f32_16x16x32_bf16 v[96:99], v[32:35], v[88:91], v[96:99]
s_waitcnt vmcnt(12)
v_mfma_f32_16x16x32_bf16 v[92:95], v[36:39], v[36:39], v[92:95]
v_mfma_f32_16x16x32_bf16 v[96:99], v[36:39], v[88:91], v[96:99]
s_waitcnt vmcnt(11)
v_mfma_f32_16x16x32_bf16 v[92:95], v[40:43], v[40:43], v[92:95]
v_mfma_f32_16x16x32_bf16 v[96:99], v[40:43], v[88:91], v[96:99]
s_waitcnt vmcnt(10)
v_mfma_f32_16x16x32_bf16 v[92:95], v[44:47], v[44:47], v[92:95]
v_mfma_f32_16x16x32_bf16 v[96:99], v[44:47], v[88:91], v[96:99]
s_waitcnt vmcnt(9)
v_mfma_f32_16x16x32_bf16 v[92:95], v[48:51], v[48:51], v[92:95]
v_mfma_f32_16x16x32_bf16 v[96:99], v[48:51], v[88:91], v[96:99]
s_waitcnt vmcnt(8)
v_mfma_f32_16x16x32_bf16 v[92:95], v[52:55], v[52:55], v[92:95]
v_mfma_f32_16x16x32_bf16 v[96:99], v[52:55], v[88:91], v[96:99]
s_waitcnt vmcnt(7)
v_mfma_f32_16x16x32_bf16 v[92:95], v[56:59], v[56:59], v[92:95]
v_mfma_f32_16x16x32_bf16 v[96:99], v[56:59], v[88:91], v[96:99]
s_waitcnt vmcnt(6)
v_mfma_f32_16x16x32_bf16 v[92:95], v[60:63], v[60:63], v[92:95]
v_mfma_f32_16x16x32_bf16 v[96:99], v[60:63], v[88:91], v[96:99]
s_waitcnt vmcnt(5)
v_mfma_f32_16x16x32_bf16 v[92:95], v[64:67], v[64:67], v[92:95]
v_mfma_f32_16x16x32_bf16 v[96:99], v[64:67], v[88:91], v[96:99]
s_waitcnt vmcnt(4)
v_mfma_f32_16x16x32_bf16 v[92:95], v[68:71], v[68:71], v[92:95]
v_mfma_f32_16x16x32_bf16 v[96:99], v[68:71], v[88:91], v[96:99]
s_waitcnt vmcnt(3)
v_mfma_f32_16x16x32_bf16 v[92:95], v[72:75], v[72:75], v[92:95]
v_mfma_f32_16x16x32_bf16 v[96:99], v[72:75], v[88:91], v[96:99]
s_waitcnt vmcnt(2)
v_mfma_f32_16x16x32_bf16 v[92:95], v[76:79], v[76:79], v[92:95]
v_mfma_f32_16x16x32_bf16 v[96:99], v[76:79], v[88:91], v[96:99]
s_waitcnt vmcnt(1)
v_mfma_f32_16x16x32_bf16 v[92:95], v[80:83], v[80:83], v[92:95]
v_mfma_f32_16x16x32_bf16 v[96:99], v[80:83], v[88:91], v[96:99]
s_waitcnt vmcnt(0)
v_mfma_f32_16x16x32_bf16 v[92:95], v[84:87], v[84:87], v[92:95]
v_mfma_f32_16x16x32_bf16 v[96:99], v[84:87], v[88:91], v[96:99]
v_and_b32 v5, 1, v1
v_cmp_eq_u32 vcc, 1, v5
v_and_b32 v5, 2, v1
v_cmp_eq_u32 s[6:7], 2, v5
s_nop 7
v_cndmask_b32 v8, v92, v93, vcc
v_cndmask_b32 v9, v94, v95, vcc
v_cndmask_b32 v10, v96, v97, vcc
v_cndmask_b32 v11, v98, v99, vcc
v_cndmask_b32 v8, v8, v9, s[6:7]
v_cndmask_b32 v9, v10, v11, s[6:7]
v_mul_f32 v12, 0.0015625, v9
v_mul_f32 v8, 0.0015625, v8
v_fma_f32 v8, -v12, v12, v8
v_max_f32 v8, 0, v8
v_add_f32 v8, 0x3727c5ac, v8
v_sqrt_f32 v14, v8
s_nop 0
v_rcp_f32 v13, v14
v_mov_b32 v15, 0
v_sub_f32 v16, 0, v12
v_cvt_pk_bf16_f32 v17, v14, v16
v_lshlrev_b32 v18, 16, v17
v_and_b32 v19, 0xffff0000, v17
v_sub_f32 v18, v14, v18
v_sub_f32 v19, v16, v19
v_cvt_pk_bf16_f32 v18, v18, v19
s_mov_b32 s6, 0x05040100
s_mov_b32 s7, 0x07060302
v_perm_b32 v20, v18, v17, s6
v_perm_b32 v21, v18, v17, s7
v_mov_b32 v22, v21
v_mov_b32 v23, 0
v_and_b32 v5, 3, v1
v_lshl_add_u32 v5, v3, 2, v5
v_add_u32 v5, s74, v5
v_lshlrev_b32 v5, 4, v5
s_mov_b32 s6, 65536
s_mov_b32 s7, 98304
s_mov_b32 exec_lo, 0x00f0000f
s_mov_b32 exec_hi, 0xf0000f00
buffer_store_dwordx4 v[20:23], v5, s[24:27], s6 offen sc1
buffer_store_dwordx4 v[12:15], v5, s[24:27], s7 offen sc1
s_mov_b64 exec, -1
s_cmp_ge_u32 s73, 27
s_cbranch_scc1 L_end_1
s_barrier
s_mov_b32 s32, s56
s_and_b32 s33, s57, 0xffff
s_mov_b32 s34, 3456
s_mov_b32 s35, 0x20000
v_lshrrev_b32 v2, 3, v0
v_and_b32 v3, 7, v0
v_mul_u32_u24 v4, 3456, v2
v_lshl_add_u32 v4, v3, 4, v4
s_lshl_b32 s6, s73, 7
buffer_load_dwordx4 v[8:11], v4, s[20:23], s6 offen
s_add_u32 s6, s6, 110592
buffer_load_dwordx4 v[12:15], v4, s[20:23], s6 offen
s_add_u32 s6, s6, 110592
buffer_load_dwordx4 v[16:19], v4, s[20:23], s6 offen
s_add_u32 s6, s6, 110592
buffer_load_dwordx4 v[20:23], v4, s[20:23], s6 offen
s_add_u32 s6, s6, 110592
buffer_load_dwordx4 v[24:27], v4, s[20:23], s6 offen
s_add_u32 s6, s6, 110592
buffer_load_dwordx4 v[28:31], v4, s[20:23], s6 offen
s_add_u32 s6, s6, 110592
buffer_load_dwordx4 v[32:35], v4, s[20:23], s6 offen
s_add_u32 s6, s6, 110592
buffer_load_dwordx4 v[36:39], v4, s[20:23], s6 offen
s_add_u32 s6, s6, 110592
buffer_load_dwordx4 v[40:43], v4, s[20:23], s6 offen
s_add_u32 s6, s6, 110592
buffer_load_dwordx4 v[44:47], v4, s[20:23], s6 offen
s_add_u32 s6, s6, 110592
buffer_load_dwordx4 v[48:51], v4, s[20:23], s6 offen
s_add_u32 s6, s6, 110592
buffer_load_dwordx4 v[52:55], v4, s[20:23], s6 offen
s_add_u32 s6, s6, 110592
buffer_load_dwordx4 v[56:59], v4, s[20:23], s6 offen
s_add_u32 s6, s6, 110592
buffer_load_dwordx4 v[60:63], v4, s[20:23], s6 offen
s_add_u32 s6, s6, 110592
buffer_load_dwordx4 v[64:67], v4, s[20:23], s6 offen
s_add_u32 s6, s6, 110592
buffer_load_dwordx4 v[68:71], v4, s[20:23], s6 offen
s_add_u32 s6, s6, 110592
buffer_load_dwordx4 v[72:75], v4, s[20:23], s6 offen
s_add_u32 s6, s6, 110592
buffer_load_dwordx4 v[76:79], v4, s[20:23], s6 offen
s_add_u32 s6, s6, 110592
buffer_load_dwordx4 v[80:83], v4, s[20:23], s6 offen
s_add_u32 s6, s6, 110592
buffer_load_dwordx4 v[84:87], v4, s[20:23], s6 offen
s_lshl_b32 s7, s73, 7
v_lshlrev_b32 v5, 1, v1
buffer_load_ushort v6, v5, s[32:35], s7 offen
v_mov_b32 v88, 0
v_mov_b32 v89, 0
v_mov_b32 v90, 0
v_mov_b32 v91, 0
v_mov_b32 v92, 0
v_mov_b32 v93, 0
v_mov_b32 v94, 0
v_mov_b32 v95, 0
s_waitcnt vmcnt(20)
v_lshlrev_b32 v100, 16, v8
v_and_b32 v101, 0xffff0000, v8
v_pk_add_f32 v[88:89], v[88:89], v[100:101]
v_lshlrev_b32 v100, 16, v9
v_and_b32 v101, 0xffff0000, v9
v_pk_add_f32 v[90:91], v[90:91], v[100:101]
v_lshlrev_b32 v100, 16, v10
v_and_b32 v101, 0xffff0000, v10
v_pk_add_f32 v[92:93], v[92:93], v[100:101]
v_lshlrev_b32 v100, 16, v11
v_and_b32 v101, 0xffff0000, v11
v_pk_add_f32 v[94:95], v[94:95], v[100:101]
s_waitcnt vmcnt(19)
v_lshlrev_b32 v100, 16, v12
v_and_b32 v101, 0xffff0000, v12
v_pk_add_f32 v[88:89], v[88:89], v[100:101]
v_lshlrev_b32 v100, 16, v13
v_and_b32 v101, 0xffff0000, v13
v_pk_add_f32 v[90:91], v[90:91], v[100:101]
v_lshlrev_b32 v100, 16, v14
v_and_b32 v101, 0xffff0000, v14
v_pk_add_f32 v[92:93], v[92:93], v[100:101]
v_lshlrev_b32 v100, 16, v15
v_and_b32 v101, 0xffff0000, v15
v_pk_add_f32 v[94:95], v[94:95], v[100:101]
s_waitcnt vmcnt(18)
v_lshlrev_b32 v100, 16, v16
v_and_b32 v101, 0xffff0000, v16
v_pk_add_f32 v[88:89], v[88:89], v[100:101]
v_lshlrev_b32 v100, 16, v17
v_and_b32 v101, 0xffff0000, v17
v_pk_add_f32 v[90:91], v[90:91], v[100:101]
v_lshlrev_b32 v100, 16, v18
v_and_b32 v101, 0xffff0000, v18
v_pk_add_f32 v[92:93], v[92:93], v[100:101]
v_lshlrev_b32 v100, 16, v19
v_and_b32 v101, 0xffff0000, v19
v_pk_add_f32 v[94:95], v[94:95], v[100:101]
s_waitcnt vmcnt(17)
v_lshlrev_b32 v100, 16, v20
v_and_b32 v101, 0xffff0000, v20
v_pk_add_f32 v[88:89], v[88:89], v[100:101]
v_lshlrev_b32 v100, 16, v21
v_and_b32 v101, 0xffff0000, v21
v_pk_add_f32 v[90:91], v[90:91], v[100:101]
v_lshlrev_b32 v100, 16, v22
v_and_b32 v101, 0xffff0000, v22
v_pk_add_f32 v[92:93], v[92:93], v[100:101]
v_lshlrev_b32 v100, 16, v23
v_and_b32 v101, 0xffff0000, v23
v_pk_add_f32 v[94:95], v[94:95], v[100:101]
s_waitcnt vmcnt(16)
v_lshlrev_b32 v100, 16, v24
v_and_b32 v101, 0xffff0000, v24
v_pk_add_f32 v[88:89], v[88:89], v[100:101]
v_lshlrev_b32 v100, 16, v25
v_and_b32 v101, 0xffff0000, v25
v_pk_add_f32 v[90:91], v[90:91], v[100:101]
v_lshlrev_b32 v100, 16, v26
v_and_b32 v101, 0xffff0000, v26
v_pk_add_f32 v[92:93], v[92:93], v[100:101]
v_lshlrev_b32 v100, 16, v27
v_and_b32 v101, 0xffff0000, v27
v_pk_add_f32 v[94:95], v[94:95], v[100:101]
s_waitcnt vmcnt(15)
v_lshlrev_b32 v100, 16, v28
v_and_b32 v101, 0xffff0000, v28
v_pk_add_f32 v[88:89], v[88:89], v[100:101]
v_lshlrev_b32 v100, 16, v29
v_and_b32 v101, 0xffff0000, v29
v_pk_add_f32 v[90:91], v[90:91], v[100:101]
v_lshlrev_b32 v100, 16, v30
v_and_b32 v101, 0xffff0000, v30
v_pk_add_f32 v[92:93], v[92:93], v[100:101]
v_lshlrev_b32 v100, 16, v31
v_and_b32 v101, 0xffff0000, v31
v_pk_add_f32 v[94:95], v[94:95], v[100:101]
s_waitcnt vmcnt(14)
v_lshlrev_b32 v100, 16, v32
v_and_b32 v101, 0xffff0000, v32
v_pk_add_f32 v[88:89], v[88:89], v[100:101]
v_lshlrev_b32 v100, 16, v33
v_and_b32 v101, 0xffff0000, v33
v_pk_add_f32 v[90:91], v[90:91], v[100:101]
v_lshlrev_b32 v100, 16, v34
v_and_b32 v101, 0xffff0000, v34
v_pk_add_f32 v[92:93], v[92:93], v[100:101]
v_lshlrev_b32 v100, 16, v35
v_and_b32 v101, 0xffff0000, v35
v_pk_add_f32 v[94:95], v[94:95], v[100:101]
s_waitcnt vmcnt(13)
v_lshlrev_b32 v100, 16, v36
v_and_b32 v101, 0xffff0000, v36
v_pk_add_f32 v[88:89], v[88:89], v[100:101]
v_lshlrev_b32 v100, 16, v37
v_and_b32 v101, 0xffff0000, v37
v_pk_add_f32 v[90:91], v[90:91], v[100:101]
v_lshlrev_b32 v100, 16, v38
v_and_b32 v101, 0xffff0000, v38
v_pk_add_f32 v[92:93], v[92:93], v[100:101]
v_lshlrev_b32 v100, 16, v39
v_and_b32 v101, 0xffff0000, v39
v_pk_add_f32 v[94:95], v[94:95], v[100:101]
s_waitcnt vmcnt(12)
v_lshlrev_b32 v100, 16, v40
v_and_b32 v101, 0xffff0000, v40
v_pk_add_f32 v[88:89], v[88:89], v[100:101]
v_lshlrev_b32 v100, 16, v41
v_and_b32 v101, 0xffff0000, v41
v_pk_add_f32 v[90:91], v[90:91], v[100:101]
v_lshlrev_b32 v100, 16, v42
v_and_b32 v101, 0xffff0000, v42
v_pk_add_f32 v[92:93], v[92:93], v[100:101]
v_lshlrev_b32 v100, 16, v43
v_and_b32 v101, 0xffff0000, v43
v_pk_add_f32 v[94:95], v[94:95], v[100:101]
s_waitcnt vmcnt(11)
v_lshlrev_b32 v100, 16, v44
v_and_b32 v101, 0xffff0000, v44
v_pk_add_f32 v[88:89], v[88:89], v[100:101]
v_lshlrev_b32 v100, 16, v45
v_and_b32 v101, 0xffff0000, v45
v_pk_add_f32 v[90:91], v[90:91], v[100:101]
v_lshlrev_b32 v100, 16, v46
v_and_b32 v101, 0xffff0000, v46
v_pk_add_f32 v[92:93], v[92:93], v[100:101]
v_lshlrev_b32 v100, 16, v47
v_and_b32 v101, 0xffff0000, v47
v_pk_add_f32 v[94:95], v[94:95], v[100:101]
s_waitcnt vmcnt(10)
v_lshlrev_b32 v100, 16, v48
v_and_b32 v101, 0xffff0000, v48
v_pk_add_f32 v[88:89], v[88:89], v[100:101]
v_lshlrev_b32 v100, 16, v49
v_and_b32 v101, 0xffff0000, v49
v_pk_add_f32 v[90:91], v[90:91], v[100:101]
v_lshlrev_b32 v100, 16, v50
v_and_b32 v101, 0xffff0000, v50
v_pk_add_f32 v[92:93], v[92:93], v[100:101]
v_lshlrev_b32 v100, 16, v51
v_and_b32 v101, 0xffff0000, v51
v_pk_add_f32 v[94:95], v[94:95], v[100:101]
s_waitcnt vmcnt(9)
v_lshlrev_b32 v100, 16, v52
v_and_b32 v101, 0xffff0000, v52
v_pk_add_f32 v[88:89], v[88:89], v[100:101]
v_lshlrev_b32 v100, 16, v53
v_and_b32 v101, 0xffff0000, v53
v_pk_add_f32 v[90:91], v[90:91], v[100:101]
v_lshlrev_b32 v100, 16, v54
v_and_b32 v101, 0xffff0000, v54
v_pk_add_f32 v[92:93], v[92:93], v[100:101]
v_lshlrev_b32 v100, 16, v55
v_and_b32 v101, 0xffff0000, v55
v_pk_add_f32 v[94:95], v[94:95], v[100:101]
s_waitcnt vmcnt(8)
v_lshlrev_b32 v100, 16, v56
v_and_b32 v101, 0xffff0000, v56
v_pk_add_f32 v[88:89], v[88:89], v[100:101]
v_lshlrev_b32 v100, 16, v57
v_and_b32 v101, 0xffff0000, v57
v_pk_add_f32 v[90:91], v[90:91], v[100:101]
v_lshlrev_b32 v100, 16, v58
v_and_b32 v101, 0xffff0000, v58
v_pk_add_f32 v[92:93], v[92:93], v[100:101]
v_lshlrev_b32 v100, 16, v59
v_and_b32 v101, 0xffff0000, v59
v_pk_add_f32 v[94:95], v[94:95], v[100:101]
s_waitcnt vmcnt(7)
v_lshlrev_b32 v100, 16, v60
v_and_b32 v101, 0xffff0000, v60
v_pk_add_f32 v[88:89], v[88:89], v[100:101]
v_lshlrev_b32 v100, 16, v61
v_and_b32 v101, 0xffff0000, v61
v_pk_add_f32 v[90:91], v[90:91], v[100:101]
v_lshlrev_b32 v100, 16, v62
v_and_b32 v101, 0xffff0000, v62
v_pk_add_f32 v[92:93], v[92:93], v[100:101]
v_lshlrev_b32 v100, 16, v63
v_and_b32 v101, 0xffff0000, v63
v_pk_add_f32 v[94:95], v[94:95], v[100:101]
s_waitcnt vmcnt(6)
v_lshlrev_b32 v100, 16, v64
v_and_b32 v101, 0xffff0000, v64
v_pk_add_f32 v[88:89], v[88:89], v[100:101]
v_lshlrev_b32 v100, 16, v65
v_and_b32 v101, 0xffff0000, v65
v_pk_add_f32 v[90:91], v[90:91], v[100:101]
v_lshlrev_b32 v100, 16, v66
v_and_b32 v101, 0xffff0000, v66
v_pk_add_f32 v[92:93], v[92:93], v[100:101]
v_lshlrev_b32 v100, 16, v67
v_and_b32 v101, 0xffff0000, v67
v_pk_add_f32 v[94:95], v[94:95], v[100:101]
s_waitcnt vmcnt(5)
v_lshlrev_b32 v100, 16, v68
v_and_b32 v101, 0xffff0000, v68
v_pk_add_f32 v[88:89], v[88:89], v[100:101]
v_lshlrev_b32 v100, 16, v69
v_and_b32 v101, 0xffff0000, v69
v_pk_add_f32 v[90:91], v[90:91], v[100:101]
v_lshlrev_b32 v100, 16, v70
v_and_b32 v101, 0xffff0000, v70
v_pk_add_f32 v[92:93], v[92:93], v[100:101]
v_lshlrev_b32 v100, 16, v71
v_and_b32 v101, 0xffff0000, v71
v_pk_add_f32 v[94:95], v[94:95], v[100:101]
s_waitcnt vmcnt(4)
v_lshlrev_b32 v100, 16, v72
v_and_b32 v101, 0xffff0000, v72
v_pk_add_f32 v[88:89], v[88:89], v[100:101]
v_lshlrev_b32 v100, 16, v73
v_and_b32 v101, 0xffff0000, v73
v_pk_add_f32 v[90:91], v[90:91], v[100:101]
v_lshlrev_b32 v100, 16, v74
v_and_b32 v101, 0xffff0000, v74
v_pk_add_f32 v[92:93], v[92:93], v[100:101]
v_lshlrev_b32 v100, 16, v75
v_and_b32 v101, 0xffff0000, v75
v_pk_add_f32 v[94:95], v[94:95], v[100:101]
s_waitcnt vmcnt(3)
v_lshlrev_b32 v100, 16, v76
v_and_b32 v101, 0xffff0000, v76
v_pk_add_f32 v[88:89], v[88:89], v[100:101]
v_lshlrev_b32 v100, 16, v77
v_and_b32 v101, 0xffff0000, v77
v_pk_add_f32 v[90:91], v[90:91], v[100:101]
v_lshlrev_b32 v100, 16, v78
v_and_b32 v101, 0xffff0000, v78
v_pk_add_f32 v[92:93], v[92:93], v[100:101]
v_lshlrev_b32 v100, 16, v79
v_and_b32 v101, 0xffff0000, v79
v_pk_add_f32 v[94:95], v[94:95], v[100:101]
s_waitcnt vmcnt(2)
v_lshlrev_b32 v100, 16, v80
v_and_b32 v101, 0xffff0000, v80
v_pk_add_f32 v[88:89], v[88:89], v[100:101]
v_lshlrev_b32 v100, 16, v81
v_and_b32 v101, 0xffff0000, v81
v_pk_add_f32 v[90:91], v[90:91], v[100:101]
v_lshlrev_b32 v100, 16, v82
v_and_b32 v101, 0xffff0000, v82
v_pk_add_f32 v[92:93], v[92:93], v[100:101]
v_lshlrev_b32 v100, 16, v83
v_and_b32 v101, 0xffff0000, v83
v_pk_add_f32 v[94:95], v[94:95], v[100:101]
s_waitcnt vmcnt(1)
v_lshlrev_b32 v100, 16, v84
v_and_b32 v101, 0xffff0000, v84
v_pk_add_f32 v[88:89], v[88:89], v[100:101]
v_lshlrev_b32 v100, 16, v85
v_and_b32 v101, 0xffff0000, v85
v_pk_add_f32 v[90:91], v[90:91], v[100:101]
v_lshlrev_b32 v100, 16, v86
v_and_b32 v101, 0xffff0000, v86
v_pk_add_f32 v[92:93], v[92:93], v[100:101]
v_lshlrev_b32 v100, 16, v87
v_and_b32 v101, 0xffff0000, v87
v_pk_add_f32 v[94:95], v[94:95], v[100:101]
v_lshlrev_b32 v4, 8, v2
v_lshl_add_u32 v4, v3, 5, v4
v_add_u32 v4, 0, v4
ds_write_b128 v4, v[88:91]
ds_write_b128 v4, v[92:95] offset:16
s_waitcnt lgkmcnt(0)
s_barrier
s_cmp_lg_u32 s5, 0
s_cbranch_scc1 L_csskip_3
v_lshlrev_b32 v4, 2, v1
v_add_u32 v4, 0, v4
ds_read_b32 v8, v4 offset:0
ds_read_b32 v9, v4 offset:256
ds_read_b32 v10, v4 offset:512
ds_read_b32 v11, v4 offset:768
ds_read_b32 v12, v4 offset:1024
ds_read_b32 v13, v4 offset:1280
ds_read_b32 v14, v4 offset:1536
ds_read_b32 v15, v4 offset:1792
ds_read_b32 v16, v4 offset:2048
ds_read_b32 v17, v4 offset:2304
ds_read_b32 v18, v4 offset:2560
ds_read_b32 v19, v4 offset:2816
ds_read_b32 v20, v4 offset:3072
ds_read_b32 v21, v4 offset:3328
ds_read_b32 v22, v4 offset:3584
ds_read_b32 v23, v4 offset:3840
ds_read_b32 v24, v4 offset:4096
ds_read_b32 v25, v4 offset:4352
ds_read_b32 v26, v4 offset:4608
ds_read_b32 v27, v4 offset:4864
ds_read_b32 v28, v4 offset:5120
ds_read_b32 v29, v4 offset:5376
ds_read_b32 v30, v4 offset:5632
ds_read_b32 v31, v4 offset:5888
ds_read_b32 v32, v4 offset:6144
ds_read_b32 v33, v4 offset:6400
ds_read_b32 v34, v4 offset:6656
ds_read_b32 v35, v4 offset:6912
ds_read_b32 v36, v4 offset:7168
ds_read_b32 v37, v4 offset:7424
ds_read_b32 v38, v4 offset:7680
ds_read_b32 v39, v4 offset:7936
s_waitcnt lgkmcnt(0)
v_add_f32 v8, v8, v24
v_add_f32 v9, v9, v25
v_add_f32 v10, v10, v26
v_add_f32 v11, v11, v27
v_add_f32 v12, v12, v28
v_add_f32 v13, v13, v29
v_add_f32 v14, v14, v30
v_add_f32 v15, v15, v31
v_add_f32 v16, v16, v32
v_add_f32 v17, v17, v33
v_add_f32 v18, v18, v34
v_add_f32 v19, v19, v35
v_add_f32 v20, v20, v36
v_add_f32 v21, v21, v37
v_add_f32 v22, v22, v38
v_add_f32 v23, v23, v39
v_add_f32 v8, v8, v16
v_add_f32 v9, v9, v17
v_add_f32 v10, v10, v18
v_add_f32 v11, v11, v19
v_add_f32 v12, v12, v20
v_add_f32 v13, v13, v21
v_add_f32 v14, v14, v22
v_add_f32 v15, v15, v23
v_add_f32 v8, v8, v12
v_add_f32 v9, v9, v13
v_add_f32 v10, v10, v14
v_add_f32 v11, v11, v15
v_add_f32 v8, v8, v10
v_add_f32 v9, v9, v11
v_add_f32 v8, v8, v9
s_waitcnt vmcnt(0)
v_cvt_pk_bf16_f32 v9, v8, v8
v_lshlrev_b32 v10, 16, v9
v_sub_f32 v10, v8, v10
v_cvt_pk_bf16_f32 v10, v10, v10
v_lshl_or_b32 v8, v6, 16, v6
v_mov_b32 v11, 0
s_lshl_b32 s6, s73, 10
s_add_u32 s6, s6, 131072
v_lshlrev_b32 v4, 4, v1
buffer_store_dwordx4 v[8:11], v4, s[24:27], s6 offen sc1
L_csskip_3:
s_barrier
s_mov_b32 s32, s58
s_and_b32 s33, s59, 0xffff
s_mov_b32 s34, 2211840
s_mov_b32 s35, 0x20000
v_lshrrev_b32 v2, 4, v1
v_and_b32 v3, 15, v1
v_add_u32 v4, 0, v2
v_and_b32 v5, 7, v4
v_lshlrev_b32 v5, 1, v5
v_xor_b32 v5, v3, v5
v_mul_u32_u24 v4, 1280, v4
v_lshl_add_u32 v4, v5, 4, v4
v_subrev_u32 v8, 0, v4
v_add_u32 v4, 4, v2
v_and_b32 v5, 7, v4
v_lshlrev_b32 v5, 1, v5
v_xor_b32 v5, v3, v5
v_mul_u32_u24 v4, 1280, v4
v_lshl_add_u32 v4, v5, 4, v4
v_subrev_u32 v9, 1024, v4
v_add_u32 v4, 8, v2
v_and_b32 v5, 7, v4
v_lshlrev_b32 v5, 1, v5
v_xor_b32 v5, v3, v5
v_mul_u32_u24 v4, 1280, v4
v_lshl_add_u32 v4, v5, 4, v4
v_subrev_u32 v10, 2048, v4
v_add_u32 v4, 12, v2
v_and_b32 v5, 7, v4
v_lshlrev_b32 v5, 1, v5
v_xor_b32 v5, v3, v5
v_mul_u32_u24 v4, 1280, v4
v_lshl_add_u32 v4, v5, 4, v4
v_subrev_u32 v11, 3072, v4
s_lshl_b32 s6, s73, 2
s_add_u32 s6, s6, s5
s_mul_i32 s6, s6, 20480
s_lshl_b32 s7, s5, 12
s_add_u32 s7, s7, 0
s_mov_b32 m0, s7
s_add_u32 s7, s7, 16384
buffer_load_dwordx4 v8, s[32:35], s6 offen offset:0 lds
buffer_load_dwordx4 v9, s[32:35], s6 offen offset:1024 lds
buffer_load_dwordx4 v10, s[32:35], s6 offen offset:2048 lds
buffer_load_dwordx4 v11, s[32:35], s6 offen offset:3072 lds
s_add_u32 s6, s6, 256
s_mov_b32 m0, s7
s_add_u32 s7, s7, 16384
buffer_load_dwordx4 v8, s[32:35], s6 offen offset:0 lds
buffer_load_dwordx4 v9, s[32:35], s6 offen offset:1024 lds
buffer_load_dwordx4 v10, s[32:35], s6 offen offset:2048 lds
buffer_load_dwordx4 v11, s[32:35], s6 offen offset:3072 lds
s_add_u32 s6, s6, 256
s_mov_b32 m0, s7
s_add_u32 s7, s7, 16384
buffer_load_dwordx4 v8, s[32:35], s6 offen offset:0 lds
buffer_load_dwordx4 v9, s[32:35], s6 offen offset:1024 lds
buffer_load_dwordx4 v10, s[32:35], s6 offen offset:2048 lds
buffer_load_dwordx4 v11, s[32:35], s6 offen offset:3072 lds
s_add_u32 s6, s6, 256
s_mov_b32 m0, s7
s_add_u32 s7, s7, 16384
buffer_load_dwordx4 v8, s[32:35], s6 offen offset:0 lds
buffer_load_dwordx4 v9, s[32:35], s6 offen offset:1024 lds
buffer_load_dwordx4 v10, s[32:35], s6 offen offset:2048 lds
buffer_load_dwordx4 v11, s[32:35], s6 offen offset:3072 lds
s_add_u32 s6, s6, 256
s_mov_b32 m0, s7
s_add_u32 s7, s7, 16384
buffer_load_dwordx4 v8, s[32:35], s6 offen offset:0 lds
buffer_load_dwordx4 v9, s[32:35], s6 offen offset:1024 lds
buffer_load_dwordx4 v10, s[32:35], s6 offen offset:2048 lds
buffer_load_dwordx4 v11, s[32:35], s6 offen offset:3072 lds
s_add_u32 s6, s6, 256
v_lshrrev_b32 v2, 4, v1
v_bfe_u32 v3, v1, 2, 2
v_and_b32 v4, 3, v1
v_lshrrev_b32 v5, 1, v2
v_lshlrev_b32 v5, 4, v5
v_and_b32 v6, 1, v2
v_lshl_add_u32 v6, v6, 2, v3
v_add_u32 v5, v5, v6
v_lshlrev_b32 v12, 8, v5
v_lshlrev_b32 v13, 1, v6
v_mul_u32_u24 v14, 40, v4
v_lshlrev_b32 v15, 4, v1
s_waitcnt vmcnt(0)
s_barrier
s_mul_i32 s6, s5, 320
s_lshl_b32 s7, s73, 1
v_add_u32 v16, s6, v14
v_add_u32 v16, 0, v16
v_lshrrev_b32 v17, 4, v16
v_and_b32 v18, 15, v17
v_xor_b32 v18, v18, v13
v_lshrrev_b32 v17, 4, v17
v_lshlrev_b32 v17, 14, v17
v_lshl_add_u32 v17, v18, 4, v17
v_and_b32 v16, 8, v16
v_add3_u32 v17, v17, v16, v12
ds_read_b64_tr_b16 v[20:21], v17 offset:0
ds_read_b64_tr_b16 v[22:23], v17 offset:2048
ds_read_b64_tr_b16 v[24:25], v17 offset:8192
ds_read_b64_tr_b16 v[26:27], v17 offset:10240
s_lshl_b32 s75, s5, 1
s_add_u32 s75, s75, 0
s_mul_i32 s75, s75, 54
s_add_u32 s75, s75, s7
s_mul_i32 s75, s75, 5120
s_add_u32 s75, s75, 7340032
s_add_u32 s76, s75, 5120
s_waitcnt lgkmcnt(2)
buffer_store_dwordx4 v[20:23], v15, s[24:27], s75 offen sc1
s_waitcnt lgkmcnt(0)
buffer_store_dwordx4 v[24:27], v15, s[24:27], s76 offen sc1
v_add_u32 v16, s6, v14
v_add_u32 v16, 8, v16
v_lshrrev_b32 v17, 4, v16
v_and_b32 v18, 15, v17
v_xor_b32 v18, v18, v13
v_lshrrev_b32 v17, 4, v17
v_lshlrev_b32 v17, 14, v17
v_lshl_add_u32 v17, v18, 4, v17
v_and_b32 v16, 8, v16
v_add3_u32 v17, v17, v16, v12
ds_read_b64_tr_b16 v[20:21], v17 offset:0
ds_read_b64_tr_b16 v[22:23], v17 offset:2048
ds_read_b64_tr_b16 v[24:25], v17 offset:8192
ds_read_b64_tr_b16 v[26:27], v17 offset:10240
s_lshl_b32 s75, s5, 1
s_add_u32 s75, s75, 0
s_mul_i32 s75, s75, 54
s_add_u32 s75, s75, s7
s_mul_i32 s75, s75, 5120
s_add_u32 s75, s75, 7341056
s_add_u32 s76, s75, 5120
s_waitcnt lgkmcnt(2)
buffer_store_dwordx4 v[20:23], v15, s[24:27], s75 offen sc1
s_waitcnt lgkmcnt(0)
buffer_store_dwordx4 v[24:27], v15, s[24:27], s76 offen sc1
v_add_u32 v16, s6, v14
v_add_u32 v16, 16, v16
v_lshrrev_b32 v17, 4, v16
v_and_b32 v18, 15, v17
v_xor_b32 v18, v18, v13
v_lshrrev_b32 v17, 4, v17
v_lshlrev_b32 v17, 14, v17
v_lshl_add_u32 v17, v18, 4, v17
v_and_b32 v16, 8, v16
v_add3_u32 v17, v17, v16, v12
ds_read_b64_tr_b16 v[20:21], v17 offset:0
ds_read_b64_tr_b16 v[22:23], v17 offset:2048
ds_read_b64_tr_b16 v[24:25], v17 offset:8192
ds_read_b64_tr_b16 v[26:27], v17 offset:10240
s_lshl_b32 s75, s5, 1
s_add_u32 s75, s75, 0
s_mul_i32 s75, s75, 54
s_add_u32 s75, s75, s7
s_mul_i32 s75, s75, 5120
s_add_u32 s75, s75, 7342080
s_add_u32 s76, s75, 5120
s_waitcnt lgkmcnt(2)
buffer_store_dwordx4 v[20:23], v15, s[24:27], s75 offen sc1
s_waitcnt lgkmcnt(0)
buffer_store_dwordx4 v[24:27], v15, s[24:27], s76 offen sc1
v_add_u32 v16, s6, v14
v_add_u32 v16, 24, v16
v_lshrrev_b32 v17, 4, v16
v_and_b32 v18, 15, v17
v_xor_b32 v18, v18, v13
v_lshrrev_b32 v17, 4, v17
v_lshlrev_b32 v17, 14, v17
v_lshl_add_u32 v17, v18, 4, v17
v_and_b32 v16, 8, v16
v_add3_u32 v17, v17, v16, v12
ds_read_b64_tr_b16 v[20:21], v17 offset:0
ds_read_b64_tr_b16 v[22:23], v17 offset:2048
ds_read_b64_tr_b16 v[24:25], v17 offset:8192
ds_read_b64_tr_b16 v[26:27], v17 offset:10240
s_lshl_b32 s75, s5, 1
s_add_u32 s75, s75, 0
s_mul_i32 s75, s75, 54
s_add_u32 s75, s75, s7
s_mul_i32 s75, s75, 5120
s_add_u32 s75, s75, 7343104
s_add_u32 s76, s75, 5120
s_waitcnt lgkmcnt(2)
buffer_store_dwordx4 v[20:23], v15, s[24:27], s75 offen sc1
s_waitcnt lgkmcnt(0)
buffer_store_dwordx4 v[24:27], v15, s[24:27], s76 offen sc1
v_add_u32 v16, s6, v14
v_add_u32 v16, 32, v16
v_lshrrev_b32 v17, 4, v16
v_and_b32 v18, 15, v17
v_xor_b32 v18, v18, v13
v_lshrrev_b32 v17, 4, v17
v_lshlrev_b32 v17, 14, v17
v_lshl_add_u32 v17, v18, 4, v17
v_and_b32 v16, 8, v16
v_add3_u32 v17, v17, v16, v12
ds_read_b64_tr_b16 v[20:21], v17 offset:0
ds_read_b64_tr_b16 v[22:23], v17 offset:2048
ds_read_b64_tr_b16 v[24:25], v17 offset:8192
ds_read_b64_tr_b16 v[26:27], v17 offset:10240
s_lshl_b32 s75, s5, 1
s_add_u32 s75, s75, 0
s_mul_i32 s75, s75, 54
s_add_u32 s75, s75, s7
s_mul_i32 s75, s75, 5120
s_add_u32 s75, s75, 7344128
s_add_u32 s76, s75, 5120
s_waitcnt lgkmcnt(2)
buffer_store_dwordx4 v[20:23], v15, s[24:27], s75 offen sc1
s_waitcnt lgkmcnt(0)
buffer_store_dwordx4 v[24:27], v15, s[24:27], s76 offen sc1
v_add_u32 v16, s6, v14
v_add_u32 v16, 160, v16
v_lshrrev_b32 v17, 4, v16
v_and_b32 v18, 15, v17
v_xor_b32 v18, v18, v13
v_lshrrev_b32 v17, 4, v17
v_lshlrev_b32 v17, 14, v17
v_lshl_add_u32 v17, v18, 4, v17
v_and_b32 v16, 8, v16
v_add3_u32 v17, v17, v16, v12
ds_read_b64_tr_b16 v[20:21], v17 offset:0
ds_read_b64_tr_b16 v[22:23], v17 offset:2048
ds_read_b64_tr_b16 v[24:25], v17 offset:8192
ds_read_b64_tr_b16 v[26:27], v17 offset:10240
s_lshl_b32 s75, s5, 1
s_add_u32 s75, s75, 1
s_mul_i32 s75, s75, 54
s_add_u32 s75, s75, s7
s_mul_i32 s75, s75, 5120
s_add_u32 s75, s75, 7340032
s_add_u32 s76, s75, 5120
s_waitcnt lgkmcnt(2)
buffer_store_dwordx4 v[20:23], v15, s[24:27], s75 offen sc1
s_waitcnt lgkmcnt(0)
buffer_store_dwordx4 v[24:27], v15, s[24:27], s76 offen sc1
v_add_u32 v16, s6, v14
v_add_u32 v16, 168, v16
v_lshrrev_b32 v17, 4, v16
v_and_b32 v18, 15, v17
v_xor_b32 v18, v18, v13
v_lshrrev_b32 v17, 4, v17
v_lshlrev_b32 v17, 14, v17
v_lshl_add_u32 v17, v18, 4, v17
v_and_b32 v16, 8, v16
v_add3_u32 v17, v17, v16, v12
ds_read_b64_tr_b16 v[20:21], v17 offset:0
ds_read_b64_tr_b16 v[22:23], v17 offset:2048
ds_read_b64_tr_b16 v[24:25], v17 offset:8192
ds_read_b64_tr_b16 v[26:27], v17 offset:10240
s_lshl_b32 s75, s5, 1
s_add_u32 s75, s75, 1
s_mul_i32 s75, s75, 54
s_add_u32 s75, s75, s7
s_mul_i32 s75, s75, 5120
s_add_u32 s75, s75, 7341056
s_add_u32 s76, s75, 5120
s_waitcnt lgkmcnt(2)
buffer_store_dwordx4 v[20:23], v15, s[24:27], s75 offen sc1
s_waitcnt lgkmcnt(0)
buffer_store_dwordx4 v[24:27], v15, s[24:27], s76 offen sc1
v_add_u32 v16, s6, v14
v_add_u32 v16, 176, v16
v_lshrrev_b32 v17, 4, v16
v_and_b32 v18, 15, v17
v_xor_b32 v18, v18, v13
v_lshrrev_b32 v17, 4, v17
v_lshlrev_b32 v17, 14, v17
v_lshl_add_u32 v17, v18, 4, v17
v_and_b32 v16, 8, v16
v_add3_u32 v17, v17, v16, v12
ds_read_b64_tr_b16 v[20:21], v17 offset:0
ds_read_b64_tr_b16 v[22:23], v17 offset:2048
ds_read_b64_tr_b16 v[24:25], v17 offset:8192
ds_read_b64_tr_b16 v[26:27], v17 offset:10240
s_lshl_b32 s75, s5, 1
s_add_u32 s75, s75, 1
s_mul_i32 s75, s75, 54
s_add_u32 s75, s75, s7
s_mul_i32 s75, s75, 5120
s_add_u32 s75, s75, 7342080
s_add_u32 s76, s75, 5120
s_waitcnt lgkmcnt(2)
buffer_store_dwordx4 v[20:23], v15, s[24:27], s75 offen sc1
s_waitcnt lgkmcnt(0)
buffer_store_dwordx4 v[24:27], v15, s[24:27], s76 offen sc1
v_add_u32 v16, s6, v14
v_add_u32 v16, 184, v16
v_lshrrev_b32 v17, 4, v16
v_and_b32 v18, 15, v17
v_xor_b32 v18, v18, v13
v_lshrrev_b32 v17, 4, v17
v_lshlrev_b32 v17, 14, v17
v_lshl_add_u32 v17, v18, 4, v17
v_and_b32 v16, 8, v16
v_add3_u32 v17, v17, v16, v12
ds_read_b64_tr_b16 v[20:21], v17 offset:0
ds_read_b64_tr_b16 v[22:23], v17 offset:2048
ds_read_b64_tr_b16 v[24:25], v17 offset:8192
ds_read_b64_tr_b16 v[26:27], v17 offset:10240
s_lshl_b32 s75, s5, 1
s_add_u32 s75, s75, 1
s_mul_i32 s75, s75, 54
s_add_u32 s75, s75, s7
s_mul_i32 s75, s75, 5120
s_add_u32 s75, s75, 7343104
s_add_u32 s76, s75, 5120
s_waitcnt lgkmcnt(2)
buffer_store_dwordx4 v[20:23], v15, s[24:27], s75 offen sc1
s_waitcnt lgkmcnt(0)
buffer_store_dwordx4 v[24:27], v15, s[24:27], s76 offen sc1
v_add_u32 v16, s6, v14
v_add_u32 v16, 192, v16
v_lshrrev_b32 v17, 4, v16
v_and_b32 v18, 15, v17
v_xor_b32 v18, v18, v13
v_lshrrev_b32 v17, 4, v17
v_lshlrev_b32 v17, 14, v17
v_lshl_add_u32 v17, v18, 4, v17
v_and_b32 v16, 8, v16
v_add3_u32 v17, v17, v16, v12
ds_read_b64_tr_b16 v[20:21], v17 offset:0
ds_read_b64_tr_b16 v[22:23], v17 offset:2048
ds_read_b64_tr_b16 v[24:25], v17 offset:8192
ds_read_b64_tr_b16 v[26:27], v17 offset:10240
s_lshl_b32 s75, s5, 1
s_add_u32 s75, s75, 1
s_mul_i32 s75, s75, 54
s_add_u32 s75, s75, s7
s_mul_i32 s75, s75, 5120
s_add_u32 s75, s75, 7344128
s_add_u32 s76, s75, 5120
s_waitcnt lgkmcnt(2)
buffer_store_dwordx4 v[20:23], v15, s[24:27], s75 offen sc1
s_waitcnt lgkmcnt(0)
buffer_store_dwordx4 v[24:27], v15, s[24:27], s76 offen sc1
L_end_1:
s_endpgm
.globl k1_kernel
.p2align 8
.type k1_kernel,@function
k1_kernel:
s_cmp_ge_u32 s2, 256
s_cbranch_scc1 L_end_4
s_load_dwordx16 s[40:55], s[0:1], 0
s_load_dwordx8 s[56:63], s[0:1], 64
s_load_dwordx4 s[64:67], s[0:1], 96
s_and_b32 s3, s2, 7
s_lshr_b32 s4, s2, 3
v_lshrrev_b32 v1, 6, v0
v_and_b32 v0, 0xff, v0
s_nop 0
v_readfirstlane_b32 s5, v1
v_and_b32 v1, 63, v0
s_waitcnt lgkmcnt(0)
s_mov_b32 s8, s40
s_and_b32 s9, s41, 0xffff
s_mov_b32 s10, 2621440
s_mov_b32 s11, 0x20000
s_mov_b32 s12, s42
s_and_b32 s13, s43, 0xffff
s_mov_b32 s14, 2621440
s_mov_b32 s15, 0x20000
s_mov_b32 s16, s44
s_and_b32 s17, s45, 0xffff
s_mov_b32 s18, 2621440
s_mov_b32 s19, 0x20000
s_mov_b32 s20, s54
s_and_b32 s21, s55, 0xffff
s_mov_b32 s22, 2211840
s_mov_b32 s23, 0x20000
s_mov_b32 s24, s66
s_and_b32 s25, s67, 0xffff
s_mov_b32 s26, 17825792
s_mov_b32 s27, 0x20000
s_mov_b32 s28, s62
s_and_b32 s29, s63, 0xffff
s_mov_b32 s30, 2621440
s_mov_b32 s31, 0x20000
s_cmp_ge_u32 s4, 28
s_cbranch_scc1 L_end_4
s_lshr_b32 s6, s3, 1
s_lshl_b32 s6, s6, 2
s_and_b32 s7, s4, 3
s_add_u32 s77, s6, s7
s_and_b32 s6, s3, 1
s_mul_i32 s6, s6, 7
s_lshr_b32 s7, s4, 2
s_add_u32 s78, s6, s7
s_lshl_b32 s79, s78, 8
s_mul_i32 s80, s77, 163840
s_lshl_b32 s81, s5, 12
s_and_b32 s82, s5, 1
s_lshr_b32 s83, s5, 1
v_lshrrev_b32 v2, 4, v1
v_and_b32 v3, 15, v1
v_lshlrev_b32 v4, 2, v2
v_xor_b32 v4, v3, v4
s_lshl_b32 s6, s5, 4
v_add_u32 v5, s6, v2
v_mul_u32_u24 v5, 3456, v5
v_lshl_add_u32 v8, v4, 4, v5
s_cmp_eq_u32 s78, 13
s_cselect_b32 s7, 8, 16
v_cmp_le_u32 vcc, s7, v4
v_mov_b32 v6, 0x7fff0000
v_cndmask_b32 v8, v8, v6, vcc
v_add_u32 v9, 12800, v8
v_add_u32 v10, 25600, v8
v_add_u32 v11, 38400, v8
v_lshrrev_b32 v4, 3, v1
v_and_b32 v5, 7, v1
s_lshl_b32 s6, s5, 5
v_add_u32 v4, s6, v4
v_mul_u32_u24 v4, 1280, v4
v_add_u32 v6, 0, v2
v_xor_b32 v6, v5, v6
v_lshl_add_u32 v6, v6, 4, v4
v_add_u32 v12, 0, v6
v_add_u32 v6, 4, v2
v_xor_b32 v6, v5, v6
v_lshl_add_u32 v6, v6, 4, v4
v_add_u32 v13, 9216, v6
v_add_u32 v6, 0, v2
v_xor_b32 v6, v5, v6
v_lshl_add_u32 v6, v6, 4, v4
v_add_u32 v14, 18432, v6
v_add_u32 v6, 4, v2
v_xor_b32 v6, v5, v6
v_lshl_add_u32 v6, v6, 4, v4
v_add_u32 v15, 27648, v6
v_bfe_u32 v4, v1, 2, 2
v_and_b32 v5, 3, v1
v_lshrrev_b32 v6, 5, v1
v_lshl_add_u32 v6, v6, 3, v4
v_lshlrev_b32 v6, 8, v6
s_lshl_b32 s6, s82, 1
v_xor_b32 v4, s6, v4
v_lshlrev_b32 v4, 2, v4
v_and_b32 v7, 1, v2
v_lshl_or_b32 v4, v7, 1, v4
v_lshrrev_b32 v7, 1, v5
v_or_b32 v4, v4, v7
v_lshl_add_u32 v6, v4, 4, v6
v_and_b32 v5, 1, v5
v_lshl_add_u32 v16, v5, 3, v6
v_xor_b32 v17, 64, v16
v_add_u32 v18, 0x10000, v16
v_add_u32 v19, 0x10000, v17
v_and_b32 v4, 31, v1
v_bfe_u32 v5, v1, 1, 3
v_lshrrev_b32 v6, 5, v1
v_xor_b32 v5, v5, v6
s_lshl_b32 s6, s83, 6
v_add_u32 v4, s6, v4
v_lshlrev_b32 v4, 7, v4
v_lshl_add_u32 v20, v5, 4, v4
v_xor_b32 v21, 32, v20
v_xor_b32 v22, 64, v20
v_xor_b32 v23, 96, v20
v_add_u32 v24, 0x10000, v20
v_add_u32 v25, 0x10000, v21
v_add_u32 v26, 0x10000, v22
v_add_u32 v27, 0x10000, v23
s_add_u32 m0, s81, 0
s_nop 0
buffer_load_dwordx4 v8, s[20:23], s79 offen offset:0 lds
buffer_load_dwordx4 v9, s[20:23], s79 offen offset:1024 lds
buffer_load_dwordx4 v10, s[20:23], s79 offen offset:2048 lds
buffer_load_dwordx4 v11, s[20:23], s79 offen offset:3072 lds
s_add_u32 m0, s81, 16384
s_nop 0
buffer_load_dwordx4 v12, s[8:11], s80 offen offset:0 lds
buffer_load_dwordx4 v13, s[8:11], s80 offen offset:1024 lds
buffer_load_dwordx4 v14, s[8:11], s80 offen offset:2048 lds
buffer_load_dwordx4 v15, s[8:11], s80 offen offset:3072 lds
s_add_u32 m0, s81, 32768
s_add_u32 s79, s79, 221184
buffer_load_dwordx4 v8, s[20:23], s79 offen offset:0 lds
buffer_load_dwordx4 v9, s[20:23], s79 offen offset:1024 lds
buffer_load_dwordx4 v10, s[20:23], s79 offen offset:2048 lds
buffer_load_dwordx4 v11, s[20:23], s79 offen offset:3072 lds
s_add_u32 m0, s81, 49152
s_add_u32 s80, s80, 128
buffer_load_dwordx4 v12, s[8:11], s80 offen offset:0 lds
buffer_load_dwordx4 v13, s[8:11], s80 offen offset:1024 lds
buffer_load_dwordx4 v14, s[8:11], s80 offen offset:2048 lds
buffer_load_dwordx4 v15, s[8:11], s80 offen offset:3072 lds
s_add_u32 m0, s81, 65536
s_add_u32 s79, s79, 221184
buffer_load_dwordx4 v8, s[20:23], s79 offen offset:0 lds
buffer_load_dwordx4 v9, s[20:23], s79 offen offset:1024 lds
buffer_load_dwordx4 v10, s[20:23], s79 offen offset:2048 lds
buffer_load_dwordx4 v11, s[20:23], s79 offen offset:3072 lds
s_add_u32 m0, s81, 81920
s_add_u32 s80, s80, 128
buffer_load_dwordx4 v12, s[8:11], s80 offen offset:0 lds
buffer_load_dwordx4 v13, s[8:11], s80 offen offset:1024 lds
buffer_load_dwordx4 v14, s[8:11], s80 offen offset:2048 lds
buffer_load_dwordx4 v15, s[8:11], s80 offen offset:3072 lds
v_mov_b32 v64, 0
v_mov_b32 v65, 0
v_mov_b32 v66, 0
v_mov_b32 v67, 0
v_mov_b32 v68, 0
v_mov_b32 v69, 0
v_mov_b32 v70, 0
v_mov_b32 v71, 0
v_mov_b32 v72, 0
v_mov_b32 v73, 0
v_mov_b32 v74, 0
v_mov_b32 v75, 0
v_mov_b32 v76, 0
v_mov_b32 v77, 0
v_mov_b32 v78, 0
v_mov_b32 v79, 0
v_mov_b32 v80, 0
v_mov_b32 v81, 0
v_mov_b32 v82, 0
v_mov_b32 v83, 0
v_mov_b32 v84, 0
v_mov_b32 v85, 0
v_mov_b32 v86, 0
v_mov_b32 v87, 0
v_mov_b32 v88, 0
v_mov_b32 v89, 0
v_mov_b32 v90, 0
v_mov_b32 v91, 0
v_mov_b32 v92, 0
v_mov_b32 v93, 0
v_mov_b32 v94, 0
v_mov_b32 v95, 0
v_mov_b32 v96, 0
v_mov_b32 v97, 0
v_mov_b32 v98, 0
v_mov_b32 v99, 0
v_mov_b32 v100, 0
v_mov_b32 v101, 0
v_mov_b32 v102, 0
v_mov_b32 v103, 0
v_mov_b32 v104, 0
v_mov_b32 v105, 0
v_mov_b32 v106, 0
v_mov_b32 v107, 0
v_mov_b32 v108, 0
v_mov_b32 v109, 0
v_mov_b32 v110, 0
v_mov_b32 v111, 0
v_mov_b32 v112, 0
v_mov_b32 v113, 0
v_mov_b32 v114, 0
v_mov_b32 v115, 0
v_mov_b32 v116, 0
v_mov_b32 v117, 0
v_mov_b32 v118, 0
v_mov_b32 v119, 0
v_mov_b32 v120, 0
v_mov_b32 v121, 0
v_mov_b32 v122, 0
v_mov_b32 v123, 0
v_mov_b32 v124, 0
v_mov_b32 v125, 0
v_mov_b32 v126, 0
v_mov_b32 v127, 0
s_waitcnt vmcnt(16)
s_barrier
ds_read_b64_tr_b16 v[128:129], v16 offset:0
ds_read_b64_tr_b16 v[130:131], v16 offset:1024
ds_read_b128 v[136:139], v20 offset:16384
ds_read_b128 v[140:143], v20 offset:20480
ds_read_b64_tr_b16 v[132:133], v17 offset:0
ds_read_b64_tr_b16 v[134:135], v17 offset:1024
s_add_u32 m0, s81, 98304
s_add_u32 s79, s79, 221184
buffer_load_dwordx4 v8, s[20:23], s79 offen offset:0 lds
buffer_load_dwordx4 v9, s[20:23], s79 offen offset:1024 lds
buffer_load_dwordx4 v10, s[20:23], s79 offen offset:2048 lds
buffer_load_dwordx4 v11, s[20:23], s79 offen offset:3072 lds
s_add_u32 m0, s81, 114688
s_add_u32 s80, s80, 128
buffer_load_dwordx4 v12, s[8:11], s80 offen offset:0 lds
buffer_load_dwordx4 v13, s[8:11], s80 offen offset:1024 lds
buffer_load_dwordx4 v14, s[8:11], s80 offen offset:2048 lds
buffer_load_dwordx4 v15, s[8:11], s80 offen offset:3072 lds
s_waitcnt lgkmcnt(3)
v_mfma_f32_32x32x16_bf16 v[64:79], v[128:131], v[136:139], v[64:79]
ds_read_b64_tr_b16 v[144:145], v16 offset:4096
ds_read_b64_tr_b16 v[146:147], v16 offset:5120
s_waitcnt lgkmcnt(4)
v_mfma_f32_32x32x16_bf16 v[80:95], v[128:131], v[140:143], v[80:95]
ds_read_b128 v[152:155], v21 offset:16384
ds_read_b128 v[156:159], v21 offset:20480
s_waitcnt lgkmcnt(4)
v_mfma_f32_32x32x16_bf16 v[96:111], v[132:135], v[136:139], v[96:111]
ds_read_b64_tr_b16 v[148:149], v17 offset:4096
ds_read_b64_tr_b16 v[150:151], v17 offset:5120
v_mfma_f32_32x32x16_bf16 v[112:127], v[132:135], v[140:143], v[112:127]
s_waitcnt lgkmcnt(3)
v_mfma_f32_32x32x16_bf16 v[64:79], v[144:147], v[152:155], v[64:79]
ds_read_b64_tr_b16 v[128:129], v16 offset:8192
ds_read_b64_tr_b16 v[130:131], v16 offset:9216
s_waitcnt lgkmcnt(4)
v_mfma_f32_32x32x16_bf16 v[80:95], v[144:147], v[156:159], v[80:95]
ds_read_b128 v[136:139], v22 offset:16384
ds_read_b128 v[140:143], v22 offset:20480
s_waitcnt lgkmcnt(4)
v_mfma_f32_32x32x16_bf16 v[96:111], v[148:151], v[152:155], v[96:111]
ds_read_b64_tr_b16 v[132:133], v17 offset:8192
ds_read_b64_tr_b16 v[134:135], v17 offset:9216
v_mfma_f32_32x32x16_bf16 v[112:127], v[148:151], v[156:159], v[112:127]
s_waitcnt lgkmcnt(3)
v_mfma_f32_32x32x16_bf16 v[64:79], v[128:131], v[136:139], v[64:79]
ds_read_b64_tr_b16 v[144:145], v16 offset:12288
ds_read_b64_tr_b16 v[146:147], v16 offset:13312
s_waitcnt lgkmcnt(4)
v_mfma_f32_32x32x16_bf16 v[80:95], v[128:131], v[140:143], v[80:95]
ds_read_b128 v[152:155], v23 offset:16384
ds_read_b128 v[156:159], v23 offset:20480
s_waitcnt lgkmcnt(4)
v_mfma_f32_32x32x16_bf16 v[96:111], v[132:135], v[136:139], v[96:111]
ds_read_b64_tr_b16 v[148:149], v17 offset:12288
ds_read_b64_tr_b16 v[150:151], v17 offset:13312
v_mfma_f32_32x32x16_bf16 v[112:127], v[132:135], v[140:143], v[112:127]
s_waitcnt lgkmcnt(0)
s_waitcnt vmcnt(16)
s_barrier
v_mfma_f32_32x32x16_bf16 v[64:79], v[144:147], v[152:155], v[64:79]
ds_read_b64_tr_b16 v[128:129], v16 offset:32768
ds_read_b64_tr_b16 v[130:131], v16 offset:33792
s_add_u32 m0, s81, 0
s_add_u32 s79, s79, 221184
buffer_load_dwordx4 v8, s[20:23], s79 offen offset:0 lds
v_mfma_f32_32x32x16_bf16 v[80:95], v[144:147], v[156:159], v[80:95]
ds_read_b128 v[136:139], v20 offset:49152
ds_read_b128 v[140:143], v20 offset:53248
buffer_load_dwordx4 v9, s[20:23], s79 offen offset:1024 lds
buffer_load_dwordx4 v10, s[20:23], s79 offen offset:2048 lds
buffer_load_dwordx4 v11, s[20:23], s79 offen offset:3072 lds
v_mfma_f32_32x32x16_bf16 v[96:111], v[148:151], v[152:155], v[96:111]
ds_read_b64_tr_b16 v[132:133], v17 offset:32768
ds_read_b64_tr_b16 v[134:135], v17 offset:33792
s_add_u32 m0, s81, 16384
s_add_u32 s80, s80, 128
buffer_load_dwordx4 v12, s[8:11], s80 offen offset:0 lds
v_mfma_f32_32x32x16_bf16 v[112:127], v[148:151], v[156:159], v[112:127]
buffer_load_dwordx4 v13, s[8:11], s80 offen offset:1024 lds
buffer_load_dwordx4 v14, s[8:11], s80 offen offset:2048 lds
buffer_load_dwordx4 v15, s[8:11], s80 offen offset:3072 lds
s_waitcnt lgkmcnt(3)
v_mfma_f32_32x32x16_bf16 v[64:79], v[128:131], v[136:139], v[64:79]
ds_read_b64_tr_b16 v[144:145], v16 offset:36864
ds_read_b64_tr_b16 v[146:147], v16 offset:37888
s_waitcnt lgkmcnt(4)
v_mfma_f32_32x32x16_bf16 v[80:95], v[128:131], v[140:143], v[80:95]
ds_read_b128 v[152:155], v21 offset:49152
ds_read_b128 v[156:159], v21 offset:53248
s_waitcnt lgkmcnt(4)
v_mfma_f32_32x32x16_bf16 v[96:111], v[132:135], v[136:139], v[96:111]
ds_read_b64_tr_b16 v[148:149], v17 offset:36864
ds_read_b64_tr_b16 v[150:151], v17 offset:37888
v_mfma_f32_32x32x16_bf16 v[112:127], v[132:135], v[140:143], v[112:127]
s_waitcnt lgkmcnt(3)
v_mfma_f32_32x32x16_bf16 v[64:79], v[144:147], v[152:155], v[64:79]
ds_read_b64_tr_b16 v[128:129], v16 offset:40960
ds_read_b64_tr_b16 v[130:131], v16 offset:41984
s_waitcnt lgkmcnt(4)
v_mfma_f32_32x32x16_bf16 v[80:95], v[144:147], v[156:159], v[80:95]
ds_read_b128 v[136:139], v22 offset:49152
ds_read_b128 v[140:143], v22 offset:53248
s_waitcnt lgkmcnt(4)
v_mfma_f32_32x32x16_bf16 v[96:111], v[148:151], v[152:155], v[96:111]
ds_read_b64_tr_b16 v[132:133], v17 offset:40960
ds_read_b64_tr_b16 v[134:135], v17 offset:41984
v_mfma_f32_32x32x16_bf16 v[112:127], v[148:151], v[156:159], v[112:127]
s_waitcnt lgkmcnt(3)
v_mfma_f32_32x32x16_bf16 v[64:79], v[128:131], v[136:139], v[64:79]
ds_read_b64_tr_b16 v[144:145], v16 offset:45056
ds_read_b64_tr_b16 v[146:147], v16 offset:46080
s_waitcnt lgkmcnt(4)
v_mfma_f32_32x32x16_bf16 v[80:95], v[128:131], v[140:143], v[80:95]
ds_read_b128 v[152:155], v23 offset:49152
ds_read_b128 v[156:159], v23 offset:53248
s_waitcnt lgkmcnt(4)
v_mfma_f32_32x32x16_bf16 v[96:111], v[132:135], v[136:139], v[96:111]
ds_read_b64_tr_b16 v[148:149], v17 offset:45056
ds_read_b64_tr_b16 v[150:151], v17 offset:46080
v_mfma_f32_32x32x16_bf16 v[112:127], v[132:135], v[140:143], v[112:127]
s_waitcnt lgkmcnt(0)
s_waitcnt vmcnt(16)
s_barrier
v_mfma_f32_32x32x16_bf16 v[64:79], v[144:147], v[152:155], v[64:79]
ds_read_b64_tr_b16 v[128:129], v18 offset:0
ds_read_b64_tr_b16 v[130:131], v18 offset:1024
s_add_u32 m0, s81, 32768
s_add_u32 s79, s79, 221184
buffer_load_dwordx4 v8, s[20:23], s79 offen offset:0 lds
v_mfma_f32_32x32x16_bf16 v[80:95], v[144:147], v[156:159], v[80:95]
ds_read_b128 v[136:139], v24 offset:16384
ds_read_b128 v[140:143], v24 offset:20480
buffer_load_dwordx4 v9, s[20:23], s79 offen offset:1024 lds
buffer_load_dwordx4 v10, s[20:23], s79 offen offset:2048 lds
buffer_load_dwordx4 v11, s[20:23], s79 offen offset:3072 lds
v_mfma_f32_32x32x16_bf16 v[96:111], v[148:151], v[152:155], v[96:111]
ds_read_b64_tr_b16 v[132:133], v19 offset:0
ds_read_b64_tr_b16 v[134:135], v19 offset:1024
s_add_u32 m0, s81, 49152
s_add_u32 s80, s80, 128
buffer_load_dwordx4 v12, s[8:11], s80 offen offset:0 lds
v_mfma_f32_32x32x16_bf16 v[112:127], v[148:151], v[156:159], v[112:127]
buffer_load_dwordx4 v13, s[8:11], s80 offen offset:1024 lds
buffer_load_dwordx4 v14, s[8:11], s80 offen offset:2048 lds
buffer_load_dwordx4 v15, s[8:11], s80 offen offset:3072 lds
s_waitcnt lgkmcnt(3)
v_mfma_f32_32x32x16_bf16 v[64:79], v[128:131], v[136:139], v[64:79]
ds_read_b64_tr_b16 v[144:145], v18 offset:4096
ds_read_b64_tr_b16 v[146:147], v18 offset:5120
s_waitcnt lgkmcnt(4)
v_mfma_f32_32x32x16_bf16 v[80:95], v[128:131], v[140:143], v[80:95]
ds_read_b128 v[152:155], v25 offset:16384
ds_read_b128 v[156:159], v25 offset:20480
s_waitcnt lgkmcnt(4)
v_mfma_f32_32x32x16_bf16 v[96:111], v[132:135], v[136:139], v[96:111]
ds_read_b64_tr_b16 v[148:149], v19 offset:4096
ds_read_b64_tr_b16 v[150:151], v19 offset:5120
v_mfma_f32_32x32x16_bf16 v[112:127], v[132:135], v[140:143], v[112:127]
s_waitcnt lgkmcnt(3)
v_mfma_f32_32x32x16_bf16 v[64:79], v[144:147], v[152:155], v[64:79]
ds_read_b64_tr_b16 v[128:129], v18 offset:8192
ds_read_b64_tr_b16 v[130:131], v18 offset:9216
s_waitcnt lgkmcnt(4)
v_mfma_f32_32x32x16_bf16 v[80:95], v[144:147], v[156:159], v[80:95]
ds_read_b128 v[136:139], v26 offset:16384
ds_read_b128 v[140:143], v26 offset:20480
s_waitcnt lgkmcnt(4)
v_mfma_f32_32x32x16_bf16 v[96:111], v[148:151], v[152:155], v[96:111]
ds_read_b64_tr_b16 v[132:133], v19 offset:8192
ds_read_b64_tr_b16 v[134:135], v19 offset:9216
v_mfma_f32_32x32x16_bf16 v[112:127], v[148:151], v[156:159], v[112:127]
s_waitcnt lgkmcnt(3)
v_mfma_f32_32x32x16_bf16 v[64:79], v[128:131], v[136:139], v[64:79]
ds_read_b64_tr_b16 v[144:145], v18 offset:12288
ds_read_b64_tr_b16 v[146:147], v18 offset:13312
s_waitcnt lgkmcnt(4)
v_mfma_f32_32x32x16_bf16 v[80:95], v[128:131], v[140:143], v[80:95]
ds_read_b128 v[152:155], v27 offset:16384
ds_read_b128 v[156:159], v27 offset:20480
s_waitcnt lgkmcnt(4)
v_mfma_f32_32x32x16_bf16 v[96:111], v[132:135], v[136:139], v[96:111]
ds_read_b64_tr_b16 v[148:149], v19 offset:12288
ds_read_b64_tr_b16 v[150:151], v19 offset:13312
v_mfma_f32_32x32x16_bf16 v[112:127], v[132:135], v[140:143], v[112:127]
s_waitcnt lgkmcnt(0)
s_waitcnt vmcnt(16)
s_barrier
v_mfma_f32_32x32x16_bf16 v[64:79], v[144:147], v[152:155], v[64:79]
ds_read_b64_tr_b16 v[128:129], v18 offset:32768
ds_read_b64_tr_b16 v[130:131], v18 offset:33792
s_add_u32 m0, s81, 65536
s_add_u32 s79, s79, 221184
buffer_load_dwordx4 v8, s[20:23], s79 offen offset:0 lds
v_mfma_f32_32x32x16_bf16 v[80:95], v[144:147], v[156:159], v[80:95]
ds_read_b128 v[136:139], v24 offset:49152
ds_read_b128 v[140:143], v24 offset:53248
buffer_load_dwordx4 v9, s[20:23], s79 offen offset:1024 lds
buffer_load_dwordx4 v10, s[20:23], s79 offen offset:2048 lds
buffer_load_dwordx4 v11, s[20:23], s79 offen offset:3072 lds
v_mfma_f32_32x32x16_bf16 v[96:111], v[148:151], v[152:155], v[96:111]
ds_read_b64_tr_b16 v[132:133], v19 offset:32768
ds_read_b64_tr_b16 v[134:135], v19 offset:33792
s_add_u32 m0, s81, 81920
s_add_u32 s80, s80, 128
buffer_load_dwordx4 v12, s[8:11], s80 offen offset:0 lds
v_mfma_f32_32x32x16_bf16 v[112:127], v[148:151], v[156:159], v[112:127]
buffer_load_dwordx4 v13, s[8:11], s80 offen offset:1024 lds
buffer_load_dwordx4 v14, s[8:11], s80 offen offset:2048 lds
buffer_load_dwordx4 v15, s[8:11], s80 offen offset:3072 lds
s_waitcnt lgkmcnt(3)
v_mfma_f32_32x32x16_bf16 v[64:79], v[128:131], v[136:139], v[64:79]
ds_read_b64_tr_b16 v[144:145], v18 offset:36864
ds_read_b64_tr_b16 v[146:147], v18 offset:37888
s_waitcnt lgkmcnt(4)
v_mfma_f32_32x32x16_bf16 v[80:95], v[128:131], v[140:143], v[80:95]
ds_read_b128 v[152:155], v25 offset:49152
ds_read_b128 v[156:159], v25 offset:53248
s_waitcnt lgkmcnt(4)
v_mfma_f32_32x32x16_bf16 v[96:111], v[132:135], v[136:139], v[96:111]
ds_read_b64_tr_b16 v[148:149], v19 offset:36864
ds_read_b64_tr_b16 v[150:151], v19 offset:37888
v_mfma_f32_32x32x16_bf16 v[112:127], v[132:135], v[140:143], v[112:127]
s_waitcnt lgkmcnt(3)
v_mfma_f32_32x32x16_bf16 v[64:79], v[144:147], v[152:155], v[64:79]
ds_read_b64_tr_b16 v[128:129], v18 offset:40960
ds_read_b64_tr_b16 v[130:131], v18 offset:41984
s_waitcnt lgkmcnt(4)
v_mfma_f32_32x32x16_bf16 v[80:95], v[144:147], v[156:159], v[80:95]
ds_read_b128 v[136:139], v26 offset:49152
ds_read_b128 v[140:143], v26 offset:53248
s_waitcnt lgkmcnt(4)
v_mfma_f32_32x32x16_bf16 v[96:111], v[148:151], v[152:155], v[96:111]
ds_read_b64_tr_b16 v[132:133], v19 offset:40960
ds_read_b64_tr_b16 v[134:135], v19 offset:41984
v_mfma_f32_32x32x16_bf16 v[112:127], v[148:151], v[156:159], v[112:127]
s_waitcnt lgkmcnt(3)
v_mfma_f32_32x32x16_bf16 v[64:79], v[128:131], v[136:139], v[64:79]
ds_read_b64_tr_b16 v[144:145], v18 offset:45056
ds_read_b64_tr_b16 v[146:147], v18 offset:46080
s_waitcnt lgkmcnt(4)
v_mfma_f32_32x32x16_bf16 v[80:95], v[128:131], v[140:143], v[80:95]
ds_read_b128 v[152:155], v27 offset:49152
ds_read_b128 v[156:159], v27 offset:53248
s_waitcnt lgkmcnt(4)
v_mfma_f32_32x32x16_bf16 v[96:111], v[132:135], v[136:139], v[96:111]
ds_read_b64_tr_b16 v[148:149], v19 offset:45056
ds_read_b64_tr_b16 v[150:151], v19 offset:46080
v_mfma_f32_32x32x16_bf16 v[112:127], v[132:135], v[140:143], v[112:127]
s_waitcnt lgkmcnt(0)
s_waitcnt vmcnt(16)
s_barrier
v_mfma_f32_32x32x16_bf16 v[64:79], v[144:147], v[152:155], v[64:79]
ds_read_b64_tr_b16 v[128:129], v16 offset:0
ds_read_b64_tr_b16 v[130:131], v16 offset:1024
s_add_u32 m0, s81, 98304
s_add_u32 s79, s79, 221184
buffer_load_dwordx4 v8, s[20:23], s79 offen offset:0 lds
v_mfma_f32_32x32x16_bf16 v[80:95], v[144:147], v[156:159], v[80:95]
ds_read_b128 v[136:139], v20 offset:16384
ds_read_b128 v[140:143], v20 offset:20480
buffer_load_dwordx4 v9, s[20:23], s79 offen offset:1024 lds
buffer_load_dwordx4 v10, s[20:23], s79 offen offset:2048 lds
buffer_load_dwordx4 v11, s[20:23], s79 offen offset:3072 lds
v_mfma_f32_32x32x16_bf16 v[96:111], v[148:151], v[152:155], v[96:111]
ds_read_b64_tr_b16 v[132:133], v17 offset:0
ds_read_b64_tr_b16 v[134:135], v17 offset:1024
s_add_u32 m0, s81, 114688
s_add_u32 s80, s80, 128
buffer_load_dwordx4 v12, s[8:11], s80 offen offset:0 lds
v_mfma_f32_32x32x16_bf16 v[112:127], v[148:151], v[156:159], v[112:127]
buffer_load_dwordx4 v13, s[8:11], s80 offen offset:1024 lds
buffer_load_dwordx4 v14, s[8:11], s80 offen offset:2048 lds
buffer_load_dwordx4 v15, s[8:11], s80 offen offset:3072 lds
s_waitcnt lgkmcnt(3)
v_mfma_f32_32x32x16_bf16 v[64:79], v[128:131], v[136:139], v[64:79]
ds_read_b64_tr_b16 v[144:145], v16 offset:4096
ds_read_b64_tr_b16 v[146:147], v16 offset:5120
s_waitcnt lgkmcnt(4)
v_mfma_f32_32x32x16_bf16 v[80:95], v[128:131], v[140:143], v[80:95]
ds_read_b128 v[152:155], v21 offset:16384
ds_read_b128 v[156:159], v21 offset:20480
s_waitcnt lgkmcnt(4)
v_mfma_f32_32x32x16_bf16 v[96:111], v[132:135], v[136:139], v[96:111]
ds_read_b64_tr_b16 v[148:149], v17 offset:4096
ds_read_b64_tr_b16 v[150:151], v17 offset:5120
v_mfma_f32_32x32x16_bf16 v[112:127], v[132:135], v[140:143], v[112:127]
s_waitcnt lgkmcnt(3)
v_mfma_f32_32x32x16_bf16 v[64:79], v[144:147], v[152:155], v[64:79]
ds_read_b64_tr_b16 v[128:129], v16 offset:8192
ds_read_b64_tr_b16 v[130:131], v16 offset:9216
s_waitcnt lgkmcnt(4)
v_mfma_f32_32x32x16_bf16 v[80:95], v[144:147], v[156:159], v[80:95]
ds_read_b128 v[136:139], v22 offset:16384
ds_read_b128 v[140:143], v22 offset:20480
s_waitcnt lgkmcnt(4)
v_mfma_f32_32x32x16_bf16 v[96:111], v[148:151], v[152:155], v[96:111]
ds_read_b64_tr_b16 v[132:133], v17 offset:8192
ds_read_b64_tr_b16 v[134:135], v17 offset:9216
v_mfma_f32_32x32x16_bf16 v[112:127], v[148:151], v[156:159], v[112:127]
s_waitcnt lgkmcnt(3)
v_mfma_f32_32x32x16_bf16 v[64:79], v[128:131], v[136:139], v[64:79]
ds_read_b64_tr_b16 v[144:145], v16 offset:12288
ds_read_b64_tr_b16 v[146:147], v16 offset:13312
s_waitcnt lgkmcnt(4)
v_mfma_f32_32x32x16_bf16 v[80:95], v[128:131], v[140:143], v[80:95]
ds_read_b128 v[152:155], v23 offset:16384
ds_read_b128 v[156:159], v23 offset:20480
s_waitcnt lgkmcnt(4)
v_mfma_f32_32x32x16_bf16 v[96:111], v[132:135], v[136:139], v[96:111]
ds_read_b64_tr_b16 v[148:149], v17 offset:12288
ds_read_b64_tr_b16 v[150:151], v17 offset:13312
v_mfma_f32_32x32x16_bf16 v[112:127], v[132:135], v[140:143], v[112:127]
s_waitcnt lgkmcnt(0)
s_waitcnt vmcnt(16)
s_barrier
v_mfma_f32_32x32x16_bf16 v[64:79], v[144:147], v[152:155], v[64:79]
ds_read_b64_tr_b16 v[128:129], v16 offset:32768
ds_read_b64_tr_b16 v[130:131], v16 offset:33792
s_add_u32 m0, s81, 0
s_add_u32 s79, s79, 221184
buffer_load_dwordx4 v8, s[20:23], s79 offen offset:0 lds
v_mfma_f32_32x32x16_bf16 v[80:95], v[144:147], v[156:159], v[80:95]
ds_read_b128 v[136:139], v20 offset:49152
ds_read_b128 v[140:143], v20 offset:53248
buffer_load_dwordx4 v9, s[20:23], s79 offen offset:1024 lds
buffer_load_dwordx4 v10, s[20:23], s79 offen offset:2048 lds
buffer_load_dwordx4 v11, s[20:23], s79 offen offset:3072 lds
v_mfma_f32_32x32x16_bf16 v[96:111], v[148:151], v[152:155], v[96:111]
ds_read_b64_tr_b16 v[132:133], v17 offset:32768
ds_read_b64_tr_b16 v[134:135], v17 offset:33792
s_add_u32 m0, s81, 16384
s_add_u32 s80, s80, 128
buffer_load_dwordx4 v12, s[8:11], s80 offen offset:0 lds
v_mfma_f32_32x32x16_bf16 v[112:127], v[148:151], v[156:159], v[112:127]
buffer_load_dwordx4 v13, s[8:11], s80 offen offset:1024 lds
buffer_load_dwordx4 v14, s[8:11], s80 offen offset:2048 lds
buffer_load_dwordx4 v15, s[8:11], s80 offen offset:3072 lds
s_waitcnt lgkmcnt(3)
v_mfma_f32_32x32x16_bf16 v[64:79], v[128:131], v[136:139], v[64:79]
ds_read_b64_tr_b16 v[144:145], v16 offset:36864
ds_read_b64_tr_b16 v[146:147], v16 offset:37888
s_waitcnt lgkmcnt(4)
v_mfma_f32_32x32x16_bf16 v[80:95], v[128:131], v[140:143], v[80:95]
ds_read_b128 v[152:155], v21 offset:49152
ds_read_b128 v[156:159], v21 offset:53248
s_waitcnt lgkmcnt(4)
v_mfma_f32_32x32x16_bf16 v[96:111], v[132:135], v[136:139], v[96:111]
ds_read_b64_tr_b16 v[148:149], v17 offset:36864
ds_read_b64_tr_b16 v[150:151], v17 offset:37888
v_mfma_f32_32x32x16_bf16 v[112:127], v[132:135], v[140:143], v[112:127]
s_waitcnt lgkmcnt(3)
v_mfma_f32_32x32x16_bf16 v[64:79], v[144:147], v[152:155], v[64:79]
ds_read_b64_tr_b16 v[128:129], v16 offset:40960
ds_read_b64_tr_b16 v[130:131], v16 offset:41984
s_waitcnt lgkmcnt(4)
v_mfma_f32_32x32x16_bf16 v[80:95], v[144:147], v[156:159], v[80:95]
ds_read_b128 v[136:139], v22 offset:49152
ds_read_b128 v[140:143], v22 offset:53248
s_waitcnt lgkmcnt(4)
v_mfma_f32_32x32x16_bf16 v[96:111], v[148:151], v[152:155], v[96:111]
ds_read_b64_tr_b16 v[132:133], v17 offset:40960
ds_read_b64_tr_b16 v[134:135], v17 offset:41984
v_mfma_f32_32x32x16_bf16 v[112:127], v[148:151], v[156:159], v[112:127]
s_waitcnt lgkmcnt(3)
v_mfma_f32_32x32x16_bf16 v[64:79], v[128:131], v[136:139], v[64:79]
ds_read_b64_tr_b16 v[144:145], v16 offset:45056
ds_read_b64_tr_b16 v[146:147], v16 offset:46080
s_waitcnt lgkmcnt(4)
v_mfma_f32_32x32x16_bf16 v[80:95], v[128:131], v[140:143], v[80:95]
ds_read_b128 v[152:155], v23 offset:49152
ds_read_b128 v[156:159], v23 offset:53248
s_waitcnt lgkmcnt(4)
v_mfma_f32_32x32x16_bf16 v[96:111], v[132:135], v[136:139], v[96:111]
ds_read_b64_tr_b16 v[148:149], v17 offset:45056
ds_read_b64_tr_b16 v[150:151], v17 offset:46080
v_mfma_f32_32x32x16_bf16 v[112:127], v[132:135], v[140:143], v[112:127]
s_waitcnt lgkmcnt(0)
s_waitcnt vmcnt(16)
s_barrier
v_mfma_f32_32x32x16_bf16 v[64:79], v[144:147], v[152:155], v[64:79]
ds_read_b64_tr_b16 v[128:129], v18 offset:0
ds_read_b64_tr_b16 v[130:131], v18 offset:1024
s_add_u32 m0, s81, 32768
s_add_u32 s79, s79, 221184
buffer_load_dwordx4 v8, s[20:23], s79 offen offset:0 lds
v_mfma_f32_32x32x16_bf16 v[80:95], v[144:147], v[156:159], v[80:95]
ds_read_b128 v[136:139], v24 offset:16384
ds_read_b128 v[140:143], v24 offset:20480
buffer_load_dwordx4 v9, s[20:23], s79 offen offset:1024 lds
buffer_load_dwordx4 v10, s[20:23], s79 offen offset:2048 lds
buffer_load_dwordx4 v11, s[20:23], s79 offen offset:3072 lds
v_mfma_f32_32x32x16_bf16 v[96:111], v[148:151], v[152:155], v[96:111]
ds_read_b64_tr_b16 v[132:133], v19 offset:0
ds_read_b64_tr_b16 v[134:135], v19 offset:1024
s_add_u32 m0, s81, 49152
s_add_u32 s80, s80, 128
buffer_load_dwordx4 v12, s[8:11], s80 offen offset:0 lds
v_mfma_f32_32x32x16_bf16 v[112:127], v[148:151], v[156:159], v[112:127]
buffer_load_dwordx4 v13, s[8:11], s80 offen offset:1024 lds
buffer_load_dwordx4 v14, s[8:11], s80 offen offset:2048 lds
buffer_load_dwordx4 v15, s[8:11], s80 offen offset:3072 lds
s_waitcnt lgkmcnt(3)
v_mfma_f32_32x32x16_bf16 v[64:79], v[128:131], v[136:139], v[64:79]
ds_read_b64_tr_b16 v[144:145], v18 offset:4096
ds_read_b64_tr_b16 v[146:147], v18 offset:5120
s_waitcnt lgkmcnt(4)
v_mfma_f32_32x32x16_bf16 v[80:95], v[128:131], v[140:143], v[80:95]
ds_read_b128 v[152:155], v25 offset:16384
ds_read_b128 v[156:159], v25 offset:20480
s_waitcnt lgkmcnt(4)
v_mfma_f32_32x32x16_bf16 v[96:111], v[132:135], v[136:139], v[96:111]
ds_read_b64_tr_b16 v[148:149], v19 offset:4096
ds_read_b64_tr_b16 v[150:151], v19 offset:5120
v_mfma_f32_32x32x16_bf16 v[112:127], v[132:135], v[140:143], v[112:127]
s_waitcnt lgkmcnt(3)
v_mfma_f32_32x32x16_bf16 v[64:79], v[144:147], v[152:155], v[64:79]
ds_read_b64_tr_b16 v[128:129], v18 offset:8192
ds_read_b64_tr_b16 v[130:131], v18 offset:9216
s_waitcnt lgkmcnt(4)
v_mfma_f32_32x32x16_bf16 v[80:95], v[144:147], v[156:159], v[80:95]
ds_read_b128 v[136:139], v26 offset:16384
ds_read_b128 v[140:143], v26 offset:20480
s_waitcnt lgkmcnt(4)
v_mfma_f32_32x32x16_bf16 v[96:111], v[148:151], v[152:155], v[96:111]
ds_read_b64_tr_b16 v[132:133], v19 offset:8192
ds_read_b64_tr_b16 v[134:135], v19 offset:9216
v_mfma_f32_32x32x16_bf16 v[112:127], v[148:151], v[156:159], v[112:127]
s_waitcnt lgkmcnt(3)
v_mfma_f32_32x32x16_bf16 v[64:79], v[128:131], v[136:139], v[64:79]
ds_read_b64_tr_b16 v[144:145], v18 offset:12288
ds_read_b64_tr_b16 v[146:147], v18 offset:13312
s_waitcnt lgkmcnt(4)
v_mfma_f32_32x32x16_bf16 v[80:95], v[128:131], v[140:143], v[80:95]
ds_read_b128 v[152:155], v27 offset:16384
ds_read_b128 v[156:159], v27 offset:20480
s_waitcnt lgkmcnt(4)
v_mfma_f32_32x32x16_bf16 v[96:111], v[132:135], v[136:139], v[96:111]
ds_read_b64_tr_b16 v[148:149], v19 offset:12288
ds_read_b64_tr_b16 v[150:151], v19 offset:13312
v_mfma_f32_32x32x16_bf16 v[112:127], v[132:135], v[140:143], v[112:127]
s_waitcnt lgkmcnt(0)
s_waitcnt vmcnt(16)
s_barrier
v_mfma_f32_32x32x16_bf16 v[64:79], v[144:147], v[152:155], v[64:79]
ds_read_b64_tr_b16 v[128:129], v18 offset:32768
ds_read_b64_tr_b16 v[130:131], v18 offset:33792
v_mfma_f32_32x32x16_bf16 v[80:95], v[144:147], v[156:159], v[80:95]
ds_read_b128 v[136:139], v24 offset:49152
ds_read_b128 v[140:143], v24 offset:53248
v_mfma_f32_32x32x16_bf16 v[96:111], v[148:151], v[152:155], v[96:111]
ds_read_b64_tr_b16 v[132:133], v19 offset:32768
ds_read_b64_tr_b16 v[134:135], v19 offset:33792
v_mfma_f32_32x32x16_bf16 v[112:127], v[148:151], v[156:159], v[112:127]
s_waitcnt lgkmcnt(3)
v_mfma_f32_32x32x16_bf16 v[64:79], v[128:131], v[136:139], v[64:79]
ds_read_b64_tr_b16 v[144:145], v18 offset:36864
ds_read_b64_tr_b16 v[146:147], v18 offset:37888
s_waitcnt lgkmcnt(4)
v_mfma_f32_32x32x16_bf16 v[80:95], v[128:131], v[140:143], v[80:95]
ds_read_b128 v[152:155], v25 offset:49152
ds_read_b128 v[156:159], v25 offset:53248
s_waitcnt lgkmcnt(4)
v_mfma_f32_32x32x16_bf16 v[96:111], v[132:135], v[136:139], v[96:111]
ds_read_b64_tr_b16 v[148:149], v19 offset:36864
ds_read_b64_tr_b16 v[150:151], v19 offset:37888
v_mfma_f32_32x32x16_bf16 v[112:127], v[132:135], v[140:143], v[112:127]
s_waitcnt lgkmcnt(3)
v_mfma_f32_32x32x16_bf16 v[64:79], v[144:147], v[152:155], v[64:79]
ds_read_b64_tr_b16 v[128:129], v18 offset:40960
ds_read_b64_tr_b16 v[130:131], v18 offset:41984
s_waitcnt lgkmcnt(4)
v_mfma_f32_32x32x16_bf16 v[80:95], v[144:147], v[156:159], v[80:95]
ds_read_b128 v[136:139], v26 offset:49152
ds_read_b128 v[140:143], v26 offset:53248
s_waitcnt lgkmcnt(4)
v_mfma_f32_32x32x16_bf16 v[96:111], v[148:151], v[152:155], v[96:111]
ds_read_b64_tr_b16 v[132:133], v19 offset:40960
ds_read_b64_tr_b16 v[134:135], v19 offset:41984
v_mfma_f32_32x32x16_bf16 v[112:127], v[148:151], v[156:159], v[112:127]
s_waitcnt lgkmcnt(3)
v_mfma_f32_32x32x16_bf16 v[64:79], v[128:131], v[136:139], v[64:79]
ds_read_b64_tr_b16 v[144:145], v18 offset:45056
ds_read_b64_tr_b16 v[146:147], v18 offset:46080
s_waitcnt lgkmcnt(4)
v_mfma_f32_32x32x16_bf16 v[80:95], v[128:131], v[140:143], v[80:95]
ds_read_b128 v[152:155], v27 offset:49152
ds_read_b128 v[156:159], v27 offset:53248
s_waitcnt lgkmcnt(4)
v_mfma_f32_32x32x16_bf16 v[96:111], v[132:135], v[136:139], v[96:111]
ds_read_b64_tr_b16 v[148:149], v19 offset:45056
ds_read_b64_tr_b16 v[150:151], v19 offset:46080
v_mfma_f32_32x32x16_bf16 v[112:127], v[132:135], v[140:143], v[112:127]
s_waitcnt lgkmcnt(0)
s_waitcnt vmcnt(8)
s_barrier
v_mfma_f32_32x32x16_bf16 v[64:79], v[144:147], v[152:155], v[64:79]
ds_read_b64_tr_b16 v[128:129], v16 offset:0
ds_read_b64_tr_b16 v[130:131], v16 offset:1024
v_mfma_f32_32x32x16_bf16 v[80:95], v[144:147], v[156:159], v[80:95]
ds_read_b128 v[136:139], v20 offset:16384
ds_read_b128 v[140:143], v20 offset:20480
v_mfma_f32_32x32x16_bf16 v[96:111], v[148:151], v[152:155], v[96:111]
ds_read_b64_tr_b16 v[132:133], v17 offset:0
ds_read_b64_tr_b16 v[134:135], v17 offset:1024
v_mfma_f32_32x32x16_bf16 v[112:127], v[148:151], v[156:159], v[112:127]
s_waitcnt lgkmcnt(3)
v_mfma_f32_32x32x16_bf16 v[64:79], v[128:131], v[136:139], v[64:79]
ds_read_b64_tr_b16 v[144:145], v16 offset:4096
ds_read_b64_tr_b16 v[146:147], v16 offset:5120
s_waitcnt lgkmcnt(4)
v_mfma_f32_32x32x16_bf16 v[80:95], v[128:131], v[140:143], v[80:95]
ds_read_b128 v[152:155], v21 offset:16384
ds_read_b128 v[156:159], v21 offset:20480
s_waitcnt lgkmcnt(4)
v_mfma_f32_32x32x16_bf16 v[96:111], v[132:135], v[136:139], v[96:111]
ds_read_b64_tr_b16 v[148:149], v17 offset:4096
ds_read_b64_tr_b16 v[150:151], v17 offset:5120
v_mfma_f32_32x32x16_bf16 v[112:127], v[132:135], v[140:143], v[112:127]
s_waitcnt lgkmcnt(3)
v_mfma_f32_32x32x16_bf16 v[64:79], v[144:147], v[152:155], v[64:79]
ds_read_b64_tr_b16 v[128:129], v16 offset:8192
ds_read_b64_tr_b16 v[130:131], v16 offset:9216
s_waitcnt lgkmcnt(4)
v_mfma_f32_32x32x16_bf16 v[80:95], v[144:147], v[156:159], v[80:95]
ds_read_b128 v[136:139], v22 offset:16384
ds_read_b128 v[140:143], v22 offset:20480
s_waitcnt lgkmcnt(4)
v_mfma_f32_32x32x16_bf16 v[96:111], v[148:151], v[152:155], v[96:111]
ds_read_b64_tr_b16 v[132:133], v17 offset:8192
ds_read_b64_tr_b16 v[134:135], v17 offset:9216
v_mfma_f32_32x32x16_bf16 v[112:127], v[148:151], v[156:159], v[112:127]
s_waitcnt lgkmcnt(3)
v_mfma_f32_32x32x16_bf16 v[64:79], v[128:131], v[136:139], v[64:79]
ds_read_b64_tr_b16 v[144:145], v16 offset:12288
ds_read_b64_tr_b16 v[146:147], v16 offset:13312
s_waitcnt lgkmcnt(4)
v_mfma_f32_32x32x16_bf16 v[80:95], v[128:131], v[140:143], v[80:95]
ds_read_b128 v[152:155], v23 offset:16384
ds_read_b128 v[156:159], v23 offset:20480
s_waitcnt lgkmcnt(4)
v_mfma_f32_32x32x16_bf16 v[96:111], v[132:135], v[136:139], v[96:111]
ds_read_b64_tr_b16 v[148:149], v17 offset:12288
ds_read_b64_tr_b16 v[150:151], v17 offset:13312
v_mfma_f32_32x32x16_bf16 v[112:127], v[132:135], v[140:143], v[112:127]
s_waitcnt lgkmcnt(0)
s_waitcnt vmcnt(0)
s_barrier
v_mfma_f32_32x32x16_bf16 v[64:79], v[144:147], v[152:155], v[64:79]
ds_read_b64_tr_b16 v[128:129], v16 offset:32768
ds_read_b64_tr_b16 v[130:131], v16 offset:33792
v_mfma_f32_32x32x16_bf16 v[80:95], v[144:147], v[156:159], v[80:95]
ds_read_b128 v[136:139], v20 offset:49152
ds_read_b128 v[140:143], v20 offset:53248
v_mfma_f32_32x32x16_bf16 v[96:111], v[148:151], v[152:155], v[96:111]
ds_read_b64_tr_b16 v[132:133], v17 offset:32768
ds_read_b64_tr_b16 v[134:135], v17 offset:33792
v_mfma_f32_32x32x16_bf16 v[112:127], v[148:151], v[156:159], v[112:127]
s_waitcnt lgkmcnt(3)
v_mfma_f32_32x32x16_bf16 v[64:79], v[128:131], v[136:139], v[64:79]
ds_read_b64_tr_b16 v[144:145], v16 offset:36864
ds_read_b64_tr_b16 v[146:147], v16 offset:37888
s_waitcnt lgkmcnt(4)
v_mfma_f32_32x32x16_bf16 v[80:95], v[128:131], v[140:143], v[80:95]
ds_read_b128 v[152:155], v21 offset:49152
ds_read_b128 v[156:159], v21 offset:53248
s_waitcnt lgkmcnt(4)
v_mfma_f32_32x32x16_bf16 v[96:111], v[132:135], v[136:139], v[96:111]
ds_read_b64_tr_b16 v[148:149], v17 offset:36864
ds_read_b64_tr_b16 v[150:151], v17 offset:37888
v_mfma_f32_32x32x16_bf16 v[112:127], v[132:135], v[140:143], v[112:127]
s_waitcnt lgkmcnt(3)
v_mfma_f32_32x32x16_bf16 v[64:79], v[144:147], v[152:155], v[64:79]
ds_read_b64_tr_b16 v[128:129], v16 offset:40960
ds_read_b64_tr_b16 v[130:131], v16 offset:41984
s_waitcnt lgkmcnt(4)
v_mfma_f32_32x32x16_bf16 v[80:95], v[144:147], v[156:159], v[80:95]
ds_read_b128 v[136:139], v22 offset:49152
ds_read_b128 v[140:143], v22 offset:53248
s_waitcnt lgkmcnt(4)
v_mfma_f32_32x32x16_bf16 v[96:111], v[148:151], v[152:155], v[96:111]
ds_read_b64_tr_b16 v[132:133], v17 offset:40960
ds_read_b64_tr_b16 v[134:135], v17 offset:41984
v_mfma_f32_32x32x16_bf16 v[112:127], v[148:151], v[156:159], v[112:127]
s_waitcnt lgkmcnt(3)
v_mfma_f32_32x32x16_bf16 v[64:79], v[128:131], v[136:139], v[64:79]
ds_read_b64_tr_b16 v[144:145], v16 offset:45056
ds_read_b64_tr_b16 v[146:147], v16 offset:46080
s_waitcnt lgkmcnt(4)
v_mfma_f32_32x32x16_bf16 v[80:95], v[128:131], v[140:143], v[80:95]
ds_read_b128 v[152:155], v23 offset:49152
ds_read_b128 v[156:159], v23 offset:53248
s_waitcnt lgkmcnt(4)
v_mfma_f32_32x32x16_bf16 v[96:111], v[132:135], v[136:139], v[96:111]
ds_read_b64_tr_b16 v[148:149], v17 offset:45056
ds_read_b64_tr_b16 v[150:151], v17 offset:46080
v_mfma_f32_32x32x16_bf16 v[112:127], v[132:135], v[140:143], v[112:127]
s_waitcnt lgkmcnt(3)
v_mfma_f32_32x32x16_bf16 v[64:79], v[144:147], v[152:155], v[64:79]
s_waitcnt lgkmcnt(2)
v_mfma_f32_32x32x16_bf16 v[80:95], v[144:147], v[156:159], v[80:95]
s_waitcnt lgkmcnt(0)
v_mfma_f32_32x32x16_bf16 v[96:111], v[148:151], v[152:155], v[96:111]
v_mfma_f32_32x32x16_bf16 v[112:127], v[148:151], v[156:159], v[112:127]
s_cmp_eq_u32 s78, 13
s_cselect_b32 s6, s82, 0
s_cmp_lg_u32 s6, 0
s_cbranch_scc1 L_end_4
v_and_b32 v2, 31, v1
s_lshl_b32 s6, s78, 7
s_lshl_b32 s7, s82, 6
s_add_u32 s6, s6, s7
v_add_u32 v3, s6, v2
v_lshlrev_b32 v3, 4, v3
s_lshl_b32 s6, s77, 7
s_lshl_b32 s7, s83, 6
s_add_u32 s6, s6, s7
v_add_u32 v4, s6, v2
v_lshlrev_b32 v4, 4, v4
v_mov_b32 v5, 0x7fff0000
v_cmp_gt_u32 vcc, 32, v1
v_cndmask_b32 v3, v5, v3, vcc
v_cndmask_b32 v5, v5, v4, vcc
s_mov_b32 s6, 131072
s_mov_b32 s7, 65536
s_mov_b32 s84, 98304
buffer_load_dwordx4 v[28:31], v3, s[24:27], s6 offen
buffer_load_dwordx4 v[36:39], v5, s[24:27], s7 offen
buffer_load_dwordx4 v[32:35], v3, s[24:27], s6 offen offset:512
buffer_load_dwordx4 v[40:43], v5, s[24:27], s7 offen offset:512
buffer_load_dwordx4 v[44:47], v4, s[24:27], s84 offen
buffer_load_dwordx4 v[48:51], v4, s[24:27], s84 offen offset:512
s_waitcnt vmcnt(0)
v_mfma_f32_32x32x16_bf16 v[64:79], v[28:31], v[36:39], v[64:79]
v_mfma_f32_32x32x16_bf16 v[80:95], v[28:31], v[40:43], v[80:95]
v_mfma_f32_32x32x16_bf16 v[96:111], v[32:35], v[36:39], v[96:111]
v_mfma_f32_32x32x16_bf16 v[112:127], v[32:35], v[40:43], v[112:127]
v_mul_f32 v52, -2.302208198144325, v45
v_mul_f32 v2, v45, v45
v_mul_f32 v2, v2, v45
v_mul_f32 v53, -0.1029432395800235, v2
v_mov_b32 v54, v46
v_mov_b32 v55, v46
v_mul_f32 v56, -2.302208198144325, v49
v_mul_f32 v2, v49, v49
v_mul_f32 v2, v2, v49
v_mul_f32 v57, -0.1029432395800235, v2
v_mov_b32 v58, v50
v_mov_b32 v59, v50
v_and_b32 v2, 15, v1
v_lshrrev_b32 v3, 3, v2
v_lshlrev_b32 v3, 3, v3
v_and_b32 v4, 1, v2
v_lshl_or_b32 v3, v4, 2, v3
v_bfe_u32 v4, v2, 1, 2
v_or_b32 v3, v3, v4
v_lshlrev_b32 v3, 4, v3
v_bfe_u32 v4, v1, 4, 1
v_lshl_or_b32 v3, v4, 10, v3
v_lshrrev_b32 v4, 5, v1
v_lshl_or_b32 v3, v4, 8, v3
s_lshl_b32 s6, s77, 1
s_add_u32 s6, s6, s83
s_mul_i32 s6, s6, 54
s_lshl_b32 s7, s78, 2
s_add_u32 s6, s6, s7
s_lshl_b32 s7, s82, 1
s_add_u32 s6, s6, s7
s_lshl_b32 s6, s6, 12
s_add_u32 s6, s6, 10485760
s_add_u32 s7, s6, 4096
s_nop 7
v_pk_mul_f32 v[160:161], v[64:65], v[64:65]
v_pk_mul_f32 v[162:163], v[66:67], v[66:67]
v_pk_mul_f32 v[164:165], v[68:69], v[68:69]
v_pk_mul_f32 v[166:167], v[70:71], v[70:71]
v_pk_fma_f32 v[160:161], v[160:161], v[52:53], v[52:53] op_sel:[0,1,0] op_sel_hi:[1,1,0]
v_pk_fma_f32 v[162:163], v[162:163], v[52:53], v[52:53] op_sel:[0,1,0] op_sel_hi:[1,1,0]
v_pk_fma_f32 v[164:165], v[164:165], v[52:53], v[52:53] op_sel:[0,1,0] op_sel_hi:[1,1,0]
v_pk_fma_f32 v[166:167], v[166:167], v[52:53], v[52:53] op_sel:[0,1,0] op_sel_hi:[1,1,0]
v_pk_mul_f32 v[160:161], v[160:161], v[64:65]
v_pk_mul_f32 v[162:163], v[162:163], v[66:67]
v_pk_mul_f32 v[164:165], v[164:165], v[68:69]
v_pk_mul_f32 v[166:167], v[166:167], v[70:71]
v_exp_f32 v160, v160
v_exp_f32 v161, v161
v_exp_f32 v162, v162
v_exp_f32 v163, v163
v_exp_f32 v164, v164
v_exp_f32 v165, v165
v_exp_f32 v166, v166
v_exp_f32 v167, v167
v_pk_fma_f32 v[160:161], v[160:161], v[54:55], v[54:55]
v_pk_fma_f32 v[162:163], v[162:163], v[54:55], v[54:55]
v_pk_fma_f32 v[164:165], v[164:165], v[54:55], v[54:55]
v_pk_fma_f32 v[166:167], v[166:167], v[54:55], v[54:55]
v_rcp_f32 v160, v160
v_rcp_f32 v161, v161
v_rcp_f32 v162, v162
v_rcp_f32 v163, v163
v_rcp_f32 v164, v164
v_rcp_f32 v165, v165
v_rcp_f32 v166, v166
v_rcp_f32 v167, v167
v_pk_mul_f32 v[160:161], v[160:161], v[64:65]
v_pk_mul_f32 v[162:163], v[162:163], v[66:67]
v_pk_mul_f32 v[164:165], v[164:165], v[68:69]
v_pk_mul_f32 v[166:167], v[166:167], v[70:71]
v_cvt_pk_bf16_f32 v168, v160, v161
v_cvt_pk_bf16_f32 v169, v162, v163
v_cvt_pk_bf16_f32 v170, v164, v165
v_cvt_pk_bf16_f32 v171, v166, v167
buffer_store_dwordx4 v[168:171], v3, s[24:27], s6 offen offset:0 sc1
v_pk_mul_f32 v[160:161], v[72:73], v[72:73]
v_pk_mul_f32 v[162:163], v[74:75], v[74:75]
v_pk_mul_f32 v[164:165], v[76:77], v[76:77]
v_pk_mul_f32 v[166:167], v[78:79], v[78:79]
v_pk_fma_f32 v[160:161], v[160:161], v[52:53], v[52:53] op_sel:[0,1,0] op_sel_hi:[1,1,0]
v_pk_fma_f32 v[162:163], v[162:163], v[52:53], v[52:53] op_sel:[0,1,0] op_sel_hi:[1,1,0]
v_pk_fma_f32 v[164:165], v[164:165], v[52:53], v[52:53] op_sel:[0,1,0] op_sel_hi:[1,1,0]
v_pk_fma_f32 v[166:167], v[166:167], v[52:53], v[52:53] op_sel:[0,1,0] op_sel_hi:[1,1,0]
v_pk_mul_f32 v[160:161], v[160:161], v[72:73]
v_pk_mul_f32 v[162:163], v[162:163], v[74:75]
v_pk_mul_f32 v[164:165], v[164:165], v[76:77]
v_pk_mul_f32 v[166:167], v[166:167], v[78:79]
v_exp_f32 v160, v160
v_exp_f32 v161, v161
v_exp_f32 v162, v162
v_exp_f32 v163, v163
v_exp_f32 v164, v164
v_exp_f32 v165, v165
v_exp_f32 v166, v166
v_exp_f32 v167, v167
v_pk_fma_f32 v[160:161], v[160:161], v[54:55], v[54:55]
v_pk_fma_f32 v[162:163], v[162:163], v[54:55], v[54:55]
v_pk_fma_f32 v[164:165], v[164:165], v[54:55], v[54:55]
v_pk_fma_f32 v[166:167], v[166:167], v[54:55], v[54:55]
v_rcp_f32 v160, v160
v_rcp_f32 v161, v161
v_rcp_f32 v162, v162
v_rcp_f32 v163, v163
v_rcp_f32 v164, v164
v_rcp_f32 v165, v165
v_rcp_f32 v166, v166
v_rcp_f32 v167, v167
v_pk_mul_f32 v[160:161], v[160:161], v[72:73]
v_pk_mul_f32 v[162:163], v[162:163], v[74:75]
v_pk_mul_f32 v[164:165], v[164:165], v[76:77]
v_pk_mul_f32 v[166:167], v[166:167], v[78:79]
v_cvt_pk_bf16_f32 v172, v160, v161
v_cvt_pk_bf16_f32 v173, v162, v163
v_cvt_pk_bf16_f32 v174, v164, v165
v_cvt_pk_bf16_f32 v175, v166, v167
buffer_store_dwordx4 v[172:175], v3, s[24:27], s6 offen offset:512 sc1
v_pk_mul_f32 v[160:161], v[80:81], v[80:81]
v_pk_mul_f32 v[162:163], v[82:83], v[82:83]
v_pk_mul_f32 v[164:165], v[84:85], v[84:85]
v_pk_mul_f32 v[166:167], v[86:87], v[86:87]
v_pk_fma_f32 v[160:161], v[160:161], v[56:57], v[56:57] op_sel:[0,1,0] op_sel_hi:[1,1,0]
v_pk_fma_f32 v[162:163], v[162:163], v[56:57], v[56:57] op_sel:[0,1,0] op_sel_hi:[1,1,0]
v_pk_fma_f32 v[164:165], v[164:165], v[56:57], v[56:57] op_sel:[0,1,0] op_sel_hi:[1,1,0]
v_pk_fma_f32 v[166:167], v[166:167], v[56:57], v[56:57] op_sel:[0,1,0] op_sel_hi:[1,1,0]
v_pk_mul_f32 v[160:161], v[160:161], v[80:81]
v_pk_mul_f32 v[162:163], v[162:163], v[82:83]
v_pk_mul_f32 v[164:165], v[164:165], v[84:85]
v_pk_mul_f32 v[166:167], v[166:167], v[86:87]
v_exp_f32 v160, v160
v_exp_f32 v161, v161
v_exp_f32 v162, v162
v_exp_f32 v163, v163
v_exp_f32 v164, v164
v_exp_f32 v165, v165
v_exp_f32 v166, v166
v_exp_f32 v167, v167
v_pk_fma_f32 v[160:161], v[160:161], v[58:59], v[58:59]
v_pk_fma_f32 v[162:163], v[162:163], v[58:59], v[58:59]
v_pk_fma_f32 v[164:165], v[164:165], v[58:59], v[58:59]
v_pk_fma_f32 v[166:167], v[166:167], v[58:59], v[58:59]
v_rcp_f32 v160, v160
v_rcp_f32 v161, v161
v_rcp_f32 v162, v162
v_rcp_f32 v163, v163
v_rcp_f32 v164, v164
v_rcp_f32 v165, v165
v_rcp_f32 v166, v166
v_rcp_f32 v167, v167
v_pk_mul_f32 v[160:161], v[160:161], v[80:81]
v_pk_mul_f32 v[162:163], v[162:163], v[82:83]
v_pk_mul_f32 v[164:165], v[164:165], v[84:85]
v_pk_mul_f32 v[166:167], v[166:167], v[86:87]
v_cvt_pk_bf16_f32 v176, v160, v161
v_cvt_pk_bf16_f32 v177, v162, v163
v_cvt_pk_bf16_f32 v178, v164, v165
v_cvt_pk_bf16_f32 v179, v166, v167
buffer_store_dwordx4 v[176:179], v3, s[24:27], s6 offen offset:2048 sc1
v_pk_mul_f32 v[160:161], v[88:89], v[88:89]
v_pk_mul_f32 v[162:163], v[90:91], v[90:91]
v_pk_mul_f32 v[164:165], v[92:93], v[92:93]
v_pk_mul_f32 v[166:167], v[94:95], v[94:95]
v_pk_fma_f32 v[160:161], v[160:161], v[56:57], v[56:57] op_sel:[0,1,0] op_sel_hi:[1,1,0]
v_pk_fma_f32 v[162:163], v[162:163], v[56:57], v[56:57] op_sel:[0,1,0] op_sel_hi:[1,1,0]
v_pk_fma_f32 v[164:165], v[164:165], v[56:57], v[56:57] op_sel:[0,1,0] op_sel_hi:[1,1,0]
v_pk_fma_f32 v[166:167], v[166:167], v[56:57], v[56:57] op_sel:[0,1,0] op_sel_hi:[1,1,0]
v_pk_mul_f32 v[160:161], v[160:161], v[88:89]
v_pk_mul_f32 v[162:163], v[162:163], v[90:91]
v_pk_mul_f32 v[164:165], v[164:165], v[92:93]
v_pk_mul_f32 v[166:167], v[166:167], v[94:95]
v_exp_f32 v160, v160
v_exp_f32 v161, v161
v_exp_f32 v162, v162
v_exp_f32 v163, v163
v_exp_f32 v164, v164
v_exp_f32 v165, v165
v_exp_f32 v166, v166
v_exp_f32 v167, v167
v_pk_fma_f32 v[160:161], v[160:161], v[58:59], v[58:59]
v_pk_fma_f32 v[162:163], v[162:163], v[58:59], v[58:59]
v_pk_fma_f32 v[164:165], v[164:165], v[58:59], v[58:59]
v_pk_fma_f32 v[166:167], v[166:167], v[58:59], v[58:59]
v_rcp_f32 v160, v160
v_rcp_f32 v161, v161
v_rcp_f32 v162, v162
v_rcp_f32 v163, v163
v_rcp_f32 v164, v164
v_rcp_f32 v165, v165
v_rcp_f32 v166, v166
v_rcp_f32 v167, v167
v_pk_mul_f32 v[160:161], v[160:161], v[88:89]
v_pk_mul_f32 v[162:163], v[162:163], v[90:91]
v_pk_mul_f32 v[164:165], v[164:165], v[92:93]
v_pk_mul_f32 v[166:167], v[166:167], v[94:95]
v_cvt_pk_bf16_f32 v180, v160, v161
v_cvt_pk_bf16_f32 v181, v162, v163
v_cvt_pk_bf16_f32 v182, v164, v165
v_cvt_pk_bf16_f32 v183, v166, v167
buffer_store_dwordx4 v[180:183], v3, s[24:27], s6 offen offset:2560 sc1
v_pk_mul_f32 v[160:161], v[96:97], v[96:97]
v_pk_mul_f32 v[162:163], v[98:99], v[98:99]
v_pk_mul_f32 v[164:165], v[100:101], v[100:101]
v_pk_mul_f32 v[166:167], v[102:103], v[102:103]
v_pk_fma_f32 v[160:161], v[160:161], v[52:53], v[52:53] op_sel:[0,1,0] op_sel_hi:[1,1,0]
v_pk_fma_f32 v[162:163], v[162:163], v[52:53], v[52:53] op_sel:[0,1,0] op_sel_hi:[1,1,0]
v_pk_fma_f32 v[164:165], v[164:165], v[52:53], v[52:53] op_sel:[0,1,0] op_sel_hi:[1,1,0]
v_pk_fma_f32 v[166:167], v[166:167], v[52:53], v[52:53] op_sel:[0,1,0] op_sel_hi:[1,1,0]
v_pk_mul_f32 v[160:161], v[160:161], v[96:97]
v_pk_mul_f32 v[162:163], v[162:163], v[98:99]
v_pk_mul_f32 v[164:165], v[164:165], v[100:101]
v_pk_mul_f32 v[166:167], v[166:167], v[102:103]
v_exp_f32 v160, v160
v_exp_f32 v161, v161
v_exp_f32 v162, v162
v_exp_f32 v163, v163
v_exp_f32 v164, v164
v_exp_f32 v165, v165
v_exp_f32 v166, v166
v_exp_f32 v167, v167
v_pk_fma_f32 v[160:161], v[160:161], v[54:55], v[54:55]
v_pk_fma_f32 v[162:163], v[162:163], v[54:55], v[54:55]
v_pk_fma_f32 v[164:165], v[164:165], v[54:55], v[54:55]
v_pk_fma_f32 v[166:167], v[166:167], v[54:55], v[54:55]
v_rcp_f32 v160, v160
v_rcp_f32 v161, v161
v_rcp_f32 v162, v162
v_rcp_f32 v163, v163
v_rcp_f32 v164, v164
v_rcp_f32 v165, v165
v_rcp_f32 v166, v166
v_rcp_f32 v167, v167
v_pk_mul_f32 v[160:161], v[160:161], v[96:97]
v_pk_mul_f32 v[162:163], v[162:163], v[98:99]
v_pk_mul_f32 v[164:165], v[164:165], v[100:101]
v_pk_mul_f32 v[166:167], v[166:167], v[102:103]
v_cvt_pk_bf16_f32 v168, v160, v161
v_cvt_pk_bf16_f32 v169, v162, v163
v_cvt_pk_bf16_f32 v170, v164, v165
v_cvt_pk_bf16_f32 v171, v166, v167
buffer_store_dwordx4 v[168:171], v3, s[24:27], s7 offen offset:0 sc1
v_pk_mul_f32 v[160:161], v[104:105], v[104:105]
v_pk_mul_f32 v[162:163], v[106:107], v[106:107]
v_pk_mul_f32 v[164:165], v[108:109], v[108:109]
v_pk_mul_f32 v[166:167], v[110:111], v[110:111]
v_pk_fma_f32 v[160:161], v[160:161], v[52:53], v[52:53] op_sel:[0,1,0] op_sel_hi:[1,1,0]
v_pk_fma_f32 v[162:163], v[162:163], v[52:53], v[52:53] op_sel:[0,1,0] op_sel_hi:[1,1,0]
v_pk_fma_f32 v[164:165], v[164:165], v[52:53], v[52:53] op_sel:[0,1,0] op_sel_hi:[1,1,0]
v_pk_fma_f32 v[166:167], v[166:167], v[52:53], v[52:53] op_sel:[0,1,0] op_sel_hi:[1,1,0]
v_pk_mul_f32 v[160:161], v[160:161], v[104:105]
v_pk_mul_f32 v[162:163], v[162:163], v[106:107]
v_pk_mul_f32 v[164:165], v[164:165], v[108:109]
v_pk_mul_f32 v[166:167], v[166:167], v[110:111]
v_exp_f32 v160, v160
v_exp_f32 v161, v161
v_exp_f32 v162, v162
v_exp_f32 v163, v163
v_exp_f32 v164, v164
v_exp_f32 v165, v165
v_exp_f32 v166, v166
v_exp_f32 v167, v167
v_pk_fma_f32 v[160:161], v[160:161], v[54:55], v[54:55]
v_pk_fma_f32 v[162:163], v[162:163], v[54:55], v[54:55]
v_pk_fma_f32 v[164:165], v[164:165], v[54:55], v[54:55]
v_pk_fma_f32 v[166:167], v[166:167], v[54:55], v[54:55]
v_rcp_f32 v160, v160
v_rcp_f32 v161, v161
v_rcp_f32 v162, v162
v_rcp_f32 v163, v163
v_rcp_f32 v164, v164
v_rcp_f32 v165, v165
v_rcp_f32 v166, v166
v_rcp_f32 v167, v167
v_pk_mul_f32 v[160:161], v[160:161], v[104:105]
v_pk_mul_f32 v[162:163], v[162:163], v[106:107]
v_pk_mul_f32 v[164:165], v[164:165], v[108:109]
v_pk_mul_f32 v[166:167], v[166:167], v[110:111]
v_cvt_pk_bf16_f32 v172, v160, v161
v_cvt_pk_bf16_f32 v173, v162, v163
v_cvt_pk_bf16_f32 v174, v164, v165
v_cvt_pk_bf16_f32 v175, v166, v167
buffer_store_dwordx4 v[172:175], v3, s[24:27], s7 offen offset:512 sc1
v_pk_mul_f32 v[160:161], v[112:113], v[112:113]
v_pk_mul_f32 v[162:163], v[114:115], v[114:115]
v_pk_mul_f32 v[164:165], v[116:117], v[116:117]
v_pk_mul_f32 v[166:167], v[118:119], v[118:119]
v_pk_fma_f32 v[160:161], v[160:161], v[56:57], v[56:57] op_sel:[0,1,0] op_sel_hi:[1,1,0]
v_pk_fma_f32 v[162:163], v[162:163], v[56:57], v[56:57] op_sel:[0,1,0] op_sel_hi:[1,1,0]
v_pk_fma_f32 v[164:165], v[164:165], v[56:57], v[56:57] op_sel:[0,1,0] op_sel_hi:[1,1,0]
v_pk_fma_f32 v[166:167], v[166:167], v[56:57], v[56:57] op_sel:[0,1,0] op_sel_hi:[1,1,0]
v_pk_mul_f32 v[160:161], v[160:161], v[112:113]
v_pk_mul_f32 v[162:163], v[162:163], v[114:115]
v_pk_mul_f32 v[164:165], v[164:165], v[116:117]
v_pk_mul_f32 v[166:167], v[166:167], v[118:119]
v_exp_f32 v160, v160
v_exp_f32 v161, v161
v_exp_f32 v162, v162
v_exp_f32 v163, v163
v_exp_f32 v164, v164
v_exp_f32 v165, v165
v_exp_f32 v166, v166
v_exp_f32 v167, v167
v_pk_fma_f32 v[160:161], v[160:161], v[58:59], v[58:59]
v_pk_fma_f32 v[162:163], v[162:163], v[58:59], v[58:59]
v_pk_fma_f32 v[164:165], v[164:165], v[58:59], v[58:59]
v_pk_fma_f32 v[166:167], v[166:167], v[58:59], v[58:59]
v_rcp_f32 v160, v160
v_rcp_f32 v161, v161
v_rcp_f32 v162, v162
v_rcp_f32 v163, v163
v_rcp_f32 v164, v164
v_rcp_f32 v165, v165
v_rcp_f32 v166, v166
v_rcp_f32 v167, v167
v_pk_mul_f32 v[160:161], v[160:161], v[112:113]
v_pk_mul_f32 v[162:163], v[162:163], v[114:115]
v_pk_mul_f32 v[164:165], v[164:165], v[116:117]
v_pk_mul_f32 v[166:167], v[166:167], v[118:119]
v_cvt_pk_bf16_f32 v176, v160, v161
v_cvt_pk_bf16_f32 v177, v162, v163
v_cvt_pk_bf16_f32 v178, v164, v165
v_cvt_pk_bf16_f32 v179, v166, v167
buffer_store_dwordx4 v[176:179], v3, s[24:27], s7 offen offset:2048 sc1
v_pk_mul_f32 v[160:161], v[120:121], v[120:121]
v_pk_mul_f32 v[162:163], v[122:123], v[122:123]
v_pk_mul_f32 v[164:165], v[124:125], v[124:125]
v_pk_mul_f32 v[166:167], v[126:127], v[126:127]
v_pk_fma_f32 v[160:161], v[160:161], v[56:57], v[56:57] op_sel:[0,1,0] op_sel_hi:[1,1,0]
v_pk_fma_f32 v[162:163], v[162:163], v[56:57], v[56:57] op_sel:[0,1,0] op_sel_hi:[1,1,0]
v_pk_fma_f32 v[164:165], v[164:165], v[56:57], v[56:57] op_sel:[0,1,0] op_sel_hi:[1,1,0]
v_pk_fma_f32 v[166:167], v[166:167], v[56:57], v[56:57] op_sel:[0,1,0] op_sel_hi:[1,1,0]
v_pk_mul_f32 v[160:161], v[160:161], v[120:121]
v_pk_mul_f32 v[162:163], v[162:163], v[122:123]
v_pk_mul_f32 v[164:165], v[164:165], v[124:125]
v_pk_mul_f32 v[166:167], v[166:167], v[126:127]
v_exp_f32 v160, v160
v_exp_f32 v161, v161
v_exp_f32 v162, v162
v_exp_f32 v163, v163
v_exp_f32 v164, v164
v_exp_f32 v165, v165
v_exp_f32 v166, v166
v_exp_f32 v167, v167
v_pk_fma_f32 v[160:161], v[160:161], v[58:59], v[58:59]
v_pk_fma_f32 v[162:163], v[162:163], v[58:59], v[58:59]
v_pk_fma_f32 v[164:165], v[164:165], v[58:59], v[58:59]
v_pk_fma_f32 v[166:167], v[166:167], v[58:59], v[58:59]
v_rcp_f32 v160, v160
v_rcp_f32 v161, v161
v_rcp_f32 v162, v162
v_rcp_f32 v163, v163
v_rcp_f32 v164, v164
v_rcp_f32 v165, v165
v_rcp_f32 v166, v166
v_rcp_f32 v167, v167
v_pk_mul_f32 v[160:161], v[160:161], v[120:121]
v_pk_mul_f32 v[162:163], v[162:163], v[122:123]
v_pk_mul_f32 v[164:165], v[164:165], v[124:125]
v_pk_mul_f32 v[166:167], v[166:167], v[126:127]
v_cvt_pk_bf16_f32 v180, v160, v161
v_cvt_pk_bf16_f32 v181, v162, v163
v_cvt_pk_bf16_f32 v182, v164, v165
v_cvt_pk_bf16_f32 v183, v166, v167
buffer_store_dwordx4 v[180:183], v3, s[24:27], s7 offen offset:2560 sc1
L_end_4:
s_endpgm
.globl k2_kernel
.p2align 8
.type k2_kernel,@function
k2_kernel:
s_cmp_ge_u32 s2, 256
s_cbranch_scc1 L_end_5
s_load_dwordx16 s[40:55], s[0:1], 0
s_load_dwordx8 s[56:63], s[0:1], 64
s_load_dwordx4 s[64:67], s[0:1], 96
s_and_b32 s3, s2, 7
s_lshr_b32 s4, s2, 3
v_lshrrev_b32 v1, 6, v0
v_and_b32 v0, 0xff, v0
s_nop 0
v_readfirstlane_b32 s5, v1
v_and_b32 v1, 63, v0
s_waitcnt lgkmcnt(0)
s_mov_b32 s8, s40
s_and_b32 s9, s41, 0xffff
s_mov_b32 s10, 2621440
s_mov_b32 s11, 0x20000
s_mov_b32 s12, s42
s_and_b32 s13, s43, 0xffff
s_mov_b32 s14, 2621440
s_mov_b32 s15, 0x20000
s_mov_b32 s16, s44
s_and_b32 s17, s45, 0xffff
s_mov_b32 s18, 2621440
s_mov_b32 s19, 0x20000
s_mov_b32 s20, s54
s_and_b32 s21, s55, 0xffff
s_mov_b32 s22, 2211840
s_mov_b32 s23, 0x20000
s_mov_b32 s24, s66
s_and_b32 s25, s67, 0xffff
s_mov_b32 s26, 17825792
s_mov_b32 s27, 0x20000
s_mov_b32 s28, s62
s_and_b32 s29, s63, 0xffff
s_mov_b32 s30, 2621440
s_mov_b32 s31, 0x20000
s_lshl_b32 s6, s3, 4
s_lshr_b32 s7, s4, 1
s_add_u32 s6, s6, s7
s_mul_i32 s6, s6, 5
s_and_b32 s89, s4, 1
s_lshl_b32 s7, s89, 1
s_add_u32 s88, s6, s7
s_lshl_b32 s6, s5, 2
v_lshlrev_b32 v2, 2, v1
v_add_u32 v2, s6, v2
v_subrev_u32 v2, 252, v2
v_lshlrev_b32 v3, 4, v1
v_add_u32 v3, s6, v3
v_add_u32 v3, 4, v3
s_mul_i32 s90, s5, 4416
s_add_u32 s6, s88, 0
s_lshl_b32 s6, s6, 12
s_add_u32 s32, s48, s6
s_addc_u32 s33, s49, 0
s_and_b32 s33, s33, 0xffff
s_mov_b32 s34, 4096
s_mov_b32 s35, 0x20000
s_add_u32 m0, s90, 0
s_nop 0
buffer_load_dword v2, s[32:35], 0 offen lds
s_add_u32 m0, s90, 256
s_nop 0
buffer_load_dwordx4 v3, s[32:35], 0 offen offset:0 lds
buffer_load_dwordx4 v3, s[32:35], 0 offen offset:1024 lds
buffer_load_dwordx4 v3, s[32:35], 0 offen offset:2048 lds
buffer_load_dwordx4 v3, s[32:35], 0 offen offset:3072 lds
s_add_u32 s6, s88, 1
s_lshl_b32 s6, s6, 12
s_add_u32 s32, s48, s6
s_addc_u32 s33, s49, 0
s_and_b32 s33, s33, 0xffff
s_mov_b32 s34, 4096
s_mov_b32 s35, 0x20000
s_add_u32 m0, s90, 30208
s_nop 0
buffer_load_dword v2, s[32:35], 0 offen lds
s_add_u32 m0, s90, 30464
s_nop 0
buffer_load_dwordx4 v3, s[32:35], 0 offen offset:0 lds
buffer_load_dwordx4 v3, s[32:35], 0 offen offset:1024 lds
buffer_load_dwordx4 v3, s[32:35], 0 offen offset:2048 lds
buffer_load_dwordx4 v3, s[32:35], 0 offen offset:3072 lds
s_add_u32 s6, s88, 2
s_lshl_b32 s6, s6, 12
s_add_u32 s32, s48, s6
s_addc_u32 s33, s49, 0
s_and_b32 s33, s33, 0xffff
s_mov_b32 s34, 4096
s_mov_b32 s35, 0x20000
s_add_u32 m0, s90, 60416
s_nop 0
buffer_load_dword v2, s[32:35], 0 offen lds
s_add_u32 m0, s90, 60672
s_nop 0
buffer_load_dwordx4 v3, s[32:35], 0 offen offset:0 lds
buffer_load_dwordx4 v3, s[32:35], 0 offen offset:1024 lds
buffer_load_dwordx4 v3, s[32:35], 0 offen offset:2048 lds
buffer_load_dwordx4 v3, s[32:35], 0 offen offset:3072 lds
v_lshlrev_b32 v4, 4, v0
s_add_u32 s6, s88, 0
s_lshl_b32 s6, s6, 12
s_add_u32 s6, s6, 1048576
s_add_u32 s36, s66, s6
s_addc_u32 s37, s67, 0
s_and_b32 s37, s37, 0xffff
s_mov_b32 s38, 4096
s_mov_b32 s39, 0x20000
buffer_load_dwordx4 v[20:23], v4, s[36:39], 0 offen
buffer_load_dword v24, v4, s[36:39], 0 offen offset:16
s_add_u32 s6, s88, 1
s_lshl_b32 s6, s6, 12
s_add_u32 s6, s6, 1048576
s_add_u32 s36, s66, s6
s_addc_u32 s37, s67, 0
s_and_b32 s37, s37, 0xffff
s_mov_b32 s38, 4096
s_mov_b32 s39, 0x20000
buffer_load_dwordx4 v[26:29], v4, s[36:39], 0 offen
buffer_load_dword v30, v4, s[36:39], 0 offen offset:16
s_add_u32 s6, s88, 2
s_lshl_b32 s6, s6, 12
s_add_u32 s6, s6, 1048576
s_add_u32 s36, s66, s6
s_addc_u32 s37, s67, 0
s_and_b32 s37, s37, 0xffff
s_mov_b32 s38, 4096
s_mov_b32 s39, 0x20000
buffer_load_dwordx4 v[32:35], v4, s[36:39], 0 offen
buffer_load_dword v36, v4, s[36:39], 0 offen offset:16
v_lshrrev_b32 v4, 4, v0
v_mul_u32_u24 v4, 272, v4
v_and_b32 v5, 15, v0
v_lshl_add_u32 v4, v5, 4, v4
v_add_u32 v4, 17664, v4
v_lshlrev_b32 v5, 4, v0
v_add_u32 v5, 22016, v5
v_add_u32 v6, 60416, v4
v_add_u32 v7, 60416, v5
v_mov_b32 v12, 0
v_mov_b32 v13, 0
v_mov_b32 v14, 0
v_mov_b32 v15, 0
v_cmp_gt_u32 vcc, 119, v0
s_and_saveexec_b64 s[6:7], vcc
ds_write_b128 v5, v[12:15] offset:0
ds_write_b128 v5, v[12:15] offset:6272
ds_write_b128 v5, v[12:15] offset:30208
ds_write_b128 v5, v[12:15] offset:36480
ds_write_b128 v7, v[12:15] offset:0
ds_write_b128 v7, v[12:15] offset:6272
s_mov_b64 exec, s[6:7]
s_waitcnt vmcnt(4)
ds_write_b128 v4, v[20:23] offset:6272
v_alignbit_b32 v12, v21, v20, 16
v_alignbit_b32 v13, v22, v21, 16
v_alignbit_b32 v14, v23, v22, 16
v_alignbit_b32 v15, v24, v23, 16
ds_write_b128 v4, v[12:15] offset:0
s_waitcnt vmcnt(2)
ds_write_b128 v4, v[26:29] offset:36480
v_alignbit_b32 v12, v27, v26, 16
v_alignbit_b32 v13, v28, v27, 16
v_alignbit_b32 v14, v29, v28, 16
v_alignbit_b32 v15, v30, v29, 16
ds_write_b128 v4, v[12:15] offset:30208
s_waitcnt vmcnt(0)
ds_write_b128 v6, v[32:35] offset:6272
v_alignbit_b32 v12, v33, v32, 16
v_alignbit_b32 v13, v34, v33, 16
v_alignbit_b32 v14, v35, v34, 16
v_alignbit_b32 v15, v36, v35, 16
ds_write_b128 v6, v[12:15] offset:0
s_waitcnt vmcnt(0) lgkmcnt(0)
s_barrier
s_lshl_b32 s6, s89, 2
s_add_u32 s6, s6, s5
s_lshl_b32 s7, s6, 1
s_lshr_b32 s85, 6436, s7
s_and_b32 s85, s85, 3
s_lshr_b32 s86, 55, s6
s_and_b32 s86, s86, 1
s_lshr_b32 s87, 61311, s7
s_and_b32 s87, s87, 3
v_and_b32 v2, 3, v1
v_mul_u32_u24 v2, 4416, v2
v_bfe_u32 v3, v1, 2, 2
v_lshrrev_b32 v4, 4, v1
v_add_u32 v3, v3, v4
v_lshl_add_u32 v16, v3, 4, v2
v_and_b32 v2, 1, v1
v_mul_u32_u24 v2, 6272, v2
v_bfe_u32 v3, v1, 1, 3
s_lshl_b32 s6, s86, 3
s_sub_u32 s6, 15, s6
v_sub_u32 v5, s6, v3
v_mul_u32_u24 v5, 272, v5
v_add_u32 v2, v2, v5
v_lshl_add_u32 v17, v4, 4, v2
s_lshl_b32 s6, s86, 3
v_add_u32 v3, s6, v3
v_lshlrev_b32 v3, 8, v3
v_and_b32 v2, 1, v1
v_lshl_or_b32 v2, v4, 1, v2
v_lshl_or_b32 v11, v2, 4, v3
L_cvunit_6:
s_mul_i32 s6, s85, 30208
s_add_u32 s6, s6, 0
v_add_u32 v8, s6, v16
s_add_u32 s6, s6, 17664
v_add_u32 v9, s6, v17
v_lshlrev_b32 v10, 5, v4
v_sub_u32 v10, v9, v10
s_add_u32 s91, s88, s85
s_lshl_b32 s6, s91, 1
s_and_b32 s6, s6, 0xfffffffc
s_load_dword s92, s[50:51], s6
s_lshl_b32 s93, s86, 2
s_add_u32 s93, s93, 4
ds_read_b128 v[64:67], v8 offset:0
ds_read_b128 v[68:71], v8 offset:64
ds_read_b128 v[72:75], v8 offset:128
ds_read_b128 v[76:79], v8 offset:192
ds_read_b128 v[80:83], v8 offset:256
ds_read_b128 v[84:87], v8 offset:320
ds_read_b128 v[88:91], v8 offset:384
ds_read_b128 v[92:95], v8 offset:448
ds_read_b128 v[96:99], v9 offset:0
ds_read_b128 v[100:103], v9 offset:64
ds_read_b128 v[104:107], v9 offset:128
v_mov_b32 v112, 0
v_mov_b32 v113, 0
v_mov_b32 v114, 0
v_mov_b32 v115, 0
v_mov_b32 v116, 0
v_mov_b32 v117, 0
v_mov_b32 v118, 0
v_mov_b32 v119, 0
v_mov_b32 v120, 0
v_mov_b32 v121, 0
v_mov_b32 v122, 0
v_mov_b32 v123, 0
v_mov_b32 v124, 0
v_mov_b32 v125, 0
v_mov_b32 v126, 0
v_mov_b32 v127, 0
s_waitcnt lgkmcnt(0)
L_cvloop_7:
s_waitcnt lgkmcnt(4)
v_mfma_f32_16x16x32_bf16 v[112:115], v[64:67], v[96:99], v[112:115]
ds_read_b128 v[64:67], v8 offset:512
v_mfma_f32_16x16x32_bf16 v[116:119], v[68:71], v[96:99], v[116:119]
ds_read_b128 v[108:111], v9 offset:192
v_mfma_f32_16x16x32_bf16 v[120:123], v[72:75], v[96:99], v[120:123]
v_mfma_f32_16x16x32_bf16 v[124:127], v[76:79], v[96:99], v[124:127]
s_waitcnt lgkmcnt(4)
v_mfma_f32_16x16x32_bf16 v[112:115], v[68:71], v[100:103], v[112:115]
ds_read_b128 v[68:71], v8 offset:576
v_mfma_f32_16x16x32_bf16 v[116:119], v[72:75], v[100:103], v[116:119]
ds_read_b128 v[96:99], v9 offset:272
v_mfma_f32_16x16x32_bf16 v[120:123], v[76:79], v[100:103], v[120:123]
v_mfma_f32_16x16x32_bf16 v[124:127], v[80:83], v[100:103], v[124:127]
s_waitcnt lgkmcnt(4)
v_mfma_f32_16x16x32_bf16 v[112:115], v[72:75], v[104:107], v[112:115]
ds_read_b128 v[72:75], v8 offset:640
v_mfma_f32_16x16x32_bf16 v[116:119], v[76:79], v[104:107], v[116:119]
ds_read_b128 v[100:103], v9 offset:336
v_mfma_f32_16x16x32_bf16 v[120:123], v[80:83], v[104:107], v[120:123]
v_mfma_f32_16x16x32_bf16 v[124:127], v[84:87], v[104:107], v[124:127]
s_waitcnt lgkmcnt(4)
v_mfma_f32_16x16x32_bf16 v[112:115], v[76:79], v[108:111], v[112:115]
ds_read_b128 v[76:79], v8 offset:704
v_mfma_f32_16x16x32_bf16 v[116:119], v[80:83], v[108:111], v[116:119]
ds_read_b128 v[104:107], v9 offset:400
v_mfma_f32_16x16x32_bf16 v[120:123], v[84:87], v[108:111], v[120:123]
v_mfma_f32_16x16x32_bf16 v[124:127], v[88:91], v[108:111], v[124:127]
s_waitcnt lgkmcnt(4)
v_mfma_f32_16x16x32_bf16 v[112:115], v[80:83], v[96:99], v[112:115]
ds_read_b128 v[80:83], v8 offset:768
v_mfma_f32_16x16x32_bf16 v[116:119], v[84:87], v[96:99], v[116:119]
ds_read_b128 v[108:111], v9 offset:464
v_mfma_f32_16x16x32_bf16 v[120:123], v[88:91], v[96:99], v[120:123]
v_mfma_f32_16x16x32_bf16 v[124:127], v[92:95], v[96:99], v[124:127]
s_waitcnt lgkmcnt(4)
v_mfma_f32_16x16x32_bf16 v[112:115], v[84:87], v[100:103], v[112:115]
ds_read_b128 v[84:87], v8 offset:832
v_mfma_f32_16x16x32_bf16 v[116:119], v[88:91], v[100:103], v[116:119]
ds_read_b128 v[96:99], v9 offset:544
v_mfma_f32_16x16x32_bf16 v[120:123], v[92:95], v[100:103], v[120:123]
v_mfma_f32_16x16x32_bf16 v[124:127], v[64:67], v[100:103], v[124:127]
s_waitcnt lgkmcnt(4)
v_mfma_f32_16x16x32_bf16 v[112:115], v[88:91], v[104:107], v[112:115]
ds_read_b128 v[88:91], v8 offset:896
v_mfma_f32_16x16x32_bf16 v[116:119], v[92:95], v[104:107], v[116:119]
ds_read_b128 v[100:103], v9 offset:608
v_mfma_f32_16x16x32_bf16 v[120:123], v[64:67], v[104:107], v[120:123]
v_mfma_f32_16x16x32_bf16 v[124:127], v[68:71], v[104:107], v[124:127]
s_waitcnt lgkmcnt(4)
v_mfma_f32_16x16x32_bf16 v[112:115], v[92:95], v[108:111], v[112:115]
ds_read_b128 v[92:95], v8 offset:960
v_mfma_f32_16x16x32_bf16 v[116:119], v[64:67], v[108:111], v[116:119]
ds_read_b128 v[104:107], v9 offset:672
v_mfma_f32_16x16x32_bf16 v[120:123], v[68:71], v[108:111], v[120:123]
v_mfma_f32_16x16x32_bf16 v[124:127], v[72:75], v[108:111], v[124:127]
v_add_u32 v8, 512, v8
v_add_u32 v9, 544, v9
s_sub_u32 s93, s93, 1
s_cmp_lg_u32 s93, 0
s_cbranch_scc1 L_cvloop_7
s_waitcnt lgkmcnt(0)
ds_read_b128 v[64:67], v10 offset:240
ds_read_b128 v[68:71], v10 offset:176
ds_read_b128 v[72:75], v10 offset:112
ds_read_b128 v[76:79], v10 offset:48
s_and_b32 s6, s91, 1
s_lshl_b32 s6, s6, 4
s_lshr_b32 s92, s92, s6
s_lshl_b32 s92, s92, 16
s_lshl_b32 s6, s91, 12
s_add_u32 s6, s6, 4194304
s_nop 4
s_waitcnt lgkmcnt(0)
v_lshlrev_b32 v67, 16, v67
v_fma_f32 v112, v67, s92, v112
v_lshlrev_b32 v66, 16, v66
v_fma_f32 v113, v66, s92, v113
v_lshlrev_b32 v65, 16, v65
v_fma_f32 v114, v65, s92, v114
v_lshlrev_b32 v64, 16, v64
v_fma_f32 v115, v64, s92, v115
v_lshlrev_b32 v71, 16, v71
v_fma_f32 v116, v71, s92, v116
v_lshlrev_b32 v70, 16, v70
v_fma_f32 v117, v70, s92, v117
v_lshlrev_b32 v69, 16, v69
v_fma_f32 v118, v69, s92, v118
v_lshlrev_b32 v68, 16, v68
v_fma_f32 v119, v68, s92, v119
v_lshlrev_b32 v75, 16, v75
v_fma_f32 v120, v75, s92, v120
v_lshlrev_b32 v74, 16, v74
v_fma_f32 v121, v74, s92, v121
v_lshlrev_b32 v73, 16, v73
v_fma_f32 v122, v73, s92, v122
v_lshlrev_b32 v72, 16, v72
v_fma_f32 v123, v72, s92, v123
v_lshlrev_b32 v79, 16, v79
v_fma_f32 v124, v79, s92, v124
v_lshlrev_b32 v78, 16, v78
v_fma_f32 v125, v78, s92, v125
v_lshlrev_b32 v77, 16, v77
v_fma_f32 v126, v77, s92, v126
v_lshlrev_b32 v76, 16, v76
v_fma_f32 v127, v76, s92, v127
v_cvt_pk_bf16_f32 v96, v112, v113
v_cvt_pk_bf16_f32 v97, v114, v115
v_cvt_pk_bf16_f32 v98, v116, v117
v_cvt_pk_bf16_f32 v99, v118, v119
buffer_store_dwordx4 v[96:99], v11, s[24:27], s6 offen offset:0 sc1
v_cvt_pk_bf16_f32 v100, v120, v121
v_cvt_pk_bf16_f32 v101, v122, v123
v_cvt_pk_bf16_f32 v102, v124, v125
v_cvt_pk_bf16_f32 v103, v126, v127
buffer_store_dwordx4 v[100:103], v11, s[24:27], s6 offen offset:128 sc1
s_cmp_eq_u32 s87, 3
s_cbranch_scc1 L_cvdone_8
s_mov_b32 s85, s87
s_mov_b32 s87, 3
s_branch L_cvunit_6
L_cvdone_8:
L_end_5:
s_endpgm
.globl k3_kernel
.p2align 8
.type k3_kernel,@function
k3_kernel:
s_cmp_ge_u32 s2, 256
s_cbranch_scc1 L_end_9
s_load_dwordx16 s[40:55], s[0:1], 0
s_load_dwordx8 s[56:63], s[0:1], 64
s_load_dwordx4 s[64:67], s[0:1], 96
s_and_b32 s3, s2, 7
s_lshr_b32 s4, s2, 3
v_lshrrev_b32 v1, 6, v0
v_and_b32 v0, 0xff, v0
s_nop 0
v_readfirstlane_b32 s5, v1
v_and_b32 v1, 63, v0
s_waitcnt lgkmcnt(0)
s_mov_b32 s8, s40
s_and_b32 s9, s41, 0xffff
s_mov_b32 s10, 2621440
s_mov_b32 s11, 0x20000
s_mov_b32 s12, s42
s_and_b32 s13, s43, 0xffff
s_mov_b32 s14, 2621440
s_mov_b32 s15, 0x20000
s_mov_b32 s16, s44
s_and_b32 s17, s45, 0xffff
s_mov_b32 s18, 2621440
s_mov_b32 s19, 0x20000
s_mov_b32 s20, s54
s_and_b32 s21, s55, 0xffff
s_mov_b32 s22, 2211840
s_mov_b32 s23, 0x20000
s_mov_b32 s24, s66
s_and_b32 s25, s67, 0xffff
s_mov_b32 s26, 17825792
s_mov_b32 s27, 0x20000
s_mov_b32 s28, s62
s_and_b32 s29, s63, 0xffff
s_mov_b32 s30, 2621440
s_mov_b32 s31, 0x20000
s_lshr_b32 s6, s3, 1
s_lshl_b32 s6, s6, 3
s_and_b32 s7, s4, 7
s_add_u32 s94, s6, s7
s_and_b32 s6, s3, 1
s_lshl_b32 s6, s6, 2
s_lshr_b32 s7, s4, 3
s_add_u32 s95, s6, s7
s_mul_i32 s96, s5, 14
s_cmp_eq_u32 s5, 3
s_cselect_b32 s6, 1, 0
s_sub_u32 s96, s96, s6
s_mul_i32 s6, s95, 54
s_add_u32 s6, s6, s96
s_mul_i32 s97, s6, 5120
s_add_u32 s97, s97, 7340032
s_add_u32 s98, s97, 4096
v_lshlrev_b32 v59, 4, v1
v_mov_b32 v55, v59
buffer_load_dwordx4 a[0:3], v55, s[24:27], s97 offen offset:0
buffer_load_dwordx4 a[4:7], v55, s[24:27], s97 offen offset:1024
buffer_load_dwordx4 a[8:11], v55, s[24:27], s97 offen offset:2048
buffer_load_dwordx4 a[12:15], v55, s[24:27], s97 offen offset:3072
buffer_load_dwordx4 a[16:19], v55, s[24:27], s98 offen
s_add_u32 s97, s97, 5120
s_add_u32 s98, s98, 5120
buffer_load_dwordx4 a[20:23], v55, s[24:27], s97 offen offset:0
buffer_load_dwordx4 a[24:27], v55, s[24:27], s97 offen offset:1024
buffer_load_dwordx4 a[28:31], v55, s[24:27], s97 offen offset:2048
buffer_load_dwordx4 a[32:35], v55, s[24:27], s97 offen offset:3072
buffer_load_dwordx4 a[36:39], v55, s[24:27], s98 offen
s_add_u32 s97, s97, 5120
s_add_u32 s98, s98, 5120
buffer_load_dwordx4 a[40:43], v55, s[24:27], s97 offen offset:0
buffer_load_dwordx4 a[44:47], v55, s[24:27], s97 offen offset:1024
buffer_load_dwordx4 a[48:51], v55, s[24:27], s97 offen offset:2048
buffer_load_dwordx4 a[52:55], v55, s[24:27], s97 offen offset:3072
buffer_load_dwordx4 a[56:59], v55, s[24:27], s98 offen
s_add_u32 s97, s97, 5120
s_add_u32 s98, s98, 5120
buffer_load_dwordx4 a[60:63], v55, s[24:27], s97 offen offset:0
buffer_load_dwordx4 a[64:67], v55, s[24:27], s97 offen offset:1024
buffer_load_dwordx4 a[68:71], v55, s[24:27], s97 offen offset:2048
buffer_load_dwordx4 a[72:75], v55, s[24:27], s97 offen offset:3072
buffer_load_dwordx4 a[76:79], v55, s[24:27], s98 offen
s_add_u32 s97, s97, 5120
s_add_u32 s98, s98, 5120
buffer_load_dwordx4 a[80:83], v55, s[24:27], s97 offen offset:0
buffer_load_dwordx4 a[84:87], v55, s[24:27], s97 offen offset:1024
buffer_load_dwordx4 a[88:91], v55, s[24:27], s97 offen offset:2048
buffer_load_dwordx4 a[92:95], v55, s[24:27], s97 offen offset:3072
buffer_load_dwordx4 a[96:99], v55, s[24:27], s98 offen
s_add_u32 s97, s97, 5120
s_add_u32 s98, s98, 5120
buffer_load_dwordx4 a[100:103], v55, s[24:27], s97 offen offset:0
buffer_load_dwordx4 a[104:107], v55, s[24:27], s97 offen offset:1024
buffer_load_dwordx4 a[108:111], v55, s[24:27], s97 offen offset:2048
buffer_load_dwordx4 a[112:115], v55, s[24:27], s97 offen offset:3072
buffer_load_dwordx4 a[116:119], v55, s[24:27], s98 offen
s_add_u32 s97, s97, 5120
s_add_u32 s98, s98, 5120
buffer_load_dwordx4 a[120:123], v55, s[24:27], s97 offen offset:0
buffer_load_dwordx4 a[124:127], v55, s[24:27], s97 offen offset:1024
buffer_load_dwordx4 a[128:131], v55, s[24:27], s97 offen offset:2048
buffer_load_dwordx4 a[132:135], v55, s[24:27], s97 offen offset:3072
buffer_load_dwordx4 a[136:139], v55, s[24:27], s98 offen
s_add_u32 s97, s97, 5120
s_add_u32 s98, s98, 5120
buffer_load_dwordx4 a[140:143], v55, s[24:27], s97 offen offset:0
buffer_load_dwordx4 a[144:147], v55, s[24:27], s97 offen offset:1024
buffer_load_dwordx4 a[148:151], v55, s[24:27], s97 offen offset:2048
buffer_load_dwordx4 a[152:155], v55, s[24:27], s97 offen offset:3072
buffer_load_dwordx4 a[156:159], v55, s[24:27], s98 offen
s_add_u32 s97, s97, 5120
s_add_u32 s98, s98, 5120
buffer_load_dwordx4 a[160:163], v55, s[24:27], s97 offen offset:0
buffer_load_dwordx4 a[164:167], v55, s[24:27], s97 offen offset:1024
buffer_load_dwordx4 a[168:171], v55, s[24:27], s97 offen offset:2048
buffer_load_dwordx4 a[172:175], v55, s[24:27], s97 offen offset:3072
buffer_load_dwordx4 a[176:179], v55, s[24:27], s98 offen
s_add_u32 s97, s97, 5120
s_add_u32 s98, s98, 5120
buffer_load_dwordx4 a[180:183], v55, s[24:27], s97 offen offset:0
buffer_load_dwordx4 a[184:187], v55, s[24:27], s97 offen offset:1024
buffer_load_dwordx4 a[188:191], v55, s[24:27], s97 offen offset:2048
buffer_load_dwordx4 a[192:195], v55, s[24:27], s97 offen offset:3072
buffer_load_dwordx4 a[196:199], v55, s[24:27], s98 offen
s_add_u32 s97, s97, 5120
s_add_u32 s98, s98, 5120
buffer_load_dwordx4 a[200:203], v55, s[24:27], s97 offen offset:0
buffer_load_dwordx4 a[204:207], v55, s[24:27], s97 offen offset:1024
buffer_load_dwordx4 a[208:211], v55, s[24:27], s97 offen offset:2048
buffer_load_dwordx4 a[212:215], v55, s[24:27], s97 offen offset:3072
buffer_load_dwordx4 a[216:219], v55, s[24:27], s98 offen
s_add_u32 s97, s97, 5120
s_add_u32 s98, s98, 5120
buffer_load_dwordx4 a[220:223], v55, s[24:27], s97 offen offset:0
buffer_load_dwordx4 a[224:227], v55, s[24:27], s97 offen offset:1024
buffer_load_dwordx4 a[228:231], v55, s[24:27], s97 offen offset:2048
buffer_load_dwordx4 a[232:235], v55, s[24:27], s97 offen offset:3072
buffer_load_dwordx4 a[236:239], v55, s[24:27], s98 offen
s_add_u32 s97, s97, 5120
s_add_u32 s98, s98, 5120
buffer_load_dwordx4 v[208:211], v55, s[24:27], s97 offen offset:0
buffer_load_dwordx4 v[212:215], v55, s[24:27], s97 offen offset:1024
buffer_load_dwordx4 v[216:219], v55, s[24:27], s97 offen offset:2048
buffer_load_dwordx4 v[220:223], v55, s[24:27], s97 offen offset:3072
buffer_load_dwordx4 v[224:227], v55, s[24:27], s98 offen
s_add_u32 s97, s97, 5120
s_add_u32 s98, s98, 5120
buffer_load_dwordx4 v[228:231], v55, s[24:27], s97 offen offset:0
buffer_load_dwordx4 v[232:235], v55, s[24:27], s97 offen offset:1024
buffer_load_dwordx4 v[236:239], v55, s[24:27], s97 offen offset:2048
buffer_load_dwordx4 v[240:243], v55, s[24:27], s97 offen offset:3072
buffer_load_dwordx4 v[244:247], v55, s[24:27], s98 offen
s_add_u32 s97, s97, 5120
s_add_u32 s98, s98, 5120
s_mov_b32 s32, s60
s_and_b32 s33, s61, 0xffff
s_mov_b32 s34, 1280
s_mov_b32 s35, 0x20000
v_and_b32 v2, 15, v1
v_lshrrev_b32 v3, 4, v1
v_lshrrev_b32 v4, 3, v2
v_lshlrev_b32 v4, 3, v4
v_and_b32 v5, 3, v2
v_lshl_or_b32 v4, v5, 1, v4
v_bfe_u32 v5, v2, 2, 1
v_or_b32 v4, v4, v5
s_lshl_b32 s6, s94, 6
s_lshl_b32 s7, s5, 4
s_add_u32 s6, s6, s7
v_add_u32 v4, s6, v4
v_lshlrev_b32 v5, 4, v4
v_mul_u32_u24 v4, 1280, v4
v_mul_u32_u24 v3, 40, v3
s_mul_i32 s6, s95, 160
v_add_u32 v3, s6, v3
v_add_u32 v60, v4, v3
s_mov_b32 s7, 98304
buffer_load_dwordx4 v[8:11], v60, s[8:11], 0 offen
buffer_load_dwordx4 v[12:15], v60, s[8:11], 0 offen offset:16
buffer_load_dwordx2 v[16:17], v60, s[8:11], 0 offen offset:32
buffer_load_dwordx4 v[20:23], v3, s[32:35], 0 offen
buffer_load_dwordx4 v[24:27], v3, s[32:35], 0 offen offset:16
buffer_load_dwordx2 v[28:29], v3, s[32:35], 0 offen offset:32
buffer_load_dwordx4 v[32:35], v5, s[24:27], s7 offen
v_lshrrev_b32 v2, 3, v1
v_and_b32 v3, 7, v1
v_lshlrev_b32 v3, 4, v3
v_lshl_add_u32 v61, v2, 12, v3
s_mul_i32 s6, s95, 80
s_lshl_b32 s7, s5, 3
s_add_u32 s6, s6, s7
s_lshl_b32 s6, s6, 12
s_lshl_b32 s7, s94, 7
s_add_u32 s6, s6, s7
s_add_u32 s6, s6, 4194304
s_lshl_b32 s7, s5, 10
s_add_u32 s7, s7, 61440
s_mov_b32 m0, s7
s_add_u32 s7, s7, 4096
buffer_load_dwordx4 v61, s[24:27], s6 offen lds
s_add_u32 s6, s6, 131072
s_mov_b32 m0, s7
s_add_u32 s7, s7, 4096
buffer_load_dwordx4 v61, s[24:27], s6 offen lds
s_add_u32 s6, s6, 131072
s_cmp_ge_u32 s5, 2
s_cbranch_scc1 L_y2skip_10
s_mov_b32 m0, s7
s_add_u32 s7, s7, 4096
buffer_load_dwordx4 v61, s[24:27], s6 offen lds
s_add_u32 s6, s6, 131072
L_y2skip_10:
s_waitcnt vmcnt(0)
s_mul_i32 s6, s94, 54
s_add_u32 s6, s6, s96
s_lshl_b32 s99, s6, 12
s_add_u32 s99, s99, 10485760
v_lshlrev_b32 v2, 4, v1
s_add_u32 s6, s5, 0
s_and_b32 s6, s6, 3
s_lshl_b32 s6, s6, 10
v_add_u32 v56, s6, v2
s_add_u32 s6, s5, 1
s_and_b32 s6, s6, 3
s_lshl_b32 s6, s6, 10
v_add_u32 v57, s6, v2
s_add_u32 s6, s5, 2
s_and_b32 s6, s6, 3
s_lshl_b32 s6, s6, 10
v_add_u32 v58, s6, v2
s_add_u32 s6, s5, 3
s_and_b32 s6, s6, 3
s_lshl_b32 s6, s6, 10
v_add_u32 v59, s6, v2
buffer_load_dwordx4 v[64:67], v56, s[24:27], s99 offen
buffer_load_dwordx4 v[68:71], v57, s[24:27], s99 offen
buffer_load_dwordx4 v[72:75], v58, s[24:27], s99 offen
buffer_load_dwordx4 v[76:79], v59, s[24:27], s99 offen
s_add_u32 s99, s99, 4096
buffer_load_dwordx4 v[80:83], v56, s[24:27], s99 offen
buffer_load_dwordx4 v[84:87], v57, s[24:27], s99 offen
buffer_load_dwordx4 v[88:91], v58, s[24:27], s99 offen
buffer_load_dwordx4 v[92:95], v59, s[24:27], s99 offen
s_add_u32 s99, s99, 4096
buffer_load_dwordx4 v[96:99], v56, s[24:27], s99 offen
buffer_load_dwordx4 v[100:103], v57, s[24:27], s99 offen
buffer_load_dwordx4 v[104:107], v58, s[24:27], s99 offen
buffer_load_dwordx4 v[108:111], v59, s[24:27], s99 offen
s_add_u32 s99, s99, 4096
v_mov_b32 v128, 0
v_mov_b32 v129, 0
v_mov_b32 v130, 0
v_mov_b32 v131, 0
v_mov_b32 v132, 0
v_mov_b32 v133, 0
v_mov_b32 v134, 0
v_mov_b32 v135, 0
v_mov_b32 v136, 0
v_mov_b32 v137, 0
v_mov_b32 v138, 0
v_mov_b32 v139, 0
v_mov_b32 v140, 0
v_mov_b32 v141, 0
v_mov_b32 v142, 0
v_mov_b32 v143, 0
v_mov_b32 v144, 0
v_mov_b32 v145, 0
v_mov_b32 v146, 0
v_mov_b32 v147, 0
v_mov_b32 v148, 0
v_mov_b32 v149, 0
v_mov_b32 v150, 0
v_mov_b32 v151, 0
v_mov_b32 v152, 0
v_mov_b32 v153, 0
v_mov_b32 v154, 0
v_mov_b32 v155, 0
v_mov_b32 v156, 0
v_mov_b32 v157, 0
v_mov_b32 v158, 0
v_mov_b32 v159, 0
v_mov_b32 v160, 0
v_mov_b32 v161, 0
v_mov_b32 v162, 0
v_mov_b32 v163, 0
v_mov_b32 v164, 0
v_mov_b32 v165, 0
v_mov_b32 v166, 0
v_mov_b32 v167, 0
v_mov_b32 v168, 0
v_mov_b32 v169, 0
v_mov_b32 v170, 0
v_mov_b32 v171, 0
v_mov_b32 v172, 0
v_mov_b32 v173, 0
v_mov_b32 v174, 0
v_mov_b32 v175, 0
v_mov_b32 v176, 0
v_mov_b32 v177, 0
v_mov_b32 v178, 0
v_mov_b32 v179, 0
v_mov_b32 v180, 0
v_mov_b32 v181, 0
v_mov_b32 v182, 0
v_mov_b32 v183, 0
v_mov_b32 v184, 0
v_mov_b32 v185, 0
v_mov_b32 v186, 0
v_mov_b32 v187, 0
v_mov_b32 v188, 0
v_mov_b32 v189, 0
v_mov_b32 v190, 0
v_mov_b32 v191, 0
v_mov_b32 v192, 0
v_mov_b32 v193, 0
v_mov_b32 v194, 0
v_mov_b32 v195, 0
v_mov_b32 v196, 0
v_mov_b32 v197, 0
v_mov_b32 v198, 0
v_mov_b32 v199, 0
v_mov_b32 v200, 0
v_mov_b32 v201, 0
v_mov_b32 v202, 0
v_mov_b32 v203, 0
v_mov_b32 v204, 0
v_mov_b32 v205, 0
v_mov_b32 v206, 0
v_mov_b32 v207, 0
s_waitcnt vmcnt(8)
v_mfma_f32_16x16x32_bf16 v[128:131], a[0:3], v[64:67], v[128:131]
buffer_load_dwordx4 v[112:115], v56, s[24:27], s99 offen
v_mfma_f32_16x16x32_bf16 v[148:151], a[0:3], v[68:71], v[148:151]
v_mfma_f32_16x16x32_bf16 v[168:171], a[0:3], v[72:75], v[168:171]
v_mfma_f32_16x16x32_bf16 v[188:191], a[0:3], v[76:79], v[188:191]
v_mfma_f32_16x16x32_bf16 v[132:135], a[4:7], v[64:67], v[132:135]
buffer_load_dwordx4 v[116:119], v57, s[24:27], s99 offen
v_mfma_f32_16x16x32_bf16 v[152:155], a[4:7], v[68:71], v[152:155]
v_mfma_f32_16x16x32_bf16 v[172:175], a[4:7], v[72:75], v[172:175]
v_mfma_f32_16x16x32_bf16 v[192:195], a[4:7], v[76:79], v[192:195]
v_mfma_f32_16x16x32_bf16 v[136:139], a[8:11], v[64:67], v[136:139]
buffer_load_dwordx4 v[120:123], v58, s[24:27], s99 offen
v_mfma_f32_16x16x32_bf16 v[156:159], a[8:11], v[68:71], v[156:159]
v_mfma_f32_16x16x32_bf16 v[176:179], a[8:11], v[72:75], v[176:179]
v_mfma_f32_16x16x32_bf16 v[196:199], a[8:11], v[76:79], v[196:199]
v_mfma_f32_16x16x32_bf16 v[140:143], a[12:15], v[64:67], v[140:143]
buffer_load_dwordx4 v[124:127], v59, s[24:27], s99 offen
v_mfma_f32_16x16x32_bf16 v[160:163], a[12:15], v[68:71], v[160:163]
v_mfma_f32_16x16x32_bf16 v[180:183], a[12:15], v[72:75], v[180:183]
v_mfma_f32_16x16x32_bf16 v[200:203], a[12:15], v[76:79], v[200:203]
v_mfma_f32_16x16x32_bf16 v[144:147], a[16:19], v[64:67], v[144:147]
s_add_u32 s99, s99, 4096
v_mfma_f32_16x16x32_bf16 v[164:167], a[16:19], v[68:71], v[164:167]
v_mfma_f32_16x16x32_bf16 v[184:187], a[16:19], v[72:75], v[184:187]
v_mfma_f32_16x16x32_bf16 v[204:207], a[16:19], v[76:79], v[204:207]
s_waitcnt vmcnt(8)
v_mfma_f32_16x16x32_bf16 v[128:131], a[20:23], v[80:83], v[128:131]
buffer_load_dwordx4 v[64:67], v56, s[24:27], s99 offen
v_mfma_f32_16x16x32_bf16 v[148:151], a[20:23], v[84:87], v[148:151]
v_mfma_f32_16x16x32_bf16 v[168:171], a[20:23], v[88:91], v[168:171]
v_mfma_f32_16x16x32_bf16 v[188:191], a[20:23], v[92:95], v[188:191]
v_mfma_f32_16x16x32_bf16 v[132:135], a[24:27], v[80:83], v[132:135]
buffer_load_dwordx4 v[68:71], v57, s[24:27], s99 offen
v_mfma_f32_16x16x32_bf16 v[152:155], a[24:27], v[84:87], v[152:155]
v_mfma_f32_16x16x32_bf16 v[172:175], a[24:27], v[88:91], v[172:175]
v_mfma_f32_16x16x32_bf16 v[192:195], a[24:27], v[92:95], v[192:195]
v_mfma_f32_16x16x32_bf16 v[136:139], a[28:31], v[80:83], v[136:139]
buffer_load_dwordx4 v[72:75], v58, s[24:27], s99 offen
v_mfma_f32_16x16x32_bf16 v[156:159], a[28:31], v[84:87], v[156:159]
v_mfma_f32_16x16x32_bf16 v[176:179], a[28:31], v[88:91], v[176:179]
v_mfma_f32_16x16x32_bf16 v[196:199], a[28:31], v[92:95], v[196:199]
v_mfma_f32_16x16x32_bf16 v[140:143], a[32:35], v[80:83], v[140:143]
buffer_load_dwordx4 v[76:79], v59, s[24:27], s99 offen
v_mfma_f32_16x16x32_bf16 v[160:163], a[32:35], v[84:87], v[160:163]
v_mfma_f32_16x16x32_bf16 v[180:183], a[32:35], v[88:91], v[180:183]
v_mfma_f32_16x16x32_bf16 v[200:203], a[32:35], v[92:95], v[200:203]
v_mfma_f32_16x16x32_bf16 v[144:147], a[36:39], v[80:83], v[144:147]
s_add_u32 s99, s99, 4096
v_mfma_f32_16x16x32_bf16 v[164:167], a[36:39], v[84:87], v[164:167]
v_mfma_f32_16x16x32_bf16 v[184:187], a[36:39], v[88:91], v[184:187]
v_mfma_f32_16x16x32_bf16 v[204:207], a[36:39], v[92:95], v[204:207]
s_waitcnt vmcnt(8)
v_mfma_f32_16x16x32_bf16 v[128:131], a[40:43], v[96:99], v[128:131]
buffer_load_dwordx4 v[80:83], v56, s[24:27], s99 offen
v_mfma_f32_16x16x32_bf16 v[148:151], a[40:43], v[100:103], v[148:151]
v_mfma_f32_16x16x32_bf16 v[168:171], a[40:43], v[104:107], v[168:171]
v_mfma_f32_16x16x32_bf16 v[188:191], a[40:43], v[108:111], v[188:191]
v_mfma_f32_16x16x32_bf16 v[132:135], a[44:47], v[96:99], v[132:135]
buffer_load_dwordx4 v[84:87], v57, s[24:27], s99 offen
v_mfma_f32_16x16x32_bf16 v[152:155], a[44:47], v[100:103], v[152:155]
v_mfma_f32_16x16x32_bf16 v[172:175], a[44:47], v[104:107], v[172:175]
v_mfma_f32_16x16x32_bf16 v[192:195], a[44:47], v[108:111], v[192:195]
v_mfma_f32_16x16x32_bf16 v[136:139], a[48:51], v[96:99], v[136:139]
buffer_load_dwordx4 v[88:91], v58, s[24:27], s99 offen
v_mfma_f32_16x16x32_bf16 v[156:159], a[48:51], v[100:103], v[156:159]
v_mfma_f32_16x16x32_bf16 v[176:179], a[48:51], v[104:107], v[176:179]
v_mfma_f32_16x16x32_bf16 v[196:199], a[48:51], v[108:111], v[196:199]
v_mfma_f32_16x16x32_bf16 v[140:143], a[52:55], v[96:99], v[140:143]
buffer_load_dwordx4 v[92:95], v59, s[24:27], s99 offen
v_mfma_f32_16x16x32_bf16 v[160:163], a[52:55], v[100:103], v[160:163]
v_mfma_f32_16x16x32_bf16 v[180:183], a[52:55], v[104:107], v[180:183]
v_mfma_f32_16x16x32_bf16 v[200:203], a[52:55], v[108:111], v[200:203]
v_mfma_f32_16x16x32_bf16 v[144:147], a[56:59], v[96:99], v[144:147]
s_add_u32 s99, s99, 4096
v_mfma_f32_16x16x32_bf16 v[164:167], a[56:59], v[100:103], v[164:167]
v_mfma_f32_16x16x32_bf16 v[184:187], a[56:59], v[104:107], v[184:187]
v_mfma_f32_16x16x32_bf16 v[204:207], a[56:59], v[108:111], v[204:207]
s_waitcnt vmcnt(8)
v_mfma_f32_16x16x32_bf16 v[128:131], a[60:63], v[112:115], v[128:131]
buffer_load_dwordx4 v[96:99], v56, s[24:27], s99 offen
v_mfma_f32_16x16x32_bf16 v[148:151], a[60:63], v[116:119], v[148:151]
v_mfma_f32_16x16x32_bf16 v[168:171], a[60:63], v[120:123], v[168:171]
v_mfma_f32_16x16x32_bf16 v[188:191], a[60:63], v[124:127], v[188:191]
v_mfma_f32_16x16x32_bf16 v[132:135], a[64:67], v[112:115], v[132:135]
buffer_load_dwordx4 v[100:103], v57, s[24:27], s99 offen
v_mfma_f32_16x16x32_bf16 v[152:155], a[64:67], v[116:119], v[152:155]
v_mfma_f32_16x16x32_bf16 v[172:175], a[64:67], v[120:123], v[172:175]
v_mfma_f32_16x16x32_bf16 v[192:195], a[64:67], v[124:127], v[192:195]
v_mfma_f32_16x16x32_bf16 v[136:139], a[68:71], v[112:115], v[136:139]
buffer_load_dwordx4 v[104:107], v58, s[24:27], s99 offen
v_mfma_f32_16x16x32_bf16 v[156:159], a[68:71], v[116:119], v[156:159]
v_mfma_f32_16x16x32_bf16 v[176:179], a[68:71], v[120:123], v[176:179]
v_mfma_f32_16x16x32_bf16 v[196:199], a[68:71], v[124:127], v[196:199]
v_mfma_f32_16x16x32_bf16 v[140:143], a[72:75], v[112:115], v[140:143]
buffer_load_dwordx4 v[108:111], v59, s[24:27], s99 offen
v_mfma_f32_16x16x32_bf16 v[160:163], a[72:75], v[116:119], v[160:163]
v_mfma_f32_16x16x32_bf16 v[180:183], a[72:75], v[120:123], v[180:183]
v_mfma_f32_16x16x32_bf16 v[200:203], a[72:75], v[124:127], v[200:203]
v_mfma_f32_16x16x32_bf16 v[144:147], a[76:79], v[112:115], v[144:147]
s_add_u32 s99, s99, 4096
v_mfma_f32_16x16x32_bf16 v[164:167], a[76:79], v[116:119], v[164:167]
v_mfma_f32_16x16x32_bf16 v[184:187], a[76:79], v[120:123], v[184:187]
v_mfma_f32_16x16x32_bf16 v[204:207], a[76:79], v[124:127], v[204:207]
s_waitcnt vmcnt(8)
v_mfma_f32_16x16x32_bf16 v[128:131], a[80:83], v[64:67], v[128:131]
buffer_load_dwordx4 v[112:115], v56, s[24:27], s99 offen
v_mfma_f32_16x16x32_bf16 v[148:151], a[80:83], v[68:71], v[148:151]
v_mfma_f32_16x16x32_bf16 v[168:171], a[80:83], v[72:75], v[168:171]
v_mfma_f32_16x16x32_bf16 v[188:191], a[80:83], v[76:79], v[188:191]
v_mfma_f32_16x16x32_bf16 v[132:135], a[84:87], v[64:67], v[132:135]
buffer_load_dwordx4 v[116:119], v57, s[24:27], s99 offen
v_mfma_f32_16x16x32_bf16 v[152:155], a[84:87], v[68:71], v[152:155]
v_mfma_f32_16x16x32_bf16 v[172:175], a[84:87], v[72:75], v[172:175]
v_mfma_f32_16x16x32_bf16 v[192:195], a[84:87], v[76:79], v[192:195]
v_mfma_f32_16x16x32_bf16 v[136:139], a[88:91], v[64:67], v[136:139]
buffer_load_dwordx4 v[120:123], v58, s[24:27], s99 offen
v_mfma_f32_16x16x32_bf16 v[156:159], a[88:91], v[68:71], v[156:159]
v_mfma_f32_16x16x32_bf16 v[176:179], a[88:91], v[72:75], v[176:179]
v_mfma_f32_16x16x32_bf16 v[196:199], a[88:91], v[76:79], v[196:199]
v_mfma_f32_16x16x32_bf16 v[140:143], a[92:95], v[64:67], v[140:143]
buffer_load_dwordx4 v[124:127], v59, s[24:27], s99 offen
v_mfma_f32_16x16x32_bf16 v[160:163], a[92:95], v[68:71], v[160:163]
v_mfma_f32_16x16x32_bf16 v[180:183], a[92:95], v[72:75], v[180:183]
v_mfma_f32_16x16x32_bf16 v[200:203], a[92:95], v[76:79], v[200:203]
v_mfma_f32_16x16x32_bf16 v[144:147], a[96:99], v[64:67], v[144:147]
s_add_u32 s99, s99, 4096
v_mfma_f32_16x16x32_bf16 v[164:167], a[96:99], v[68:71], v[164:167]
v_mfma_f32_16x16x32_bf16 v[184:187], a[96:99], v[72:75], v[184:187]
v_mfma_f32_16x16x32_bf16 v[204:207], a[96:99], v[76:79], v[204:207]
s_waitcnt vmcnt(8)
v_mfma_f32_16x16x32_bf16 v[128:131], a[100:103], v[80:83], v[128:131]
buffer_load_dwordx4 v[64:67], v56, s[24:27], s99 offen
v_mfma_f32_16x16x32_bf16 v[148:151], a[100:103], v[84:87], v[148:151]
v_mfma_f32_16x16x32_bf16 v[168:171], a[100:103], v[88:91], v[168:171]
v_mfma_f32_16x16x32_bf16 v[188:191], a[100:103], v[92:95], v[188:191]
v_mfma_f32_16x16x32_bf16 v[132:135], a[104:107], v[80:83], v[132:135]
buffer_load_dwordx4 v[68:71], v57, s[24:27], s99 offen
v_mfma_f32_16x16x32_bf16 v[152:155], a[104:107], v[84:87], v[152:155]
v_mfma_f32_16x16x32_bf16 v[172:175], a[104:107], v[88:91], v[172:175]
v_mfma_f32_16x16x32_bf16 v[192:195], a[104:107], v[92:95], v[192:195]
v_mfma_f32_16x16x32_bf16 v[136:139], a[108:111], v[80:83], v[136:139]
buffer_load_dwordx4 v[72:75], v58, s[24:27], s99 offen
v_mfma_f32_16x16x32_bf16 v[156:159], a[108:111], v[84:87], v[156:159]
v_mfma_f32_16x16x32_bf16 v[176:179], a[108:111], v[88:91], v[176:179]
v_mfma_f32_16x16x32_bf16 v[196:199], a[108:111], v[92:95], v[196:199]
v_mfma_f32_16x16x32_bf16 v[140:143], a[112:115], v[80:83], v[140:143]
buffer_load_dwordx4 v[76:79], v59, s[24:27], s99 offen
v_mfma_f32_16x16x32_bf16 v[160:163], a[112:115], v[84:87], v[160:163]
v_mfma_f32_16x16x32_bf16 v[180:183], a[112:115], v[88:91], v[180:183]
v_mfma_f32_16x16x32_bf16 v[200:203], a[112:115], v[92:95], v[200:203]
v_mfma_f32_16x16x32_bf16 v[144:147], a[116:119], v[80:83], v[144:147]
s_add_u32 s99, s99, 4096
v_mfma_f32_16x16x32_bf16 v[164:167], a[116:119], v[84:87], v[164:167]
v_mfma_f32_16x16x32_bf16 v[184:187], a[116:119], v[88:91], v[184:187]
v_mfma_f32_16x16x32_bf16 v[204:207], a[116:119], v[92:95], v[204:207]
s_waitcnt vmcnt(8)
v_mfma_f32_16x16x32_bf16 v[128:131], a[120:123], v[96:99], v[128:131]
buffer_load_dwordx4 v[80:83], v56, s[24:27], s99 offen
v_mfma_f32_16x16x32_bf16 v[148:151], a[120:123], v[100:103], v[148:151]
v_mfma_f32_16x16x32_bf16 v[168:171], a[120:123], v[104:107], v[168:171]
v_mfma_f32_16x16x32_bf16 v[188:191], a[120:123], v[108:111], v[188:191]
v_mfma_f32_16x16x32_bf16 v[132:135], a[124:127], v[96:99], v[132:135]
buffer_load_dwordx4 v[84:87], v57, s[24:27], s99 offen
v_mfma_f32_16x16x32_bf16 v[152:155], a[124:127], v[100:103], v[152:155]
v_mfma_f32_16x16x32_bf16 v[172:175], a[124:127], v[104:107], v[172:175]
v_mfma_f32_16x16x32_bf16 v[192:195], a[124:127], v[108:111], v[192:195]
v_mfma_f32_16x16x32_bf16 v[136:139], a[128:131], v[96:99], v[136:139]
buffer_load_dwordx4 v[88:91], v58, s[24:27], s99 offen
v_mfma_f32_16x16x32_bf16 v[156:159], a[128:131], v[100:103], v[156:159]
v_mfma_f32_16x16x32_bf16 v[176:179], a[128:131], v[104:107], v[176:179]
v_mfma_f32_16x16x32_bf16 v[196:199], a[128:131], v[108:111], v[196:199]
v_mfma_f32_16x16x32_bf16 v[140:143], a[132:135], v[96:99], v[140:143]
buffer_load_dwordx4 v[92:95], v59, s[24:27], s99 offen
v_mfma_f32_16x16x32_bf16 v[160:163], a[132:135], v[100:103], v[160:163]
v_mfma_f32_16x16x32_bf16 v[180:183], a[132:135], v[104:107], v[180:183]
v_mfma_f32_16x16x32_bf16 v[200:203], a[132:135], v[108:111], v[200:203]
v_mfma_f32_16x16x32_bf16 v[144:147], a[136:139], v[96:99], v[144:147]
s_add_u32 s99, s99, 4096
v_mfma_f32_16x16x32_bf16 v[164:167], a[136:139], v[100:103], v[164:167]
v_mfma_f32_16x16x32_bf16 v[184:187], a[136:139], v[104:107], v[184:187]
v_mfma_f32_16x16x32_bf16 v[204:207], a[136:139], v[108:111], v[204:207]
s_waitcnt vmcnt(8)
v_mfma_f32_16x16x32_bf16 v[128:131], a[140:143], v[112:115], v[128:131]
buffer_load_dwordx4 v[96:99], v56, s[24:27], s99 offen
v_mfma_f32_16x16x32_bf16 v[148:151], a[140:143], v[116:119], v[148:151]
v_mfma_f32_16x16x32_bf16 v[168:171], a[140:143], v[120:123], v[168:171]
v_mfma_f32_16x16x32_bf16 v[188:191], a[140:143], v[124:127], v[188:191]
v_mfma_f32_16x16x32_bf16 v[132:135], a[144:147], v[112:115], v[132:135]
buffer_load_dwordx4 v[100:103], v57, s[24:27], s99 offen
v_mfma_f32_16x16x32_bf16 v[152:155], a[144:147], v[116:119], v[152:155]
v_mfma_f32_16x16x32_bf16 v[172:175], a[144:147], v[120:123], v[172:175]
v_mfma_f32_16x16x32_bf16 v[192:195], a[144:147], v[124:127], v[192:195]
v_mfma_f32_16x16x32_bf16 v[136:139], a[148:151], v[112:115], v[136:139]
buffer_load_dwordx4 v[104:107], v58, s[24:27], s99 offen
v_mfma_f32_16x16x32_bf16 v[156:159], a[148:151], v[116:119], v[156:159]
v_mfma_f32_16x16x32_bf16 v[176:179], a[148:151], v[120:123], v[176:179]
v_mfma_f32_16x16x32_bf16 v[196:199], a[148:151], v[124:127], v[196:199]
v_mfma_f32_16x16x32_bf16 v[140:143], a[152:155], v[112:115], v[140:143]
buffer_load_dwordx4 v[108:111], v59, s[24:27], s99 offen
v_mfma_f32_16x16x32_bf16 v[160:163], a[152:155], v[116:119], v[160:163]
v_mfma_f32_16x16x32_bf16 v[180:183], a[152:155], v[120:123], v[180:183]
v_mfma_f32_16x16x32_bf16 v[200:203], a[152:155], v[124:127], v[200:203]
v_mfma_f32_16x16x32_bf16 v[144:147], a[156:159], v[112:115], v[144:147]
s_add_u32 s99, s99, 4096
v_mfma_f32_16x16x32_bf16 v[164:167], a[156:159], v[116:119], v[164:167]
v_mfma_f32_16x16x32_bf16 v[184:187], a[156:159], v[120:123], v[184:187]
v_mfma_f32_16x16x32_bf16 v[204:207], a[156:159], v[124:127], v[204:207]
s_waitcnt vmcnt(8)
v_mfma_f32_16x16x32_bf16 v[128:131], a[160:163], v[64:67], v[128:131]
buffer_load_dwordx4 v[112:115], v56, s[24:27], s99 offen
v_mfma_f32_16x16x32_bf16 v[148:151], a[160:163], v[68:71], v[148:151]
v_mfma_f32_16x16x32_bf16 v[168:171], a[160:163], v[72:75], v[168:171]
v_mfma_f32_16x16x32_bf16 v[188:191], a[160:163], v[76:79], v[188:191]
v_mfma_f32_16x16x32_bf16 v[132:135], a[164:167], v[64:67], v[132:135]
buffer_load_dwordx4 v[116:119], v57, s[24:27], s99 offen
v_mfma_f32_16x16x32_bf16 v[152:155], a[164:167], v[68:71], v[152:155]
v_mfma_f32_16x16x32_bf16 v[172:175], a[164:167], v[72:75], v[172:175]
v_mfma_f32_16x16x32_bf16 v[192:195], a[164:167], v[76:79], v[192:195]
v_mfma_f32_16x16x32_bf16 v[136:139], a[168:171], v[64:67], v[136:139]
buffer_load_dwordx4 v[120:123], v58, s[24:27], s99 offen
v_mfma_f32_16x16x32_bf16 v[156:159], a[168:171], v[68:71], v[156:159]
v_mfma_f32_16x16x32_bf16 v[176:179], a[168:171], v[72:75], v[176:179]
v_mfma_f32_16x16x32_bf16 v[196:199], a[168:171], v[76:79], v[196:199]
v_mfma_f32_16x16x32_bf16 v[140:143], a[172:175], v[64:67], v[140:143]
buffer_load_dwordx4 v[124:127], v59, s[24:27], s99 offen
v_mfma_f32_16x16x32_bf16 v[160:163], a[172:175], v[68:71], v[160:163]
v_mfma_f32_16x16x32_bf16 v[180:183], a[172:175], v[72:75], v[180:183]
v_mfma_f32_16x16x32_bf16 v[200:203], a[172:175], v[76:79], v[200:203]
v_mfma_f32_16x16x32_bf16 v[144:147], a[176:179], v[64:67], v[144:147]
s_add_u32 s99, s99, 4096
v_mfma_f32_16x16x32_bf16 v[164:167], a[176:179], v[68:71], v[164:167]
v_mfma_f32_16x16x32_bf16 v[184:187], a[176:179], v[72:75], v[184:187]
v_mfma_f32_16x16x32_bf16 v[204:207], a[176:179], v[76:79], v[204:207]
s_waitcnt vmcnt(8)
v_mfma_f32_16x16x32_bf16 v[128:131], a[180:183], v[80:83], v[128:131]
buffer_load_dwordx4 v[64:67], v56, s[24:27], s99 offen
v_mfma_f32_16x16x32_bf16 v[148:151], a[180:183], v[84:87], v[148:151]
v_mfma_f32_16x16x32_bf16 v[168:171], a[180:183], v[88:91], v[168:171]
v_mfma_f32_16x16x32_bf16 v[188:191], a[180:183], v[92:95], v[188:191]
v_mfma_f32_16x16x32_bf16 v[132:135], a[184:187], v[80:83], v[132:135]
buffer_load_dwordx4 v[68:71], v57, s[24:27], s99 offen
v_mfma_f32_16x16x32_bf16 v[152:155], a[184:187], v[84:87], v[152:155]
v_mfma_f32_16x16x32_bf16 v[172:175], a[184:187], v[88:91], v[172:175]
v_mfma_f32_16x16x32_bf16 v[192:195], a[184:187], v[92:95], v[192:195]
v_mfma_f32_16x16x32_bf16 v[136:139], a[188:191], v[80:83], v[136:139]
buffer_load_dwordx4 v[72:75], v58, s[24:27], s99 offen
v_mfma_f32_16x16x32_bf16 v[156:159], a[188:191], v[84:87], v[156:159]
v_mfma_f32_16x16x32_bf16 v[176:179], a[188:191], v[88:91], v[176:179]
v_mfma_f32_16x16x32_bf16 v[196:199], a[188:191], v[92:95], v[196:199]
v_mfma_f32_16x16x32_bf16 v[140:143], a[192:195], v[80:83], v[140:143]
buffer_load_dwordx4 v[76:79], v59, s[24:27], s99 offen
v_mfma_f32_16x16x32_bf16 v[160:163], a[192:195], v[84:87], v[160:163]
v_mfma_f32_16x16x32_bf16 v[180:183], a[192:195], v[88:91], v[180:183]
v_mfma_f32_16x16x32_bf16 v[200:203], a[192:195], v[92:95], v[200:203]
v_mfma_f32_16x16x32_bf16 v[144:147], a[196:199], v[80:83], v[144:147]
s_add_u32 s99, s99, 4096
v_mfma_f32_16x16x32_bf16 v[164:167], a[196:199], v[84:87], v[164:167]
v_mfma_f32_16x16x32_bf16 v[184:187], a[196:199], v[88:91], v[184:187]
v_mfma_f32_16x16x32_bf16 v[204:207], a[196:199], v[92:95], v[204:207]
s_waitcnt vmcnt(8)
v_mfma_f32_16x16x32_bf16 v[128:131], a[200:203], v[96:99], v[128:131]
buffer_load_dwordx4 v[80:83], v56, s[24:27], s99 offen
v_mfma_f32_16x16x32_bf16 v[148:151], a[200:203], v[100:103], v[148:151]
v_mfma_f32_16x16x32_bf16 v[168:171], a[200:203], v[104:107], v[168:171]
v_mfma_f32_16x16x32_bf16 v[188:191], a[200:203], v[108:111], v[188:191]
v_mfma_f32_16x16x32_bf16 v[132:135], a[204:207], v[96:99], v[132:135]
buffer_load_dwordx4 v[84:87], v57, s[24:27], s99 offen
v_mfma_f32_16x16x32_bf16 v[152:155], a[204:207], v[100:103], v[152:155]
v_mfma_f32_16x16x32_bf16 v[172:175], a[204:207], v[104:107], v[172:175]
v_mfma_f32_16x16x32_bf16 v[192:195], a[204:207], v[108:111], v[192:195]
v_mfma_f32_16x16x32_bf16 v[136:139], a[208:211], v[96:99], v[136:139]
buffer_load_dwordx4 v[88:91], v58, s[24:27], s99 offen
v_mfma_f32_16x16x32_bf16 v[156:159], a[208:211], v[100:103], v[156:159]
v_mfma_f32_16x16x32_bf16 v[176:179], a[208:211], v[104:107], v[176:179]
v_mfma_f32_16x16x32_bf16 v[196:199], a[208:211], v[108:111], v[196:199]
v_mfma_f32_16x16x32_bf16 v[140:143], a[212:215], v[96:99], v[140:143]
buffer_load_dwordx4 v[92:95], v59, s[24:27], s99 offen
v_mfma_f32_16x16x32_bf16 v[160:163], a[212:215], v[100:103], v[160:163]
v_mfma_f32_16x16x32_bf16 v[180:183], a[212:215], v[104:107], v[180:183]
v_mfma_f32_16x16x32_bf16 v[200:203], a[212:215], v[108:111], v[200:203]
v_mfma_f32_16x16x32_bf16 v[144:147], a[216:219], v[96:99], v[144:147]
s_add_u32 s99, s99, 4096
v_mfma_f32_16x16x32_bf16 v[164:167], a[216:219], v[100:103], v[164:167]
v_mfma_f32_16x16x32_bf16 v[184:187], a[216:219], v[104:107], v[184:187]
v_mfma_f32_16x16x32_bf16 v[204:207], a[216:219], v[108:111], v[204:207]
s_waitcnt vmcnt(8)
v_mfma_f32_16x16x32_bf16 v[128:131], a[220:223], v[112:115], v[128:131]
v_mfma_f32_16x16x32_bf16 v[148:151], a[220:223], v[116:119], v[148:151]
v_mfma_f32_16x16x32_bf16 v[168:171], a[220:223], v[120:123], v[168:171]
v_mfma_f32_16x16x32_bf16 v[188:191], a[220:223], v[124:127], v[188:191]
v_mfma_f32_16x16x32_bf16 v[132:135], a[224:227], v[112:115], v[132:135]
v_mfma_f32_16x16x32_bf16 v[152:155], a[224:227], v[116:119], v[152:155]
v_mfma_f32_16x16x32_bf16 v[172:175], a[224:227], v[120:123], v[172:175]
v_mfma_f32_16x16x32_bf16 v[192:195], a[224:227], v[124:127], v[192:195]
v_mfma_f32_16x16x32_bf16 v[136:139], a[228:231], v[112:115], v[136:139]
v_mfma_f32_16x16x32_bf16 v[156:159], a[228:231], v[116:119], v[156:159]
v_mfma_f32_16x16x32_bf16 v[176:179], a[228:231], v[120:123], v[176:179]
v_mfma_f32_16x16x32_bf16 v[196:199], a[228:231], v[124:127], v[196:199]
v_mfma_f32_16x16x32_bf16 v[140:143], a[232:235], v[112:115], v[140:143]
v_mfma_f32_16x16x32_bf16 v[160:163], a[232:235], v[116:119], v[160:163]
v_mfma_f32_16x16x32_bf16 v[180:183], a[232:235], v[120:123], v[180:183]
v_mfma_f32_16x16x32_bf16 v[200:203], a[232:235], v[124:127], v[200:203]
v_mfma_f32_16x16x32_bf16 v[144:147], a[236:239], v[112:115], v[144:147]
v_mfma_f32_16x16x32_bf16 v[164:167], a[236:239], v[116:119], v[164:167]
v_mfma_f32_16x16x32_bf16 v[184:187], a[236:239], v[120:123], v[184:187]
v_mfma_f32_16x16x32_bf16 v[204:207], a[236:239], v[124:127], v[204:207]
s_waitcnt vmcnt(4)
v_mfma_f32_16x16x32_bf16 v[128:131], v[208:211], v[64:67], v[128:131]
v_mfma_f32_16x16x32_bf16 v[148:151], v[208:211], v[68:71], v[148:151]
v_mfma_f32_16x16x32_bf16 v[168:171], v[208:211], v[72:75], v[168:171]
v_mfma_f32_16x16x32_bf16 v[188:191], v[208:211], v[76:79], v[188:191]
v_mfma_f32_16x16x32_bf16 v[132:135], v[212:215], v[64:67], v[132:135]
v_mfma_f32_16x16x32_bf16 v[152:155], v[212:215], v[68:71], v[152:155]
v_mfma_f32_16x16x32_bf16 v[172:175], v[212:215], v[72:75], v[172:175]
v_mfma_f32_16x16x32_bf16 v[192:195], v[212:215], v[76:79], v[192:195]
v_mfma_f32_16x16x32_bf16 v[136:139], v[216:219], v[64:67], v[136:139]
v_mfma_f32_16x16x32_bf16 v[156:159], v[216:219], v[68:71], v[156:159]
v_mfma_f32_16x16x32_bf16 v[176:179], v[216:219], v[72:75], v[176:179]
v_mfma_f32_16x16x32_bf16 v[196:199], v[216:219], v[76:79], v[196:199]
v_mfma_f32_16x16x32_bf16 v[140:143], v[220:223], v[64:67], v[140:143]
v_mfma_f32_16x16x32_bf16 v[160:163], v[220:223], v[68:71], v[160:163]
v_mfma_f32_16x16x32_bf16 v[180:183], v[220:223], v[72:75], v[180:183]
v_mfma_f32_16x16x32_bf16 v[200:203], v[220:223], v[76:79], v[200:203]
v_mfma_f32_16x16x32_bf16 v[144:147], v[224:227], v[64:67], v[144:147]
v_mfma_f32_16x16x32_bf16 v[164:167], v[224:227], v[68:71], v[164:167]
v_mfma_f32_16x16x32_bf16 v[184:187], v[224:227], v[72:75], v[184:187]
v_mfma_f32_16x16x32_bf16 v[204:207], v[224:227], v[76:79], v[204:207]
s_cmp_ge_u32 s5, 2
s_cbranch_scc1 L_g2skip_11
s_waitcnt vmcnt(0)
v_mfma_f32_16x16x32_bf16 v[128:131], v[228:231], v[80:83], v[128:131]
v_mfma_f32_16x16x32_bf16 v[148:151], v[228:231], v[84:87], v[148:151]
v_mfma_f32_16x16x32_bf16 v[168:171], v[228:231], v[88:91], v[168:171]
v_mfma_f32_16x16x32_bf16 v[188:191], v[228:231], v[92:95], v[188:191]
v_mfma_f32_16x16x32_bf16 v[132:135], v[232:235], v[80:83], v[132:135]
v_mfma_f32_16x16x32_bf16 v[152:155], v[232:235], v[84:87], v[152:155]
v_mfma_f32_16x16x32_bf16 v[172:175], v[232:235], v[88:91], v[172:175]
v_mfma_f32_16x16x32_bf16 v[192:195], v[232:235], v[92:95], v[192:195]
v_mfma_f32_16x16x32_bf16 v[136:139], v[236:239], v[80:83], v[136:139]
v_mfma_f32_16x16x32_bf16 v[156:159], v[236:239], v[84:87], v[156:159]
v_mfma_f32_16x16x32_bf16 v[176:179], v[236:239], v[88:91], v[176:179]
v_mfma_f32_16x16x32_bf16 v[196:199], v[236:239], v[92:95], v[196:199]
v_mfma_f32_16x16x32_bf16 v[140:143], v[240:243], v[80:83], v[140:143]
v_mfma_f32_16x16x32_bf16 v[160:163], v[240:243], v[84:87], v[160:163]
v_mfma_f32_16x16x32_bf16 v[180:183], v[240:243], v[88:91], v[180:183]
v_mfma_f32_16x16x32_bf16 v[200:203], v[240:243], v[92:95], v[200:203]
v_mfma_f32_16x16x32_bf16 v[144:147], v[244:247], v[80:83], v[144:147]
v_mfma_f32_16x16x32_bf16 v[164:167], v[244:247], v[84:87], v[164:167]
v_mfma_f32_16x16x32_bf16 v[184:187], v[244:247], v[88:91], v[184:187]
v_mfma_f32_16x16x32_bf16 v[204:207], v[244:247], v[92:95], v[204:207]
L_g2skip_11:
v_lshlrev_b32 v2, 4, v1
s_mul_i32 s6, s5, 15360
s_add_u32 s6, s6, 0
v_add_u32 v62, s6, v2
s_add_u32 s6, s5, 1
s_and_b32 s6, s6, 3
s_mul_i32 s6, s6, 15360
s_add_u32 s6, s6, 0
v_add_u32 v57, s6, v2
s_add_u32 s6, s5, 2
s_and_b32 s6, s6, 3
s_mul_i32 s6, s6, 15360
s_add_u32 s6, s6, 5120
v_add_u32 v58, s6, v2
s_add_u32 s6, s5, 3
s_and_b32 s6, s6, 3
s_mul_i32 s6, s6, 15360
s_add_u32 s6, s6, 10240
v_add_u32 v59, s6, v2
s_nop 4
ds_write_b128 v57, v[148:151] offset:0
ds_write_b128 v57, v[152:155] offset:1024
ds_write_b128 v57, v[156:159] offset:2048
ds_write_b128 v57, v[160:163] offset:3072
ds_write_b128 v57, v[164:167] offset:4096
ds_write_b128 v58, v[168:171] offset:0
ds_write_b128 v58, v[172:175] offset:1024
ds_write_b128 v58, v[176:179] offset:2048
ds_write_b128 v58, v[180:183] offset:3072
ds_write_b128 v58, v[184:187] offset:4096
ds_write_b128 v59, v[188:191] offset:0
ds_write_b128 v59, v[192:195] offset:1024
ds_write_b128 v59, v[196:199] offset:2048
ds_write_b128 v59, v[200:203] offset:3072
ds_write_b128 v59, v[204:207] offset:4096
v_lshrrev_b32 v3, 4, v1
v_mul_u32_u24 v3, 20, v3
v_bfe_u32 v4, v1, 2, 2
v_add_u32 v3, v3, v4
v_lshlrev_b32 v3, 7, v3
v_and_b32 v4, 3, v1
v_lshl_add_u32 v3, v4, 4, v3
s_and_b32 s6, s5, 1
s_lshl_b32 s6, s6, 6
s_lshr_b32 s7, s5, 1
s_lshl_b32 s7, s7, 3
s_add_u32 s6, s6, s7
s_add_u32 s6, s6, 61440
v_add_u32 v63, s6, v3
s_waitcnt vmcnt(0) lgkmcnt(0)
s_barrier
ds_read_b128 v[64:67], v62 offset:0
ds_read_b128 v[68:71], v62 offset:1024
ds_read_b128 v[72:75], v62 offset:2048
ds_read_b128 v[76:79], v62 offset:3072
ds_read_b128 v[80:83], v62 offset:4096
ds_read_b128 v[84:87], v62 offset:5120
ds_read_b128 v[88:91], v62 offset:6144
ds_read_b128 v[92:95], v62 offset:7168
ds_read_b128 v[96:99], v62 offset:8192
ds_read_b128 v[100:103], v62 offset:9216
ds_read_b128 v[104:107], v62 offset:10240
ds_read_b128 v[108:111], v62 offset:11264
ds_read_b128 v[112:115], v62 offset:12288
ds_read_b128 v[116:119], v62 offset:13312
ds_read_b128 v[120:123], v62 offset:14336
ds_read_b64_tr_b16 v[36:37], v63 offset:0
ds_read_b64_tr_b16 v[38:39], v63 offset:512
ds_read_b64_tr_b16 v[40:41], v63 offset:1024
ds_read_b64_tr_b16 v[42:43], v63 offset:1536
ds_read_b64_tr_b16 v[44:45], v63 offset:2048
v_mul_f32 v46, v32, v33
v_sub_f32 v46, 0, v46
v_mov_b32 v47, v33
v_mov_b32 v48, -1.4426950408889634
v_mov_b32 v49, 1.0
s_waitcnt lgkmcnt(15)
v_pk_add_f32 v[128:129], v[128:129], v[64:65]
v_pk_add_f32 v[130:131], v[130:131], v[66:67]
v_pk_add_f32 v[132:133], v[132:133], v[68:69]
v_pk_add_f32 v[134:135], v[134:135], v[70:71]
v_pk_add_f32 v[136:137], v[136:137], v[72:73]
v_pk_add_f32 v[138:139], v[138:139], v[74:75]
v_pk_add_f32 v[140:141], v[140:141], v[76:77]
v_pk_add_f32 v[142:143], v[142:143], v[78:79]
v_pk_add_f32 v[144:145], v[144:145], v[80:81]
v_pk_add_f32 v[146:147], v[146:147], v[82:83]
s_waitcnt lgkmcnt(10)
v_pk_add_f32 v[128:129], v[128:129], v[84:85]
v_pk_add_f32 v[130:131], v[130:131], v[86:87]
v_pk_add_f32 v[132:133], v[132:133], v[88:89]
v_pk_add_f32 v[134:135], v[134:135], v[90:91]
v_pk_add_f32 v[136:137], v[136:137], v[92:93]
v_pk_add_f32 v[138:139], v[138:139], v[94:95]
v_pk_add_f32 v[140:141], v[140:141], v[96:97]
v_pk_add_f32 v[142:143], v[142:143], v[98:99]
v_pk_add_f32 v[144:145], v[144:145], v[100:101]
v_pk_add_f32 v[146:147], v[146:147], v[102:103]
s_waitcnt lgkmcnt(5)
v_pk_add_f32 v[128:129], v[128:129], v[104:105]
v_pk_add_f32 v[130:131], v[130:131], v[106:107]
v_pk_add_f32 v[132:133], v[132:133], v[108:109]
v_pk_add_f32 v[134:135], v[134:135], v[110:111]
v_pk_add_f32 v[136:137], v[136:137], v[112:113]
v_pk_add_f32 v[138:139], v[138:139], v[114:115]
v_pk_add_f32 v[140:141], v[140:141], v[116:117]
v_pk_add_f32 v[142:143], v[142:143], v[118:119]
v_pk_add_f32 v[144:145], v[144:145], v[120:121]
v_pk_add_f32 v[146:147], v[146:147], v[122:123]
s_waitcnt lgkmcnt(0)
v_lshlrev_b32 v64, 16, v20
v_and_b32 v65, 0xffff0000, v20
v_lshlrev_b32 v66, 16, v21
v_and_b32 v67, 0xffff0000, v21
v_lshlrev_b32 v68, 16, v22
v_and_b32 v69, 0xffff0000, v22
v_lshlrev_b32 v70, 16, v23
v_and_b32 v71, 0xffff0000, v23
v_lshlrev_b32 v72, 16, v24
v_and_b32 v73, 0xffff0000, v24
v_pk_add_f32 v[128:129], v[128:129], v[64:65]
v_pk_add_f32 v[130:131], v[130:131], v[66:67]
v_pk_add_f32 v[132:133], v[132:133], v[68:69]
v_pk_add_f32 v[134:135], v[134:135], v[70:71]
v_pk_add_f32 v[136:137], v[136:137], v[72:73]
v_pk_mul_f32 v[64:65], v[128:129], v[48:49] op_sel_hi:[1,0]
v_pk_mul_f32 v[66:67], v[130:131], v[48:49] op_sel_hi:[1,0]
v_pk_mul_f32 v[68:69], v[132:133], v[48:49] op_sel_hi:[1,0]
v_pk_mul_f32 v[70:71], v[134:135], v[48:49] op_sel_hi:[1,0]
v_pk_mul_f32 v[72:73], v[136:137], v[48:49] op_sel_hi:[1,0]
v_exp_f32 v64, v64
v_exp_f32 v65, v65
v_exp_f32 v66, v66
v_exp_f32 v67, v67
v_exp_f32 v68, v68
v_exp_f32 v69, v69
v_exp_f32 v70, v70
v_exp_f32 v71, v71
v_exp_f32 v72, v72
v_exp_f32 v73, v73
v_lshlrev_b32 v74, 16, v8
v_and_b32 v75, 0xffff0000, v8
v_lshlrev_b32 v76, 16, v9
v_and_b32 v77, 0xffff0000, v9
v_lshlrev_b32 v78, 16, v10
v_and_b32 v79, 0xffff0000, v10
v_lshlrev_b32 v80, 16, v11
v_and_b32 v81, 0xffff0000, v11
v_lshlrev_b32 v82, 16, v12
v_and_b32 v83, 0xffff0000, v12
v_pk_add_f32 v[64:65], v[64:65], v[48:49] op_sel:[0,1] op_sel_hi:[1,1]
v_pk_add_f32 v[66:67], v[66:67], v[48:49] op_sel:[0,1] op_sel_hi:[1,1]
v_pk_add_f32 v[68:69], v[68:69], v[48:49] op_sel:[0,1] op_sel_hi:[1,1]
v_pk_add_f32 v[70:71], v[70:71], v[48:49] op_sel:[0,1] op_sel_hi:[1,1]
v_pk_add_f32 v[72:73], v[72:73], v[48:49] op_sel:[0,1] op_sel_hi:[1,1]
v_rcp_f32 v64, v64
v_rcp_f32 v65, v65
v_rcp_f32 v66, v66
v_rcp_f32 v67, v67
v_rcp_f32 v68, v68
v_rcp_f32 v69, v69
v_rcp_f32 v70, v70
v_rcp_f32 v71, v71
v_rcp_f32 v72, v72
v_rcp_f32 v73, v73
v_lshlrev_b32 v84, 16, v36
v_and_b32 v85, 0xffff0000, v36
v_lshlrev_b32 v86, 16, v37
v_and_b32 v87, 0xffff0000, v37
v_lshlrev_b32 v88, 16, v38
v_and_b32 v89, 0xffff0000, v38
v_lshlrev_b32 v90, 16, v39
v_and_b32 v91, 0xffff0000, v39
v_lshlrev_b32 v92, 16, v40
v_and_b32 v93, 0xffff0000, v40
v_pk_mul_f32 v[64:65], v[64:65], v[128:129]
v_pk_mul_f32 v[66:67], v[66:67], v[130:131]
v_pk_mul_f32 v[68:69], v[68:69], v[132:133]
v_pk_mul_f32 v[70:71], v[70:71], v[134:135]
v_pk_mul_f32 v[72:73], v[72:73], v[136:137]
v_pk_fma_f32 v[128:129], v[74:75], v[46:47], v[46:47] op_sel:[0,1,0] op_sel_hi:[1,1,0]
v_pk_fma_f32 v[130:131], v[76:77], v[46:47], v[46:47] op_sel:[0,1,0] op_sel_hi:[1,1,0]
v_pk_fma_f32 v[132:133], v[78:79], v[46:47], v[46:47] op_sel:[0,1,0] op_sel_hi:[1,1,0]
v_pk_fma_f32 v[134:135], v[80:81], v[46:47], v[46:47] op_sel:[0,1,0] op_sel_hi:[1,1,0]
v_pk_fma_f32 v[136:137], v[82:83], v[46:47], v[46:47] op_sel:[0,1,0] op_sel_hi:[1,1,0]
v_pk_mul_f32 v[128:129], v[128:129], v[84:85]
v_pk_mul_f32 v[130:131], v[130:131], v[86:87]
v_pk_mul_f32 v[132:133], v[132:133], v[88:89]
v_pk_mul_f32 v[134:135], v[134:135], v[90:91]
v_pk_mul_f32 v[136:137], v[136:137], v[92:93]
v_pk_fma_f32 v[128:129], v[128:129], v[64:65], v[74:75]
v_pk_fma_f32 v[130:131], v[130:131], v[66:67], v[76:77]
v_pk_fma_f32 v[132:133], v[132:133], v[68:69], v[78:79]
v_pk_fma_f32 v[134:135], v[134:135], v[70:71], v[80:81]
v_pk_fma_f32 v[136:137], v[136:137], v[72:73], v[82:83]
v_cvt_pk_bf16_f32 v100, v128, v129
v_cvt_pk_bf16_f32 v101, v130, v131
v_cvt_pk_bf16_f32 v102, v132, v133
v_cvt_pk_bf16_f32 v103, v134, v135
v_cvt_pk_bf16_f32 v104, v136, v137
v_lshlrev_b32 v64, 16, v25
v_and_b32 v65, 0xffff0000, v25
v_lshlrev_b32 v66, 16, v26
v_and_b32 v67, 0xffff0000, v26
v_lshlrev_b32 v68, 16, v27
v_and_b32 v69, 0xffff0000, v27
v_lshlrev_b32 v70, 16, v28
v_and_b32 v71, 0xffff0000, v28
v_lshlrev_b32 v72, 16, v29
v_and_b32 v73, 0xffff0000, v29
v_pk_add_f32 v[138:139], v[138:139], v[64:65]
v_pk_add_f32 v[140:141], v[140:141], v[66:67]
v_pk_add_f32 v[142:143], v[142:143], v[68:69]
v_pk_add_f32 v[144:145], v[144:145], v[70:71]
v_pk_add_f32 v[146:147], v[146:147], v[72:73]
v_pk_mul_f32 v[64:65], v[138:139], v[48:49] op_sel_hi:[1,0]
v_pk_mul_f32 v[66:67], v[140:141], v[48:49] op_sel_hi:[1,0]
v_pk_mul_f32 v[68:69], v[142:143], v[48:49] op_sel_hi:[1,0]
v_pk_mul_f32 v[70:71], v[144:145], v[48:49] op_sel_hi:[1,0]
v_pk_mul_f32 v[72:73], v[146:147], v[48:49] op_sel_hi:[1,0]
v_exp_f32 v64, v64
v_exp_f32 v65, v65
v_exp_f32 v66, v66
v_exp_f32 v67, v67
v_exp_f32 v68, v68
v_exp_f32 v69, v69
v_exp_f32 v70, v70
v_exp_f32 v71, v71
v_exp_f32 v72, v72
v_exp_f32 v73, v73
v_lshlrev_b32 v74, 16, v13
v_and_b32 v75, 0xffff0000, v13
v_lshlrev_b32 v76, 16, v14
v_and_b32 v77, 0xffff0000, v14
v_lshlrev_b32 v78, 16, v15
v_and_b32 v79, 0xffff0000, v15
v_lshlrev_b32 v80, 16, v16
v_and_b32 v81, 0xffff0000, v16
v_lshlrev_b32 v82, 16, v17
v_and_b32 v83, 0xffff0000, v17
v_pk_add_f32 v[64:65], v[64:65], v[48:49] op_sel:[0,1] op_sel_hi:[1,1]
v_pk_add_f32 v[66:67], v[66:67], v[48:49] op_sel:[0,1] op_sel_hi:[1,1]
v_pk_add_f32 v[68:69], v[68:69], v[48:49] op_sel:[0,1] op_sel_hi:[1,1]
v_pk_add_f32 v[70:71], v[70:71], v[48:49] op_sel:[0,1] op_sel_hi:[1,1]
v_pk_add_f32 v[72:73], v[72:73], v[48:49] op_sel:[0,1] op_sel_hi:[1,1]
v_rcp_f32 v64, v64
v_rcp_f32 v65, v65
v_rcp_f32 v66, v66
v_rcp_f32 v67, v67
v_rcp_f32 v68, v68
v_rcp_f32 v69, v69
v_rcp_f32 v70, v70
v_rcp_f32 v71, v71
v_rcp_f32 v72, v72
v_rcp_f32 v73, v73
v_lshlrev_b32 v84, 16, v41
v_and_b32 v85, 0xffff0000, v41
v_lshlrev_b32 v86, 16, v42
v_and_b32 v87, 0xffff0000, v42
v_lshlrev_b32 v88, 16, v43
v_and_b32 v89, 0xffff0000, v43
v_lshlrev_b32 v90, 16, v44
v_and_b32 v91, 0xffff0000, v44
v_lshlrev_b32 v92, 16, v45
v_and_b32 v93, 0xffff0000, v45
v_pk_mul_f32 v[64:65], v[64:65], v[138:139]
v_pk_mul_f32 v[66:67], v[66:67], v[140:141]
v_pk_mul_f32 v[68:69], v[68:69], v[142:143]
v_pk_mul_f32 v[70:71], v[70:71], v[144:145]
v_pk_mul_f32 v[72:73], v[72:73], v[146:147]
v_pk_fma_f32 v[138:139], v[74:75], v[46:47], v[46:47] op_sel:[0,1,0] op_sel_hi:[1,1,0]
v_pk_fma_f32 v[140:141], v[76:77], v[46:47], v[46:47] op_sel:[0,1,0] op_sel_hi:[1,1,0]
v_pk_fma_f32 v[142:143], v[78:79], v[46:47], v[46:47] op_sel:[0,1,0] op_sel_hi:[1,1,0]
v_pk_fma_f32 v[144:145], v[80:81], v[46:47], v[46:47] op_sel:[0,1,0] op_sel_hi:[1,1,0]
v_pk_fma_f32 v[146:147], v[82:83], v[46:47], v[46:47] op_sel:[0,1,0] op_sel_hi:[1,1,0]
v_pk_mul_f32 v[138:139], v[138:139], v[84:85]
v_pk_mul_f32 v[140:141], v[140:141], v[86:87]
v_pk_mul_f32 v[142:143], v[142:143], v[88:89]
v_pk_mul_f32 v[144:145], v[144:145], v[90:91]
v_pk_mul_f32 v[146:147], v[146:147], v[92:93]
v_pk_fma_f32 v[138:139], v[138:139], v[64:65], v[74:75]
v_pk_fma_f32 v[140:141], v[140:141], v[66:67], v[76:77]
v_pk_fma_f32 v[142:143], v[142:143], v[68:69], v[78:79]
v_pk_fma_f32 v[144:145], v[144:145], v[70:71], v[80:81]
v_pk_fma_f32 v[146:147], v[146:147], v[72:73], v[82:83]
v_cvt_pk_bf16_f32 v105, v138, v139
v_cvt_pk_bf16_f32 v106, v140, v141
v_cvt_pk_bf16_f32 v107, v142, v143
v_cvt_pk_bf16_f32 v108, v144, v145
v_cvt_pk_bf16_f32 v109, v146, v147
buffer_store_dwordx4 v[100:103], v60, s[28:31], 0 offen
buffer_store_dwordx4 v[104:107], v60, s[28:31], 0 offen offset:16
buffer_store_dwordx2 v[108:109], v60, s[28:31], 0 offen offset:32
L_end_9:
s_endpgm
.section .rodata,"a"
.p2align 6
.amdhsa_kernel k0_kernel
  .amdhsa_next_free_vgpr 512
  .amdhsa_next_free_sgpr 102
  .amdhsa_accum_offset 256
  .amdhsa_group_segment_fixed_size 0
  .amdhsa_kernarg_size 112
  .amdhsa_user_sgpr_count 2
  .amdhsa_user_sgpr_kernarg_segment_ptr 1
  .amdhsa_system_sgpr_workgroup_id_x 1
.end_amdhsa_kernel
.p2align 6
.amdhsa_kernel k1_kernel
  .amdhsa_next_free_vgpr 512
  .amdhsa_next_free_sgpr 102
  .amdhsa_accum_offset 256
  .amdhsa_group_segment_fixed_size 0
  .amdhsa_kernarg_size 112
  .amdhsa_user_sgpr_count 2
  .amdhsa_user_sgpr_kernarg_segment_ptr 1
  .amdhsa_system_sgpr_workgroup_id_x 1
.end_amdhsa_kernel
.p2align 6
.amdhsa_kernel k2_kernel
  .amdhsa_next_free_vgpr 512
  .amdhsa_next_free_sgpr 102
  .amdhsa_accum_offset 256
  .amdhsa_group_segment_fixed_size 0
  .amdhsa_kernarg_size 112
  .amdhsa_user_sgpr_count 2
  .amdhsa_user_sgpr_kernarg_segment_ptr 1
  .amdhsa_system_sgpr_workgroup_id_x 1
.end_amdhsa_kernel
.p2align 6
.amdhsa_kernel k3_kernel
  .amdhsa_next_free_vgpr 512
  .amdhsa_next_free_sgpr 102
  .amdhsa_accum_offset 256
  .amdhsa_group_segment_fixed_size 0
  .amdhsa_kernarg_size 112
  .amdhsa_user_sgpr_count 2
  .amdhsa_user_sgpr_kernarg_segment_ptr 1
  .amdhsa_system_sgpr_workgroup_id_x 1
.end_amdhsa_kernel
```

```asm
; @launch grid=(256,1,1) block=(256,1,1) lds=163840
.amdgcn_target "amdgcn-amd-amdhsa--gfx950"
.text
.globl recurrent_scan__ssm_conv_h3__dense_activation_gelu__prompt_kernel
.p2align 8
.type recurrent_scan__ssm_conv_h3__dense_activation_gelu__prompt_kernel,@function
recurrent_scan__ssm_conv_h3__dense_activation_gelu__prompt_kernel:
s_cmp_ge_u32 s2, 256
s_cbranch_scc1 L_end
s_load_dwordx16 s[40:55], s[0:1], 0
s_load_dwordx8 s[56:63], s[0:1], 64
s_load_dwordx4 s[64:67], s[0:1], 96
s_and_b32 s3, s2, 7
s_lshr_b32 s4, s2, 3
v_lshrrev_b32 v1, 6, v0
v_and_b32 v0, 0xff, v0
v_mov_b32 v253, 1
v_readfirstlane_b32 s5, v1
v_and_b32 v1, 63, v0
s_lshl_b32 s6, s2, 7
v_mov_b32 v252, s6
v_lshlrev_b32 v248, 4, v1
v_and_b32 v230, 7, v1
v_lshlrev_b32 v230, 5, v230
v_mov_b32 v255, 0
s_waitcnt lgkmcnt(0)
s_mov_b32 s24, s66
s_and_b32 s25, s67, 0xffff
s_mov_b32 s26, 17825792
s_mov_b32 s27, 0x20000
s_cmp_lg_u32 s5, 0
s_cbranch_scc1 L_clr_1
v_lshl_add_u32 v2, v1, 2, v252
v_mov_b32 v3, 0
s_mov_b64 exec, 0xff
buffer_store_dword v3, v2, s[24:27], 0 offen sc1
s_mov_b64 exec, -1
L_clr_1:
s_mov_b32 s12, s42
s_and_b32 s13, s43, 0xffff
s_mov_b32 s14, 2621440
s_mov_b32 s15, 0x20000
s_mov_b32 s16, s44
s_and_b32 s17, s45, 0xffff
s_mov_b32 s18, 2621440
s_mov_b32 s19, 0x20000
s_mov_b32 s8, s40
s_and_b32 s9, s41, 0xffff
s_mov_b32 s10, 2621440
s_mov_b32 s11, 0x20000
s_mov_b32 s20, s54
s_and_b32 s21, s55, 0xffff
s_mov_b32 s22, 2211840
s_mov_b32 s23, 0x20000
s_mov_b32 s28, s62
s_and_b32 s29, s63, 0xffff
s_mov_b32 s30, 2621440
s_mov_b32 s31, 0x20000
s_mov_b32 s52, s64
s_and_b32 s53, s65, 0xffff
s_mov_b32 s54, 256
s_mov_b32 s55, 0x20000
s_mov_b32 s42, 0
s_cmp_ge_u32 s4, 28
s_cbranch_scc1 L_spare
s_mov_b32 s32, s46
s_and_b32 s33, s47, 0xffff
s_mov_b32 s34, 5120
s_mov_b32 s35, 0x20000
s_lshr_b32 s6, s4, 3
s_lshl_b32 s7, s3, 2
s_add_u32 s68, s6, s7
s_and_b32 s69, s4, 7
v_mul_u32_u24 v2, 26, v1
v_lshrrev_b32 v2, 8, v2
v_mul_u32_u24 v3, 10, v2
v_sub_u32 v3, v1, v3
s_lshl_b32 s6, s68, 6
s_lshl_b32 s7, s5, 4
s_add_u32 s6, s6, s7
s_mul_i32 s6, s6, 1280
s_mul_i32 s7, s69, 160
s_add_u32 s6, s6, s7
v_mul_u32_u24 v4, 5120, v2
v_lshl_add_u32 v4, v3, 4, v4
v_add_u32 v4, s6, v4
v_subrev_u32 v5, 3840, v4
s_mul_i32 s7, s69, 640
v_lshlrev_b32 v6, 6, v3
v_add_u32 v6, s7, v6
s_mov_b32 exec_hi, 0xff
buffer_load_dwordx4 v[8:11], v5, s[12:15], 0 offen offset:0
buffer_load_dwordx4 v[12:15], v5, s[12:15], 0 offen offset:1280
buffer_load_dwordx4 v[16:19], v5, s[12:15], 0 offen offset:2560
buffer_load_dwordx4 v[20:23], v4, s[12:15], 0 offen offset:0
buffer_load_dwordx4 v[24:27], v4, s[12:15], 0 offen offset:1280
buffer_load_dwordx4 v[28:31], v4, s[12:15], 0 offen offset:2560
buffer_load_dwordx4 v[32:35], v4, s[12:15], 0 offen offset:3840
buffer_load_dwordx4 v[52:55], v6, s[32:35], 0 offen offset:0
buffer_load_dwordx4 v[56:59], v6, s[32:35], 0 offen offset:16
buffer_load_dwordx4 v[60:63], v6, s[32:35], 0 offen offset:32
buffer_load_dwordx4 v[64:67], v6, s[32:35], 0 offen offset:48
buffer_load_dwordx4 v[36:39], v4, s[16:19], 0 offen offset:0
buffer_load_dwordx4 v[40:43], v4, s[16:19], 0 offen offset:1280
buffer_load_dwordx4 v[44:47], v4, s[16:19], 0 offen offset:2560
buffer_load_dwordx4 v[48:51], v4, s[16:19], 0 offen offset:3840
s_lshl_b32 s7, s5, 5
s_sub_u32 s7, 131192, s7
v_mul_u32_u24 v7, 1152, v3
v_lshlrev_b32 v2, 3, v2
v_sub_u32 v7, v7, v2
v_add_u32 v7, s7, v7
s_mov_b64 exec, -1
s_mov_b32 s36, s58
s_and_b32 s37, s59, 0xffff
s_mov_b32 s38, 2211840
s_mov_b32 s39, 0x20000
s_lshr_b32 s6, s2, 2
s_lshl_b32 s6, s6, 5
s_lshl_b32 s7, s5, 3
s_add_u32 s6, s6, s7
s_mul_i32 s6, s6, 1280
s_and_b32 s7, s2, 3
s_mul_i32 s7, s7, 320
s_add_u32 s6, s6, s7
s_cmp_lt_u32 s2, 216
s_cselect_b32 s6, s6, 2147418112
v_add_u32 v2, 0, v1
v_mul_u32_u24 v3, 205, v2
v_lshrrev_b32 v3, 12, v3
v_mul_u32_u24 v4, 20, v3
v_sub_u32 v2, v2, v4
v_mul_u32_u24 v3, 1280, v3
v_lshl_add_u32 v2, v2, 4, v3
v_add_u32 v2, s6, v2
v_subrev_u32 v204, 0, v2
v_add_u32 v2, 64, v1
v_mul_u32_u24 v3, 205, v2
v_lshrrev_b32 v3, 12, v3
v_mul_u32_u24 v4, 20, v3
v_sub_u32 v2, v2, v4
v_mul_u32_u24 v3, 1280, v3
v_lshl_add_u32 v2, v2, 4, v3
v_add_u32 v2, s6, v2
v_subrev_u32 v205, 1024, v2
v_add_u32 v2, 128, v1
v_mul_u32_u24 v3, 205, v2
v_lshrrev_b32 v3, 12, v3
v_mul_u32_u24 v4, 20, v3
v_sub_u32 v2, v2, v4
v_mul_u32_u24 v3, 1280, v3
v_lshl_add_u32 v2, v2, 4, v3
v_add_u32 v2, s6, v2
v_subrev_u32 v206, 2048, v2
s_mul_i32 s6, s5, 2560
s_add_u32 m0, s6, 142592
s_nop 0
buffer_load_dwordx4 v204, s[36:39], 0 offen lds
buffer_load_dwordx4 v205, s[36:39], 0 offen offset:1024 lds
s_mov_b32 exec_hi, 0
buffer_load_dwordx4 v206, s[36:39], 0 offen offset:2048 lds
s_mov_b64 exec, -1
s_lshr_b32 s6, s3, 1
s_lshl_b32 s6, s6, 2
s_and_b32 s7, s4, 3
s_add_u32 s77, s6, s7
s_and_b32 s6, s3, 1
s_mul_i32 s6, s6, 7
s_lshr_b32 s7, s4, 2
s_add_u32 s78, s6, s7
s_and_b32 s82, s5, 1
s_lshr_b32 s83, s5, 1
s_lshl_b32 s6, s3, 4
s_lshr_b32 s7, s4, 1
s_add_u32 s6, s6, s7
s_mul_i32 s6, s6, 5
s_and_b32 s89, s4, 1
s_lshl_b32 s7, s89, 1
s_add_u32 s88, s6, s7
s_lshr_b32 s6, s3, 1
s_lshl_b32 s6, s6, 3
s_and_b32 s7, s4, 7
s_add_u32 s94, s6, s7
s_and_b32 s6, s3, 1
s_lshl_b32 s6, s6, 2
s_lshr_b32 s7, s4, 3
s_add_u32 s95, s6, s7
s_mul_i32 s96, s5, 14
s_cmp_eq_u32 s5, 3
s_cselect_b32 s6, 1, 0
s_sub_u32 s96, s96, s6
s_lshl_b32 s79, s78, 8
s_mul_i32 s80, s77, 163840
s_lshl_b32 s81, s5, 12
v_lshrrev_b32 v2, 4, v1
v_and_b32 v3, 15, v1
v_lshlrev_b32 v4, 2, v2
v_xor_b32 v4, v3, v4
s_lshl_b32 s6, s5, 4
v_add_u32 v5, s6, v2
v_mul_u32_u24 v5, 3456, v5
v_lshl_add_u32 v208, v4, 4, v5
s_cmp_eq_u32 s78, 13
s_cselect_b32 s7, 8, 16
v_cmp_le_u32 vcc, s7, v4
v_mov_b32 v6, 2147418112
v_cndmask_b32 v208, v208, v6, vcc
v_add_u32 v209, 12800, v208
v_add_u32 v210, 25600, v208
v_add_u32 v211, 38400, v208
v_lshrrev_b32 v4, 3, v1
v_and_b32 v5, 7, v1
s_lshl_b32 s6, s5, 5
v_add_u32 v4, s6, v4
v_mul_u32_u24 v4, 1280, v4
v_add_u32 v6, 0, v2
v_xor_b32 v6, v5, v6
v_lshl_add_u32 v6, v6, 4, v4
v_add_u32 v212, 0, v6
v_add_u32 v6, 4, v2
v_xor_b32 v6, v5, v6
v_lshl_add_u32 v6, v6, 4, v4
v_add_u32 v213, 9216, v6
v_add_u32 v6, 0, v2
v_xor_b32 v6, v5, v6
v_lshl_add_u32 v6, v6, 4, v4
v_add_u32 v214, 18432, v6
v_add_u32 v6, 4, v2
v_xor_b32 v6, v5, v6
v_lshl_add_u32 v6, v6, 4, v4
v_add_u32 v215, 27648, v6
s_add_u32 m0, s81, 0
s_nop 0
buffer_load_dwordx4 v208, s[20:23], s79 offen offset:0 lds
buffer_load_dwordx4 v209, s[20:23], s79 offen offset:1024 lds
buffer_load_dwordx4 v210, s[20:23], s79 offen offset:2048 lds
buffer_load_dwordx4 v211, s[20:23], s79 offen offset:3072 lds
s_add_u32 m0, s81, 16384
s_nop 0
buffer_load_dwordx4 v212, s[8:11], s80 offen offset:0 lds
buffer_load_dwordx4 v213, s[8:11], s80 offen offset:1024 lds
buffer_load_dwordx4 v214, s[8:11], s80 offen offset:2048 lds
buffer_load_dwordx4 v215, s[8:11], s80 offen offset:3072 lds
v_lshrrev_b32 v2, 4, v1
v_bfe_u32 v4, v1, 2, 2
v_and_b32 v5, 3, v1
v_lshrrev_b32 v6, 5, v1
v_lshl_add_u32 v6, v6, 3, v4
v_lshlrev_b32 v6, 8, v6
s_lshl_b32 s6, s82, 1
v_xor_b32 v4, s6, v4
v_lshlrev_b32 v4, 2, v4
v_and_b32 v3, 1, v2
v_lshl_or_b32 v4, v3, 1, v4
v_lshrrev_b32 v3, 1, v5
v_or_b32 v4, v4, v3
v_lshl_add_u32 v6, v4, 4, v6
v_and_b32 v5, 1, v5
v_lshl_add_u32 v216, v5, 3, v6
v_xor_b32 v217, 64, v216
v_add_u32 v218, 0x10000, v216
v_add_u32 v219, 0x10000, v217
v_and_b32 v4, 31, v1
v_bfe_u32 v5, v1, 1, 3
v_lshrrev_b32 v6, 5, v1
v_xor_b32 v5, v5, v6
s_lshl_b32 s6, s83, 6
v_add_u32 v4, s6, v4
v_lshlrev_b32 v4, 7, v4
v_lshl_add_u32 v220, v5, 4, v4
v_xor_b32 v221, 32, v220
v_xor_b32 v222, 64, v220
v_xor_b32 v223, 96, v220
v_add_u32 v224, 0x10000, v220
v_add_u32 v225, 0x10000, v221
v_add_u32 v226, 0x10000, v222
v_add_u32 v227, 0x10000, v223
v_lshlrev_b32 v2, 2, v1
s_lshr_b32 s43, s95, 1
v_add_u32 v2, s43, v2
v_mov_b32 v3, 0
s_lshl_b32 s6, s77, 1
s_sub_u32 s6, s6, 54
v_add_u32 v4, s6, v1
v_and_b32 v5, 3, v4
v_add_u32 v5, 28, v5
v_lshrrev_b32 v4, 2, v4
v_lshl_add_u32 v4, v5, 3, v4
v_cmp_lt_u32 vcc, 53, v1
v_cndmask_b32 v2, v2, v4, vcc
v_mov_b32 v5, 4
v_cndmask_b32 v3, v3, v5, vcc
s_lshr_b32 s6, s4, 2
s_lshl_b32 s6, s6, 1
s_sub_u32 s6, s6, 56
v_add_u32 v4, s6, v1
s_and_b32 s7, s3, 1
s_sub_u32 s6, 13, s7
v_min_u32 v4, s6, v4
v_and_b32 v5, 3, v4
v_add_u32 v5, 28, v5
v_lshrrev_b32 v4, 2, v4
v_lshlrev_b32 v4, 1, v4
v_add_u32 v4, s7, v4
v_lshl_add_u32 v4, v5, 3, v4
v_cmp_lt_u32 vcc, 55, v1
v_cndmask_b32 v2, v2, v4, vcc
v_mov_b32 v5, 8
v_cndmask_b32 v3, v3, v5, vcc
v_cmp_lt_u32 vcc, 57, v1
v_mov_b32 v4, s43
v_cndmask_b32 v2, v2, v4, vcc
v_mov_b32 v5, 0
v_cndmask_b32 v3, v3, v5, vcc
v_lshl_add_u32 v228, v2, 7, v3
v_and_b32 v2, 31, v1
v_and_b32 v3, 7, v2
v_lshrrev_b32 v2, 3, v2
v_lshlrev_b32 v2, 3, v2
v_add_u32 v2, s3, v2
v_lshl_add_u32 v2, v2, 3, v3
v_lshlrev_b32 v229, 7, v2
v_cmp_gt_u32 vcc, 14, v1
v_cndmask_b32 v2, 0, v1, vcc
v_cmp_lt_u32 vcc, 6, v2
v_cndmask_b32 v3, 0, 1, vcc
v_mul_u32_u24 v4, 7, v3
v_sub_u32 v2, v2, v4
s_lshr_b32 s6, s94, 1
s_and_b32 s7, s6, 3
s_lshr_b32 s6, s6, 2
s_lshl_b32 s6, s6, 1
v_lshlrev_b32 v2, 2, v2
v_add_u32 v2, s7, v2
v_add_u32 v3, s6, v3
v_lshl_add_u32 v2, v2, 3, v3
v_lshlrev_b32 v2, 7, v2
v_add_u32 v249, 16, v2
v_and_b32 v2, 31, v1
v_lshlrev_b32 v2, 3, v2
v_add_u32 v2, s95, v2
v_lshlrev_b32 v2, 7, v2
v_add_u32 v250, 20, v2
s_waitcnt vmcnt(15)
s_cmp_lg_u32 s5, 0
s_cbranch_scc1 L_arr_2
s_and_b32 s6, s2, 7
s_lshl_b32 s6, s6, 5
v_mov_b32 v2, s6
s_mov_b64 exec, 1
buffer_atomic_add v253, v2, s[52:55], 0 offen sc1
s_mov_b64 exec, -1
L_arr_2:
v_lshlrev_b32 v68, 16, v52
v_lshlrev_b32 v69, 16, v54
v_and_b32 v76, 0xffff0000, v52
v_and_b32 v77, 0xffff0000, v54
s_add_u32 m0, s81, 32768
v_lshlrev_b32 v84, 16, v53
v_lshlrev_b32 v85, 16, v55
v_and_b32 v92, 0xffff0000, v53
v_and_b32 v93, 0xffff0000, v55
s_add_u32 s79, s79, 221184
v_lshlrev_b32 v70, 16, v56
v_lshlrev_b32 v71, 16, v58
v_and_b32 v78, 0xffff0000, v56
v_and_b32 v79, 0xffff0000, v58
buffer_load_dwordx4 v208, s[20:23], s79 offen offset:0 lds
v_lshlrev_b32 v86, 16, v57
v_lshlrev_b32 v87, 16, v59
v_and_b32 v94, 0xffff0000, v57
v_and_b32 v95, 0xffff0000, v59
buffer_load_dwordx4 v209, s[20:23], s79 offen offset:1024 lds
v_lshlrev_b32 v72, 16, v60
v_lshlrev_b32 v73, 16, v62
v_and_b32 v80, 0xffff0000, v60
v_and_b32 v81, 0xffff0000, v62
buffer_load_dwordx4 v210, s[20:23], s79 offen offset:2048 lds
v_lshlrev_b32 v88, 16, v61
v_lshlrev_b32 v89, 16, v63
v_and_b32 v96, 0xffff0000, v61
v_and_b32 v97, 0xffff0000, v63
buffer_load_dwordx4 v211, s[20:23], s79 offen offset:3072 lds
v_lshlrev_b32 v74, 16, v64
v_lshlrev_b32 v75, 16, v66
v_and_b32 v82, 0xffff0000, v64
v_and_b32 v83, 0xffff0000, v66
v_lshlrev_b32 v90, 16, v65
v_lshlrev_b32 v91, 16, v67
v_and_b32 v98, 0xffff0000, v65
v_and_b32 v99, 0xffff0000, v67
s_waitcnt vmcnt(15)
v_lshlrev_b32 v100, 16, v8
v_and_b32 v101, 0xffff0000, v8
v_lshlrev_b32 v102, 16, v12
v_and_b32 v103, 0xffff0000, v12
v_lshlrev_b32 v104, 16, v16
v_and_b32 v105, 0xffff0000, v16
v_lshlrev_b32 v106, 16, v20
v_and_b32 v107, 0xffff0000, v20
v_lshlrev_b32 v108, 16, v24
v_and_b32 v109, 0xffff0000, v24
v_lshlrev_b32 v110, 16, v28
v_and_b32 v111, 0xffff0000, v28
s_add_u32 m0, s81, 49152
v_lshlrev_b32 v112, 16, v32
v_and_b32 v113, 0xffff0000, v32
v_lshlrev_b32 v114, 16, v36
v_and_b32 v115, 0xffff0000, v36
v_lshlrev_b32 v116, 16, v40
v_and_b32 v117, 0xffff0000, v40
v_lshlrev_b32 v118, 16, v44
v_and_b32 v119, 0xffff0000, v44
v_lshlrev_b32 v120, 16, v48
v_and_b32 v121, 0xffff0000, v48
v_pk_mul_f32 v[122:123], v[106:107], v[68:69]
v_pk_mul_f32 v[124:125], v[108:109], v[68:69]
s_add_u32 s80, s80, 128
v_pk_mul_f32 v[126:127], v[110:111], v[68:69]
v_pk_mul_f32 v[128:129], v[112:113], v[68:69]
v_pk_fma_f32 v[122:123], v[104:105], v[76:77], v[122:123]
v_pk_fma_f32 v[124:125], v[106:107], v[76:77], v[124:125]
v_pk_fma_f32 v[126:127], v[108:109], v[76:77], v[126:127]
v_pk_fma_f32 v[128:129], v[110:111], v[76:77], v[128:129]
v_pk_fma_f32 v[122:123], v[102:103], v[84:85], v[122:123]
v_pk_fma_f32 v[124:125], v[104:105], v[84:85], v[124:125]
v_pk_fma_f32 v[126:127], v[106:107], v[84:85], v[126:127]
v_pk_fma_f32 v[128:129], v[108:109], v[84:85], v[128:129]
v_pk_fma_f32 v[122:123], v[100:101], v[92:93], v[122:123]
v_pk_fma_f32 v[124:125], v[102:103], v[92:93], v[124:125]
buffer_load_dwordx4 v212, s[8:11], s80 offen offset:0 lds
v_pk_fma_f32 v[126:127], v[104:105], v[92:93], v[126:127]
v_pk_fma_f32 v[128:129], v[106:107], v[92:93], v[128:129]
v_pk_mul_f32 v[122:123], v[122:123], v[114:115]
v_pk_mul_f32 v[124:125], v[124:125], v[116:117]
v_pk_mul_f32 v[126:127], v[126:127], v[118:119]
v_pk_mul_f32 v[128:129], v[128:129], v[120:121]
s_mov_b32 exec_hi, 0xff
v_cvt_pk_bf16_f32 v100, v128, v126
v_cvt_pk_bf16_f32 v101, v124, v122
ds_write_b64 v7, v[100:101] offset:0
v_cvt_pk_bf16_f32 v102, v129, v127
v_cvt_pk_bf16_f32 v103, v125, v123
ds_write_b64 v7, v[102:103] offset:144
s_mov_b64 exec, -1
v_lshlrev_b32 v100, 16, v9
v_and_b32 v101, 0xffff0000, v9
v_lshlrev_b32 v102, 16, v13
v_and_b32 v103, 0xffff0000, v13
v_lshlrev_b32 v104, 16, v17
v_and_b32 v105, 0xffff0000, v17
buffer_load_dwordx4 v213, s[8:11], s80 offen offset:1024 lds
v_lshlrev_b32 v106, 16, v21
v_and_b32 v107, 0xffff0000, v21
v_lshlrev_b32 v108, 16, v25
v_and_b32 v109, 0xffff0000, v25
v_lshlrev_b32 v110, 16, v29
v_and_b32 v111, 0xffff0000, v29
v_lshlrev_b32 v112, 16, v33
v_and_b32 v113, 0xffff0000, v33
v_lshlrev_b32 v114, 16, v37
v_and_b32 v115, 0xffff0000, v37
v_lshlrev_b32 v116, 16, v41
v_and_b32 v117, 0xffff0000, v41
buffer_load_dwordx4 v214, s[8:11], s80 offen offset:2048 lds
v_lshlrev_b32 v118, 16, v45
v_and_b32 v119, 0xffff0000, v45
v_lshlrev_b32 v120, 16, v49
v_and_b32 v121, 0xffff0000, v49
v_pk_mul_f32 v[122:123], v[106:107], v[70:71]
v_pk_mul_f32 v[124:125], v[108:109], v[70:71]
v_pk_mul_f32 v[126:127], v[110:111], v[70:71]
v_pk_mul_f32 v[128:129], v[112:113], v[70:71]
v_pk_fma_f32 v[122:123], v[104:105], v[78:79], v[122:123]
v_pk_fma_f32 v[124:125], v[106:107], v[78:79], v[124:125]
v_pk_fma_f32 v[126:127], v[108:109], v[78:79], v[126:127]
v_pk_fma_f32 v[128:129], v[110:111], v[78:79], v[128:129]
buffer_load_dwordx4 v215, s[8:11], s80 offen offset:3072 lds
v_pk_fma_f32 v[122:123], v[102:103], v[86:87], v[122:123]
v_pk_fma_f32 v[124:125], v[104:105], v[86:87], v[124:125]
v_pk_fma_f32 v[126:127], v[106:107], v[86:87], v[126:127]
v_pk_fma_f32 v[128:129], v[108:109], v[86:87], v[128:129]
v_pk_fma_f32 v[122:123], v[100:101], v[94:95], v[122:123]
v_pk_fma_f32 v[124:125], v[102:103], v[94:95], v[124:125]
v_pk_fma_f32 v[126:127], v[104:105], v[94:95], v[126:127]
v_pk_fma_f32 v[128:129], v[106:107], v[94:95], v[128:129]
v_pk_mul_f32 v[122:123], v[122:123], v[114:115]
v_pk_mul_f32 v[124:125], v[124:125], v[116:117]
v_pk_mul_f32 v[126:127], v[126:127], v[118:119]
v_pk_mul_f32 v[128:129], v[128:129], v[120:121]
s_add_u32 m0, s81, 65536
s_mov_b32 exec_hi, 0xff
v_cvt_pk_bf16_f32 v100, v128, v126
v_cvt_pk_bf16_f32 v101, v124, v122
ds_write_b64 v7, v[100:101] offset:288
v_cvt_pk_bf16_f32 v102, v129, v127
v_cvt_pk_bf16_f32 v103, v125, v123
ds_write_b64 v7, v[102:103] offset:432
s_mov_b64 exec, -1
v_lshlrev_b32 v100, 16, v10
v_and_b32 v101, 0xffff0000, v10
v_lshlrev_b32 v102, 16, v14
v_and_b32 v103, 0xffff0000, v14
v_lshlrev_b32 v104, 16, v18
v_and_b32 v105, 0xffff0000, v18
v_lshlrev_b32 v106, 16, v22
v_and_b32 v107, 0xffff0000, v22
v_lshlrev_b32 v108, 16, v26
v_and_b32 v109, 0xffff0000, v26
v_lshlrev_b32 v110, 16, v30
v_and_b32 v111, 0xffff0000, v30
s_add_u32 s79, s79, 221184
v_lshlrev_b32 v112, 16, v34
v_and_b32 v113, 0xffff0000, v34
v_lshlrev_b32 v114, 16, v38
v_and_b32 v115, 0xffff0000, v38
v_lshlrev_b32 v116, 16, v42
v_and_b32 v117, 0xffff0000, v42
v_lshlrev_b32 v118, 16, v46
v_and_b32 v119, 0xffff0000, v46
v_lshlrev_b32 v120, 16, v50
v_and_b32 v121, 0xffff0000, v50
v_pk_mul_f32 v[122:123], v[106:107], v[72:73]
v_pk_mul_f32 v[124:125], v[108:109], v[72:73]
buffer_load_dwordx4 v208, s[20:23], s79 offen offset:0 lds
v_pk_mul_f32 v[126:127], v[110:111], v[72:73]
v_pk_mul_f32 v[128:129], v[112:113], v[72:73]
v_pk_fma_f32 v[122:123], v[104:105], v[80:81], v[122:123]
v_pk_fma_f32 v[124:125], v[106:107], v[80:81], v[124:125]
v_pk_fma_f32 v[126:127], v[108:109], v[80:81], v[126:127]
v_pk_fma_f32 v[128:129], v[110:111], v[80:81], v[128:129]
v_pk_fma_f32 v[122:123], v[102:103], v[88:89], v[122:123]
v_pk_fma_f32 v[124:125], v[104:105], v[88:89], v[124:125]
v_pk_fma_f32 v[126:127], v[106:107], v[88:89], v[126:127]
v_pk_fma_f32 v[128:129], v[108:109], v[88:89], v[128:129]
v_pk_fma_f32 v[122:123], v[100:101], v[96:97], v[122:123]
v_pk_fma_f32 v[124:125], v[102:103], v[96:97], v[124:125]
buffer_load_dwordx4 v209, s[20:23], s79 offen offset:1024 lds
v_pk_fma_f32 v[126:127], v[104:105], v[96:97], v[126:127]
v_pk_fma_f32 v[128:129], v[106:107], v[96:97], v[128:129]
v_pk_mul_f32 v[122:123], v[122:123], v[114:115]
v_pk_mul_f32 v[124:125], v[124:125], v[116:117]
v_pk_mul_f32 v[126:127], v[126:127], v[118:119]
v_pk_mul_f32 v[128:129], v[128:129], v[120:121]
s_mov_b32 exec_hi, 0xff
v_cvt_pk_bf16_f32 v100, v128, v126
v_cvt_pk_bf16_f32 v101, v124, v122
ds_write_b64 v7, v[100:101] offset:576
v_cvt_pk_bf16_f32 v102, v129, v127
v_cvt_pk_bf16_f32 v103, v125, v123
ds_write_b64 v7, v[102:103] offset:720
s_mov_b64 exec, -1
v_lshlrev_b32 v100, 16, v11
v_and_b32 v101, 0xffff0000, v11
v_lshlrev_b32 v102, 16, v15
v_and_b32 v103, 0xffff0000, v15
v_lshlrev_b32 v104, 16, v19
v_and_b32 v105, 0xffff0000, v19
buffer_load_dwordx4 v210, s[20:23], s79 offen offset:2048 lds
v_lshlrev_b32 v106, 16, v23
v_and_b32 v107, 0xffff0000, v23
v_lshlrev_b32 v108, 16, v27
v_and_b32 v109, 0xffff0000, v27
v_lshlrev_b32 v110, 16, v31
v_and_b32 v111, 0xffff0000, v31
v_lshlrev_b32 v112, 16, v35
v_and_b32 v113, 0xffff0000, v35
v_lshlrev_b32 v114, 16, v39
v_and_b32 v115, 0xffff0000, v39
v_lshlrev_b32 v116, 16, v43
v_and_b32 v117, 0xffff0000, v43
buffer_load_dwordx4 v211, s[20:23], s79 offen offset:3072 lds
v_lshlrev_b32 v118, 16, v47
v_and_b32 v119, 0xffff0000, v47
v_lshlrev_b32 v120, 16, v51
v_and_b32 v121, 0xffff0000, v51
v_pk_mul_f32 v[122:123], v[106:107], v[74:75]
v_pk_mul_f32 v[124:125], v[108:109], v[74:75]
v_pk_mul_f32 v[126:127], v[110:111], v[74:75]
v_pk_mul_f32 v[128:129], v[112:113], v[74:75]
v_pk_fma_f32 v[122:123], v[104:105], v[82:83], v[122:123]
v_pk_fma_f32 v[124:125], v[106:107], v[82:83], v[124:125]
v_pk_fma_f32 v[126:127], v[108:109], v[82:83], v[126:127]
v_pk_fma_f32 v[128:129], v[110:111], v[82:83], v[128:129]
s_add_u32 m0, s81, 81920
v_pk_fma_f32 v[122:123], v[102:103], v[90:91], v[122:123]
v_pk_fma_f32 v[124:125], v[104:105], v[90:91], v[124:125]
v_pk_fma_f32 v[126:127], v[106:107], v[90:91], v[126:127]
v_pk_fma_f32 v[128:129], v[108:109], v[90:91], v[128:129]
v_pk_fma_f32 v[122:123], v[100:101], v[98:99], v[122:123]
v_pk_fma_f32 v[124:125], v[102:103], v[98:99], v[124:125]
v_pk_fma_f32 v[126:127], v[104:105], v[98:99], v[126:127]
v_pk_fma_f32 v[128:129], v[106:107], v[98:99], v[128:129]
v_pk_mul_f32 v[122:123], v[122:123], v[114:115]
v_pk_mul_f32 v[124:125], v[124:125], v[116:117]
v_pk_mul_f32 v[126:127], v[126:127], v[118:119]
v_pk_mul_f32 v[128:129], v[128:129], v[120:121]
s_add_u32 s80, s80, 128
s_mov_b32 exec_hi, 0xff
v_cvt_pk_bf16_f32 v100, v128, v126
v_cvt_pk_bf16_f32 v101, v124, v122
ds_write_b64 v7, v[100:101] offset:864
v_cvt_pk_bf16_f32 v102, v129, v127
v_cvt_pk_bf16_f32 v103, v125, v123
ds_write_b64 v7, v[102:103] offset:1008
s_mov_b64 exec, -1
buffer_load_dwordx4 v212, s[8:11], s80 offen offset:0 lds
buffer_load_dwordx4 v213, s[8:11], s80 offen offset:1024 lds
buffer_load_dwordx4 v214, s[8:11], s80 offen offset:2048 lds
buffer_load_dwordx4 v215, s[8:11], s80 offen offset:3072 lds
v_lshrrev_b32 v2, 4, v1
v_bfe_u32 v3, v1, 2, 2
v_lshrrev_b32 v4, 1, v2
v_lshlrev_b32 v4, 4, v4
v_and_b32 v2, 1, v2
v_lshl_add_u32 v2, v2, 2, v3
v_add_u32 v2, v2, v4
v_mul_u32_u24 v2, 320, v2
v_and_b32 v3, 3, v1
v_mul_u32_u24 v3, 40, v3
v_add_u32 v2, v2, v3
v_add_u32 v204, 142592, v2
s_and_b32 s6, s2, 3
s_lshl_b32 s6, s6, 1
s_mul_i32 s6, s6, 54
s_lshr_b32 s7, s2, 2
s_add_u32 s6, s6, s7
s_mul_i32 s74, s6, 5120
s_add_u32 s74, s74, 7340032
v_mov_b32 v205, 2147418112
s_cmp_lt_u32 s2, 216
s_cselect_b64 vcc, -1, 0
v_cndmask_b32 v205, v205, v248, vcc
v_lshrrev_b32 v2, 3, v1
s_mul_i32 s6, s5, 20
v_add_u32 v2, s6, v2
v_and_b32 v3, 7, v1
v_lshlrev_b32 v3, 4, v3
v_mul_u32_u24 v4, 144, v2
v_add_u32 v4, v4, v3
v_add_u32 v4, 131072, v4
v_lshl_add_u32 v5, v2, 12, v3
s_mul_i32 s6, s69, 327680
s_lshl_b32 s7, s68, 7
s_sub_u32 s6, s6, s7
s_add_u32 s70, s6, 1052544
s_add_u32 s71, s70, 32768
s_add_u32 s72, s70, 65536
s_waitcnt vmcnt(24)
s_waitcnt lgkmcnt(0)
s_barrier
ds_read_b128 v[8:11], v4
ds_read_b128 v[12:15], v4 offset:1152
ds_read_b128 v[16:19], v4 offset:2304
s_add_u32 s6, s5, 0
s_cmp_ge_u32 s6, 5
s_cselect_b32 s7, 5, 0
s_cselect_b32 s43, 276480, 0
s_cselect_b32 s75, 160, 0
s_sub_u32 s6, s6, s7
s_lshl_b32 s7, s6, 3
s_add_u32 s75, s75, s7
v_add_u32 v2, s75, v204
s_lshl_b32 s6, s6, 10
s_add_u32 s6, s6, s43
s_add_u32 s75, s6, s74
ds_read_b64_tr_b16 v[20:21], v2
ds_read_b64_tr_b16 v[22:23], v2 offset:2560
s_add_u32 s6, s5, 4
s_cmp_ge_u32 s6, 5
s_cselect_b32 s7, 5, 0
s_cselect_b32 s43, 276480, 0
s_cselect_b32 s76, 160, 0
s_sub_u32 s6, s6, s7
s_lshl_b32 s7, s6, 3
s_add_u32 s76, s76, s7
v_add_u32 v2, s76, v204
s_lshl_b32 s6, s6, 10
s_add_u32 s6, s6, s43
s_add_u32 s76, s6, s74
ds_read_b64_tr_b16 v[24:25], v2
ds_read_b64_tr_b16 v[26:27], v2 offset:2560
s_waitcnt lgkmcnt(6)
buffer_store_dwordx4 v[8:11], v5, s[24:27], s70 offen sc1
s_waitcnt lgkmcnt(5)
buffer_store_dwordx4 v[12:15], v5, s[24:27], s71 offen sc1
s_waitcnt lgkmcnt(4)
s_mov_b32 exec_hi, 0
buffer_store_dwordx4 v[16:19], v5, s[24:27], s72 offen sc1
s_mov_b64 exec, -1
s_waitcnt lgkmcnt(2)
buffer_store_dwordx4 v[20:23], v205, s[24:27], s75 offen sc1
s_waitcnt lgkmcnt(0)
buffer_store_dwordx4 v[24:27], v205, s[24:27], s76 offen sc1
s_add_u32 s6, s5, 8
s_cmp_ge_u32 s6, 5
s_cselect_b32 s7, 5, 0
s_cselect_b32 s43, 276480, 0
s_cselect_b32 s93, 160, 0
s_sub_u32 s6, s6, s7
s_lshl_b32 s7, s6, 3
s_add_u32 s93, s93, s7
v_add_u32 v2, s93, v204
s_lshl_b32 s6, s6, 10
s_add_u32 s6, s6, s43
s_add_u32 s93, s6, s74
ds_read_b64_tr_b16 v[28:29], v2
ds_read_b64_tr_b16 v[30:31], v2 offset:2560
s_cmp_ge_u32 s5, 2
s_cselect_b64 vcc, -1, 0
v_mov_b32 v3, 2147418112
v_cndmask_b32 v3, v205, v3, vcc
s_waitcnt lgkmcnt(0)
buffer_store_dwordx4 v[28:31], v3, s[24:27], s93 offen sc1
v_mov_b32 v64, 0
v_mov_b32 v65, 0
v_mov_b32 v66, 0
v_mov_b32 v67, 0
v_mov_b32 v68, 0
v_mov_b32 v69, 0
v_mov_b32 v70, 0
v_mov_b32 v71, 0
v_mov_b32 v72, 0
v_mov_b32 v73, 0
v_mov_b32 v74, 0
v_mov_b32 v75, 0
v_mov_b32 v76, 0
v_mov_b32 v77, 0
v_mov_b32 v78, 0
v_mov_b32 v79, 0
v_mov_b32 v80, 0
v_mov_b32 v81, 0
v_mov_b32 v82, 0
v_mov_b32 v83, 0
v_mov_b32 v84, 0
v_mov_b32 v85, 0
v_mov_b32 v86, 0
v_mov_b32 v87, 0
v_mov_b32 v88, 0
v_mov_b32 v89, 0
v_mov_b32 v90, 0
v_mov_b32 v91, 0
v_mov_b32 v92, 0
v_mov_b32 v93, 0
v_mov_b32 v94, 0
v_mov_b32 v95, 0
v_mov_b32 v96, 0
v_mov_b32 v97, 0
v_mov_b32 v98, 0
v_mov_b32 v99, 0
v_mov_b32 v100, 0
v_mov_b32 v101, 0
v_mov_b32 v102, 0
v_mov_b32 v103, 0
v_mov_b32 v104, 0
v_mov_b32 v105, 0
v_mov_b32 v106, 0
v_mov_b32 v107, 0
v_mov_b32 v108, 0
v_mov_b32 v109, 0
v_mov_b32 v110, 0
v_mov_b32 v111, 0
v_mov_b32 v112, 0
v_mov_b32 v113, 0
v_mov_b32 v114, 0
v_mov_b32 v115, 0
v_mov_b32 v116, 0
v_mov_b32 v117, 0
v_mov_b32 v118, 0
v_mov_b32 v119, 0
v_mov_b32 v120, 0
v_mov_b32 v121, 0
v_mov_b32 v122, 0
v_mov_b32 v123, 0
v_mov_b32 v124, 0
v_mov_b32 v125, 0
v_mov_b32 v126, 0
v_mov_b32 v127, 0
s_waitcnt vmcnt(22)
s_barrier
ds_read_b64_tr_b16 v[128:129], v216 offset:0
ds_read_b64_tr_b16 v[130:131], v216 offset:1024
ds_read_b128 v[136:139], v220 offset:16384
ds_read_b128 v[140:143], v220 offset:20480
ds_read_b64_tr_b16 v[132:133], v217 offset:0
ds_read_b64_tr_b16 v[134:135], v217 offset:1024
s_add_u32 m0, s81, 98304
s_add_u32 s79, s79, 221184
buffer_load_dwordx4 v208, s[20:23], s79 offen offset:0 lds
buffer_load_dwordx4 v209, s[20:23], s79 offen offset:1024 lds
buffer_load_dwordx4 v210, s[20:23], s79 offen offset:2048 lds
buffer_load_dwordx4 v211, s[20:23], s79 offen offset:3072 lds
s_add_u32 m0, s81, 114688
s_add_u32 s80, s80, 128
buffer_load_dwordx4 v212, s[8:11], s80 offen offset:0 lds
buffer_load_dwordx4 v213, s[8:11], s80 offen offset:1024 lds
buffer_load_dwordx4 v214, s[8:11], s80 offen offset:2048 lds
buffer_load_dwordx4 v215, s[8:11], s80 offen offset:3072 lds
s_waitcnt lgkmcnt(3)
v_mfma_f32_32x32x16_bf16 v[64:79], v[128:131], v[136:139], v[64:79]
ds_read_b64_tr_b16 v[144:145], v216 offset:4096
ds_read_b64_tr_b16 v[146:147], v216 offset:5120
s_waitcnt lgkmcnt(4)
v_mfma_f32_32x32x16_bf16 v[80:95], v[128:131], v[140:143], v[80:95]
ds_read_b128 v[152:155], v221 offset:16384
ds_read_b128 v[156:159], v221 offset:20480
s_waitcnt lgkmcnt(4)
v_mfma_f32_32x32x16_bf16 v[96:111], v[132:135], v[136:139], v[96:111]
ds_read_b64_tr_b16 v[148:149], v217 offset:4096
ds_read_b64_tr_b16 v[150:151], v217 offset:5120
v_mfma_f32_32x32x16_bf16 v[112:127], v[132:135], v[140:143], v[112:127]
s_waitcnt lgkmcnt(3)
v_mfma_f32_32x32x16_bf16 v[64:79], v[144:147], v[152:155], v[64:79]
ds_read_b64_tr_b16 v[128:129], v216 offset:8192
ds_read_b64_tr_b16 v[130:131], v216 offset:9216
s_waitcnt lgkmcnt(4)
v_mfma_f32_32x32x16_bf16 v[80:95], v[144:147], v[156:159], v[80:95]
ds_read_b128 v[136:139], v222 offset:16384
ds_read_b128 v[140:143], v222 offset:20480
s_waitcnt lgkmcnt(4)
v_mfma_f32_32x32x16_bf16 v[96:111], v[148:151], v[152:155], v[96:111]
ds_read_b64_tr_b16 v[132:133], v217 offset:8192
ds_read_b64_tr_b16 v[134:135], v217 offset:9216
v_mfma_f32_32x32x16_bf16 v[112:127], v[148:151], v[156:159], v[112:127]
s_waitcnt lgkmcnt(3)
v_mfma_f32_32x32x16_bf16 v[64:79], v[128:131], v[136:139], v[64:79]
ds_read_b64_tr_b16 v[144:145], v216 offset:12288
ds_read_b64_tr_b16 v[146:147], v216 offset:13312
s_waitcnt lgkmcnt(4)
v_mfma_f32_32x32x16_bf16 v[80:95], v[128:131], v[140:143], v[80:95]
ds_read_b128 v[152:155], v223 offset:16384
ds_read_b128 v[156:159], v223 offset:20480
s_waitcnt lgkmcnt(4)
v_mfma_f32_32x32x16_bf16 v[96:111], v[132:135], v[136:139], v[96:111]
ds_read_b64_tr_b16 v[148:149], v217 offset:12288
ds_read_b64_tr_b16 v[150:151], v217 offset:13312
v_mfma_f32_32x32x16_bf16 v[112:127], v[132:135], v[140:143], v[112:127]
s_waitcnt lgkmcnt(0)
s_waitcnt vmcnt(22)
s_barrier
buffer_load_dword v254, v230, s[52:55], 0 offen sc1
v_mfma_f32_32x32x16_bf16 v[64:79], v[144:147], v[152:155], v[64:79]
ds_read_b64_tr_b16 v[128:129], v216 offset:32768
ds_read_b64_tr_b16 v[130:131], v216 offset:33792
s_add_u32 m0, s81, 0
s_add_u32 s79, s79, 221184
buffer_load_dwordx4 v208, s[20:23], s79 offen offset:0 lds
v_mfma_f32_32x32x16_bf16 v[80:95], v[144:147], v[156:159], v[80:95]
ds_read_b128 v[136:139], v220 offset:49152
ds_read_b128 v[140:143], v220 offset:53248
buffer_load_dwordx4 v209, s[20:23], s79 offen offset:1024 lds
buffer_load_dwordx4 v210, s[20:23], s79 offen offset:2048 lds
buffer_load_dwordx4 v211, s[20:23], s79 offen offset:3072 lds
v_mfma_f32_32x32x16_bf16 v[96:111], v[148:151], v[152:155], v[96:111]
ds_read_b64_tr_b16 v[132:133], v217 offset:32768
ds_read_b64_tr_b16 v[134:135], v217 offset:33792
s_add_u32 m0, s81, 16384
s_add_u32 s80, s80, 128
buffer_load_dwordx4 v212, s[8:11], s80 offen offset:0 lds
v_mfma_f32_32x32x16_bf16 v[112:127], v[148:151], v[156:159], v[112:127]
buffer_load_dwordx4 v213, s[8:11], s80 offen offset:1024 lds
buffer_load_dwordx4 v214, s[8:11], s80 offen offset:2048 lds
buffer_load_dwordx4 v215, s[8:11], s80 offen offset:3072 lds
s_waitcnt lgkmcnt(3)
v_mfma_f32_32x32x16_bf16 v[64:79], v[128:131], v[136:139], v[64:79]
ds_read_b64_tr_b16 v[144:145], v216 offset:36864
ds_read_b64_tr_b16 v[146:147], v216 offset:37888
s_waitcnt lgkmcnt(4)
v_mfma_f32_32x32x16_bf16 v[80:95], v[128:131], v[140:143], v[80:95]
ds_read_b128 v[152:155], v221 offset:49152
ds_read_b128 v[156:159], v221 offset:53248
s_waitcnt lgkmcnt(4)
v_mfma_f32_32x32x16_bf16 v[96:111], v[132:135], v[136:139], v[96:111]
ds_read_b64_tr_b16 v[148:149], v217 offset:36864
ds_read_b64_tr_b16 v[150:151], v217 offset:37888
v_mfma_f32_32x32x16_bf16 v[112:127], v[132:135], v[140:143], v[112:127]
s_waitcnt lgkmcnt(3)
v_mfma_f32_32x32x16_bf16 v[64:79], v[144:147], v[152:155], v[64:79]
ds_read_b64_tr_b16 v[128:129], v216 offset:40960
ds_read_b64_tr_b16 v[130:131], v216 offset:41984
s_waitcnt lgkmcnt(4)
v_mfma_f32_32x32x16_bf16 v[80:95], v[144:147], v[156:159], v[80:95]
ds_read_b128 v[136:139], v222 offset:49152
ds_read_b128 v[140:143], v222 offset:53248
s_waitcnt lgkmcnt(4)
v_mfma_f32_32x32x16_bf16 v[96:111], v[148:151], v[152:155], v[96:111]
ds_read_b64_tr_b16 v[132:133], v217 offset:40960
ds_read_b64_tr_b16 v[134:135], v217 offset:41984
v_mfma_f32_32x32x16_bf16 v[112:127], v[148:151], v[156:159], v[112:127]
s_waitcnt lgkmcnt(3)
v_mfma_f32_32x32x16_bf16 v[64:79], v[128:131], v[136:139], v[64:79]
ds_read_b64_tr_b16 v[144:145], v216 offset:45056
ds_read_b64_tr_b16 v[146:147], v216 offset:46080
s_waitcnt lgkmcnt(4)
v_mfma_f32_32x32x16_bf16 v[80:95], v[128:131], v[140:143], v[80:95]
ds_read_b128 v[152:155], v223 offset:49152
ds_read_b128 v[156:159], v223 offset:53248
s_waitcnt lgkmcnt(4)
v_mfma_f32_32x32x16_bf16 v[96:111], v[132:135], v[136:139], v[96:111]
ds_read_b64_tr_b16 v[148:149], v217 offset:45056
ds_read_b64_tr_b16 v[150:151], v217 offset:46080
v_mfma_f32_32x32x16_bf16 v[112:127], v[132:135], v[140:143], v[112:127]
s_waitcnt lgkmcnt(0)
s_waitcnt vmcnt(23)
s_barrier
v_mfma_f32_32x32x16_bf16 v[64:79], v[144:147], v[152:155], v[64:79]
ds_read_b64_tr_b16 v[128:129], v218 offset:0
ds_read_b64_tr_b16 v[130:131], v218 offset:1024
s_add_u32 m0, s81, 32768
s_add_u32 s79, s79, 221184
buffer_load_dwordx4 v208, s[20:23], s79 offen offset:0 lds
v_mfma_f32_32x32x16_bf16 v[80:95], v[144:147], v[156:159], v[80:95]
ds_read_b128 v[136:139], v224 offset:16384
ds_read_b128 v[140:143], v224 offset:20480
buffer_load_dwordx4 v209, s[20:23], s79 offen offset:1024 lds
buffer_load_dwordx4 v210, s[20:23], s79 offen offset:2048 lds
buffer_load_dwordx4 v211, s[20:23], s79 offen offset:3072 lds
v_mfma_f32_32x32x16_bf16 v[96:111], v[148:151], v[152:155], v[96:111]
ds_read_b64_tr_b16 v[132:133], v219 offset:0
ds_read_b64_tr_b16 v[134:135], v219 offset:1024
s_add_u32 m0, s81, 49152
s_add_u32 s80, s80, 128
buffer_load_dwordx4 v212, s[8:11], s80 offen offset:0 lds
v_mfma_f32_32x32x16_bf16 v[112:127], v[148:151], v[156:159], v[112:127]
buffer_load_dwordx4 v213, s[8:11], s80 offen offset:1024 lds
buffer_load_dwordx4 v214, s[8:11], s80 offen offset:2048 lds
buffer_load_dwordx4 v215, s[8:11], s80 offen offset:3072 lds
s_waitcnt lgkmcnt(3)
v_mfma_f32_32x32x16_bf16 v[64:79], v[128:131], v[136:139], v[64:79]
ds_read_b64_tr_b16 v[144:145], v218 offset:4096
ds_read_b64_tr_b16 v[146:147], v218 offset:5120
s_waitcnt lgkmcnt(4)
v_mfma_f32_32x32x16_bf16 v[80:95], v[128:131], v[140:143], v[80:95]
ds_read_b128 v[152:155], v225 offset:16384
ds_read_b128 v[156:159], v225 offset:20480
s_waitcnt lgkmcnt(4)
v_mfma_f32_32x32x16_bf16 v[96:111], v[132:135], v[136:139], v[96:111]
ds_read_b64_tr_b16 v[148:149], v219 offset:4096
ds_read_b64_tr_b16 v[150:151], v219 offset:5120
v_mfma_f32_32x32x16_bf16 v[112:127], v[132:135], v[140:143], v[112:127]
s_waitcnt lgkmcnt(3)
v_mfma_f32_32x32x16_bf16 v[64:79], v[144:147], v[152:155], v[64:79]
ds_read_b64_tr_b16 v[128:129], v218 offset:8192
ds_read_b64_tr_b16 v[130:131], v218 offset:9216
s_waitcnt lgkmcnt(4)
v_mfma_f32_32x32x16_bf16 v[80:95], v[144:147], v[156:159], v[80:95]
ds_read_b128 v[136:139], v226 offset:16384
ds_read_b128 v[140:143], v226 offset:20480
s_waitcnt lgkmcnt(4)
v_mfma_f32_32x32x16_bf16 v[96:111], v[148:151], v[152:155], v[96:111]
ds_read_b64_tr_b16 v[132:133], v219 offset:8192
ds_read_b64_tr_b16 v[134:135], v219 offset:9216
v_mfma_f32_32x32x16_bf16 v[112:127], v[148:151], v[156:159], v[112:127]
s_waitcnt lgkmcnt(3)
v_mfma_f32_32x32x16_bf16 v[64:79], v[128:131], v[136:139], v[64:79]
ds_read_b64_tr_b16 v[144:145], v218 offset:12288
ds_read_b64_tr_b16 v[146:147], v218 offset:13312
s_waitcnt lgkmcnt(4)
v_mfma_f32_32x32x16_bf16 v[80:95], v[128:131], v[140:143], v[80:95]
ds_read_b128 v[152:155], v227 offset:16384
ds_read_b128 v[156:159], v227 offset:20480
s_waitcnt lgkmcnt(4)
v_mfma_f32_32x32x16_bf16 v[96:111], v[132:135], v[136:139], v[96:111]
ds_read_b64_tr_b16 v[148:149], v219 offset:12288
ds_read_b64_tr_b16 v[150:151], v219 offset:13312
v_mfma_f32_32x32x16_bf16 v[112:127], v[132:135], v[140:143], v[112:127]
s_waitcnt lgkmcnt(0)
s_waitcnt vmcnt(17)
s_waitcnt vmcnt(16)
v_cmp_gt_u32 vcc, 32, v254
s_cbranch_vccnz L_slow_3
L_back_4:
s_barrier
s_cmp_lg_u32 s5, 0
s_cbranch_scc1 L_fl_5
s_mov_b64 exec, 1
buffer_store_dword v253, v252, s[24:27], 0 offen offset:0 sc1
s_mov_b64 exec, -1
L_fl_5:
v_mfma_f32_32x32x16_bf16 v[64:79], v[144:147], v[152:155], v[64:79]
ds_read_b64_tr_b16 v[128:129], v218 offset:32768
ds_read_b64_tr_b16 v[130:131], v218 offset:33792
s_add_u32 m0, s81, 65536
s_add_u32 s79, s79, 221184
buffer_load_dwordx4 v208, s[20:23], s79 offen offset:0 lds
v_mfma_f32_32x32x16_bf16 v[80:95], v[144:147], v[156:159], v[80:95]
ds_read_b128 v[136:139], v224 offset:49152
ds_read_b128 v[140:143], v224 offset:53248
buffer_load_dwordx4 v209, s[20:23], s79 offen offset:1024 lds
buffer_load_dwordx4 v210, s[20:23], s79 offen offset:2048 lds
buffer_load_dwordx4 v211, s[20:23], s79 offen offset:3072 lds
v_mfma_f32_32x32x16_bf16 v[96:111], v[148:151], v[152:155], v[96:111]
ds_read_b64_tr_b16 v[132:133], v219 offset:32768
ds_read_b64_tr_b16 v[134:135], v219 offset:33792
s_add_u32 m0, s81, 81920
s_add_u32 s80, s80, 128
buffer_load_dwordx4 v212, s[8:11], s80 offen offset:0 lds
v_mfma_f32_32x32x16_bf16 v[112:127], v[148:151], v[156:159], v[112:127]
buffer_load_dwordx4 v213, s[8:11], s80 offen offset:1024 lds
buffer_load_dwordx4 v214, s[8:11], s80 offen offset:2048 lds
buffer_load_dwordx4 v215, s[8:11], s80 offen offset:3072 lds
s_waitcnt lgkmcnt(3)
v_mfma_f32_32x32x16_bf16 v[64:79], v[128:131], v[136:139], v[64:79]
ds_read_b64_tr_b16 v[144:145], v218 offset:36864
ds_read_b64_tr_b16 v[146:147], v218 offset:37888
s_waitcnt lgkmcnt(4)
v_mfma_f32_32x32x16_bf16 v[80:95], v[128:131], v[140:143], v[80:95]
ds_read_b128 v[152:155], v225 offset:49152
ds_read_b128 v[156:159], v225 offset:53248
s_waitcnt lgkmcnt(4)
v_mfma_f32_32x32x16_bf16 v[96:111], v[132:135], v[136:139], v[96:111]
ds_read_b64_tr_b16 v[148:149], v219 offset:36864
ds_read_b64_tr_b16 v[150:151], v219 offset:37888
v_mfma_f32_32x32x16_bf16 v[112:127], v[132:135], v[140:143], v[112:127]
s_waitcnt lgkmcnt(3)
v_mfma_f32_32x32x16_bf16 v[64:79], v[144:147], v[152:155], v[64:79]
ds_read_b64_tr_b16 v[128:129], v218 offset:40960
ds_read_b64_tr_b16 v[130:131], v218 offset:41984
s_waitcnt lgkmcnt(4)
v_mfma_f32_32x32x16_bf16 v[80:95], v[144:147], v[156:159], v[80:95]
ds_read_b128 v[136:139], v226 offset:49152
ds_read_b128 v[140:143], v226 offset:53248
s_waitcnt lgkmcnt(4)
v_mfma_f32_32x32x16_bf16 v[96:111], v[148:151], v[152:155], v[96:111]
ds_read_b64_tr_b16 v[132:133], v219 offset:40960
ds_read_b64_tr_b16 v[134:135], v219 offset:41984
v_mfma_f32_32x32x16_bf16 v[112:127], v[148:151], v[156:159], v[112:127]
s_waitcnt lgkmcnt(3)
v_mfma_f32_32x32x16_bf16 v[64:79], v[128:131], v[136:139], v[64:79]
ds_read_b64_tr_b16 v[144:145], v218 offset:45056
ds_read_b64_tr_b16 v[146:147], v218 offset:46080
s_waitcnt lgkmcnt(4)
v_mfma_f32_32x32x16_bf16 v[80:95], v[128:131], v[140:143], v[80:95]
ds_read_b128 v[152:155], v227 offset:49152
ds_read_b128 v[156:159], v227 offset:53248
s_waitcnt lgkmcnt(4)
v_mfma_f32_32x32x16_bf16 v[96:111], v[132:135], v[136:139], v[96:111]
ds_read_b64_tr_b16 v[148:149], v219 offset:45056
ds_read_b64_tr_b16 v[150:151], v219 offset:46080
v_mfma_f32_32x32x16_bf16 v[112:127], v[132:135], v[140:143], v[112:127]
s_waitcnt lgkmcnt(0)
s_waitcnt vmcnt(16)
s_barrier
buffer_load_dword v254, v228, s[24:27], 0 offen sc1
v_mfma_f32_32x32x16_bf16 v[64:79], v[144:147], v[152:155], v[64:79]
ds_read_b64_tr_b16 v[128:129], v216 offset:0
ds_read_b64_tr_b16 v[130:131], v216 offset:1024
s_add_u32 m0, s81, 98304
s_add_u32 s79, s79, 221184
buffer_load_dwordx4 v208, s[20:23], s79 offen offset:0 lds
v_mfma_f32_32x32x16_bf16 v[80:95], v[144:147], v[156:159], v[80:95]
ds_read_b128 v[136:139], v220 offset:16384
ds_read_b128 v[140:143], v220 offset:20480
buffer_load_dwordx4 v209, s[20:23], s79 offen offset:1024 lds
buffer_load_dwordx4 v210, s[20:23], s79 offen offset:2048 lds
buffer_load_dwordx4 v211, s[20:23], s79 offen offset:3072 lds
v_mfma_f32_32x32x16_bf16 v[96:111], v[148:151], v[152:155], v[96:111]
ds_read_b64_tr_b16 v[132:133], v217 offset:0
ds_read_b64_tr_b16 v[134:135], v217 offset:1024
s_add_u32 m0, s81, 114688
s_add_u32 s80, s80, 128
buffer_load_dwordx4 v212, s[8:11], s80 offen offset:0 lds
v_mfma_f32_32x32x16_bf16 v[112:127], v[148:151], v[156:159], v[112:127]
buffer_load_dwordx4 v213, s[8:11], s80 offen offset:1024 lds
buffer_load_dwordx4 v214, s[8:11], s80 offen offset:2048 lds
buffer_load_dwordx4 v215, s[8:11], s80 offen offset:3072 lds
s_waitcnt lgkmcnt(3)
v_mfma_f32_32x32x16_bf16 v[64:79], v[128:131], v[136:139], v[64:79]
ds_read_b64_tr_b16 v[144:145], v216 offset:4096
ds_read_b64_tr_b16 v[146:147], v216 offset:5120
s_waitcnt lgkmcnt(4)
v_mfma_f32_32x32x16_bf16 v[80:95], v[128:131], v[140:143], v[80:95]
ds_read_b128 v[152:155], v221 offset:16384
ds_read_b128 v[156:159], v221 offset:20480
s_waitcnt lgkmcnt(4)
v_mfma_f32_32x32x16_bf16 v[96:111], v[132:135], v[136:139], v[96:111]
ds_read_b64_tr_b16 v[148:149], v217 offset:4096
ds_read_b64_tr_b16 v[150:151], v217 offset:5120
v_mfma_f32_32x32x16_bf16 v[112:127], v[132:135], v[140:143], v[112:127]
s_waitcnt lgkmcnt(3)
v_mfma_f32_32x32x16_bf16 v[64:79], v[144:147], v[152:155], v[64:79]
ds_read_b64_tr_b16 v[128:129], v216 offset:8192
ds_read_b64_tr_b16 v[130:131], v216 offset:9216
s_waitcnt lgkmcnt(4)
v_mfma_f32_32x32x16_bf16 v[80:95], v[144:147], v[156:159], v[80:95]
ds_read_b128 v[136:139], v222 offset:16384
ds_read_b128 v[140:143], v222 offset:20480
s_waitcnt lgkmcnt(4)
v_mfma_f32_32x32x16_bf16 v[96:111], v[148:151], v[152:155], v[96:111]
ds_read_b64_tr_b16 v[132:133], v217 offset:8192
ds_read_b64_tr_b16 v[134:135], v217 offset:9216
v_mfma_f32_32x32x16_bf16 v[112:127], v[148:151], v[156:159], v[112:127]
s_waitcnt lgkmcnt(3)
v_mfma_f32_32x32x16_bf16 v[64:79], v[128:131], v[136:139], v[64:79]
ds_read_b64_tr_b16 v[144:145], v216 offset:12288
ds_read_b64_tr_b16 v[146:147], v216 offset:13312
s_waitcnt lgkmcnt(4)
v_mfma_f32_32x32x16_bf16 v[80:95], v[128:131], v[140:143], v[80:95]
ds_read_b128 v[152:155], v223 offset:16384
ds_read_b128 v[156:159], v223 offset:20480
s_waitcnt lgkmcnt(4)
v_mfma_f32_32x32x16_bf16 v[96:111], v[132:135], v[136:139], v[96:111]
ds_read_b64_tr_b16 v[148:149], v217 offset:12288
ds_read_b64_tr_b16 v[150:151], v217 offset:13312
v_mfma_f32_32x32x16_bf16 v[112:127], v[132:135], v[140:143], v[112:127]
s_waitcnt lgkmcnt(0)
s_waitcnt vmcnt(17)
s_barrier
v_mfma_f32_32x32x16_bf16 v[64:79], v[144:147], v[152:155], v[64:79]
ds_read_b64_tr_b16 v[128:129], v216 offset:32768
ds_read_b64_tr_b16 v[130:131], v216 offset:33792
s_add_u32 m0, s81, 0
s_add_u32 s79, s79, 221184
buffer_load_dwordx4 v208, s[20:23], s79 offen offset:0 lds
v_mfma_f32_32x32x16_bf16 v[80:95], v[144:147], v[156:159], v[80:95]
ds_read_b128 v[136:139], v220 offset:49152
ds_read_b128 v[140:143], v220 offset:53248
buffer_load_dwordx4 v209, s[20:23], s79 offen offset:1024 lds
buffer_load_dwordx4 v210, s[20:23], s79 offen offset:2048 lds
buffer_load_dwordx4 v211, s[20:23], s79 offen offset:3072 lds
v_mfma_f32_32x32x16_bf16 v[96:111], v[148:151], v[152:155], v[96:111]
ds_read_b64_tr_b16 v[132:133], v217 offset:32768
ds_read_b64_tr_b16 v[134:135], v217 offset:33792
s_add_u32 m0, s81, 16384
s_add_u32 s80, s80, 128
buffer_load_dwordx4 v212, s[8:11], s80 offen offset:0 lds
v_mfma_f32_32x32x16_bf16 v[112:127], v[148:151], v[156:159], v[112:127]
buffer_load_dwordx4 v213, s[8:11], s80 offen offset:1024 lds
buffer_load_dwordx4 v214, s[8:11], s80 offen offset:2048 lds
buffer_load_dwordx4 v215, s[8:11], s80 offen offset:3072 lds
s_waitcnt lgkmcnt(3)
v_mfma_f32_32x32x16_bf16 v[64:79], v[128:131], v[136:139], v[64:79]
ds_read_b64_tr_b16 v[144:145], v216 offset:36864
ds_read_b64_tr_b16 v[146:147], v216 offset:37888
s_waitcnt lgkmcnt(4)
v_mfma_f32_32x32x16_bf16 v[80:95], v[128:131], v[140:143], v[80:95]
ds_read_b128 v[152:155], v221 offset:49152
ds_read_b128 v[156:159], v221 offset:53248
s_waitcnt lgkmcnt(4)
v_mfma_f32_32x32x16_bf16 v[96:111], v[132:135], v[136:139], v[96:111]
ds_read_b64_tr_b16 v[148:149], v217 offset:36864
ds_read_b64_tr_b16 v[150:151], v217 offset:37888
v_mfma_f32_32x32x16_bf16 v[112:127], v[132:135], v[140:143], v[112:127]
s_waitcnt lgkmcnt(3)
v_mfma_f32_32x32x16_bf16 v[64:79], v[144:147], v[152:155], v[64:79]
ds_read_b64_tr_b16 v[128:129], v216 offset:40960
ds_read_b64_tr_b16 v[130:131], v216 offset:41984
s_waitcnt lgkmcnt(4)
v_mfma_f32_32x32x16_bf16 v[80:95], v[144:147], v[156:159], v[80:95]
ds_read_b128 v[136:139], v222 offset:49152
ds_read_b128 v[140:143], v222 offset:53248
s_waitcnt lgkmcnt(4)
v_mfma_f32_32x32x16_bf16 v[96:111], v[148:151], v[152:155], v[96:111]
ds_read_b64_tr_b16 v[132:133], v217 offset:40960
ds_read_b64_tr_b16 v[134:135], v217 offset:41984
v_mfma_f32_32x32x16_bf16 v[112:127], v[148:151], v[156:159], v[112:127]
s_waitcnt lgkmcnt(3)
v_mfma_f32_32x32x16_bf16 v[64:79], v[128:131], v[136:139], v[64:79]
ds_read_b64_tr_b16 v[144:145], v216 offset:45056
ds_read_b64_tr_b16 v[146:147], v216 offset:46080
s_waitcnt lgkmcnt(4)
v_mfma_f32_32x32x16_bf16 v[80:95], v[128:131], v[140:143], v[80:95]
ds_read_b128 v[152:155], v223 offset:49152
ds_read_b128 v[156:159], v223 offset:53248
s_waitcnt lgkmcnt(4)
v_mfma_f32_32x32x16_bf16 v[96:111], v[132:135], v[136:139], v[96:111]
ds_read_b64_tr_b16 v[148:149], v217 offset:45056
ds_read_b64_tr_b16 v[150:151], v217 offset:46080
v_mfma_f32_32x32x16_bf16 v[112:127], v[132:135], v[140:143], v[112:127]
s_waitcnt lgkmcnt(0)
s_waitcnt vmcnt(17)
s_waitcnt vmcnt(16)
v_cmp_eq_u32 vcc, 0, v254
s_cbranch_vccnz L_slow_6
L_back_7:
s_barrier
v_and_b32 v2, 31, v1
s_lshl_b32 s6, s78, 7
s_lshl_b32 s7, s82, 6
s_add_u32 s6, s6, s7
v_add_u32 v3, s6, v2
v_lshlrev_b32 v3, 4, v3
s_cmp_ge_u32 s6, 1728
s_cselect_b32 s101, 0, 32
s_lshl_b32 s6, s77, 7
s_lshl_b32 s7, s83, 6
s_add_u32 s6, s6, s7
v_add_u32 v4, s6, v2
v_lshlrev_b32 v4, 4, v4
v_mov_b32 v5, 2147418112
v_cmp_gt_u32 vcc, s101, v1
v_cndmask_b32 v3, v5, v3, vcc
v_cmp_gt_u32 vcc, 32, v1
v_cndmask_b32 v5, v5, v4, vcc
s_mov_b32 s6, 131072
s_mov_b32 s7, 65536
s_mov_b32 s84, 98304
buffer_load_dwordx4 v[28:31], v3, s[24:27], s6 offen
buffer_load_dwordx4 v[36:39], v5, s[24:27], s7 offen
buffer_load_dwordx4 v[32:35], v3, s[24:27], s6 offen offset:512
buffer_load_dwordx4 v[40:43], v5, s[24:27], s7 offen offset:512
buffer_load_dwordx4 v[44:47], v4, s[24:27], s84 offen
buffer_load_dwordx4 v[48:51], v4, s[24:27], s84 offen offset:512
buffer_load_dword v254, v229, s[24:27], 0 offen sc1
s_mul_i32 s6, s95, 54
s_add_u32 s6, s6, s96
s_mul_i32 s97, s6, 5120
s_add_u32 s97, s97, 7340032
s_add_u32 s98, s97, 4096
s_lshl_b32 s6, s5, 2
v_lshlrev_b32 v202, 2, v1
v_add_u32 v202, s6, v202
v_subrev_u32 v202, 252, v202
v_add_u32 v203, s6, v248
v_add_u32 v203, 4, v203
s_mul_i32 s90, s5, 4416
v_mfma_f32_32x32x16_bf16 v[64:79], v[144:147], v[152:155], v[64:79]
ds_read_b64_tr_b16 v[128:129], v218 offset:0
ds_read_b64_tr_b16 v[130:131], v218 offset:1024
s_add_u32 m0, s81, 32768
s_add_u32 s79, s79, 221184
buffer_load_dwordx4 v208, s[20:23], s79 offen offset:0 lds
v_mfma_f32_32x32x16_bf16 v[80:95], v[144:147], v[156:159], v[80:95]
ds_read_b128 v[136:139], v224 offset:16384
ds_read_b128 v[140:143], v224 offset:20480
buffer_load_dwordx4 v209, s[20:23], s79 offen offset:1024 lds
buffer_load_dwordx4 v210, s[20:23], s79 offen offset:2048 lds
buffer_load_dwordx4 v211, s[20:23], s79 offen offset:3072 lds
v_mfma_f32_32x32x16_bf16 v[96:111], v[148:151], v[152:155], v[96:111]
ds_read_b64_tr_b16 v[132:133], v219 offset:0
ds_read_b64_tr_b16 v[134:135], v219 offset:1024
s_add_u32 m0, s81, 49152
s_add_u32 s80, s80, 128
buffer_load_dwordx4 v212, s[8:11], s80 offen offset:0 lds
v_mfma_f32_32x32x16_bf16 v[112:127], v[148:151], v[156:159], v[112:127]
buffer_load_dwordx4 v213, s[8:11], s80 offen offset:1024 lds
buffer_load_dwordx4 v214, s[8:11], s80 offen offset:2048 lds
buffer_load_dwordx4 v215, s[8:11], s80 offen offset:3072 lds
s_waitcnt lgkmcnt(3)
v_mfma_f32_32x32x16_bf16 v[64:79], v[128:131], v[136:139], v[64:79]
ds_read_b64_tr_b16 v[144:145], v218 offset:4096
ds_read_b64_tr_b16 v[146:147], v218 offset:5120
s_waitcnt lgkmcnt(4)
v_mfma_f32_32x32x16_bf16 v[80:95], v[128:131], v[140:143], v[80:95]
ds_read_b128 v[152:155], v225 offset:16384
ds_read_b128 v[156:159], v225 offset:20480
s_waitcnt lgkmcnt(4)
v_mfma_f32_32x32x16_bf16 v[96:111], v[132:135], v[136:139], v[96:111]
ds_read_b64_tr_b16 v[148:149], v219 offset:4096
ds_read_b64_tr_b16 v[150:151], v219 offset:5120
v_mfma_f32_32x32x16_bf16 v[112:127], v[132:135], v[140:143], v[112:127]
s_waitcnt lgkmcnt(3)
v_mfma_f32_32x32x16_bf16 v[64:79], v[144:147], v[152:155], v[64:79]
ds_read_b64_tr_b16 v[128:129], v218 offset:8192
ds_read_b64_tr_b16 v[130:131], v218 offset:9216
s_waitcnt lgkmcnt(4)
v_mfma_f32_32x32x16_bf16 v[80:95], v[144:147], v[156:159], v[80:95]
ds_read_b128 v[136:139], v226 offset:16384
ds_read_b128 v[140:143], v226 offset:20480
s_waitcnt lgkmcnt(4)
v_mfma_f32_32x32x16_bf16 v[96:111], v[148:151], v[152:155], v[96:111]
ds_read_b64_tr_b16 v[132:133], v219 offset:8192
ds_read_b64_tr_b16 v[134:135], v219 offset:9216
v_mfma_f32_32x32x16_bf16 v[112:127], v[148:151], v[156:159], v[112:127]
s_waitcnt lgkmcnt(3)
v_mfma_f32_32x32x16_bf16 v[64:79], v[128:131], v[136:139], v[64:79]
ds_read_b64_tr_b16 v[144:145], v218 offset:12288
ds_read_b64_tr_b16 v[146:147], v218 offset:13312
s_waitcnt lgkmcnt(4)
v_mfma_f32_32x32x16_bf16 v[80:95], v[128:131], v[140:143], v[80:95]
ds_read_b128 v[152:155], v227 offset:16384
ds_read_b128 v[156:159], v227 offset:20480
s_waitcnt lgkmcnt(4)
v_mfma_f32_32x32x16_bf16 v[96:111], v[132:135], v[136:139], v[96:111]
ds_read_b64_tr_b16 v[148:149], v219 offset:12288
ds_read_b64_tr_b16 v[150:151], v219 offset:13312
v_mfma_f32_32x32x16_bf16 v[112:127], v[132:135], v[140:143], v[112:127]
s_waitcnt lgkmcnt(0)
s_waitcnt vmcnt(23)
s_barrier
v_mfma_f32_32x32x16_bf16 v[64:79], v[144:147], v[152:155], v[64:79]
ds_read_b64_tr_b16 v[128:129], v218 offset:32768
ds_read_b64_tr_b16 v[130:131], v218 offset:33792
v_mfma_f32_32x32x16_bf16 v[80:95], v[144:147], v[156:159], v[80:95]
ds_read_b128 v[136:139], v224 offset:49152
ds_read_b128 v[140:143], v224 offset:53248
v_mfma_f32_32x32x16_bf16 v[96:111], v[148:151], v[152:155], v[96:111]
ds_read_b64_tr_b16 v[132:133], v219 offset:32768
ds_read_b64_tr_b16 v[134:135], v219 offset:33792
v_mfma_f32_32x32x16_bf16 v[112:127], v[148:151], v[156:159], v[112:127]
s_waitcnt lgkmcnt(3)
v_mfma_f32_32x32x16_bf16 v[64:79], v[128:131], v[136:139], v[64:79]
ds_read_b64_tr_b16 v[144:145], v218 offset:36864
ds_read_b64_tr_b16 v[146:147], v218 offset:37888
s_waitcnt lgkmcnt(4)
v_mfma_f32_32x32x16_bf16 v[80:95], v[128:131], v[140:143], v[80:95]
ds_read_b128 v[152:155], v225 offset:49152
ds_read_b128 v[156:159], v225 offset:53248
buffer_load_dwordx4 a[0:3], v248, s[24:27], s97 offen offset:0
s_waitcnt lgkmcnt(4)
v_mfma_f32_32x32x16_bf16 v[96:111], v[132:135], v[136:139], v[96:111]
ds_read_b64_tr_b16 v[148:149], v219 offset:36864
ds_read_b64_tr_b16 v[150:151], v219 offset:37888
buffer_load_dwordx4 a[4:7], v248, s[24:27], s97 offen offset:1024
v_mfma_f32_32x32x16_bf16 v[112:127], v[132:135], v[140:143], v[112:127]
buffer_load_dwordx4 a[8:11], v248, s[24:27], s97 offen offset:2048
s_waitcnt lgkmcnt(3)
v_mfma_f32_32x32x16_bf16 v[64:79], v[144:147], v[152:155], v[64:79]
ds_read_b64_tr_b16 v[128:129], v218 offset:40960
ds_read_b64_tr_b16 v[130:131], v218 offset:41984
buffer_load_dwordx4 a[12:15], v248, s[24:27], s97 offen offset:3072
s_waitcnt lgkmcnt(4)
v_mfma_f32_32x32x16_bf16 v[80:95], v[144:147], v[156:159], v[80:95]
ds_read_b128 v[136:139], v226 offset:49152
ds_read_b128 v[140:143], v226 offset:53248
buffer_load_dwordx4 a[16:19], v248, s[24:27], s98 offen
s_waitcnt lgkmcnt(4)
v_mfma_f32_32x32x16_bf16 v[96:111], v[148:151], v[152:155], v[96:111]
ds_read_b64_tr_b16 v[132:133], v219 offset:40960
ds_read_b64_tr_b16 v[134:135], v219 offset:41984
s_add_u32 s97, s97, 5120
v_mfma_f32_32x32x16_bf16 v[112:127], v[148:151], v[156:159], v[112:127]
s_add_u32 s98, s98, 5120
buffer_load_dwordx4 a[20:23], v248, s[24:27], s97 offen offset:0
s_waitcnt lgkmcnt(3)
v_mfma_f32_32x32x16_bf16 v[64:79], v[128:131], v[136:139], v[64:79]
ds_read_b64_tr_b16 v[144:145], v218 offset:45056
ds_read_b64_tr_b16 v[146:147], v218 offset:46080
buffer_load_dwordx4 a[24:27], v248, s[24:27], s97 offen offset:1024
s_waitcnt lgkmcnt(4)
v_mfma_f32_32x32x16_bf16 v[80:95], v[128:131], v[140:143], v[80:95]
ds_read_b128 v[152:155], v227 offset:49152
ds_read_b128 v[156:159], v227 offset:53248
buffer_load_dwordx4 a[28:31], v248, s[24:27], s97 offen offset:2048
buffer_load_dwordx4 a[32:35], v248, s[24:27], s97 offen offset:3072
s_waitcnt lgkmcnt(4)
v_mfma_f32_32x32x16_bf16 v[96:111], v[132:135], v[136:139], v[96:111]
ds_read_b64_tr_b16 v[148:149], v219 offset:45056
ds_read_b64_tr_b16 v[150:151], v219 offset:46080
buffer_load_dwordx4 a[36:39], v248, s[24:27], s98 offen
v_mfma_f32_32x32x16_bf16 v[112:127], v[132:135], v[140:143], v[112:127]
s_add_u32 s97, s97, 5120
s_add_u32 s98, s98, 5120
s_waitcnt lgkmcnt(0)
s_waitcnt vmcnt(25)
s_waitcnt vmcnt(18)
v_cmp_eq_u32 vcc, 0, v254
s_cbranch_vccnz L_slow_8
L_back_9:
s_barrier
v_mfma_f32_32x32x16_bf16 v[64:79], v[144:147], v[152:155], v[64:79]
ds_read_b64_tr_b16 v[128:129], v216 offset:0
ds_read_b64_tr_b16 v[130:131], v216 offset:1024
v_mfma_f32_32x32x16_bf16 v[80:95], v[144:147], v[156:159], v[80:95]
ds_read_b128 v[136:139], v220 offset:16384
ds_read_b128 v[140:143], v220 offset:20480
v_mfma_f32_32x32x16_bf16 v[96:111], v[148:151], v[152:155], v[96:111]
ds_read_b64_tr_b16 v[132:133], v217 offset:0
ds_read_b64_tr_b16 v[134:135], v217 offset:1024
v_mfma_f32_32x32x16_bf16 v[112:127], v[148:151], v[156:159], v[112:127]
s_waitcnt lgkmcnt(3)
v_mfma_f32_32x32x16_bf16 v[64:79], v[128:131], v[136:139], v[64:79]
ds_read_b64_tr_b16 v[144:145], v216 offset:4096
ds_read_b64_tr_b16 v[146:147], v216 offset:5120
v_lshlrev_b32 v4, 4, v0
s_add_u32 s6, s88, 0
s_lshl_b32 s6, s6, 12
s_add_u32 s6, s6, 1048576
s_add_u32 s36, s66, s6
s_addc_u32 s37, s67, 0
s_and_b32 s37, s37, 0xffff
s_waitcnt lgkmcnt(4)
v_mfma_f32_32x32x16_bf16 v[80:95], v[128:131], v[140:143], v[80:95]
ds_read_b128 v[152:155], v221 offset:16384
ds_read_b128 v[156:159], v221 offset:20480
s_mov_b32 s38, 4096
s_mov_b32 s39, 0x20000
buffer_load_dwordx4 v[184:187], v4, s[36:39], 0 offen
buffer_load_dword v188, v4, s[36:39], 0 offen offset:16
s_add_u32 s6, s88, 1
s_lshl_b32 s6, s6, 12
s_add_u32 s6, s6, 1048576
s_add_u32 s36, s66, s6
s_waitcnt lgkmcnt(4)
v_mfma_f32_32x32x16_bf16 v[96:111], v[132:135], v[136:139], v[96:111]
ds_read_b64_tr_b16 v[148:149], v217 offset:4096
ds_read_b64_tr_b16 v[150:151], v217 offset:5120
s_addc_u32 s37, s67, 0
s_and_b32 s37, s37, 0xffff
s_mov_b32 s38, 4096
s_mov_b32 s39, 0x20000
buffer_load_dwordx4 v[190:193], v4, s[36:39], 0 offen
buffer_load_dword v194, v4, s[36:39], 0 offen offset:16
s_add_u32 s6, s88, 2
s_lshl_b32 s6, s6, 12
v_mfma_f32_32x32x16_bf16 v[112:127], v[132:135], v[140:143], v[112:127]
s_add_u32 s6, s6, 1048576
s_add_u32 s36, s66, s6
s_addc_u32 s37, s67, 0
s_and_b32 s37, s37, 0xffff
s_mov_b32 s38, 4096
s_mov_b32 s39, 0x20000
buffer_load_dwordx4 v[196:199], v4, s[36:39], 0 offen
buffer_load_dword v200, v4, s[36:39], 0 offen offset:16
s_waitcnt lgkmcnt(3)
v_mfma_f32_32x32x16_bf16 v[64:79], v[144:147], v[152:155], v[64:79]
ds_read_b64_tr_b16 v[128:129], v216 offset:8192
ds_read_b64_tr_b16 v[130:131], v216 offset:9216
s_add_u32 s6, s88, 0
s_lshl_b32 s6, s6, 12
s_add_u32 s32, s48, s6
s_addc_u32 s33, s49, 0
s_waitcnt lgkmcnt(4)
v_mfma_f32_32x32x16_bf16 v[80:95], v[144:147], v[156:159], v[80:95]
ds_read_b128 v[136:139], v222 offset:16384
ds_read_b128 v[140:143], v222 offset:20480
s_and_b32 s33, s33, 0xffff
s_mov_b32 s34, 4096
s_mov_b32 s35, 0x20000
s_add_u32 m0, s90, 65536
s_waitcnt lgkmcnt(4)
v_mfma_f32_32x32x16_bf16 v[96:111], v[148:151], v[152:155], v[96:111]
ds_read_b64_tr_b16 v[132:133], v217 offset:8192
ds_read_b64_tr_b16 v[134:135], v217 offset:9216
s_nop 0
buffer_load_dword v202, s[32:35], 0 offen lds
s_add_u32 m0, s90, 65792
s_nop 0
v_mfma_f32_32x32x16_bf16 v[112:127], v[148:151], v[156:159], v[112:127]
buffer_load_dwordx4 v203, s[32:35], 0 offen offset:0 lds
buffer_load_dwordx4 v203, s[32:35], 0 offen offset:1024 lds
buffer_load_dwordx4 v203, s[32:35], 0 offen offset:2048 lds
buffer_load_dwordx4 v203, s[32:35], 0 offen offset:3072 lds
s_waitcnt lgkmcnt(3)
v_mfma_f32_32x32x16_bf16 v[64:79], v[128:131], v[136:139], v[64:79]
ds_read_b64_tr_b16 v[144:145], v216 offset:12288
ds_read_b64_tr_b16 v[146:147], v216 offset:13312
s_add_u32 s6, s88, 1
s_lshl_b32 s6, s6, 12
s_add_u32 s32, s48, s6
s_addc_u32 s33, s49, 0
s_waitcnt lgkmcnt(4)
v_mfma_f32_32x32x16_bf16 v[80:95], v[128:131], v[140:143], v[80:95]
ds_read_b128 v[152:155], v223 offset:16384
ds_read_b128 v[156:159], v223 offset:20480
s_and_b32 s33, s33, 0xffff
s_mov_b32 s34, 4096
s_mov_b32 s35, 0x20000
s_add_u32 m0, s90, 95744
s_waitcnt lgkmcnt(4)
v_mfma_f32_32x32x16_bf16 v[96:111], v[132:135], v[136:139], v[96:111]
ds_read_b64_tr_b16 v[148:149], v217 offset:12288
ds_read_b64_tr_b16 v[150:151], v217 offset:13312
s_nop 0
buffer_load_dword v202, s[32:35], 0 offen lds
s_add_u32 m0, s90, 96000
s_nop 0
v_mfma_f32_32x32x16_bf16 v[112:127], v[132:135], v[140:143], v[112:127]
buffer_load_dwordx4 v203, s[32:35], 0 offen offset:0 lds
buffer_load_dwordx4 v203, s[32:35], 0 offen offset:1024 lds
buffer_load_dwordx4 v203, s[32:35], 0 offen offset:2048 lds
buffer_load_dwordx4 v203, s[32:35], 0 offen offset:3072 lds
s_waitcnt lgkmcnt(0)
s_waitcnt vmcnt(26)
s_barrier
v_mfma_f32_32x32x16_bf16 v[64:79], v[144:147], v[152:155], v[64:79]
ds_read_b64_tr_b16 v[128:129], v216 offset:32768
ds_read_b64_tr_b16 v[130:131], v216 offset:33792
v_mfma_f32_32x32x16_bf16 v[80:95], v[144:147], v[156:159], v[80:95]
ds_read_b128 v[136:139], v220 offset:49152
ds_read_b128 v[140:143], v220 offset:53248
v_mfma_f32_32x32x16_bf16 v[96:111], v[148:151], v[152:155], v[96:111]
ds_read_b64_tr_b16 v[132:133], v217 offset:32768
ds_read_b64_tr_b16 v[134:135], v217 offset:33792
v_mfma_f32_32x32x16_bf16 v[112:127], v[148:151], v[156:159], v[112:127]
s_waitcnt lgkmcnt(3)
v_mfma_f32_32x32x16_bf16 v[64:79], v[128:131], v[136:139], v[64:79]
ds_read_b64_tr_b16 v[144:145], v216 offset:36864
ds_read_b64_tr_b16 v[146:147], v216 offset:37888
s_add_u32 s6, s88, 2
s_lshl_b32 s6, s6, 12
s_add_u32 s32, s48, s6
s_addc_u32 s33, s49, 0
s_waitcnt lgkmcnt(4)
v_mfma_f32_32x32x16_bf16 v[80:95], v[128:131], v[140:143], v[80:95]
ds_read_b128 v[152:155], v221 offset:49152
ds_read_b128 v[156:159], v221 offset:53248
s_and_b32 s33, s33, 0xffff
s_mov_b32 s34, 4096
s_mov_b32 s35, 0x20000
s_add_u32 m0, s90, 125952
s_waitcnt lgkmcnt(4)
v_mfma_f32_32x32x16_bf16 v[96:111], v[132:135], v[136:139], v[96:111]
ds_read_b64_tr_b16 v[148:149], v217 offset:36864
ds_read_b64_tr_b16 v[150:151], v217 offset:37888
s_nop 0
buffer_load_dword v202, s[32:35], 0 offen lds
s_add_u32 m0, s90, 126208
s_nop 0
v_mfma_f32_32x32x16_bf16 v[112:127], v[132:135], v[140:143], v[112:127]
buffer_load_dwordx4 v203, s[32:35], 0 offen offset:0 lds
buffer_load_dwordx4 v203, s[32:35], 0 offen offset:1024 lds
buffer_load_dwordx4 v203, s[32:35], 0 offen offset:2048 lds
buffer_load_dwordx4 v203, s[32:35], 0 offen offset:3072 lds
s_waitcnt lgkmcnt(3)
v_mfma_f32_32x32x16_bf16 v[64:79], v[144:147], v[152:155], v[64:79]
ds_read_b64_tr_b16 v[128:129], v216 offset:40960
ds_read_b64_tr_b16 v[130:131], v216 offset:41984
s_waitcnt lgkmcnt(4)
v_mfma_f32_32x32x16_bf16 v[80:95], v[144:147], v[156:159], v[80:95]
ds_read_b128 v[136:139], v222 offset:49152
ds_read_b128 v[140:143], v222 offset:53248
s_waitcnt lgkmcnt(4)
v_mfma_f32_32x32x16_bf16 v[96:111], v[148:151], v[152:155], v[96:111]
ds_read_b64_tr_b16 v[132:133], v217 offset:40960
ds_read_b64_tr_b16 v[134:135], v217 offset:41984
v_mfma_f32_32x32x16_bf16 v[112:127], v[148:151], v[156:159], v[112:127]
s_waitcnt lgkmcnt(3)
v_mfma_f32_32x32x16_bf16 v[64:79], v[128:131], v[136:139], v[64:79]
ds_read_b64_tr_b16 v[144:145], v216 offset:45056
ds_read_b64_tr_b16 v[146:147], v216 offset:46080
s_waitcnt lgkmcnt(4)
v_mfma_f32_32x32x16_bf16 v[80:95], v[128:131], v[140:143], v[80:95]
ds_read_b128 v[152:155], v223 offset:49152
ds_read_b128 v[156:159], v223 offset:53248
s_waitcnt lgkmcnt(4)
v_mfma_f32_32x32x16_bf16 v[96:111], v[132:135], v[136:139], v[96:111]
ds_read_b64_tr_b16 v[148:149], v217 offset:45056
ds_read_b64_tr_b16 v[150:151], v217 offset:46080
v_mfma_f32_32x32x16_bf16 v[112:127], v[132:135], v[140:143], v[112:127]
s_waitcnt lgkmcnt(3)
v_mfma_f32_32x32x16_bf16 v[64:79], v[144:147], v[152:155], v[64:79]
s_waitcnt lgkmcnt(2)
v_mfma_f32_32x32x16_bf16 v[80:95], v[144:147], v[156:159], v[80:95]
s_waitcnt lgkmcnt(0)
v_mfma_f32_32x32x16_bf16 v[96:111], v[148:151], v[152:155], v[96:111]
v_mfma_f32_32x32x16_bf16 v[112:127], v[148:151], v[156:159], v[112:127]
v_mfma_f32_32x32x16_bf16 v[64:79], v[28:31], v[36:39], v[64:79]
v_mfma_f32_32x32x16_bf16 v[80:95], v[28:31], v[40:43], v[80:95]
v_mfma_f32_32x32x16_bf16 v[96:111], v[32:35], v[36:39], v[96:111]
v_mfma_f32_32x32x16_bf16 v[112:127], v[32:35], v[40:43], v[112:127]
v_mul_f32 v52, -2.302208198144325, v45
v_mul_f32 v2, v45, v45
v_mul_f32 v2, v2, v45
v_mul_f32 v53, -0.1029432395800235, v2
v_mov_b32 v54, v46
v_mov_b32 v55, v46
v_mul_f32 v56, -2.302208198144325, v49
v_mul_f32 v2, v49, v49
v_mul_f32 v2, v2, v49
v_mul_f32 v57, -0.1029432395800235, v2
v_mov_b32 v58, v50
v_mov_b32 v59, v50
v_and_b32 v2, 15, v1
v_lshrrev_b32 v3, 3, v2
v_lshlrev_b32 v3, 3, v3
v_and_b32 v4, 1, v2
v_lshl_or_b32 v3, v4, 2, v3
v_bfe_u32 v4, v2, 1, 2
v_or_b32 v3, v3, v4
v_lshlrev_b32 v3, 4, v3
v_bfe_u32 v4, v1, 4, 1
v_lshl_or_b32 v3, v4, 10, v3
v_lshrrev_b32 v4, 5, v1
v_lshl_or_b32 v3, v4, 8, v3
v_mov_b32 v4, 2147418112
s_cmp_eq_u32 s101, 0
s_cselect_b64 vcc, -1, 0
v_cndmask_b32 v60, v3, v4, vcc
s_lshl_b32 s6, s77, 1
s_add_u32 s6, s6, s83
s_mul_i32 s6, s6, 54
s_lshl_b32 s7, s78, 2
s_add_u32 s6, s6, s7
s_lshl_b32 s7, s82, 1
s_add_u32 s6, s6, s7
s_lshl_b32 s6, s6, 12
s_add_u32 s100, s6, 10485760
s_add_u32 s101, s100, 4096
buffer_load_dwordx4 a[40:43], v248, s[24:27], s97 offen offset:0
buffer_load_dwordx4 a[44:47], v248, s[24:27], s97 offen offset:1024
buffer_load_dwordx4 a[48:51], v248, s[24:27], s97 offen offset:2048
v_pk_mul_f32 v[160:161], v[64:65], v[64:65]
v_pk_mul_f32 v[162:163], v[66:67], v[66:67]
v_pk_mul_f32 v[164:165], v[68:69], v[68:69]
v_pk_mul_f32 v[166:167], v[70:71], v[70:71]
v_pk_fma_f32 v[160:161], v[160:161], v[52:53], v[52:53] op_sel:[0,1,0] op_sel_hi:[1,1,0]
v_pk_fma_f32 v[162:163], v[162:163], v[52:53], v[52:53] op_sel:[0,1,0] op_sel_hi:[1,1,0]
v_pk_fma_f32 v[164:165], v[164:165], v[52:53], v[52:53] op_sel:[0,1,0] op_sel_hi:[1,1,0]
v_pk_fma_f32 v[166:167], v[166:167], v[52:53], v[52:53] op_sel:[0,1,0] op_sel_hi:[1,1,0]
v_pk_mul_f32 v[160:161], v[160:161], v[64:65]
v_pk_mul_f32 v[162:163], v[162:163], v[66:67]
v_pk_mul_f32 v[164:165], v[164:165], v[68:69]
v_pk_mul_f32 v[166:167], v[166:167], v[70:71]
v_exp_f32 v160, v160
v_exp_f32 v161, v161
v_exp_f32 v162, v162
v_exp_f32 v163, v163
v_exp_f32 v164, v164
v_exp_f32 v165, v165
v_exp_f32 v166, v166
v_exp_f32 v167, v167
v_pk_fma_f32 v[160:161], v[160:161], v[54:55], v[54:55]
v_pk_fma_f32 v[162:163], v[162:163], v[54:55], v[54:55]
v_pk_fma_f32 v[164:165], v[164:165], v[54:55], v[54:55]
v_pk_fma_f32 v[166:167], v[166:167], v[54:55], v[54:55]
v_rcp_f32 v160, v160
v_rcp_f32 v161, v161
v_rcp_f32 v162, v162
v_rcp_f32 v163, v163
v_rcp_f32 v164, v164
v_rcp_f32 v165, v165
v_rcp_f32 v166, v166
v_rcp_f32 v167, v167
v_pk_mul_f32 v[160:161], v[160:161], v[64:65]
v_pk_mul_f32 v[162:163], v[162:163], v[66:67]
v_pk_mul_f32 v[164:165], v[164:165], v[68:69]
v_pk_mul_f32 v[166:167], v[166:167], v[70:71]
v_cvt_pk_bf16_f32 v168, v160, v161
v_cvt_pk_bf16_f32 v169, v162, v163
v_cvt_pk_bf16_f32 v170, v164, v165
v_cvt_pk_bf16_f32 v171, v166, v167
buffer_store_dwordx4 v[168:171], v60, s[24:27], s100 offen offset:0 sc1
buffer_load_dwordx4 a[52:55], v248, s[24:27], s97 offen offset:3072
buffer_load_dwordx4 a[56:59], v248, s[24:27], s98 offen
s_add_u32 s97, s97, 5120
s_add_u32 s98, s98, 5120
buffer_load_dwordx4 a[60:63], v248, s[24:27], s97 offen offset:0
v_pk_mul_f32 v[160:161], v[72:73], v[72:73]
v_pk_mul_f32 v[162:163], v[74:75], v[74:75]
v_pk_mul_f32 v[164:165], v[76:77], v[76:77]
v_pk_mul_f32 v[166:167], v[78:79], v[78:79]
v_pk_fma_f32 v[160:161], v[160:161], v[52:53], v[52:53] op_sel:[0,1,0] op_sel_hi:[1,1,0]
v_pk_fma_f32 v[162:163], v[162:163], v[52:53], v[52:53] op_sel:[0,1,0] op_sel_hi:[1,1,0]
v_pk_fma_f32 v[164:165], v[164:165], v[52:53], v[52:53] op_sel:[0,1,0] op_sel_hi:[1,1,0]
v_pk_fma_f32 v[166:167], v[166:167], v[52:53], v[52:53] op_sel:[0,1,0] op_sel_hi:[1,1,0]
v_pk_mul_f32 v[160:161], v[160:161], v[72:73]
v_pk_mul_f32 v[162:163], v[162:163], v[74:75]
v_pk_mul_f32 v[164:165], v[164:165], v[76:77]
v_pk_mul_f32 v[166:167], v[166:167], v[78:79]
v_exp_f32 v160, v160
v_exp_f32 v161, v161
v_exp_f32 v162, v162
v_exp_f32 v163, v163
v_exp_f32 v164, v164
v_exp_f32 v165, v165
v_exp_f32 v166, v166
v_exp_f32 v167, v167
v_pk_fma_f32 v[160:161], v[160:161], v[54:55], v[54:55]
v_pk_fma_f32 v[162:163], v[162:163], v[54:55], v[54:55]
v_pk_fma_f32 v[164:165], v[164:165], v[54:55], v[54:55]
v_pk_fma_f32 v[166:167], v[166:167], v[54:55], v[54:55]
v_rcp_f32 v160, v160
v_rcp_f32 v161, v161
v_rcp_f32 v162, v162
v_rcp_f32 v163, v163
v_rcp_f32 v164, v164
v_rcp_f32 v165, v165
v_rcp_f32 v166, v166
v_rcp_f32 v167, v167
v_pk_mul_f32 v[160:161], v[160:161], v[72:73]
v_pk_mul_f32 v[162:163], v[162:163], v[74:75]
v_pk_mul_f32 v[164:165], v[164:165], v[76:77]
v_pk_mul_f32 v[166:167], v[166:167], v[78:79]
v_cvt_pk_bf16_f32 v172, v160, v161
v_cvt_pk_bf16_f32 v173, v162, v163
v_cvt_pk_bf16_f32 v174, v164, v165
v_cvt_pk_bf16_f32 v175, v166, v167
buffer_store_dwordx4 v[172:175], v60, s[24:27], s100 offen offset:512 sc1
v_lshlrev_b32 v5, 4, v0
v_add_u32 v5, 87552, v5
v_add_u32 v7, 60416, v5
v_mov_b32 v12, 0
v_mov_b32 v13, 0
v_mov_b32 v14, 0
v_mov_b32 v15, 0
v_cmp_gt_u32 vcc, 119, v0
s_and_saveexec_b64 s[6:7], vcc
ds_write_b128 v5, v[12:15] offset:0
ds_write_b128 v5, v[12:15] offset:6272
ds_write_b128 v5, v[12:15] offset:30208
ds_write_b128 v5, v[12:15] offset:36480
ds_write_b128 v7, v[12:15] offset:0
ds_write_b128 v7, v[12:15] offset:6272
s_mov_b64 exec, s[6:7]
v_lshrrev_b32 v4, 4, v0
v_mul_u32_u24 v4, 272, v4
v_and_b32 v5, 15, v0
v_lshl_add_u32 v4, v5, 4, v4
v_add_u32 v4, 83200, v4
v_add_u32 v6, 60416, v4
s_waitcnt vmcnt(23)
ds_write_b128 v4, v[184:187] offset:6272
v_alignbit_b32 v12, v185, v184, 16
v_alignbit_b32 v13, v186, v185, 16
v_alignbit_b32 v14, v187, v186, 16
v_alignbit_b32 v15, v188, v187, 16
ds_write_b128 v4, v[12:15] offset:0
ds_write_b128 v4, v[190:193] offset:36480
v_alignbit_b32 v12, v191, v190, 16
v_alignbit_b32 v13, v192, v191, 16
v_alignbit_b32 v14, v193, v192, 16
v_alignbit_b32 v15, v194, v193, 16
ds_write_b128 v4, v[12:15] offset:30208
ds_write_b128 v6, v[196:199] offset:6272
v_alignbit_b32 v12, v197, v196, 16
v_alignbit_b32 v13, v198, v197, 16
v_alignbit_b32 v14, v199, v198, 16
v_alignbit_b32 v15, v200, v199, 16
ds_write_b128 v6, v[12:15] offset:0
buffer_load_dwordx4 a[64:67], v248, s[24:27], s97 offen offset:1024
buffer_load_dwordx4 a[68:71], v248, s[24:27], s97 offen offset:2048
buffer_load_dwordx4 a[72:75], v248, s[24:27], s97 offen offset:3072
v_pk_mul_f32 v[160:161], v[80:81], v[80:81]
v_pk_mul_f32 v[162:163], v[82:83], v[82:83]
v_pk_mul_f32 v[164:165], v[84:85], v[84:85]
v_pk_mul_f32 v[166:167], v[86:87], v[86:87]
v_pk_fma_f32 v[160:161], v[160:161], v[56:57], v[56:57] op_sel:[0,1,0] op_sel_hi:[1,1,0]
v_pk_fma_f32 v[162:163], v[162:163], v[56:57], v[56:57] op_sel:[0,1,0] op_sel_hi:[1,1,0]
v_pk_fma_f32 v[164:165], v[164:165], v[56:57], v[56:57] op_sel:[0,1,0] op_sel_hi:[1,1,0]
v_pk_fma_f32 v[166:167], v[166:167], v[56:57], v[56:57] op_sel:[0,1,0] op_sel_hi:[1,1,0]
v_pk_mul_f32 v[160:161], v[160:161], v[80:81]
v_pk_mul_f32 v[162:163], v[162:163], v[82:83]
v_pk_mul_f32 v[164:165], v[164:165], v[84:85]
v_pk_mul_f32 v[166:167], v[166:167], v[86:87]
v_exp_f32 v160, v160
v_exp_f32 v161, v161
v_exp_f32 v162, v162
v_exp_f32 v163, v163
v_exp_f32 v164, v164
v_exp_f32 v165, v165
v_exp_f32 v166, v166
v_exp_f32 v167, v167
v_pk_fma_f32 v[160:161], v[160:161], v[58:59], v[58:59]
v_pk_fma_f32 v[162:163], v[162:163], v[58:59], v[58:59]
v_pk_fma_f32 v[164:165], v[164:165], v[58:59], v[58:59]
v_pk_fma_f32 v[166:167], v[166:167], v[58:59], v[58:59]
v_rcp_f32 v160, v160
v_rcp_f32 v161, v161
v_rcp_f32 v162, v162
v_rcp_f32 v163, v163
v_rcp_f32 v164, v164
v_rcp_f32 v165, v165
v_rcp_f32 v166, v166
v_rcp_f32 v167, v167
v_pk_mul_f32 v[160:161], v[160:161], v[80:81]
v_pk_mul_f32 v[162:163], v[162:163], v[82:83]
v_pk_mul_f32 v[164:165], v[164:165], v[84:85]
v_pk_mul_f32 v[166:167], v[166:167], v[86:87]
v_cvt_pk_bf16_f32 v176, v160, v161
v_cvt_pk_bf16_f32 v177, v162, v163
v_cvt_pk_bf16_f32 v178, v164, v165
v_cvt_pk_bf16_f32 v179, v166, v167
buffer_store_dwordx4 v[176:179], v60, s[24:27], s100 offen offset:2048 sc1
buffer_load_dwordx4 a[76:79], v248, s[24:27], s98 offen
s_add_u32 s97, s97, 5120
s_add_u32 s98, s98, 5120
buffer_load_dwordx4 a[80:83], v248, s[24:27], s97 offen offset:0
buffer_load_dwordx4 a[84:87], v248, s[24:27], s97 offen offset:1024
v_pk_mul_f32 v[160:161], v[88:89], v[88:89]
v_pk_mul_f32 v[162:163], v[90:91], v[90:91]
v_pk_mul_f32 v[164:165], v[92:93], v[92:93]
v_pk_mul_f32 v[166:167], v[94:95], v[94:95]
v_pk_fma_f32 v[160:161], v[160:161], v[56:57], v[56:57] op_sel:[0,1,0] op_sel_hi:[1,1,0]
v_pk_fma_f32 v[162:163], v[162:163], v[56:57], v[56:57] op_sel:[0,1,0] op_sel_hi:[1,1,0]
v_pk_fma_f32 v[164:165], v[164:165], v[56:57], v[56:57] op_sel:[0,1,0] op_sel_hi:[1,1,0]
v_pk_fma_f32 v[166:167], v[166:167], v[56:57], v[56:57] op_sel:[0,1,0] op_sel_hi:[1,1,0]
v_pk_mul_f32 v[160:161], v[160:161], v[88:89]
v_pk_mul_f32 v[162:163], v[162:163], v[90:91]
v_pk_mul_f32 v[164:165], v[164:165], v[92:93]
v_pk_mul_f32 v[166:167], v[166:167], v[94:95]
v_exp_f32 v160, v160
v_exp_f32 v161, v161
v_exp_f32 v162, v162
v_exp_f32 v163, v163
v_exp_f32 v164, v164
v_exp_f32 v165, v165
v_exp_f32 v166, v166
v_exp_f32 v167, v167
v_pk_fma_f32 v[160:161], v[160:161], v[58:59], v[58:59]
v_pk_fma_f32 v[162:163], v[162:163], v[58:59], v[58:59]
v_pk_fma_f32 v[164:165], v[164:165], v[58:59], v[58:59]
v_pk_fma_f32 v[166:167], v[166:167], v[58:59], v[58:59]
v_rcp_f32 v160, v160
v_rcp_f32 v161, v161
v_rcp_f32 v162, v162
v_rcp_f32 v163, v163
v_rcp_f32 v164, v164
v_rcp_f32 v165, v165
v_rcp_f32 v166, v166
v_rcp_f32 v167, v167
v_pk_mul_f32 v[160:161], v[160:161], v[88:89]
v_pk_mul_f32 v[162:163], v[162:163], v[90:91]
v_pk_mul_f32 v[164:165], v[164:165], v[92:93]
v_pk_mul_f32 v[166:167], v[166:167], v[94:95]
v_cvt_pk_bf16_f32 v180, v160, v161
v_cvt_pk_bf16_f32 v181, v162, v163
v_cvt_pk_bf16_f32 v182, v164, v165
v_cvt_pk_bf16_f32 v183, v166, v167
buffer_store_dwordx4 v[180:183], v60, s[24:27], s100 offen offset:2560 sc1
buffer_load_dwordx4 a[88:91], v248, s[24:27], s97 offen offset:2048
buffer_load_dwordx4 a[92:95], v248, s[24:27], s97 offen offset:3072
buffer_load_dwordx4 a[96:99], v248, s[24:27], s98 offen
s_add_u32 s97, s97, 5120
s_add_u32 s98, s98, 5120
v_pk_mul_f32 v[160:161], v[96:97], v[96:97]
v_pk_mul_f32 v[162:163], v[98:99], v[98:99]
v_pk_mul_f32 v[164:165], v[100:101], v[100:101]
v_pk_mul_f32 v[166:167], v[102:103], v[102:103]
v_pk_fma_f32 v[160:161], v[160:161], v[52:53], v[52:53] op_sel:[0,1,0] op_sel_hi:[1,1,0]
v_pk_fma_f32 v[162:163], v[162:163], v[52:53], v[52:53] op_sel:[0,1,0] op_sel_hi:[1,1,0]
v_pk_fma_f32 v[164:165], v[164:165], v[52:53], v[52:53] op_sel:[0,1,0] op_sel_hi:[1,1,0]
v_pk_fma_f32 v[166:167], v[166:167], v[52:53], v[52:53] op_sel:[0,1,0] op_sel_hi:[1,1,0]
v_pk_mul_f32 v[160:161], v[160:161], v[96:97]
v_pk_mul_f32 v[162:163], v[162:163], v[98:99]
v_pk_mul_f32 v[164:165], v[164:165], v[100:101]
v_pk_mul_f32 v[166:167], v[166:167], v[102:103]
v_exp_f32 v160, v160
v_exp_f32 v161, v161
v_exp_f32 v162, v162
v_exp_f32 v163, v163
v_exp_f32 v164, v164
v_exp_f32 v165, v165
v_exp_f32 v166, v166
v_exp_f32 v167, v167
v_pk_fma_f32 v[160:161], v[160:161], v[54:55], v[54:55]
v_pk_fma_f32 v[162:163], v[162:163], v[54:55], v[54:55]
v_pk_fma_f32 v[164:165], v[164:165], v[54:55], v[54:55]
v_pk_fma_f32 v[166:167], v[166:167], v[54:55], v[54:55]
v_rcp_f32 v160, v160
v_rcp_f32 v161, v161
v_rcp_f32 v162, v162
v_rcp_f32 v163, v163
v_rcp_f32 v164, v164
v_rcp_f32 v165, v165
v_rcp_f32 v166, v166
v_rcp_f32 v167, v167
v_pk_mul_f32 v[160:161], v[160:161], v[96:97]
v_pk_mul_f32 v[162:163], v[162:163], v[98:99]
v_pk_mul_f32 v[164:165], v[164:165], v[100:101]
v_pk_mul_f32 v[166:167], v[166:167], v[102:103]
v_cvt_pk_bf16_f32 v168, v160, v161
v_cvt_pk_bf16_f32 v169, v162, v163
v_cvt_pk_bf16_f32 v170, v164, v165
v_cvt_pk_bf16_f32 v171, v166, v167
buffer_store_dwordx4 v[168:171], v60, s[24:27], s101 offen offset:0 sc1
buffer_load_dwordx4 a[100:103], v248, s[24:27], s97 offen offset:0
buffer_load_dwordx4 a[104:107], v248, s[24:27], s97 offen offset:1024
buffer_load_dwordx4 a[108:111], v248, s[24:27], s97 offen offset:2048
v_pk_mul_f32 v[160:161], v[104:105], v[104:105]
v_pk_mul_f32 v[162:163], v[106:107], v[106:107]
v_pk_mul_f32 v[164:165], v[108:109], v[108:109]
v_pk_mul_f32 v[166:167], v[110:111], v[110:111]
v_pk_fma_f32 v[160:161], v[160:161], v[52:53], v[52:53] op_sel:[0,1,0] op_sel_hi:[1,1,0]
v_pk_fma_f32 v[162:163], v[162:163], v[52:53], v[52:53] op_sel:[0,1,0] op_sel_hi:[1,1,0]
v_pk_fma_f32 v[164:165], v[164:165], v[52:53], v[52:53] op_sel:[0,1,0] op_sel_hi:[1,1,0]
v_pk_fma_f32 v[166:167], v[166:167], v[52:53], v[52:53] op_sel:[0,1,0] op_sel_hi:[1,1,0]
v_pk_mul_f32 v[160:161], v[160:161], v[104:105]
v_pk_mul_f32 v[162:163], v[162:163], v[106:107]
v_pk_mul_f32 v[164:165], v[164:165], v[108:109]
v_pk_mul_f32 v[166:167], v[166:167], v[110:111]
v_exp_f32 v160, v160
v_exp_f32 v161, v161
v_exp_f32 v162, v162
v_exp_f32 v163, v163
v_exp_f32 v164, v164
v_exp_f32 v165, v165
v_exp_f32 v166, v166
v_exp_f32 v167, v167
v_pk_fma_f32 v[160:161], v[160:161], v[54:55], v[54:55]
v_pk_fma_f32 v[162:163], v[162:163], v[54:55], v[54:55]
v_pk_fma_f32 v[164:165], v[164:165], v[54:55], v[54:55]
v_pk_fma_f32 v[166:167], v[166:167], v[54:55], v[54:55]
v_rcp_f32 v160, v160
v_rcp_f32 v161, v161
v_rcp_f32 v162, v162
v_rcp_f32 v163, v163
v_rcp_f32 v164, v164
v_rcp_f32 v165, v165
v_rcp_f32 v166, v166
v_rcp_f32 v167, v167
v_pk_mul_f32 v[160:161], v[160:161], v[104:105]
v_pk_mul_f32 v[162:163], v[162:163], v[106:107]
v_pk_mul_f32 v[164:165], v[164:165], v[108:109]
v_pk_mul_f32 v[166:167], v[166:167], v[110:111]
v_cvt_pk_bf16_f32 v172, v160, v161
v_cvt_pk_bf16_f32 v173, v162, v163
v_cvt_pk_bf16_f32 v174, v164, v165
v_cvt_pk_bf16_f32 v175, v166, v167
buffer_store_dwordx4 v[172:175], v60, s[24:27], s101 offen offset:512 sc1
buffer_load_dwordx4 a[112:115], v248, s[24:27], s97 offen offset:3072
buffer_load_dwordx4 a[116:119], v248, s[24:27], s98 offen
s_add_u32 s97, s97, 5120
s_add_u32 s98, s98, 5120
buffer_load_dwordx4 a[120:123], v248, s[24:27], s97 offen offset:0
v_pk_mul_f32 v[160:161], v[112:113], v[112:113]
v_pk_mul_f32 v[162:163], v[114:115], v[114:115]
v_pk_mul_f32 v[164:165], v[116:117], v[116:117]
v_pk_mul_f32 v[166:167], v[118:119], v[118:119]
v_pk_fma_f32 v[160:161], v[160:161], v[56:57], v[56:57] op_sel:[0,1,0] op_sel_hi:[1,1,0]
v_pk_fma_f32 v[162:163], v[162:163], v[56:57], v[56:57] op_sel:[0,1,0] op_sel_hi:[1,1,0]
v_pk_fma_f32 v[164:165], v[164:165], v[56:57], v[56:57] op_sel:[0,1,0] op_sel_hi:[1,1,0]
v_pk_fma_f32 v[166:167], v[166:167], v[56:57], v[56:57] op_sel:[0,1,0] op_sel_hi:[1,1,0]
v_pk_mul_f32 v[160:161], v[160:161], v[112:113]
v_pk_mul_f32 v[162:163], v[162:163], v[114:115]
v_pk_mul_f32 v[164:165], v[164:165], v[116:117]
v_pk_mul_f32 v[166:167], v[166:167], v[118:119]
v_exp_f32 v160, v160
v_exp_f32 v161, v161
v_exp_f32 v162, v162
v_exp_f32 v163, v163
v_exp_f32 v164, v164
v_exp_f32 v165, v165
v_exp_f32 v166, v166
v_exp_f32 v167, v167
v_pk_fma_f32 v[160:161], v[160:161], v[58:59], v[58:59]
v_pk_fma_f32 v[162:163], v[162:163], v[58:59], v[58:59]
v_pk_fma_f32 v[164:165], v[164:165], v[58:59], v[58:59]
v_pk_fma_f32 v[166:167], v[166:167], v[58:59], v[58:59]
v_rcp_f32 v160, v160
v_rcp_f32 v161, v161
v_rcp_f32 v162, v162
v_rcp_f32 v163, v163
v_rcp_f32 v164, v164
v_rcp_f32 v165, v165
v_rcp_f32 v166, v166
v_rcp_f32 v167, v167
v_pk_mul_f32 v[160:161], v[160:161], v[112:113]
v_pk_mul_f32 v[162:163], v[162:163], v[114:115]
v_pk_mul_f32 v[164:165], v[164:165], v[116:117]
v_pk_mul_f32 v[166:167], v[166:167], v[118:119]
v_cvt_pk_bf16_f32 v176, v160, v161
v_cvt_pk_bf16_f32 v177, v162, v163
v_cvt_pk_bf16_f32 v178, v164, v165
v_cvt_pk_bf16_f32 v179, v166, v167
buffer_store_dwordx4 v[176:179], v60, s[24:27], s101 offen offset:2048 sc1
buffer_load_dwordx4 a[124:127], v248, s[24:27], s97 offen offset:1024
buffer_load_dwordx4 a[128:131], v248, s[24:27], s97 offen offset:2048
buffer_load_dwordx4 a[132:135], v248, s[24:27], s97 offen offset:3072
v_pk_mul_f32 v[160:161], v[120:121], v[120:121]
v_pk_mul_f32 v[162:163], v[122:123], v[122:123]
v_pk_mul_f32 v[164:165], v[124:125], v[124:125]
v_pk_mul_f32 v[166:167], v[126:127], v[126:127]
v_pk_fma_f32 v[160:161], v[160:161], v[56:57], v[56:57] op_sel:[0,1,0] op_sel_hi:[1,1,0]
v_pk_fma_f32 v[162:163], v[162:163], v[56:57], v[56:57] op_sel:[0,1,0] op_sel_hi:[1,1,0]
v_pk_fma_f32 v[164:165], v[164:165], v[56:57], v[56:57] op_sel:[0,1,0] op_sel_hi:[1,1,0]
v_pk_fma_f32 v[166:167], v[166:167], v[56:57], v[56:57] op_sel:[0,1,0] op_sel_hi:[1,1,0]
v_pk_mul_f32 v[160:161], v[160:161], v[120:121]
v_pk_mul_f32 v[162:163], v[162:163], v[122:123]
v_pk_mul_f32 v[164:165], v[164:165], v[124:125]
v_pk_mul_f32 v[166:167], v[166:167], v[126:127]
v_exp_f32 v160, v160
v_exp_f32 v161, v161
v_exp_f32 v162, v162
v_exp_f32 v163, v163
v_exp_f32 v164, v164
v_exp_f32 v165, v165
v_exp_f32 v166, v166
v_exp_f32 v167, v167
v_pk_fma_f32 v[160:161], v[160:161], v[58:59], v[58:59]
v_pk_fma_f32 v[162:163], v[162:163], v[58:59], v[58:59]
v_pk_fma_f32 v[164:165], v[164:165], v[58:59], v[58:59]
v_pk_fma_f32 v[166:167], v[166:167], v[58:59], v[58:59]
v_rcp_f32 v160, v160
v_rcp_f32 v161, v161
v_rcp_f32 v162, v162
v_rcp_f32 v163, v163
v_rcp_f32 v164, v164
v_rcp_f32 v165, v165
v_rcp_f32 v166, v166
v_rcp_f32 v167, v167
v_pk_mul_f32 v[160:161], v[160:161], v[120:121]
v_pk_mul_f32 v[162:163], v[162:163], v[122:123]
v_pk_mul_f32 v[164:165], v[164:165], v[124:125]
v_pk_mul_f32 v[166:167], v[166:167], v[126:127]
v_cvt_pk_bf16_f32 v180, v160, v161
v_cvt_pk_bf16_f32 v181, v162, v163
v_cvt_pk_bf16_f32 v182, v164, v165
v_cvt_pk_bf16_f32 v183, v166, v167
buffer_store_dwordx4 v[180:183], v60, s[24:27], s101 offen offset:2560 sc1
s_waitcnt vmcnt(32)
L_conv:
s_lshl_b32 s6, s89, 2
s_add_u32 s6, s6, s5
s_lshl_b32 s7, s6, 1
s_lshr_b32 s85, 6436, s7
s_and_b32 s85, s85, 3
s_lshr_b32 s86, 55, s6
s_and_b32 s86, s86, 1
s_lshr_b32 s87, 61311, s7
s_and_b32 s87, s87, 3
v_and_b32 v2, 3, v1
v_mul_u32_u24 v2, 4416, v2
v_bfe_u32 v3, v1, 2, 2
v_lshrrev_b32 v18, 4, v1
v_add_u32 v3, v3, v18
v_lshl_add_u32 v16, v3, 4, v2
v_and_b32 v2, 1, v1
v_mul_u32_u24 v2, 6272, v2
v_bfe_u32 v3, v1, 1, 3
s_lshl_b32 s6, s86, 3
s_sub_u32 s6, 15, s6
v_sub_u32 v5, s6, v3
v_mul_u32_u24 v5, 272, v5
v_add_u32 v2, v2, v5
v_lshl_add_u32 v17, v18, 4, v2
s_lshl_b32 s6, s86, 3
v_add_u32 v3, s6, v3
v_lshlrev_b32 v3, 8, v3
v_and_b32 v2, 1, v1
v_lshl_or_b32 v2, v18, 1, v2
v_lshl_or_b32 v11, v2, 4, v3
s_mul_i32 s6, s85, 30208
s_add_u32 s6, s6, 65536
v_add_u32 v8, s6, v16
s_add_u32 s6, s6, 17664
v_add_u32 v9, s6, v17
v_lshlrev_b32 v10, 5, v18
v_sub_u32 v10, v9, v10
v_add_u32 v10, 0, v10
s_add_u32 s91, s88, s85
s_lshl_b32 s6, s91, 1
s_and_b32 s6, s6, 0xfffffffc
s_load_dword s92, s[50:51], s6
s_waitcnt lgkmcnt(0)
s_barrier
ds_read_b128 v[128:131], v8 offset:0
ds_read_b128 v[132:135], v8 offset:64
ds_read_b128 v[136:139], v8 offset:128
ds_read_b128 v[140:143], v8 offset:192
ds_read_b128 v[144:147], v8 offset:256
ds_read_b128 v[148:151], v8 offset:320
ds_read_b128 v[152:155], v8 offset:384
ds_read_b128 v[156:159], v8 offset:448
ds_read_b128 v[160:163], v9 offset:0
ds_read_b128 v[164:167], v9 offset:64
ds_read_b128 v[168:171], v9 offset:128
v_mov_b32 v176, 0
v_mov_b32 v177, 0
v_mov_b32 v178, 0
v_mov_b32 v179, 0
v_mov_b32 v180, 0
v_mov_b32 v181, 0
v_mov_b32 v182, 0
v_mov_b32 v183, 0
v_mov_b32 v184, 0
v_mov_b32 v185, 0
v_mov_b32 v186, 0
v_mov_b32 v187, 0
v_mov_b32 v188, 0
v_mov_b32 v189, 0
v_mov_b32 v190, 0
v_mov_b32 v191, 0
s_waitcnt lgkmcnt(0)
ds_read_b128 v[128:131], v8 offset:512
ds_read_b128 v[172:175], v9 offset:192
v_mfma_f32_16x16x32_bf16 v[188:191], v[140:143], v[160:163], v[188:191]
ds_read_b128 v[132:135], v8 offset:576
ds_read_b128 v[160:163], v9 offset:272
v_mfma_f32_16x16x32_bf16 v[184:187], v[140:143], v[164:167], v[184:187]
v_mfma_f32_16x16x32_bf16 v[188:191], v[144:147], v[164:167], v[188:191]
ds_read_b128 v[136:139], v8 offset:640
v_mfma_f32_16x16x32_bf16 v[180:183], v[140:143], v[168:171], v[180:183]
ds_read_b128 v[164:167], v9 offset:336
v_mfma_f32_16x16x32_bf16 v[184:187], v[144:147], v[168:171], v[184:187]
v_mfma_f32_16x16x32_bf16 v[188:191], v[148:151], v[168:171], v[188:191]
s_waitcnt lgkmcnt(4)
v_mfma_f32_16x16x32_bf16 v[176:179], v[140:143], v[172:175], v[176:179]
ds_read_b128 v[140:143], v8 offset:704
v_mfma_f32_16x16x32_bf16 v[180:183], v[144:147], v[172:175], v[180:183]
ds_read_b128 v[168:171], v9 offset:400
v_mfma_f32_16x16x32_bf16 v[184:187], v[148:151], v[172:175], v[184:187]
v_mfma_f32_16x16x32_bf16 v[188:191], v[152:155], v[172:175], v[188:191]
s_waitcnt lgkmcnt(4)
v_mfma_f32_16x16x32_bf16 v[176:179], v[144:147], v[160:163], v[176:179]
ds_read_b128 v[144:147], v8 offset:768
v_mfma_f32_16x16x32_bf16 v[180:183], v[148:151], v[160:163], v[180:183]
ds_read_b128 v[172:175], v9 offset:464
v_mfma_f32_16x16x32_bf16 v[184:187], v[152:155], v[160:163], v[184:187]
buffer_load_dwordx4 a[136:139], v248, s[24:27], s98 offen
v_mfma_f32_16x16x32_bf16 v[188:191], v[156:159], v[160:163], v[188:191]
s_add_u32 s97, s97, 5120
s_add_u32 s98, s98, 5120
s_waitcnt lgkmcnt(4)
v_mfma_f32_16x16x32_bf16 v[176:179], v[148:151], v[164:167], v[176:179]
ds_read_b128 v[148:151], v8 offset:832
v_mfma_f32_16x16x32_bf16 v[180:183], v[152:155], v[164:167], v[180:183]
ds_read_b128 v[160:163], v9 offset:544
v_mfma_f32_16x16x32_bf16 v[184:187], v[156:159], v[164:167], v[184:187]
buffer_load_dwordx4 a[140:143], v248, s[24:27], s97 offen offset:0
v_mfma_f32_16x16x32_bf16 v[188:191], v[128:131], v[164:167], v[188:191]
s_waitcnt lgkmcnt(4)
v_mfma_f32_16x16x32_bf16 v[176:179], v[152:155], v[168:171], v[176:179]
ds_read_b128 v[152:155], v8 offset:896
v_mfma_f32_16x16x32_bf16 v[180:183], v[156:159], v[168:171], v[180:183]
ds_read_b128 v[164:167], v9 offset:608
v_mfma_f32_16x16x32_bf16 v[184:187], v[128:131], v[168:171], v[184:187]
buffer_load_dwordx4 a[144:147], v248, s[24:27], s97 offen offset:1024
v_mfma_f32_16x16x32_bf16 v[188:191], v[132:135], v[168:171], v[188:191]
s_waitcnt lgkmcnt(4)
v_mfma_f32_16x16x32_bf16 v[176:179], v[156:159], v[172:175], v[176:179]
ds_read_b128 v[156:159], v8 offset:960
v_mfma_f32_16x16x32_bf16 v[180:183], v[128:131], v[172:175], v[180:183]
ds_read_b128 v[168:171], v9 offset:672
v_mfma_f32_16x16x32_bf16 v[184:187], v[132:135], v[172:175], v[184:187]
v_mfma_f32_16x16x32_bf16 v[188:191], v[136:139], v[172:175], v[188:191]
s_waitcnt lgkmcnt(4)
v_mfma_f32_16x16x32_bf16 v[176:179], v[128:131], v[160:163], v[176:179]
ds_read_b128 v[128:131], v8 offset:1024
v_mfma_f32_16x16x32_bf16 v[180:183], v[132:135], v[160:163], v[180:183]
ds_read_b128 v[172:175], v9 offset:736
v_mfma_f32_16x16x32_bf16 v[184:187], v[136:139], v[160:163], v[184:187]
buffer_load_dwordx4 a[148:151], v248, s[24:27], s97 offen offset:2048
v_mfma_f32_16x16x32_bf16 v[188:191], v[140:143], v[160:163], v[188:191]
s_waitcnt lgkmcnt(4)
v_mfma_f32_16x16x32_bf16 v[176:179], v[132:135], v[164:167], v[176:179]
ds_read_b128 v[132:135], v8 offset:1088
v_mfma_f32_16x16x32_bf16 v[180:183], v[136:139], v[164:167], v[180:183]
ds_read_b128 v[160:163], v9 offset:816
v_mfma_f32_16x16x32_bf16 v[184:187], v[140:143], v[164:167], v[184:187]
buffer_load_dwordx4 a[152:155], v248, s[24:27], s97 offen offset:3072
v_mfma_f32_16x16x32_bf16 v[188:191], v[144:147], v[164:167], v[188:191]
s_waitcnt lgkmcnt(4)
v_mfma_f32_16x16x32_bf16 v[176:179], v[136:139], v[168:171], v[176:179]
ds_read_b128 v[136:139], v8 offset:1152
v_mfma_f32_16x16x32_bf16 v[180:183], v[140:143], v[168:171], v[180:183]
ds_read_b128 v[164:167], v9 offset:880
v_mfma_f32_16x16x32_bf16 v[184:187], v[144:147], v[168:171], v[184:187]
v_mfma_f32_16x16x32_bf16 v[188:191], v[148:151], v[168:171], v[188:191]
s_waitcnt lgkmcnt(4)
v_mfma_f32_16x16x32_bf16 v[176:179], v[140:143], v[172:175], v[176:179]
ds_read_b128 v[140:143], v8 offset:1216
v_mfma_f32_16x16x32_bf16 v[180:183], v[144:147], v[172:175], v[180:183]
ds_read_b128 v[168:171], v9 offset:944
v_mfma_f32_16x16x32_bf16 v[184:187], v[148:151], v[172:175], v[184:187]
buffer_load_dwordx4 a[156:159], v248, s[24:27], s98 offen
v_mfma_f32_16x16x32_bf16 v[188:191], v[152:155], v[172:175], v[188:191]
s_add_u32 s97, s97, 5120
s_add_u32 s98, s98, 5120
s_waitcnt lgkmcnt(4)
v_mfma_f32_16x16x32_bf16 v[176:179], v[144:147], v[160:163], v[176:179]
ds_read_b128 v[144:147], v8 offset:1280
v_mfma_f32_16x16x32_bf16 v[180:183], v[148:151], v[160:163], v[180:183]
ds_read_b128 v[172:175], v9 offset:1008
v_mfma_f32_16x16x32_bf16 v[184:187], v[152:155], v[160:163], v[184:187]
buffer_load_dwordx4 a[160:163], v248, s[24:27], s97 offen offset:0
v_mfma_f32_16x16x32_bf16 v[188:191], v[156:159], v[160:163], v[188:191]
s_waitcnt lgkmcnt(4)
v_mfma_f32_16x16x32_bf16 v[176:179], v[148:151], v[164:167], v[176:179]
ds_read_b128 v[148:151], v8 offset:1344
v_mfma_f32_16x16x32_bf16 v[180:183], v[152:155], v[164:167], v[180:183]
ds_read_b128 v[160:163], v9 offset:1088
v_mfma_f32_16x16x32_bf16 v[184:187], v[156:159], v[164:167], v[184:187]
v_mfma_f32_16x16x32_bf16 v[188:191], v[128:131], v[164:167], v[188:191]
s_waitcnt lgkmcnt(4)
v_mfma_f32_16x16x32_bf16 v[176:179], v[152:155], v[168:171], v[176:179]
ds_read_b128 v[152:155], v8 offset:1408
v_mfma_f32_16x16x32_bf16 v[180:183], v[156:159], v[168:171], v[180:183]
ds_read_b128 v[164:167], v9 offset:1152
v_mfma_f32_16x16x32_bf16 v[184:187], v[128:131], v[168:171], v[184:187]
buffer_load_dwordx4 a[164:167], v248, s[24:27], s97 offen offset:1024
v_mfma_f32_16x16x32_bf16 v[188:191], v[132:135], v[168:171], v[188:191]
s_waitcnt lgkmcnt(4)
v_mfma_f32_16x16x32_bf16 v[176:179], v[156:159], v[172:175], v[176:179]
ds_read_b128 v[156:159], v8 offset:1472
v_mfma_f32_16x16x32_bf16 v[180:183], v[128:131], v[172:175], v[180:183]
ds_read_b128 v[168:171], v9 offset:1216
v_mfma_f32_16x16x32_bf16 v[184:187], v[132:135], v[172:175], v[184:187]
buffer_load_dwordx4 a[168:171], v248, s[24:27], s97 offen offset:2048
v_mfma_f32_16x16x32_bf16 v[188:191], v[136:139], v[172:175], v[188:191]
s_waitcnt vmcnt(9)
s_barrier
s_cmp_lg_u32 s5, 0
s_cbranch_scc1 L_fl_10
s_mov_b64 exec, 1
buffer_store_dword v253, v252, s[24:27], 0 offen offset:16 sc1
s_mov_b64 exec, -1
L_fl_10:
s_waitcnt lgkmcnt(4)
v_mfma_f32_16x16x32_bf16 v[176:179], v[128:131], v[160:163], v[176:179]
ds_read_b128 v[128:131], v8 offset:1536
v_mfma_f32_16x16x32_bf16 v[180:183], v[132:135], v[160:163], v[180:183]
ds_read_b128 v[172:175], v9 offset:1280
v_mfma_f32_16x16x32_bf16 v[184:187], v[136:139], v[160:163], v[184:187]
v_mfma_f32_16x16x32_bf16 v[188:191], v[140:143], v[160:163], v[188:191]
s_waitcnt lgkmcnt(4)
v_mfma_f32_16x16x32_bf16 v[176:179], v[132:135], v[164:167], v[176:179]
ds_read_b128 v[132:135], v8 offset:1600
v_mfma_f32_16x16x32_bf16 v[180:183], v[136:139], v[164:167], v[180:183]
ds_read_b128 v[160:163], v9 offset:1360
v_mfma_f32_16x16x32_bf16 v[184:187], v[140:143], v[164:167], v[184:187]
buffer_load_dwordx4 a[172:175], v248, s[24:27], s97 offen offset:3072
v_mfma_f32_16x16x32_bf16 v[188:191], v[144:147], v[164:167], v[188:191]
s_waitcnt lgkmcnt(4)
v_mfma_f32_16x16x32_bf16 v[176:179], v[136:139], v[168:171], v[176:179]
ds_read_b128 v[136:139], v8 offset:1664
v_mfma_f32_16x16x32_bf16 v[180:183], v[140:143], v[168:171], v[180:183]
ds_read_b128 v[164:167], v9 offset:1424
v_mfma_f32_16x16x32_bf16 v[184:187], v[144:147], v[168:171], v[184:187]
buffer_load_dwordx4 a[176:179], v248, s[24:27], s98 offen
v_mfma_f32_16x16x32_bf16 v[188:191], v[148:151], v[168:171], v[188:191]
s_add_u32 s97, s97, 5120
s_add_u32 s98, s98, 5120
s_waitcnt lgkmcnt(4)
v_mfma_f32_16x16x32_bf16 v[176:179], v[140:143], v[172:175], v[176:179]
ds_read_b128 v[140:143], v8 offset:1728
v_mfma_f32_16x16x32_bf16 v[180:183], v[144:147], v[172:175], v[180:183]
ds_read_b128 v[168:171], v9 offset:1488
v_mfma_f32_16x16x32_bf16 v[184:187], v[148:151], v[172:175], v[184:187]
buffer_load_dwordx4 a[180:183], v248, s[24:27], s97 offen offset:0
v_mfma_f32_16x16x32_bf16 v[188:191], v[152:155], v[172:175], v[188:191]
s_waitcnt lgkmcnt(4)
v_mfma_f32_16x16x32_bf16 v[176:179], v[144:147], v[160:163], v[176:179]
ds_read_b128 v[144:147], v8 offset:1792
v_mfma_f32_16x16x32_bf16 v[180:183], v[148:151], v[160:163], v[180:183]
ds_read_b128 v[172:175], v9 offset:1552
v_mfma_f32_16x16x32_bf16 v[184:187], v[152:155], v[160:163], v[184:187]
v_mfma_f32_16x16x32_bf16 v[188:191], v[156:159], v[160:163], v[188:191]
s_waitcnt lgkmcnt(4)
v_mfma_f32_16x16x32_bf16 v[176:179], v[148:151], v[164:167], v[176:179]
ds_read_b128 v[148:151], v8 offset:1856
v_mfma_f32_16x16x32_bf16 v[180:183], v[152:155], v[164:167], v[180:183]
ds_read_b128 v[160:163], v9 offset:1632
v_mfma_f32_16x16x32_bf16 v[184:187], v[156:159], v[164:167], v[184:187]
buffer_load_dwordx4 a[184:187], v248, s[24:27], s97 offen offset:1024
v_mfma_f32_16x16x32_bf16 v[188:191], v[128:131], v[164:167], v[188:191]
s_waitcnt lgkmcnt(4)
v_mfma_f32_16x16x32_bf16 v[176:179], v[152:155], v[168:171], v[176:179]
ds_read_b128 v[152:155], v8 offset:1920
v_mfma_f32_16x16x32_bf16 v[180:183], v[156:159], v[168:171], v[180:183]
ds_read_b128 v[164:167], v9 offset:1696
v_mfma_f32_16x16x32_bf16 v[184:187], v[128:131], v[168:171], v[184:187]
buffer_load_dwordx4 a[188:191], v248, s[24:27], s97 offen offset:2048
v_mfma_f32_16x16x32_bf16 v[188:191], v[132:135], v[168:171], v[188:191]
s_waitcnt lgkmcnt(4)
v_mfma_f32_16x16x32_bf16 v[176:179], v[156:159], v[172:175], v[176:179]
ds_read_b128 v[156:159], v8 offset:1984
v_mfma_f32_16x16x32_bf16 v[180:183], v[128:131], v[172:175], v[180:183]
ds_read_b128 v[168:171], v9 offset:1760
v_mfma_f32_16x16x32_bf16 v[184:187], v[132:135], v[172:175], v[184:187]
v_mfma_f32_16x16x32_bf16 v[188:191], v[136:139], v[172:175], v[188:191]
s_waitcnt lgkmcnt(4)
v_mfma_f32_16x16x32_bf16 v[176:179], v[128:131], v[160:163], v[176:179]
ds_read_b128 v[128:131], v8 offset:2048
v_mfma_f32_16x16x32_bf16 v[180:183], v[132:135], v[160:163], v[180:183]
ds_read_b128 v[172:175], v9 offset:1824
v_mfma_f32_16x16x32_bf16 v[184:187], v[136:139], v[160:163], v[184:187]
buffer_load_dwordx4 a[192:195], v248, s[24:27], s97 offen offset:3072
v_mfma_f32_16x16x32_bf16 v[188:191], v[140:143], v[160:163], v[188:191]
s_waitcnt lgkmcnt(4)
v_mfma_f32_16x16x32_bf16 v[176:179], v[132:135], v[164:167], v[176:179]
ds_read_b128 v[132:135], v8 offset:2112
v_mfma_f32_16x16x32_bf16 v[180:183], v[136:139], v[164:167], v[180:183]
ds_read_b128 v[160:163], v9 offset:1904
v_mfma_f32_16x16x32_bf16 v[184:187], v[140:143], v[164:167], v[184:187]
buffer_load_dwordx4 a[196:199], v248, s[24:27], s98 offen
v_mfma_f32_16x16x32_bf16 v[188:191], v[144:147], v[164:167], v[188:191]
s_add_u32 s97, s97, 5120
s_add_u32 s98, s98, 5120
s_waitcnt lgkmcnt(4)
v_mfma_f32_16x16x32_bf16 v[176:179], v[136:139], v[168:171], v[176:179]
ds_read_b128 v[136:139], v8 offset:2176
v_mfma_f32_16x16x32_bf16 v[180:183], v[140:143], v[168:171], v[180:183]
ds_read_b128 v[164:167], v9 offset:1968
v_mfma_f32_16x16x32_bf16 v[184:187], v[144:147], v[168:171], v[184:187]
v_mfma_f32_16x16x32_bf16 v[188:191], v[148:151], v[168:171], v[188:191]
s_waitcnt lgkmcnt(4)
v_mfma_f32_16x16x32_bf16 v[176:179], v[140:143], v[172:175], v[176:179]
ds_read_b128 v[140:143], v8 offset:2240
v_mfma_f32_16x16x32_bf16 v[180:183], v[144:147], v[172:175], v[180:183]
ds_read_b128 v[168:171], v9 offset:2032
v_mfma_f32_16x16x32_bf16 v[184:187], v[148:151], v[172:175], v[184:187]
buffer_load_dwordx4 a[200:203], v248, s[24:27], s97 offen offset:0
v_mfma_f32_16x16x32_bf16 v[188:191], v[152:155], v[172:175], v[188:191]
s_waitcnt lgkmcnt(4)
v_mfma_f32_16x16x32_bf16 v[176:179], v[144:147], v[160:163], v[176:179]
ds_read_b128 v[144:147], v8 offset:2304
v_mfma_f32_16x16x32_bf16 v[180:183], v[148:151], v[160:163], v[180:183]
ds_read_b128 v[172:175], v9 offset:2096
v_mfma_f32_16x16x32_bf16 v[184:187], v[152:155], v[160:163], v[184:187]
buffer_load_dwordx4 a[204:207], v248, s[24:27], s97 offen offset:1024
v_mfma_f32_16x16x32_bf16 v[188:191], v[156:159], v[160:163], v[188:191]
s_waitcnt lgkmcnt(4)
v_mfma_f32_16x16x32_bf16 v[176:179], v[148:151], v[164:167], v[176:179]
ds_read_b128 v[148:151], v8 offset:2368
v_mfma_f32_16x16x32_bf16 v[180:183], v[152:155], v[164:167], v[180:183]
ds_read_b128 v[160:163], v9 offset:2176
v_mfma_f32_16x16x32_bf16 v[184:187], v[156:159], v[164:167], v[184:187]
v_mfma_f32_16x16x32_bf16 v[188:191], v[128:131], v[164:167], v[188:191]
s_waitcnt lgkmcnt(4)
v_mfma_f32_16x16x32_bf16 v[176:179], v[152:155], v[168:171], v[176:179]
ds_read_b128 v[152:155], v8 offset:2432
v_mfma_f32_16x16x32_bf16 v[180:183], v[156:159], v[168:171], v[180:183]
ds_read_b128 v[164:167], v9 offset:2240
v_mfma_f32_16x16x32_bf16 v[184:187], v[128:131], v[168:171], v[184:187]
v_mfma_f32_16x16x32_bf16 v[188:191], v[132:135], v[168:171], v[188:191]
s_waitcnt lgkmcnt(4)
v_mfma_f32_16x16x32_bf16 v[176:179], v[156:159], v[172:175], v[176:179]
ds_read_b128 v[156:159], v8 offset:2496
v_mfma_f32_16x16x32_bf16 v[180:183], v[128:131], v[172:175], v[180:183]
ds_read_b128 v[168:171], v9 offset:2304
v_mfma_f32_16x16x32_bf16 v[184:187], v[132:135], v[172:175], v[184:187]
v_mfma_f32_16x16x32_bf16 v[188:191], v[136:139], v[172:175], v[188:191]
s_cmp_eq_u32 s86, 0
s_cbranch_scc1 L_two_11
L_halfb_13:
s_waitcnt lgkmcnt(4)
v_mfma_f32_16x16x32_bf16 v[176:179], v[128:131], v[160:163], v[176:179]
ds_read_b128 v[128:131], v8 offset:2560
v_mfma_f32_16x16x32_bf16 v[180:183], v[132:135], v[160:163], v[180:183]
ds_read_b128 v[172:175], v9 offset:2368
v_mfma_f32_16x16x32_bf16 v[184:187], v[136:139], v[160:163], v[184:187]
buffer_load_dwordx4 a[208:211], v248, s[24:27], s97 offen offset:2048
v_mfma_f32_16x16x32_bf16 v[188:191], v[140:143], v[160:163], v[188:191]
s_waitcnt lgkmcnt(4)
v_mfma_f32_16x16x32_bf16 v[176:179], v[132:135], v[164:167], v[176:179]
ds_read_b128 v[132:135], v8 offset:2624
v_mfma_f32_16x16x32_bf16 v[180:183], v[136:139], v[164:167], v[180:183]
ds_read_b128 v[160:163], v9 offset:2448
v_mfma_f32_16x16x32_bf16 v[184:187], v[140:143], v[164:167], v[184:187]
buffer_load_dwordx4 a[212:215], v248, s[24:27], s97 offen offset:3072
v_mfma_f32_16x16x32_bf16 v[188:191], v[144:147], v[164:167], v[188:191]
s_waitcnt lgkmcnt(4)
v_mfma_f32_16x16x32_bf16 v[176:179], v[136:139], v[168:171], v[176:179]
ds_read_b128 v[136:139], v8 offset:2688
v_mfma_f32_16x16x32_bf16 v[180:183], v[140:143], v[168:171], v[180:183]
ds_read_b128 v[164:167], v9 offset:2512
v_mfma_f32_16x16x32_bf16 v[184:187], v[144:147], v[168:171], v[184:187]
buffer_load_dwordx4 a[216:219], v248, s[24:27], s98 offen
v_mfma_f32_16x16x32_bf16 v[188:191], v[148:151], v[168:171], v[188:191]
s_add_u32 s97, s97, 5120
s_add_u32 s98, s98, 5120
s_waitcnt lgkmcnt(4)
v_mfma_f32_16x16x32_bf16 v[176:179], v[140:143], v[172:175], v[176:179]
ds_read_b128 v[140:143], v8 offset:2752
v_mfma_f32_16x16x32_bf16 v[180:183], v[144:147], v[172:175], v[180:183]
ds_read_b128 v[168:171], v9 offset:2576
v_mfma_f32_16x16x32_bf16 v[184:187], v[148:151], v[172:175], v[184:187]
buffer_load_dwordx4 a[220:223], v248, s[24:27], s97 offen offset:0
v_mfma_f32_16x16x32_bf16 v[188:191], v[152:155], v[172:175], v[188:191]
s_waitcnt lgkmcnt(4)
v_mfma_f32_16x16x32_bf16 v[176:179], v[144:147], v[160:163], v[176:179]
ds_read_b128 v[144:147], v8 offset:2816
v_mfma_f32_16x16x32_bf16 v[180:183], v[148:151], v[160:163], v[180:183]
ds_read_b128 v[172:175], v9 offset:2640
v_mfma_f32_16x16x32_bf16 v[184:187], v[152:155], v[160:163], v[184:187]
buffer_load_dwordx4 a[224:227], v248, s[24:27], s97 offen offset:1024
v_mfma_f32_16x16x32_bf16 v[188:191], v[156:159], v[160:163], v[188:191]
s_waitcnt lgkmcnt(4)
v_mfma_f32_16x16x32_bf16 v[176:179], v[148:151], v[164:167], v[176:179]
ds_read_b128 v[148:151], v8 offset:2880
v_mfma_f32_16x16x32_bf16 v[180:183], v[152:155], v[164:167], v[180:183]
ds_read_b128 v[160:163], v9 offset:2720
v_mfma_f32_16x16x32_bf16 v[184:187], v[156:159], v[164:167], v[184:187]
buffer_load_dwordx4 a[228:231], v248, s[24:27], s97 offen offset:2048
v_mfma_f32_16x16x32_bf16 v[188:191], v[128:131], v[164:167], v[188:191]
s_waitcnt lgkmcnt(4)
v_mfma_f32_16x16x32_bf16 v[176:179], v[152:155], v[168:171], v[176:179]
ds_read_b128 v[152:155], v8 offset:2944
v_mfma_f32_16x16x32_bf16 v[180:183], v[156:159], v[168:171], v[180:183]
ds_read_b128 v[164:167], v9 offset:2784
v_mfma_f32_16x16x32_bf16 v[184:187], v[128:131], v[168:171], v[184:187]
buffer_load_dwordx4 a[232:235], v248, s[24:27], s97 offen offset:3072
v_mfma_f32_16x16x32_bf16 v[188:191], v[132:135], v[168:171], v[188:191]
s_waitcnt lgkmcnt(4)
v_mfma_f32_16x16x32_bf16 v[176:179], v[156:159], v[172:175], v[176:179]
ds_read_b128 v[156:159], v8 offset:3008
v_mfma_f32_16x16x32_bf16 v[180:183], v[128:131], v[172:175], v[180:183]
ds_read_b128 v[168:171], v9 offset:2848
v_mfma_f32_16x16x32_bf16 v[184:187], v[132:135], v[172:175], v[184:187]
buffer_load_dwordx4 a[236:239], v248, s[24:27], s98 offen
v_mfma_f32_16x16x32_bf16 v[188:191], v[136:139], v[172:175], v[188:191]
s_add_u32 s97, s97, 5120
s_add_u32 s98, s98, 5120
s_waitcnt lgkmcnt(4)
v_mfma_f32_16x16x32_bf16 v[176:179], v[128:131], v[160:163], v[176:179]
ds_read_b128 v[128:131], v8 offset:3072
v_mfma_f32_16x16x32_bf16 v[180:183], v[132:135], v[160:163], v[180:183]
ds_read_b128 v[172:175], v9 offset:2912
v_mfma_f32_16x16x32_bf16 v[184:187], v[136:139], v[160:163], v[184:187]
buffer_load_dwordx4 v[208:211], v248, s[24:27], s97 offen offset:0
v_mfma_f32_16x16x32_bf16 v[188:191], v[140:143], v[160:163], v[188:191]
s_waitcnt lgkmcnt(4)
v_mfma_f32_16x16x32_bf16 v[176:179], v[132:135], v[164:167], v[176:179]
ds_read_b128 v[132:135], v8 offset:3136
v_mfma_f32_16x16x32_bf16 v[180:183], v[136:139], v[164:167], v[180:183]
ds_read_b128 v[160:163], v9 offset:2992
v_mfma_f32_16x16x32_bf16 v[184:187], v[140:143], v[164:167], v[184:187]
buffer_load_dwordx4 v[212:215], v248, s[24:27], s97 offen offset:1024
v_mfma_f32_16x16x32_bf16 v[188:191], v[144:147], v[164:167], v[188:191]
s_waitcnt lgkmcnt(4)
v_mfma_f32_16x16x32_bf16 v[176:179], v[136:139], v[168:171], v[176:179]
ds_read_b128 v[136:139], v8 offset:3200
v_mfma_f32_16x16x32_bf16 v[180:183], v[140:143], v[168:171], v[180:183]
ds_read_b128 v[164:167], v9 offset:3056
v_mfma_f32_16x16x32_bf16 v[184:187], v[144:147], v[168:171], v[184:187]
buffer_load_dwordx4 v[216:219], v248, s[24:27], s97 offen offset:2048
v_mfma_f32_16x16x32_bf16 v[188:191], v[148:151], v[168:171], v[188:191]
s_waitcnt lgkmcnt(4)
v_mfma_f32_16x16x32_bf16 v[176:179], v[140:143], v[172:175], v[176:179]
ds_read_b128 v[140:143], v8 offset:3264
v_mfma_f32_16x16x32_bf16 v[180:183], v[144:147], v[172:175], v[180:183]
ds_read_b128 v[168:171], v9 offset:3120
v_mfma_f32_16x16x32_bf16 v[184:187], v[148:151], v[172:175], v[184:187]
buffer_load_dwordx4 v[220:223], v248, s[24:27], s97 offen offset:3072
v_mfma_f32_16x16x32_bf16 v[188:191], v[152:155], v[172:175], v[188:191]
buffer_load_dword v254, v249, s[24:27], 0 offen sc1
s_waitcnt lgkmcnt(4)
v_mfma_f32_16x16x32_bf16 v[176:179], v[144:147], v[160:163], v[176:179]
ds_read_b128 v[144:147], v8 offset:3328
v_mfma_f32_16x16x32_bf16 v[180:183], v[148:151], v[160:163], v[180:183]
ds_read_b128 v[172:175], v9 offset:3184
v_mfma_f32_16x16x32_bf16 v[184:187], v[152:155], v[160:163], v[184:187]
buffer_load_dwordx4 v[224:227], v248, s[24:27], s98 offen
v_mfma_f32_16x16x32_bf16 v[188:191], v[156:159], v[160:163], v[188:191]
s_add_u32 s97, s97, 5120
s_add_u32 s98, s98, 5120
s_waitcnt lgkmcnt(4)
v_mfma_f32_16x16x32_bf16 v[176:179], v[148:151], v[164:167], v[176:179]
ds_read_b128 v[148:151], v8 offset:3392
v_mfma_f32_16x16x32_bf16 v[180:183], v[152:155], v[164:167], v[180:183]
ds_read_b128 v[160:163], v9 offset:3264
v_mfma_f32_16x16x32_bf16 v[184:187], v[156:159], v[164:167], v[184:187]
buffer_load_dwordx4 v[228:231], v248, s[24:27], s97 offen offset:0
v_mfma_f32_16x16x32_bf16 v[188:191], v[128:131], v[164:167], v[188:191]
s_waitcnt lgkmcnt(4)
v_mfma_f32_16x16x32_bf16 v[176:179], v[152:155], v[168:171], v[176:179]
ds_read_b128 v[152:155], v8 offset:3456
v_mfma_f32_16x16x32_bf16 v[180:183], v[156:159], v[168:171], v[180:183]
ds_read_b128 v[164:167], v9 offset:3328
v_mfma_f32_16x16x32_bf16 v[184:187], v[128:131], v[168:171], v[184:187]
buffer_load_dwordx4 v[232:235], v248, s[24:27], s97 offen offset:1024
v_mfma_f32_16x16x32_bf16 v[188:191], v[132:135], v[168:171], v[188:191]
s_waitcnt lgkmcnt(4)
v_mfma_f32_16x16x32_bf16 v[176:179], v[156:159], v[172:175], v[176:179]
ds_read_b128 v[156:159], v8 offset:3520
v_mfma_f32_16x16x32_bf16 v[180:183], v[128:131], v[172:175], v[180:183]
ds_read_b128 v[168:171], v9 offset:3392
v_mfma_f32_16x16x32_bf16 v[184:187], v[132:135], v[172:175], v[184:187]
buffer_load_dwordx4 v[236:239], v248, s[24:27], s97 offen offset:2048
v_mfma_f32_16x16x32_bf16 v[188:191], v[136:139], v[172:175], v[188:191]
s_waitcnt lgkmcnt(4)
v_mfma_f32_16x16x32_bf16 v[176:179], v[128:131], v[160:163], v[176:179]
ds_read_b128 v[128:131], v8 offset:3584
v_mfma_f32_16x16x32_bf16 v[180:183], v[132:135], v[160:163], v[180:183]
ds_read_b128 v[172:175], v9 offset:3456
v_mfma_f32_16x16x32_bf16 v[184:187], v[136:139], v[160:163], v[184:187]
buffer_load_dwordx4 v[240:243], v248, s[24:27], s97 offen offset:3072
v_mfma_f32_16x16x32_bf16 v[188:191], v[140:143], v[160:163], v[188:191]
s_waitcnt lgkmcnt(4)
v_mfma_f32_16x16x32_bf16 v[176:179], v[132:135], v[164:167], v[176:179]
ds_read_b128 v[132:135], v8 offset:3648
v_mfma_f32_16x16x32_bf16 v[180:183], v[136:139], v[164:167], v[180:183]
ds_read_b128 v[160:163], v9 offset:3536
v_mfma_f32_16x16x32_bf16 v[184:187], v[140:143], v[164:167], v[184:187]
buffer_load_dwordx4 v[244:247], v248, s[24:27], s98 offen
v_mfma_f32_16x16x32_bf16 v[188:191], v[144:147], v[164:167], v[188:191]
s_add_u32 s97, s97, 5120
s_add_u32 s98, s98, 5120
s_waitcnt lgkmcnt(4)
v_mfma_f32_16x16x32_bf16 v[176:179], v[136:139], v[168:171], v[176:179]
ds_read_b128 v[136:139], v8 offset:3712
v_mfma_f32_16x16x32_bf16 v[180:183], v[140:143], v[168:171], v[180:183]
ds_read_b128 v[164:167], v9 offset:3600
v_mfma_f32_16x16x32_bf16 v[184:187], v[144:147], v[168:171], v[184:187]
v_mfma_f32_16x16x32_bf16 v[188:191], v[148:151], v[168:171], v[188:191]
s_waitcnt lgkmcnt(4)
v_mfma_f32_16x16x32_bf16 v[176:179], v[140:143], v[172:175], v[176:179]
ds_read_b128 v[140:143], v8 offset:3776
v_mfma_f32_16x16x32_bf16 v[180:183], v[144:147], v[172:175], v[180:183]
ds_read_b128 v[168:171], v9 offset:3664
v_mfma_f32_16x16x32_bf16 v[184:187], v[148:151], v[172:175], v[184:187]
v_mfma_f32_16x16x32_bf16 v[188:191], v[152:155], v[172:175], v[188:191]
s_waitcnt lgkmcnt(4)
v_mfma_f32_16x16x32_bf16 v[176:179], v[144:147], v[160:163], v[176:179]
ds_read_b128 v[144:147], v8 offset:3840
v_mfma_f32_16x16x32_bf16 v[180:183], v[148:151], v[160:163], v[180:183]
ds_read_b128 v[172:175], v9 offset:3728
v_mfma_f32_16x16x32_bf16 v[184:187], v[152:155], v[160:163], v[184:187]
v_mfma_f32_16x16x32_bf16 v[188:191], v[156:159], v[160:163], v[188:191]
s_waitcnt lgkmcnt(4)
v_mfma_f32_16x16x32_bf16 v[176:179], v[148:151], v[164:167], v[176:179]
ds_read_b128 v[148:151], v8 offset:3904
v_mfma_f32_16x16x32_bf16 v[180:183], v[152:155], v[164:167], v[180:183]
ds_read_b128 v[160:163], v9 offset:3808
v_mfma_f32_16x16x32_bf16 v[184:187], v[156:159], v[164:167], v[184:187]
v_mfma_f32_16x16x32_bf16 v[188:191], v[128:131], v[164:167], v[188:191]
s_waitcnt vmcnt(6)
v_cmp_eq_u32 vcc, 0, v254
s_cbranch_vccnz L_slow_14
L_back_15:
s_mul_i32 s6, s94, 54
s_add_u32 s6, s6, s96
s_lshl_b32 s99, s6, 12
s_add_u32 s99, s99, 10485760
s_add_u32 s6, s5, 0
s_and_b32 s6, s6, 3
s_lshl_b32 s6, s6, 10
v_add_u32 v56, s6, v248
s_add_u32 s6, s5, 1
s_and_b32 s6, s6, 3
s_lshl_b32 s6, s6, 10
v_add_u32 v57, s6, v248
s_add_u32 s6, s5, 2
s_and_b32 s6, s6, 3
s_lshl_b32 s6, s6, 10
v_add_u32 v58, s6, v248
s_add_u32 s6, s5, 3
s_and_b32 s6, s6, 3
s_lshl_b32 s6, s6, 10
v_add_u32 v59, s6, v248
s_waitcnt lgkmcnt(4)
v_mfma_f32_16x16x32_bf16 v[176:179], v[152:155], v[168:171], v[176:179]
ds_read_b128 v[152:155], v8 offset:3968
v_mfma_f32_16x16x32_bf16 v[180:183], v[156:159], v[168:171], v[180:183]
ds_read_b128 v[164:167], v9 offset:3872
v_mfma_f32_16x16x32_bf16 v[184:187], v[128:131], v[168:171], v[184:187]
v_mfma_f32_16x16x32_bf16 v[188:191], v[132:135], v[168:171], v[188:191]
s_waitcnt lgkmcnt(4)
v_mfma_f32_16x16x32_bf16 v[176:179], v[156:159], v[172:175], v[176:179]
ds_read_b128 v[156:159], v8 offset:4032
v_mfma_f32_16x16x32_bf16 v[180:183], v[128:131], v[172:175], v[180:183]
ds_read_b128 v[168:171], v9 offset:3936
v_mfma_f32_16x16x32_bf16 v[184:187], v[132:135], v[172:175], v[184:187]
v_mfma_f32_16x16x32_bf16 v[188:191], v[136:139], v[172:175], v[188:191]
s_waitcnt lgkmcnt(4)
v_mfma_f32_16x16x32_bf16 v[176:179], v[128:131], v[160:163], v[176:179]
ds_read_b128 v[128:131], v8 offset:4096
v_mfma_f32_16x16x32_bf16 v[180:183], v[132:135], v[160:163], v[180:183]
ds_read_b128 v[172:175], v9 offset:4000
v_mfma_f32_16x16x32_bf16 v[184:187], v[136:139], v[160:163], v[184:187]
buffer_load_dwordx4 v[64:67], v56, s[24:27], s99 offen
v_mfma_f32_16x16x32_bf16 v[188:191], v[140:143], v[160:163], v[188:191]
buffer_load_dwordx4 v[68:71], v57, s[24:27], s99 offen
buffer_load_dwordx4 v[72:75], v58, s[24:27], s99 offen
buffer_load_dwordx4 v[76:79], v59, s[24:27], s99 offen
s_add_u32 s99, s99, 4096
s_waitcnt lgkmcnt(4)
v_mfma_f32_16x16x32_bf16 v[176:179], v[132:135], v[164:167], v[176:179]
ds_read_b128 v[132:135], v8 offset:4160
v_mfma_f32_16x16x32_bf16 v[180:183], v[136:139], v[164:167], v[180:183]
ds_read_b128 v[160:163], v9 offset:4080
v_mfma_f32_16x16x32_bf16 v[184:187], v[140:143], v[164:167], v[184:187]
v_mfma_f32_16x16x32_bf16 v[188:191], v[144:147], v[164:167], v[188:191]
s_waitcnt lgkmcnt(4)
v_mfma_f32_16x16x32_bf16 v[176:179], v[136:139], v[168:171], v[176:179]
ds_read_b128 v[136:139], v8 offset:4224
v_mfma_f32_16x16x32_bf16 v[180:183], v[140:143], v[168:171], v[180:183]
ds_read_b128 v[164:167], v9 offset:4144
v_mfma_f32_16x16x32_bf16 v[184:187], v[144:147], v[168:171], v[184:187]
buffer_load_dwordx4 v[80:83], v56, s[24:27], s99 offen
v_mfma_f32_16x16x32_bf16 v[188:191], v[148:151], v[168:171], v[188:191]
buffer_load_dwordx4 v[84:87], v57, s[24:27], s99 offen
buffer_load_dwordx4 v[88:91], v58, s[24:27], s99 offen
buffer_load_dwordx4 v[92:95], v59, s[24:27], s99 offen
s_add_u32 s99, s99, 4096
s_waitcnt lgkmcnt(4)
v_mfma_f32_16x16x32_bf16 v[176:179], v[140:143], v[172:175], v[176:179]
ds_read_b128 v[140:143], v8 offset:4288
v_mfma_f32_16x16x32_bf16 v[180:183], v[144:147], v[172:175], v[180:183]
ds_read_b128 v[168:171], v9 offset:4208
v_mfma_f32_16x16x32_bf16 v[184:187], v[148:151], v[172:175], v[184:187]
v_mfma_f32_16x16x32_bf16 v[188:191], v[152:155], v[172:175], v[188:191]
s_waitcnt lgkmcnt(4)
v_mfma_f32_16x16x32_bf16 v[176:179], v[144:147], v[160:163], v[176:179]
ds_read_b128 v[144:147], v8 offset:4352
v_mfma_f32_16x16x32_bf16 v[180:183], v[148:151], v[160:163], v[180:183]
ds_read_b128 v[172:175], v9 offset:4272
v_mfma_f32_16x16x32_bf16 v[184:187], v[152:155], v[160:163], v[184:187]
buffer_load_dwordx4 v[96:99], v56, s[24:27], s99 offen
v_mfma_f32_16x16x32_bf16 v[188:191], v[156:159], v[160:163], v[188:191]
buffer_load_dwordx4 v[100:103], v57, s[24:27], s99 offen
buffer_load_dwordx4 v[104:107], v58, s[24:27], s99 offen
buffer_load_dwordx4 v[108:111], v59, s[24:27], s99 offen
s_add_u32 s99, s99, 4096
s_waitcnt lgkmcnt(4)
v_mfma_f32_16x16x32_bf16 v[176:179], v[148:151], v[164:167], v[176:179]
ds_read_b128 v[148:151], v8 offset:4416
v_mfma_f32_16x16x32_bf16 v[180:183], v[152:155], v[164:167], v[180:183]
ds_read_b128 v[160:163], v9 offset:4352
v_mfma_f32_16x16x32_bf16 v[184:187], v[156:159], v[164:167], v[184:187]
v_mfma_f32_16x16x32_bf16 v[188:191], v[128:131], v[164:167], v[188:191]
s_waitcnt lgkmcnt(4)
v_mfma_f32_16x16x32_bf16 v[176:179], v[152:155], v[168:171], v[176:179]
ds_read_b128 v[152:155], v8 offset:4480
v_mfma_f32_16x16x32_bf16 v[180:183], v[156:159], v[168:171], v[180:183]
ds_read_b128 v[164:167], v9 offset:4416
v_mfma_f32_16x16x32_bf16 v[184:187], v[128:131], v[168:171], v[184:187]
v_mfma_f32_16x16x32_bf16 v[188:191], v[132:135], v[168:171], v[188:191]
s_waitcnt lgkmcnt(4)
v_mfma_f32_16x16x32_bf16 v[176:179], v[156:159], v[172:175], v[176:179]
ds_read_b128 v[156:159], v8 offset:4544
v_mfma_f32_16x16x32_bf16 v[180:183], v[128:131], v[172:175], v[180:183]
ds_read_b128 v[168:171], v9 offset:4480
v_mfma_f32_16x16x32_bf16 v[184:187], v[132:135], v[172:175], v[184:187]
v_mfma_f32_16x16x32_bf16 v[188:191], v[136:139], v[172:175], v[188:191]
s_waitcnt lgkmcnt(0)
ds_read_b128 v[128:131], v10 offset:240
ds_read_b128 v[132:135], v10 offset:176
ds_read_b128 v[136:139], v10 offset:112
ds_read_b128 v[140:143], v10 offset:48
s_and_b32 s6, s91, 1
s_lshl_b32 s6, s6, 4
s_lshr_b32 s92, s92, s6
s_lshl_b32 s92, s92, 16
s_lshl_b32 s6, s91, 12
s_add_u32 s6, s6, 4194304
s_nop 4
s_waitcnt lgkmcnt(0)
v_lshlrev_b32 v131, 16, v131
v_fma_f32 v176, v131, s92, v176
v_lshlrev_b32 v130, 16, v130
v_fma_f32 v177, v130, s92, v177
v_lshlrev_b32 v129, 16, v129
v_fma_f32 v178, v129, s92, v178
v_lshlrev_b32 v128, 16, v128
v_fma_f32 v179, v128, s92, v179
v_lshlrev_b32 v135, 16, v135
v_fma_f32 v180, v135, s92, v180
v_lshlrev_b32 v134, 16, v134
v_fma_f32 v181, v134, s92, v181
v_lshlrev_b32 v133, 16, v133
v_fma_f32 v182, v133, s92, v182
v_lshlrev_b32 v132, 16, v132
v_fma_f32 v183, v132, s92, v183
v_lshlrev_b32 v139, 16, v139
v_fma_f32 v184, v139, s92, v184
v_lshlrev_b32 v138, 16, v138
v_fma_f32 v185, v138, s92, v185
v_lshlrev_b32 v137, 16, v137
v_fma_f32 v186, v137, s92, v186
v_lshlrev_b32 v136, 16, v136
v_fma_f32 v187, v136, s92, v187
v_lshlrev_b32 v143, 16, v143
v_fma_f32 v188, v143, s92, v188
v_lshlrev_b32 v142, 16, v142
v_fma_f32 v189, v142, s92, v189
v_lshlrev_b32 v141, 16, v141
v_fma_f32 v190, v141, s92, v190
v_lshlrev_b32 v140, 16, v140
v_fma_f32 v191, v140, s92, v191
v_cvt_pk_bf16_f32 v160, v176, v177
v_cvt_pk_bf16_f32 v161, v178, v179
v_cvt_pk_bf16_f32 v162, v180, v181
v_cvt_pk_bf16_f32 v163, v182, v183
buffer_store_dwordx4 v[160:163], v11, s[24:27], s6 offen offset:0 sc1
v_cvt_pk_bf16_f32 v164, v184, v185
v_cvt_pk_bf16_f32 v165, v186, v187
v_cvt_pk_bf16_f32 v166, v188, v189
v_cvt_pk_bf16_f32 v167, v190, v191
buffer_store_dwordx4 v[164:167], v11, s[24:27], s6 offen offset:128 sc1
L_gemm2:
v_mov_b32 v128, 0
v_mov_b32 v129, 0
v_mov_b32 v130, 0
v_mov_b32 v131, 0
v_mov_b32 v132, 0
v_mov_b32 v133, 0
v_mov_b32 v134, 0
v_mov_b32 v135, 0
v_mov_b32 v136, 0
v_mov_b32 v137, 0
v_mov_b32 v138, 0
v_mov_b32 v139, 0
v_mov_b32 v140, 0
v_mov_b32 v141, 0
v_mov_b32 v142, 0
v_mov_b32 v143, 0
v_mov_b32 v144, 0
v_mov_b32 v145, 0
v_mov_b32 v146, 0
v_mov_b32 v147, 0
v_mov_b32 v148, 0
v_mov_b32 v149, 0
v_mov_b32 v150, 0
v_mov_b32 v151, 0
v_mov_b32 v152, 0
v_mov_b32 v153, 0
v_mov_b32 v154, 0
v_mov_b32 v155, 0
v_mov_b32 v156, 0
v_mov_b32 v157, 0
v_mov_b32 v158, 0
v_mov_b32 v159, 0
v_mov_b32 v160, 0
v_mov_b32 v161, 0
v_mov_b32 v162, 0
v_mov_b32 v163, 0
v_mov_b32 v164, 0
v_mov_b32 v165, 0
v_mov_b32 v166, 0
v_mov_b32 v167, 0
v_mov_b32 v168, 0
v_mov_b32 v169, 0
v_mov_b32 v170, 0
v_mov_b32 v171, 0
v_mov_b32 v172, 0
v_mov_b32 v173, 0
v_mov_b32 v174, 0
v_mov_b32 v175, 0
v_mov_b32 v176, 0
v_mov_b32 v177, 0
v_mov_b32 v178, 0
v_mov_b32 v179, 0
v_mov_b32 v180, 0
v_mov_b32 v181, 0
v_mov_b32 v182, 0
v_mov_b32 v183, 0
v_mov_b32 v184, 0
v_mov_b32 v185, 0
v_mov_b32 v186, 0
v_mov_b32 v187, 0
v_mov_b32 v188, 0
v_mov_b32 v189, 0
v_mov_b32 v190, 0
v_mov_b32 v191, 0
v_mov_b32 v192, 0
v_mov_b32 v193, 0
v_mov_b32 v194, 0
v_mov_b32 v195, 0
v_mov_b32 v196, 0
v_mov_b32 v197, 0
v_mov_b32 v198, 0
v_mov_b32 v199, 0
v_mov_b32 v200, 0
v_mov_b32 v201, 0
v_mov_b32 v202, 0
v_mov_b32 v203, 0
v_mov_b32 v204, 0
v_mov_b32 v205, 0
v_mov_b32 v206, 0
v_mov_b32 v207, 0
s_mov_b32 s32, s60
s_and_b32 s33, s61, 0xffff
s_mov_b32 s34, 1280
s_mov_b32 s35, 0x20000
v_and_b32 v2, 15, v1
v_lshrrev_b32 v3, 4, v1
v_lshrrev_b32 v4, 3, v2
v_lshlrev_b32 v4, 3, v4
v_and_b32 v5, 3, v2
v_lshl_or_b32 v4, v5, 1, v4
v_bfe_u32 v5, v2, 2, 1
v_or_b32 v4, v4, v5
s_lshl_b32 s6, s94, 6
s_lshl_b32 s7, s5, 4
s_add_u32 s6, s6, s7
v_add_u32 v4, s6, v4
v_lshlrev_b32 v5, 4, v4
v_mul_u32_u24 v4, 1280, v4
v_mul_u32_u24 v3, 40, v3
s_mul_i32 s6, s95, 160
v_add_u32 v3, s6, v3
v_add_u32 v60, v4, v3
s_mov_b32 s7, 98304
buffer_load_dwordx4 v[8:11], v60, s[8:11], 0 offen
buffer_load_dwordx4 v[12:15], v60, s[8:11], 0 offen offset:16
buffer_load_dwordx2 v[16:17], v60, s[8:11], 0 offen offset:32
buffer_load_dwordx4 v[20:23], v3, s[32:35], 0 offen
buffer_load_dwordx4 v[24:27], v3, s[32:35], 0 offen offset:16
buffer_load_dwordx2 v[28:29], v3, s[32:35], 0 offen offset:32
buffer_load_dwordx4 v[32:35], v5, s[24:27], s7 offen
s_waitcnt vmcnt(17)
v_mfma_f32_16x16x32_bf16 v[128:131], a[0:3], v[64:67], v[128:131]
buffer_load_dwordx4 v[112:115], v56, s[24:27], s99 offen
v_mfma_f32_16x16x32_bf16 v[148:151], a[0:3], v[68:71], v[148:151]
v_mfma_f32_16x16x32_bf16 v[168:171], a[0:3], v[72:75], v[168:171]
v_mfma_f32_16x16x32_bf16 v[188:191], a[0:3], v[76:79], v[188:191]
v_mfma_f32_16x16x32_bf16 v[132:135], a[4:7], v[64:67], v[132:135]
buffer_load_dwordx4 v[116:119], v57, s[24:27], s99 offen
v_mfma_f32_16x16x32_bf16 v[152:155], a[4:7], v[68:71], v[152:155]
v_mfma_f32_16x16x32_bf16 v[172:175], a[4:7], v[72:75], v[172:175]
v_mfma_f32_16x16x32_bf16 v[192:195], a[4:7], v[76:79], v[192:195]
v_mfma_f32_16x16x32_bf16 v[136:139], a[8:11], v[64:67], v[136:139]
buffer_load_dwordx4 v[120:123], v58, s[24:27], s99 offen
v_mfma_f32_16x16x32_bf16 v[156:159], a[8:11], v[68:71], v[156:159]
v_mfma_f32_16x16x32_bf16 v[176:179], a[8:11], v[72:75], v[176:179]
v_mfma_f32_16x16x32_bf16 v[196:199], a[8:11], v[76:79], v[196:199]
v_mfma_f32_16x16x32_bf16 v[140:143], a[12:15], v[64:67], v[140:143]
buffer_load_dwordx4 v[124:127], v59, s[24:27], s99 offen
v_mfma_f32_16x16x32_bf16 v[160:163], a[12:15], v[68:71], v[160:163]
v_mfma_f32_16x16x32_bf16 v[180:183], a[12:15], v[72:75], v[180:183]
v_mfma_f32_16x16x32_bf16 v[200:203], a[12:15], v[76:79], v[200:203]
v_mfma_f32_16x16x32_bf16 v[144:147], a[16:19], v[64:67], v[144:147]
s_add_u32 s99, s99, 4096
v_mfma_f32_16x16x32_bf16 v[164:167], a[16:19], v[68:71], v[164:167]
v_mfma_f32_16x16x32_bf16 v[184:187], a[16:19], v[72:75], v[184:187]
v_mfma_f32_16x16x32_bf16 v[204:207], a[16:19], v[76:79], v[204:207]
s_waitcnt vmcnt(17)
v_mfma_f32_16x16x32_bf16 v[128:131], a[20:23], v[80:83], v[128:131]
buffer_load_dwordx4 v[64:67], v56, s[24:27], s99 offen
v_mfma_f32_16x16x32_bf16 v[148:151], a[20:23], v[84:87], v[148:151]
v_mfma_f32_16x16x32_bf16 v[168:171], a[20:23], v[88:91], v[168:171]
v_mfma_f32_16x16x32_bf16 v[188:191], a[20:23], v[92:95], v[188:191]
v_mfma_f32_16x16x32_bf16 v[132:135], a[24:27], v[80:83], v[132:135]
buffer_load_dwordx4 v[68:71], v57, s[24:27], s99 offen
v_mfma_f32_16x16x32_bf16 v[152:155], a[24:27], v[84:87], v[152:155]
v_mfma_f32_16x16x32_bf16 v[172:175], a[24:27], v[88:91], v[172:175]
v_mfma_f32_16x16x32_bf16 v[192:195], a[24:27], v[92:95], v[192:195]
v_mfma_f32_16x16x32_bf16 v[136:139], a[28:31], v[80:83], v[136:139]
buffer_load_dwordx4 v[72:75], v58, s[24:27], s99 offen
v_mfma_f32_16x16x32_bf16 v[156:159], a[28:31], v[84:87], v[156:159]
v_mfma_f32_16x16x32_bf16 v[176:179], a[28:31], v[88:91], v[176:179]
v_mfma_f32_16x16x32_bf16 v[196:199], a[28:31], v[92:95], v[196:199]
v_mfma_f32_16x16x32_bf16 v[140:143], a[32:35], v[80:83], v[140:143]
buffer_load_dwordx4 v[76:79], v59, s[24:27], s99 offen
v_mfma_f32_16x16x32_bf16 v[160:163], a[32:35], v[84:87], v[160:163]
v_mfma_f32_16x16x32_bf16 v[180:183], a[32:35], v[88:91], v[180:183]
v_mfma_f32_16x16x32_bf16 v[200:203], a[32:35], v[92:95], v[200:203]
v_mfma_f32_16x16x32_bf16 v[144:147], a[36:39], v[80:83], v[144:147]
s_add_u32 s99, s99, 4096
v_mfma_f32_16x16x32_bf16 v[164:167], a[36:39], v[84:87], v[164:167]
v_mfma_f32_16x16x32_bf16 v[184:187], a[36:39], v[88:91], v[184:187]
v_mfma_f32_16x16x32_bf16 v[204:207], a[36:39], v[92:95], v[204:207]
s_waitcnt vmcnt(17)
v_mfma_f32_16x16x32_bf16 v[128:131], a[40:43], v[96:99], v[128:131]
buffer_load_dwordx4 v[80:83], v56, s[24:27], s99 offen
v_mfma_f32_16x16x32_bf16 v[148:151], a[40:43], v[100:103], v[148:151]
v_mfma_f32_16x16x32_bf16 v[168:171], a[40:43], v[104:107], v[168:171]
v_mfma_f32_16x16x32_bf16 v[188:191], a[40:43], v[108:111], v[188:191]
v_mfma_f32_16x16x32_bf16 v[132:135], a[44:47], v[96:99], v[132:135]
buffer_load_dwordx4 v[84:87], v57, s[24:27], s99 offen
v_mfma_f32_16x16x32_bf16 v[152:155], a[44:47], v[100:103], v[152:155]
v_mfma_f32_16x16x32_bf16 v[172:175], a[44:47], v[104:107], v[172:175]
v_mfma_f32_16x16x32_bf16 v[192:195], a[44:47], v[108:111], v[192:195]
v_mfma_f32_16x16x32_bf16 v[136:139], a[48:51], v[96:99], v[136:139]
buffer_load_dwordx4 v[88:91], v58, s[24:27], s99 offen
v_mfma_f32_16x16x32_bf16 v[156:159], a[48:51], v[100:103], v[156:159]
v_mfma_f32_16x16x32_bf16 v[176:179], a[48:51], v[104:107], v[176:179]
v_mfma_f32_16x16x32_bf16 v[196:199], a[48:51], v[108:111], v[196:199]
v_mfma_f32_16x16x32_bf16 v[140:143], a[52:55], v[96:99], v[140:143]
buffer_load_dwordx4 v[92:95], v59, s[24:27], s99 offen
v_mfma_f32_16x16x32_bf16 v[160:163], a[52:55], v[100:103], v[160:163]
v_mfma_f32_16x16x32_bf16 v[180:183], a[52:55], v[104:107], v[180:183]
v_mfma_f32_16x16x32_bf16 v[200:203], a[52:55], v[108:111], v[200:203]
v_mfma_f32_16x16x32_bf16 v[144:147], a[56:59], v[96:99], v[144:147]
s_add_u32 s99, s99, 4096
v_mfma_f32_16x16x32_bf16 v[164:167], a[56:59], v[100:103], v[164:167]
v_mfma_f32_16x16x32_bf16 v[184:187], a[56:59], v[104:107], v[184:187]
v_mfma_f32_16x16x32_bf16 v[204:207], a[56:59], v[108:111], v[204:207]
s_waitcnt vmcnt(19)
s_barrier
s_cmp_lg_u32 s5, 0
s_cbranch_scc1 L_fl_17
s_mov_b64 exec, 1
buffer_store_dword v253, v252, s[24:27], 0 offen offset:20 sc1
s_mov_b64 exec, -1
L_fl_17:
s_waitcnt vmcnt(8)
v_mfma_f32_16x16x32_bf16 v[128:131], a[60:63], v[112:115], v[128:131]
buffer_load_dwordx4 v[96:99], v56, s[24:27], s99 offen
v_mfma_f32_16x16x32_bf16 v[148:151], a[60:63], v[116:119], v[148:151]
v_mfma_f32_16x16x32_bf16 v[168:171], a[60:63], v[120:123], v[168:171]
v_mfma_f32_16x16x32_bf16 v[188:191], a[60:63], v[124:127], v[188:191]
v_mfma_f32_16x16x32_bf16 v[132:135], a[64:67], v[112:115], v[132:135]
buffer_load_dwordx4 v[100:103], v57, s[24:27], s99 offen
v_mfma_f32_16x16x32_bf16 v[152:155], a[64:67], v[116:119], v[152:155]
v_mfma_f32_16x16x32_bf16 v[172:175], a[64:67], v[120:123], v[172:175]
v_mfma_f32_16x16x32_bf16 v[192:195], a[64:67], v[124:127], v[192:195]
v_mfma_f32_16x16x32_bf16 v[136:139], a[68:71], v[112:115], v[136:139]
buffer_load_dwordx4 v[104:107], v58, s[24:27], s99 offen
v_mfma_f32_16x16x32_bf16 v[156:159], a[68:71], v[116:119], v[156:159]
v_mfma_f32_16x16x32_bf16 v[176:179], a[68:71], v[120:123], v[176:179]
v_mfma_f32_16x16x32_bf16 v[196:199], a[68:71], v[124:127], v[196:199]
v_mfma_f32_16x16x32_bf16 v[140:143], a[72:75], v[112:115], v[140:143]
buffer_load_dwordx4 v[108:111], v59, s[24:27], s99 offen
v_mfma_f32_16x16x32_bf16 v[160:163], a[72:75], v[116:119], v[160:163]
v_mfma_f32_16x16x32_bf16 v[180:183], a[72:75], v[120:123], v[180:183]
v_mfma_f32_16x16x32_bf16 v[200:203], a[72:75], v[124:127], v[200:203]
v_mfma_f32_16x16x32_bf16 v[144:147], a[76:79], v[112:115], v[144:147]
s_add_u32 s99, s99, 4096
v_mfma_f32_16x16x32_bf16 v[164:167], a[76:79], v[116:119], v[164:167]
v_mfma_f32_16x16x32_bf16 v[184:187], a[76:79], v[120:123], v[184:187]
v_mfma_f32_16x16x32_bf16 v[204:207], a[76:79], v[124:127], v[204:207]
s_waitcnt vmcnt(8)
v_mfma_f32_16x16x32_bf16 v[128:131], a[80:83], v[64:67], v[128:131]
buffer_load_dwordx4 v[112:115], v56, s[24:27], s99 offen
v_mfma_f32_16x16x32_bf16 v[148:151], a[80:83], v[68:71], v[148:151]
v_mfma_f32_16x16x32_bf16 v[168:171], a[80:83], v[72:75], v[168:171]
v_mfma_f32_16x16x32_bf16 v[188:191], a[80:83], v[76:79], v[188:191]
v_mfma_f32_16x16x32_bf16 v[132:135], a[84:87], v[64:67], v[132:135]
buffer_load_dwordx4 v[116:119], v57, s[24:27], s99 offen
v_mfma_f32_16x16x32_bf16 v[152:155], a[84:87], v[68:71], v[152:155]
v_mfma_f32_16x16x32_bf16 v[172:175], a[84:87], v[72:75], v[172:175]
v_mfma_f32_16x16x32_bf16 v[192:195], a[84:87], v[76:79], v[192:195]
v_mfma_f32_16x16x32_bf16 v[136:139], a[88:91], v[64:67], v[136:139]
buffer_load_dwordx4 v[120:123], v58, s[24:27], s99 offen
v_mfma_f32_16x16x32_bf16 v[156:159], a[88:91], v[68:71], v[156:159]
v_mfma_f32_16x16x32_bf16 v[176:179], a[88:91], v[72:75], v[176:179]
v_mfma_f32_16x16x32_bf16 v[196:199], a[88:91], v[76:79], v[196:199]
v_mfma_f32_16x16x32_bf16 v[140:143], a[92:95], v[64:67], v[140:143]
buffer_load_dwordx4 v[124:127], v59, s[24:27], s99 offen
v_mfma_f32_16x16x32_bf16 v[160:163], a[92:95], v[68:71], v[160:163]
v_mfma_f32_16x16x32_bf16 v[180:183], a[92:95], v[72:75], v[180:183]
v_mfma_f32_16x16x32_bf16 v[200:203], a[92:95], v[76:79], v[200:203]
v_mfma_f32_16x16x32_bf16 v[144:147], a[96:99], v[64:67], v[144:147]
s_add_u32 s99, s99, 4096
v_mfma_f32_16x16x32_bf16 v[164:167], a[96:99], v[68:71], v[164:167]
v_mfma_f32_16x16x32_bf16 v[184:187], a[96:99], v[72:75], v[184:187]
v_mfma_f32_16x16x32_bf16 v[204:207], a[96:99], v[76:79], v[204:207]
s_waitcnt vmcnt(8)
v_mfma_f32_16x16x32_bf16 v[128:131], a[100:103], v[80:83], v[128:131]
buffer_load_dwordx4 v[64:67], v56, s[24:27], s99 offen
v_mfma_f32_16x16x32_bf16 v[148:151], a[100:103], v[84:87], v[148:151]
v_mfma_f32_16x16x32_bf16 v[168:171], a[100:103], v[88:91], v[168:171]
v_mfma_f32_16x16x32_bf16 v[188:191], a[100:103], v[92:95], v[188:191]
v_mfma_f32_16x16x32_bf16 v[132:135], a[104:107], v[80:83], v[132:135]
buffer_load_dwordx4 v[68:71], v57, s[24:27], s99 offen
v_mfma_f32_16x16x32_bf16 v[152:155], a[104:107], v[84:87], v[152:155]
v_mfma_f32_16x16x32_bf16 v[172:175], a[104:107], v[88:91], v[172:175]
v_mfma_f32_16x16x32_bf16 v[192:195], a[104:107], v[92:95], v[192:195]
v_mfma_f32_16x16x32_bf16 v[136:139], a[108:111], v[80:83], v[136:139]
buffer_load_dwordx4 v[72:75], v58, s[24:27], s99 offen
v_mfma_f32_16x16x32_bf16 v[156:159], a[108:111], v[84:87], v[156:159]
v_mfma_f32_16x16x32_bf16 v[176:179], a[108:111], v[88:91], v[176:179]
v_mfma_f32_16x16x32_bf16 v[196:199], a[108:111], v[92:95], v[196:199]
v_mfma_f32_16x16x32_bf16 v[140:143], a[112:115], v[80:83], v[140:143]
buffer_load_dwordx4 v[76:79], v59, s[24:27], s99 offen
v_mfma_f32_16x16x32_bf16 v[160:163], a[112:115], v[84:87], v[160:163]
v_mfma_f32_16x16x32_bf16 v[180:183], a[112:115], v[88:91], v[180:183]
v_mfma_f32_16x16x32_bf16 v[200:203], a[112:115], v[92:95], v[200:203]
v_mfma_f32_16x16x32_bf16 v[144:147], a[116:119], v[80:83], v[144:147]
s_add_u32 s99, s99, 4096
v_mfma_f32_16x16x32_bf16 v[164:167], a[116:119], v[84:87], v[164:167]
v_mfma_f32_16x16x32_bf16 v[184:187], a[116:119], v[88:91], v[184:187]
v_mfma_f32_16x16x32_bf16 v[204:207], a[116:119], v[92:95], v[204:207]
buffer_load_dword v254, v250, s[24:27], 0 offen sc1
s_waitcnt vmcnt(9)
v_mfma_f32_16x16x32_bf16 v[128:131], a[120:123], v[96:99], v[128:131]
buffer_load_dwordx4 v[80:83], v56, s[24:27], s99 offen
v_mfma_f32_16x16x32_bf16 v[148:151], a[120:123], v[100:103], v[148:151]
v_mfma_f32_16x16x32_bf16 v[168:171], a[120:123], v[104:107], v[168:171]
v_mfma_f32_16x16x32_bf16 v[188:191], a[120:123], v[108:111], v[188:191]
v_mfma_f32_16x16x32_bf16 v[132:135], a[124:127], v[96:99], v[132:135]
buffer_load_dwordx4 v[84:87], v57, s[24:27], s99 offen
v_mfma_f32_16x16x32_bf16 v[152:155], a[124:127], v[100:103], v[152:155]
v_mfma_f32_16x16x32_bf16 v[172:175], a[124:127], v[104:107], v[172:175]
v_mfma_f32_16x16x32_bf16 v[192:195], a[124:127], v[108:111], v[192:195]
v_mfma_f32_16x16x32_bf16 v[136:139], a[128:131], v[96:99], v[136:139]
buffer_load_dwordx4 v[88:91], v58, s[24:27], s99 offen
v_mfma_f32_16x16x32_bf16 v[156:159], a[128:131], v[100:103], v[156:159]
v_mfma_f32_16x16x32_bf16 v[176:179], a[128:131], v[104:107], v[176:179]
v_mfma_f32_16x16x32_bf16 v[196:199], a[128:131], v[108:111], v[196:199]
v_mfma_f32_16x16x32_bf16 v[140:143], a[132:135], v[96:99], v[140:143]
buffer_load_dwordx4 v[92:95], v59, s[24:27], s99 offen
v_mfma_f32_16x16x32_bf16 v[160:163], a[132:135], v[100:103], v[160:163]
v_mfma_f32_16x16x32_bf16 v[180:183], a[132:135], v[104:107], v[180:183]
v_mfma_f32_16x16x32_bf16 v[200:203], a[132:135], v[108:111], v[200:203]
v_mfma_f32_16x16x32_bf16 v[144:147], a[136:139], v[96:99], v[144:147]
s_add_u32 s99, s99, 4096
v_mfma_f32_16x16x32_bf16 v[164:167], a[136:139], v[100:103], v[164:167]
v_mfma_f32_16x16x32_bf16 v[184:187], a[136:139], v[104:107], v[184:187]
v_mfma_f32_16x16x32_bf16 v[204:207], a[136:139], v[108:111], v[204:207]
s_waitcnt vmcnt(9)
v_mfma_f32_16x16x32_bf16 v[128:131], a[140:143], v[112:115], v[128:131]
buffer_load_dwordx4 v[96:99], v56, s[24:27], s99 offen
v_mfma_f32_16x16x32_bf16 v[148:151], a[140:143], v[116:119], v[148:151]
v_mfma_f32_16x16x32_bf16 v[168:171], a[140:143], v[120:123], v[168:171]
v_mfma_f32_16x16x32_bf16 v[188:191], a[140:143], v[124:127], v[188:191]
v_mfma_f32_16x16x32_bf16 v[132:135], a[144:147], v[112:115], v[132:135]
buffer_load_dwordx4 v[100:103], v57, s[24:27], s99 offen
v_mfma_f32_16x16x32_bf16 v[152:155], a[144:147], v[116:119], v[152:155]
v_mfma_f32_16x16x32_bf16 v[172:175], a[144:147], v[120:123], v[172:175]
v_mfma_f32_16x16x32_bf16 v[192:195], a[144:147], v[124:127], v[192:195]
v_mfma_f32_16x16x32_bf16 v[136:139], a[148:151], v[112:115], v[136:139]
buffer_load_dwordx4 v[104:107], v58, s[24:27], s99 offen
v_mfma_f32_16x16x32_bf16 v[156:159], a[148:151], v[116:119], v[156:159]
v_mfma_f32_16x16x32_bf16 v[176:179], a[148:151], v[120:123], v[176:179]
v_mfma_f32_16x16x32_bf16 v[196:199], a[148:151], v[124:127], v[196:199]
v_mfma_f32_16x16x32_bf16 v[140:143], a[152:155], v[112:115], v[140:143]
buffer_load_dwordx4 v[108:111], v59, s[24:27], s99 offen
v_mfma_f32_16x16x32_bf16 v[160:163], a[152:155], v[116:119], v[160:163]
v_mfma_f32_16x16x32_bf16 v[180:183], a[152:155], v[120:123], v[180:183]
v_mfma_f32_16x16x32_bf16 v[200:203], a[152:155], v[124:127], v[200:203]
v_mfma_f32_16x16x32_bf16 v[144:147], a[156:159], v[112:115], v[144:147]
s_add_u32 s99, s99, 4096
v_mfma_f32_16x16x32_bf16 v[164:167], a[156:159], v[116:119], v[164:167]
v_mfma_f32_16x16x32_bf16 v[184:187], a[156:159], v[120:123], v[184:187]
v_mfma_f32_16x16x32_bf16 v[204:207], a[156:159], v[124:127], v[204:207]
s_waitcnt vmcnt(9)
v_mfma_f32_16x16x32_bf16 v[128:131], a[160:163], v[64:67], v[128:131]
buffer_load_dwordx4 v[112:115], v56, s[24:27], s99 offen
v_mfma_f32_16x16x32_bf16 v[148:151], a[160:163], v[68:71], v[148:151]
v_mfma_f32_16x16x32_bf16 v[168:171], a[160:163], v[72:75], v[168:171]
v_mfma_f32_16x16x32_bf16 v[188:191], a[160:163], v[76:79], v[188:191]
v_mfma_f32_16x16x32_bf16 v[132:135], a[164:167], v[64:67], v[132:135]
buffer_load_dwordx4 v[116:119], v57, s[24:27], s99 offen
v_mfma_f32_16x16x32_bf16 v[152:155], a[164:167], v[68:71], v[152:155]
v_mfma_f32_16x16x32_bf16 v[172:175], a[164:167], v[72:75], v[172:175]
v_mfma_f32_16x16x32_bf16 v[192:195], a[164:167], v[76:79], v[192:195]
v_mfma_f32_16x16x32_bf16 v[136:139], a[168:171], v[64:67], v[136:139]
buffer_load_dwordx4 v[120:123], v58, s[24:27], s99 offen
v_mfma_f32_16x16x32_bf16 v[156:159], a[168:171], v[68:71], v[156:159]
v_mfma_f32_16x16x32_bf16 v[176:179], a[168:171], v[72:75], v[176:179]
v_mfma_f32_16x16x32_bf16 v[196:199], a[168:171], v[76:79], v[196:199]
v_mfma_f32_16x16x32_bf16 v[140:143], a[172:175], v[64:67], v[140:143]
buffer_load_dwordx4 v[124:127], v59, s[24:27], s99 offen
v_mfma_f32_16x16x32_bf16 v[160:163], a[172:175], v[68:71], v[160:163]
v_mfma_f32_16x16x32_bf16 v[180:183], a[172:175], v[72:75], v[180:183]
v_mfma_f32_16x16x32_bf16 v[200:203], a[172:175], v[76:79], v[200:203]
v_mfma_f32_16x16x32_bf16 v[144:147], a[176:179], v[64:67], v[144:147]
s_add_u32 s99, s99, 4096
v_mfma_f32_16x16x32_bf16 v[164:167], a[176:179], v[68:71], v[164:167]
v_mfma_f32_16x16x32_bf16 v[184:187], a[176:179], v[72:75], v[184:187]
v_mfma_f32_16x16x32_bf16 v[204:207], a[176:179], v[76:79], v[204:207]
s_waitcnt vmcnt(12)
v_cmp_eq_u32 vcc, 0, v254
s_cbranch_vccnz L_slow_18
L_back_19:
v_lshrrev_b32 v2, 3, v1
v_and_b32 v3, 7, v1
v_lshlrev_b32 v3, 4, v3
v_lshl_add_u32 v61, v2, 12, v3
s_mul_i32 s6, s95, 80
s_lshl_b32 s7, s5, 3
s_add_u32 s6, s6, s7
s_lshl_b32 s6, s6, 12
s_lshl_b32 s7, s94, 7
s_add_u32 s6, s6, s7
s_add_u32 s6, s6, 4194304
s_lshl_b32 s7, s5, 10
s_add_u32 s7, s7, 61440
s_mov_b32 m0, s7
s_add_u32 s7, s7, 4096
buffer_load_dwordx4 v61, s[24:27], s6 offen lds
s_add_u32 s6, s6, 131072
s_mov_b32 m0, s7
s_add_u32 s7, s7, 4096
buffer_load_dwordx4 v61, s[24:27], s6 offen lds
s_add_u32 s6, s6, 131072
s_cmp_ge_u32 s5, 2
s_cbranch_scc1 L_y2skip_20
s_mov_b32 m0, s7
s_add_u32 s7, s7, 4096
buffer_load_dwordx4 v61, s[24:27], s6 offen lds
s_add_u32 s6, s6, 131072
L_y2skip_20:
s_waitcnt vmcnt(10)
v_mfma_f32_16x16x32_bf16 v[128:131], a[180:183], v[80:83], v[128:131]
buffer_load_dwordx4 v[64:67], v56, s[24:27], s99 offen
v_mfma_f32_16x16x32_bf16 v[148:151], a[180:183], v[84:87], v[148:151]
v_mfma_f32_16x16x32_bf16 v[168:171], a[180:183], v[88:91], v[168:171]
v_mfma_f32_16x16x32_bf16 v[188:191], a[180:183], v[92:95], v[188:191]
v_mfma_f32_16x16x32_bf16 v[132:135], a[184:187], v[80:83], v[132:135]
buffer_load_dwordx4 v[68:71], v57, s[24:27], s99 offen
v_mfma_f32_16x16x32_bf16 v[152:155], a[184:187], v[84:87], v[152:155]
v_mfma_f32_16x16x32_bf16 v[172:175], a[184:187], v[88:91], v[172:175]
v_mfma_f32_16x16x32_bf16 v[192:195], a[184:187], v[92:95], v[192:195]
v_mfma_f32_16x16x32_bf16 v[136:139], a[188:191], v[80:83], v[136:139]
buffer_load_dwordx4 v[72:75], v58, s[24:27], s99 offen
v_mfma_f32_16x16x32_bf16 v[156:159], a[188:191], v[84:87], v[156:159]
v_mfma_f32_16x16x32_bf16 v[176:179], a[188:191], v[88:91], v[176:179]
v_mfma_f32_16x16x32_bf16 v[196:199], a[188:191], v[92:95], v[196:199]
v_mfma_f32_16x16x32_bf16 v[140:143], a[192:195], v[80:83], v[140:143]
buffer_load_dwordx4 v[76:79], v59, s[24:27], s99 offen
v_mfma_f32_16x16x32_bf16 v[160:163], a[192:195], v[84:87], v[160:163]
v_mfma_f32_16x16x32_bf16 v[180:183], a[192:195], v[88:91], v[180:183]
v_mfma_f32_16x16x32_bf16 v[200:203], a[192:195], v[92:95], v[200:203]
v_mfma_f32_16x16x32_bf16 v[144:147], a[196:199], v[80:83], v[144:147]
s_add_u32 s99, s99, 4096
v_mfma_f32_16x16x32_bf16 v[164:167], a[196:199], v[84:87], v[164:167]
v_mfma_f32_16x16x32_bf16 v[184:187], a[196:199], v[88:91], v[184:187]
v_mfma_f32_16x16x32_bf16 v[204:207], a[196:199], v[92:95], v[204:207]
s_waitcnt vmcnt(10)
v_mfma_f32_16x16x32_bf16 v[128:131], a[200:203], v[96:99], v[128:131]
buffer_load_dwordx4 v[80:83], v56, s[24:27], s99 offen
v_mfma_f32_16x16x32_bf16 v[148:151], a[200:203], v[100:103], v[148:151]
v_mfma_f32_16x16x32_bf16 v[168:171], a[200:203], v[104:107], v[168:171]
v_mfma_f32_16x16x32_bf16 v[188:191], a[200:203], v[108:111], v[188:191]
v_mfma_f32_16x16x32_bf16 v[132:135], a[204:207], v[96:99], v[132:135]
buffer_load_dwordx4 v[84:87], v57, s[24:27], s99 offen
v_mfma_f32_16x16x32_bf16 v[152:155], a[204:207], v[100:103], v[152:155]
v_mfma_f32_16x16x32_bf16 v[172:175], a[204:207], v[104:107], v[172:175]
v_mfma_f32_16x16x32_bf16 v[192:195], a[204:207], v[108:111], v[192:195]
v_mfma_f32_16x16x32_bf16 v[136:139], a[208:211], v[96:99], v[136:139]
buffer_load_dwordx4 v[88:91], v58, s[24:27], s99 offen
v_mfma_f32_16x16x32_bf16 v[156:159], a[208:211], v[100:103], v[156:159]
v_mfma_f32_16x16x32_bf16 v[176:179], a[208:211], v[104:107], v[176:179]
v_mfma_f32_16x16x32_bf16 v[196:199], a[208:211], v[108:111], v[196:199]
v_mfma_f32_16x16x32_bf16 v[140:143], a[212:215], v[96:99], v[140:143]
buffer_load_dwordx4 v[92:95], v59, s[24:27], s99 offen
v_mfma_f32_16x16x32_bf16 v[160:163], a[212:215], v[100:103], v[160:163]
v_mfma_f32_16x16x32_bf16 v[180:183], a[212:215], v[104:107], v[180:183]
v_mfma_f32_16x16x32_bf16 v[200:203], a[212:215], v[108:111], v[200:203]
v_mfma_f32_16x16x32_bf16 v[144:147], a[216:219], v[96:99], v[144:147]
s_add_u32 s99, s99, 4096
v_mfma_f32_16x16x32_bf16 v[164:167], a[216:219], v[100:103], v[164:167]
v_mfma_f32_16x16x32_bf16 v[184:187], a[216:219], v[104:107], v[184:187]
v_mfma_f32_16x16x32_bf16 v[204:207], a[216:219], v[108:111], v[204:207]
s_waitcnt vmcnt(10)
v_mfma_f32_16x16x32_bf16 v[128:131], a[220:223], v[112:115], v[128:131]
v_mfma_f32_16x16x32_bf16 v[148:151], a[220:223], v[116:119], v[148:151]
v_mfma_f32_16x16x32_bf16 v[168:171], a[220:223], v[120:123], v[168:171]
v_mfma_f32_16x16x32_bf16 v[188:191], a[220:223], v[124:127], v[188:191]
v_mfma_f32_16x16x32_bf16 v[132:135], a[224:227], v[112:115], v[132:135]
v_mfma_f32_16x16x32_bf16 v[152:155], a[224:227], v[116:119], v[152:155]
v_mfma_f32_16x16x32_bf16 v[172:175], a[224:227], v[120:123], v[172:175]
v_mfma_f32_16x16x32_bf16 v[192:195], a[224:227], v[124:127], v[192:195]
v_mfma_f32_16x16x32_bf16 v[136:139], a[228:231], v[112:115], v[136:139]
v_mfma_f32_16x16x32_bf16 v[156:159], a[228:231], v[116:119], v[156:159]
v_mfma_f32_16x16x32_bf16 v[176:179], a[228:231], v[120:123], v[176:179]
v_mfma_f32_16x16x32_bf16 v[196:199], a[228:231], v[124:127], v[196:199]
v_mfma_f32_16x16x32_bf16 v[140:143], a[232:235], v[112:115], v[140:143]
v_mfma_f32_16x16x32_bf16 v[160:163], a[232:235], v[116:119], v[160:163]
v_mfma_f32_16x16x32_bf16 v[180:183], a[232:235], v[120:123], v[180:183]
v_mfma_f32_16x16x32_bf16 v[200:203], a[232:235], v[124:127], v[200:203]
v_mfma_f32_16x16x32_bf16 v[144:147], a[236:239], v[112:115], v[144:147]
v_mfma_f32_16x16x32_bf16 v[164:167], a[236:239], v[116:119], v[164:167]
v_mfma_f32_16x16x32_bf16 v[184:187], a[236:239], v[120:123], v[184:187]
v_mfma_f32_16x16x32_bf16 v[204:207], a[236:239], v[124:127], v[204:207]
s_waitcnt vmcnt(4)
v_mfma_f32_16x16x32_bf16 v[128:131], v[208:211], v[64:67], v[128:131]
v_mfma_f32_16x16x32_bf16 v[148:151], v[208:211], v[68:71], v[148:151]
v_mfma_f32_16x16x32_bf16 v[168:171], v[208:211], v[72:75], v[168:171]
v_mfma_f32_16x16x32_bf16 v[188:191], v[208:211], v[76:79], v[188:191]
v_mfma_f32_16x16x32_bf16 v[132:135], v[212:215], v[64:67], v[132:135]
v_mfma_f32_16x16x32_bf16 v[152:155], v[212:215], v[68:71], v[152:155]
v_mfma_f32_16x16x32_bf16 v[172:175], v[212:215], v[72:75], v[172:175]
v_mfma_f32_16x16x32_bf16 v[192:195], v[212:215], v[76:79], v[192:195]
v_mfma_f32_16x16x32_bf16 v[136:139], v[216:219], v[64:67], v[136:139]
v_mfma_f32_16x16x32_bf16 v[156:159], v[216:219], v[68:71], v[156:159]
v_mfma_f32_16x16x32_bf16 v[176:179], v[216:219], v[72:75], v[176:179]
v_mfma_f32_16x16x32_bf16 v[196:199], v[216:219], v[76:79], v[196:199]
v_mfma_f32_16x16x32_bf16 v[140:143], v[220:223], v[64:67], v[140:143]
v_mfma_f32_16x16x32_bf16 v[160:163], v[220:223], v[68:71], v[160:163]
v_mfma_f32_16x16x32_bf16 v[180:183], v[220:223], v[72:75], v[180:183]
v_mfma_f32_16x16x32_bf16 v[200:203], v[220:223], v[76:79], v[200:203]
v_mfma_f32_16x16x32_bf16 v[144:147], v[224:227], v[64:67], v[144:147]
v_mfma_f32_16x16x32_bf16 v[164:167], v[224:227], v[68:71], v[164:167]
v_mfma_f32_16x16x32_bf16 v[184:187], v[224:227], v[72:75], v[184:187]
v_mfma_f32_16x16x32_bf16 v[204:207], v[224:227], v[76:79], v[204:207]
s_cmp_ge_u32 s5, 2
s_cbranch_scc1 L_g2skip_16
s_waitcnt vmcnt(0)
v_mfma_f32_16x16x32_bf16 v[128:131], v[228:231], v[80:83], v[128:131]
v_mfma_f32_16x16x32_bf16 v[148:151], v[228:231], v[84:87], v[148:151]
v_mfma_f32_16x16x32_bf16 v[168:171], v[228:231], v[88:91], v[168:171]
v_mfma_f32_16x16x32_bf16 v[188:191], v[228:231], v[92:95], v[188:191]
v_mfma_f32_16x16x32_bf16 v[132:135], v[232:235], v[80:83], v[132:135]
v_mfma_f32_16x16x32_bf16 v[152:155], v[232:235], v[84:87], v[152:155]
v_mfma_f32_16x16x32_bf16 v[172:175], v[232:235], v[88:91], v[172:175]
v_mfma_f32_16x16x32_bf16 v[192:195], v[232:235], v[92:95], v[192:195]
v_mfma_f32_16x16x32_bf16 v[136:139], v[236:239], v[80:83], v[136:139]
v_mfma_f32_16x16x32_bf16 v[156:159], v[236:239], v[84:87], v[156:159]
v_mfma_f32_16x16x32_bf16 v[176:179], v[236:239], v[88:91], v[176:179]
v_mfma_f32_16x16x32_bf16 v[196:199], v[236:239], v[92:95], v[196:199]
v_mfma_f32_16x16x32_bf16 v[140:143], v[240:243], v[80:83], v[140:143]
v_mfma_f32_16x16x32_bf16 v[160:163], v[240:243], v[84:87], v[160:163]
v_mfma_f32_16x16x32_bf16 v[180:183], v[240:243], v[88:91], v[180:183]
v_mfma_f32_16x16x32_bf16 v[200:203], v[240:243], v[92:95], v[200:203]
v_mfma_f32_16x16x32_bf16 v[144:147], v[244:247], v[80:83], v[144:147]
v_mfma_f32_16x16x32_bf16 v[164:167], v[244:247], v[84:87], v[164:167]
v_mfma_f32_16x16x32_bf16 v[184:187], v[244:247], v[88:91], v[184:187]
v_mfma_f32_16x16x32_bf16 v[204:207], v[244:247], v[92:95], v[204:207]
L_g2skip_16:
s_mul_i32 s6, s5, 15360
s_add_u32 s6, s6, 0
v_add_u32 v62, s6, v248
s_add_u32 s6, s5, 1
s_and_b32 s6, s6, 3
s_mul_i32 s6, s6, 15360
s_add_u32 s6, s6, 0
v_add_u32 v57, s6, v248
s_add_u32 s6, s5, 2
s_and_b32 s6, s6, 3
s_mul_i32 s6, s6, 15360
s_add_u32 s6, s6, 5120
v_add_u32 v58, s6, v248
s_add_u32 s6, s5, 3
s_and_b32 s6, s6, 3
s_mul_i32 s6, s6, 15360
s_add_u32 s6, s6, 10240
v_add_u32 v59, s6, v248
s_nop 4
ds_write_b128 v57, v[148:151] offset:0
ds_write_b128 v57, v[152:155] offset:1024
ds_write_b128 v57, v[156:159] offset:2048
ds_write_b128 v57, v[160:163] offset:3072
ds_write_b128 v57, v[164:167] offset:4096
ds_write_b128 v58, v[168:171] offset:0
ds_write_b128 v58, v[172:175] offset:1024
ds_write_b128 v58, v[176:179] offset:2048
ds_write_b128 v58, v[180:183] offset:3072
ds_write_b128 v58, v[184:187] offset:4096
ds_write_b128 v59, v[188:191] offset:0
ds_write_b128 v59, v[192:195] offset:1024
ds_write_b128 v59, v[196:199] offset:2048
ds_write_b128 v59, v[200:203] offset:3072
ds_write_b128 v59, v[204:207] offset:4096
v_lshrrev_b32 v3, 4, v1
v_mul_u32_u24 v3, 20, v3
v_bfe_u32 v4, v1, 2, 2
v_add_u32 v3, v3, v4
v_lshlrev_b32 v3, 7, v3
v_and_b32 v4, 3, v1
v_lshl_add_u32 v3, v4, 4, v3
s_and_b32 s6, s5, 1
s_lshl_b32 s6, s6, 6
s_lshr_b32 s7, s5, 1
s_lshl_b32 s7, s7, 3
s_add_u32 s6, s6, s7
s_add_u32 s6, s6, 61440
v_add_u32 v63, s6, v3
s_waitcnt vmcnt(0) lgkmcnt(0)
s_barrier
ds_read_b128 v[64:67], v62 offset:0
ds_read_b128 v[68:71], v62 offset:1024
ds_read_b128 v[72:75], v62 offset:2048
ds_read_b128 v[76:79], v62 offset:3072
ds_read_b128 v[80:83], v62 offset:4096
ds_read_b128 v[84:87], v62 offset:5120
ds_read_b128 v[88:91], v62 offset:6144
ds_read_b128 v[92:95], v62 offset:7168
ds_read_b128 v[96:99], v62 offset:8192
ds_read_b128 v[100:103], v62 offset:9216
ds_read_b128 v[104:107], v62 offset:10240
ds_read_b128 v[108:111], v62 offset:11264
ds_read_b128 v[112:115], v62 offset:12288
ds_read_b128 v[116:119], v62 offset:13312
ds_read_b128 v[120:123], v62 offset:14336
ds_read_b64_tr_b16 v[36:37], v63 offset:0
ds_read_b64_tr_b16 v[38:39], v63 offset:512
ds_read_b64_tr_b16 v[40:41], v63 offset:1024
ds_read_b64_tr_b16 v[42:43], v63 offset:1536
ds_read_b64_tr_b16 v[44:45], v63 offset:2048
v_mul_f32 v46, v32, v33
v_sub_f32 v46, 0, v46
v_mov_b32 v47, v33
v_mov_b32 v48, -1.4426950408889634
v_mov_b32 v49, 1.0
s_waitcnt lgkmcnt(15)
v_pk_add_f32 v[128:129], v[128:129], v[64:65]
v_pk_add_f32 v[130:131], v[130:131], v[66:67]
v_pk_add_f32 v[132:133], v[132:133], v[68:69]
v_pk_add_f32 v[134:135], v[134:135], v[70:71]
v_pk_add_f32 v[136:137], v[136:137], v[72:73]
v_pk_add_f32 v[138:139], v[138:139], v[74:75]
v_pk_add_f32 v[140:141], v[140:141], v[76:77]
v_pk_add_f32 v[142:143], v[142:143], v[78:79]
v_pk_add_f32 v[144:145], v[144:145], v[80:81]
v_pk_add_f32 v[146:147], v[146:147], v[82:83]
s_waitcnt lgkmcnt(10)
v_pk_add_f32 v[128:129], v[128:129], v[84:85]
v_pk_add_f32 v[130:131], v[130:131], v[86:87]
v_pk_add_f32 v[132:133], v[132:133], v[88:89]
v_pk_add_f32 v[134:135], v[134:135], v[90:91]
v_pk_add_f32 v[136:137], v[136:137], v[92:93]
v_pk_add_f32 v[138:139], v[138:139], v[94:95]
v_pk_add_f32 v[140:141], v[140:141], v[96:97]
v_pk_add_f32 v[142:143], v[142:143], v[98:99]
v_pk_add_f32 v[144:145], v[144:145], v[100:101]
v_pk_add_f32 v[146:147], v[146:147], v[102:103]
s_waitcnt lgkmcnt(5)
v_pk_add_f32 v[128:129], v[128:129], v[104:105]
v_pk_add_f32 v[130:131], v[130:131], v[106:107]
v_pk_add_f32 v[132:133], v[132:133], v[108:109]
v_pk_add_f32 v[134:135], v[134:135], v[110:111]
v_pk_add_f32 v[136:137], v[136:137], v[112:113]
v_pk_add_f32 v[138:139], v[138:139], v[114:115]
v_pk_add_f32 v[140:141], v[140:141], v[116:117]
v_pk_add_f32 v[142:143], v[142:143], v[118:119]
v_pk_add_f32 v[144:145], v[144:145], v[120:121]
v_pk_add_f32 v[146:147], v[146:147], v[122:123]
s_waitcnt lgkmcnt(0)
v_lshlrev_b32 v64, 16, v20
v_and_b32 v65, 0xffff0000, v20
v_lshlrev_b32 v66, 16, v21
v_and_b32 v67, 0xffff0000, v21
v_lshlrev_b32 v68, 16, v22
v_and_b32 v69, 0xffff0000, v22
v_lshlrev_b32 v70, 16, v23
v_and_b32 v71, 0xffff0000, v23
v_lshlrev_b32 v72, 16, v24
v_and_b32 v73, 0xffff0000, v24
v_pk_add_f32 v[128:129], v[128:129], v[64:65]
v_pk_add_f32 v[130:131], v[130:131], v[66:67]
v_pk_add_f32 v[132:133], v[132:133], v[68:69]
v_pk_add_f32 v[134:135], v[134:135], v[70:71]
v_pk_add_f32 v[136:137], v[136:137], v[72:73]
v_pk_mul_f32 v[64:65], v[128:129], v[48:49] op_sel_hi:[1,0]
v_pk_mul_f32 v[66:67], v[130:131], v[48:49] op_sel_hi:[1,0]
v_pk_mul_f32 v[68:69], v[132:133], v[48:49] op_sel_hi:[1,0]
v_pk_mul_f32 v[70:71], v[134:135], v[48:49] op_sel_hi:[1,0]
v_pk_mul_f32 v[72:73], v[136:137], v[48:49] op_sel_hi:[1,0]
v_exp_f32 v64, v64
v_exp_f32 v65, v65
v_exp_f32 v66, v66
v_exp_f32 v67, v67
v_exp_f32 v68, v68
v_exp_f32 v69, v69
v_exp_f32 v70, v70
v_exp_f32 v71, v71
v_exp_f32 v72, v72
v_exp_f32 v73, v73
v_lshlrev_b32 v74, 16, v8
v_and_b32 v75, 0xffff0000, v8
v_lshlrev_b32 v76, 16, v9
v_and_b32 v77, 0xffff0000, v9
v_lshlrev_b32 v78, 16, v10
v_and_b32 v79, 0xffff0000, v10
v_lshlrev_b32 v80, 16, v11
v_and_b32 v81, 0xffff0000, v11
v_lshlrev_b32 v82, 16, v12
v_and_b32 v83, 0xffff0000, v12
v_pk_add_f32 v[64:65], v[64:65], v[48:49] op_sel:[0,1] op_sel_hi:[1,1]
v_pk_add_f32 v[66:67], v[66:67], v[48:49] op_sel:[0,1] op_sel_hi:[1,1]
v_pk_add_f32 v[68:69], v[68:69], v[48:49] op_sel:[0,1] op_sel_hi:[1,1]
v_pk_add_f32 v[70:71], v[70:71], v[48:49] op_sel:[0,1] op_sel_hi:[1,1]
v_pk_add_f32 v[72:73], v[72:73], v[48:49] op_sel:[0,1] op_sel_hi:[1,1]
v_rcp_f32 v64, v64
v_rcp_f32 v65, v65
v_rcp_f32 v66, v66
v_rcp_f32 v67, v67
v_rcp_f32 v68, v68
v_rcp_f32 v69, v69
v_rcp_f32 v70, v70
v_rcp_f32 v71, v71
v_rcp_f32 v72, v72
v_rcp_f32 v73, v73
v_lshlrev_b32 v84, 16, v36
v_and_b32 v85, 0xffff0000, v36
v_lshlrev_b32 v86, 16, v37
v_and_b32 v87, 0xffff0000, v37
v_lshlrev_b32 v88, 16, v38
v_and_b32 v89, 0xffff0000, v38
v_lshlrev_b32 v90, 16, v39
v_and_b32 v91, 0xffff0000, v39
v_lshlrev_b32 v92, 16, v40
v_and_b32 v93, 0xffff0000, v40
v_pk_mul_f32 v[64:65], v[64:65], v[128:129]
v_pk_mul_f32 v[66:67], v[66:67], v[130:131]
v_pk_mul_f32 v[68:69], v[68:69], v[132:133]
v_pk_mul_f32 v[70:71], v[70:71], v[134:135]
v_pk_mul_f32 v[72:73], v[72:73], v[136:137]
v_pk_fma_f32 v[128:129], v[74:75], v[46:47], v[46:47] op_sel:[0,1,0] op_sel_hi:[1,1,0]
v_pk_fma_f32 v[130:131], v[76:77], v[46:47], v[46:47] op_sel:[0,1,0] op_sel_hi:[1,1,0]
v_pk_fma_f32 v[132:133], v[78:79], v[46:47], v[46:47] op_sel:[0,1,0] op_sel_hi:[1,1,0]
v_pk_fma_f32 v[134:135], v[80:81], v[46:47], v[46:47] op_sel:[0,1,0] op_sel_hi:[1,1,0]
v_pk_fma_f32 v[136:137], v[82:83], v[46:47], v[46:47] op_sel:[0,1,0] op_sel_hi:[1,1,0]
v_pk_mul_f32 v[128:129], v[128:129], v[84:85]
v_pk_mul_f32 v[130:131], v[130:131], v[86:87]
v_pk_mul_f32 v[132:133], v[132:133], v[88:89]
v_pk_mul_f32 v[134:135], v[134:135], v[90:91]
v_pk_mul_f32 v[136:137], v[136:137], v[92:93]
v_pk_fma_f32 v[128:129], v[128:129], v[64:65], v[74:75]
v_pk_fma_f32 v[130:131], v[130:131], v[66:67], v[76:77]
v_pk_fma_f32 v[132:133], v[132:133], v[68:69], v[78:79]
v_pk_fma_f32 v[134:135], v[134:135], v[70:71], v[80:81]
v_pk_fma_f32 v[136:137], v[136:137], v[72:73], v[82:83]
v_cvt_pk_bf16_f32 v100, v128, v129
v_cvt_pk_bf16_f32 v101, v130, v131
v_cvt_pk_bf16_f32 v102, v132, v133
v_cvt_pk_bf16_f32 v103, v134, v135
v_cvt_pk_bf16_f32 v104, v136, v137
v_lshlrev_b32 v64, 16, v25
v_and_b32 v65, 0xffff0000, v25
v_lshlrev_b32 v66, 16, v26
v_and_b32 v67, 0xffff0000, v26
v_lshlrev_b32 v68, 16, v27
v_and_b32 v69, 0xffff0000, v27
v_lshlrev_b32 v70, 16, v28
v_and_b32 v71, 0xffff0000, v28
v_lshlrev_b32 v72, 16, v29
v_and_b32 v73, 0xffff0000, v29
v_pk_add_f32 v[138:139], v[138:139], v[64:65]
v_pk_add_f32 v[140:141], v[140:141], v[66:67]
v_pk_add_f32 v[142:143], v[142:143], v[68:69]
v_pk_add_f32 v[144:145], v[144:145], v[70:71]
v_pk_add_f32 v[146:147], v[146:147], v[72:73]
v_pk_mul_f32 v[64:65], v[138:139], v[48:49] op_sel_hi:[1,0]
v_pk_mul_f32 v[66:67], v[140:141], v[48:49] op_sel_hi:[1,0]
v_pk_mul_f32 v[68:69], v[142:143], v[48:49] op_sel_hi:[1,0]
v_pk_mul_f32 v[70:71], v[144:145], v[48:49] op_sel_hi:[1,0]
v_pk_mul_f32 v[72:73], v[146:147], v[48:49] op_sel_hi:[1,0]
v_exp_f32 v64, v64
v_exp_f32 v65, v65
v_exp_f32 v66, v66
v_exp_f32 v67, v67
v_exp_f32 v68, v68
v_exp_f32 v69, v69
v_exp_f32 v70, v70
v_exp_f32 v71, v71
v_exp_f32 v72, v72
v_exp_f32 v73, v73
v_lshlrev_b32 v74, 16, v13
v_and_b32 v75, 0xffff0000, v13
v_lshlrev_b32 v76, 16, v14
v_and_b32 v77, 0xffff0000, v14
v_lshlrev_b32 v78, 16, v15
v_and_b32 v79, 0xffff0000, v15
v_lshlrev_b32 v80, 16, v16
v_and_b32 v81, 0xffff0000, v16
v_lshlrev_b32 v82, 16, v17
v_and_b32 v83, 0xffff0000, v17
v_pk_add_f32 v[64:65], v[64:65], v[48:49] op_sel:[0,1] op_sel_hi:[1,1]
v_pk_add_f32 v[66:67], v[66:67], v[48:49] op_sel:[0,1] op_sel_hi:[1,1]
v_pk_add_f32 v[68:69], v[68:69], v[48:49] op_sel:[0,1] op_sel_hi:[1,1]
v_pk_add_f32 v[70:71], v[70:71], v[48:49] op_sel:[0,1] op_sel_hi:[1,1]
v_pk_add_f32 v[72:73], v[72:73], v[48:49] op_sel:[0,1] op_sel_hi:[1,1]
v_rcp_f32 v64, v64
v_rcp_f32 v65, v65
v_rcp_f32 v66, v66
v_rcp_f32 v67, v67
v_rcp_f32 v68, v68
v_rcp_f32 v69, v69
v_rcp_f32 v70, v70
v_rcp_f32 v71, v71
v_rcp_f32 v72, v72
v_rcp_f32 v73, v73
v_lshlrev_b32 v84, 16, v41
v_and_b32 v85, 0xffff0000, v41
v_lshlrev_b32 v86, 16, v42
v_and_b32 v87, 0xffff0000, v42
v_lshlrev_b32 v88, 16, v43
v_and_b32 v89, 0xffff0000, v43
v_lshlrev_b32 v90, 16, v44
v_and_b32 v91, 0xffff0000, v44
v_lshlrev_b32 v92, 16, v45
v_and_b32 v93, 0xffff0000, v45
v_pk_mul_f32 v[64:65], v[64:65], v[138:139]
v_pk_mul_f32 v[66:67], v[66:67], v[140:141]
v_pk_mul_f32 v[68:69], v[68:69], v[142:143]
v_pk_mul_f32 v[70:71], v[70:71], v[144:145]
v_pk_mul_f32 v[72:73], v[72:73], v[146:147]
v_pk_fma_f32 v[138:139], v[74:75], v[46:47], v[46:47] op_sel:[0,1,0] op_sel_hi:[1,1,0]
v_pk_fma_f32 v[140:141], v[76:77], v[46:47], v[46:47] op_sel:[0,1,0] op_sel_hi:[1,1,0]
v_pk_fma_f32 v[142:143], v[78:79], v[46:47], v[46:47] op_sel:[0,1,0] op_sel_hi:[1,1,0]
v_pk_fma_f32 v[144:145], v[80:81], v[46:47], v[46:47] op_sel:[0,1,0] op_sel_hi:[1,1,0]
v_pk_fma_f32 v[146:147], v[82:83], v[46:47], v[46:47] op_sel:[0,1,0] op_sel_hi:[1,1,0]
v_pk_mul_f32 v[138:139], v[138:139], v[84:85]
v_pk_mul_f32 v[140:141], v[140:141], v[86:87]
v_pk_mul_f32 v[142:143], v[142:143], v[88:89]
v_pk_mul_f32 v[144:145], v[144:145], v[90:91]
v_pk_mul_f32 v[146:147], v[146:147], v[92:93]
v_pk_fma_f32 v[138:139], v[138:139], v[64:65], v[74:75]
v_pk_fma_f32 v[140:141], v[140:141], v[66:67], v[76:77]
v_pk_fma_f32 v[142:143], v[142:143], v[68:69], v[78:79]
v_pk_fma_f32 v[144:145], v[144:145], v[70:71], v[80:81]
v_pk_fma_f32 v[146:147], v[146:147], v[72:73], v[82:83]
v_cvt_pk_bf16_f32 v105, v138, v139
v_cvt_pk_bf16_f32 v106, v140, v141
v_cvt_pk_bf16_f32 v107, v142, v143
v_cvt_pk_bf16_f32 v108, v144, v145
v_cvt_pk_bf16_f32 v109, v146, v147
buffer_store_dwordx4 v[100:103], v60, s[28:31], 0 offen
buffer_store_dwordx4 v[104:107], v60, s[28:31], 0 offen offset:16
buffer_store_dwordx2 v[108:109], v60, s[28:31], 0 offen offset:32
L_end:
s_endpgm
L_two_11:
s_waitcnt lgkmcnt(0)
ds_read_b128 v[128:131], v10 offset:240
ds_read_b128 v[132:135], v10 offset:176
ds_read_b128 v[136:139], v10 offset:112
ds_read_b128 v[140:143], v10 offset:48
s_and_b32 s6, s91, 1
s_lshl_b32 s6, s6, 4
s_lshr_b32 s92, s92, s6
s_lshl_b32 s92, s92, 16
s_lshl_b32 s6, s91, 12
s_add_u32 s6, s6, 4194304
s_nop 4
s_waitcnt lgkmcnt(0)
v_lshlrev_b32 v131, 16, v131
v_fma_f32 v176, v131, s92, v176
v_lshlrev_b32 v130, 16, v130
v_fma_f32 v177, v130, s92, v177
v_lshlrev_b32 v129, 16, v129
v_fma_f32 v178, v129, s92, v178
v_lshlrev_b32 v128, 16, v128
v_fma_f32 v179, v128, s92, v179
v_lshlrev_b32 v135, 16, v135
v_fma_f32 v180, v135, s92, v180
v_lshlrev_b32 v134, 16, v134
v_fma_f32 v181, v134, s92, v181
v_lshlrev_b32 v133, 16, v133
v_fma_f32 v182, v133, s92, v182
v_lshlrev_b32 v132, 16, v132
v_fma_f32 v183, v132, s92, v183
v_lshlrev_b32 v139, 16, v139
v_fma_f32 v184, v139, s92, v184
v_lshlrev_b32 v138, 16, v138
v_fma_f32 v185, v138, s92, v185
v_lshlrev_b32 v137, 16, v137
v_fma_f32 v186, v137, s92, v186
v_lshlrev_b32 v136, 16, v136
v_fma_f32 v187, v136, s92, v187
v_lshlrev_b32 v143, 16, v143
v_fma_f32 v188, v143, s92, v188
v_lshlrev_b32 v142, 16, v142
v_fma_f32 v189, v142, s92, v189
v_lshlrev_b32 v141, 16, v141
v_fma_f32 v190, v141, s92, v190
v_lshlrev_b32 v140, 16, v140
v_fma_f32 v191, v140, s92, v191
v_cvt_pk_bf16_f32 v160, v176, v177
v_cvt_pk_bf16_f32 v161, v178, v179
v_cvt_pk_bf16_f32 v162, v180, v181
v_cvt_pk_bf16_f32 v163, v182, v183
buffer_store_dwordx4 v[160:163], v11, s[24:27], s6 offen offset:0 sc1
v_cvt_pk_bf16_f32 v164, v184, v185
v_cvt_pk_bf16_f32 v165, v186, v187
v_cvt_pk_bf16_f32 v166, v188, v189
v_cvt_pk_bf16_f32 v167, v190, v191
buffer_store_dwordx4 v[164:167], v11, s[24:27], s6 offen offset:128 sc1
s_cmp_eq_u32 s87, 3
s_cbranch_scc1 L_short_12
s_mov_b32 s85, s87
s_mul_i32 s6, s85, 30208
s_add_u32 s6, s6, 63488
v_add_u32 v8, s6, v16
s_add_u32 s6, s6, 17536
v_add_u32 v9, s6, v17
v_lshlrev_b32 v10, 5, v18
v_sub_u32 v10, v9, v10
v_add_u32 v10, 2176, v10
s_add_u32 s91, s88, s85
s_lshl_b32 s6, s91, 1
s_and_b32 s6, s6, 0xfffffffc
s_load_dword s92, s[50:51], s6
ds_read_b128 v[128:131], v8 offset:2048
ds_read_b128 v[132:135], v8 offset:2112
ds_read_b128 v[136:139], v8 offset:2176
ds_read_b128 v[140:143], v8 offset:2240
ds_read_b128 v[144:147], v8 offset:2304
ds_read_b128 v[148:151], v8 offset:2368
ds_read_b128 v[152:155], v8 offset:2432
ds_read_b128 v[156:159], v8 offset:2496
ds_read_b128 v[160:163], v9 offset:2176
ds_read_b128 v[164:167], v9 offset:2240
ds_read_b128 v[168:171], v9 offset:2304
v_mov_b32 v176, 0
v_mov_b32 v177, 0
v_mov_b32 v178, 0
v_mov_b32 v179, 0
v_mov_b32 v180, 0
v_mov_b32 v181, 0
v_mov_b32 v182, 0
v_mov_b32 v183, 0
v_mov_b32 v184, 0
v_mov_b32 v185, 0
v_mov_b32 v186, 0
v_mov_b32 v187, 0
v_mov_b32 v188, 0
v_mov_b32 v189, 0
v_mov_b32 v190, 0
v_mov_b32 v191, 0
s_waitcnt lgkmcnt(0)
s_branch L_halfb_13
L_short_12:
buffer_load_dwordx4 a[208:211], v248, s[24:27], s97 offen offset:2048
buffer_load_dwordx4 a[212:215], v248, s[24:27], s97 offen offset:3072
buffer_load_dwordx4 a[216:219], v248, s[24:27], s98 offen
s_add_u32 s97, s97, 5120
s_add_u32 s98, s98, 5120
buffer_load_dwordx4 a[220:223], v248, s[24:27], s97 offen offset:0
buffer_load_dwordx4 a[224:227], v248, s[24:27], s97 offen offset:1024
buffer_load_dwordx4 a[228:231], v248, s[24:27], s97 offen offset:2048
buffer_load_dwordx4 a[232:235], v248, s[24:27], s97 offen offset:3072
buffer_load_dwordx4 a[236:239], v248, s[24:27], s98 offen
s_add_u32 s97, s97, 5120
s_add_u32 s98, s98, 5120
buffer_load_dwordx4 v[208:211], v248, s[24:27], s97 offen offset:0
buffer_load_dwordx4 v[212:215], v248, s[24:27], s97 offen offset:1024
buffer_load_dwordx4 v[216:219], v248, s[24:27], s97 offen offset:2048
buffer_load_dwordx4 v[220:223], v248, s[24:27], s97 offen offset:3072
buffer_load_dwordx4 v[224:227], v248, s[24:27], s98 offen
s_add_u32 s97, s97, 5120
s_add_u32 s98, s98, 5120
buffer_load_dwordx4 v[228:231], v248, s[24:27], s97 offen offset:0
buffer_load_dwordx4 v[232:235], v248, s[24:27], s97 offen offset:1024
buffer_load_dwordx4 v[236:239], v248, s[24:27], s97 offen offset:2048
buffer_load_dwordx4 v[240:243], v248, s[24:27], s97 offen offset:3072
buffer_load_dwordx4 v[244:247], v248, s[24:27], s98 offen
s_add_u32 s97, s97, 5120
s_add_u32 s98, s98, 5120
buffer_load_dword v254, v249, s[24:27], 0 offen sc1
s_waitcnt vmcnt(0)
v_cmp_eq_u32 vcc, 0, v254
s_cbranch_vccnz L_slow_1016
L_back_1017:
s_mul_i32 s6, s94, 54
s_add_u32 s6, s6, s96
s_lshl_b32 s99, s6, 12
s_add_u32 s99, s99, 10485760
s_add_u32 s6, s5, 0
s_and_b32 s6, s6, 3
s_lshl_b32 s6, s6, 10
v_add_u32 v56, s6, v248
s_add_u32 s6, s5, 1
s_and_b32 s6, s6, 3
s_lshl_b32 s6, s6, 10
v_add_u32 v57, s6, v248
s_add_u32 s6, s5, 2
s_and_b32 s6, s6, 3
s_lshl_b32 s6, s6, 10
v_add_u32 v58, s6, v248
s_add_u32 s6, s5, 3
s_and_b32 s6, s6, 3
s_lshl_b32 s6, s6, 10
v_add_u32 v59, s6, v248
buffer_load_dwordx4 v[64:67], v56, s[24:27], s99 offen
buffer_load_dwordx4 v[68:71], v57, s[24:27], s99 offen
buffer_load_dwordx4 v[72:75], v58, s[24:27], s99 offen
buffer_load_dwordx4 v[76:79], v59, s[24:27], s99 offen
s_add_u32 s99, s99, 4096
buffer_load_dwordx4 v[80:83], v56, s[24:27], s99 offen
buffer_load_dwordx4 v[84:87], v57, s[24:27], s99 offen
buffer_load_dwordx4 v[88:91], v58, s[24:27], s99 offen
buffer_load_dwordx4 v[92:95], v59, s[24:27], s99 offen
s_add_u32 s99, s99, 4096
buffer_load_dwordx4 v[96:99], v56, s[24:27], s99 offen
buffer_load_dwordx4 v[100:103], v57, s[24:27], s99 offen
buffer_load_dwordx4 v[104:107], v58, s[24:27], s99 offen
buffer_load_dwordx4 v[108:111], v59, s[24:27], s99 offen
s_add_u32 s99, s99, 4096
s_waitcnt vmcnt(0)
s_branch L_gemm2
L_spare:
s_lshl_b32 s73, s3, 2
s_add_u32 s73, s73, s4
s_sub_u32 s73, s73, 28
s_mov_b32 s32, s46
s_and_b32 s33, s47, 0xffff
s_mov_b32 s34, 5120
s_mov_b32 s35, 0x20000
s_lshr_b32 s6, s4, 3
s_lshl_b32 s7, s3, 2
s_add_u32 s68, s6, s7
s_and_b32 s69, s4, 7
v_mul_u32_u24 v2, 26, v1
v_lshrrev_b32 v2, 8, v2
v_mul_u32_u24 v3, 10, v2
v_sub_u32 v3, v1, v3
s_lshl_b32 s6, s68, 6
s_lshl_b32 s7, s5, 4
s_add_u32 s6, s6, s7
s_mul_i32 s6, s6, 1280
s_mul_i32 s7, s69, 160
s_add_u32 s6, s6, s7
v_mul_u32_u24 v4, 5120, v2
v_lshl_add_u32 v4, v3, 4, v4
v_add_u32 v4, s6, v4
v_subrev_u32 v5, 3840, v4
s_mul_i32 s7, s69, 640
v_lshlrev_b32 v6, 6, v3
v_add_u32 v6, s7, v6
s_mov_b32 exec_hi, 0xff
buffer_load_dwordx4 v[8:11], v5, s[12:15], 0 offen offset:0
buffer_load_dwordx4 v[12:15], v5, s[12:15], 0 offen offset:1280
buffer_load_dwordx4 v[16:19], v5, s[12:15], 0 offen offset:2560
buffer_load_dwordx4 v[20:23], v4, s[12:15], 0 offen offset:0
buffer_load_dwordx4 v[24:27], v4, s[12:15], 0 offen offset:1280
buffer_load_dwordx4 v[28:31], v4, s[12:15], 0 offen offset:2560
buffer_load_dwordx4 v[32:35], v4, s[12:15], 0 offen offset:3840
buffer_load_dwordx4 v[52:55], v6, s[32:35], 0 offen offset:0
buffer_load_dwordx4 v[56:59], v6, s[32:35], 0 offen offset:16
buffer_load_dwordx4 v[60:63], v6, s[32:35], 0 offen offset:32
buffer_load_dwordx4 v[64:67], v6, s[32:35], 0 offen offset:48
buffer_load_dwordx4 v[36:39], v4, s[16:19], 0 offen offset:0
buffer_load_dwordx4 v[40:43], v4, s[16:19], 0 offen offset:1280
buffer_load_dwordx4 v[44:47], v4, s[16:19], 0 offen offset:2560
buffer_load_dwordx4 v[48:51], v4, s[16:19], 0 offen offset:3840
s_lshl_b32 s7, s5, 5
s_sub_u32 s7, 131192, s7
v_mul_u32_u24 v7, 1152, v3
v_lshlrev_b32 v2, 3, v2
v_sub_u32 v7, v7, v2
v_add_u32 v7, s7, v7
s_mov_b64 exec, -1
s_lshl_b32 s6, s73, 6
s_lshl_b32 s7, s5, 4
s_add_u32 s74, s6, s7
v_and_b32 v2, 15, v1
v_lshrrev_b32 v3, 4, v1
v_add_u32 v4, s74, v2
v_mul_u32_u24 v4, 1280, v4
v_lshl_add_u32 v4, v3, 4, v4
buffer_load_dwordx4 a[0:3], v4, s[8:11], 0 offen offset:0
buffer_load_dwordx4 a[4:7], v4, s[8:11], 0 offen offset:64
buffer_load_dwordx4 a[8:11], v4, s[8:11], 0 offen offset:128
buffer_load_dwordx4 a[12:15], v4, s[8:11], 0 offen offset:192
buffer_load_dwordx4 a[16:19], v4, s[8:11], 0 offen offset:256
buffer_load_dwordx4 a[20:23], v4, s[8:11], 0 offen offset:320
buffer_load_dwordx4 a[24:27], v4, s[8:11], 0 offen offset:384
buffer_load_dwordx4 a[28:31], v4, s[8:11], 0 offen offset:448
buffer_load_dwordx4 a[32:35], v4, s[8:11], 0 offen offset:512
buffer_load_dwordx4 a[36:39], v4, s[8:11], 0 offen offset:576
buffer_load_dwordx4 a[40:43], v4, s[8:11], 0 offen offset:640
buffer_load_dwordx4 a[44:47], v4, s[8:11], 0 offen offset:704
buffer_load_dwordx4 a[48:51], v4, s[8:11], 0 offen offset:768
buffer_load_dwordx4 a[52:55], v4, s[8:11], 0 offen offset:832
buffer_load_dwordx4 a[56:59], v4, s[8:11], 0 offen offset:896
buffer_load_dwordx4 a[60:63], v4, s[8:11], 0 offen offset:960
buffer_load_dwordx4 a[64:67], v4, s[8:11], 0 offen offset:1024
buffer_load_dwordx4 a[68:71], v4, s[8:11], 0 offen offset:1088
buffer_load_dwordx4 a[72:75], v4, s[8:11], 0 offen offset:1152
buffer_load_dwordx4 a[76:79], v4, s[8:11], 0 offen offset:1216
s_lshr_b32 s6, s3, 1
s_lshl_b32 s6, s6, 2
s_and_b32 s7, s4, 3
s_add_u32 s77, s6, s7
s_and_b32 s6, s3, 1
s_mul_i32 s6, s6, 7
s_lshr_b32 s7, s4, 2
s_add_u32 s78, s6, s7
s_and_b32 s82, s5, 1
s_lshr_b32 s83, s5, 1
s_lshl_b32 s6, s3, 4
s_lshr_b32 s7, s4, 1
s_add_u32 s6, s6, s7
s_mul_i32 s6, s6, 5
s_and_b32 s89, s4, 1
s_lshl_b32 s7, s89, 1
s_add_u32 s88, s6, s7
s_lshr_b32 s6, s3, 1
s_lshl_b32 s6, s6, 3
s_and_b32 s7, s4, 7
s_add_u32 s94, s6, s7
s_and_b32 s6, s3, 1
s_lshl_b32 s6, s6, 2
s_lshr_b32 s7, s4, 3
s_add_u32 s95, s6, s7
s_mul_i32 s96, s5, 14
s_cmp_eq_u32 s5, 3
s_cselect_b32 s6, 1, 0
s_sub_u32 s96, s96, s6
v_lshlrev_b32 v2, 2, v1
s_lshr_b32 s43, s95, 1
v_add_u32 v2, s43, v2
v_mov_b32 v3, 0
s_lshl_b32 s6, s77, 1
s_sub_u32 s6, s6, 54
v_add_u32 v4, s6, v1
v_and_b32 v5, 3, v4
v_add_u32 v5, 28, v5
v_lshrrev_b32 v4, 2, v4
v_lshl_add_u32 v4, v5, 3, v4
v_cmp_lt_u32 vcc, 53, v1
v_cndmask_b32 v2, v2, v4, vcc
v_mov_b32 v5, 4
v_cndmask_b32 v3, v3, v5, vcc
s_lshr_b32 s6, s4, 2
s_lshl_b32 s6, s6, 1
s_sub_u32 s6, s6, 56
v_add_u32 v4, s6, v1
s_and_b32 s7, s3, 1
s_sub_u32 s6, 13, s7
v_min_u32 v4, s6, v4
v_and_b32 v5, 3, v4
v_add_u32 v5, 28, v5
v_lshrrev_b32 v4, 2, v4
v_lshlrev_b32 v4, 1, v4
v_add_u32 v4, s7, v4
v_lshl_add_u32 v4, v5, 3, v4
v_cmp_lt_u32 vcc, 55, v1
v_cndmask_b32 v2, v2, v4, vcc
v_mov_b32 v5, 8
v_cndmask_b32 v3, v3, v5, vcc
v_cmp_lt_u32 vcc, 57, v1
v_mov_b32 v4, s43
v_cndmask_b32 v2, v2, v4, vcc
v_mov_b32 v5, 0
v_cndmask_b32 v3, v3, v5, vcc
v_lshl_add_u32 v228, v2, 7, v3
v_and_b32 v2, 31, v1
v_and_b32 v3, 7, v2
v_lshrrev_b32 v2, 3, v2
v_lshlrev_b32 v2, 3, v2
v_add_u32 v2, s3, v2
v_lshl_add_u32 v2, v2, 3, v3
v_lshlrev_b32 v229, 7, v2
v_cmp_gt_u32 vcc, 14, v1
v_cndmask_b32 v2, 0, v1, vcc
v_cmp_lt_u32 vcc, 6, v2
v_cndmask_b32 v3, 0, 1, vcc
v_mul_u32_u24 v4, 7, v3
v_sub_u32 v2, v2, v4
s_lshr_b32 s6, s94, 1
s_and_b32 s7, s6, 3
s_lshr_b32 s6, s6, 2
s_lshl_b32 s6, s6, 1
v_lshlrev_b32 v2, 2, v2
v_add_u32 v2, s7, v2
v_add_u32 v3, s6, v3
v_lshl_add_u32 v2, v2, 3, v3
v_lshlrev_b32 v2, 7, v2
v_add_u32 v249, 16, v2
v_and_b32 v2, 31, v1
v_lshlrev_b32 v2, 3, v2
v_add_u32 v2, s95, v2
v_lshlrev_b32 v2, 7, v2
v_add_u32 v250, 20, v2
s_mov_b32 s36, s56
s_and_b32 s37, s57, 0xffff
s_mov_b32 s38, 3456
s_mov_b32 s39, 0x20000
s_lshr_b32 s6, s3, 1
s_lshl_b32 s6, s6, 2
s_add_u32 s6, s6, s4
s_sub_u32 s6, s6, 28
s_and_b32 s7, s3, 1
s_mul_i32 s75, s7, 14
s_add_u32 s75, s75, s6
s_sub_u32 s7, 14, s7
s_cmp_lt_u32 s6, s7
s_cselect_b32 s76, 0, 2147418112
s_cselect_b32 s75, s75, 0
v_lshrrev_b32 v2, 3, v0
v_and_b32 v3, 7, v0
v_mul_u32_u24 v4, 3456, v2
v_lshl_add_u32 v4, v3, 4, v4
v_add_u32 v211, s76, v4
s_lshl_b32 s93, s75, 7
v_lshlrev_b32 v5, 1, v1
v_add_u32 v212, s93, v5
v_add_u32 v212, s76, v212
s_waitcnt vmcnt(24)
s_cmp_lg_u32 s5, 0
s_cbranch_scc1 L_arr_21
s_and_b32 s6, s2, 7
s_lshl_b32 s6, s6, 5
v_mov_b32 v2, s6
s_mov_b64 exec, 1
buffer_atomic_add v253, v2, s[52:55], 0 offen sc1
s_mov_b64 exec, -1
L_arr_21:
v_lshlrev_b32 v68, 16, v52
v_lshlrev_b32 v69, 16, v54
v_and_b32 v76, 0xffff0000, v52
v_and_b32 v77, 0xffff0000, v54
buffer_load_dwordx4 v[130:133], v211, s[20:23], s93 offen
v_lshlrev_b32 v84, 16, v53
v_lshlrev_b32 v85, 16, v55
v_and_b32 v92, 0xffff0000, v53
v_and_b32 v93, 0xffff0000, v55
s_add_u32 s93, s93, 110592
v_lshlrev_b32 v70, 16, v56
v_lshlrev_b32 v71, 16, v58
v_and_b32 v78, 0xffff0000, v56
v_and_b32 v79, 0xffff0000, v58
buffer_load_dwordx4 v[134:137], v211, s[20:23], s93 offen
v_lshlrev_b32 v86, 16, v57
v_lshlrev_b32 v87, 16, v59
v_and_b32 v94, 0xffff0000, v57
v_and_b32 v95, 0xffff0000, v59
s_add_u32 s93, s93, 110592
v_lshlrev_b32 v72, 16, v60
v_lshlrev_b32 v73, 16, v62
v_and_b32 v80, 0xffff0000, v60
v_and_b32 v81, 0xffff0000, v62
buffer_load_dwordx4 v[138:141], v211, s[20:23], s93 offen
v_lshlrev_b32 v88, 16, v61
v_lshlrev_b32 v89, 16, v63
v_and_b32 v96, 0xffff0000, v61
v_and_b32 v97, 0xffff0000, v63
s_add_u32 s93, s93, 110592
v_lshlrev_b32 v74, 16, v64
v_lshlrev_b32 v75, 16, v66
v_and_b32 v82, 0xffff0000, v64
v_and_b32 v83, 0xffff0000, v66
v_lshlrev_b32 v90, 16, v65
v_lshlrev_b32 v91, 16, v67
v_and_b32 v98, 0xffff0000, v65
v_and_b32 v99, 0xffff0000, v67
s_waitcnt vmcnt(23)
v_lshlrev_b32 v100, 16, v8
v_and_b32 v101, 0xffff0000, v8
v_lshlrev_b32 v102, 16, v12
v_and_b32 v103, 0xffff0000, v12
v_lshlrev_b32 v104, 16, v16
v_and_b32 v105, 0xffff0000, v16
v_lshlrev_b32 v106, 16, v20
v_and_b32 v107, 0xffff0000, v20
v_lshlrev_b32 v108, 16, v24
v_and_b32 v109, 0xffff0000, v24
v_lshlrev_b32 v110, 16, v28
v_and_b32 v111, 0xffff0000, v28
buffer_load_dwordx4 v[142:145], v211, s[20:23], s93 offen
v_lshlrev_b32 v112, 16, v32
v_and_b32 v113, 0xffff0000, v32
v_lshlrev_b32 v114, 16, v36
v_and_b32 v115, 0xffff0000, v36
v_lshlrev_b32 v116, 16, v40
v_and_b32 v117, 0xffff0000, v40
v_lshlrev_b32 v118, 16, v44
v_and_b32 v119, 0xffff0000, v44
v_lshlrev_b32 v120, 16, v48
v_and_b32 v121, 0xffff0000, v48
v_pk_mul_f32 v[122:123], v[106:107], v[68:69]
v_pk_mul_f32 v[124:125], v[108:109], v[68:69]
s_add_u32 s93, s93, 110592
v_pk_mul_f32 v[126:127], v[110:111], v[68:69]
v_pk_mul_f32 v[128:129], v[112:113], v[68:69]
v_pk_fma_f32 v[122:123], v[104:105], v[76:77], v[122:123]
v_pk_fma_f32 v[124:125], v[106:107], v[76:77], v[124:125]
v_pk_fma_f32 v[126:127], v[108:109], v[76:77], v[126:127]
v_pk_fma_f32 v[128:129], v[110:111], v[76:77], v[128:129]
v_pk_fma_f32 v[122:123], v[102:103], v[84:85], v[122:123]
v_pk_fma_f32 v[124:125], v[104:105], v[84:85], v[124:125]
v_pk_fma_f32 v[126:127], v[106:107], v[84:85], v[126:127]
v_pk_fma_f32 v[128:129], v[108:109], v[84:85], v[128:129]
v_pk_fma_f32 v[122:123], v[100:101], v[92:93], v[122:123]
v_pk_fma_f32 v[124:125], v[102:103], v[92:93], v[124:125]
buffer_load_dwordx4 v[146:149], v211, s[20:23], s93 offen
v_pk_fma_f32 v[126:127], v[104:105], v[92:93], v[126:127]
v_pk_fma_f32 v[128:129], v[106:107], v[92:93], v[128:129]
v_pk_mul_f32 v[122:123], v[122:123], v[114:115]
v_pk_mul_f32 v[124:125], v[124:125], v[116:117]
v_pk_mul_f32 v[126:127], v[126:127], v[118:119]
v_pk_mul_f32 v[128:129], v[128:129], v[120:121]
s_mov_b32 exec_hi, 0xff
v_cvt_pk_bf16_f32 v100, v128, v126
v_cvt_pk_bf16_f32 v101, v124, v122
ds_write_b64 v7, v[100:101] offset:0
v_cvt_pk_bf16_f32 v102, v129, v127
v_cvt_pk_bf16_f32 v103, v125, v123
ds_write_b64 v7, v[102:103] offset:144
s_mov_b64 exec, -1
v_lshlrev_b32 v100, 16, v9
v_and_b32 v101, 0xffff0000, v9
v_lshlrev_b32 v102, 16, v13
v_and_b32 v103, 0xffff0000, v13
v_lshlrev_b32 v104, 16, v17
v_and_b32 v105, 0xffff0000, v17
s_add_u32 s93, s93, 110592
v_lshlrev_b32 v106, 16, v21
v_and_b32 v107, 0xffff0000, v21
v_lshlrev_b32 v108, 16, v25
v_and_b32 v109, 0xffff0000, v25
v_lshlrev_b32 v110, 16, v29
v_and_b32 v111, 0xffff0000, v29
v_lshlrev_b32 v112, 16, v33
v_and_b32 v113, 0xffff0000, v33
v_lshlrev_b32 v114, 16, v37
v_and_b32 v115, 0xffff0000, v37
v_lshlrev_b32 v116, 16, v41
v_and_b32 v117, 0xffff0000, v41
buffer_load_dwordx4 v[150:153], v211, s[20:23], s93 offen
v_lshlrev_b32 v118, 16, v45
v_and_b32 v119, 0xffff0000, v45
v_lshlrev_b32 v120, 16, v49
v_and_b32 v121, 0xffff0000, v49
v_pk_mul_f32 v[122:123], v[106:107], v[70:71]
v_pk_mul_f32 v[124:125], v[108:109], v[70:71]
v_pk_mul_f32 v[126:127], v[110:111], v[70:71]
v_pk_mul_f32 v[128:129], v[112:113], v[70:71]
v_pk_fma_f32 v[122:123], v[104:105], v[78:79], v[122:123]
v_pk_fma_f32 v[124:125], v[106:107], v[78:79], v[124:125]
v_pk_fma_f32 v[126:127], v[108:109], v[78:79], v[126:127]
v_pk_fma_f32 v[128:129], v[110:111], v[78:79], v[128:129]
s_add_u32 s93, s93, 110592
v_pk_fma_f32 v[122:123], v[102:103], v[86:87], v[122:123]
v_pk_fma_f32 v[124:125], v[104:105], v[86:87], v[124:125]
v_pk_fma_f32 v[126:127], v[106:107], v[86:87], v[126:127]
v_pk_fma_f32 v[128:129], v[108:109], v[86:87], v[128:129]
v_pk_fma_f32 v[122:123], v[100:101], v[94:95], v[122:123]
v_pk_fma_f32 v[124:125], v[102:103], v[94:95], v[124:125]
v_pk_fma_f32 v[126:127], v[104:105], v[94:95], v[126:127]
v_pk_fma_f32 v[128:129], v[106:107], v[94:95], v[128:129]
v_pk_mul_f32 v[122:123], v[122:123], v[114:115]
v_pk_mul_f32 v[124:125], v[124:125], v[116:117]
v_pk_mul_f32 v[126:127], v[126:127], v[118:119]
v_pk_mul_f32 v[128:129], v[128:129], v[120:121]
buffer_load_dwordx4 v[154:157], v211, s[20:23], s93 offen
s_mov_b32 exec_hi, 0xff
v_cvt_pk_bf16_f32 v100, v128, v126
v_cvt_pk_bf16_f32 v101, v124, v122
ds_write_b64 v7, v[100:101] offset:288
v_cvt_pk_bf16_f32 v102, v129, v127
v_cvt_pk_bf16_f32 v103, v125, v123
ds_write_b64 v7, v[102:103] offset:432
s_mov_b64 exec, -1
v_lshlrev_b32 v100, 16, v10
v_and_b32 v101, 0xffff0000, v10
v_lshlrev_b32 v102, 16, v14
v_and_b32 v103, 0xffff0000, v14
v_lshlrev_b32 v104, 16, v18
v_and_b32 v105, 0xffff0000, v18
v_lshlrev_b32 v106, 16, v22
v_and_b32 v107, 0xffff0000, v22
v_lshlrev_b32 v108, 16, v26
v_and_b32 v109, 0xffff0000, v26
v_lshlrev_b32 v110, 16, v30
v_and_b32 v111, 0xffff0000, v30
s_add_u32 s93, s93, 110592
v_lshlrev_b32 v112, 16, v34
v_and_b32 v113, 0xffff0000, v34
v_lshlrev_b32 v114, 16, v38
v_and_b32 v115, 0xffff0000, v38
v_lshlrev_b32 v116, 16, v42
v_and_b32 v117, 0xffff0000, v42
v_lshlrev_b32 v118, 16, v46
v_and_b32 v119, 0xffff0000, v46
v_lshlrev_b32 v120, 16, v50
v_and_b32 v121, 0xffff0000, v50
v_pk_mul_f32 v[122:123], v[106:107], v[72:73]
v_pk_mul_f32 v[124:125], v[108:109], v[72:73]
buffer_load_dwordx4 v[158:161], v211, s[20:23], s93 offen
v_pk_mul_f32 v[126:127], v[110:111], v[72:73]
v_pk_mul_f32 v[128:129], v[112:113], v[72:73]
v_pk_fma_f32 v[122:123], v[104:105], v[80:81], v[122:123]
v_pk_fma_f32 v[124:125], v[106:107], v[80:81], v[124:125]
v_pk_fma_f32 v[126:127], v[108:109], v[80:81], v[126:127]
v_pk_fma_f32 v[128:129], v[110:111], v[80:81], v[128:129]
v_pk_fma_f32 v[122:123], v[102:103], v[88:89], v[122:123]
v_pk_fma_f32 v[124:125], v[104:105], v[88:89], v[124:125]
v_pk_fma_f32 v[126:127], v[106:107], v[88:89], v[126:127]
v_pk_fma_f32 v[128:129], v[108:109], v[88:89], v[128:129]
v_pk_fma_f32 v[122:123], v[100:101], v[96:97], v[122:123]
v_pk_fma_f32 v[124:125], v[102:103], v[96:97], v[124:125]
s_add_u32 s93, s93, 110592
v_pk_fma_f32 v[126:127], v[104:105], v[96:97], v[126:127]
v_pk_fma_f32 v[128:129], v[106:107], v[96:97], v[128:129]
v_pk_mul_f32 v[122:123], v[122:123], v[114:115]
v_pk_mul_f32 v[124:125], v[124:125], v[116:117]
v_pk_mul_f32 v[126:127], v[126:127], v[118:119]
v_pk_mul_f32 v[128:129], v[128:129], v[120:121]
s_mov_b32 exec_hi, 0xff
v_cvt_pk_bf16_f32 v100, v128, v126
v_cvt_pk_bf16_f32 v101, v124, v122
ds_write_b64 v7, v[100:101] offset:576
v_cvt_pk_bf16_f32 v102, v129, v127
v_cvt_pk_bf16_f32 v103, v125, v123
ds_write_b64 v7, v[102:103] offset:720
s_mov_b64 exec, -1
v_lshlrev_b32 v100, 16, v11
v_and_b32 v101, 0xffff0000, v11
v_lshlrev_b32 v102, 16, v15
v_and_b32 v103, 0xffff0000, v15
v_lshlrev_b32 v104, 16, v19
v_and_b32 v105, 0xffff0000, v19
buffer_load_dwordx4 v[162:165], v211, s[20:23], s93 offen
v_lshlrev_b32 v106, 16, v23
v_and_b32 v107, 0xffff0000, v23
v_lshlrev_b32 v108, 16, v27
v_and_b32 v109, 0xffff0000, v27
v_lshlrev_b32 v110, 16, v31
v_and_b32 v111, 0xffff0000, v31
v_lshlrev_b32 v112, 16, v35
v_and_b32 v113, 0xffff0000, v35
v_lshlrev_b32 v114, 16, v39
v_and_b32 v115, 0xffff0000, v39
v_lshlrev_b32 v116, 16, v43
v_and_b32 v117, 0xffff0000, v43
s_add_u32 s93, s93, 110592
v_lshlrev_b32 v118, 16, v47
v_and_b32 v119, 0xffff0000, v47
v_lshlrev_b32 v120, 16, v51
v_and_b32 v121, 0xffff0000, v51
v_pk_mul_f32 v[122:123], v[106:107], v[74:75]
v_pk_mul_f32 v[124:125], v[108:109], v[74:75]
v_pk_mul_f32 v[126:127], v[110:111], v[74:75]
v_pk_mul_f32 v[128:129], v[112:113], v[74:75]
v_pk_fma_f32 v[122:123], v[104:105], v[82:83], v[122:123]
v_pk_fma_f32 v[124:125], v[106:107], v[82:83], v[124:125]
v_pk_fma_f32 v[126:127], v[108:109], v[82:83], v[126:127]
v_pk_fma_f32 v[128:129], v[110:111], v[82:83], v[128:129]
buffer_load_dwordx4 v[166:169], v211, s[20:23], s93 offen
v_pk_fma_f32 v[122:123], v[102:103], v[90:91], v[122:123]
v_pk_fma_f32 v[124:125], v[104:105], v[90:91], v[124:125]
v_pk_fma_f32 v[126:127], v[106:107], v[90:91], v[126:127]
v_pk_fma_f32 v[128:129], v[108:109], v[90:91], v[128:129]
v_pk_fma_f32 v[122:123], v[100:101], v[98:99], v[122:123]
v_pk_fma_f32 v[124:125], v[102:103], v[98:99], v[124:125]
v_pk_fma_f32 v[126:127], v[104:105], v[98:99], v[126:127]
v_pk_fma_f32 v[128:129], v[106:107], v[98:99], v[128:129]
v_pk_mul_f32 v[122:123], v[122:123], v[114:115]
v_pk_mul_f32 v[124:125], v[124:125], v[116:117]
v_pk_mul_f32 v[126:127], v[126:127], v[118:119]
v_pk_mul_f32 v[128:129], v[128:129], v[120:121]
s_add_u32 s93, s93, 110592
s_mov_b32 exec_hi, 0xff
v_cvt_pk_bf16_f32 v100, v128, v126
v_cvt_pk_bf16_f32 v101, v124, v122
ds_write_b64 v7, v[100:101] offset:864
v_cvt_pk_bf16_f32 v102, v129, v127
v_cvt_pk_bf16_f32 v103, v125, v123
ds_write_b64 v7, v[102:103] offset:1008
s_mov_b64 exec, -1
buffer_load_dwordx4 v[170:173], v211, s[20:23], s93 offen
s_add_u32 s93, s93, 110592
buffer_load_dwordx4 v[174:177], v211, s[20:23], s93 offen
s_add_u32 s93, s93, 110592
buffer_load_dwordx4 v[178:181], v211, s[20:23], s93 offen
s_add_u32 s93, s93, 110592
buffer_load_dwordx4 v[182:185], v211, s[20:23], s93 offen
s_add_u32 s93, s93, 110592
buffer_load_dwordx4 v[186:189], v211, s[20:23], s93 offen
s_add_u32 s93, s93, 110592
buffer_load_dwordx4 v[190:193], v211, s[20:23], s93 offen
s_add_u32 s93, s93, 110592
buffer_load_dwordx4 v[194:197], v211, s[20:23], s93 offen
s_add_u32 s93, s93, 110592
buffer_load_dwordx4 v[198:201], v211, s[20:23], s93 offen
s_add_u32 s93, s93, 110592
buffer_load_dwordx4 v[202:205], v211, s[20:23], s93 offen
s_add_u32 s93, s93, 110592
buffer_load_dwordx4 v[206:209], v211, s[20:23], s93 offen
buffer_load_ushort v210, v212, s[36:39], 0 offen
v_lshrrev_b32 v2, 3, v1
s_mul_i32 s6, s5, 20
v_add_u32 v2, s6, v2
v_and_b32 v3, 7, v1
v_lshlrev_b32 v3, 4, v3
v_mul_u32_u24 v4, 144, v2
v_add_u32 v4, v4, v3
v_add_u32 v4, 131072, v4
v_lshl_add_u32 v5, v2, 12, v3
s_mul_i32 s6, s69, 327680
s_lshl_b32 s7, s68, 7
s_sub_u32 s6, s6, s7
s_add_u32 s70, s6, 1052544
s_add_u32 s71, s70, 32768
s_add_u32 s72, s70, 65536
s_waitcnt lgkmcnt(0)
s_barrier
ds_read_b128 v[8:11], v4
ds_read_b128 v[12:15], v4 offset:1152
ds_read_b128 v[16:19], v4 offset:2304
s_waitcnt lgkmcnt(2)
buffer_store_dwordx4 v[8:11], v5, s[24:27], s70 offen sc1
s_waitcnt lgkmcnt(1)
buffer_store_dwordx4 v[12:15], v5, s[24:27], s71 offen sc1
s_waitcnt lgkmcnt(0)
s_mov_b32 exec_hi, 0
buffer_store_dwordx4 v[16:19], v5, s[24:27], s72 offen sc1
s_mov_b64 exec, -1
v_mov_b32 v24, 0x3f803f80
v_mov_b32 v25, 0x3f803f80
v_mov_b32 v26, 0x3f803f80
v_mov_b32 v27, 0x3f803f80
v_mov_b32 v28, 0
v_mov_b32 v29, 0
v_mov_b32 v30, 0
v_mov_b32 v31, 0
v_mov_b32 v32, 0
v_mov_b32 v33, 0
v_mov_b32 v34, 0
v_mov_b32 v35, 0
s_waitcnt vmcnt(43)
v_mfma_f32_16x16x32_bf16 v[28:31], a[0:3], a[0:3], v[28:31]
v_mfma_f32_16x16x32_bf16 v[32:35], a[0:3], v[24:27], v[32:35]
s_waitcnt vmcnt(42)
v_mfma_f32_16x16x32_bf16 v[28:31], a[4:7], a[4:7], v[28:31]
v_mfma_f32_16x16x32_bf16 v[32:35], a[4:7], v[24:27], v[32:35]
s_waitcnt vmcnt(41)
v_mfma_f32_16x16x32_bf16 v[28:31], a[8:11], a[8:11], v[28:31]
v_mfma_f32_16x16x32_bf16 v[32:35], a[8:11], v[24:27], v[32:35]
s_waitcnt vmcnt(40)
v_mfma_f32_16x16x32_bf16 v[28:31], a[12:15], a[12:15], v[28:31]
v_mfma_f32_16x16x32_bf16 v[32:35], a[12:15], v[24:27], v[32:35]
s_waitcnt vmcnt(39)
v_mfma_f32_16x16x32_bf16 v[28:31], a[16:19], a[16:19], v[28:31]
v_mfma_f32_16x16x32_bf16 v[32:35], a[16:19], v[24:27], v[32:35]
s_waitcnt vmcnt(38)
v_mfma_f32_16x16x32_bf16 v[28:31], a[20:23], a[20:23], v[28:31]
v_mfma_f32_16x16x32_bf16 v[32:35], a[20:23], v[24:27], v[32:35]
s_waitcnt vmcnt(37)
v_mfma_f32_16x16x32_bf16 v[28:31], a[24:27], a[24:27], v[28:31]
v_mfma_f32_16x16x32_bf16 v[32:35], a[24:27], v[24:27], v[32:35]
s_waitcnt vmcnt(36)
v_mfma_f32_16x16x32_bf16 v[28:31], a[28:31], a[28:31], v[28:31]
v_mfma_f32_16x16x32_bf16 v[32:35], a[28:31], v[24:27], v[32:35]
s_waitcnt vmcnt(35)
v_mfma_f32_16x16x32_bf16 v[28:31], a[32:35], a[32:35], v[28:31]
v_mfma_f32_16x16x32_bf16 v[32:35], a[32:35], v[24:27], v[32:35]
s_waitcnt vmcnt(34)
v_mfma_f32_16x16x32_bf16 v[28:31], a[36:39], a[36:39], v[28:31]
v_mfma_f32_16x16x32_bf16 v[32:35], a[36:39], v[24:27], v[32:35]
s_waitcnt vmcnt(33)
v_mfma_f32_16x16x32_bf16 v[28:31], a[40:43], a[40:43], v[28:31]
v_mfma_f32_16x16x32_bf16 v[32:35], a[40:43], v[24:27], v[32:35]
s_waitcnt vmcnt(32)
v_mfma_f32_16x16x32_bf16 v[28:31], a[44:47], a[44:47], v[28:31]
v_mfma_f32_16x16x32_bf16 v[32:35], a[44:47], v[24:27], v[32:35]
s_waitcnt vmcnt(31)
v_mfma_f32_16x16x32_bf16 v[28:31], a[48:51], a[48:51], v[28:31]
v_mfma_f32_16x16x32_bf16 v[32:35], a[48:51], v[24:27], v[32:35]
s_waitcnt vmcnt(30)
v_mfma_f32_16x16x32_bf16 v[28:31], a[52:55], a[52:55], v[28:31]
v_mfma_f32_16x16x32_bf16 v[32:35], a[52:55], v[24:27], v[32:35]
s_waitcnt vmcnt(29)
v_mfma_f32_16x16x32_bf16 v[28:31], a[56:59], a[56:59], v[28:31]
v_mfma_f32_16x16x32_bf16 v[32:35], a[56:59], v[24:27], v[32:35]
s_waitcnt vmcnt(28)
v_mfma_f32_16x16x32_bf16 v[28:31], a[60:63], a[60:63], v[28:31]
v_mfma_f32_16x16x32_bf16 v[32:35], a[60:63], v[24:27], v[32:35]
s_waitcnt vmcnt(27)
v_mfma_f32_16x16x32_bf16 v[28:31], a[64:67], a[64:67], v[28:31]
v_mfma_f32_16x16x32_bf16 v[32:35], a[64:67], v[24:27], v[32:35]
s_waitcnt vmcnt(26)
v_mfma_f32_16x16x32_bf16 v[28:31], a[68:71], a[68:71], v[28:31]
v_mfma_f32_16x16x32_bf16 v[32:35], a[68:71], v[24:27], v[32:35]
s_waitcnt vmcnt(25)
v_mfma_f32_16x16x32_bf16 v[28:31], a[72:75], a[72:75], v[28:31]
v_mfma_f32_16x16x32_bf16 v[32:35], a[72:75], v[24:27], v[32:35]
s_waitcnt vmcnt(24)
v_mfma_f32_16x16x32_bf16 v[28:31], a[76:79], a[76:79], v[28:31]
v_mfma_f32_16x16x32_bf16 v[32:35], a[76:79], v[24:27], v[32:35]
v_and_b32 v5, 1, v1
v_cmp_eq_u32 vcc, 1, v5
v_and_b32 v5, 2, v1
v_cmp_eq_u32 s[6:7], 2, v5
s_nop 7
v_cndmask_b32 v2, v28, v29, vcc
v_cndmask_b32 v3, v30, v31, vcc
v_cndmask_b32 v4, v32, v33, vcc
v_cndmask_b32 v5, v34, v35, vcc
v_cndmask_b32 v2, v2, v3, s[6:7]
v_cndmask_b32 v3, v4, v5, s[6:7]
v_mul_f32 v24, 0.0015625, v3
v_mul_f32 v2, 0.0015625, v2
v_fma_f32 v2, -v24, v24, v2
v_max_f32 v2, 0, v2
v_add_f32 v2, 0x3727c5ac, v2
v_sqrt_f32 v26, v2
s_nop 0
v_rcp_f32 v25, v26
v_mov_b32 v27, 0
v_sub_f32 v3, 0, v24
v_cvt_pk_bf16_f32 v4, v26, v3
v_lshlrev_b32 v5, 16, v4
v_and_b32 v6, 0xffff0000, v4
v_sub_f32 v5, v26, v5
v_sub_f32 v6, v3, v6
v_cvt_pk_bf16_f32 v5, v5, v6
s_mov_b32 s6, 0x05040100
s_mov_b32 s7, 0x07060302
v_perm_b32 v28, v5, v4, s6
v_perm_b32 v29, v5, v4, s7
v_mov_b32 v30, v29
v_mov_b32 v31, 0
v_lshrrev_b32 v3, 4, v1
v_and_b32 v5, 3, v1
v_lshl_add_u32 v5, v3, 2, v5
v_add_u32 v5, s74, v5
v_lshlrev_b32 v5, 4, v5
s_mov_b32 s6, 65536
s_mov_b32 s7, 98304
s_mov_b32 exec_lo, 0x00f0000f
s_mov_b32 exec_hi, 0xf0000f00
buffer_store_dwordx4 v[28:31], v5, s[24:27], s6 offen sc1
buffer_store_dwordx4 v[24:27], v5, s[24:27], s7 offen sc1
s_mov_b64 exec, -1
v_mov_b32 v36, 0
v_mov_b32 v37, 0
v_mov_b32 v38, 0
v_mov_b32 v39, 0
v_mov_b32 v40, 0
v_mov_b32 v41, 0
v_mov_b32 v42, 0
v_mov_b32 v43, 0
s_waitcnt vmcnt(25)
v_lshlrev_b32 v2, 16, v130
v_and_b32 v3, 0xffff0000, v130
v_pk_add_f32 v[36:37], v[36:37], v[2:3]
v_lshlrev_b32 v2, 16, v131
v_and_b32 v3, 0xffff0000, v131
v_pk_add_f32 v[38:39], v[38:39], v[2:3]
v_lshlrev_b32 v2, 16, v132
v_and_b32 v3, 0xffff0000, v132
v_pk_add_f32 v[40:41], v[40:41], v[2:3]
v_lshlrev_b32 v2, 16, v133
v_and_b32 v3, 0xffff0000, v133
v_pk_add_f32 v[42:43], v[42:43], v[2:3]
s_waitcnt vmcnt(24)
v_lshlrev_b32 v2, 16, v134
v_and_b32 v3, 0xffff0000, v134
v_pk_add_f32 v[36:37], v[36:37], v[2:3]
v_lshlrev_b32 v2, 16, v135
v_and_b32 v3, 0xffff0000, v135
v_pk_add_f32 v[38:39], v[38:39], v[2:3]
v_lshlrev_b32 v2, 16, v136
v_and_b32 v3, 0xffff0000, v136
v_pk_add_f32 v[40:41], v[40:41], v[2:3]
v_lshlrev_b32 v2, 16, v137
v_and_b32 v3, 0xffff0000, v137
v_pk_add_f32 v[42:43], v[42:43], v[2:3]
s_waitcnt vmcnt(23)
v_lshlrev_b32 v2, 16, v138
v_and_b32 v3, 0xffff0000, v138
v_pk_add_f32 v[36:37], v[36:37], v[2:3]
v_lshlrev_b32 v2, 16, v139
v_and_b32 v3, 0xffff0000, v139
v_pk_add_f32 v[38:39], v[38:39], v[2:3]
v_lshlrev_b32 v2, 16, v140
v_and_b32 v3, 0xffff0000, v140
v_pk_add_f32 v[40:41], v[40:41], v[2:3]
v_lshlrev_b32 v2, 16, v141
v_and_b32 v3, 0xffff0000, v141
v_pk_add_f32 v[42:43], v[42:43], v[2:3]
s_waitcnt vmcnt(22)
v_lshlrev_b32 v2, 16, v142
v_and_b32 v3, 0xffff0000, v142
v_pk_add_f32 v[36:37], v[36:37], v[2:3]
v_lshlrev_b32 v2, 16, v143
v_and_b32 v3, 0xffff0000, v143
v_pk_add_f32 v[38:39], v[38:39], v[2:3]
v_lshlrev_b32 v2, 16, v144
v_and_b32 v3, 0xffff0000, v144
v_pk_add_f32 v[40:41], v[40:41], v[2:3]
v_lshlrev_b32 v2, 16, v145
v_and_b32 v3, 0xffff0000, v145
v_pk_add_f32 v[42:43], v[42:43], v[2:3]
s_waitcnt vmcnt(21)
v_lshlrev_b32 v2, 16, v146
v_and_b32 v3, 0xffff0000, v146
v_pk_add_f32 v[36:37], v[36:37], v[2:3]
v_lshlrev_b32 v2, 16, v147
v_and_b32 v3, 0xffff0000, v147
v_pk_add_f32 v[38:39], v[38:39], v[2:3]
v_lshlrev_b32 v2, 16, v148
v_and_b32 v3, 0xffff0000, v148
v_pk_add_f32 v[40:41], v[40:41], v[2:3]
v_lshlrev_b32 v2, 16, v149
v_and_b32 v3, 0xffff0000, v149
v_pk_add_f32 v[42:43], v[42:43], v[2:3]
s_waitcnt vmcnt(20)
v_lshlrev_b32 v2, 16, v150
v_and_b32 v3, 0xffff0000, v150
v_pk_add_f32 v[36:37], v[36:37], v[2:3]
v_lshlrev_b32 v2, 16, v151
v_and_b32 v3, 0xffff0000, v151
v_pk_add_f32 v[38:39], v[38:39], v[2:3]
v_lshlrev_b32 v2, 16, v152
v_and_b32 v3, 0xffff0000, v152
v_pk_add_f32 v[40:41], v[40:41], v[2:3]
v_lshlrev_b32 v2, 16, v153
v_and_b32 v3, 0xffff0000, v153
v_pk_add_f32 v[42:43], v[42:43], v[2:3]
s_waitcnt vmcnt(19)
v_lshlrev_b32 v2, 16, v154
v_and_b32 v3, 0xffff0000, v154
v_pk_add_f32 v[36:37], v[36:37], v[2:3]
v_lshlrev_b32 v2, 16, v155
v_and_b32 v3, 0xffff0000, v155
v_pk_add_f32 v[38:39], v[38:39], v[2:3]
v_lshlrev_b32 v2, 16, v156
v_and_b32 v3, 0xffff0000, v156
v_pk_add_f32 v[40:41], v[40:41], v[2:3]
v_lshlrev_b32 v2, 16, v157
v_and_b32 v3, 0xffff0000, v157
v_pk_add_f32 v[42:43], v[42:43], v[2:3]
s_waitcnt vmcnt(18)
v_lshlrev_b32 v2, 16, v158
v_and_b32 v3, 0xffff0000, v158
v_pk_add_f32 v[36:37], v[36:37], v[2:3]
v_lshlrev_b32 v2, 16, v159
v_and_b32 v3, 0xffff0000, v159
v_pk_add_f32 v[38:39], v[38:39], v[2:3]
v_lshlrev_b32 v2, 16, v160
v_and_b32 v3, 0xffff0000, v160
v_pk_add_f32 v[40:41], v[40:41], v[2:3]
v_lshlrev_b32 v2, 16, v161
v_and_b32 v3, 0xffff0000, v161
v_pk_add_f32 v[42:43], v[42:43], v[2:3]
s_waitcnt vmcnt(17)
v_lshlrev_b32 v2, 16, v162
v_and_b32 v3, 0xffff0000, v162
v_pk_add_f32 v[36:37], v[36:37], v[2:3]
v_lshlrev_b32 v2, 16, v163
v_and_b32 v3, 0xffff0000, v163
v_pk_add_f32 v[38:39], v[38:39], v[2:3]
v_lshlrev_b32 v2, 16, v164
v_and_b32 v3, 0xffff0000, v164
v_pk_add_f32 v[40:41], v[40:41], v[2:3]
v_lshlrev_b32 v2, 16, v165
v_and_b32 v3, 0xffff0000, v165
v_pk_add_f32 v[42:43], v[42:43], v[2:3]
s_waitcnt vmcnt(16)
v_lshlrev_b32 v2, 16, v166
v_and_b32 v3, 0xffff0000, v166
v_pk_add_f32 v[36:37], v[36:37], v[2:3]
v_lshlrev_b32 v2, 16, v167
v_and_b32 v3, 0xffff0000, v167
v_pk_add_f32 v[38:39], v[38:39], v[2:3]
v_lshlrev_b32 v2, 16, v168
v_and_b32 v3, 0xffff0000, v168
v_pk_add_f32 v[40:41], v[40:41], v[2:3]
v_lshlrev_b32 v2, 16, v169
v_and_b32 v3, 0xffff0000, v169
v_pk_add_f32 v[42:43], v[42:43], v[2:3]
s_waitcnt vmcnt(15)
v_lshlrev_b32 v2, 16, v170
v_and_b32 v3, 0xffff0000, v170
v_pk_add_f32 v[36:37], v[36:37], v[2:3]
v_lshlrev_b32 v2, 16, v171
v_and_b32 v3, 0xffff0000, v171
v_pk_add_f32 v[38:39], v[38:39], v[2:3]
v_lshlrev_b32 v2, 16, v172
v_and_b32 v3, 0xffff0000, v172
v_pk_add_f32 v[40:41], v[40:41], v[2:3]
v_lshlrev_b32 v2, 16, v173
v_and_b32 v3, 0xffff0000, v173
v_pk_add_f32 v[42:43], v[42:43], v[2:3]
s_waitcnt vmcnt(14)
v_lshlrev_b32 v2, 16, v174
v_and_b32 v3, 0xffff0000, v174
v_pk_add_f32 v[36:37], v[36:37], v[2:3]
v_lshlrev_b32 v2, 16, v175
v_and_b32 v3, 0xffff0000, v175
v_pk_add_f32 v[38:39], v[38:39], v[2:3]
v_lshlrev_b32 v2, 16, v176
v_and_b32 v3, 0xffff0000, v176
v_pk_add_f32 v[40:41], v[40:41], v[2:3]
v_lshlrev_b32 v2, 16, v177
v_and_b32 v3, 0xffff0000, v177
v_pk_add_f32 v[42:43], v[42:43], v[2:3]
s_waitcnt vmcnt(13)
v_lshlrev_b32 v2, 16, v178
v_and_b32 v3, 0xffff0000, v178
v_pk_add_f32 v[36:37], v[36:37], v[2:3]
v_lshlrev_b32 v2, 16, v179
v_and_b32 v3, 0xffff0000, v179
v_pk_add_f32 v[38:39], v[38:39], v[2:3]
v_lshlrev_b32 v2, 16, v180
v_and_b32 v3, 0xffff0000, v180
v_pk_add_f32 v[40:41], v[40:41], v[2:3]
v_lshlrev_b32 v2, 16, v181
v_and_b32 v3, 0xffff0000, v181
v_pk_add_f32 v[42:43], v[42:43], v[2:3]
s_waitcnt vmcnt(12)
v_lshlrev_b32 v2, 16, v182
v_and_b32 v3, 0xffff0000, v182
v_pk_add_f32 v[36:37], v[36:37], v[2:3]
v_lshlrev_b32 v2, 16, v183
v_and_b32 v3, 0xffff0000, v183
v_pk_add_f32 v[38:39], v[38:39], v[2:3]
v_lshlrev_b32 v2, 16, v184
v_and_b32 v3, 0xffff0000, v184
v_pk_add_f32 v[40:41], v[40:41], v[2:3]
v_lshlrev_b32 v2, 16, v185
v_and_b32 v3, 0xffff0000, v185
v_pk_add_f32 v[42:43], v[42:43], v[2:3]
s_waitcnt vmcnt(11)
v_lshlrev_b32 v2, 16, v186
v_and_b32 v3, 0xffff0000, v186
v_pk_add_f32 v[36:37], v[36:37], v[2:3]
v_lshlrev_b32 v2, 16, v187
v_and_b32 v3, 0xffff0000, v187
v_pk_add_f32 v[38:39], v[38:39], v[2:3]
v_lshlrev_b32 v2, 16, v188
v_and_b32 v3, 0xffff0000, v188
v_pk_add_f32 v[40:41], v[40:41], v[2:3]
v_lshlrev_b32 v2, 16, v189
v_and_b32 v3, 0xffff0000, v189
v_pk_add_f32 v[42:43], v[42:43], v[2:3]
s_waitcnt vmcnt(10)
v_lshlrev_b32 v2, 16, v190
v_and_b32 v3, 0xffff0000, v190
v_pk_add_f32 v[36:37], v[36:37], v[2:3]
v_lshlrev_b32 v2, 16, v191
v_and_b32 v3, 0xffff0000, v191
v_pk_add_f32 v[38:39], v[38:39], v[2:3]
v_lshlrev_b32 v2, 16, v192
v_and_b32 v3, 0xffff0000, v192
v_pk_add_f32 v[40:41], v[40:41], v[2:3]
v_lshlrev_b32 v2, 16, v193
v_and_b32 v3, 0xffff0000, v193
v_pk_add_f32 v[42:43], v[42:43], v[2:3]
s_waitcnt vmcnt(9)
v_lshlrev_b32 v2, 16, v194
v_and_b32 v3, 0xffff0000, v194
v_pk_add_f32 v[36:37], v[36:37], v[2:3]
v_lshlrev_b32 v2, 16, v195
v_and_b32 v3, 0xffff0000, v195
v_pk_add_f32 v[38:39], v[38:39], v[2:3]
v_lshlrev_b32 v2, 16, v196
v_and_b32 v3, 0xffff0000, v196
v_pk_add_f32 v[40:41], v[40:41], v[2:3]
v_lshlrev_b32 v2, 16, v197
v_and_b32 v3, 0xffff0000, v197
v_pk_add_f32 v[42:43], v[42:43], v[2:3]
s_waitcnt vmcnt(8)
v_lshlrev_b32 v2, 16, v198
v_and_b32 v3, 0xffff0000, v198
v_pk_add_f32 v[36:37], v[36:37], v[2:3]
v_lshlrev_b32 v2, 16, v199
v_and_b32 v3, 0xffff0000, v199
v_pk_add_f32 v[38:39], v[38:39], v[2:3]
v_lshlrev_b32 v2, 16, v200
v_and_b32 v3, 0xffff0000, v200
v_pk_add_f32 v[40:41], v[40:41], v[2:3]
v_lshlrev_b32 v2, 16, v201
v_and_b32 v3, 0xffff0000, v201
v_pk_add_f32 v[42:43], v[42:43], v[2:3]
s_waitcnt vmcnt(7)
v_lshlrev_b32 v2, 16, v202
v_and_b32 v3, 0xffff0000, v202
v_pk_add_f32 v[36:37], v[36:37], v[2:3]
v_lshlrev_b32 v2, 16, v203
v_and_b32 v3, 0xffff0000, v203
v_pk_add_f32 v[38:39], v[38:39], v[2:3]
v_lshlrev_b32 v2, 16, v204
v_and_b32 v3, 0xffff0000, v204
v_pk_add_f32 v[40:41], v[40:41], v[2:3]
v_lshlrev_b32 v2, 16, v205
v_and_b32 v3, 0xffff0000, v205
v_pk_add_f32 v[42:43], v[42:43], v[2:3]
s_waitcnt vmcnt(6)
v_lshlrev_b32 v2, 16, v206
v_and_b32 v3, 0xffff0000, v206
v_pk_add_f32 v[36:37], v[36:37], v[2:3]
v_lshlrev_b32 v2, 16, v207
v_and_b32 v3, 0xffff0000, v207
v_pk_add_f32 v[38:39], v[38:39], v[2:3]
v_lshlrev_b32 v2, 16, v208
v_and_b32 v3, 0xffff0000, v208
v_pk_add_f32 v[40:41], v[40:41], v[2:3]
v_lshlrev_b32 v2, 16, v209
v_and_b32 v3, 0xffff0000, v209
v_pk_add_f32 v[42:43], v[42:43], v[2:3]
v_lshrrev_b32 v2, 3, v0
v_and_b32 v3, 7, v0
v_lshlrev_b32 v4, 8, v2
v_lshl_add_u32 v4, v3, 5, v4
v_add_u32 v4, 81920, v4
ds_write_b128 v4, v[36:39]
ds_write_b128 v4, v[40:43] offset:16
s_waitcnt lgkmcnt(0)
s_waitcnt vmcnt(0)
s_barrier
s_cmp_lg_u32 s5, 0
s_cbranch_scc1 L_fl_23
s_mov_b64 exec, 1
buffer_store_dword v253, v252, s[24:27], 0 offen offset:0 sc1
s_mov_b64 exec, -1
L_fl_23:
s_cmp_lg_u32 s5, 0
s_cbranch_scc1 L_fl_24
s_mov_b64 exec, 1
buffer_store_dword v253, v252, s[24:27], 0 offen offset:4 sc1
s_mov_b64 exec, -1
L_fl_24:
s_cmp_lg_u32 s5, 0
s_cbranch_scc1 L_csskip_22
v_lshlrev_b32 v4, 2, v1
v_add_u32 v4, 81920, v4
ds_read_b32 v130, v4 offset:0
ds_read_b32 v131, v4 offset:256
ds_read_b32 v132, v4 offset:512
ds_read_b32 v133, v4 offset:768
ds_read_b32 v134, v4 offset:1024
ds_read_b32 v135, v4 offset:1280
ds_read_b32 v136, v4 offset:1536
ds_read_b32 v137, v4 offset:1792
ds_read_b32 v138, v4 offset:2048
ds_read_b32 v139, v4 offset:2304
ds_read_b32 v140, v4 offset:2560
ds_read_b32 v141, v4 offset:2816
ds_read_b32 v142, v4 offset:3072
ds_read_b32 v143, v4 offset:3328
ds_read_b32 v144, v4 offset:3584
ds_read_b32 v145, v4 offset:3840
ds_read_b32 v146, v4 offset:4096
ds_read_b32 v147, v4 offset:4352
ds_read_b32 v148, v4 offset:4608
ds_read_b32 v149, v4 offset:4864
ds_read_b32 v150, v4 offset:5120
ds_read_b32 v151, v4 offset:5376
ds_read_b32 v152, v4 offset:5632
ds_read_b32 v153, v4 offset:5888
ds_read_b32 v154, v4 offset:6144
ds_read_b32 v155, v4 offset:6400
ds_read_b32 v156, v4 offset:6656
ds_read_b32 v157, v4 offset:6912
ds_read_b32 v158, v4 offset:7168
ds_read_b32 v159, v4 offset:7424
ds_read_b32 v160, v4 offset:7680
ds_read_b32 v161, v4 offset:7936
s_waitcnt lgkmcnt(0)
v_add_f32 v130, v130, v146
v_add_f32 v131, v131, v147
v_add_f32 v132, v132, v148
v_add_f32 v133, v133, v149
v_add_f32 v134, v134, v150
v_add_f32 v135, v135, v151
v_add_f32 v136, v136, v152
v_add_f32 v137, v137, v153
v_add_f32 v138, v138, v154
v_add_f32 v139, v139, v155
v_add_f32 v140, v140, v156
v_add_f32 v141, v141, v157
v_add_f32 v142, v142, v158
v_add_f32 v143, v143, v159
v_add_f32 v144, v144, v160
v_add_f32 v145, v145, v161
v_add_f32 v130, v130, v138
v_add_f32 v131, v131, v139
v_add_f32 v132, v132, v140
v_add_f32 v133, v133, v141
v_add_f32 v134, v134, v142
v_add_f32 v135, v135, v143
v_add_f32 v136, v136, v144
v_add_f32 v137, v137, v145
v_add_f32 v130, v130, v134
v_add_f32 v131, v131, v135
v_add_f32 v132, v132, v136
v_add_f32 v133, v133, v137
v_add_f32 v130, v130, v132
v_add_f32 v131, v131, v133
v_add_f32 v130, v130, v131
v_cvt_pk_bf16_f32 v131, v130, v130
v_lshlrev_b32 v132, 16, v131
v_sub_f32 v132, v130, v132
v_cvt_pk_bf16_f32 v132, v132, v132
v_lshl_or_b32 v130, v210, 16, v210
v_mov_b32 v133, 0
s_lshl_b32 s6, s75, 10
s_add_u32 s6, s6, 131072
v_add_u32 v4, s76, v248
buffer_store_dwordx4 v[130:133], v4, s[24:27], s6 offen sc1
s_waitcnt vmcnt(0)
L_csskip_22:
s_cmp_lg_u32 s5, 0
s_cbranch_scc1 L_fl_25
s_mov_b64 exec, 1
buffer_store_dword v253, v252, s[24:27], 0 offen offset:8 sc1
s_mov_b64 exec, -1
L_fl_25:
s_waitcnt vmcnt(0)
buffer_load_dword v254, v230, s[52:55], 0 offen sc1
s_waitcnt vmcnt(0)
v_cmp_gt_u32 vcc, 32, v254
s_cbranch_vccnz L_slow_26
L_back_27:
v_readfirstlane_b32 s6, v228
v_cmp_lt_u32 vcc, 53, v1
v_mov_b32 v2, s6
v_cndmask_b32 v228, v228, v2, vcc
buffer_load_dword v254, v229, s[24:27], 0 offen sc1
s_waitcnt vmcnt(0)
v_cmp_eq_u32 vcc, 0, v254
s_cbranch_vccnz L_slow_28
L_back_29:
s_barrier
s_lshl_b32 s6, s5, 2
v_lshlrev_b32 v202, 2, v1
v_add_u32 v202, s6, v202
v_subrev_u32 v202, 252, v202
v_add_u32 v203, s6, v248
v_add_u32 v203, 4, v203
s_mul_i32 s90, s5, 4416
v_lshlrev_b32 v4, 4, v0
s_add_u32 s6, s88, 0
s_lshl_b32 s6, s6, 12
s_add_u32 s6, s6, 1048576
s_add_u32 s36, s66, s6
s_addc_u32 s37, s67, 0
s_and_b32 s37, s37, 0xffff
s_mov_b32 s38, 4096
s_mov_b32 s39, 0x20000
buffer_load_dwordx4 v[184:187], v4, s[36:39], 0 offen
buffer_load_dword v188, v4, s[36:39], 0 offen offset:16
s_add_u32 s6, s88, 1
s_lshl_b32 s6, s6, 12
s_add_u32 s6, s6, 1048576
s_add_u32 s36, s66, s6
s_addc_u32 s37, s67, 0
s_and_b32 s37, s37, 0xffff
s_mov_b32 s38, 4096
s_mov_b32 s39, 0x20000
buffer_load_dwordx4 v[190:193], v4, s[36:39], 0 offen
buffer_load_dword v194, v4, s[36:39], 0 offen offset:16
s_add_u32 s6, s88, 2
s_lshl_b32 s6, s6, 12
s_add_u32 s6, s6, 1048576
s_add_u32 s36, s66, s6
s_addc_u32 s37, s67, 0
s_and_b32 s37, s37, 0xffff
s_mov_b32 s38, 4096
s_mov_b32 s39, 0x20000
buffer_load_dwordx4 v[196:199], v4, s[36:39], 0 offen
buffer_load_dword v200, v4, s[36:39], 0 offen offset:16
s_add_u32 s6, s88, 0
s_lshl_b32 s6, s6, 12
s_add_u32 s32, s48, s6
s_addc_u32 s33, s49, 0
s_and_b32 s33, s33, 0xffff
s_mov_b32 s34, 4096
s_mov_b32 s35, 0x20000
s_add_u32 m0, s90, 65536
s_nop 0
buffer_load_dword v202, s[32:35], 0 offen lds
s_add_u32 m0, s90, 65792
s_nop 0
buffer_load_dwordx4 v203, s[32:35], 0 offen offset:0 lds
buffer_load_dwordx4 v203, s[32:35], 0 offen offset:1024 lds
buffer_load_dwordx4 v203, s[32:35], 0 offen offset:2048 lds
buffer_load_dwordx4 v203, s[32:35], 0 offen offset:3072 lds
s_add_u32 s6, s88, 1
s_lshl_b32 s6, s6, 12
s_add_u32 s32, s48, s6
s_addc_u32 s33, s49, 0
s_and_b32 s33, s33, 0xffff
s_mov_b32 s34, 4096
s_mov_b32 s35, 0x20000
s_add_u32 m0, s90, 95744
s_nop 0
buffer_load_dword v202, s[32:35], 0 offen lds
s_add_u32 m0, s90, 96000
s_nop 0
buffer_load_dwordx4 v203, s[32:35], 0 offen offset:0 lds
buffer_load_dwordx4 v203, s[32:35], 0 offen offset:1024 lds
buffer_load_dwordx4 v203, s[32:35], 0 offen offset:2048 lds
buffer_load_dwordx4 v203, s[32:35], 0 offen offset:3072 lds
s_add_u32 s6, s88, 2
s_lshl_b32 s6, s6, 12
s_add_u32 s32, s48, s6
s_addc_u32 s33, s49, 0
s_and_b32 s33, s33, 0xffff
s_mov_b32 s34, 4096
s_mov_b32 s35, 0x20000
s_add_u32 m0, s90, 125952
s_nop 0
buffer_load_dword v202, s[32:35], 0 offen lds
s_add_u32 m0, s90, 126208
s_nop 0
buffer_load_dwordx4 v203, s[32:35], 0 offen offset:0 lds
buffer_load_dwordx4 v203, s[32:35], 0 offen offset:1024 lds
buffer_load_dwordx4 v203, s[32:35], 0 offen offset:2048 lds
buffer_load_dwordx4 v203, s[32:35], 0 offen offset:3072 lds
buffer_load_dword v254, v228, s[24:27], 0 offen sc1
s_waitcnt vmcnt(0)
v_cmp_eq_u32 vcc, 0, v254
s_cbranch_vccnz L_slow_30
L_back_31:
s_mul_i32 s6, s95, 54
s_add_u32 s6, s6, s96
s_mul_i32 s97, s6, 5120
s_add_u32 s97, s97, 7340032
s_add_u32 s98, s97, 4096
buffer_load_dwordx4 a[0:3], v248, s[24:27], s97 offen offset:0
buffer_load_dwordx4 a[4:7], v248, s[24:27], s97 offen offset:1024
buffer_load_dwordx4 a[8:11], v248, s[24:27], s97 offen offset:2048
buffer_load_dwordx4 a[12:15], v248, s[24:27], s97 offen offset:3072
buffer_load_dwordx4 a[16:19], v248, s[24:27], s98 offen
s_add_u32 s97, s97, 5120
s_add_u32 s98, s98, 5120
buffer_load_dwordx4 a[20:23], v248, s[24:27], s97 offen offset:0
buffer_load_dwordx4 a[24:27], v248, s[24:27], s97 offen offset:1024
buffer_load_dwordx4 a[28:31], v248, s[24:27], s97 offen offset:2048
buffer_load_dwordx4 a[32:35], v248, s[24:27], s97 offen offset:3072
buffer_load_dwordx4 a[36:39], v248, s[24:27], s98 offen
s_add_u32 s97, s97, 5120
s_add_u32 s98, s98, 5120
buffer_load_dwordx4 a[40:43], v248, s[24:27], s97 offen offset:0
buffer_load_dwordx4 a[44:47], v248, s[24:27], s97 offen offset:1024
buffer_load_dwordx4 a[48:51], v248, s[24:27], s97 offen offset:2048
buffer_load_dwordx4 a[52:55], v248, s[24:27], s97 offen offset:3072
buffer_load_dwordx4 a[56:59], v248, s[24:27], s98 offen
s_add_u32 s97, s97, 5120
s_add_u32 s98, s98, 5120
buffer_load_dwordx4 a[60:63], v248, s[24:27], s97 offen offset:0
buffer_load_dwordx4 a[64:67], v248, s[24:27], s97 offen offset:1024
buffer_load_dwordx4 a[68:71], v248, s[24:27], s97 offen offset:2048
buffer_load_dwordx4 a[72:75], v248, s[24:27], s97 offen offset:3072
buffer_load_dwordx4 a[76:79], v248, s[24:27], s98 offen
s_add_u32 s97, s97, 5120
s_add_u32 s98, s98, 5120
buffer_load_dwordx4 a[80:83], v248, s[24:27], s97 offen offset:0
buffer_load_dwordx4 a[84:87], v248, s[24:27], s97 offen offset:1024
buffer_load_dwordx4 a[88:91], v248, s[24:27], s97 offen offset:2048
buffer_load_dwordx4 a[92:95], v248, s[24:27], s97 offen offset:3072
buffer_load_dwordx4 a[96:99], v248, s[24:27], s98 offen
s_add_u32 s97, s97, 5120
s_add_u32 s98, s98, 5120
buffer_load_dwordx4 a[100:103], v248, s[24:27], s97 offen offset:0
buffer_load_dwordx4 a[104:107], v248, s[24:27], s97 offen offset:1024
buffer_load_dwordx4 a[108:111], v248, s[24:27], s97 offen offset:2048
buffer_load_dwordx4 a[112:115], v248, s[24:27], s97 offen offset:3072
buffer_load_dwordx4 a[116:119], v248, s[24:27], s98 offen
s_add_u32 s97, s97, 5120
s_add_u32 s98, s98, 5120
buffer_load_dwordx4 a[120:123], v248, s[24:27], s97 offen offset:0
buffer_load_dwordx4 a[124:127], v248, s[24:27], s97 offen offset:1024
buffer_load_dwordx4 a[128:131], v248, s[24:27], s97 offen offset:2048
buffer_load_dwordx4 a[132:135], v248, s[24:27], s97 offen offset:3072
v_lshlrev_b32 v5, 4, v0
v_add_u32 v5, 87552, v5
v_add_u32 v7, 60416, v5
v_mov_b32 v12, 0
v_mov_b32 v13, 0
v_mov_b32 v14, 0
v_mov_b32 v15, 0
v_cmp_gt_u32 vcc, 119, v0
s_and_saveexec_b64 s[6:7], vcc
ds_write_b128 v5, v[12:15] offset:0
ds_write_b128 v5, v[12:15] offset:6272
ds_write_b128 v5, v[12:15] offset:30208
ds_write_b128 v5, v[12:15] offset:36480
ds_write_b128 v7, v[12:15] offset:0
ds_write_b128 v7, v[12:15] offset:6272
s_mov_b64 exec, s[6:7]
v_lshrrev_b32 v4, 4, v0
v_mul_u32_u24 v4, 272, v4
v_and_b32 v5, 15, v0
v_lshl_add_u32 v4, v5, 4, v4
v_add_u32 v4, 83200, v4
v_add_u32 v6, 60416, v4
ds_write_b128 v4, v[184:187] offset:6272
v_alignbit_b32 v12, v185, v184, 16
v_alignbit_b32 v13, v186, v185, 16
v_alignbit_b32 v14, v187, v186, 16
v_alignbit_b32 v15, v188, v187, 16
ds_write_b128 v4, v[12:15] offset:0
ds_write_b128 v4, v[190:193] offset:36480
v_alignbit_b32 v12, v191, v190, 16
v_alignbit_b32 v13, v192, v191, 16
v_alignbit_b32 v14, v193, v192, 16
v_alignbit_b32 v15, v194, v193, 16
ds_write_b128 v4, v[12:15] offset:30208
ds_write_b128 v6, v[196:199] offset:6272
v_alignbit_b32 v12, v197, v196, 16
v_alignbit_b32 v13, v198, v197, 16
v_alignbit_b32 v14, v199, v198, 16
v_alignbit_b32 v15, v200, v199, 16
ds_write_b128 v6, v[12:15] offset:0
s_waitcnt vmcnt(0)
s_branch L_conv
L_slow_3:
s_add_u32 s42, s42, 1
s_cmp_gt_u32 s42, 200000
s_cbranch_scc1 L_back_4
buffer_load_dword v254, v230, s[52:55], 0 offen sc1
s_waitcnt vmcnt(0)
v_cmp_gt_u32 vcc, 32, v254
s_cbranch_vccnz L_slow_3
s_branch L_back_4
L_slow_6:
s_add_u32 s42, s42, 1
s_cmp_gt_u32 s42, 200000
s_cbranch_scc1 L_back_7
buffer_load_dword v254, v228, s[24:27], 0 offen sc1
s_waitcnt vmcnt(0)
v_cmp_eq_u32 vcc, 0, v254
s_cbranch_vccnz L_slow_6
s_branch L_back_7
L_slow_8:
s_add_u32 s42, s42, 1
s_cmp_gt_u32 s42, 200000
s_cbranch_scc1 L_back_9
buffer_load_dword v254, v229, s[24:27], 0 offen sc1
s_waitcnt vmcnt(0)
v_cmp_eq_u32 vcc, 0, v254
s_cbranch_vccnz L_slow_8
s_branch L_back_9
L_slow_14:
s_add_u32 s42, s42, 1
s_cmp_gt_u32 s42, 200000
s_cbranch_scc1 L_back_15
buffer_load_dword v254, v249, s[24:27], 0 offen sc1
s_waitcnt vmcnt(0)
v_cmp_eq_u32 vcc, 0, v254
s_cbranch_vccnz L_slow_14
s_branch L_back_15
L_slow_1016:
s_add_u32 s42, s42, 1
s_cmp_gt_u32 s42, 200000
s_cbranch_scc1 L_back_1017
buffer_load_dword v254, v249, s[24:27], 0 offen sc1
s_waitcnt vmcnt(0)
v_cmp_eq_u32 vcc, 0, v254
s_cbranch_vccnz L_slow_1016
s_branch L_back_1017
L_slow_18:
s_add_u32 s42, s42, 1
s_cmp_gt_u32 s42, 200000
s_cbranch_scc1 L_back_19
buffer_load_dword v254, v250, s[24:27], 0 offen sc1
s_waitcnt vmcnt(0)
v_cmp_eq_u32 vcc, 0, v254
s_cbranch_vccnz L_slow_18
s_branch L_back_19
L_slow_26:
s_add_u32 s42, s42, 1
s_cmp_gt_u32 s42, 200000
s_cbranch_scc1 L_back_27
buffer_load_dword v254, v230, s[52:55], 0 offen sc1
s_waitcnt vmcnt(0)
v_cmp_gt_u32 vcc, 32, v254
s_cbranch_vccnz L_slow_26
s_branch L_back_27
L_slow_28:
s_add_u32 s42, s42, 1
s_cmp_gt_u32 s42, 200000
s_cbranch_scc1 L_back_29
buffer_load_dword v254, v229, s[24:27], 0 offen sc1
s_waitcnt vmcnt(0)
v_cmp_eq_u32 vcc, 0, v254
s_cbranch_vccnz L_slow_28
s_branch L_back_29
L_slow_30:
s_add_u32 s42, s42, 1
s_cmp_gt_u32 s42, 200000
s_cbranch_scc1 L_back_31
buffer_load_dword v254, v228, s[24:27], 0 offen sc1
s_waitcnt vmcnt(0)
v_cmp_eq_u32 vcc, 0, v254
s_cbranch_vccnz L_slow_30
s_branch L_back_31
.section .rodata,"a"
.p2align 6
.amdhsa_kernel recurrent_scan__ssm_conv_h3__dense_activation_gelu__prompt_kernel
  .amdhsa_next_free_vgpr 512
  .amdhsa_next_free_sgpr 102
  .amdhsa_accum_offset 256
  .amdhsa_group_segment_fixed_size 0
  .amdhsa_kernarg_size 112
  .amdhsa_user_sgpr_count 2
  .amdhsa_user_sgpr_kernarg_segment_ptr 1
  .amdhsa_system_sgpr_workgroup_id_x 1
.end_amdhsa_kernel
```

```asm
; @launch grid=(256,1,1) block=(256,1,1) lds=163840
.amdgcn_target "amdgcn-amd-amdhsa--gfx950"
.text
.globl recurrent_scan__ssm_conv_h3__dense_activation_gelu__prompt_kernel
.p2align 8
.type recurrent_scan__ssm_conv_h3__dense_activation_gelu__prompt_kernel,@function
recurrent_scan__ssm_conv_h3__dense_activation_gelu__prompt_kernel:
s_cmp_ge_u32 s2, 256
s_cbranch_scc1 L_end
s_load_dwordx16 s[40:55], s[0:1], 0
s_load_dwordx8 s[56:63], s[0:1], 64
s_load_dwordx4 s[64:67], s[0:1], 96
s_and_b32 s3, s2, 7
s_lshr_b32 s4, s2, 3
v_lshrrev_b32 v1, 6, v0
v_and_b32 v0, 0xff, v0
v_mov_b32 v253, 1
v_readfirstlane_b32 s5, v1
v_and_b32 v1, 63, v0
s_lshl_b32 s6, s2, 7
v_mov_b32 v252, s6
v_lshlrev_b32 v248, 4, v1
v_and_b32 v230, 7, v1
v_lshlrev_b32 v230, 5, v230
v_mov_b32 v255, 0
s_waitcnt lgkmcnt(0)
s_mov_b32 s24, s66
s_and_b32 s25, s67, 0xffff
s_mov_b32 s26, 17825792
s_mov_b32 s27, 0x20000
s_cmp_lg_u32 s5, 0
s_cbranch_scc1 L_clr_1
v_lshl_add_u32 v2, v1, 2, v252
v_mov_b32 v3, 0
s_mov_b64 exec, 0xff
buffer_store_dword v3, v2, s[24:27], 0 offen sc1
s_mov_b64 exec, -1
L_clr_1:
s_mov_b32 s12, s42
s_and_b32 s13, s43, 0xffff
s_mov_b32 s14, 2621440
s_mov_b32 s15, 0x20000
s_mov_b32 s16, s44
s_and_b32 s17, s45, 0xffff
s_mov_b32 s18, 2621440
s_mov_b32 s19, 0x20000
s_mov_b32 s8, s40
s_and_b32 s9, s41, 0xffff
s_mov_b32 s10, 2621440
s_mov_b32 s11, 0x20000
s_mov_b32 s20, s54
s_and_b32 s21, s55, 0xffff
s_mov_b32 s22, 2211840
s_mov_b32 s23, 0x20000
s_mov_b32 s28, s62
s_and_b32 s29, s63, 0xffff
s_mov_b32 s30, 2621440
s_mov_b32 s31, 0x20000
s_mov_b32 s52, s64
s_and_b32 s53, s65, 0xffff
s_mov_b32 s54, 256
s_mov_b32 s55, 0x20000
s_mov_b32 s42, 0
s_cmp_ge_u32 s4, 28
s_cbranch_scc1 L_spare
s_mov_b32 s32, s46
s_and_b32 s33, s47, 0xffff
s_mov_b32 s34, 5120
s_mov_b32 s35, 0x20000
s_lshr_b32 s6, s4, 3
s_lshl_b32 s7, s3, 2
s_add_u32 s68, s6, s7
s_and_b32 s69, s4, 7
v_mul_u32_u24 v2, 26, v1
v_lshrrev_b32 v2, 8, v2
v_mul_u32_u24 v3, 10, v2
v_sub_u32 v3, v1, v3
s_lshl_b32 s6, s68, 6
s_lshl_b32 s7, s5, 4
s_add_u32 s6, s6, s7
s_mul_i32 s6, s6, 1280
s_mul_i32 s7, s69, 160
s_add_u32 s6, s6, s7
v_mul_u32_u24 v4, 5120, v2
v_lshl_add_u32 v4, v3, 4, v4
v_add_u32 v4, s6, v4
v_subrev_u32 v5, 3840, v4
s_mul_i32 s7, s69, 640
v_lshlrev_b32 v6, 6, v3
v_add_u32 v6, s7, v6
s_mov_b32 exec_hi, 0xff
buffer_load_dwordx4 v[8:11], v5, s[12:15], 0 offen offset:0
buffer_load_dwordx4 v[12:15], v5, s[12:15], 0 offen offset:1280
buffer_load_dwordx4 v[16:19], v5, s[12:15], 0 offen offset:2560
buffer_load_dwordx4 v[20:23], v4, s[12:15], 0 offen offset:0
buffer_load_dwordx4 v[24:27], v4, s[12:15], 0 offen offset:1280
buffer_load_dwordx4 v[28:31], v4, s[12:15], 0 offen offset:2560
buffer_load_dwordx4 v[32:35], v4, s[12:15], 0 offen offset:3840
buffer_load_dwordx4 v[52:55], v6, s[32:35], 0 offen offset:0
buffer_load_dwordx4 v[56:59], v6, s[32:35], 0 offen offset:16
buffer_load_dwordx4 v[60:63], v6, s[32:35], 0 offen offset:32
buffer_load_dwordx4 v[64:67], v6, s[32:35], 0 offen offset:48
buffer_load_dwordx4 v[36:39], v4, s[16:19], 0 offen offset:0
buffer_load_dwordx4 v[40:43], v4, s[16:19], 0 offen offset:1280
buffer_load_dwordx4 v[44:47], v4, s[16:19], 0 offen offset:2560
buffer_load_dwordx4 v[48:51], v4, s[16:19], 0 offen offset:3840
s_lshl_b32 s7, s5, 5
s_sub_u32 s7, 131192, s7
v_mul_u32_u24 v7, 1152, v3
v_lshlrev_b32 v2, 3, v2
v_sub_u32 v7, v7, v2
v_add_u32 v7, s7, v7
s_mov_b64 exec, -1
s_lshr_b32 s6, s3, 1
s_lshl_b32 s6, s6, 2
s_and_b32 s7, s4, 3
s_add_u32 s77, s6, s7
s_and_b32 s6, s3, 1
s_mul_i32 s6, s6, 7
s_lshr_b32 s7, s4, 2
s_add_u32 s78, s6, s7
s_and_b32 s82, s5, 1
s_lshr_b32 s83, s5, 1
s_lshl_b32 s6, s3, 4
s_lshr_b32 s7, s4, 1
s_add_u32 s6, s6, s7
s_mul_i32 s6, s6, 5
s_and_b32 s89, s4, 1
s_lshl_b32 s7, s89, 1
s_add_u32 s88, s6, s7
s_lshr_b32 s6, s3, 1
s_lshl_b32 s6, s6, 3
s_and_b32 s7, s4, 7
s_add_u32 s94, s6, s7
s_and_b32 s6, s3, 1
s_lshl_b32 s6, s6, 2
s_lshr_b32 s7, s4, 3
s_add_u32 s95, s6, s7
s_mul_i32 s96, s5, 14
s_cmp_eq_u32 s5, 3
s_cselect_b32 s6, 1, 0
s_sub_u32 s96, s96, s6
s_lshl_b32 s79, s78, 8
s_mul_i32 s80, s77, 163840
s_lshl_b32 s81, s5, 12
v_lshrrev_b32 v2, 4, v1
v_and_b32 v3, 15, v1
v_lshlrev_b32 v4, 2, v2
v_xor_b32 v4, v3, v4
s_lshl_b32 s6, s5, 4
v_add_u32 v5, s6, v2
v_mul_u32_u24 v5, 3456, v5
v_lshl_add_u32 v208, v4, 4, v5
s_cmp_eq_u32 s78, 13
s_cselect_b32 s7, 8, 16
v_cmp_le_u32 vcc, s7, v4
v_mov_b32 v6, 2147418112
v_cndmask_b32 v208, v208, v6, vcc
v_add_u32 v209, 12800, v208
v_add_u32 v210, 25600, v208
v_add_u32 v211, 38400, v208
v_lshrrev_b32 v4, 3, v1
v_and_b32 v5, 7, v1
s_lshl_b32 s6, s5, 5
v_add_u32 v4, s6, v4
v_mul_u32_u24 v4, 1280, v4
v_add_u32 v6, 0, v2
v_xor_b32 v6, v5, v6
v_lshl_add_u32 v6, v6, 4, v4
v_add_u32 v212, 0, v6
v_add_u32 v6, 4, v2
v_xor_b32 v6, v5, v6
v_lshl_add_u32 v6, v6, 4, v4
v_add_u32 v213, 9216, v6
v_add_u32 v6, 0, v2
v_xor_b32 v6, v5, v6
v_lshl_add_u32 v6, v6, 4, v4
v_add_u32 v214, 18432, v6
v_add_u32 v6, 4, v2
v_xor_b32 v6, v5, v6
v_lshl_add_u32 v6, v6, 4, v4
v_add_u32 v215, 27648, v6
s_mov_b32 s36, s58
s_and_b32 s37, s59, 0xffff
s_mov_b32 s38, 2211840
s_mov_b32 s39, 0x20000
s_lshr_b32 s6, s2, 2
s_lshl_b32 s6, s6, 5
s_lshl_b32 s7, s5, 3
s_add_u32 s6, s6, s7
s_mul_i32 s6, s6, 1280
s_and_b32 s7, s2, 3
s_mul_i32 s7, s7, 320
s_add_u32 s6, s6, s7
s_cmp_lt_u32 s2, 216
s_cselect_b32 s6, s6, 2147418112
v_add_u32 v2, 0, v1
v_mul_u32_u24 v3, 205, v2
v_lshrrev_b32 v3, 12, v3
v_mul_u32_u24 v4, 20, v3
v_sub_u32 v2, v2, v4
v_mul_u32_u24 v3, 1280, v3
v_lshl_add_u32 v2, v2, 4, v3
v_add_u32 v2, s6, v2
v_subrev_u32 v204, 0, v2
v_add_u32 v2, 64, v1
v_mul_u32_u24 v3, 205, v2
v_lshrrev_b32 v3, 12, v3
v_mul_u32_u24 v4, 20, v3
v_sub_u32 v2, v2, v4
v_mul_u32_u24 v3, 1280, v3
v_lshl_add_u32 v2, v2, 4, v3
v_add_u32 v2, s6, v2
v_subrev_u32 v205, 1024, v2
v_add_u32 v2, 128, v1
v_mul_u32_u24 v3, 205, v2
v_lshrrev_b32 v3, 12, v3
v_mul_u32_u24 v4, 20, v3
v_sub_u32 v2, v2, v4
v_mul_u32_u24 v3, 1280, v3
v_lshl_add_u32 v2, v2, 4, v3
v_add_u32 v2, s6, v2
v_subrev_u32 v206, 2048, v2
s_mul_i32 s6, s5, 2560
s_add_u32 s74, s6, 142592
v_lshrrev_b32 v2, 4, v1
v_bfe_u32 v4, v1, 2, 2
v_and_b32 v5, 3, v1
v_lshrrev_b32 v6, 5, v1
v_lshl_add_u32 v6, v6, 3, v4
v_lshlrev_b32 v6, 8, v6
s_lshl_b32 s6, s82, 1
v_xor_b32 v4, s6, v4
v_lshlrev_b32 v4, 2, v4
v_and_b32 v3, 1, v2
v_lshl_or_b32 v4, v3, 1, v4
v_lshrrev_b32 v3, 1, v5
v_or_b32 v4, v4, v3
v_lshl_add_u32 v6, v4, 4, v6
v_and_b32 v5, 1, v5
v_lshl_add_u32 v216, v5, 3, v6
v_xor_b32 v217, 64, v216
v_add_u32 v218, 0x10000, v216
v_add_u32 v219, 0x10000, v217
v_and_b32 v4, 31, v1
v_bfe_u32 v5, v1, 1, 3
v_lshrrev_b32 v6, 5, v1
v_xor_b32 v5, v5, v6
s_lshl_b32 s6, s83, 6
v_add_u32 v4, s6, v4
v_lshlrev_b32 v4, 7, v4
v_lshl_add_u32 v220, v5, 4, v4
v_xor_b32 v221, 32, v220
v_xor_b32 v222, 64, v220
v_xor_b32 v223, 96, v220
v_add_u32 v224, 0x10000, v220
v_add_u32 v225, 0x10000, v221
v_add_u32 v226, 0x10000, v222
v_add_u32 v227, 0x10000, v223
v_min_u32 v2, 53, v1
v_lshlrev_b32 v2, 2, v2
s_lshr_b32 s43, s95, 1
v_add_u32 v2, s43, v2
v_lshlrev_b32 v2, 7, v2
v_add_u32 v228, 0, v2
s_lshl_b32 s6, s77, 1
v_and_b32 v4, 1, v1
v_add_u32 v4, s6, v4
v_and_b32 v5, 3, v4
v_add_u32 v5, 28, v5
v_lshrrev_b32 v4, 2, v4
v_lshl_add_u32 v4, v5, 3, v4
v_lshlrev_b32 v4, 7, v4
v_add_u32 v231, 4, v4
v_and_b32 v2, 31, v1
v_and_b32 v3, 7, v2
v_lshrrev_b32 v2, 3, v2
v_lshlrev_b32 v2, 3, v2
v_add_u32 v2, s3, v2
v_lshl_add_u32 v2, v2, 3, v3
v_lshlrev_b32 v229, 7, v2
v_cmp_gt_u32 vcc, 14, v1
v_cndmask_b32 v2, 0, v1, vcc
v_cmp_lt_u32 vcc, 6, v2
v_cndmask_b32 v3, 0, 1, vcc
v_mul_u32_u24 v4, 7, v3
v_sub_u32 v2, v2, v4
s_lshr_b32 s6, s94, 1
s_and_b32 s7, s6, 3
s_lshr_b32 s6, s6, 2
s_lshl_b32 s6, s6, 1
v_lshlrev_b32 v2, 2, v2
v_add_u32 v2, s7, v2
v_add_u32 v3, s6, v3
v_lshl_add_u32 v2, v2, 3, v3
v_lshlrev_b32 v2, 7, v2
v_add_u32 v249, 16, v2
v_and_b32 v2, 31, v1
v_lshlrev_b32 v2, 3, v2
v_add_u32 v2, s95, v2
v_lshlrev_b32 v2, 7, v2
v_add_u32 v250, 20, v2
v_mov_b32 v2, 2147418112
s_cmp_lg_u32 s5, 0
s_cselect_b64 vcc, -1, 0
v_cndmask_b32 v228, v228, v2, vcc
v_cndmask_b32 v229, v229, v2, vcc
v_cndmask_b32 v231, v231, v2, vcc
v_cndmask_b32 v230, v230, v2, vcc
s_lshl_b32 s6, s4, 2
s_add_u32 s6, s6, s5
s_lshl_b32 s7, s6, 3
v_and_b32 v2, 7, v1
v_add_u32 v2, s7, v2
v_lshrrev_b32 v3, 3, v1
v_mul_u32_u24 v4, 4682, v2
v_lshrrev_b32 v4, 16, v4
v_mul_u32_u24 v5, 14, v4
v_sub_u32 v5, v2, v5
v_lshl_add_u32 v4, v3, 6, v4
v_mul_u32_u24 v4, 3456, v4
v_lshl_add_u32 v4, v5, 7, v4
s_and_b32 s7, s3, 1
s_mul_i32 s43, s7, 1792
v_add_u32 v4, s43, v4
s_sub_u32 s7, 13, s7
v_mov_b32 v6, 2147418112
v_cmp_lt_u32 vcc, s7, v5
v_cndmask_b32 v232, v4, v6, vcc
s_lshr_b32 s7, s3, 1
s_mul_i32 s7, s7, 655360
s_mul_i32 s6, s6, 5888
s_add_u32 s7, s7, s6
v_lshlrev_b32 v2, 7, v1
v_add_u32 v2, s7, v2
v_cmp_gt_u32 vcc, 46, v1
v_cndmask_b32 v233, v6, v2, vcc
s_mov_b32 s41, 1769472
buffer_load_dword v235, v233, s[8:11], 0 offen
s_mov_b32 exec_lo, 0xffffffff
s_mov_b32 exec_hi, 0xff
buffer_load_dword v234, v232, s[20:23], 0 offen
s_mov_b64 exec, -1
s_waitcnt vmcnt(6)
s_cmp_lg_u32 s5, 0
s_cbranch_scc1 L_arr_2
s_and_b32 s6, s2, 7
s_lshl_b32 s6, s6, 5
v_mov_b32 v2, s6
s_mov_b64 exec, 1
buffer_atomic_add v253, v2, s[52:55], 0 offen sc1
s_mov_b64 exec, -1
L_arr_2:
v_lshlrev_b32 v68, 16, v52
v_lshlrev_b32 v69, 16, v54
v_and_b32 v76, 0xffff0000, v52
v_and_b32 v77, 0xffff0000, v54
v_lshlrev_b32 v84, 16, v53
v_lshlrev_b32 v85, 16, v55
s_mov_b32 m0, s74
s_nop 0
buffer_load_dwordx4 v204, s[36:39], 0 offen lds
v_and_b32 v92, 0xffff0000, v53
v_and_b32 v93, 0xffff0000, v55
v_lshlrev_b32 v70, 16, v56
v_lshlrev_b32 v71, 16, v58
v_and_b32 v78, 0xffff0000, v56
v_and_b32 v79, 0xffff0000, v58
buffer_load_dwordx4 v205, s[36:39], 0 offen offset:1024 lds
v_lshlrev_b32 v86, 16, v57
v_lshlrev_b32 v87, 16, v59
v_and_b32 v94, 0xffff0000, v57
v_and_b32 v95, 0xffff0000, v59
v_lshlrev_b32 v72, 16, v60
v_lshlrev_b32 v73, 16, v62
s_mov_b32 exec_hi, 0
buffer_load_dwordx4 v206, s[36:39], 0 offen offset:2048 lds
s_mov_b64 exec, -1
v_and_b32 v80, 0xffff0000, v60
v_and_b32 v81, 0xffff0000, v62
v_lshlrev_b32 v88, 16, v61
v_lshlrev_b32 v89, 16, v63
v_and_b32 v96, 0xffff0000, v61
v_and_b32 v97, 0xffff0000, v63
s_add_u32 m0, s81, 0
s_nop 0
buffer_load_dwordx4 v208, s[20:23], s79 offen offset:0 lds
v_lshlrev_b32 v74, 16, v64
v_lshlrev_b32 v75, 16, v66
v_and_b32 v82, 0xffff0000, v64
v_and_b32 v83, 0xffff0000, v66
v_lshlrev_b32 v90, 16, v65
v_lshlrev_b32 v91, 16, v67
buffer_load_dwordx4 v209, s[20:23], s79 offen offset:1024 lds
v_and_b32 v98, 0xffff0000, v65
v_and_b32 v99, 0xffff0000, v67
s_waitcnt vmcnt(7)
v_lshlrev_b32 v100, 16, v8
v_and_b32 v101, 0xffff0000, v8
v_lshlrev_b32 v102, 16, v12
v_and_b32 v103, 0xffff0000, v12
v_lshlrev_b32 v104, 16, v16
v_and_b32 v105, 0xffff0000, v16
buffer_load_dwordx4 v210, s[20:23], s79 offen offset:2048 lds
v_lshlrev_b32 v106, 16, v20
v_and_b32 v107, 0xffff0000, v20
v_lshlrev_b32 v108, 16, v24
v_and_b32 v109, 0xffff0000, v24
v_lshlrev_b32 v110, 16, v28
v_and_b32 v111, 0xffff0000, v28
buffer_load_dwordx4 v211, s[20:23], s79 offen offset:3072 lds
v_lshlrev_b32 v112, 16, v32
v_and_b32 v113, 0xffff0000, v32
v_lshlrev_b32 v114, 16, v36
v_and_b32 v115, 0xffff0000, v36
v_lshlrev_b32 v116, 16, v40
v_and_b32 v117, 0xffff0000, v40
s_add_u32 m0, s81, 16384
s_nop 0
buffer_load_dwordx4 v212, s[8:11], s80 offen offset:0 lds
v_lshlrev_b32 v118, 16, v44
v_and_b32 v119, 0xffff0000, v44
v_lshlrev_b32 v120, 16, v48
v_and_b32 v121, 0xffff0000, v48
v_pk_mul_f32 v[122:123], v[106:107], v[68:69]
v_pk_mul_f32 v[124:125], v[108:109], v[68:69]
buffer_load_dwordx4 v213, s[8:11], s80 offen offset:1024 lds
v_pk_mul_f32 v[126:127], v[110:111], v[68:69]
v_pk_mul_f32 v[128:129], v[112:113], v[68:69]
v_pk_fma_f32 v[122:123], v[104:105], v[76:77], v[122:123]
v_pk_fma_f32 v[124:125], v[106:107], v[76:77], v[124:125]
v_pk_fma_f32 v[126:127], v[108:109], v[76:77], v[126:127]
v_pk_fma_f32 v[128:129], v[110:111], v[76:77], v[128:129]
buffer_load_dwordx4 v214, s[8:11], s80 offen offset:2048 lds
v_pk_fma_f32 v[122:123], v[102:103], v[84:85], v[122:123]
v_pk_fma_f32 v[124:125], v[104:105], v[84:85], v[124:125]
v_pk_fma_f32 v[126:127], v[106:107], v[84:85], v[126:127]
v_pk_fma_f32 v[128:129], v[108:109], v[84:85], v[128:129]
v_pk_fma_f32 v[122:123], v[100:101], v[92:93], v[122:123]
v_pk_fma_f32 v[124:125], v[102:103], v[92:93], v[124:125]
buffer_load_dwordx4 v215, s[8:11], s80 offen offset:3072 lds
v_pk_fma_f32 v[126:127], v[104:105], v[92:93], v[126:127]
v_pk_fma_f32 v[128:129], v[106:107], v[92:93], v[128:129]
v_pk_mul_f32 v[122:123], v[122:123], v[114:115]
v_pk_mul_f32 v[124:125], v[124:125], v[116:117]
v_pk_mul_f32 v[126:127], v[126:127], v[118:119]
v_pk_mul_f32 v[128:129], v[128:129], v[120:121]
s_add_u32 m0, s81, 32768
s_add_u32 s79, s79, 221184
buffer_load_dwordx4 v208, s[20:23], s79 offen offset:0 lds
s_mov_b32 exec_hi, 0xff
v_cvt_pk_bf16_f32 v100, v128, v126
v_cvt_pk_bf16_f32 v101, v124, v122
ds_write_b64 v7, v[100:101] offset:0
v_cvt_pk_bf16_f32 v102, v129, v127
v_cvt_pk_bf16_f32 v103, v125, v123
ds_write_b64 v7, v[102:103] offset:144
s_mov_b64 exec, -1
v_lshlrev_b32 v100, 16, v9
v_and_b32 v101, 0xffff0000, v9
v_lshlrev_b32 v102, 16, v13
v_and_b32 v103, 0xffff0000, v13
v_lshlrev_b32 v104, 16, v17
v_and_b32 v105, 0xffff0000, v17
buffer_load_dwordx4 v209, s[20:23], s79 offen offset:1024 lds
v_lshlrev_b32 v106, 16, v21
v_and_b32 v107, 0xffff0000, v21
v_lshlrev_b32 v108, 16, v25
v_and_b32 v109, 0xffff0000, v25
v_lshlrev_b32 v110, 16, v29
v_and_b32 v111, 0xffff0000, v29
buffer_load_dwordx4 v210, s[20:23], s79 offen offset:2048 lds
v_lshlrev_b32 v112, 16, v33
v_and_b32 v113, 0xffff0000, v33
v_lshlrev_b32 v114, 16, v37
v_and_b32 v115, 0xffff0000, v37
v_lshlrev_b32 v116, 16, v41
v_and_b32 v117, 0xffff0000, v41
buffer_load_dwordx4 v211, s[20:23], s79 offen offset:3072 lds
v_lshlrev_b32 v118, 16, v45
v_and_b32 v119, 0xffff0000, v45
v_lshlrev_b32 v120, 16, v49
v_and_b32 v121, 0xffff0000, v49
v_pk_mul_f32 v[122:123], v[106:107], v[70:71]
v_pk_mul_f32 v[124:125], v[108:109], v[70:71]
s_add_u32 m0, s81, 49152
s_add_u32 s80, s80, 128
buffer_load_dwordx4 v212, s[8:11], s80 offen offset:0 lds
v_pk_mul_f32 v[126:127], v[110:111], v[70:71]
v_pk_mul_f32 v[128:129], v[112:113], v[70:71]
v_pk_fma_f32 v[122:123], v[104:105], v[78:79], v[122:123]
v_pk_fma_f32 v[124:125], v[106:107], v[78:79], v[124:125]
v_pk_fma_f32 v[126:127], v[108:109], v[78:79], v[126:127]
v_pk_fma_f32 v[128:129], v[110:111], v[78:79], v[128:129]
buffer_load_dwordx4 v213, s[8:11], s80 offen offset:1024 lds
v_pk_fma_f32 v[122:123], v[102:103], v[86:87], v[122:123]
v_pk_fma_f32 v[124:125], v[104:105], v[86:87], v[124:125]
v_pk_fma_f32 v[126:127], v[106:107], v[86:87], v[126:127]
v_pk_fma_f32 v[128:129], v[108:109], v[86:87], v[128:129]
v_pk_fma_f32 v[122:123], v[100:101], v[94:95], v[122:123]
v_pk_fma_f32 v[124:125], v[102:103], v[94:95], v[124:125]
buffer_load_dwordx4 v214, s[8:11], s80 offen offset:2048 lds
v_pk_fma_f32 v[126:127], v[104:105], v[94:95], v[126:127]
v_pk_fma_f32 v[128:129], v[106:107], v[94:95], v[128:129]
v_pk_mul_f32 v[122:123], v[122:123], v[114:115]
v_pk_mul_f32 v[124:125], v[124:125], v[116:117]
v_pk_mul_f32 v[126:127], v[126:127], v[118:119]
v_pk_mul_f32 v[128:129], v[128:129], v[120:121]
buffer_load_dwordx4 v215, s[8:11], s80 offen offset:3072 lds
s_mov_b32 exec_hi, 0xff
v_cvt_pk_bf16_f32 v100, v128, v126
v_cvt_pk_bf16_f32 v101, v124, v122
ds_write_b64 v7, v[100:101] offset:288
v_cvt_pk_bf16_f32 v102, v129, v127
v_cvt_pk_bf16_f32 v103, v125, v123
ds_write_b64 v7, v[102:103] offset:432
s_mov_b64 exec, -1
v_lshlrev_b32 v100, 16, v10
v_and_b32 v101, 0xffff0000, v10
v_lshlrev_b32 v102, 16, v14
v_and_b32 v103, 0xffff0000, v14
v_lshlrev_b32 v104, 16, v18
v_and_b32 v105, 0xffff0000, v18
v_lshlrev_b32 v106, 16, v22
v_and_b32 v107, 0xffff0000, v22
v_lshlrev_b32 v108, 16, v26
v_and_b32 v109, 0xffff0000, v26
v_lshlrev_b32 v110, 16, v30
v_and_b32 v111, 0xffff0000, v30
v_lshlrev_b32 v112, 16, v34
v_and_b32 v113, 0xffff0000, v34
v_lshlrev_b32 v114, 16, v38
v_and_b32 v115, 0xffff0000, v38
v_lshlrev_b32 v116, 16, v42
v_and_b32 v117, 0xffff0000, v42
v_lshlrev_b32 v118, 16, v46
v_and_b32 v119, 0xffff0000, v46
v_lshlrev_b32 v120, 16, v50
v_and_b32 v121, 0xffff0000, v50
v_pk_mul_f32 v[122:123], v[106:107], v[72:73]
v_pk_mul_f32 v[124:125], v[108:109], v[72:73]
v_pk_mul_f32 v[126:127], v[110:111], v[72:73]
v_pk_mul_f32 v[128:129], v[112:113], v[72:73]
v_pk_fma_f32 v[122:123], v[104:105], v[80:81], v[122:123]
v_pk_fma_f32 v[124:125], v[106:107], v[80:81], v[124:125]
v_pk_fma_f32 v[126:127], v[108:109], v[80:81], v[126:127]
v_pk_fma_f32 v[128:129], v[110:111], v[80:81], v[128:129]
v_pk_fma_f32 v[122:123], v[102:103], v[88:89], v[122:123]
v_pk_fma_f32 v[124:125], v[104:105], v[88:89], v[124:125]
v_pk_fma_f32 v[126:127], v[106:107], v[88:89], v[126:127]
v_pk_fma_f32 v[128:129], v[108:109], v[88:89], v[128:129]
v_pk_fma_f32 v[122:123], v[100:101], v[96:97], v[122:123]
v_pk_fma_f32 v[124:125], v[102:103], v[96:97], v[124:125]
v_pk_fma_f32 v[126:127], v[104:105], v[96:97], v[126:127]
v_pk_fma_f32 v[128:129], v[106:107], v[96:97], v[128:129]
v_pk_mul_f32 v[122:123], v[122:123], v[114:115]
v_pk_mul_f32 v[124:125], v[124:125], v[116:117]
v_pk_mul_f32 v[126:127], v[126:127], v[118:119]
v_pk_mul_f32 v[128:129], v[128:129], v[120:121]
s_mov_b32 exec_hi, 0xff
v_cvt_pk_bf16_f32 v100, v128, v126
v_cvt_pk_bf16_f32 v101, v124, v122
ds_write_b64 v7, v[100:101] offset:576
v_cvt_pk_bf16_f32 v102, v129, v127
v_cvt_pk_bf16_f32 v103, v125, v123
ds_write_b64 v7, v[102:103] offset:720
s_mov_b64 exec, -1
v_lshlrev_b32 v100, 16, v11
v_and_b32 v101, 0xffff0000, v11
v_lshlrev_b32 v102, 16, v15
v_and_b32 v103, 0xffff0000, v15
v_lshlrev_b32 v104, 16, v19
v_and_b32 v105, 0xffff0000, v19
v_lshlrev_b32 v106, 16, v23
v_and_b32 v107, 0xffff0000, v23
v_lshlrev_b32 v108, 16, v27
v_and_b32 v109, 0xffff0000, v27
v_lshlrev_b32 v110, 16, v31
v_and_b32 v111, 0xffff0000, v31
v_lshlrev_b32 v112, 16, v35
v_and_b32 v113, 0xffff0000, v35
v_lshlrev_b32 v114, 16, v39
v_and_b32 v115, 0xffff0000, v39
v_lshlrev_b32 v116, 16, v43
v_and_b32 v117, 0xffff0000, v43
v_lshlrev_b32 v118, 16, v47
v_and_b32 v119, 0xffff0000, v47
v_lshlrev_b32 v120, 16, v51
v_and_b32 v121, 0xffff0000, v51
v_pk_mul_f32 v[122:123], v[106:107], v[74:75]
v_pk_mul_f32 v[124:125], v[108:109], v[74:75]
v_pk_mul_f32 v[126:127], v[110:111], v[74:75]
v_pk_mul_f32 v[128:129], v[112:113], v[74:75]
v_pk_fma_f32 v[122:123], v[104:105], v[82:83], v[122:123]
v_pk_fma_f32 v[124:125], v[106:107], v[82:83], v[124:125]
v_pk_fma_f32 v[126:127], v[108:109], v[82:83], v[126:127]
v_pk_fma_f32 v[128:129], v[110:111], v[82:83], v[128:129]
v_pk_fma_f32 v[122:123], v[102:103], v[90:91], v[122:123]
v_pk_fma_f32 v[124:125], v[104:105], v[90:91], v[124:125]
v_pk_fma_f32 v[126:127], v[106:107], v[90:91], v[126:127]
v_pk_fma_f32 v[128:129], v[108:109], v[90:91], v[128:129]
v_pk_fma_f32 v[122:123], v[100:101], v[98:99], v[122:123]
v_pk_fma_f32 v[124:125], v[102:103], v[98:99], v[124:125]
v_pk_fma_f32 v[126:127], v[104:105], v[98:99], v[126:127]
v_pk_fma_f32 v[128:129], v[106:107], v[98:99], v[128:129]
v_pk_mul_f32 v[122:123], v[122:123], v[114:115]
v_pk_mul_f32 v[124:125], v[124:125], v[116:117]
v_pk_mul_f32 v[126:127], v[126:127], v[118:119]
v_pk_mul_f32 v[128:129], v[128:129], v[120:121]
s_mov_b32 exec_hi, 0xff
v_cvt_pk_bf16_f32 v100, v128, v126
v_cvt_pk_bf16_f32 v101, v124, v122
ds_write_b64 v7, v[100:101] offset:864
v_cvt_pk_bf16_f32 v102, v129, v127
v_cvt_pk_bf16_f32 v103, v125, v123
ds_write_b64 v7, v[102:103] offset:1008
s_mov_b64 exec, -1
v_lshrrev_b32 v2, 4, v1
v_bfe_u32 v3, v1, 2, 2
v_lshrrev_b32 v4, 1, v2
v_lshlrev_b32 v4, 4, v4
v_and_b32 v2, 1, v2
v_lshl_add_u32 v2, v2, 2, v3
v_add_u32 v2, v2, v4
v_mul_u32_u24 v2, 320, v2
v_and_b32 v3, 3, v1
v_mul_u32_u24 v3, 40, v3
v_add_u32 v2, v2, v3
v_add_u32 v204, 142592, v2
s_and_b32 s6, s2, 3
s_lshl_b32 s6, s6, 1
s_mul_i32 s6, s6, 54
s_lshr_b32 s7, s2, 2
s_add_u32 s6, s6, s7
s_mul_i32 s74, s6, 5120
s_add_u32 s74, s74, 7340032
v_mov_b32 v205, 2147418112
s_cmp_lt_u32 s2, 216
s_cselect_b64 vcc, -1, 0
v_cndmask_b32 v205, v205, v248, vcc
v_lshrrev_b32 v2, 3, v1
s_mul_i32 s6, s5, 20
v_add_u32 v2, s6, v2
v_and_b32 v3, 7, v1
v_lshlrev_b32 v3, 4, v3
v_mul_u32_u24 v4, 144, v2
v_add_u32 v4, v4, v3
v_add_u32 v4, 131072, v4
v_lshl_add_u32 v5, v2, 12, v3
s_mul_i32 s6, s69, 327680
s_lshl_b32 s7, s68, 7
s_sub_u32 s6, s6, s7
s_add_u32 s70, s6, 1052544
s_add_u32 s71, s70, 32768
s_add_u32 s72, s70, 65536
s_waitcnt vmcnt(16)
s_waitcnt lgkmcnt(0)
s_barrier
ds_read_b128 v[8:11], v4
ds_read_b128 v[12:15], v4 offset:1152
ds_read_b128 v[16:19], v4 offset:2304
s_add_u32 s6, s5, 0
s_cmp_ge_u32 s6, 5
s_cselect_b32 s7, 5, 0
s_cselect_b32 s43, 276480, 0
s_cselect_b32 s75, 160, 0
s_sub_u32 s6, s6, s7
s_lshl_b32 s7, s6, 3
s_add_u32 s75, s75, s7
v_add_u32 v2, s75, v204
s_lshl_b32 s6, s6, 10
s_add_u32 s6, s6, s43
s_add_u32 s75, s6, s74
ds_read_b64_tr_b16 v[20:21], v2
ds_read_b64_tr_b16 v[22:23], v2 offset:2560
s_add_u32 s6, s5, 4
s_cmp_ge_u32 s6, 5
s_cselect_b32 s7, 5, 0
s_cselect_b32 s43, 276480, 0
s_cselect_b32 s76, 160, 0
s_sub_u32 s6, s6, s7
s_lshl_b32 s7, s6, 3
s_add_u32 s76, s76, s7
v_add_u32 v2, s76, v204
s_lshl_b32 s6, s6, 10
s_add_u32 s6, s6, s43
s_add_u32 s76, s6, s74
ds_read_b64_tr_b16 v[24:25], v2
ds_read_b64_tr_b16 v[26:27], v2 offset:2560
s_add_u32 s6, s5, 8
s_cmp_ge_u32 s6, 5
s_cselect_b32 s7, 5, 0
s_cselect_b32 s43, 276480, 0
s_cselect_b32 s93, 160, 0
s_sub_u32 s6, s6, s7
s_lshl_b32 s7, s6, 3
s_add_u32 s93, s93, s7
v_add_u32 v2, s93, v204
s_lshl_b32 s6, s6, 10
s_add_u32 s6, s6, s43
s_add_u32 s93, s6, s74
ds_read_b64_tr_b16 v[28:29], v2
ds_read_b64_tr_b16 v[30:31], v2 offset:2560
v_mov_b32 v172, v5
s_cmp_ge_u32 s5, 2
s_cselect_b64 vcc, -1, 0
v_mov_b32 v3, 2147418112
v_cndmask_b32 v173, v205, v3, vcc
v_mov_b32 v64, 0
v_mov_b32 v65, 0
v_mov_b32 v66, 0
v_mov_b32 v67, 0
v_mov_b32 v68, 0
v_mov_b32 v69, 0
v_mov_b32 v70, 0
v_mov_b32 v71, 0
v_mov_b32 v72, 0
v_mov_b32 v73, 0
v_mov_b32 v74, 0
v_mov_b32 v75, 0
v_mov_b32 v76, 0
v_mov_b32 v77, 0
v_mov_b32 v78, 0
v_mov_b32 v79, 0
v_mov_b32 v80, 0
v_mov_b32 v81, 0
v_mov_b32 v82, 0
v_mov_b32 v83, 0
v_mov_b32 v84, 0
v_mov_b32 v85, 0
v_mov_b32 v86, 0
v_mov_b32 v87, 0
v_mov_b32 v88, 0
v_mov_b32 v89, 0
v_mov_b32 v90, 0
v_mov_b32 v91, 0
v_mov_b32 v92, 0
v_mov_b32 v93, 0
v_mov_b32 v94, 0
v_mov_b32 v95, 0
v_mov_b32 v96, 0
v_mov_b32 v97, 0
v_mov_b32 v98, 0
v_mov_b32 v99, 0
v_mov_b32 v100, 0
v_mov_b32 v101, 0
v_mov_b32 v102, 0
v_mov_b32 v103, 0
v_mov_b32 v104, 0
v_mov_b32 v105, 0
v_mov_b32 v106, 0
v_mov_b32 v107, 0
v_mov_b32 v108, 0
v_mov_b32 v109, 0
v_mov_b32 v110, 0
v_mov_b32 v111, 0
v_mov_b32 v112, 0
v_mov_b32 v113, 0
v_mov_b32 v114, 0
v_mov_b32 v115, 0
v_mov_b32 v116, 0
v_mov_b32 v117, 0
v_mov_b32 v118, 0
v_mov_b32 v119, 0
v_mov_b32 v120, 0
v_mov_b32 v121, 0
v_mov_b32 v122, 0
v_mov_b32 v123, 0
v_mov_b32 v124, 0
v_mov_b32 v125, 0
v_mov_b32 v126, 0
v_mov_b32 v127, 0
v_and_b32 v2, 15, v1
v_bfe_u32 v3, v1, 4, 1
v_lshlrev_b32 v3, 2, v3
v_cmp_eq_u32 vcc, v2, v3
v_mov_b32 v2, 0x3f803f80
v_cndmask_b32 v160, 0, v2, vcc
v_mov_b32 v161, v160
v_mov_b32 v162, v160
v_mov_b32 v163, v160
v_mov_b32 v164, 0
v_mov_b32 v165, 0
v_mov_b32 v166, 0
v_mov_b32 v167, 0
v_mov_b32 v168, 0
v_mov_b32 v169, 0
v_mov_b32 v170, 0
v_mov_b32 v171, 0
s_waitcnt lgkmcnt(0)
s_waitcnt vmcnt(8)
s_barrier
ds_read_b64_tr_b16 v[128:129], v216 offset:0
ds_read_b64_tr_b16 v[130:131], v216 offset:1024
ds_read_b128 v[136:139], v220 offset:16384
ds_read_b128 v[140:143], v220 offset:20480
ds_read_b64_tr_b16 v[132:133], v217 offset:0
ds_read_b64_tr_b16 v[134:135], v217 offset:1024
s_add_u32 m0, s81, 65536
s_add_u32 s79, s79, 221184
buffer_load_dwordx4 v208, s[20:23], s79 offen offset:0 lds
buffer_load_dwordx4 v209, s[20:23], s79 offen offset:1024 lds
buffer_load_dwordx4 v210, s[20:23], s79 offen offset:2048 lds
buffer_load_dwordx4 v211, s[20:23], s79 offen offset:3072 lds
s_waitcnt lgkmcnt(3)
v_mfma_f32_32x32x16_bf16 v[64:79], v[128:131], v[136:139], v[64:79]
ds_read_b64_tr_b16 v[144:145], v216 offset:4096
ds_read_b64_tr_b16 v[146:147], v216 offset:5120
s_add_u32 m0, s81, 81920
s_waitcnt lgkmcnt(4)
v_mfma_f32_32x32x16_bf16 v[80:95], v[128:131], v[140:143], v[80:95]
v_mfma_f32_16x16x32_bf16 v[164:167], v[160:163], v[128:131], v[164:167]
ds_read_b128 v[152:155], v221 offset:16384
ds_read_b128 v[156:159], v221 offset:20480
s_add_u32 s80, s80, 128
buffer_load_dwordx4 v212, s[8:11], s80 offen offset:0 lds
s_waitcnt lgkmcnt(4)
v_mfma_f32_32x32x16_bf16 v[96:111], v[132:135], v[136:139], v[96:111]
ds_read_b64_tr_b16 v[148:149], v217 offset:4096
ds_read_b64_tr_b16 v[150:151], v217 offset:5120
buffer_load_dwordx4 v213, s[8:11], s80 offen offset:1024 lds
v_mfma_f32_32x32x16_bf16 v[112:127], v[132:135], v[140:143], v[112:127]
v_mfma_f32_16x16x32_bf16 v[168:171], v[160:163], v[132:135], v[168:171]
buffer_load_dwordx4 v214, s[8:11], s80 offen offset:2048 lds
buffer_load_dwordx4 v215, s[8:11], s80 offen offset:3072 lds
s_waitcnt lgkmcnt(3)
v_mfma_f32_32x32x16_bf16 v[64:79], v[144:147], v[152:155], v[64:79]
ds_read_b64_tr_b16 v[128:129], v216 offset:8192
ds_read_b64_tr_b16 v[130:131], v216 offset:9216
s_add_u32 m0, s81, 98304
s_waitcnt lgkmcnt(4)
v_mfma_f32_32x32x16_bf16 v[80:95], v[144:147], v[156:159], v[80:95]
v_mfma_f32_16x16x32_bf16 v[164:167], v[160:163], v[144:147], v[164:167]
ds_read_b128 v[136:139], v222 offset:16384
ds_read_b128 v[140:143], v222 offset:20480
s_add_u32 s79, s79, 221184
buffer_load_dwordx4 v208, s[20:23], s79 offen offset:0 lds
s_waitcnt lgkmcnt(4)
v_mfma_f32_32x32x16_bf16 v[96:111], v[148:151], v[152:155], v[96:111]
ds_read_b64_tr_b16 v[132:133], v217 offset:8192
ds_read_b64_tr_b16 v[134:135], v217 offset:9216
buffer_load_dwordx4 v209, s[20:23], s79 offen offset:1024 lds
v_mfma_f32_32x32x16_bf16 v[112:127], v[148:151], v[156:159], v[112:127]
v_mfma_f32_16x16x32_bf16 v[168:171], v[160:163], v[148:151], v[168:171]
buffer_load_dwordx4 v210, s[20:23], s79 offen offset:2048 lds
buffer_load_dwordx4 v211, s[20:23], s79 offen offset:3072 lds
s_waitcnt lgkmcnt(3)
v_mfma_f32_32x32x16_bf16 v[64:79], v[128:131], v[136:139], v[64:79]
ds_read_b64_tr_b16 v[144:145], v216 offset:12288
ds_read_b64_tr_b16 v[146:147], v216 offset:13312
s_add_u32 m0, s81, 114688
s_waitcnt lgkmcnt(4)
v_mfma_f32_32x32x16_bf16 v[80:95], v[128:131], v[140:143], v[80:95]
v_mfma_f32_16x16x32_bf16 v[164:167], v[160:163], v[128:131], v[164:167]
ds_read_b128 v[152:155], v223 offset:16384
ds_read_b128 v[156:159], v223 offset:20480
s_add_u32 s80, s80, 128
buffer_load_dwordx4 v212, s[8:11], s80 offen offset:0 lds
s_waitcnt lgkmcnt(4)
v_mfma_f32_32x32x16_bf16 v[96:111], v[132:135], v[136:139], v[96:111]
ds_read_b64_tr_b16 v[148:149], v217 offset:12288
ds_read_b64_tr_b16 v[150:151], v217 offset:13312
buffer_load_dwordx4 v213, s[8:11], s80 offen offset:1024 lds
buffer_load_dwordx4 v214, s[8:11], s80 offen offset:2048 lds
v_mfma_f32_32x32x16_bf16 v[112:127], v[132:135], v[140:143], v[112:127]
v_mfma_f32_16x16x32_bf16 v[168:171], v[160:163], v[132:135], v[168:171]
buffer_load_dwordx4 v215, s[8:11], s80 offen offset:3072 lds
s_mov_b32 exec_lo, 0x0
s_mov_b32 exec_hi, 0xff00
buffer_load_dword v234, v232, s[20:23], 0 offen
s_mov_b64 exec, -1
s_waitcnt lgkmcnt(0)
s_waitcnt vmcnt(17)
s_barrier
v_mfma_f32_32x32x16_bf16 v[64:79], v[144:147], v[152:155], v[64:79]
ds_read_b64_tr_b16 v[128:129], v216 offset:32768
ds_read_b64_tr_b16 v[130:131], v216 offset:33792
s_add_u32 m0, s81, 0
v_mfma_f32_32x32x16_bf16 v[80:95], v[144:147], v[156:159], v[80:95]
v_mfma_f32_16x16x32_bf16 v[164:167], v[160:163], v[144:147], v[164:167]
ds_read_b128 v[136:139], v220 offset:49152
ds_read_b128 v[140:143], v220 offset:53248
s_add_u32 s79, s79, 221184
v_mfma_f32_32x32x16_bf16 v[96:111], v[148:151], v[152:155], v[96:111]
ds_read_b64_tr_b16 v[132:133], v217 offset:32768
ds_read_b64_tr_b16 v[134:135], v217 offset:33792
buffer_load_dwordx4 v208, s[20:23], s79 offen offset:0 lds
v_mfma_f32_32x32x16_bf16 v[112:127], v[148:151], v[156:159], v[112:127]
v_mfma_f32_16x16x32_bf16 v[168:171], v[160:163], v[148:151], v[168:171]
buffer_load_dwordx4 v209, s[20:23], s79 offen offset:1024 lds
s_waitcnt lgkmcnt(3)
v_mfma_f32_32x32x16_bf16 v[64:79], v[128:131], v[136:139], v[64:79]
ds_read_b64_tr_b16 v[144:145], v216 offset:36864
ds_read_b64_tr_b16 v[146:147], v216 offset:37888
s_waitcnt lgkmcnt(4)
v_mfma_f32_32x32x16_bf16 v[80:95], v[128:131], v[140:143], v[80:95]
v_mfma_f32_16x16x32_bf16 v[164:167], v[160:163], v[128:131], v[164:167]
ds_read_b128 v[152:155], v221 offset:49152
ds_read_b128 v[156:159], v221 offset:53248
buffer_load_dwordx4 v210, s[20:23], s79 offen offset:2048 lds
s_waitcnt lgkmcnt(4)
v_mfma_f32_32x32x16_bf16 v[96:111], v[132:135], v[136:139], v[96:111]
ds_read_b64_tr_b16 v[148:149], v217 offset:36864
ds_read_b64_tr_b16 v[150:151], v217 offset:37888
buffer_load_dwordx4 v211, s[20:23], s79 offen offset:3072 lds
v_mfma_f32_32x32x16_bf16 v[112:127], v[132:135], v[140:143], v[112:127]
v_mfma_f32_16x16x32_bf16 v[168:171], v[160:163], v[132:135], v[168:171]
buffer_store_dwordx4 v[8:11], v172, s[24:27], s70 offen sc1
s_waitcnt lgkmcnt(3)
v_mfma_f32_32x32x16_bf16 v[64:79], v[144:147], v[152:155], v[64:79]
ds_read_b64_tr_b16 v[128:129], v216 offset:40960
ds_read_b64_tr_b16 v[130:131], v216 offset:41984
s_add_u32 m0, s81, 16384
s_waitcnt lgkmcnt(4)
v_mfma_f32_32x32x16_bf16 v[80:95], v[144:147], v[156:159], v[80:95]
v_mfma_f32_16x16x32_bf16 v[164:167], v[160:163], v[144:147], v[164:167]
ds_read_b128 v[136:139], v222 offset:49152
ds_read_b128 v[140:143], v222 offset:53248
s_add_u32 s80, s80, 128
s_waitcnt lgkmcnt(4)
v_mfma_f32_32x32x16_bf16 v[96:111], v[148:151], v[152:155], v[96:111]
ds_read_b64_tr_b16 v[132:133], v217 offset:40960
ds_read_b64_tr_b16 v[134:135], v217 offset:41984
buffer_load_dwordx4 v212, s[8:11], s80 offen offset:0 lds
v_mfma_f32_32x32x16_bf16 v[112:127], v[148:151], v[156:159], v[112:127]
v_mfma_f32_16x16x32_bf16 v[168:171], v[160:163], v[148:151], v[168:171]
buffer_load_dwordx4 v213, s[8:11], s80 offen offset:1024 lds
s_waitcnt lgkmcnt(3)
v_mfma_f32_32x32x16_bf16 v[64:79], v[128:131], v[136:139], v[64:79]
ds_read_b64_tr_b16 v[144:145], v216 offset:45056
ds_read_b64_tr_b16 v[146:147], v216 offset:46080
s_waitcnt lgkmcnt(4)
v_mfma_f32_32x32x16_bf16 v[80:95], v[128:131], v[140:143], v[80:95]
v_mfma_f32_16x16x32_bf16 v[164:167], v[160:163], v[128:131], v[164:167]
ds_read_b128 v[152:155], v223 offset:49152
ds_read_b128 v[156:159], v223 offset:53248
buffer_load_dwordx4 v214, s[8:11], s80 offen offset:2048 lds
s_waitcnt lgkmcnt(4)
v_mfma_f32_32x32x16_bf16 v[96:111], v[132:135], v[136:139], v[96:111]
ds_read_b64_tr_b16 v[148:149], v217 offset:45056
ds_read_b64_tr_b16 v[150:151], v217 offset:46080
buffer_load_dwordx4 v215, s[8:11], s80 offen offset:3072 lds
v_mfma_f32_32x32x16_bf16 v[112:127], v[132:135], v[140:143], v[112:127]
v_mfma_f32_16x16x32_bf16 v[168:171], v[160:163], v[132:135], v[168:171]
s_mov_b32 exec_lo, 0x0
s_mov_b32 exec_hi, 0xff0000
buffer_load_dword v234, v232, s[20:23], 0 offen
s_mov_b64 exec, -1
s_waitcnt lgkmcnt(0)
s_waitcnt vmcnt(19)
s_barrier
buffer_load_dword v254, v230, s[52:55], 0 offen sc1
v_mfma_f32_32x32x16_bf16 v[64:79], v[144:147], v[152:155], v[64:79]
ds_read_b64_tr_b16 v[128:129], v218 offset:0
ds_read_b64_tr_b16 v[130:131], v218 offset:1024
s_add_u32 m0, s81, 32768
v_mfma_f32_32x32x16_bf16 v[80:95], v[144:147], v[156:159], v[80:95]
v_mfma_f32_16x16x32_bf16 v[164:167], v[160:163], v[144:147], v[164:167]
ds_read_b128 v[136:139], v224 offset:16384
ds_read_b128 v[140:143], v224 offset:20480
s_add_u32 s79, s79, 221184
v_mfma_f32_32x32x16_bf16 v[96:111], v[148:151], v[152:155], v[96:111]
ds_read_b64_tr_b16 v[132:133], v219 offset:0
ds_read_b64_tr_b16 v[134:135], v219 offset:1024
buffer_load_dwordx4 v208, s[20:23], s79 offen offset:0 lds
v_mfma_f32_32x32x16_bf16 v[112:127], v[148:151], v[156:159], v[112:127]
v_mfma_f32_16x16x32_bf16 v[168:171], v[160:163], v[148:151], v[168:171]
buffer_load_dwordx4 v209, s[20:23], s79 offen offset:1024 lds
s_waitcnt lgkmcnt(3)
v_mfma_f32_32x32x16_bf16 v[64:79], v[128:131], v[136:139], v[64:79]
ds_read_b64_tr_b16 v[144:145], v218 offset:4096
ds_read_b64_tr_b16 v[146:147], v218 offset:5120
s_waitcnt lgkmcnt(4)
v_mfma_f32_32x32x16_bf16 v[80:95], v[128:131], v[140:143], v[80:95]
v_mfma_f32_16x16x32_bf16 v[164:167], v[160:163], v[128:131], v[164:167]
ds_read_b128 v[152:155], v225 offset:16384
ds_read_b128 v[156:159], v225 offset:20480
buffer_load_dwordx4 v210, s[20:23], s79 offen offset:2048 lds
s_waitcnt lgkmcnt(4)
v_mfma_f32_32x32x16_bf16 v[96:111], v[132:135], v[136:139], v[96:111]
ds_read_b64_tr_b16 v[148:149], v219 offset:4096
ds_read_b64_tr_b16 v[150:151], v219 offset:5120
buffer_load_dwordx4 v211, s[20:23], s79 offen offset:3072 lds
v_mfma_f32_32x32x16_bf16 v[112:127], v[132:135], v[140:143], v[112:127]
v_mfma_f32_16x16x32_bf16 v[168:171], v[160:163], v[132:135], v[168:171]
buffer_store_dwordx4 v[12:15], v172, s[24:27], s71 offen sc1
s_waitcnt lgkmcnt(3)
v_mfma_f32_32x32x16_bf16 v[64:79], v[144:147], v[152:155], v[64:79]
ds_read_b64_tr_b16 v[128:129], v218 offset:8192
ds_read_b64_tr_b16 v[130:131], v218 offset:9216
s_add_u32 m0, s81, 49152
s_waitcnt lgkmcnt(4)
v_mfma_f32_32x32x16_bf16 v[80:95], v[144:147], v[156:159], v[80:95]
v_mfma_f32_16x16x32_bf16 v[164:167], v[160:163], v[144:147], v[164:167]
ds_read_b128 v[136:139], v226 offset:16384
ds_read_b128 v[140:143], v226 offset:20480
s_add_u32 s80, s80, 128
s_waitcnt lgkmcnt(4)
v_mfma_f32_32x32x16_bf16 v[96:111], v[148:151], v[152:155], v[96:111]
ds_read_b64_tr_b16 v[132:133], v219 offset:8192
ds_read_b64_tr_b16 v[134:135], v219 offset:9216
buffer_load_dwordx4 v212, s[8:11], s80 offen offset:0 lds
v_mfma_f32_32x32x16_bf16 v[112:127], v[148:151], v[156:159], v[112:127]
v_mfma_f32_16x16x32_bf16 v[168:171], v[160:163], v[148:151], v[168:171]
buffer_load_dwordx4 v213, s[8:11], s80 offen offset:1024 lds
s_waitcnt lgkmcnt(3)
v_mfma_f32_32x32x16_bf16 v[64:79], v[128:131], v[136:139], v[64:79]
ds_read_b64_tr_b16 v[144:145], v218 offset:12288
ds_read_b64_tr_b16 v[146:147], v218 offset:13312
s_waitcnt lgkmcnt(4)
v_mfma_f32_32x32x16_bf16 v[80:95], v[128:131], v[140:143], v[80:95]
v_mfma_f32_16x16x32_bf16 v[164:167], v[160:163], v[128:131], v[164:167]
ds_read_b128 v[152:155], v227 offset:16384
ds_read_b128 v[156:159], v227 offset:20480
buffer_load_dwordx4 v214, s[8:11], s80 offen offset:2048 lds
s_waitcnt lgkmcnt(4)
v_mfma_f32_32x32x16_bf16 v[96:111], v[132:135], v[136:139], v[96:111]
ds_read_b64_tr_b16 v[148:149], v219 offset:12288
ds_read_b64_tr_b16 v[150:151], v219 offset:13312
buffer_load_dwordx4 v215, s[8:11], s80 offen offset:3072 lds
v_mfma_f32_32x32x16_bf16 v[112:127], v[132:135], v[140:143], v[112:127]
v_mfma_f32_16x16x32_bf16 v[168:171], v[160:163], v[132:135], v[168:171]
s_mov_b32 exec_lo, 0x0
s_mov_b32 exec_hi, 0xff000000
buffer_load_dword v234, v232, s[20:23], 0 offen
s_mov_b64 exec, -1
s_waitcnt lgkmcnt(0)
s_waitcnt vmcnt(22)
s_barrier
v_mfma_f32_32x32x16_bf16 v[64:79], v[144:147], v[152:155], v[64:79]
ds_read_b64_tr_b16 v[128:129], v218 offset:32768
ds_read_b64_tr_b16 v[130:131], v218 offset:33792
s_add_u32 m0, s81, 65536
v_mfma_f32_32x32x16_bf16 v[80:95], v[144:147], v[156:159], v[80:95]
v_mfma_f32_16x16x32_bf16 v[164:167], v[160:163], v[144:147], v[164:167]
ds_read_b128 v[136:139], v224 offset:49152
ds_read_b128 v[140:143], v224 offset:53248
s_add_u32 s79, s79, 221184
v_mfma_f32_32x32x16_bf16 v[96:111], v[148:151], v[152:155], v[96:111]
ds_read_b64_tr_b16 v[132:133], v219 offset:32768
ds_read_b64_tr_b16 v[134:135], v219 offset:33792
buffer_load_dwordx4 v208, s[20:23], s79 offen offset:0 lds
v_mfma_f32_32x32x16_bf16 v[112:127], v[148:151], v[156:159], v[112:127]
v_mfma_f32_16x16x32_bf16 v[168:171], v[160:163], v[148:151], v[168:171]
buffer_load_dwordx4 v209, s[20:23], s79 offen offset:1024 lds
s_waitcnt lgkmcnt(3)
v_mfma_f32_32x32x16_bf16 v[64:79], v[128:131], v[136:139], v[64:79]
ds_read_b64_tr_b16 v[144:145], v218 offset:36864
ds_read_b64_tr_b16 v[146:147], v218 offset:37888
s_waitcnt lgkmcnt(4)
v_mfma_f32_32x32x16_bf16 v[80:95], v[128:131], v[140:143], v[80:95]
v_mfma_f32_16x16x32_bf16 v[164:167], v[160:163], v[128:131], v[164:167]
ds_read_b128 v[152:155], v225 offset:49152
ds_read_b128 v[156:159], v225 offset:53248
buffer_load_dwordx4 v210, s[20:23], s79 offen offset:2048 lds
s_waitcnt lgkmcnt(4)
v_mfma_f32_32x32x16_bf16 v[96:111], v[132:135], v[136:139], v[96:111]
ds_read_b64_tr_b16 v[148:149], v219 offset:36864
ds_read_b64_tr_b16 v[150:151], v219 offset:37888
buffer_load_dwordx4 v211, s[20:23], s79 offen offset:3072 lds
v_mfma_f32_32x32x16_bf16 v[112:127], v[132:135], v[140:143], v[112:127]
v_mfma_f32_16x16x32_bf16 v[168:171], v[160:163], v[132:135], v[168:171]
s_mov_b32 exec_hi, 0
buffer_store_dwordx4 v[16:19], v172, s[24:27], s72 offen sc1
s_mov_b64 exec, -1
s_waitcnt lgkmcnt(3)
v_mfma_f32_32x32x16_bf16 v[64:79], v[144:147], v[152:155], v[64:79]
ds_read_b64_tr_b16 v[128:129], v218 offset:40960
ds_read_b64_tr_b16 v[130:131], v218 offset:41984
s_add_u32 m0, s81, 81920
s_waitcnt lgkmcnt(4)
v_mfma_f32_32x32x16_bf16 v[80:95], v[144:147], v[156:159], v[80:95]
v_mfma_f32_16x16x32_bf16 v[164:167], v[160:163], v[144:147], v[164:167]
ds_read_b128 v[136:139], v226 offset:49152
ds_read_b128 v[140:143], v226 offset:53248
s_add_u32 s80, s80, 128
s_waitcnt lgkmcnt(4)
v_mfma_f32_32x32x16_bf16 v[96:111], v[148:151], v[152:155], v[96:111]
ds_read_b64_tr_b16 v[132:133], v219 offset:40960
ds_read_b64_tr_b16 v[134:135], v219 offset:41984
buffer_load_dwordx4 v212, s[8:11], s80 offen offset:0 lds
v_mfma_f32_32x32x16_bf16 v[112:127], v[148:151], v[156:159], v[112:127]
v_mfma_f32_16x16x32_bf16 v[168:171], v[160:163], v[148:151], v[168:171]
buffer_load_dwordx4 v213, s[8:11], s80 offen offset:1024 lds
s_waitcnt lgkmcnt(3)
v_mfma_f32_32x32x16_bf16 v[64:79], v[128:131], v[136:139], v[64:79]
ds_read_b64_tr_b16 v[144:145], v218 offset:45056
ds_read_b64_tr_b16 v[146:147], v218 offset:46080
s_waitcnt lgkmcnt(4)
v_mfma_f32_32x32x16_bf16 v[80:95], v[128:131], v[140:143], v[80:95]
v_mfma_f32_16x16x32_bf16 v[164:167], v[160:163], v[128:131], v[164:167]
ds_read_b128 v[152:155], v227 offset:49152
ds_read_b128 v[156:159], v227 offset:53248
buffer_load_dwordx4 v214, s[8:11], s80 offen offset:2048 lds
s_waitcnt lgkmcnt(4)
v_mfma_f32_32x32x16_bf16 v[96:111], v[132:135], v[136:139], v[96:111]
ds_read_b64_tr_b16 v[148:149], v219 offset:45056
ds_read_b64_tr_b16 v[150:151], v219 offset:46080
buffer_load_dwordx4 v215, s[8:11], s80 offen offset:3072 lds
v_mfma_f32_32x32x16_bf16 v[112:127], v[132:135], v[140:143], v[112:127]
v_mfma_f32_16x16x32_bf16 v[168:171], v[160:163], v[132:135], v[168:171]
s_mov_b32 exec_lo, 0xff
s_mov_b32 exec_hi, 0x0
buffer_load_dword v234, v232, s[20:23], s41 offen
s_mov_b64 exec, -1
s_waitcnt lgkmcnt(0)
s_waitcnt vmcnt(22)
s_barrier
v_mfma_f32_32x32x16_bf16 v[64:79], v[144:147], v[152:155], v[64:79]
ds_read_b64_tr_b16 v[128:129], v216 offset:0
ds_read_b64_tr_b16 v[130:131], v216 offset:1024
s_add_u32 m0, s81, 98304
v_mfma_f32_32x32x16_bf16 v[80:95], v[144:147], v[156:159], v[80:95]
v_mfma_f32_16x16x32_bf16 v[164:167], v[160:163], v[144:147], v[164:167]
ds_read_b128 v[136:139], v220 offset:16384
ds_read_b128 v[140:143], v220 offset:20480
s_add_u32 s79, s79, 221184
v_mfma_f32_32x32x16_bf16 v[96:111], v[148:151], v[152:155], v[96:111]
ds_read_b64_tr_b16 v[132:133], v217 offset:0
ds_read_b64_tr_b16 v[134:135], v217 offset:1024
buffer_load_dwordx4 v208, s[20:23], s79 offen offset:0 lds
v_mfma_f32_32x32x16_bf16 v[112:127], v[148:151], v[156:159], v[112:127]
v_mfma_f32_16x16x32_bf16 v[168:171], v[160:163], v[148:151], v[168:171]
buffer_load_dwordx4 v209, s[20:23], s79 offen offset:1024 lds
s_waitcnt lgkmcnt(3)
v_mfma_f32_32x32x16_bf16 v[64:79], v[128:131], v[136:139], v[64:79]
ds_read_b64_tr_b16 v[144:145], v216 offset:4096
ds_read_b64_tr_b16 v[146:147], v216 offset:5120
s_waitcnt lgkmcnt(4)
v_mfma_f32_32x32x16_bf16 v[80:95], v[128:131], v[140:143], v[80:95]
v_mfma_f32_16x16x32_bf16 v[164:167], v[160:163], v[128:131], v[164:167]
ds_read_b128 v[152:155], v221 offset:16384
ds_read_b128 v[156:159], v221 offset:20480
buffer_load_dwordx4 v210, s[20:23], s79 offen offset:2048 lds
s_waitcnt lgkmcnt(4)
v_mfma_f32_32x32x16_bf16 v[96:111], v[132:135], v[136:139], v[96:111]
ds_read_b64_tr_b16 v[148:149], v217 offset:4096
ds_read_b64_tr_b16 v[150:151], v217 offset:5120
buffer_load_dwordx4 v211, s[20:23], s79 offen offset:3072 lds
v_mfma_f32_32x32x16_bf16 v[112:127], v[132:135], v[140:143], v[112:127]
v_mfma_f32_16x16x32_bf16 v[168:171], v[160:163], v[132:135], v[168:171]
buffer_store_dwordx4 v[20:23], v205, s[24:27], s75 offen sc1
s_waitcnt lgkmcnt(3)
v_mfma_f32_32x32x16_bf16 v[64:79], v[144:147], v[152:155], v[64:79]
ds_read_b64_tr_b16 v[128:129], v216 offset:8192
ds_read_b64_tr_b16 v[130:131], v216 offset:9216
s_add_u32 m0, s81, 114688
s_waitcnt lgkmcnt(4)
v_mfma_f32_32x32x16_bf16 v[80:95], v[144:147], v[156:159], v[80:95]
v_mfma_f32_16x16x32_bf16 v[164:167], v[160:163], v[144:147], v[164:167]
ds_read_b128 v[136:139], v222 offset:16384
ds_read_b128 v[140:143], v222 offset:20480
s_add_u32 s80, s80, 128
s_waitcnt lgkmcnt(4)
v_mfma_f32_32x32x16_bf16 v[96:111], v[148:151], v[152:155], v[96:111]
ds_read_b64_tr_b16 v[132:133], v217 offset:8192
ds_read_b64_tr_b16 v[134:135], v217 offset:9216
buffer_load_dwordx4 v212, s[8:11], s80 offen offset:0 lds
v_mfma_f32_32x32x16_bf16 v[112:127], v[148:151], v[156:159], v[112:127]
v_mfma_f32_16x16x32_bf16 v[168:171], v[160:163], v[148:151], v[168:171]
buffer_load_dwordx4 v213, s[8:11], s80 offen offset:1024 lds
s_waitcnt lgkmcnt(3)
v_mfma_f32_32x32x16_bf16 v[64:79], v[128:131], v[136:139], v[64:79]
ds_read_b64_tr_b16 v[144:145], v216 offset:12288
ds_read_b64_tr_b16 v[146:147], v216 offset:13312
s_waitcnt lgkmcnt(4)
v_mfma_f32_32x32x16_bf16 v[80:95], v[128:131], v[140:143], v[80:95]
v_mfma_f32_16x16x32_bf16 v[164:167], v[160:163], v[128:131], v[164:167]
ds_read_b128 v[152:155], v223 offset:16384
ds_read_b128 v[156:159], v223 offset:20480
buffer_load_dwordx4 v214, s[8:11], s80 offen offset:2048 lds
s_waitcnt lgkmcnt(4)
v_mfma_f32_32x32x16_bf16 v[96:111], v[132:135], v[136:139], v[96:111]
ds_read_b64_tr_b16 v[148:149], v217 offset:12288
ds_read_b64_tr_b16 v[150:151], v217 offset:13312
buffer_load_dwordx4 v215, s[8:11], s80 offen offset:3072 lds
v_mfma_f32_32x32x16_bf16 v[112:127], v[132:135], v[140:143], v[112:127]
v_mfma_f32_16x16x32_bf16 v[168:171], v[160:163], v[132:135], v[168:171]
s_mov_b32 exec_lo, 0xff00
s_mov_b32 exec_hi, 0x0
buffer_load_dword v234, v232, s[20:23], s41 offen
s_mov_b64 exec, -1
s_waitcnt lgkmcnt(0)
s_waitcnt vmcnt(21)
s_cmp_lg_u32 s5, 0
s_cbranch_scc1 L_back_4
v_cmp_gt_u32 vcc, 32, v254
s_cbranch_vccnz L_slow_3
L_back_4:
s_barrier
v_mfma_f32_32x32x16_bf16 v[64:79], v[144:147], v[152:155], v[64:79]
ds_read_b64_tr_b16 v[128:129], v216 offset:32768
ds_read_b64_tr_b16 v[130:131], v216 offset:33792
s_add_u32 m0, s81, 0
v_mfma_f32_32x32x16_bf16 v[80:95], v[144:147], v[156:159], v[80:95]
v_mfma_f32_16x16x32_bf16 v[164:167], v[160:163], v[144:147], v[164:167]
ds_read_b128 v[136:139], v220 offset:49152
ds_read_b128 v[140:143], v220 offset:53248
s_add_u32 s79, s79, 221184
v_mfma_f32_32x32x16_bf16 v[96:111], v[148:151], v[152:155], v[96:111]
ds_read_b64_tr_b16 v[132:133], v217 offset:32768
ds_read_b64_tr_b16 v[134:135], v217 offset:33792
buffer_load_dwordx4 v208, s[20:23], s79 offen offset:0 lds
v_mfma_f32_32x32x16_bf16 v[112:127], v[148:151], v[156:159], v[112:127]
v_mfma_f32_16x16x32_bf16 v[168:171], v[160:163], v[148:151], v[168:171]
buffer_load_dwordx4 v209, s[20:23], s79 offen offset:1024 lds
s_waitcnt lgkmcnt(3)
v_mfma_f32_32x32x16_bf16 v[64:79], v[128:131], v[136:139], v[64:79]
ds_read_b64_tr_b16 v[144:145], v216 offset:36864
ds_read_b64_tr_b16 v[146:147], v216 offset:37888
s_waitcnt lgkmcnt(4)
v_mfma_f32_32x32x16_bf16 v[80:95], v[128:131], v[140:143], v[80:95]
v_mfma_f32_16x16x32_bf16 v[164:167], v[160:163], v[128:131], v[164:167]
ds_read_b128 v[152:155], v221 offset:49152
ds_read_b128 v[156:159], v221 offset:53248
buffer_load_dwordx4 v210, s[20:23], s79 offen offset:2048 lds
s_waitcnt lgkmcnt(4)
v_mfma_f32_32x32x16_bf16 v[96:111], v[132:135], v[136:139], v[96:111]
ds_read_b64_tr_b16 v[148:149], v217 offset:36864
ds_read_b64_tr_b16 v[150:151], v217 offset:37888
buffer_load_dwordx4 v211, s[20:23], s79 offen offset:3072 lds
v_mfma_f32_32x32x16_bf16 v[112:127], v[132:135], v[140:143], v[112:127]
v_mfma_f32_16x16x32_bf16 v[168:171], v[160:163], v[132:135], v[168:171]
buffer_store_dwordx4 v[24:27], v205, s[24:27], s76 offen sc1
s_waitcnt lgkmcnt(3)
v_mfma_f32_32x32x16_bf16 v[64:79], v[144:147], v[152:155], v[64:79]
ds_read_b64_tr_b16 v[128:129], v216 offset:40960
ds_read_b64_tr_b16 v[130:131], v216 offset:41984
s_add_u32 m0, s81, 16384
s_waitcnt lgkmcnt(4)
v_mfma_f32_32x32x16_bf16 v[80:95], v[144:147], v[156:159], v[80:95]
v_mfma_f32_16x16x32_bf16 v[164:167], v[160:163], v[144:147], v[164:167]
ds_read_b128 v[136:139], v222 offset:49152
ds_read_b128 v[140:143], v222 offset:53248
s_add_u32 s80, s80, 128
s_waitcnt lgkmcnt(4)
v_mfma_f32_32x32x16_bf16 v[96:111], v[148:151], v[152:155], v[96:111]
ds_read_b64_tr_b16 v[132:133], v217 offset:40960
ds_read_b64_tr_b16 v[134:135], v217 offset:41984
buffer_load_dwordx4 v212, s[8:11], s80 offen offset:0 lds
v_mfma_f32_32x32x16_bf16 v[112:127], v[148:151], v[156:159], v[112:127]
v_mfma_f32_16x16x32_bf16 v[168:171], v[160:163], v[148:151], v[168:171]
buffer_load_dwordx4 v213, s[8:11], s80 offen offset:1024 lds
s_waitcnt lgkmcnt(3)
v_mfma_f32_32x32x16_bf16 v[64:79], v[128:131], v[136:139], v[64:79]
ds_read_b64_tr_b16 v[144:145], v216 offset:45056
ds_read_b64_tr_b16 v[146:147], v216 offset:46080
s_waitcnt lgkmcnt(4)
v_mfma_f32_32x32x16_bf16 v[80:95], v[128:131], v[140:143], v[80:95]
v_mfma_f32_16x16x32_bf16 v[164:167], v[160:163], v[128:131], v[164:167]
ds_read_b128 v[152:155], v223 offset:49152
ds_read_b128 v[156:159], v223 offset:53248
buffer_load_dwordx4 v214, s[8:11], s80 offen offset:2048 lds
s_waitcnt lgkmcnt(4)
v_mfma_f32_32x32x16_bf16 v[96:111], v[132:135], v[136:139], v[96:111]
ds_read_b64_tr_b16 v[148:149], v217 offset:45056
ds_read_b64_tr_b16 v[150:151], v217 offset:46080
v_mfma_f32_32x32x16_bf16 v[112:127], v[132:135], v[140:143], v[112:127]
v_mfma_f32_16x16x32_bf16 v[168:171], v[160:163], v[132:135], v[168:171]
buffer_load_dwordx4 v215, s[8:11], s80 offen offset:3072 lds
s_waitcnt lgkmcnt(0)
s_waitcnt vmcnt(20)
s_barrier
buffer_load_dword v254, v231, s[24:27], 0 offen sc1
v_mfma_f32_32x32x16_bf16 v[64:79], v[144:147], v[152:155], v[64:79]
ds_read_b64_tr_b16 v[128:129], v218 offset:0
ds_read_b64_tr_b16 v[130:131], v218 offset:1024
s_add_u32 m0, s81, 32768
v_mfma_f32_32x32x16_bf16 v[80:95], v[144:147], v[156:159], v[80:95]
v_mfma_f32_16x16x32_bf16 v[164:167], v[160:163], v[144:147], v[164:167]
ds_read_b128 v[136:139], v224 offset:16384
ds_read_b128 v[140:143], v224 offset:20480
s_add_u32 s79, s79, 221184
v_mfma_f32_32x32x16_bf16 v[96:111], v[148:151], v[152:155], v[96:111]
ds_read_b64_tr_b16 v[132:133], v219 offset:0
ds_read_b64_tr_b16 v[134:135], v219 offset:1024
buffer_load_dwordx4 v208, s[20:23], s79 offen offset:0 lds
v_mfma_f32_32x32x16_bf16 v[112:127], v[148:151], v[156:159], v[112:127]
v_mfma_f32_16x16x32_bf16 v[168:171], v[160:163], v[148:151], v[168:171]
buffer_load_dwordx4 v209, s[20:23], s79 offen offset:1024 lds
s_waitcnt lgkmcnt(3)
v_mfma_f32_32x32x16_bf16 v[64:79], v[128:131], v[136:139], v[64:79]
ds_read_b64_tr_b16 v[144:145], v218 offset:4096
ds_read_b64_tr_b16 v[146:147], v218 offset:5120
s_waitcnt lgkmcnt(4)
v_mfma_f32_32x32x16_bf16 v[80:95], v[128:131], v[140:143], v[80:95]
v_mfma_f32_16x16x32_bf16 v[164:167], v[160:163], v[128:131], v[164:167]
ds_read_b128 v[152:155], v225 offset:16384
ds_read_b128 v[156:159], v225 offset:20480
buffer_load_dwordx4 v210, s[20:23], s79 offen offset:2048 lds
s_waitcnt lgkmcnt(4)
v_mfma_f32_32x32x16_bf16 v[96:111], v[132:135], v[136:139], v[96:111]
ds_read_b64_tr_b16 v[148:149], v219 offset:4096
ds_read_b64_tr_b16 v[150:151], v219 offset:5120
buffer_load_dwordx4 v211, s[20:23], s79 offen offset:3072 lds
v_mfma_f32_32x32x16_bf16 v[112:127], v[132:135], v[140:143], v[112:127]
v_mfma_f32_16x16x32_bf16 v[168:171], v[160:163], v[132:135], v[168:171]
buffer_store_dwordx4 v[28:31], v173, s[24:27], s93 offen sc1
s_waitcnt lgkmcnt(3)
v_mfma_f32_32x32x16_bf16 v[64:79], v[144:147], v[152:155], v[64:79]
ds_read_b64_tr_b16 v[128:129], v218 offset:8192
ds_read_b64_tr_b16 v[130:131], v218 offset:9216
s_add_u32 m0, s81, 49152
s_waitcnt lgkmcnt(4)
v_mfma_f32_32x32x16_bf16 v[80:95], v[144:147], v[156:159], v[80:95]
v_mfma_f32_16x16x32_bf16 v[164:167], v[160:163], v[144:147], v[164:167]
ds_read_b128 v[136:139], v226 offset:16384
ds_read_b128 v[140:143], v226 offset:20480
s_add_u32 s80, s80, 128
s_waitcnt lgkmcnt(4)
v_mfma_f32_32x32x16_bf16 v[96:111], v[148:151], v[152:155], v[96:111]
ds_read_b64_tr_b16 v[132:133], v219 offset:8192
ds_read_b64_tr_b16 v[134:135], v219 offset:9216
buffer_load_dwordx4 v212, s[8:11], s80 offen offset:0 lds
v_mfma_f32_32x32x16_bf16 v[112:127], v[148:151], v[156:159], v[112:127]
v_mfma_f32_16x16x32_bf16 v[168:171], v[160:163], v[148:151], v[168:171]
buffer_load_dwordx4 v213, s[8:11], s80 offen offset:1024 lds
s_waitcnt lgkmcnt(3)
v_mfma_f32_32x32x16_bf16 v[64:79], v[128:131], v[136:139], v[64:79]
ds_read_b64_tr_b16 v[144:145], v218 offset:12288
ds_read_b64_tr_b16 v[146:147], v218 offset:13312
s_waitcnt lgkmcnt(4)
v_mfma_f32_32x32x16_bf16 v[80:95], v[128:131], v[140:143], v[80:95]
v_mfma_f32_16x16x32_bf16 v[164:167], v[160:163], v[128:131], v[164:167]
ds_read_b128 v[152:155], v227 offset:16384
ds_read_b128 v[156:159], v227 offset:20480
buffer_load_dwordx4 v214, s[8:11], s80 offen offset:2048 lds
s_waitcnt lgkmcnt(4)
v_mfma_f32_32x32x16_bf16 v[96:111], v[132:135], v[136:139], v[96:111]
ds_read_b64_tr_b16 v[148:149], v219 offset:12288
ds_read_b64_tr_b16 v[150:151], v219 offset:13312
v_mfma_f32_32x32x16_bf16 v[112:127], v[132:135], v[140:143], v[112:127]
v_mfma_f32_16x16x32_bf16 v[168:171], v[160:163], v[132:135], v[168:171]
buffer_load_dwordx4 v215, s[8:11], s80 offen offset:3072 lds
s_waitcnt lgkmcnt(0)
s_waitcnt vmcnt(20)
s_barrier
s_lshl_b32 s6, s5, 2
v_lshlrev_b32 v202, 2, v1
v_add_u32 v202, s6, v202
v_subrev_u32 v202, 252, v202
v_add_u32 v203, s6, v248
v_add_u32 v203, 4, v203
s_mul_i32 s90, s5, 4416
v_mfma_f32_32x32x16_bf16 v[64:79], v[144:147], v[152:155], v[64:79]
ds_read_b64_tr_b16 v[128:129], v218 offset:32768
ds_read_b64_tr_b16 v[130:131], v218 offset:33792
v_mfma_f32_32x32x16_bf16 v[80:95], v[144:147], v[156:159], v[80:95]
v_mfma_f32_16x16x32_bf16 v[164:167], v[160:163], v[144:147], v[164:167]
ds_read_b128 v[136:139], v224 offset:49152
ds_read_b128 v[140:143], v224 offset:53248
v_mfma_f32_32x32x16_bf16 v[96:111], v[148:151], v[152:155], v[96:111]
ds_read_b64_tr_b16 v[132:133], v219 offset:32768
ds_read_b64_tr_b16 v[134:135], v219 offset:33792
v_mfma_f32_32x32x16_bf16 v[112:127], v[148:151], v[156:159], v[112:127]
v_mfma_f32_16x16x32_bf16 v[168:171], v[160:163], v[148:151], v[168:171]
s_waitcnt lgkmcnt(3)
v_mfma_f32_32x32x16_bf16 v[64:79], v[128:131], v[136:139], v[64:79]
ds_read_b64_tr_b16 v[144:145], v218 offset:36864
ds_read_b64_tr_b16 v[146:147], v218 offset:37888
s_waitcnt lgkmcnt(4)
v_mfma_f32_32x32x16_bf16 v[80:95], v[128:131], v[140:143], v[80:95]
v_mfma_f32_16x16x32_bf16 v[164:167], v[160:163], v[128:131], v[164:167]
ds_read_b128 v[152:155], v225 offset:49152
ds_read_b128 v[156:159], v225 offset:53248
s_waitcnt lgkmcnt(4)
v_mfma_f32_32x32x16_bf16 v[96:111], v[132:135], v[136:139], v[96:111]
ds_read_b64_tr_b16 v[148:149], v219 offset:36864
ds_read_b64_tr_b16 v[150:151], v219 offset:37888
v_mfma_f32_32x32x16_bf16 v[112:127], v[132:135], v[140:143], v[112:127]
v_mfma_f32_16x16x32_bf16 v[168:171], v[160:163], v[132:135], v[168:171]
s_waitcnt lgkmcnt(3)
v_mfma_f32_32x32x16_bf16 v[64:79], v[144:147], v[152:155], v[64:79]
ds_read_b64_tr_b16 v[128:129], v218 offset:40960
ds_read_b64_tr_b16 v[130:131], v218 offset:41984
s_waitcnt lgkmcnt(4)
v_mfma_f32_32x32x16_bf16 v[80:95], v[144:147], v[156:159], v[80:95]
v_mfma_f32_16x16x32_bf16 v[164:167], v[160:163], v[144:147], v[164:167]
ds_read_b128 v[136:139], v226 offset:49152
ds_read_b128 v[140:143], v226 offset:53248
s_waitcnt lgkmcnt(4)
v_mfma_f32_32x32x16_bf16 v[96:111], v[148:151], v[152:155], v[96:111]
ds_read_b64_tr_b16 v[132:133], v219 offset:40960
ds_read_b64_tr_b16 v[134:135], v219 offset:41984
v_mfma_f32_32x32x16_bf16 v[112:127], v[148:151], v[156:159], v[112:127]
v_mfma_f32_16x16x32_bf16 v[168:171], v[160:163], v[148:151], v[168:171]
s_waitcnt lgkmcnt(3)
v_mfma_f32_32x32x16_bf16 v[64:79], v[128:131], v[136:139], v[64:79]
ds_read_b64_tr_b16 v[144:145], v218 offset:45056
ds_read_b64_tr_b16 v[146:147], v218 offset:46080
s_waitcnt lgkmcnt(4)
v_mfma_f32_32x32x16_bf16 v[80:95], v[128:131], v[140:143], v[80:95]
v_mfma_f32_16x16x32_bf16 v[164:167], v[160:163], v[128:131], v[164:167]
ds_read_b128 v[152:155], v227 offset:49152
ds_read_b128 v[156:159], v227 offset:53248
s_waitcnt lgkmcnt(4)
v_mfma_f32_32x32x16_bf16 v[96:111], v[132:135], v[136:139], v[96:111]
ds_read_b64_tr_b16 v[148:149], v219 offset:45056
ds_read_b64_tr_b16 v[150:151], v219 offset:46080
v_mfma_f32_32x32x16_bf16 v[112:127], v[132:135], v[140:143], v[112:127]
v_mfma_f32_16x16x32_bf16 v[168:171], v[160:163], v[132:135], v[168:171]
s_waitcnt lgkmcnt(0)
s_waitcnt vmcnt(10)
s_waitcnt vmcnt(4)
s_cmp_lg_u32 s5, 0
s_cbranch_scc1 L_back_6
v_cmp_eq_u32 vcc, 0, v254
s_cbranch_vccnz L_slow_5
L_back_6:
s_barrier
s_cmp_lg_u32 s5, 0
s_cbranch_scc1 L_fl_7
s_mov_b64 exec, 1
buffer_store_dword v253, v252, s[24:27], 0 offen offset:0 sc1
s_mov_b64 exec, -1
L_fl_7:
s_mov_b32 s36, s56
s_and_b32 s37, s57, 0xffff
s_mov_b32 s38, 3456
s_mov_b32 s39, 0x20000
v_and_b32 v2, 31, v1
s_lshl_b32 s6, s78, 7
s_lshl_b32 s7, s82, 6
s_add_u32 s6, s6, s7
v_add_u32 v3, s6, v2
v_lshlrev_b32 v3, 1, v3
s_cmp_ge_u32 s6, 1728
s_cselect_b32 s101, 0, 32
s_lshl_b32 s6, s77, 7
s_lshl_b32 s7, s83, 6
s_add_u32 s6, s6, s7
v_add_u32 v4, s6, v2
v_lshlrev_b32 v4, 4, v4
v_mov_b32 v5, 2147418112
v_cmp_gt_u32 vcc, 32, v1
v_cndmask_b32 v3, v5, v3, vcc
v_cndmask_b32 v5, v5, v4, vcc
s_mov_b32 s7, 65536
s_mov_b32 s84, 98304
buffer_load_ushort v28, v3, s[36:39], 0 offen
buffer_load_ushort v32, v3, s[36:39], 0 offen offset:64
buffer_load_dwordx4 v[36:39], v5, s[24:27], s7 offen
buffer_load_dwordx4 v[40:43], v5, s[24:27], s7 offen offset:512
buffer_load_dwordx4 v[44:47], v4, s[24:27], s84 offen
buffer_load_dwordx4 v[48:51], v4, s[24:27], s84 offen offset:512
v_mfma_f32_32x32x16_bf16 v[64:79], v[144:147], v[152:155], v[64:79]
ds_read_b64_tr_b16 v[128:129], v216 offset:0
ds_read_b64_tr_b16 v[130:131], v216 offset:1024
v_mfma_f32_32x32x16_bf16 v[80:95], v[144:147], v[156:159], v[80:95]
v_mfma_f32_16x16x32_bf16 v[164:167], v[160:163], v[144:147], v[164:167]
ds_read_b128 v[136:139], v220 offset:16384
ds_read_b128 v[140:143], v220 offset:20480
v_mfma_f32_32x32x16_bf16 v[96:111], v[148:151], v[152:155], v[96:111]
ds_read_b64_tr_b16 v[132:133], v217 offset:0
ds_read_b64_tr_b16 v[134:135], v217 offset:1024
v_mfma_f32_32x32x16_bf16 v[112:127], v[148:151], v[156:159], v[112:127]
v_mfma_f32_16x16x32_bf16 v[168:171], v[160:163], v[148:151], v[168:171]
s_waitcnt lgkmcnt(3)
v_mfma_f32_32x32x16_bf16 v[64:79], v[128:131], v[136:139], v[64:79]
ds_read_b64_tr_b16 v[144:145], v216 offset:4096
ds_read_b64_tr_b16 v[146:147], v216 offset:5120
s_add_u32 s6, s88, 0
s_lshl_b32 s6, s6, 12
s_add_u32 s32, s48, s6
s_addc_u32 s33, s49, 0
s_waitcnt lgkmcnt(4)
v_mfma_f32_32x32x16_bf16 v[80:95], v[128:131], v[140:143], v[80:95]
v_mfma_f32_16x16x32_bf16 v[164:167], v[160:163], v[128:131], v[164:167]
ds_read_b128 v[152:155], v221 offset:16384
ds_read_b128 v[156:159], v221 offset:20480
s_and_b32 s33, s33, 0xffff
s_mov_b32 s34, 4096
s_mov_b32 s35, 0x20000
s_add_u32 m0, s90, 65536
s_waitcnt lgkmcnt(4)
v_mfma_f32_32x32x16_bf16 v[96:111], v[132:135], v[136:139], v[96:111]
ds_read_b64_tr_b16 v[148:149], v217 offset:4096
ds_read_b64_tr_b16 v[150:151], v217 offset:5120
s_nop 0
buffer_load_dword v202, s[32:35], 0 offen lds
s_add_u32 m0, s90, 65792
s_nop 0
v_mfma_f32_32x32x16_bf16 v[112:127], v[132:135], v[140:143], v[112:127]
v_mfma_f32_16x16x32_bf16 v[168:171], v[160:163], v[132:135], v[168:171]
buffer_load_dwordx4 v203, s[32:35], 0 offen offset:0 lds
buffer_load_dwordx4 v203, s[32:35], 0 offen offset:1024 lds
buffer_load_dwordx4 v203, s[32:35], 0 offen offset:2048 lds
buffer_load_dwordx4 v203, s[32:35], 0 offen offset:3072 lds
s_waitcnt lgkmcnt(3)
v_mfma_f32_32x32x16_bf16 v[64:79], v[144:147], v[152:155], v[64:79]
ds_read_b64_tr_b16 v[128:129], v216 offset:8192
ds_read_b64_tr_b16 v[130:131], v216 offset:9216
s_waitcnt lgkmcnt(4)
v_mfma_f32_32x32x16_bf16 v[80:95], v[144:147], v[156:159], v[80:95]
v_mfma_f32_16x16x32_bf16 v[164:167], v[160:163], v[144:147], v[164:167]
ds_read_b128 v[136:139], v222 offset:16384
ds_read_b128 v[140:143], v222 offset:20480
s_waitcnt lgkmcnt(4)
v_mfma_f32_32x32x16_bf16 v[96:111], v[148:151], v[152:155], v[96:111]
ds_read_b64_tr_b16 v[132:133], v217 offset:8192
ds_read_b64_tr_b16 v[134:135], v217 offset:9216
v_mfma_f32_32x32x16_bf16 v[112:127], v[148:151], v[156:159], v[112:127]
v_mfma_f32_16x16x32_bf16 v[168:171], v[160:163], v[148:151], v[168:171]
s_waitcnt lgkmcnt(3)
v_mfma_f32_32x32x16_bf16 v[64:79], v[128:131], v[136:139], v[64:79]
ds_read_b64_tr_b16 v[144:145], v216 offset:12288
ds_read_b64_tr_b16 v[146:147], v216 offset:13312
s_add_u32 s6, s88, 1
s_lshl_b32 s6, s6, 12
s_add_u32 s32, s48, s6
s_addc_u32 s33, s49, 0
s_waitcnt lgkmcnt(4)
v_mfma_f32_32x32x16_bf16 v[80:95], v[128:131], v[140:143], v[80:95]
v_mfma_f32_16x16x32_bf16 v[164:167], v[160:163], v[128:131], v[164:167]
ds_read_b128 v[152:155], v223 offset:16384
ds_read_b128 v[156:159], v223 offset:20480
s_and_b32 s33, s33, 0xffff
s_mov_b32 s34, 4096
s_mov_b32 s35, 0x20000
s_add_u32 m0, s90, 95744
s_waitcnt lgkmcnt(4)
v_mfma_f32_32x32x16_bf16 v[96:111], v[132:135], v[136:139], v[96:111]
ds_read_b64_tr_b16 v[148:149], v217 offset:12288
ds_read_b64_tr_b16 v[150:151], v217 offset:13312
s_nop 0
buffer_load_dword v202, s[32:35], 0 offen lds
s_add_u32 m0, s90, 96000
s_nop 0
v_mfma_f32_32x32x16_bf16 v[112:127], v[132:135], v[140:143], v[112:127]
v_mfma_f32_16x16x32_bf16 v[168:171], v[160:163], v[132:135], v[168:171]
buffer_load_dwordx4 v203, s[32:35], 0 offen offset:0 lds
buffer_load_dwordx4 v203, s[32:35], 0 offen offset:1024 lds
buffer_load_dwordx4 v203, s[32:35], 0 offen offset:2048 lds
buffer_load_dwordx4 v203, s[32:35], 0 offen offset:3072 lds
s_waitcnt lgkmcnt(0)
s_waitcnt vmcnt(16)
s_barrier
s_mul_i32 s6, s95, 54
s_add_u32 s6, s6, s96
s_mul_i32 s97, s6, 5120
s_add_u32 s97, s97, 7340032
s_add_u32 s98, s97, 4096
buffer_load_dword v254, v228, s[24:27], 0 offen sc1
buffer_load_dword v251, v229, s[24:27], 0 offen sc1
v_mfma_f32_32x32x16_bf16 v[64:79], v[144:147], v[152:155], v[64:79]
ds_read_b64_tr_b16 v[128:129], v216 offset:32768
ds_read_b64_tr_b16 v[130:131], v216 offset:33792
v_mfma_f32_32x32x16_bf16 v[80:95], v[144:147], v[156:159], v[80:95]
v_mfma_f32_16x16x32_bf16 v[164:167], v[160:163], v[144:147], v[164:167]
ds_read_b128 v[136:139], v220 offset:49152
ds_read_b128 v[140:143], v220 offset:53248
v_mfma_f32_32x32x16_bf16 v[96:111], v[148:151], v[152:155], v[96:111]
ds_read_b64_tr_b16 v[132:133], v217 offset:32768
ds_read_b64_tr_b16 v[134:135], v217 offset:33792
v_mfma_f32_32x32x16_bf16 v[112:127], v[148:151], v[156:159], v[112:127]
v_mfma_f32_16x16x32_bf16 v[168:171], v[160:163], v[148:151], v[168:171]
s_waitcnt lgkmcnt(3)
v_mfma_f32_32x32x16_bf16 v[64:79], v[128:131], v[136:139], v[64:79]
ds_read_b64_tr_b16 v[144:145], v216 offset:36864
ds_read_b64_tr_b16 v[146:147], v216 offset:37888
s_add_u32 s6, s88, 2
s_lshl_b32 s6, s6, 12
s_add_u32 s32, s48, s6
s_addc_u32 s33, s49, 0
s_waitcnt lgkmcnt(4)
v_mfma_f32_32x32x16_bf16 v[80:95], v[128:131], v[140:143], v[80:95]
v_mfma_f32_16x16x32_bf16 v[164:167], v[160:163], v[128:131], v[164:167]
ds_read_b128 v[152:155], v221 offset:49152
ds_read_b128 v[156:159], v221 offset:53248
s_and_b32 s33, s33, 0xffff
s_mov_b32 s34, 4096
s_mov_b32 s35, 0x20000
s_add_u32 m0, s90, 125952
s_waitcnt lgkmcnt(4)
v_mfma_f32_32x32x16_bf16 v[96:111], v[132:135], v[136:139], v[96:111]
ds_read_b64_tr_b16 v[148:149], v217 offset:36864
ds_read_b64_tr_b16 v[150:151], v217 offset:37888
s_nop 0
buffer_load_dword v202, s[32:35], 0 offen lds
s_add_u32 m0, s90, 126208
s_nop 0
v_mfma_f32_32x32x16_bf16 v[112:127], v[132:135], v[140:143], v[112:127]
v_mfma_f32_16x16x32_bf16 v[168:171], v[160:163], v[132:135], v[168:171]
buffer_load_dwordx4 v203, s[32:35], 0 offen offset:0 lds
buffer_load_dwordx4 v203, s[32:35], 0 offen offset:1024 lds
buffer_load_dwordx4 v203, s[32:35], 0 offen offset:2048 lds
buffer_load_dwordx4 v203, s[32:35], 0 offen offset:3072 lds
s_waitcnt lgkmcnt(3)
v_mfma_f32_32x32x16_bf16 v[64:79], v[144:147], v[152:155], v[64:79]
ds_read_b64_tr_b16 v[128:129], v216 offset:40960
ds_read_b64_tr_b16 v[130:131], v216 offset:41984
s_waitcnt lgkmcnt(4)
v_mfma_f32_32x32x16_bf16 v[80:95], v[144:147], v[156:159], v[80:95]
v_mfma_f32_16x16x32_bf16 v[164:167], v[160:163], v[144:147], v[164:167]
ds_read_b128 v[136:139], v222 offset:49152
ds_read_b128 v[140:143], v222 offset:53248
s_waitcnt lgkmcnt(4)
v_mfma_f32_32x32x16_bf16 v[96:111], v[148:151], v[152:155], v[96:111]
ds_read_b64_tr_b16 v[132:133], v217 offset:40960
ds_read_b64_tr_b16 v[134:135], v217 offset:41984
v_mfma_f32_32x32x16_bf16 v[112:127], v[148:151], v[156:159], v[112:127]
v_mfma_f32_16x16x32_bf16 v[168:171], v[160:163], v[148:151], v[168:171]
s_waitcnt lgkmcnt(3)
v_mfma_f32_32x32x16_bf16 v[64:79], v[128:131], v[136:139], v[64:79]
ds_read_b64_tr_b16 v[144:145], v216 offset:45056
ds_read_b64_tr_b16 v[146:147], v216 offset:46080
s_waitcnt lgkmcnt(4)
v_mfma_f32_32x32x16_bf16 v[80:95], v[128:131], v[140:143], v[80:95]
v_mfma_f32_16x16x32_bf16 v[164:167], v[160:163], v[128:131], v[164:167]
ds_read_b128 v[152:155], v223 offset:49152
ds_read_b128 v[156:159], v223 offset:53248
s_waitcnt lgkmcnt(4)
v_mfma_f32_32x32x16_bf16 v[96:111], v[132:135], v[136:139], v[96:111]
ds_read_b64_tr_b16 v[148:149], v217 offset:45056
ds_read_b64_tr_b16 v[150:151], v217 offset:46080
v_mfma_f32_32x32x16_bf16 v[112:127], v[132:135], v[140:143], v[112:127]
v_mfma_f32_16x16x32_bf16 v[168:171], v[160:163], v[132:135], v[168:171]
s_waitcnt lgkmcnt(3)
v_mfma_f32_32x32x16_bf16 v[64:79], v[144:147], v[152:155], v[64:79]
s_waitcnt lgkmcnt(2)
v_mfma_f32_32x32x16_bf16 v[80:95], v[144:147], v[156:159], v[80:95]
v_mfma_f32_16x16x32_bf16 v[164:167], v[160:163], v[144:147], v[164:167]
s_waitcnt lgkmcnt(0)
v_mfma_f32_32x32x16_bf16 v[96:111], v[148:151], v[152:155], v[96:111]
v_mfma_f32_32x32x16_bf16 v[112:127], v[148:151], v[156:159], v[112:127]
v_mfma_f32_16x16x32_bf16 v[168:171], v[160:163], v[148:151], v[168:171]
s_waitcnt vmcnt(17)
s_nop 7
v_lshl_or_b32 v28, v28, 16, v28
v_cvt_pk_bf16_f32 v29, v164, v164
v_lshlrev_b32 v2, 16, v29
v_sub_f32 v2, v164, v2
v_cvt_pk_bf16_f32 v30, v2, v2
v_mov_b32 v31, 0
v_lshl_or_b32 v32, v32, 16, v32
v_cvt_pk_bf16_f32 v33, v168, v168
v_lshlrev_b32 v2, 16, v33
v_sub_f32 v2, v168, v2
v_cvt_pk_bf16_f32 v34, v2, v2
v_mov_b32 v35, 0
s_nop 1
v_mfma_f32_32x32x16_bf16 v[64:79], v[28:31], v[36:39], v[64:79]
v_mfma_f32_32x32x16_bf16 v[80:95], v[28:31], v[40:43], v[80:95]
v_mfma_f32_32x32x16_bf16 v[96:111], v[32:35], v[36:39], v[96:111]
v_mfma_f32_32x32x16_bf16 v[112:127], v[32:35], v[40:43], v[112:127]
v_mul_f32 v52, -2.302208198144325, v45
v_mul_f32 v2, v45, v45
v_mul_f32 v2, v2, v45
v_mul_f32 v53, -0.1029432395800235, v2
v_mov_b32 v54, v46
v_mov_b32 v55, v46
v_mul_f32 v56, -2.302208198144325, v49
v_mul_f32 v2, v49, v49
v_mul_f32 v2, v2, v49
v_mul_f32 v57, -0.1029432395800235, v2
v_mov_b32 v58, v50
v_mov_b32 v59, v50
v_and_b32 v2, 15, v1
v_lshrrev_b32 v3, 3, v2
v_lshlrev_b32 v3, 3, v3
v_and_b32 v4, 1, v2
v_lshl_or_b32 v3, v4, 2, v3
v_bfe_u32 v4, v2, 1, 2
v_or_b32 v3, v3, v4
v_lshlrev_b32 v3, 4, v3
v_bfe_u32 v4, v1, 4, 1
v_lshl_or_b32 v3, v4, 10, v3
v_lshrrev_b32 v4, 5, v1
v_lshl_or_b32 v3, v4, 8, v3
v_mov_b32 v4, 2147418112
s_cmp_eq_u32 s101, 0
s_cselect_b64 vcc, -1, 0
v_cndmask_b32 v60, v3, v4, vcc
s_lshl_b32 s6, s77, 1
s_add_u32 s6, s6, s83
s_mul_i32 s6, s6, 54
s_lshl_b32 s7, s78, 2
s_add_u32 s6, s6, s7
s_lshl_b32 s7, s82, 1
s_add_u32 s6, s6, s7
s_lshl_b32 s6, s6, 12
s_add_u32 s100, s6, 10485760
s_add_u32 s101, s100, 4096
v_pk_mul_f32 v[160:161], v[64:65], v[64:65]
v_pk_mul_f32 v[162:163], v[66:67], v[66:67]
v_pk_mul_f32 v[164:165], v[68:69], v[68:69]
v_pk_mul_f32 v[166:167], v[70:71], v[70:71]
v_pk_fma_f32 v[160:161], v[160:161], v[52:53], v[52:53] op_sel:[0,1,0] op_sel_hi:[1,1,0]
v_pk_fma_f32 v[162:163], v[162:163], v[52:53], v[52:53] op_sel:[0,1,0] op_sel_hi:[1,1,0]
v_pk_fma_f32 v[164:165], v[164:165], v[52:53], v[52:53] op_sel:[0,1,0] op_sel_hi:[1,1,0]
v_pk_fma_f32 v[166:167], v[166:167], v[52:53], v[52:53] op_sel:[0,1,0] op_sel_hi:[1,1,0]
v_pk_mul_f32 v[160:161], v[160:161], v[64:65]
v_pk_mul_f32 v[162:163], v[162:163], v[66:67]
v_pk_mul_f32 v[164:165], v[164:165], v[68:69]
v_pk_mul_f32 v[166:167], v[166:167], v[70:71]
v_exp_f32 v160, v160
v_exp_f32 v161, v161
v_exp_f32 v162, v162
v_exp_f32 v163, v163
v_exp_f32 v164, v164
v_exp_f32 v165, v165
v_exp_f32 v166, v166
v_exp_f32 v167, v167
v_pk_fma_f32 v[160:161], v[160:161], v[54:55], v[54:55]
v_pk_fma_f32 v[162:163], v[162:163], v[54:55], v[54:55]
v_pk_fma_f32 v[164:165], v[164:165], v[54:55], v[54:55]
v_pk_fma_f32 v[166:167], v[166:167], v[54:55], v[54:55]
v_rcp_f32 v160, v160
v_rcp_f32 v161, v161
v_rcp_f32 v162, v162
v_rcp_f32 v163, v163
v_rcp_f32 v164, v164
v_rcp_f32 v165, v165
v_rcp_f32 v166, v166
v_rcp_f32 v167, v167
v_pk_mul_f32 v[160:161], v[160:161], v[64:65]
v_pk_mul_f32 v[162:163], v[162:163], v[66:67]
v_pk_mul_f32 v[164:165], v[164:165], v[68:69]
v_pk_mul_f32 v[166:167], v[166:167], v[70:71]
v_cvt_pk_bf16_f32 v64, v160, v161
v_cvt_pk_bf16_f32 v65, v162, v163
v_cvt_pk_bf16_f32 v66, v164, v165
v_cvt_pk_bf16_f32 v67, v166, v167
buffer_store_dwordx4 v[64:67], v60, s[24:27], s100 offen offset:0 sc1
s_waitcnt vmcnt(7)
s_cmp_lg_u32 s5, 0
s_cbranch_scc1 L_back_9
v_cmp_eq_u32 vcc, 0, v254
s_cbranch_vccnz L_slow_8
L_back_9:
s_waitcnt vmcnt(6)
s_cmp_lg_u32 s5, 0
s_cbranch_scc1 L_back_11
v_cmp_eq_u32 vcc, 0, v251
s_cbranch_vccnz L_slow_10
L_back_11:
s_barrier
v_lshlrev_b32 v4, 4, v0
s_add_u32 s6, s88, 0
s_lshl_b32 s6, s6, 12
s_add_u32 s6, s6, 1048576
s_add_u32 s36, s66, s6
s_addc_u32 s37, s67, 0
s_and_b32 s37, s37, 0xffff
s_mov_b32 s38, 4096
s_mov_b32 s39, 0x20000
buffer_load_dwordx4 v[32:35], v4, s[36:39], 0 offen
buffer_load_dword v36, v4, s[36:39], 0 offen offset:16
s_add_u32 s6, s88, 1
s_lshl_b32 s6, s6, 12
s_add_u32 s6, s6, 1048576
s_add_u32 s36, s66, s6
s_addc_u32 s37, s67, 0
s_and_b32 s37, s37, 0xffff
s_mov_b32 s38, 4096
s_mov_b32 s39, 0x20000
buffer_load_dwordx4 v[38:41], v4, s[36:39], 0 offen
buffer_load_dword v42, v4, s[36:39], 0 offen offset:16
s_add_u32 s6, s88, 2
s_lshl_b32 s6, s6, 12
s_add_u32 s6, s6, 1048576
s_add_u32 s36, s66, s6
s_addc_u32 s37, s67, 0
s_and_b32 s37, s37, 0xffff
s_mov_b32 s38, 4096
s_mov_b32 s39, 0x20000
buffer_load_dwordx4 v[44:47], v4, s[36:39], 0 offen
buffer_load_dword v48, v4, s[36:39], 0 offen offset:16
v_pk_mul_f32 v[160:161], v[72:73], v[72:73]
v_pk_mul_f32 v[162:163], v[74:75], v[74:75]
v_pk_mul_f32 v[164:165], v[76:77], v[76:77]
v_pk_mul_f32 v[166:167], v[78:79], v[78:79]
v_pk_fma_f32 v[160:161], v[160:161], v[52:53], v[52:53] op_sel:[0,1,0] op_sel_hi:[1,1,0]
v_pk_fma_f32 v[162:163], v[162:163], v[52:53], v[52:53] op_sel:[0,1,0] op_sel_hi:[1,1,0]
v_pk_fma_f32 v[164:165], v[164:165], v[52:53], v[52:53] op_sel:[0,1,0] op_sel_hi:[1,1,0]
v_pk_fma_f32 v[166:167], v[166:167], v[52:53], v[52:53] op_sel:[0,1,0] op_sel_hi:[1,1,0]
v_pk_mul_f32 v[160:161], v[160:161], v[72:73]
v_pk_mul_f32 v[162:163], v[162:163], v[74:75]
v_pk_mul_f32 v[164:165], v[164:165], v[76:77]
v_pk_mul_f32 v[166:167], v[166:167], v[78:79]
v_exp_f32 v160, v160
v_exp_f32 v161, v161
v_exp_f32 v162, v162
v_exp_f32 v163, v163
v_exp_f32 v164, v164
v_exp_f32 v165, v165
v_exp_f32 v166, v166
v_exp_f32 v167, v167
v_pk_fma_f32 v[160:161], v[160:161], v[54:55], v[54:55]
v_pk_fma_f32 v[162:163], v[162:163], v[54:55], v[54:55]
v_pk_fma_f32 v[164:165], v[164:165], v[54:55], v[54:55]
v_pk_fma_f32 v[166:167], v[166:167], v[54:55], v[54:55]
v_rcp_f32 v160, v160
v_rcp_f32 v161, v161
v_rcp_f32 v162, v162
v_rcp_f32 v163, v163
v_rcp_f32 v164, v164
v_rcp_f32 v165, v165
v_rcp_f32 v166, v166
v_rcp_f32 v167, v167
v_pk_mul_f32 v[160:161], v[160:161], v[72:73]
v_pk_mul_f32 v[162:163], v[162:163], v[74:75]
v_pk_mul_f32 v[164:165], v[164:165], v[76:77]
v_pk_mul_f32 v[166:167], v[166:167], v[78:79]
v_cvt_pk_bf16_f32 v72, v160, v161
v_cvt_pk_bf16_f32 v73, v162, v163
v_cvt_pk_bf16_f32 v74, v164, v165
v_cvt_pk_bf16_f32 v75, v166, v167
buffer_load_dwordx4 a[0:3], v248, s[24:27], s97 offen offset:0
buffer_load_dwordx4 a[4:7], v248, s[24:27], s97 offen offset:1024
buffer_load_dwordx4 a[8:11], v248, s[24:27], s97 offen offset:2048
buffer_load_dwordx4 a[12:15], v248, s[24:27], s97 offen offset:3072
v_pk_mul_f32 v[160:161], v[80:81], v[80:81]
v_pk_mul_f32 v[162:163], v[82:83], v[82:83]
v_pk_mul_f32 v[164:165], v[84:85], v[84:85]
v_pk_mul_f32 v[166:167], v[86:87], v[86:87]
v_pk_fma_f32 v[160:161], v[160:161], v[56:57], v[56:57] op_sel:[0,1,0] op_sel_hi:[1,1,0]
v_pk_fma_f32 v[162:163], v[162:163], v[56:57], v[56:57] op_sel:[0,1,0] op_sel_hi:[1,1,0]
v_pk_fma_f32 v[164:165], v[164:165], v[56:57], v[56:57] op_sel:[0,1,0] op_sel_hi:[1,1,0]
v_pk_fma_f32 v[166:167], v[166:167], v[56:57], v[56:57] op_sel:[0,1,0] op_sel_hi:[1,1,0]
v_pk_mul_f32 v[160:161], v[160:161], v[80:81]
v_pk_mul_f32 v[162:163], v[162:163], v[82:83]
v_pk_mul_f32 v[164:165], v[164:165], v[84:85]
v_pk_mul_f32 v[166:167], v[166:167], v[86:87]
v_exp_f32 v160, v160
v_exp_f32 v161, v161
v_exp_f32 v162, v162
v_exp_f32 v163, v163
v_exp_f32 v164, v164
v_exp_f32 v165, v165
v_exp_f32 v166, v166
v_exp_f32 v167, v167
v_pk_fma_f32 v[160:161], v[160:161], v[58:59], v[58:59]
v_pk_fma_f32 v[162:163], v[162:163], v[58:59], v[58:59]
v_pk_fma_f32 v[164:165], v[164:165], v[58:59], v[58:59]
v_pk_fma_f32 v[166:167], v[166:167], v[58:59], v[58:59]
v_rcp_f32 v160, v160
v_rcp_f32 v161, v161
v_rcp_f32 v162, v162
v_rcp_f32 v163, v163
v_rcp_f32 v164, v164
v_rcp_f32 v165, v165
v_rcp_f32 v166, v166
v_rcp_f32 v167, v167
v_pk_mul_f32 v[160:161], v[160:161], v[80:81]
v_pk_mul_f32 v[162:163], v[162:163], v[82:83]
v_pk_mul_f32 v[164:165], v[164:165], v[84:85]
v_pk_mul_f32 v[166:167], v[166:167], v[86:87]
v_cvt_pk_bf16_f32 v80, v160, v161
v_cvt_pk_bf16_f32 v81, v162, v163
v_cvt_pk_bf16_f32 v82, v164, v165
v_cvt_pk_bf16_f32 v83, v166, v167
buffer_store_dwordx4 v[72:75], v60, s[24:27], s100 offen offset:512 sc1
buffer_load_dwordx4 a[16:19], v248, s[24:27], s98 offen
s_add_u32 s97, s97, 5120
s_add_u32 s98, s98, 5120
buffer_load_dwordx4 a[20:23], v248, s[24:27], s97 offen offset:0
buffer_load_dwordx4 a[24:27], v248, s[24:27], s97 offen offset:1024
buffer_load_dwordx4 a[28:31], v248, s[24:27], s97 offen offset:2048
v_pk_mul_f32 v[160:161], v[88:89], v[88:89]
v_pk_mul_f32 v[162:163], v[90:91], v[90:91]
v_pk_mul_f32 v[164:165], v[92:93], v[92:93]
v_pk_mul_f32 v[166:167], v[94:95], v[94:95]
v_pk_fma_f32 v[160:161], v[160:161], v[56:57], v[56:57] op_sel:[0,1,0] op_sel_hi:[1,1,0]
v_pk_fma_f32 v[162:163], v[162:163], v[56:57], v[56:57] op_sel:[0,1,0] op_sel_hi:[1,1,0]
v_pk_fma_f32 v[164:165], v[164:165], v[56:57], v[56:57] op_sel:[0,1,0] op_sel_hi:[1,1,0]
v_pk_fma_f32 v[166:167], v[166:167], v[56:57], v[56:57] op_sel:[0,1,0] op_sel_hi:[1,1,0]
v_pk_mul_f32 v[160:161], v[160:161], v[88:89]
v_pk_mul_f32 v[162:163], v[162:163], v[90:91]
v_pk_mul_f32 v[164:165], v[164:165], v[92:93]
v_pk_mul_f32 v[166:167], v[166:167], v[94:95]
v_exp_f32 v160, v160
v_exp_f32 v161, v161
v_exp_f32 v162, v162
v_exp_f32 v163, v163
v_exp_f32 v164, v164
v_exp_f32 v165, v165
v_exp_f32 v166, v166
v_exp_f32 v167, v167
v_pk_fma_f32 v[160:161], v[160:161], v[58:59], v[58:59]
v_pk_fma_f32 v[162:163], v[162:163], v[58:59], v[58:59]
v_pk_fma_f32 v[164:165], v[164:165], v[58:59], v[58:59]
v_pk_fma_f32 v[166:167], v[166:167], v[58:59], v[58:59]
v_rcp_f32 v160, v160
v_rcp_f32 v161, v161
v_rcp_f32 v162, v162
v_rcp_f32 v163, v163
v_rcp_f32 v164, v164
v_rcp_f32 v165, v165
v_rcp_f32 v166, v166
v_rcp_f32 v167, v167
v_pk_mul_f32 v[160:161], v[160:161], v[88:89]
v_pk_mul_f32 v[162:163], v[162:163], v[90:91]
v_pk_mul_f32 v[164:165], v[164:165], v[92:93]
v_pk_mul_f32 v[166:167], v[166:167], v[94:95]
v_cvt_pk_bf16_f32 v88, v160, v161
v_cvt_pk_bf16_f32 v89, v162, v163
v_cvt_pk_bf16_f32 v90, v164, v165
v_cvt_pk_bf16_f32 v91, v166, v167
buffer_store_dwordx4 v[80:83], v60, s[24:27], s100 offen offset:2048 sc1
buffer_load_dwordx4 a[32:35], v248, s[24:27], s97 offen offset:3072
buffer_load_dwordx4 a[36:39], v248, s[24:27], s98 offen
s_add_u32 s97, s97, 5120
s_add_u32 s98, s98, 5120
buffer_load_dwordx4 a[40:43], v248, s[24:27], s97 offen offset:0
buffer_load_dwordx4 a[44:47], v248, s[24:27], s97 offen offset:1024
v_pk_mul_f32 v[160:161], v[96:97], v[96:97]
v_pk_mul_f32 v[162:163], v[98:99], v[98:99]
v_pk_mul_f32 v[164:165], v[100:101], v[100:101]
v_pk_mul_f32 v[166:167], v[102:103], v[102:103]
v_pk_fma_f32 v[160:161], v[160:161], v[52:53], v[52:53] op_sel:[0,1,0] op_sel_hi:[1,1,0]
v_pk_fma_f32 v[162:163], v[162:163], v[52:53], v[52:53] op_sel:[0,1,0] op_sel_hi:[1,1,0]
v_pk_fma_f32 v[164:165], v[164:165], v[52:53], v[52:53] op_sel:[0,1,0] op_sel_hi:[1,1,0]
v_pk_fma_f32 v[166:167], v[166:167], v[52:53], v[52:53] op_sel:[0,1,0] op_sel_hi:[1,1,0]
v_pk_mul_f32 v[160:161], v[160:161], v[96:97]
v_pk_mul_f32 v[162:163], v[162:163], v[98:99]
v_pk_mul_f32 v[164:165], v[164:165], v[100:101]
v_pk_mul_f32 v[166:167], v[166:167], v[102:103]
v_exp_f32 v160, v160
v_exp_f32 v161, v161
v_exp_f32 v162, v162
v_exp_f32 v163, v163
v_exp_f32 v164, v164
v_exp_f32 v165, v165
v_exp_f32 v166, v166
v_exp_f32 v167, v167
v_pk_fma_f32 v[160:161], v[160:161], v[54:55], v[54:55]
v_pk_fma_f32 v[162:163], v[162:163], v[54:55], v[54:55]
v_pk_fma_f32 v[164:165], v[164:165], v[54:55], v[54:55]
v_pk_fma_f32 v[166:167], v[166:167], v[54:55], v[54:55]
v_rcp_f32 v160, v160
v_rcp_f32 v161, v161
v_rcp_f32 v162, v162
v_rcp_f32 v163, v163
v_rcp_f32 v164, v164
v_rcp_f32 v165, v165
v_rcp_f32 v166, v166
v_rcp_f32 v167, v167
v_pk_mul_f32 v[160:161], v[160:161], v[96:97]
v_pk_mul_f32 v[162:163], v[162:163], v[98:99]
v_pk_mul_f32 v[164:165], v[164:165], v[100:101]
v_pk_mul_f32 v[166:167], v[166:167], v[102:103]
v_cvt_pk_bf16_f32 v96, v160, v161
v_cvt_pk_bf16_f32 v97, v162, v163
v_cvt_pk_bf16_f32 v98, v164, v165
v_cvt_pk_bf16_f32 v99, v166, v167
buffer_load_dwordx4 a[48:51], v248, s[24:27], s97 offen offset:2048
buffer_load_dwordx4 a[52:55], v248, s[24:27], s97 offen offset:3072
buffer_load_dwordx4 a[56:59], v248, s[24:27], s98 offen
s_add_u32 s97, s97, 5120
s_add_u32 s98, s98, 5120
buffer_load_dwordx4 a[60:63], v248, s[24:27], s97 offen offset:0
v_pk_mul_f32 v[160:161], v[104:105], v[104:105]
v_pk_mul_f32 v[162:163], v[106:107], v[106:107]
v_pk_mul_f32 v[164:165], v[108:109], v[108:109]
v_pk_mul_f32 v[166:167], v[110:111], v[110:111]
v_pk_fma_f32 v[160:161], v[160:161], v[52:53], v[52:53] op_sel:[0,1,0] op_sel_hi:[1,1,0]
v_pk_fma_f32 v[162:163], v[162:163], v[52:53], v[52:53] op_sel:[0,1,0] op_sel_hi:[1,1,0]
v_pk_fma_f32 v[164:165], v[164:165], v[52:53], v[52:53] op_sel:[0,1,0] op_sel_hi:[1,1,0]
v_pk_fma_f32 v[166:167], v[166:167], v[52:53], v[52:53] op_sel:[0,1,0] op_sel_hi:[1,1,0]
v_pk_mul_f32 v[160:161], v[160:161], v[104:105]
v_pk_mul_f32 v[162:163], v[162:163], v[106:107]
v_pk_mul_f32 v[164:165], v[164:165], v[108:109]
v_pk_mul_f32 v[166:167], v[166:167], v[110:111]
v_exp_f32 v160, v160
v_exp_f32 v161, v161
v_exp_f32 v162, v162
v_exp_f32 v163, v163
v_exp_f32 v164, v164
v_exp_f32 v165, v165
v_exp_f32 v166, v166
v_exp_f32 v167, v167
v_pk_fma_f32 v[160:161], v[160:161], v[54:55], v[54:55]
v_pk_fma_f32 v[162:163], v[162:163], v[54:55], v[54:55]
v_pk_fma_f32 v[164:165], v[164:165], v[54:55], v[54:55]
v_pk_fma_f32 v[166:167], v[166:167], v[54:55], v[54:55]
v_rcp_f32 v160, v160
v_rcp_f32 v161, v161
v_rcp_f32 v162, v162
v_rcp_f32 v163, v163
v_rcp_f32 v164, v164
v_rcp_f32 v165, v165
v_rcp_f32 v166, v166
v_rcp_f32 v167, v167
v_pk_mul_f32 v[160:161], v[160:161], v[104:105]
v_pk_mul_f32 v[162:163], v[162:163], v[106:107]
v_pk_mul_f32 v[164:165], v[164:165], v[108:109]
v_pk_mul_f32 v[166:167], v[166:167], v[110:111]
v_cvt_pk_bf16_f32 v104, v160, v161
v_cvt_pk_bf16_f32 v105, v162, v163
v_cvt_pk_bf16_f32 v106, v164, v165
v_cvt_pk_bf16_f32 v107, v166, v167
buffer_store_dwordx4 v[88:91], v60, s[24:27], s100 offen offset:2560 sc1
v_lshlrev_b32 v5, 4, v0
v_add_u32 v5, 87552, v5
v_add_u32 v7, 60416, v5
v_mov_b32 v12, 0
v_mov_b32 v13, 0
v_mov_b32 v14, 0
v_mov_b32 v15, 0
v_cmp_gt_u32 vcc, 119, v0
s_and_saveexec_b64 s[6:7], vcc
ds_write_b128 v5, v[12:15] offset:0
ds_write_b128 v5, v[12:15] offset:6272
ds_write_b128 v5, v[12:15] offset:30208
ds_write_b128 v5, v[12:15] offset:36480
ds_write_b128 v7, v[12:15] offset:0
ds_write_b128 v7, v[12:15] offset:6272
s_mov_b64 exec, s[6:7]
v_lshrrev_b32 v4, 4, v0
v_mul_u32_u24 v4, 272, v4
v_and_b32 v5, 15, v0
v_lshl_add_u32 v4, v5, 4, v4
v_add_u32 v4, 83200, v4
v_add_u32 v6, 60416, v4
s_waitcnt vmcnt(19)
ds_write_b128 v4, v[32:35] offset:6272
v_alignbit_b32 v12, v33, v32, 16
v_alignbit_b32 v13, v34, v33, 16
v_alignbit_b32 v14, v35, v34, 16
v_alignbit_b32 v15, v36, v35, 16
ds_write_b128 v4, v[12:15] offset:0
ds_write_b128 v4, v[38:41] offset:36480
v_alignbit_b32 v12, v39, v38, 16
v_alignbit_b32 v13, v40, v39, 16
v_alignbit_b32 v14, v41, v40, 16
v_alignbit_b32 v15, v42, v41, 16
ds_write_b128 v4, v[12:15] offset:30208
ds_write_b128 v6, v[44:47] offset:6272
v_alignbit_b32 v12, v45, v44, 16
v_alignbit_b32 v13, v46, v45, 16
v_alignbit_b32 v14, v47, v46, 16
v_alignbit_b32 v15, v48, v47, 16
ds_write_b128 v6, v[12:15] offset:0
buffer_load_dwordx4 a[64:67], v248, s[24:27], s97 offen offset:1024
buffer_load_dwordx4 a[68:71], v248, s[24:27], s97 offen offset:2048
buffer_load_dwordx4 a[72:75], v248, s[24:27], s97 offen offset:3072
buffer_load_dwordx4 a[76:79], v248, s[24:27], s98 offen
s_add_u32 s97, s97, 5120
s_add_u32 s98, s98, 5120
v_pk_mul_f32 v[160:161], v[112:113], v[112:113]
v_pk_mul_f32 v[162:163], v[114:115], v[114:115]
v_pk_mul_f32 v[164:165], v[116:117], v[116:117]
v_pk_mul_f32 v[166:167], v[118:119], v[118:119]
v_pk_fma_f32 v[160:161], v[160:161], v[56:57], v[56:57] op_sel:[0,1,0] op_sel_hi:[1,1,0]
v_pk_fma_f32 v[162:163], v[162:163], v[56:57], v[56:57] op_sel:[0,1,0] op_sel_hi:[1,1,0]
v_pk_fma_f32 v[164:165], v[164:165], v[56:57], v[56:57] op_sel:[0,1,0] op_sel_hi:[1,1,0]
v_pk_fma_f32 v[166:167], v[166:167], v[56:57], v[56:57] op_sel:[0,1,0] op_sel_hi:[1,1,0]
v_pk_mul_f32 v[160:161], v[160:161], v[112:113]
v_pk_mul_f32 v[162:163], v[162:163], v[114:115]
v_pk_mul_f32 v[164:165], v[164:165], v[116:117]
v_pk_mul_f32 v[166:167], v[166:167], v[118:119]
v_exp_f32 v160, v160
v_exp_f32 v161, v161
v_exp_f32 v162, v162
v_exp_f32 v163, v163
v_exp_f32 v164, v164
v_exp_f32 v165, v165
v_exp_f32 v166, v166
v_exp_f32 v167, v167
v_pk_fma_f32 v[160:161], v[160:161], v[58:59], v[58:59]
v_pk_fma_f32 v[162:163], v[162:163], v[58:59], v[58:59]
v_pk_fma_f32 v[164:165], v[164:165], v[58:59], v[58:59]
v_pk_fma_f32 v[166:167], v[166:167], v[58:59], v[58:59]
v_rcp_f32 v160, v160
v_rcp_f32 v161, v161
v_rcp_f32 v162, v162
v_rcp_f32 v163, v163
v_rcp_f32 v164, v164
v_rcp_f32 v165, v165
v_rcp_f32 v166, v166
v_rcp_f32 v167, v167
v_pk_mul_f32 v[160:161], v[160:161], v[112:113]
v_pk_mul_f32 v[162:163], v[162:163], v[114:115]
v_pk_mul_f32 v[164:165], v[164:165], v[116:117]
v_pk_mul_f32 v[166:167], v[166:167], v[118:119]
v_cvt_pk_bf16_f32 v112, v160, v161
v_cvt_pk_bf16_f32 v113, v162, v163
v_cvt_pk_bf16_f32 v114, v164, v165
v_cvt_pk_bf16_f32 v115, v166, v167
buffer_load_dwordx4 a[80:83], v248, s[24:27], s97 offen offset:0
buffer_load_dwordx4 a[84:87], v248, s[24:27], s97 offen offset:1024
buffer_load_dwordx4 a[88:91], v248, s[24:27], s97 offen offset:2048
buffer_load_dwordx4 a[92:95], v248, s[24:27], s97 offen offset:3072
v_pk_mul_f32 v[160:161], v[120:121], v[120:121]
v_pk_mul_f32 v[162:163], v[122:123], v[122:123]
v_pk_mul_f32 v[164:165], v[124:125], v[124:125]
v_pk_mul_f32 v[166:167], v[126:127], v[126:127]
v_pk_fma_f32 v[160:161], v[160:161], v[56:57], v[56:57] op_sel:[0,1,0] op_sel_hi:[1,1,0]
v_pk_fma_f32 v[162:163], v[162:163], v[56:57], v[56:57] op_sel:[0,1,0] op_sel_hi:[1,1,0]
v_pk_fma_f32 v[164:165], v[164:165], v[56:57], v[56:57] op_sel:[0,1,0] op_sel_hi:[1,1,0]
v_pk_fma_f32 v[166:167], v[166:167], v[56:57], v[56:57] op_sel:[0,1,0] op_sel_hi:[1,1,0]
v_pk_mul_f32 v[160:161], v[160:161], v[120:121]
v_pk_mul_f32 v[162:163], v[162:163], v[122:123]
v_pk_mul_f32 v[164:165], v[164:165], v[124:125]
v_pk_mul_f32 v[166:167], v[166:167], v[126:127]
v_exp_f32 v160, v160
v_exp_f32 v161, v161
v_exp_f32 v162, v162
v_exp_f32 v163, v163
v_exp_f32 v164, v164
v_exp_f32 v165, v165
v_exp_f32 v166, v166
v_exp_f32 v167, v167
v_pk_fma_f32 v[160:161], v[160:161], v[58:59], v[58:59]
v_pk_fma_f32 v[162:163], v[162:163], v[58:59], v[58:59]
v_pk_fma_f32 v[164:165], v[164:165], v[58:59], v[58:59]
v_pk_fma_f32 v[166:167], v[166:167], v[58:59], v[58:59]
v_rcp_f32 v160, v160
v_rcp_f32 v161, v161
v_rcp_f32 v162, v162
v_rcp_f32 v163, v163
v_rcp_f32 v164, v164
v_rcp_f32 v165, v165
v_rcp_f32 v166, v166
v_rcp_f32 v167, v167
v_pk_mul_f32 v[160:161], v[160:161], v[120:121]
v_pk_mul_f32 v[162:163], v[162:163], v[122:123]
v_pk_mul_f32 v[164:165], v[164:165], v[124:125]
v_pk_mul_f32 v[166:167], v[166:167], v[126:127]
v_cvt_pk_bf16_f32 v120, v160, v161
v_cvt_pk_bf16_f32 v121, v162, v163
v_cvt_pk_bf16_f32 v122, v164, v165
v_cvt_pk_bf16_f32 v123, v166, v167
buffer_store_dwordx4 v[96:99], v60, s[24:27], s101 offen offset:0 sc1
L_conv:
s_lshl_b32 s6, s89, 2
s_add_u32 s6, s6, s5
s_lshl_b32 s7, s6, 1
s_lshr_b32 s85, 6436, s7
s_and_b32 s85, s85, 3
s_lshr_b32 s86, 55, s6
s_and_b32 s86, s86, 1
s_lshr_b32 s87, 61311, s7
s_and_b32 s87, s87, 3
v_and_b32 v2, 3, v1
v_mul_u32_u24 v2, 4416, v2
v_bfe_u32 v3, v1, 2, 2
v_lshrrev_b32 v18, 4, v1
v_add_u32 v3, v3, v18
v_lshl_add_u32 v16, v3, 4, v2
v_and_b32 v2, 1, v1
v_mul_u32_u24 v2, 6272, v2
v_bfe_u32 v3, v1, 1, 3
s_lshl_b32 s6, s86, 3
s_sub_u32 s6, 15, s6
v_sub_u32 v5, s6, v3
v_mul_u32_u24 v5, 272, v5
v_add_u32 v2, v2, v5
v_lshl_add_u32 v17, v18, 4, v2
s_lshl_b32 s6, s86, 3
v_add_u32 v3, s6, v3
v_lshlrev_b32 v3, 8, v3
v_and_b32 v2, 1, v1
v_lshl_or_b32 v2, v18, 1, v2
v_lshl_or_b32 v11, v2, 4, v3
s_mul_i32 s6, s85, 30208
s_add_u32 s6, s6, 65536
v_add_u32 v8, s6, v16
s_add_u32 s6, s6, 17664
v_add_u32 v9, s6, v17
v_lshlrev_b32 v10, 5, v18
v_sub_u32 v10, v9, v10
v_add_u32 v10, 0, v10
s_add_u32 s91, s88, s85
s_lshl_b32 s6, s91, 1
s_and_b32 s6, s6, 0xfffffffc
s_load_dword s92, s[50:51], s6
s_waitcnt lgkmcnt(0)
s_barrier
ds_read_b128 v[128:131], v8 offset:0
ds_read_b128 v[132:135], v8 offset:64
ds_read_b128 v[136:139], v8 offset:128
ds_read_b128 v[140:143], v8 offset:192
ds_read_b128 v[144:147], v8 offset:256
ds_read_b128 v[148:151], v8 offset:320
ds_read_b128 v[152:155], v8 offset:384
ds_read_b128 v[156:159], v8 offset:448
ds_read_b128 v[160:163], v9 offset:0
ds_read_b128 v[164:167], v9 offset:64
ds_read_b128 v[168:171], v9 offset:128
v_mov_b32 v176, 0
v_mov_b32 v177, 0
v_mov_b32 v178, 0
v_mov_b32 v179, 0
v_mov_b32 v180, 0
v_mov_b32 v181, 0
v_mov_b32 v182, 0
v_mov_b32 v183, 0
v_mov_b32 v184, 0
v_mov_b32 v185, 0
v_mov_b32 v186, 0
v_mov_b32 v187, 0
v_mov_b32 v188, 0
v_mov_b32 v189, 0
v_mov_b32 v190, 0
v_mov_b32 v191, 0
s_waitcnt lgkmcnt(0)
ds_read_b128 v[128:131], v8 offset:512
ds_read_b128 v[172:175], v9 offset:192
v_mfma_f32_16x16x32_bf16 v[188:191], v[140:143], v[160:163], v[188:191]
ds_read_b128 v[132:135], v8 offset:576
ds_read_b128 v[160:163], v9 offset:272
v_mfma_f32_16x16x32_bf16 v[184:187], v[140:143], v[164:167], v[184:187]
buffer_load_dwordx4 a[96:99], v248, s[24:27], s98 offen
v_mfma_f32_16x16x32_bf16 v[188:191], v[144:147], v[164:167], v[188:191]
s_add_u32 s97, s97, 5120
s_add_u32 s98, s98, 5120
ds_read_b128 v[136:139], v8 offset:640
v_mfma_f32_16x16x32_bf16 v[180:183], v[140:143], v[168:171], v[180:183]
ds_read_b128 v[164:167], v9 offset:336
v_mfma_f32_16x16x32_bf16 v[184:187], v[144:147], v[168:171], v[184:187]
buffer_load_dwordx4 a[100:103], v248, s[24:27], s97 offen offset:0
v_mfma_f32_16x16x32_bf16 v[188:191], v[148:151], v[168:171], v[188:191]
s_waitcnt lgkmcnt(4)
v_mfma_f32_16x16x32_bf16 v[176:179], v[140:143], v[172:175], v[176:179]
ds_read_b128 v[140:143], v8 offset:704
v_mfma_f32_16x16x32_bf16 v[180:183], v[144:147], v[172:175], v[180:183]
ds_read_b128 v[168:171], v9 offset:400
v_mfma_f32_16x16x32_bf16 v[184:187], v[148:151], v[172:175], v[184:187]
buffer_store_dwordx4 v[104:107], v60, s[24:27], s101 offen offset:512 sc1
v_mfma_f32_16x16x32_bf16 v[188:191], v[152:155], v[172:175], v[188:191]
buffer_load_dwordx4 a[104:107], v248, s[24:27], s97 offen offset:1024
s_waitcnt lgkmcnt(4)
v_mfma_f32_16x16x32_bf16 v[176:179], v[144:147], v[160:163], v[176:179]
ds_read_b128 v[144:147], v8 offset:768
v_mfma_f32_16x16x32_bf16 v[180:183], v[148:151], v[160:163], v[180:183]
ds_read_b128 v[172:175], v9 offset:464
v_mfma_f32_16x16x32_bf16 v[184:187], v[152:155], v[160:163], v[184:187]
buffer_load_dwordx4 a[108:111], v248, s[24:27], s97 offen offset:2048
v_mfma_f32_16x16x32_bf16 v[188:191], v[156:159], v[160:163], v[188:191]
s_waitcnt lgkmcnt(4)
v_mfma_f32_16x16x32_bf16 v[176:179], v[148:151], v[164:167], v[176:179]
ds_read_b128 v[148:151], v8 offset:832
v_mfma_f32_16x16x32_bf16 v[180:183], v[152:155], v[164:167], v[180:183]
ds_read_b128 v[160:163], v9 offset:544
v_mfma_f32_16x16x32_bf16 v[184:187], v[156:159], v[164:167], v[184:187]
v_mfma_f32_16x16x32_bf16 v[188:191], v[128:131], v[164:167], v[188:191]
s_waitcnt lgkmcnt(4)
v_mfma_f32_16x16x32_bf16 v[176:179], v[152:155], v[168:171], v[176:179]
ds_read_b128 v[152:155], v8 offset:896
v_mfma_f32_16x16x32_bf16 v[180:183], v[156:159], v[168:171], v[180:183]
ds_read_b128 v[164:167], v9 offset:608
v_mfma_f32_16x16x32_bf16 v[184:187], v[128:131], v[168:171], v[184:187]
buffer_load_dwordx4 a[112:115], v248, s[24:27], s97 offen offset:3072
v_mfma_f32_16x16x32_bf16 v[188:191], v[132:135], v[168:171], v[188:191]
s_waitcnt lgkmcnt(4)
v_mfma_f32_16x16x32_bf16 v[176:179], v[156:159], v[172:175], v[176:179]
ds_read_b128 v[156:159], v8 offset:960
v_mfma_f32_16x16x32_bf16 v[180:183], v[128:131], v[172:175], v[180:183]
ds_read_b128 v[168:171], v9 offset:672
v_mfma_f32_16x16x32_bf16 v[184:187], v[132:135], v[172:175], v[184:187]
buffer_load_dwordx4 a[116:119], v248, s[24:27], s98 offen
v_mfma_f32_16x16x32_bf16 v[188:191], v[136:139], v[172:175], v[188:191]
s_add_u32 s97, s97, 5120
s_add_u32 s98, s98, 5120
s_waitcnt lgkmcnt(4)
v_mfma_f32_16x16x32_bf16 v[176:179], v[128:131], v[160:163], v[176:179]
ds_read_b128 v[128:131], v8 offset:1024
v_mfma_f32_16x16x32_bf16 v[180:183], v[132:135], v[160:163], v[180:183]
ds_read_b128 v[172:175], v9 offset:736
v_mfma_f32_16x16x32_bf16 v[184:187], v[136:139], v[160:163], v[184:187]
buffer_load_dwordx4 a[120:123], v248, s[24:27], s97 offen offset:0
v_mfma_f32_16x16x32_bf16 v[188:191], v[140:143], v[160:163], v[188:191]
s_waitcnt lgkmcnt(4)
v_mfma_f32_16x16x32_bf16 v[176:179], v[132:135], v[164:167], v[176:179]
ds_read_b128 v[132:135], v8 offset:1088
v_mfma_f32_16x16x32_bf16 v[180:183], v[136:139], v[164:167], v[180:183]
ds_read_b128 v[160:163], v9 offset:816
v_mfma_f32_16x16x32_bf16 v[184:187], v[140:143], v[164:167], v[184:187]
buffer_store_dwordx4 v[112:115], v60, s[24:27], s101 offen offset:2048 sc1
v_mfma_f32_16x16x32_bf16 v[188:191], v[144:147], v[164:167], v[188:191]
s_waitcnt lgkmcnt(4)
v_mfma_f32_16x16x32_bf16 v[176:179], v[136:139], v[168:171], v[176:179]
ds_read_b128 v[136:139], v8 offset:1152
v_mfma_f32_16x16x32_bf16 v[180:183], v[140:143], v[168:171], v[180:183]
ds_read_b128 v[164:167], v9 offset:880
v_mfma_f32_16x16x32_bf16 v[184:187], v[144:147], v[168:171], v[184:187]
buffer_load_dwordx4 a[124:127], v248, s[24:27], s97 offen offset:1024
v_mfma_f32_16x16x32_bf16 v[188:191], v[148:151], v[168:171], v[188:191]
s_waitcnt lgkmcnt(4)
v_mfma_f32_16x16x32_bf16 v[176:179], v[140:143], v[172:175], v[176:179]
ds_read_b128 v[140:143], v8 offset:1216
v_mfma_f32_16x16x32_bf16 v[180:183], v[144:147], v[172:175], v[180:183]
ds_read_b128 v[168:171], v9 offset:944
v_mfma_f32_16x16x32_bf16 v[184:187], v[148:151], v[172:175], v[184:187]
buffer_load_dwordx4 a[128:131], v248, s[24:27], s97 offen offset:2048
v_mfma_f32_16x16x32_bf16 v[188:191], v[152:155], v[172:175], v[188:191]
s_waitcnt lgkmcnt(4)
v_mfma_f32_16x16x32_bf16 v[176:179], v[144:147], v[160:163], v[176:179]
ds_read_b128 v[144:147], v8 offset:1280
v_mfma_f32_16x16x32_bf16 v[180:183], v[148:151], v[160:163], v[180:183]
ds_read_b128 v[172:175], v9 offset:1008
v_mfma_f32_16x16x32_bf16 v[184:187], v[152:155], v[160:163], v[184:187]
buffer_load_dwordx4 a[132:135], v248, s[24:27], s97 offen offset:3072
v_mfma_f32_16x16x32_bf16 v[188:191], v[156:159], v[160:163], v[188:191]
s_waitcnt lgkmcnt(4)
v_mfma_f32_16x16x32_bf16 v[176:179], v[148:151], v[164:167], v[176:179]
ds_read_b128 v[148:151], v8 offset:1344
v_mfma_f32_16x16x32_bf16 v[180:183], v[152:155], v[164:167], v[180:183]
ds_read_b128 v[160:163], v9 offset:1088
v_mfma_f32_16x16x32_bf16 v[184:187], v[156:159], v[164:167], v[184:187]
v_mfma_f32_16x16x32_bf16 v[188:191], v[128:131], v[164:167], v[188:191]
s_waitcnt lgkmcnt(4)
v_mfma_f32_16x16x32_bf16 v[176:179], v[152:155], v[168:171], v[176:179]
ds_read_b128 v[152:155], v8 offset:1408
v_mfma_f32_16x16x32_bf16 v[180:183], v[156:159], v[168:171], v[180:183]
ds_read_b128 v[164:167], v9 offset:1152
v_mfma_f32_16x16x32_bf16 v[184:187], v[128:131], v[168:171], v[184:187]
buffer_load_dwordx4 a[136:139], v248, s[24:27], s98 offen
v_mfma_f32_16x16x32_bf16 v[188:191], v[132:135], v[168:171], v[188:191]
s_add_u32 s97, s97, 5120
s_add_u32 s98, s98, 5120
s_waitcnt lgkmcnt(4)
v_mfma_f32_16x16x32_bf16 v[176:179], v[156:159], v[172:175], v[176:179]
ds_read_b128 v[156:159], v8 offset:1472
v_mfma_f32_16x16x32_bf16 v[180:183], v[128:131], v[172:175], v[180:183]
ds_read_b128 v[168:171], v9 offset:1216
v_mfma_f32_16x16x32_bf16 v[184:187], v[132:135], v[172:175], v[184:187]
buffer_store_dwordx4 v[120:123], v60, s[24:27], s101 offen offset:2560 sc1
v_mfma_f32_16x16x32_bf16 v[188:191], v[136:139], v[172:175], v[188:191]
buffer_load_dwordx4 a[140:143], v248, s[24:27], s97 offen offset:0
s_waitcnt lgkmcnt(4)
v_mfma_f32_16x16x32_bf16 v[176:179], v[128:131], v[160:163], v[176:179]
ds_read_b128 v[128:131], v8 offset:1536
v_mfma_f32_16x16x32_bf16 v[180:183], v[132:135], v[160:163], v[180:183]
ds_read_b128 v[172:175], v9 offset:1280
v_mfma_f32_16x16x32_bf16 v[184:187], v[136:139], v[160:163], v[184:187]
buffer_load_dwordx4 a[144:147], v248, s[24:27], s97 offen offset:1024
v_mfma_f32_16x16x32_bf16 v[188:191], v[140:143], v[160:163], v[188:191]
s_waitcnt lgkmcnt(4)
v_mfma_f32_16x16x32_bf16 v[176:179], v[132:135], v[164:167], v[176:179]
ds_read_b128 v[132:135], v8 offset:1600
v_mfma_f32_16x16x32_bf16 v[180:183], v[136:139], v[164:167], v[180:183]
ds_read_b128 v[160:163], v9 offset:1360
v_mfma_f32_16x16x32_bf16 v[184:187], v[140:143], v[164:167], v[184:187]
buffer_load_dwordx4 a[148:151], v248, s[24:27], s97 offen offset:2048
v_mfma_f32_16x16x32_bf16 v[188:191], v[144:147], v[164:167], v[188:191]
s_waitcnt lgkmcnt(4)
v_mfma_f32_16x16x32_bf16 v[176:179], v[136:139], v[168:171], v[176:179]
ds_read_b128 v[136:139], v8 offset:1664
v_mfma_f32_16x16x32_bf16 v[180:183], v[140:143], v[168:171], v[180:183]
ds_read_b128 v[164:167], v9 offset:1424
v_mfma_f32_16x16x32_bf16 v[184:187], v[144:147], v[168:171], v[184:187]
v_mfma_f32_16x16x32_bf16 v[188:191], v[148:151], v[168:171], v[188:191]
s_waitcnt lgkmcnt(4)
v_mfma_f32_16x16x32_bf16 v[176:179], v[140:143], v[172:175], v[176:179]
ds_read_b128 v[140:143], v8 offset:1728
v_mfma_f32_16x16x32_bf16 v[180:183], v[144:147], v[172:175], v[180:183]
ds_read_b128 v[168:171], v9 offset:1488
v_mfma_f32_16x16x32_bf16 v[184:187], v[148:151], v[172:175], v[184:187]
buffer_load_dwordx4 a[152:155], v248, s[24:27], s97 offen offset:3072
v_mfma_f32_16x16x32_bf16 v[188:191], v[152:155], v[172:175], v[188:191]
s_waitcnt lgkmcnt(4)
v_mfma_f32_16x16x32_bf16 v[176:179], v[144:147], v[160:163], v[176:179]
ds_read_b128 v[144:147], v8 offset:1792
v_mfma_f32_16x16x32_bf16 v[180:183], v[148:151], v[160:163], v[180:183]
ds_read_b128 v[172:175], v9 offset:1552
v_mfma_f32_16x16x32_bf16 v[184:187], v[152:155], v[160:163], v[184:187]
buffer_load_dwordx4 a[156:159], v248, s[24:27], s98 offen
v_mfma_f32_16x16x32_bf16 v[188:191], v[156:159], v[160:163], v[188:191]
s_add_u32 s97, s97, 5120
s_add_u32 s98, s98, 5120
s_waitcnt lgkmcnt(4)
v_mfma_f32_16x16x32_bf16 v[176:179], v[148:151], v[164:167], v[176:179]
ds_read_b128 v[148:151], v8 offset:1856
v_mfma_f32_16x16x32_bf16 v[180:183], v[152:155], v[164:167], v[180:183]
ds_read_b128 v[160:163], v9 offset:1632
v_mfma_f32_16x16x32_bf16 v[184:187], v[156:159], v[164:167], v[184:187]
buffer_load_dwordx4 a[160:163], v248, s[24:27], s97 offen offset:0
v_mfma_f32_16x16x32_bf16 v[188:191], v[128:131], v[164:167], v[188:191]
s_waitcnt lgkmcnt(4)
v_mfma_f32_16x16x32_bf16 v[176:179], v[152:155], v[168:171], v[176:179]
ds_read_b128 v[152:155], v8 offset:1920
v_mfma_f32_16x16x32_bf16 v[180:183], v[156:159], v[168:171], v[180:183]
ds_read_b128 v[164:167], v9 offset:1696
v_mfma_f32_16x16x32_bf16 v[184:187], v[128:131], v[168:171], v[184:187]
v_mfma_f32_16x16x32_bf16 v[188:191], v[132:135], v[168:171], v[188:191]
s_waitcnt lgkmcnt(4)
v_mfma_f32_16x16x32_bf16 v[176:179], v[156:159], v[172:175], v[176:179]
ds_read_b128 v[156:159], v8 offset:1984
v_mfma_f32_16x16x32_bf16 v[180:183], v[128:131], v[172:175], v[180:183]
ds_read_b128 v[168:171], v9 offset:1760
v_mfma_f32_16x16x32_bf16 v[184:187], v[132:135], v[172:175], v[184:187]
buffer_load_dwordx4 a[164:167], v248, s[24:27], s97 offen offset:1024
v_mfma_f32_16x16x32_bf16 v[188:191], v[136:139], v[172:175], v[188:191]
s_waitcnt lgkmcnt(4)
v_mfma_f32_16x16x32_bf16 v[176:179], v[128:131], v[160:163], v[176:179]
ds_read_b128 v[128:131], v8 offset:2048
v_mfma_f32_16x16x32_bf16 v[180:183], v[132:135], v[160:163], v[180:183]
ds_read_b128 v[172:175], v9 offset:1824
v_mfma_f32_16x16x32_bf16 v[184:187], v[136:139], v[160:163], v[184:187]
buffer_load_dwordx4 a[168:171], v248, s[24:27], s97 offen offset:2048
v_mfma_f32_16x16x32_bf16 v[188:191], v[140:143], v[160:163], v[188:191]
s_waitcnt lgkmcnt(4)
v_mfma_f32_16x16x32_bf16 v[176:179], v[132:135], v[164:167], v[176:179]
ds_read_b128 v[132:135], v8 offset:2112
v_mfma_f32_16x16x32_bf16 v[180:183], v[136:139], v[164:167], v[180:183]
ds_read_b128 v[160:163], v9 offset:1904
v_mfma_f32_16x16x32_bf16 v[184:187], v[140:143], v[164:167], v[184:187]
buffer_load_dwordx4 a[172:175], v248, s[24:27], s97 offen offset:3072
v_mfma_f32_16x16x32_bf16 v[188:191], v[144:147], v[164:167], v[188:191]
s_waitcnt lgkmcnt(4)
v_mfma_f32_16x16x32_bf16 v[176:179], v[136:139], v[168:171], v[176:179]
ds_read_b128 v[136:139], v8 offset:2176
v_mfma_f32_16x16x32_bf16 v[180:183], v[140:143], v[168:171], v[180:183]
ds_read_b128 v[164:167], v9 offset:1968
v_mfma_f32_16x16x32_bf16 v[184:187], v[144:147], v[168:171], v[184:187]
v_mfma_f32_16x16x32_bf16 v[188:191], v[148:151], v[168:171], v[188:191]
s_waitcnt lgkmcnt(4)
v_mfma_f32_16x16x32_bf16 v[176:179], v[140:143], v[172:175], v[176:179]
ds_read_b128 v[140:143], v8 offset:2240
v_mfma_f32_16x16x32_bf16 v[180:183], v[144:147], v[172:175], v[180:183]
ds_read_b128 v[168:171], v9 offset:2032
v_mfma_f32_16x16x32_bf16 v[184:187], v[148:151], v[172:175], v[184:187]
buffer_load_dwordx4 a[176:179], v248, s[24:27], s98 offen
v_mfma_f32_16x16x32_bf16 v[188:191], v[152:155], v[172:175], v[188:191]
s_add_u32 s97, s97, 5120
s_add_u32 s98, s98, 5120
s_waitcnt lgkmcnt(4)
v_mfma_f32_16x16x32_bf16 v[176:179], v[144:147], v[160:163], v[176:179]
ds_read_b128 v[144:147], v8 offset:2304
v_mfma_f32_16x16x32_bf16 v[180:183], v[148:151], v[160:163], v[180:183]
ds_read_b128 v[172:175], v9 offset:2096
v_mfma_f32_16x16x32_bf16 v[184:187], v[152:155], v[160:163], v[184:187]
buffer_load_dwordx4 a[180:183], v248, s[24:27], s97 offen offset:0
v_mfma_f32_16x16x32_bf16 v[188:191], v[156:159], v[160:163], v[188:191]
s_waitcnt lgkmcnt(4)
v_mfma_f32_16x16x32_bf16 v[176:179], v[148:151], v[164:167], v[176:179]
ds_read_b128 v[148:151], v8 offset:2368
v_mfma_f32_16x16x32_bf16 v[180:183], v[152:155], v[164:167], v[180:183]
ds_read_b128 v[160:163], v9 offset:2176
v_mfma_f32_16x16x32_bf16 v[184:187], v[156:159], v[164:167], v[184:187]
buffer_load_dwordx4 a[184:187], v248, s[24:27], s97 offen offset:1024
v_mfma_f32_16x16x32_bf16 v[188:191], v[128:131], v[164:167], v[188:191]
s_waitcnt lgkmcnt(4)
v_mfma_f32_16x16x32_bf16 v[176:179], v[152:155], v[168:171], v[176:179]
ds_read_b128 v[152:155], v8 offset:2432
v_mfma_f32_16x16x32_bf16 v[180:183], v[156:159], v[168:171], v[180:183]
ds_read_b128 v[164:167], v9 offset:2240
v_mfma_f32_16x16x32_bf16 v[184:187], v[128:131], v[168:171], v[184:187]
v_mfma_f32_16x16x32_bf16 v[188:191], v[132:135], v[168:171], v[188:191]
s_waitcnt lgkmcnt(4)
v_mfma_f32_16x16x32_bf16 v[176:179], v[156:159], v[172:175], v[176:179]
ds_read_b128 v[156:159], v8 offset:2496
v_mfma_f32_16x16x32_bf16 v[180:183], v[128:131], v[172:175], v[180:183]
ds_read_b128 v[168:171], v9 offset:2304
v_mfma_f32_16x16x32_bf16 v[184:187], v[132:135], v[172:175], v[184:187]
v_mfma_f32_16x16x32_bf16 v[188:191], v[136:139], v[172:175], v[188:191]
s_cmp_eq_u32 s86, 0
s_cbranch_scc1 L_two_12
L_halfb_13:
s_waitcnt lgkmcnt(4)
v_mfma_f32_16x16x32_bf16 v[176:179], v[128:131], v[160:163], v[176:179]
ds_read_b128 v[128:131], v8 offset:2560
v_mfma_f32_16x16x32_bf16 v[180:183], v[132:135], v[160:163], v[180:183]
ds_read_b128 v[172:175], v9 offset:2368
v_mfma_f32_16x16x32_bf16 v[184:187], v[136:139], v[160:163], v[184:187]
buffer_load_dwordx4 a[188:191], v248, s[24:27], s97 offen offset:2048
v_mfma_f32_16x16x32_bf16 v[188:191], v[140:143], v[160:163], v[188:191]
buffer_load_dwordx4 a[192:195], v248, s[24:27], s97 offen offset:3072
s_waitcnt lgkmcnt(4)
v_mfma_f32_16x16x32_bf16 v[176:179], v[132:135], v[164:167], v[176:179]
ds_read_b128 v[132:135], v8 offset:2624
v_mfma_f32_16x16x32_bf16 v[180:183], v[136:139], v[164:167], v[180:183]
ds_read_b128 v[160:163], v9 offset:2448
v_mfma_f32_16x16x32_bf16 v[184:187], v[140:143], v[164:167], v[184:187]
buffer_load_dwordx4 a[196:199], v248, s[24:27], s98 offen
v_mfma_f32_16x16x32_bf16 v[188:191], v[144:147], v[164:167], v[188:191]
s_add_u32 s97, s97, 5120
s_add_u32 s98, s98, 5120
s_waitcnt lgkmcnt(4)
v_mfma_f32_16x16x32_bf16 v[176:179], v[136:139], v[168:171], v[176:179]
ds_read_b128 v[136:139], v8 offset:2688
v_mfma_f32_16x16x32_bf16 v[180:183], v[140:143], v[168:171], v[180:183]
ds_read_b128 v[164:167], v9 offset:2512
v_mfma_f32_16x16x32_bf16 v[184:187], v[144:147], v[168:171], v[184:187]
buffer_load_dwordx4 a[200:203], v248, s[24:27], s97 offen offset:0
v_mfma_f32_16x16x32_bf16 v[188:191], v[148:151], v[168:171], v[188:191]
s_waitcnt lgkmcnt(4)
v_mfma_f32_16x16x32_bf16 v[176:179], v[140:143], v[172:175], v[176:179]
ds_read_b128 v[140:143], v8 offset:2752
v_mfma_f32_16x16x32_bf16 v[180:183], v[144:147], v[172:175], v[180:183]
ds_read_b128 v[168:171], v9 offset:2576
v_mfma_f32_16x16x32_bf16 v[184:187], v[148:151], v[172:175], v[184:187]
buffer_load_dwordx4 a[204:207], v248, s[24:27], s97 offen offset:1024
v_mfma_f32_16x16x32_bf16 v[188:191], v[152:155], v[172:175], v[188:191]
s_waitcnt vmcnt(17)
s_barrier
s_cmp_lg_u32 s5, 0
s_cbranch_scc1 L_fl_14
s_mov_b64 exec, 1
buffer_store_dword v253, v252, s[24:27], 0 offen offset:16 sc1
s_mov_b64 exec, -1
L_fl_14:
s_waitcnt lgkmcnt(4)
v_mfma_f32_16x16x32_bf16 v[176:179], v[144:147], v[160:163], v[176:179]
ds_read_b128 v[144:147], v8 offset:2816
v_mfma_f32_16x16x32_bf16 v[180:183], v[148:151], v[160:163], v[180:183]
ds_read_b128 v[172:175], v9 offset:2640
v_mfma_f32_16x16x32_bf16 v[184:187], v[152:155], v[160:163], v[184:187]
buffer_load_dwordx4 a[208:211], v248, s[24:27], s97 offen offset:2048
v_mfma_f32_16x16x32_bf16 v[188:191], v[156:159], v[160:163], v[188:191]
s_waitcnt lgkmcnt(4)
v_mfma_f32_16x16x32_bf16 v[176:179], v[148:151], v[164:167], v[176:179]
ds_read_b128 v[148:151], v8 offset:2880
v_mfma_f32_16x16x32_bf16 v[180:183], v[152:155], v[164:167], v[180:183]
ds_read_b128 v[160:163], v9 offset:2720
v_mfma_f32_16x16x32_bf16 v[184:187], v[156:159], v[164:167], v[184:187]
buffer_load_dwordx4 a[212:215], v248, s[24:27], s97 offen offset:3072
v_mfma_f32_16x16x32_bf16 v[188:191], v[128:131], v[164:167], v[188:191]
s_waitcnt lgkmcnt(4)
v_mfma_f32_16x16x32_bf16 v[176:179], v[152:155], v[168:171], v[176:179]
ds_read_b128 v[152:155], v8 offset:2944
v_mfma_f32_16x16x32_bf16 v[180:183], v[156:159], v[168:171], v[180:183]
ds_read_b128 v[164:167], v9 offset:2784
v_mfma_f32_16x16x32_bf16 v[184:187], v[128:131], v[168:171], v[184:187]
buffer_load_dwordx4 a[216:219], v248, s[24:27], s98 offen
v_mfma_f32_16x16x32_bf16 v[188:191], v[132:135], v[168:171], v[188:191]
s_add_u32 s97, s97, 5120
s_add_u32 s98, s98, 5120
s_waitcnt lgkmcnt(4)
v_mfma_f32_16x16x32_bf16 v[176:179], v[156:159], v[172:175], v[176:179]
ds_read_b128 v[156:159], v8 offset:3008
v_mfma_f32_16x16x32_bf16 v[180:183], v[128:131], v[172:175], v[180:183]
ds_read_b128 v[168:171], v9 offset:2848
v_mfma_f32_16x16x32_bf16 v[184:187], v[132:135], v[172:175], v[184:187]
buffer_load_dwordx4 a[220:223], v248, s[24:27], s97 offen offset:0
v_mfma_f32_16x16x32_bf16 v[188:191], v[136:139], v[172:175], v[188:191]
s_waitcnt lgkmcnt(4)
v_mfma_f32_16x16x32_bf16 v[176:179], v[128:131], v[160:163], v[176:179]
ds_read_b128 v[128:131], v8 offset:3072
v_mfma_f32_16x16x32_bf16 v[180:183], v[132:135], v[160:163], v[180:183]
ds_read_b128 v[172:175], v9 offset:2912
v_mfma_f32_16x16x32_bf16 v[184:187], v[136:139], v[160:163], v[184:187]
buffer_load_dwordx4 a[224:227], v248, s[24:27], s97 offen offset:1024
v_mfma_f32_16x16x32_bf16 v[188:191], v[140:143], v[160:163], v[188:191]
s_waitcnt lgkmcnt(4)
v_mfma_f32_16x16x32_bf16 v[176:179], v[132:135], v[164:167], v[176:179]
ds_read_b128 v[132:135], v8 offset:3136
v_mfma_f32_16x16x32_bf16 v[180:183], v[136:139], v[164:167], v[180:183]
ds_read_b128 v[160:163], v9 offset:2992
v_mfma_f32_16x16x32_bf16 v[184:187], v[140:143], v[164:167], v[184:187]
buffer_load_dwordx4 a[228:231], v248, s[24:27], s97 offen offset:2048
v_mfma_f32_16x16x32_bf16 v[188:191], v[144:147], v[164:167], v[188:191]
s_waitcnt lgkmcnt(4)
v_mfma_f32_16x16x32_bf16 v[176:179], v[136:139], v[168:171], v[176:179]
ds_read_b128 v[136:139], v8 offset:3200
v_mfma_f32_16x16x32_bf16 v[180:183], v[140:143], v[168:171], v[180:183]
ds_read_b128 v[164:167], v9 offset:3056
v_mfma_f32_16x16x32_bf16 v[184:187], v[144:147], v[168:171], v[184:187]
buffer_load_dwordx4 a[232:235], v248, s[24:27], s97 offen offset:3072
v_mfma_f32_16x16x32_bf16 v[188:191], v[148:151], v[168:171], v[188:191]
s_waitcnt lgkmcnt(4)
v_mfma_f32_16x16x32_bf16 v[176:179], v[140:143], v[172:175], v[176:179]
ds_read_b128 v[140:143], v8 offset:3264
v_mfma_f32_16x16x32_bf16 v[180:183], v[144:147], v[172:175], v[180:183]
ds_read_b128 v[168:171], v9 offset:3120
v_mfma_f32_16x16x32_bf16 v[184:187], v[148:151], v[172:175], v[184:187]
buffer_load_dwordx4 a[236:239], v248, s[24:27], s98 offen
v_mfma_f32_16x16x32_bf16 v[188:191], v[152:155], v[172:175], v[188:191]
s_add_u32 s97, s97, 5120
s_add_u32 s98, s98, 5120
s_waitcnt lgkmcnt(4)
v_mfma_f32_16x16x32_bf16 v[176:179], v[144:147], v[160:163], v[176:179]
ds_read_b128 v[144:147], v8 offset:3328
v_mfma_f32_16x16x32_bf16 v[180:183], v[148:151], v[160:163], v[180:183]
ds_read_b128 v[172:175], v9 offset:3184
v_mfma_f32_16x16x32_bf16 v[184:187], v[152:155], v[160:163], v[184:187]
buffer_load_dwordx4 v[208:211], v248, s[24:27], s97 offen offset:0
v_mfma_f32_16x16x32_bf16 v[188:191], v[156:159], v[160:163], v[188:191]
s_waitcnt lgkmcnt(4)
v_mfma_f32_16x16x32_bf16 v[176:179], v[148:151], v[164:167], v[176:179]
ds_read_b128 v[148:151], v8 offset:3392
v_mfma_f32_16x16x32_bf16 v[180:183], v[152:155], v[164:167], v[180:183]
ds_read_b128 v[160:163], v9 offset:3264
v_mfma_f32_16x16x32_bf16 v[184:187], v[156:159], v[164:167], v[184:187]
buffer_load_dwordx4 v[212:215], v248, s[24:27], s97 offen offset:1024
v_mfma_f32_16x16x32_bf16 v[188:191], v[128:131], v[164:167], v[188:191]
buffer_load_dword v254, v249, s[24:27], 0 offen sc1
s_waitcnt lgkmcnt(4)
v_mfma_f32_16x16x32_bf16 v[176:179], v[152:155], v[168:171], v[176:179]
ds_read_b128 v[152:155], v8 offset:3456
v_mfma_f32_16x16x32_bf16 v[180:183], v[156:159], v[168:171], v[180:183]
ds_read_b128 v[164:167], v9 offset:3328
v_mfma_f32_16x16x32_bf16 v[184:187], v[128:131], v[168:171], v[184:187]
buffer_load_dwordx4 v[216:219], v248, s[24:27], s97 offen offset:2048
v_mfma_f32_16x16x32_bf16 v[188:191], v[132:135], v[168:171], v[188:191]
s_waitcnt lgkmcnt(4)
v_mfma_f32_16x16x32_bf16 v[176:179], v[156:159], v[172:175], v[176:179]
ds_read_b128 v[156:159], v8 offset:3520
v_mfma_f32_16x16x32_bf16 v[180:183], v[128:131], v[172:175], v[180:183]
ds_read_b128 v[168:171], v9 offset:3392
v_mfma_f32_16x16x32_bf16 v[184:187], v[132:135], v[172:175], v[184:187]
buffer_load_dwordx4 v[220:223], v248, s[24:27], s97 offen offset:3072
v_mfma_f32_16x16x32_bf16 v[188:191], v[136:139], v[172:175], v[188:191]
s_waitcnt lgkmcnt(4)
v_mfma_f32_16x16x32_bf16 v[176:179], v[128:131], v[160:163], v[176:179]
ds_read_b128 v[128:131], v8 offset:3584
v_mfma_f32_16x16x32_bf16 v[180:183], v[132:135], v[160:163], v[180:183]
ds_read_b128 v[172:175], v9 offset:3456
v_mfma_f32_16x16x32_bf16 v[184:187], v[136:139], v[160:163], v[184:187]
buffer_load_dwordx4 v[224:227], v248, s[24:27], s98 offen
v_mfma_f32_16x16x32_bf16 v[188:191], v[140:143], v[160:163], v[188:191]
s_add_u32 s97, s97, 5120
s_add_u32 s98, s98, 5120
s_waitcnt lgkmcnt(4)
v_mfma_f32_16x16x32_bf16 v[176:179], v[132:135], v[164:167], v[176:179]
ds_read_b128 v[132:135], v8 offset:3648
v_mfma_f32_16x16x32_bf16 v[180:183], v[136:139], v[164:167], v[180:183]
ds_read_b128 v[160:163], v9 offset:3536
v_mfma_f32_16x16x32_bf16 v[184:187], v[140:143], v[164:167], v[184:187]
buffer_load_dwordx4 v[228:231], v248, s[24:27], s97 offen offset:0
v_mfma_f32_16x16x32_bf16 v[188:191], v[144:147], v[164:167], v[188:191]
s_waitcnt lgkmcnt(4)
v_mfma_f32_16x16x32_bf16 v[176:179], v[136:139], v[168:171], v[176:179]
ds_read_b128 v[136:139], v8 offset:3712
v_mfma_f32_16x16x32_bf16 v[180:183], v[140:143], v[168:171], v[180:183]
ds_read_b128 v[164:167], v9 offset:3600
v_mfma_f32_16x16x32_bf16 v[184:187], v[144:147], v[168:171], v[184:187]
buffer_load_dwordx4 v[232:235], v248, s[24:27], s97 offen offset:1024
v_mfma_f32_16x16x32_bf16 v[188:191], v[148:151], v[168:171], v[188:191]
s_waitcnt lgkmcnt(4)
v_mfma_f32_16x16x32_bf16 v[176:179], v[140:143], v[172:175], v[176:179]
ds_read_b128 v[140:143], v8 offset:3776
v_mfma_f32_16x16x32_bf16 v[180:183], v[144:147], v[172:175], v[180:183]
ds_read_b128 v[168:171], v9 offset:3664
v_mfma_f32_16x16x32_bf16 v[184:187], v[148:151], v[172:175], v[184:187]
buffer_load_dwordx4 v[236:239], v248, s[24:27], s97 offen offset:2048
v_mfma_f32_16x16x32_bf16 v[188:191], v[152:155], v[172:175], v[188:191]
s_waitcnt lgkmcnt(4)
v_mfma_f32_16x16x32_bf16 v[176:179], v[144:147], v[160:163], v[176:179]
ds_read_b128 v[144:147], v8 offset:3840
v_mfma_f32_16x16x32_bf16 v[180:183], v[148:151], v[160:163], v[180:183]
ds_read_b128 v[172:175], v9 offset:3728
v_mfma_f32_16x16x32_bf16 v[184:187], v[152:155], v[160:163], v[184:187]
buffer_load_dwordx4 v[240:243], v248, s[24:27], s97 offen offset:3072
v_mfma_f32_16x16x32_bf16 v[188:191], v[156:159], v[160:163], v[188:191]
s_waitcnt lgkmcnt(4)
v_mfma_f32_16x16x32_bf16 v[176:179], v[148:151], v[164:167], v[176:179]
ds_read_b128 v[148:151], v8 offset:3904
v_mfma_f32_16x16x32_bf16 v[180:183], v[152:155], v[164:167], v[180:183]
ds_read_b128 v[160:163], v9 offset:3808
v_mfma_f32_16x16x32_bf16 v[184:187], v[156:159], v[164:167], v[184:187]
buffer_load_dwordx4 v[244:247], v248, s[24:27], s98 offen
v_mfma_f32_16x16x32_bf16 v[188:191], v[128:131], v[164:167], v[188:191]
s_add_u32 s97, s97, 5120
s_add_u32 s98, s98, 5120
s_waitcnt vmcnt(8)
v_cmp_eq_u32 vcc, 0, v254
s_cbranch_vccnz L_slow_15
L_back_16:
s_mul_i32 s6, s94, 54
s_add_u32 s6, s6, s96
s_lshl_b32 s99, s6, 12
s_add_u32 s99, s99, 10485760
s_add_u32 s6, s5, 0
s_and_b32 s6, s6, 3
s_lshl_b32 s6, s6, 10
v_add_u32 v56, s6, v248
s_add_u32 s6, s5, 1
s_and_b32 s6, s6, 3
s_lshl_b32 s6, s6, 10
v_add_u32 v57, s6, v248
s_add_u32 s6, s5, 2
s_and_b32 s6, s6, 3
s_lshl_b32 s6, s6, 10
v_add_u32 v58, s6, v248
s_add_u32 s6, s5, 3
s_and_b32 s6, s6, 3
s_lshl_b32 s6, s6, 10
v_add_u32 v59, s6, v248
s_waitcnt lgkmcnt(4)
v_mfma_f32_16x16x32_bf16 v[176:179], v[152:155], v[168:171], v[176:179]
ds_read_b128 v[152:155], v8 offset:3968
v_mfma_f32_16x16x32_bf16 v[180:183], v[156:159], v[168:171], v[180:183]
ds_read_b128 v[164:167], v9 offset:3872
v_mfma_f32_16x16x32_bf16 v[184:187], v[128:131], v[168:171], v[184:187]
v_mfma_f32_16x16x32_bf16 v[188:191], v[132:135], v[168:171], v[188:191]
s_waitcnt lgkmcnt(4)
v_mfma_f32_16x16x32_bf16 v[176:179], v[156:159], v[172:175], v[176:179]
ds_read_b128 v[156:159], v8 offset:4032
v_mfma_f32_16x16x32_bf16 v[180:183], v[128:131], v[172:175], v[180:183]
ds_read_b128 v[168:171], v9 offset:3936
v_mfma_f32_16x16x32_bf16 v[184:187], v[132:135], v[172:175], v[184:187]
buffer_load_dwordx4 v[64:67], v56, s[24:27], s99 offen
v_mfma_f32_16x16x32_bf16 v[188:191], v[136:139], v[172:175], v[188:191]
buffer_load_dwordx4 v[68:71], v57, s[24:27], s99 offen
buffer_load_dwordx4 v[72:75], v58, s[24:27], s99 offen
buffer_load_dwordx4 v[76:79], v59, s[24:27], s99 offen
s_add_u32 s99, s99, 4096
s_waitcnt lgkmcnt(4)
v_mfma_f32_16x16x32_bf16 v[176:179], v[128:131], v[160:163], v[176:179]
ds_read_b128 v[128:131], v8 offset:4096
v_mfma_f32_16x16x32_bf16 v[180:183], v[132:135], v[160:163], v[180:183]
ds_read_b128 v[172:175], v9 offset:4000
v_mfma_f32_16x16x32_bf16 v[184:187], v[136:139], v[160:163], v[184:187]
v_mfma_f32_16x16x32_bf16 v[188:191], v[140:143], v[160:163], v[188:191]
s_waitcnt lgkmcnt(4)
v_mfma_f32_16x16x32_bf16 v[176:179], v[132:135], v[164:167], v[176:179]
ds_read_b128 v[132:135], v8 offset:4160
v_mfma_f32_16x16x32_bf16 v[180:183], v[136:139], v[164:167], v[180:183]
ds_read_b128 v[160:163], v9 offset:4080
v_mfma_f32_16x16x32_bf16 v[184:187], v[140:143], v[164:167], v[184:187]
v_mfma_f32_16x16x32_bf16 v[188:191], v[144:147], v[164:167], v[188:191]
s_waitcnt lgkmcnt(4)
v_mfma_f32_16x16x32_bf16 v[176:179], v[136:139], v[168:171], v[176:179]
ds_read_b128 v[136:139], v8 offset:4224
v_mfma_f32_16x16x32_bf16 v[180:183], v[140:143], v[168:171], v[180:183]
ds_read_b128 v[164:167], v9 offset:4144
v_mfma_f32_16x16x32_bf16 v[184:187], v[144:147], v[168:171], v[184:187]
buffer_load_dwordx4 v[80:83], v56, s[24:27], s99 offen
v_mfma_f32_16x16x32_bf16 v[188:191], v[148:151], v[168:171], v[188:191]
buffer_load_dwordx4 v[84:87], v57, s[24:27], s99 offen
buffer_load_dwordx4 v[88:91], v58, s[24:27], s99 offen
buffer_load_dwordx4 v[92:95], v59, s[24:27], s99 offen
s_add_u32 s99, s99, 4096
s_waitcnt lgkmcnt(4)
v_mfma_f32_16x16x32_bf16 v[176:179], v[140:143], v[172:175], v[176:179]
ds_read_b128 v[140:143], v8 offset:4288
v_mfma_f32_16x16x32_bf16 v[180:183], v[144:147], v[172:175], v[180:183]
ds_read_b128 v[168:171], v9 offset:4208
v_mfma_f32_16x16x32_bf16 v[184:187], v[148:151], v[172:175], v[184:187]
v_mfma_f32_16x16x32_bf16 v[188:191], v[152:155], v[172:175], v[188:191]
s_waitcnt lgkmcnt(4)
v_mfma_f32_16x16x32_bf16 v[176:179], v[144:147], v[160:163], v[176:179]
ds_read_b128 v[144:147], v8 offset:4352
v_mfma_f32_16x16x32_bf16 v[180:183], v[148:151], v[160:163], v[180:183]
ds_read_b128 v[172:175], v9 offset:4272
v_mfma_f32_16x16x32_bf16 v[184:187], v[152:155], v[160:163], v[184:187]
v_mfma_f32_16x16x32_bf16 v[188:191], v[156:159], v[160:163], v[188:191]
s_waitcnt lgkmcnt(4)
v_mfma_f32_16x16x32_bf16 v[176:179], v[148:151], v[164:167], v[176:179]
ds_read_b128 v[148:151], v8 offset:4416
v_mfma_f32_16x16x32_bf16 v[180:183], v[152:155], v[164:167], v[180:183]
ds_read_b128 v[160:163], v9 offset:4352
v_mfma_f32_16x16x32_bf16 v[184:187], v[156:159], v[164:167], v[184:187]
buffer_load_dwordx4 v[96:99], v56, s[24:27], s99 offen
v_mfma_f32_16x16x32_bf16 v[188:191], v[128:131], v[164:167], v[188:191]
buffer_load_dwordx4 v[100:103], v57, s[24:27], s99 offen
buffer_load_dwordx4 v[104:107], v58, s[24:27], s99 offen
buffer_load_dwordx4 v[108:111], v59, s[24:27], s99 offen
s_add_u32 s99, s99, 4096
s_waitcnt lgkmcnt(4)
v_mfma_f32_16x16x32_bf16 v[176:179], v[152:155], v[168:171], v[176:179]
ds_read_b128 v[152:155], v8 offset:4480
v_mfma_f32_16x16x32_bf16 v[180:183], v[156:159], v[168:171], v[180:183]
ds_read_b128 v[164:167], v9 offset:4416
v_mfma_f32_16x16x32_bf16 v[184:187], v[128:131], v[168:171], v[184:187]
v_mfma_f32_16x16x32_bf16 v[188:191], v[132:135], v[168:171], v[188:191]
s_waitcnt lgkmcnt(4)
v_mfma_f32_16x16x32_bf16 v[176:179], v[156:159], v[172:175], v[176:179]
ds_read_b128 v[156:159], v8 offset:4544
v_mfma_f32_16x16x32_bf16 v[180:183], v[128:131], v[172:175], v[180:183]
ds_read_b128 v[168:171], v9 offset:4480
v_mfma_f32_16x16x32_bf16 v[184:187], v[132:135], v[172:175], v[184:187]
v_mfma_f32_16x16x32_bf16 v[188:191], v[136:139], v[172:175], v[188:191]
s_waitcnt lgkmcnt(0)
ds_read_b128 v[128:131], v10 offset:240
ds_read_b128 v[132:135], v10 offset:176
ds_read_b128 v[136:139], v10 offset:112
ds_read_b128 v[140:143], v10 offset:48
s_and_b32 s6, s91, 1
s_lshl_b32 s6, s6, 4
s_lshr_b32 s92, s92, s6
s_lshl_b32 s92, s92, 16
s_lshl_b32 s6, s91, 12
s_add_u32 s6, s6, 4194304
s_nop 4
s_waitcnt lgkmcnt(0)
v_lshlrev_b32 v131, 16, v131
v_fma_f32 v176, v131, s92, v176
v_lshlrev_b32 v130, 16, v130
v_fma_f32 v177, v130, s92, v177
v_lshlrev_b32 v129, 16, v129
v_fma_f32 v178, v129, s92, v178
v_lshlrev_b32 v128, 16, v128
v_fma_f32 v179, v128, s92, v179
v_lshlrev_b32 v135, 16, v135
v_fma_f32 v180, v135, s92, v180
v_lshlrev_b32 v134, 16, v134
v_fma_f32 v181, v134, s92, v181
v_lshlrev_b32 v133, 16, v133
v_fma_f32 v182, v133, s92, v182
v_lshlrev_b32 v132, 16, v132
v_fma_f32 v183, v132, s92, v183
v_lshlrev_b32 v139, 16, v139
v_fma_f32 v184, v139, s92, v184
v_lshlrev_b32 v138, 16, v138
v_fma_f32 v185, v138, s92, v185
v_lshlrev_b32 v137, 16, v137
v_fma_f32 v186, v137, s92, v186
v_lshlrev_b32 v136, 16, v136
v_fma_f32 v187, v136, s92, v187
v_lshlrev_b32 v143, 16, v143
v_fma_f32 v188, v143, s92, v188
v_lshlrev_b32 v142, 16, v142
v_fma_f32 v189, v142, s92, v189
v_lshlrev_b32 v141, 16, v141
v_fma_f32 v190, v141, s92, v190
v_lshlrev_b32 v140, 16, v140
v_fma_f32 v191, v140, s92, v191
v_cvt_pk_bf16_f32 v160, v176, v177
v_cvt_pk_bf16_f32 v161, v178, v179
v_cvt_pk_bf16_f32 v162, v180, v181
v_cvt_pk_bf16_f32 v163, v182, v183
buffer_store_dwordx4 v[160:163], v11, s[24:27], s6 offen offset:0 sc1
v_cvt_pk_bf16_f32 v164, v184, v185
v_cvt_pk_bf16_f32 v165, v186, v187
v_cvt_pk_bf16_f32 v166, v188, v189
v_cvt_pk_bf16_f32 v167, v190, v191
buffer_store_dwordx4 v[164:167], v11, s[24:27], s6 offen offset:128 sc1
L_gemm2:
v_mov_b32 v128, 0
v_mov_b32 v129, 0
v_mov_b32 v130, 0
v_mov_b32 v131, 0
v_mov_b32 v132, 0
v_mov_b32 v133, 0
v_mov_b32 v134, 0
v_mov_b32 v135, 0
v_mov_b32 v136, 0
v_mov_b32 v137, 0
v_mov_b32 v138, 0
v_mov_b32 v139, 0
v_mov_b32 v140, 0
v_mov_b32 v141, 0
v_mov_b32 v142, 0
v_mov_b32 v143, 0
v_mov_b32 v144, 0
v_mov_b32 v145, 0
v_mov_b32 v146, 0
v_mov_b32 v147, 0
v_mov_b32 v148, 0
v_mov_b32 v149, 0
v_mov_b32 v150, 0
v_mov_b32 v151, 0
v_mov_b32 v152, 0
v_mov_b32 v153, 0
v_mov_b32 v154, 0
v_mov_b32 v155, 0
v_mov_b32 v156, 0
v_mov_b32 v157, 0
v_mov_b32 v158, 0
v_mov_b32 v159, 0
v_mov_b32 v160, 0
v_mov_b32 v161, 0
v_mov_b32 v162, 0
v_mov_b32 v163, 0
v_mov_b32 v164, 0
v_mov_b32 v165, 0
v_mov_b32 v166, 0
v_mov_b32 v167, 0
v_mov_b32 v168, 0
v_mov_b32 v169, 0
v_mov_b32 v170, 0
v_mov_b32 v171, 0
v_mov_b32 v172, 0
v_mov_b32 v173, 0
v_mov_b32 v174, 0
v_mov_b32 v175, 0
v_mov_b32 v176, 0
v_mov_b32 v177, 0
v_mov_b32 v178, 0
v_mov_b32 v179, 0
v_mov_b32 v180, 0
v_mov_b32 v181, 0
v_mov_b32 v182, 0
v_mov_b32 v183, 0
v_mov_b32 v184, 0
v_mov_b32 v185, 0
v_mov_b32 v186, 0
v_mov_b32 v187, 0
v_mov_b32 v188, 0
v_mov_b32 v189, 0
v_mov_b32 v190, 0
v_mov_b32 v191, 0
v_mov_b32 v192, 0
v_mov_b32 v193, 0
v_mov_b32 v194, 0
v_mov_b32 v195, 0
v_mov_b32 v196, 0
v_mov_b32 v197, 0
v_mov_b32 v198, 0
v_mov_b32 v199, 0
v_mov_b32 v200, 0
v_mov_b32 v201, 0
v_mov_b32 v202, 0
v_mov_b32 v203, 0
v_mov_b32 v204, 0
v_mov_b32 v205, 0
v_mov_b32 v206, 0
v_mov_b32 v207, 0
s_mov_b32 s32, s60
s_and_b32 s33, s61, 0xffff
s_mov_b32 s34, 1280
s_mov_b32 s35, 0x20000
v_and_b32 v2, 15, v1
v_lshrrev_b32 v3, 4, v1
v_lshrrev_b32 v4, 3, v2
v_lshlrev_b32 v4, 3, v4
v_and_b32 v5, 3, v2
v_lshl_or_b32 v4, v5, 1, v4
v_bfe_u32 v5, v2, 2, 1
v_or_b32 v4, v4, v5
s_lshl_b32 s6, s94, 6
s_lshl_b32 s7, s5, 4
s_add_u32 s6, s6, s7
v_add_u32 v4, s6, v4
v_lshlrev_b32 v5, 4, v4
v_mul_u32_u24 v4, 1280, v4
v_mul_u32_u24 v3, 40, v3
s_mul_i32 s6, s95, 160
v_add_u32 v3, s6, v3
v_add_u32 v60, v4, v3
s_mov_b32 s7, 98304
buffer_load_dwordx4 v[8:11], v60, s[8:11], 0 offen
buffer_load_dwordx4 v[12:15], v60, s[8:11], 0 offen offset:16
buffer_load_dwordx2 v[16:17], v60, s[8:11], 0 offen offset:32
buffer_load_dwordx4 v[20:23], v3, s[32:35], 0 offen
buffer_load_dwordx4 v[24:27], v3, s[32:35], 0 offen offset:16
buffer_load_dwordx2 v[28:29], v3, s[32:35], 0 offen offset:32
buffer_load_dwordx4 v[32:35], v5, s[24:27], s7 offen
s_waitcnt vmcnt(17)
v_mfma_f32_16x16x32_bf16 v[128:131], a[0:3], v[64:67], v[128:131]
buffer_load_dwordx4 v[112:115], v56, s[24:27], s99 offen
v_mfma_f32_16x16x32_bf16 v[148:151], a[0:3], v[68:71], v[148:151]
v_mfma_f32_16x16x32_bf16 v[168:171], a[0:3], v[72:75], v[168:171]
v_mfma_f32_16x16x32_bf16 v[188:191], a[0:3], v[76:79], v[188:191]
v_mfma_f32_16x16x32_bf16 v[132:135], a[4:7], v[64:67], v[132:135]
buffer_load_dwordx4 v[116:119], v57, s[24:27], s99 offen
v_mfma_f32_16x16x32_bf16 v[152:155], a[4:7], v[68:71], v[152:155]
v_mfma_f32_16x16x32_bf16 v[172:175], a[4:7], v[72:75], v[172:175]
v_mfma_f32_16x16x32_bf16 v[192:195], a[4:7], v[76:79], v[192:195]
v_mfma_f32_16x16x32_bf16 v[136:139], a[8:11], v[64:67], v[136:139]
buffer_load_dwordx4 v[120:123], v58, s[24:27], s99 offen
v_mfma_f32_16x16x32_bf16 v[156:159], a[8:11], v[68:71], v[156:159]
v_mfma_f32_16x16x32_bf16 v[176:179], a[8:11], v[72:75], v[176:179]
v_mfma_f32_16x16x32_bf16 v[196:199], a[8:11], v[76:79], v[196:199]
v_mfma_f32_16x16x32_bf16 v[140:143], a[12:15], v[64:67], v[140:143]
buffer_load_dwordx4 v[124:127], v59, s[24:27], s99 offen
v_mfma_f32_16x16x32_bf16 v[160:163], a[12:15], v[68:71], v[160:163]
v_mfma_f32_16x16x32_bf16 v[180:183], a[12:15], v[72:75], v[180:183]
v_mfma_f32_16x16x32_bf16 v[200:203], a[12:15], v[76:79], v[200:203]
v_mfma_f32_16x16x32_bf16 v[144:147], a[16:19], v[64:67], v[144:147]
s_add_u32 s99, s99, 4096
v_mfma_f32_16x16x32_bf16 v[164:167], a[16:19], v[68:71], v[164:167]
v_mfma_f32_16x16x32_bf16 v[184:187], a[16:19], v[72:75], v[184:187]
v_mfma_f32_16x16x32_bf16 v[204:207], a[16:19], v[76:79], v[204:207]
s_waitcnt vmcnt(17)
v_mfma_f32_16x16x32_bf16 v[128:131], a[20:23], v[80:83], v[128:131]
buffer_load_dwordx4 v[64:67], v56, s[24:27], s99 offen
v_mfma_f32_16x16x32_bf16 v[148:151], a[20:23], v[84:87], v[148:151]
v_mfma_f32_16x16x32_bf16 v[168:171], a[20:23], v[88:91], v[168:171]
v_mfma_f32_16x16x32_bf16 v[188:191], a[20:23], v[92:95], v[188:191]
v_mfma_f32_16x16x32_bf16 v[132:135], a[24:27], v[80:83], v[132:135]
buffer_load_dwordx4 v[68:71], v57, s[24:27], s99 offen
v_mfma_f32_16x16x32_bf16 v[152:155], a[24:27], v[84:87], v[152:155]
v_mfma_f32_16x16x32_bf16 v[172:175], a[24:27], v[88:91], v[172:175]
v_mfma_f32_16x16x32_bf16 v[192:195], a[24:27], v[92:95], v[192:195]
v_mfma_f32_16x16x32_bf16 v[136:139], a[28:31], v[80:83], v[136:139]
buffer_load_dwordx4 v[72:75], v58, s[24:27], s99 offen
v_mfma_f32_16x16x32_bf16 v[156:159], a[28:31], v[84:87], v[156:159]
v_mfma_f32_16x16x32_bf16 v[176:179], a[28:31], v[88:91], v[176:179]
v_mfma_f32_16x16x32_bf16 v[196:199], a[28:31], v[92:95], v[196:199]
v_mfma_f32_16x16x32_bf16 v[140:143], a[32:35], v[80:83], v[140:143]
buffer_load_dwordx4 v[76:79], v59, s[24:27], s99 offen
v_mfma_f32_16x16x32_bf16 v[160:163], a[32:35], v[84:87], v[160:163]
v_mfma_f32_16x16x32_bf16 v[180:183], a[32:35], v[88:91], v[180:183]
v_mfma_f32_16x16x32_bf16 v[200:203], a[32:35], v[92:95], v[200:203]
v_mfma_f32_16x16x32_bf16 v[144:147], a[36:39], v[80:83], v[144:147]
s_add_u32 s99, s99, 4096
v_mfma_f32_16x16x32_bf16 v[164:167], a[36:39], v[84:87], v[164:167]
v_mfma_f32_16x16x32_bf16 v[184:187], a[36:39], v[88:91], v[184:187]
v_mfma_f32_16x16x32_bf16 v[204:207], a[36:39], v[92:95], v[204:207]
s_waitcnt vmcnt(17)
v_mfma_f32_16x16x32_bf16 v[128:131], a[40:43], v[96:99], v[128:131]
buffer_load_dwordx4 v[80:83], v56, s[24:27], s99 offen
v_mfma_f32_16x16x32_bf16 v[148:151], a[40:43], v[100:103], v[148:151]
v_mfma_f32_16x16x32_bf16 v[168:171], a[40:43], v[104:107], v[168:171]
v_mfma_f32_16x16x32_bf16 v[188:191], a[40:43], v[108:111], v[188:191]
v_mfma_f32_16x16x32_bf16 v[132:135], a[44:47], v[96:99], v[132:135]
buffer_load_dwordx4 v[84:87], v57, s[24:27], s99 offen
v_mfma_f32_16x16x32_bf16 v[152:155], a[44:47], v[100:103], v[152:155]
v_mfma_f32_16x16x32_bf16 v[172:175], a[44:47], v[104:107], v[172:175]
v_mfma_f32_16x16x32_bf16 v[192:195], a[44:47], v[108:111], v[192:195]
v_mfma_f32_16x16x32_bf16 v[136:139], a[48:51], v[96:99], v[136:139]
buffer_load_dwordx4 v[88:91], v58, s[24:27], s99 offen
v_mfma_f32_16x16x32_bf16 v[156:159], a[48:51], v[100:103], v[156:159]
v_mfma_f32_16x16x32_bf16 v[176:179], a[48:51], v[104:107], v[176:179]
v_mfma_f32_16x16x32_bf16 v[196:199], a[48:51], v[108:111], v[196:199]
v_mfma_f32_16x16x32_bf16 v[140:143], a[52:55], v[96:99], v[140:143]
buffer_load_dwordx4 v[92:95], v59, s[24:27], s99 offen
v_mfma_f32_16x16x32_bf16 v[160:163], a[52:55], v[100:103], v[160:163]
v_mfma_f32_16x16x32_bf16 v[180:183], a[52:55], v[104:107], v[180:183]
v_mfma_f32_16x16x32_bf16 v[200:203], a[52:55], v[108:111], v[200:203]
v_mfma_f32_16x16x32_bf16 v[144:147], a[56:59], v[96:99], v[144:147]
s_add_u32 s99, s99, 4096
v_mfma_f32_16x16x32_bf16 v[164:167], a[56:59], v[100:103], v[164:167]
v_mfma_f32_16x16x32_bf16 v[184:187], a[56:59], v[104:107], v[184:187]
v_mfma_f32_16x16x32_bf16 v[204:207], a[56:59], v[108:111], v[204:207]
s_waitcnt vmcnt(19)
s_barrier
s_cmp_lg_u32 s5, 0
s_cbranch_scc1 L_fl_18
s_mov_b64 exec, 1
buffer_store_dword v253, v252, s[24:27], 0 offen offset:20 sc1
s_mov_b64 exec, -1
L_fl_18:
s_waitcnt vmcnt(8)
v_mfma_f32_16x16x32_bf16 v[128:131], a[60:63], v[112:115], v[128:131]
buffer_load_dwordx4 v[96:99], v56, s[24:27], s99 offen
v_mfma_f32_16x16x32_bf16 v[148:151], a[60:63], v[116:119], v[148:151]
v_mfma_f32_16x16x32_bf16 v[168:171], a[60:63], v[120:123], v[168:171]
v_mfma_f32_16x16x32_bf16 v[188:191], a[60:63], v[124:127], v[188:191]
v_mfma_f32_16x16x32_bf16 v[132:135], a[64:67], v[112:115], v[132:135]
buffer_load_dwordx4 v[100:103], v57, s[24:27], s99 offen
v_mfma_f32_16x16x32_bf16 v[152:155], a[64:67], v[116:119], v[152:155]
v_mfma_f32_16x16x32_bf16 v[172:175], a[64:67], v[120:123], v[172:175]
v_mfma_f32_16x16x32_bf16 v[192:195], a[64:67], v[124:127], v[192:195]
v_mfma_f32_16x16x32_bf16 v[136:139], a[68:71], v[112:115], v[136:139]
buffer_load_dwordx4 v[104:107], v58, s[24:27], s99 offen
v_mfma_f32_16x16x32_bf16 v[156:159], a[68:71], v[116:119], v[156:159]
v_mfma_f32_16x16x32_bf16 v[176:179], a[68:71], v[120:123], v[176:179]
v_mfma_f32_16x16x32_bf16 v[196:199], a[68:71], v[124:127], v[196:199]
v_mfma_f32_16x16x32_bf16 v[140:143], a[72:75], v[112:115], v[140:143]
buffer_load_dwordx4 v[108:111], v59, s[24:27], s99 offen
v_mfma_f32_16x16x32_bf16 v[160:163], a[72:75], v[116:119], v[160:163]
v_mfma_f32_16x16x32_bf16 v[180:183], a[72:75], v[120:123], v[180:183]
v_mfma_f32_16x16x32_bf16 v[200:203], a[72:75], v[124:127], v[200:203]
v_mfma_f32_16x16x32_bf16 v[144:147], a[76:79], v[112:115], v[144:147]
s_add_u32 s99, s99, 4096
v_mfma_f32_16x16x32_bf16 v[164:167], a[76:79], v[116:119], v[164:167]
v_mfma_f32_16x16x32_bf16 v[184:187], a[76:79], v[120:123], v[184:187]
v_mfma_f32_16x16x32_bf16 v[204:207], a[76:79], v[124:127], v[204:207]
s_waitcnt vmcnt(8)
v_mfma_f32_16x16x32_bf16 v[128:131], a[80:83], v[64:67], v[128:131]
buffer_load_dwordx4 v[112:115], v56, s[24:27], s99 offen
v_mfma_f32_16x16x32_bf16 v[148:151], a[80:83], v[68:71], v[148:151]
v_mfma_f32_16x16x32_bf16 v[168:171], a[80:83], v[72:75], v[168:171]
v_mfma_f32_16x16x32_bf16 v[188:191], a[80:83], v[76:79], v[188:191]
v_mfma_f32_16x16x32_bf16 v[132:135], a[84:87], v[64:67], v[132:135]
buffer_load_dwordx4 v[116:119], v57, s[24:27], s99 offen
v_mfma_f32_16x16x32_bf16 v[152:155], a[84:87], v[68:71], v[152:155]
v_mfma_f32_16x16x32_bf16 v[172:175], a[84:87], v[72:75], v[172:175]
v_mfma_f32_16x16x32_bf16 v[192:195], a[84:87], v[76:79], v[192:195]
v_mfma_f32_16x16x32_bf16 v[136:139], a[88:91], v[64:67], v[136:139]
buffer_load_dwordx4 v[120:123], v58, s[24:27], s99 offen
v_mfma_f32_16x16x32_bf16 v[156:159], a[88:91], v[68:71], v[156:159]
v_mfma_f32_16x16x32_bf16 v[176:179], a[88:91], v[72:75], v[176:179]
v_mfma_f32_16x16x32_bf16 v[196:199], a[88:91], v[76:79], v[196:199]
v_mfma_f32_16x16x32_bf16 v[140:143], a[92:95], v[64:67], v[140:143]
buffer_load_dwordx4 v[124:127], v59, s[24:27], s99 offen
v_mfma_f32_16x16x32_bf16 v[160:163], a[92:95], v[68:71], v[160:163]
v_mfma_f32_16x16x32_bf16 v[180:183], a[92:95], v[72:75], v[180:183]
v_mfma_f32_16x16x32_bf16 v[200:203], a[92:95], v[76:79], v[200:203]
v_mfma_f32_16x16x32_bf16 v[144:147], a[96:99], v[64:67], v[144:147]
s_add_u32 s99, s99, 4096
v_mfma_f32_16x16x32_bf16 v[164:167], a[96:99], v[68:71], v[164:167]
v_mfma_f32_16x16x32_bf16 v[184:187], a[96:99], v[72:75], v[184:187]
v_mfma_f32_16x16x32_bf16 v[204:207], a[96:99], v[76:79], v[204:207]
s_waitcnt vmcnt(8)
v_mfma_f32_16x16x32_bf16 v[128:131], a[100:103], v[80:83], v[128:131]
buffer_load_dwordx4 v[64:67], v56, s[24:27], s99 offen
v_mfma_f32_16x16x32_bf16 v[148:151], a[100:103], v[84:87], v[148:151]
v_mfma_f32_16x16x32_bf16 v[168:171], a[100:103], v[88:91], v[168:171]
v_mfma_f32_16x16x32_bf16 v[188:191], a[100:103], v[92:95], v[188:191]
v_mfma_f32_16x16x32_bf16 v[132:135], a[104:107], v[80:83], v[132:135]
buffer_load_dwordx4 v[68:71], v57, s[24:27], s99 offen
v_mfma_f32_16x16x32_bf16 v[152:155], a[104:107], v[84:87], v[152:155]
v_mfma_f32_16x16x32_bf16 v[172:175], a[104:107], v[88:91], v[172:175]
v_mfma_f32_16x16x32_bf16 v[192:195], a[104:107], v[92:95], v[192:195]
v_mfma_f32_16x16x32_bf16 v[136:139], a[108:111], v[80:83], v[136:139]
buffer_load_dwordx4 v[72:75], v58, s[24:27], s99 offen
v_mfma_f32_16x16x32_bf16 v[156:159], a[108:111], v[84:87], v[156:159]
v_mfma_f32_16x16x32_bf16 v[176:179], a[108:111], v[88:91], v[176:179]
v_mfma_f32_16x16x32_bf16 v[196:199], a[108:111], v[92:95], v[196:199]
v_mfma_f32_16x16x32_bf16 v[140:143], a[112:115], v[80:83], v[140:143]
buffer_load_dwordx4 v[76:79], v59, s[24:27], s99 offen
v_mfma_f32_16x16x32_bf16 v[160:163], a[112:115], v[84:87], v[160:163]
v_mfma_f32_16x16x32_bf16 v[180:183], a[112:115], v[88:91], v[180:183]
v_mfma_f32_16x16x32_bf16 v[200:203], a[112:115], v[92:95], v[200:203]
v_mfma_f32_16x16x32_bf16 v[144:147], a[116:119], v[80:83], v[144:147]
s_add_u32 s99, s99, 4096
v_mfma_f32_16x16x32_bf16 v[164:167], a[116:119], v[84:87], v[164:167]
v_mfma_f32_16x16x32_bf16 v[184:187], a[116:119], v[88:91], v[184:187]
v_mfma_f32_16x16x32_bf16 v[204:207], a[116:119], v[92:95], v[204:207]
buffer_load_dword v254, v250, s[24:27], 0 offen sc1
s_waitcnt vmcnt(9)
v_mfma_f32_16x16x32_bf16 v[128:131], a[120:123], v[96:99], v[128:131]
buffer_load_dwordx4 v[80:83], v56, s[24:27], s99 offen
v_mfma_f32_16x16x32_bf16 v[148:151], a[120:123], v[100:103], v[148:151]
v_mfma_f32_16x16x32_bf16 v[168:171], a[120:123], v[104:107], v[168:171]
v_mfma_f32_16x16x32_bf16 v[188:191], a[120:123], v[108:111], v[188:191]
v_mfma_f32_16x16x32_bf16 v[132:135], a[124:127], v[96:99], v[132:135]
buffer_load_dwordx4 v[84:87], v57, s[24:27], s99 offen
v_mfma_f32_16x16x32_bf16 v[152:155], a[124:127], v[100:103], v[152:155]
v_mfma_f32_16x16x32_bf16 v[172:175], a[124:127], v[104:107], v[172:175]
v_mfma_f32_16x16x32_bf16 v[192:195], a[124:127], v[108:111], v[192:195]
v_mfma_f32_16x16x32_bf16 v[136:139], a[128:131], v[96:99], v[136:139]
buffer_load_dwordx4 v[88:91], v58, s[24:27], s99 offen
v_mfma_f32_16x16x32_bf16 v[156:159], a[128:131], v[100:103], v[156:159]
v_mfma_f32_16x16x32_bf16 v[176:179], a[128:131], v[104:107], v[176:179]
v_mfma_f32_16x16x32_bf16 v[196:199], a[128:131], v[108:111], v[196:199]
v_mfma_f32_16x16x32_bf16 v[140:143], a[132:135], v[96:99], v[140:143]
buffer_load_dwordx4 v[92:95], v59, s[24:27], s99 offen
v_mfma_f32_16x16x32_bf16 v[160:163], a[132:135], v[100:103], v[160:163]
v_mfma_f32_16x16x32_bf16 v[180:183], a[132:135], v[104:107], v[180:183]
v_mfma_f32_16x16x32_bf16 v[200:203], a[132:135], v[108:111], v[200:203]
v_mfma_f32_16x16x32_bf16 v[144:147], a[136:139], v[96:99], v[144:147]
s_add_u32 s99, s99, 4096
v_mfma_f32_16x16x32_bf16 v[164:167], a[136:139], v[100:103], v[164:167]
v_mfma_f32_16x16x32_bf16 v[184:187], a[136:139], v[104:107], v[184:187]
v_mfma_f32_16x16x32_bf16 v[204:207], a[136:139], v[108:111], v[204:207]
s_waitcnt vmcnt(9)
v_mfma_f32_16x16x32_bf16 v[128:131], a[140:143], v[112:115], v[128:131]
buffer_load_dwordx4 v[96:99], v56, s[24:27], s99 offen
v_mfma_f32_16x16x32_bf16 v[148:151], a[140:143], v[116:119], v[148:151]
v_mfma_f32_16x16x32_bf16 v[168:171], a[140:143], v[120:123], v[168:171]
v_mfma_f32_16x16x32_bf16 v[188:191], a[140:143], v[124:127], v[188:191]
v_mfma_f32_16x16x32_bf16 v[132:135], a[144:147], v[112:115], v[132:135]
buffer_load_dwordx4 v[100:103], v57, s[24:27], s99 offen
v_mfma_f32_16x16x32_bf16 v[152:155], a[144:147], v[116:119], v[152:155]
v_mfma_f32_16x16x32_bf16 v[172:175], a[144:147], v[120:123], v[172:175]
v_mfma_f32_16x16x32_bf16 v[192:195], a[144:147], v[124:127], v[192:195]
v_mfma_f32_16x16x32_bf16 v[136:139], a[148:151], v[112:115], v[136:139]
buffer_load_dwordx4 v[104:107], v58, s[24:27], s99 offen
v_mfma_f32_16x16x32_bf16 v[156:159], a[148:151], v[116:119], v[156:159]
v_mfma_f32_16x16x32_bf16 v[176:179], a[148:151], v[120:123], v[176:179]
v_mfma_f32_16x16x32_bf16 v[196:199], a[148:151], v[124:127], v[196:199]
v_mfma_f32_16x16x32_bf16 v[140:143], a[152:155], v[112:115], v[140:143]
buffer_load_dwordx4 v[108:111], v59, s[24:27], s99 offen
v_mfma_f32_16x16x32_bf16 v[160:163], a[152:155], v[116:119], v[160:163]
v_mfma_f32_16x16x32_bf16 v[180:183], a[152:155], v[120:123], v[180:183]
v_mfma_f32_16x16x32_bf16 v[200:203], a[152:155], v[124:127], v[200:203]
v_mfma_f32_16x16x32_bf16 v[144:147], a[156:159], v[112:115], v[144:147]
s_add_u32 s99, s99, 4096
v_mfma_f32_16x16x32_bf16 v[164:167], a[156:159], v[116:119], v[164:167]
v_mfma_f32_16x16x32_bf16 v[184:187], a[156:159], v[120:123], v[184:187]
v_mfma_f32_16x16x32_bf16 v[204:207], a[156:159], v[124:127], v[204:207]
s_waitcnt vmcnt(9)
v_mfma_f32_16x16x32_bf16 v[128:131], a[160:163], v[64:67], v[128:131]
buffer_load_dwordx4 v[112:115], v56, s[24:27], s99 offen
v_mfma_f32_16x16x32_bf16 v[148:151], a[160:163], v[68:71], v[148:151]
v_mfma_f32_16x16x32_bf16 v[168:171], a[160:163], v[72:75], v[168:171]
v_mfma_f32_16x16x32_bf16 v[188:191], a[160:163], v[76:79], v[188:191]
v_mfma_f32_16x16x32_bf16 v[132:135], a[164:167], v[64:67], v[132:135]
buffer_load_dwordx4 v[116:119], v57, s[24:27], s99 offen
v_mfma_f32_16x16x32_bf16 v[152:155], a[164:167], v[68:71], v[152:155]
v_mfma_f32_16x16x32_bf16 v[172:175], a[164:167], v[72:75], v[172:175]
v_mfma_f32_16x16x32_bf16 v[192:195], a[164:167], v[76:79], v[192:195]
v_mfma_f32_16x16x32_bf16 v[136:139], a[168:171], v[64:67], v[136:139]
buffer_load_dwordx4 v[120:123], v58, s[24:27], s99 offen
v_mfma_f32_16x16x32_bf16 v[156:159], a[168:171], v[68:71], v[156:159]
v_mfma_f32_16x16x32_bf16 v[176:179], a[168:171], v[72:75], v[176:179]
v_mfma_f32_16x16x32_bf16 v[196:199], a[168:171], v[76:79], v[196:199]
v_mfma_f32_16x16x32_bf16 v[140:143], a[172:175], v[64:67], v[140:143]
buffer_load_dwordx4 v[124:127], v59, s[24:27], s99 offen
v_mfma_f32_16x16x32_bf16 v[160:163], a[172:175], v[68:71], v[160:163]
v_mfma_f32_16x16x32_bf16 v[180:183], a[172:175], v[72:75], v[180:183]
v_mfma_f32_16x16x32_bf16 v[200:203], a[172:175], v[76:79], v[200:203]
v_mfma_f32_16x16x32_bf16 v[144:147], a[176:179], v[64:67], v[144:147]
s_add_u32 s99, s99, 4096
v_mfma_f32_16x16x32_bf16 v[164:167], a[176:179], v[68:71], v[164:167]
v_mfma_f32_16x16x32_bf16 v[184:187], a[176:179], v[72:75], v[184:187]
v_mfma_f32_16x16x32_bf16 v[204:207], a[176:179], v[76:79], v[204:207]
s_waitcnt vmcnt(12)
v_cmp_eq_u32 vcc, 0, v254
s_cbranch_vccnz L_slow_19
L_back_20:
v_lshrrev_b32 v2, 3, v1
v_and_b32 v3, 7, v1
v_lshlrev_b32 v3, 4, v3
v_lshl_add_u32 v61, v2, 12, v3
s_mul_i32 s6, s95, 80
s_lshl_b32 s7, s5, 3
s_add_u32 s6, s6, s7
s_lshl_b32 s6, s6, 12
s_lshl_b32 s7, s94, 7
s_add_u32 s6, s6, s7
s_add_u32 s6, s6, 4194304
s_lshl_b32 s7, s5, 10
s_add_u32 s7, s7, 61440
s_mov_b32 m0, s7
s_add_u32 s7, s7, 4096
buffer_load_dwordx4 v61, s[24:27], s6 offen lds
s_add_u32 s6, s6, 131072
s_mov_b32 m0, s7
s_add_u32 s7, s7, 4096
buffer_load_dwordx4 v61, s[24:27], s6 offen lds
s_add_u32 s6, s6, 131072
s_cmp_ge_u32 s5, 2
s_cbranch_scc1 L_y2skip_21
s_mov_b32 m0, s7
s_add_u32 s7, s7, 4096
buffer_load_dwordx4 v61, s[24:27], s6 offen lds
s_add_u32 s6, s6, 131072
L_y2skip_21:
s_waitcnt vmcnt(10)
v_mfma_f32_16x16x32_bf16 v[128:131], a[180:183], v[80:83], v[128:131]
buffer_load_dwordx4 v[64:67], v56, s[24:27], s99 offen
v_mfma_f32_16x16x32_bf16 v[148:151], a[180:183], v[84:87], v[148:151]
v_mfma_f32_16x16x32_bf16 v[168:171], a[180:183], v[88:91], v[168:171]
v_mfma_f32_16x16x32_bf16 v[188:191], a[180:183], v[92:95], v[188:191]
v_mfma_f32_16x16x32_bf16 v[132:135], a[184:187], v[80:83], v[132:135]
buffer_load_dwordx4 v[68:71], v57, s[24:27], s99 offen
v_mfma_f32_16x16x32_bf16 v[152:155], a[184:187], v[84:87], v[152:155]
v_mfma_f32_16x16x32_bf16 v[172:175], a[184:187], v[88:91], v[172:175]
v_mfma_f32_16x16x32_bf16 v[192:195], a[184:187], v[92:95], v[192:195]
v_mfma_f32_16x16x32_bf16 v[136:139], a[188:191], v[80:83], v[136:139]
buffer_load_dwordx4 v[72:75], v58, s[24:27], s99 offen
v_mfma_f32_16x16x32_bf16 v[156:159], a[188:191], v[84:87], v[156:159]
v_mfma_f32_16x16x32_bf16 v[176:179], a[188:191], v[88:91], v[176:179]
v_mfma_f32_16x16x32_bf16 v[196:199], a[188:191], v[92:95], v[196:199]
v_mfma_f32_16x16x32_bf16 v[140:143], a[192:195], v[80:83], v[140:143]
buffer_load_dwordx4 v[76:79], v59, s[24:27], s99 offen
v_mfma_f32_16x16x32_bf16 v[160:163], a[192:195], v[84:87], v[160:163]
v_mfma_f32_16x16x32_bf16 v[180:183], a[192:195], v[88:91], v[180:183]
v_mfma_f32_16x16x32_bf16 v[200:203], a[192:195], v[92:95], v[200:203]
v_mfma_f32_16x16x32_bf16 v[144:147], a[196:199], v[80:83], v[144:147]
s_add_u32 s99, s99, 4096
v_mfma_f32_16x16x32_bf16 v[164:167], a[196:199], v[84:87], v[164:167]
v_mfma_f32_16x16x32_bf16 v[184:187], a[196:199], v[88:91], v[184:187]
v_mfma_f32_16x16x32_bf16 v[204:207], a[196:199], v[92:95], v[204:207]
s_waitcnt vmcnt(10)
v_mfma_f32_16x16x32_bf16 v[128:131], a[200:203], v[96:99], v[128:131]
buffer_load_dwordx4 v[80:83], v56, s[24:27], s99 offen
v_mfma_f32_16x16x32_bf16 v[148:151], a[200:203], v[100:103], v[148:151]
v_mfma_f32_16x16x32_bf16 v[168:171], a[200:203], v[104:107], v[168:171]
v_mfma_f32_16x16x32_bf16 v[188:191], a[200:203], v[108:111], v[188:191]
v_mfma_f32_16x16x32_bf16 v[132:135], a[204:207], v[96:99], v[132:135]
buffer_load_dwordx4 v[84:87], v57, s[24:27], s99 offen
v_mfma_f32_16x16x32_bf16 v[152:155], a[204:207], v[100:103], v[152:155]
v_mfma_f32_16x16x32_bf16 v[172:175], a[204:207], v[104:107], v[172:175]
v_mfma_f32_16x16x32_bf16 v[192:195], a[204:207], v[108:111], v[192:195]
v_mfma_f32_16x16x32_bf16 v[136:139], a[208:211], v[96:99], v[136:139]
buffer_load_dwordx4 v[88:91], v58, s[24:27], s99 offen
v_mfma_f32_16x16x32_bf16 v[156:159], a[208:211], v[100:103], v[156:159]
v_mfma_f32_16x16x32_bf16 v[176:179], a[208:211], v[104:107], v[176:179]
v_mfma_f32_16x16x32_bf16 v[196:199], a[208:211], v[108:111], v[196:199]
v_mfma_f32_16x16x32_bf16 v[140:143], a[212:215], v[96:99], v[140:143]
buffer_load_dwordx4 v[92:95], v59, s[24:27], s99 offen
v_mfma_f32_16x16x32_bf16 v[160:163], a[212:215], v[100:103], v[160:163]
v_mfma_f32_16x16x32_bf16 v[180:183], a[212:215], v[104:107], v[180:183]
v_mfma_f32_16x16x32_bf16 v[200:203], a[212:215], v[108:111], v[200:203]
v_mfma_f32_16x16x32_bf16 v[144:147], a[216:219], v[96:99], v[144:147]
s_add_u32 s99, s99, 4096
v_mfma_f32_16x16x32_bf16 v[164:167], a[216:219], v[100:103], v[164:167]
v_mfma_f32_16x16x32_bf16 v[184:187], a[216:219], v[104:107], v[184:187]
v_mfma_f32_16x16x32_bf16 v[204:207], a[216:219], v[108:111], v[204:207]
s_waitcnt vmcnt(10)
v_mfma_f32_16x16x32_bf16 v[128:131], a[220:223], v[112:115], v[128:131]
v_mfma_f32_16x16x32_bf16 v[148:151], a[220:223], v[116:119], v[148:151]
v_mfma_f32_16x16x32_bf16 v[168:171], a[220:223], v[120:123], v[168:171]
v_mfma_f32_16x16x32_bf16 v[188:191], a[220:223], v[124:127], v[188:191]
v_mfma_f32_16x16x32_bf16 v[132:135], a[224:227], v[112:115], v[132:135]
v_mfma_f32_16x16x32_bf16 v[152:155], a[224:227], v[116:119], v[152:155]
v_mfma_f32_16x16x32_bf16 v[172:175], a[224:227], v[120:123], v[172:175]
v_mfma_f32_16x16x32_bf16 v[192:195], a[224:227], v[124:127], v[192:195]
v_mfma_f32_16x16x32_bf16 v[136:139], a[228:231], v[112:115], v[136:139]
v_mfma_f32_16x16x32_bf16 v[156:159], a[228:231], v[116:119], v[156:159]
v_mfma_f32_16x16x32_bf16 v[176:179], a[228:231], v[120:123], v[176:179]
v_mfma_f32_16x16x32_bf16 v[196:199], a[228:231], v[124:127], v[196:199]
v_mfma_f32_16x16x32_bf16 v[140:143], a[232:235], v[112:115], v[140:143]
v_mfma_f32_16x16x32_bf16 v[160:163], a[232:235], v[116:119], v[160:163]
v_mfma_f32_16x16x32_bf16 v[180:183], a[232:235], v[120:123], v[180:183]
v_mfma_f32_16x16x32_bf16 v[200:203], a[232:235], v[124:127], v[200:203]
v_mfma_f32_16x16x32_bf16 v[144:147], a[236:239], v[112:115], v[144:147]
v_mfma_f32_16x16x32_bf16 v[164:167], a[236:239], v[116:119], v[164:167]
v_mfma_f32_16x16x32_bf16 v[184:187], a[236:239], v[120:123], v[184:187]
v_mfma_f32_16x16x32_bf16 v[204:207], a[236:239], v[124:127], v[204:207]
s_waitcnt vmcnt(4)
v_mfma_f32_16x16x32_bf16 v[128:131], v[208:211], v[64:67], v[128:131]
v_mfma_f32_16x16x32_bf16 v[148:151], v[208:211], v[68:71], v[148:151]
v_mfma_f32_16x16x32_bf16 v[168:171], v[208:211], v[72:75], v[168:171]
v_mfma_f32_16x16x32_bf16 v[188:191], v[208:211], v[76:79], v[188:191]
v_mfma_f32_16x16x32_bf16 v[132:135], v[212:215], v[64:67], v[132:135]
v_mfma_f32_16x16x32_bf16 v[152:155], v[212:215], v[68:71], v[152:155]
v_mfma_f32_16x16x32_bf16 v[172:175], v[212:215], v[72:75], v[172:175]
v_mfma_f32_16x16x32_bf16 v[192:195], v[212:215], v[76:79], v[192:195]
v_mfma_f32_16x16x32_bf16 v[136:139], v[216:219], v[64:67], v[136:139]
v_mfma_f32_16x16x32_bf16 v[156:159], v[216:219], v[68:71], v[156:159]
v_mfma_f32_16x16x32_bf16 v[176:179], v[216:219], v[72:75], v[176:179]
v_mfma_f32_16x16x32_bf16 v[196:199], v[216:219], v[76:79], v[196:199]
v_mfma_f32_16x16x32_bf16 v[140:143], v[220:223], v[64:67], v[140:143]
v_mfma_f32_16x16x32_bf16 v[160:163], v[220:223], v[68:71], v[160:163]
v_mfma_f32_16x16x32_bf16 v[180:183], v[220:223], v[72:75], v[180:183]
v_mfma_f32_16x16x32_bf16 v[200:203], v[220:223], v[76:79], v[200:203]
v_mfma_f32_16x16x32_bf16 v[144:147], v[224:227], v[64:67], v[144:147]
v_mfma_f32_16x16x32_bf16 v[164:167], v[224:227], v[68:71], v[164:167]
v_mfma_f32_16x16x32_bf16 v[184:187], v[224:227], v[72:75], v[184:187]
v_mfma_f32_16x16x32_bf16 v[204:207], v[224:227], v[76:79], v[204:207]
s_cmp_ge_u32 s5, 2
s_cbranch_scc1 L_g2skip_17
s_waitcnt vmcnt(0)
v_mfma_f32_16x16x32_bf16 v[128:131], v[228:231], v[80:83], v[128:131]
v_mfma_f32_16x16x32_bf16 v[148:151], v[228:231], v[84:87], v[148:151]
v_mfma_f32_16x16x32_bf16 v[168:171], v[228:231], v[88:91], v[168:171]
v_mfma_f32_16x16x32_bf16 v[188:191], v[228:231], v[92:95], v[188:191]
v_mfma_f32_16x16x32_bf16 v[132:135], v[232:235], v[80:83], v[132:135]
v_mfma_f32_16x16x32_bf16 v[152:155], v[232:235], v[84:87], v[152:155]
v_mfma_f32_16x16x32_bf16 v[172:175], v[232:235], v[88:91], v[172:175]
v_mfma_f32_16x16x32_bf16 v[192:195], v[232:235], v[92:95], v[192:195]
v_mfma_f32_16x16x32_bf16 v[136:139], v[236:239], v[80:83], v[136:139]
v_mfma_f32_16x16x32_bf16 v[156:159], v[236:239], v[84:87], v[156:159]
v_mfma_f32_16x16x32_bf16 v[176:179], v[236:239], v[88:91], v[176:179]
v_mfma_f32_16x16x32_bf16 v[196:199], v[236:239], v[92:95], v[196:199]
v_mfma_f32_16x16x32_bf16 v[140:143], v[240:243], v[80:83], v[140:143]
v_mfma_f32_16x16x32_bf16 v[160:163], v[240:243], v[84:87], v[160:163]
v_mfma_f32_16x16x32_bf16 v[180:183], v[240:243], v[88:91], v[180:183]
v_mfma_f32_16x16x32_bf16 v[200:203], v[240:243], v[92:95], v[200:203]
v_mfma_f32_16x16x32_bf16 v[144:147], v[244:247], v[80:83], v[144:147]
v_mfma_f32_16x16x32_bf16 v[164:167], v[244:247], v[84:87], v[164:167]
v_mfma_f32_16x16x32_bf16 v[184:187], v[244:247], v[88:91], v[184:187]
v_mfma_f32_16x16x32_bf16 v[204:207], v[244:247], v[92:95], v[204:207]
L_g2skip_17:
s_mul_i32 s6, s5, 15360
s_add_u32 s6, s6, 0
v_add_u32 v62, s6, v248
s_add_u32 s6, s5, 1
s_and_b32 s6, s6, 3
s_mul_i32 s6, s6, 15360
s_add_u32 s6, s6, 0
v_add_u32 v57, s6, v248
s_add_u32 s6, s5, 2
s_and_b32 s6, s6, 3
s_mul_i32 s6, s6, 15360
s_add_u32 s6, s6, 5120
v_add_u32 v58, s6, v248
s_add_u32 s6, s5, 3
s_and_b32 s6, s6, 3
s_mul_i32 s6, s6, 15360
s_add_u32 s6, s6, 10240
v_add_u32 v59, s6, v248
s_nop 4
ds_write_b128 v57, v[148:151] offset:0
ds_write_b128 v57, v[152:155] offset:1024
ds_write_b128 v57, v[156:159] offset:2048
ds_write_b128 v57, v[160:163] offset:3072
ds_write_b128 v57, v[164:167] offset:4096
ds_write_b128 v58, v[168:171] offset:0
ds_write_b128 v58, v[172:175] offset:1024
ds_write_b128 v58, v[176:179] offset:2048
ds_write_b128 v58, v[180:183] offset:3072
ds_write_b128 v58, v[184:187] offset:4096
ds_write_b128 v59, v[188:191] offset:0
ds_write_b128 v59, v[192:195] offset:1024
ds_write_b128 v59, v[196:199] offset:2048
ds_write_b128 v59, v[200:203] offset:3072
ds_write_b128 v59, v[204:207] offset:4096
v_lshrrev_b32 v3, 4, v1
v_mul_u32_u24 v3, 20, v3
v_bfe_u32 v4, v1, 2, 2
v_add_u32 v3, v3, v4
v_lshlrev_b32 v3, 7, v3
v_and_b32 v4, 3, v1
v_lshl_add_u32 v3, v4, 4, v3
s_and_b32 s6, s5, 1
s_lshl_b32 s6, s6, 6
s_lshr_b32 s7, s5, 1
s_lshl_b32 s7, s7, 3
s_add_u32 s6, s6, s7
s_add_u32 s6, s6, 61440
v_add_u32 v63, s6, v3
s_waitcnt vmcnt(0) lgkmcnt(0)
s_barrier
ds_read_b128 v[64:67], v62 offset:0
ds_read_b128 v[68:71], v62 offset:1024
ds_read_b128 v[72:75], v62 offset:2048
ds_read_b128 v[76:79], v62 offset:3072
ds_read_b128 v[80:83], v62 offset:4096
ds_read_b128 v[84:87], v62 offset:5120
ds_read_b128 v[88:91], v62 offset:6144
ds_read_b128 v[92:95], v62 offset:7168
ds_read_b128 v[96:99], v62 offset:8192
ds_read_b128 v[100:103], v62 offset:9216
ds_read_b128 v[104:107], v62 offset:10240
ds_read_b128 v[108:111], v62 offset:11264
ds_read_b128 v[112:115], v62 offset:12288
ds_read_b128 v[116:119], v62 offset:13312
ds_read_b128 v[120:123], v62 offset:14336
ds_read_b64_tr_b16 v[36:37], v63 offset:0
ds_read_b64_tr_b16 v[38:39], v63 offset:512
ds_read_b64_tr_b16 v[40:41], v63 offset:1024
ds_read_b64_tr_b16 v[42:43], v63 offset:1536
ds_read_b64_tr_b16 v[44:45], v63 offset:2048
v_mul_f32 v46, v32, v33
v_sub_f32 v46, 0, v46
v_mov_b32 v47, v33
v_mov_b32 v48, -1.4426950408889634
v_mov_b32 v49, 1.0
s_waitcnt lgkmcnt(15)
v_pk_add_f32 v[128:129], v[128:129], v[64:65]
v_pk_add_f32 v[130:131], v[130:131], v[66:67]
v_pk_add_f32 v[132:133], v[132:133], v[68:69]
v_pk_add_f32 v[134:135], v[134:135], v[70:71]
v_pk_add_f32 v[136:137], v[136:137], v[72:73]
v_pk_add_f32 v[138:139], v[138:139], v[74:75]
v_pk_add_f32 v[140:141], v[140:141], v[76:77]
v_pk_add_f32 v[142:143], v[142:143], v[78:79]
v_pk_add_f32 v[144:145], v[144:145], v[80:81]
v_pk_add_f32 v[146:147], v[146:147], v[82:83]
s_waitcnt lgkmcnt(10)
v_pk_add_f32 v[128:129], v[128:129], v[84:85]
v_pk_add_f32 v[130:131], v[130:131], v[86:87]
v_pk_add_f32 v[132:133], v[132:133], v[88:89]
v_pk_add_f32 v[134:135], v[134:135], v[90:91]
v_pk_add_f32 v[136:137], v[136:137], v[92:93]
v_pk_add_f32 v[138:139], v[138:139], v[94:95]
v_pk_add_f32 v[140:141], v[140:141], v[96:97]
v_pk_add_f32 v[142:143], v[142:143], v[98:99]
v_pk_add_f32 v[144:145], v[144:145], v[100:101]
v_pk_add_f32 v[146:147], v[146:147], v[102:103]
s_waitcnt lgkmcnt(5)
v_pk_add_f32 v[128:129], v[128:129], v[104:105]
v_pk_add_f32 v[130:131], v[130:131], v[106:107]
v_pk_add_f32 v[132:133], v[132:133], v[108:109]
v_pk_add_f32 v[134:135], v[134:135], v[110:111]
v_pk_add_f32 v[136:137], v[136:137], v[112:113]
v_pk_add_f32 v[138:139], v[138:139], v[114:115]
v_pk_add_f32 v[140:141], v[140:141], v[116:117]
v_pk_add_f32 v[142:143], v[142:143], v[118:119]
v_pk_add_f32 v[144:145], v[144:145], v[120:121]
v_pk_add_f32 v[146:147], v[146:147], v[122:123]
s_waitcnt lgkmcnt(0)
v_lshlrev_b32 v64, 16, v20
v_and_b32 v65, 0xffff0000, v20
v_lshlrev_b32 v66, 16, v21
v_and_b32 v67, 0xffff0000, v21
v_lshlrev_b32 v68, 16, v22
v_and_b32 v69, 0xffff0000, v22
v_lshlrev_b32 v70, 16, v23
v_and_b32 v71, 0xffff0000, v23
v_lshlrev_b32 v72, 16, v24
v_and_b32 v73, 0xffff0000, v24
v_pk_add_f32 v[128:129], v[128:129], v[64:65]
v_pk_add_f32 v[130:131], v[130:131], v[66:67]
v_pk_add_f32 v[132:133], v[132:133], v[68:69]
v_pk_add_f32 v[134:135], v[134:135], v[70:71]
v_pk_add_f32 v[136:137], v[136:137], v[72:73]
v_pk_mul_f32 v[64:65], v[128:129], v[48:49] op_sel_hi:[1,0]
v_pk_mul_f32 v[66:67], v[130:131], v[48:49] op_sel_hi:[1,0]
v_pk_mul_f32 v[68:69], v[132:133], v[48:49] op_sel_hi:[1,0]
v_pk_mul_f32 v[70:71], v[134:135], v[48:49] op_sel_hi:[1,0]
v_pk_mul_f32 v[72:73], v[136:137], v[48:49] op_sel_hi:[1,0]
v_exp_f32 v64, v64
v_exp_f32 v65, v65
v_exp_f32 v66, v66
v_exp_f32 v67, v67
v_exp_f32 v68, v68
v_exp_f32 v69, v69
v_exp_f32 v70, v70
v_exp_f32 v71, v71
v_exp_f32 v72, v72
v_exp_f32 v73, v73
v_lshlrev_b32 v74, 16, v8
v_and_b32 v75, 0xffff0000, v8
v_lshlrev_b32 v76, 16, v9
v_and_b32 v77, 0xffff0000, v9
v_lshlrev_b32 v78, 16, v10
v_and_b32 v79, 0xffff0000, v10
v_lshlrev_b32 v80, 16, v11
v_and_b32 v81, 0xffff0000, v11
v_lshlrev_b32 v82, 16, v12
v_and_b32 v83, 0xffff0000, v12
v_pk_add_f32 v[64:65], v[64:65], v[48:49] op_sel:[0,1] op_sel_hi:[1,1]
v_pk_add_f32 v[66:67], v[66:67], v[48:49] op_sel:[0,1] op_sel_hi:[1,1]
v_pk_add_f32 v[68:69], v[68:69], v[48:49] op_sel:[0,1] op_sel_hi:[1,1]
v_pk_add_f32 v[70:71], v[70:71], v[48:49] op_sel:[0,1] op_sel_hi:[1,1]
v_pk_add_f32 v[72:73], v[72:73], v[48:49] op_sel:[0,1] op_sel_hi:[1,1]
v_rcp_f32 v64, v64
v_rcp_f32 v65, v65
v_rcp_f32 v66, v66
v_rcp_f32 v67, v67
v_rcp_f32 v68, v68
v_rcp_f32 v69, v69
v_rcp_f32 v70, v70
v_rcp_f32 v71, v71
v_rcp_f32 v72, v72
v_rcp_f32 v73, v73
v_lshlrev_b32 v84, 16, v36
v_and_b32 v85, 0xffff0000, v36
v_lshlrev_b32 v86, 16, v37
v_and_b32 v87, 0xffff0000, v37
v_lshlrev_b32 v88, 16, v38
v_and_b32 v89, 0xffff0000, v38
v_lshlrev_b32 v90, 16, v39
v_and_b32 v91, 0xffff0000, v39
v_lshlrev_b32 v92, 16, v40
v_and_b32 v93, 0xffff0000, v40
v_pk_mul_f32 v[64:65], v[64:65], v[128:129]
v_pk_mul_f32 v[66:67], v[66:67], v[130:131]
v_pk_mul_f32 v[68:69], v[68:69], v[132:133]
v_pk_mul_f32 v[70:71], v[70:71], v[134:135]
v_pk_mul_f32 v[72:73], v[72:73], v[136:137]
v_pk_fma_f32 v[128:129], v[74:75], v[46:47], v[46:47] op_sel:[0,1,0] op_sel_hi:[1,1,0]
v_pk_fma_f32 v[130:131], v[76:77], v[46:47], v[46:47] op_sel:[0,1,0] op_sel_hi:[1,1,0]
v_pk_fma_f32 v[132:133], v[78:79], v[46:47], v[46:47] op_sel:[0,1,0] op_sel_hi:[1,1,0]
v_pk_fma_f32 v[134:135], v[80:81], v[46:47], v[46:47] op_sel:[0,1,0] op_sel_hi:[1,1,0]
v_pk_fma_f32 v[136:137], v[82:83], v[46:47], v[46:47] op_sel:[0,1,0] op_sel_hi:[1,1,0]
v_pk_mul_f32 v[128:129], v[128:129], v[84:85]
v_pk_mul_f32 v[130:131], v[130:131], v[86:87]
v_pk_mul_f32 v[132:133], v[132:133], v[88:89]
v_pk_mul_f32 v[134:135], v[134:135], v[90:91]
v_pk_mul_f32 v[136:137], v[136:137], v[92:93]
v_pk_fma_f32 v[128:129], v[128:129], v[64:65], v[74:75]
v_pk_fma_f32 v[130:131], v[130:131], v[66:67], v[76:77]
v_pk_fma_f32 v[132:133], v[132:133], v[68:69], v[78:79]
v_pk_fma_f32 v[134:135], v[134:135], v[70:71], v[80:81]
v_pk_fma_f32 v[136:137], v[136:137], v[72:73], v[82:83]
v_cvt_pk_bf16_f32 v100, v128, v129
v_cvt_pk_bf16_f32 v101, v130, v131
v_cvt_pk_bf16_f32 v102, v132, v133
v_cvt_pk_bf16_f32 v103, v134, v135
v_cvt_pk_bf16_f32 v104, v136, v137
v_lshlrev_b32 v64, 16, v25
v_and_b32 v65, 0xffff0000, v25
v_lshlrev_b32 v66, 16, v26
v_and_b32 v67, 0xffff0000, v26
v_lshlrev_b32 v68, 16, v27
v_and_b32 v69, 0xffff0000, v27
v_lshlrev_b32 v70, 16, v28
v_and_b32 v71, 0xffff0000, v28
v_lshlrev_b32 v72, 16, v29
v_and_b32 v73, 0xffff0000, v29
v_pk_add_f32 v[138:139], v[138:139], v[64:65]
v_pk_add_f32 v[140:141], v[140:141], v[66:67]
v_pk_add_f32 v[142:143], v[142:143], v[68:69]
v_pk_add_f32 v[144:145], v[144:145], v[70:71]
v_pk_add_f32 v[146:147], v[146:147], v[72:73]
v_pk_mul_f32 v[64:65], v[138:139], v[48:49] op_sel_hi:[1,0]
v_pk_mul_f32 v[66:67], v[140:141], v[48:49] op_sel_hi:[1,0]
v_pk_mul_f32 v[68:69], v[142:143], v[48:49] op_sel_hi:[1,0]
v_pk_mul_f32 v[70:71], v[144:145], v[48:49] op_sel_hi:[1,0]
v_pk_mul_f32 v[72:73], v[146:147], v[48:49] op_sel_hi:[1,0]
v_exp_f32 v64, v64
v_exp_f32 v65, v65
v_exp_f32 v66, v66
v_exp_f32 v67, v67
v_exp_f32 v68, v68
v_exp_f32 v69, v69
v_exp_f32 v70, v70
v_exp_f32 v71, v71
v_exp_f32 v72, v72
v_exp_f32 v73, v73
v_lshlrev_b32 v74, 16, v13
v_and_b32 v75, 0xffff0000, v13
v_lshlrev_b32 v76, 16, v14
v_and_b32 v77, 0xffff0000, v14
v_lshlrev_b32 v78, 16, v15
v_and_b32 v79, 0xffff0000, v15
v_lshlrev_b32 v80, 16, v16
v_and_b32 v81, 0xffff0000, v16
v_lshlrev_b32 v82, 16, v17
v_and_b32 v83, 0xffff0000, v17
v_pk_add_f32 v[64:65], v[64:65], v[48:49] op_sel:[0,1] op_sel_hi:[1,1]
v_pk_add_f32 v[66:67], v[66:67], v[48:49] op_sel:[0,1] op_sel_hi:[1,1]
v_pk_add_f32 v[68:69], v[68:69], v[48:49] op_sel:[0,1] op_sel_hi:[1,1]
v_pk_add_f32 v[70:71], v[70:71], v[48:49] op_sel:[0,1] op_sel_hi:[1,1]
v_pk_add_f32 v[72:73], v[72:73], v[48:49] op_sel:[0,1] op_sel_hi:[1,1]
v_rcp_f32 v64, v64
v_rcp_f32 v65, v65
v_rcp_f32 v66, v66
v_rcp_f32 v67, v67
v_rcp_f32 v68, v68
v_rcp_f32 v69, v69
v_rcp_f32 v70, v70
v_rcp_f32 v71, v71
v_rcp_f32 v72, v72
v_rcp_f32 v73, v73
v_lshlrev_b32 v84, 16, v41
v_and_b32 v85, 0xffff0000, v41
v_lshlrev_b32 v86, 16, v42
v_and_b32 v87, 0xffff0000, v42
v_lshlrev_b32 v88, 16, v43
v_and_b32 v89, 0xffff0000, v43
v_lshlrev_b32 v90, 16, v44
v_and_b32 v91, 0xffff0000, v44
v_lshlrev_b32 v92, 16, v45
v_and_b32 v93, 0xffff0000, v45
v_pk_mul_f32 v[64:65], v[64:65], v[138:139]
v_pk_mul_f32 v[66:67], v[66:67], v[140:141]
v_pk_mul_f32 v[68:69], v[68:69], v[142:143]
v_pk_mul_f32 v[70:71], v[70:71], v[144:145]
v_pk_mul_f32 v[72:73], v[72:73], v[146:147]
v_pk_fma_f32 v[138:139], v[74:75], v[46:47], v[46:47] op_sel:[0,1,0] op_sel_hi:[1,1,0]
v_pk_fma_f32 v[140:141], v[76:77], v[46:47], v[46:47] op_sel:[0,1,0] op_sel_hi:[1,1,0]
v_pk_fma_f32 v[142:143], v[78:79], v[46:47], v[46:47] op_sel:[0,1,0] op_sel_hi:[1,1,0]
v_pk_fma_f32 v[144:145], v[80:81], v[46:47], v[46:47] op_sel:[0,1,0] op_sel_hi:[1,1,0]
v_pk_fma_f32 v[146:147], v[82:83], v[46:47], v[46:47] op_sel:[0,1,0] op_sel_hi:[1,1,0]
v_pk_mul_f32 v[138:139], v[138:139], v[84:85]
v_pk_mul_f32 v[140:141], v[140:141], v[86:87]
v_pk_mul_f32 v[142:143], v[142:143], v[88:89]
v_pk_mul_f32 v[144:145], v[144:145], v[90:91]
v_pk_mul_f32 v[146:147], v[146:147], v[92:93]
v_pk_fma_f32 v[138:139], v[138:139], v[64:65], v[74:75]
v_pk_fma_f32 v[140:141], v[140:141], v[66:67], v[76:77]
v_pk_fma_f32 v[142:143], v[142:143], v[68:69], v[78:79]
v_pk_fma_f32 v[144:145], v[144:145], v[70:71], v[80:81]
v_pk_fma_f32 v[146:147], v[146:147], v[72:73], v[82:83]
v_cvt_pk_bf16_f32 v105, v138, v139
v_cvt_pk_bf16_f32 v106, v140, v141
v_cvt_pk_bf16_f32 v107, v142, v143
v_cvt_pk_bf16_f32 v108, v144, v145
v_cvt_pk_bf16_f32 v109, v146, v147
buffer_store_dwordx4 v[100:103], v60, s[28:31], 0 offen
buffer_store_dwordx4 v[104:107], v60, s[28:31], 0 offen offset:16
buffer_store_dwordx2 v[108:109], v60, s[28:31], 0 offen offset:32
L_end:
s_endpgm
L_two_12:
s_waitcnt lgkmcnt(0)
ds_read_b128 v[128:131], v10 offset:240
ds_read_b128 v[132:135], v10 offset:176
ds_read_b128 v[136:139], v10 offset:112
ds_read_b128 v[140:143], v10 offset:48
s_and_b32 s6, s91, 1
s_lshl_b32 s6, s6, 4
s_lshr_b32 s92, s92, s6
s_lshl_b32 s92, s92, 16
s_lshl_b32 s6, s91, 12
s_add_u32 s6, s6, 4194304
s_nop 4
s_waitcnt lgkmcnt(0)
v_lshlrev_b32 v131, 16, v131
v_fma_f32 v176, v131, s92, v176
v_lshlrev_b32 v130, 16, v130
v_fma_f32 v177, v130, s92, v177
v_lshlrev_b32 v129, 16, v129
v_fma_f32 v178, v129, s92, v178
v_lshlrev_b32 v128, 16, v128
v_fma_f32 v179, v128, s92, v179
v_lshlrev_b32 v135, 16, v135
v_fma_f32 v180, v135, s92, v180
v_lshlrev_b32 v134, 16, v134
v_fma_f32 v181, v134, s92, v181
v_lshlrev_b32 v133, 16, v133
v_fma_f32 v182, v133, s92, v182
v_lshlrev_b32 v132, 16, v132
v_fma_f32 v183, v132, s92, v183
v_lshlrev_b32 v139, 16, v139
v_fma_f32 v184, v139, s92, v184
v_lshlrev_b32 v138, 16, v138
v_fma_f32 v185, v138, s92, v185
v_lshlrev_b32 v137, 16, v137
v_fma_f32 v186, v137, s92, v186
v_lshlrev_b32 v136, 16, v136
v_fma_f32 v187, v136, s92, v187
v_lshlrev_b32 v143, 16, v143
v_fma_f32 v188, v143, s92, v188
v_lshlrev_b32 v142, 16, v142
v_fma_f32 v189, v142, s92, v189
v_lshlrev_b32 v141, 16, v141
v_fma_f32 v190, v141, s92, v190
v_lshlrev_b32 v140, 16, v140
v_fma_f32 v191, v140, s92, v191
v_cvt_pk_bf16_f32 v160, v176, v177
v_cvt_pk_bf16_f32 v161, v178, v179
v_cvt_pk_bf16_f32 v162, v180, v181
v_cvt_pk_bf16_f32 v163, v182, v183
buffer_store_dwordx4 v[160:163], v11, s[24:27], s6 offen offset:0 sc1
v_cvt_pk_bf16_f32 v164, v184, v185
v_cvt_pk_bf16_f32 v165, v186, v187
v_cvt_pk_bf16_f32 v166, v188, v189
v_cvt_pk_bf16_f32 v167, v190, v191
buffer_store_dwordx4 v[164:167], v11, s[24:27], s6 offen offset:128 sc1
s_cmp_eq_u32 s87, 3
s_cselect_b32 s85, s85, s87
s_cselect_b64 vcc, -1, 0
v_mov_b32 v2, 2147418112
v_cndmask_b32 v11, v11, v2, vcc
s_mul_i32 s6, s85, 30208
s_add_u32 s6, s6, 63488
v_add_u32 v8, s6, v16
s_add_u32 s6, s6, 17536
v_add_u32 v9, s6, v17
v_lshlrev_b32 v10, 5, v18
v_sub_u32 v10, v9, v10
v_add_u32 v10, 2176, v10
s_add_u32 s91, s88, s85
s_lshl_b32 s6, s91, 1
s_and_b32 s6, s6, 0xfffffffc
s_load_dword s92, s[50:51], s6
ds_read_b128 v[128:131], v8 offset:2048
ds_read_b128 v[132:135], v8 offset:2112
ds_read_b128 v[136:139], v8 offset:2176
ds_read_b128 v[140:143], v8 offset:2240
ds_read_b128 v[144:147], v8 offset:2304
ds_read_b128 v[148:151], v8 offset:2368
ds_read_b128 v[152:155], v8 offset:2432
ds_read_b128 v[156:159], v8 offset:2496
ds_read_b128 v[160:163], v9 offset:2176
ds_read_b128 v[164:167], v9 offset:2240
ds_read_b128 v[168:171], v9 offset:2304
v_mov_b32 v176, 0
v_mov_b32 v177, 0
v_mov_b32 v178, 0
v_mov_b32 v179, 0
v_mov_b32 v180, 0
v_mov_b32 v181, 0
v_mov_b32 v182, 0
v_mov_b32 v183, 0
v_mov_b32 v184, 0
v_mov_b32 v185, 0
v_mov_b32 v186, 0
v_mov_b32 v187, 0
v_mov_b32 v188, 0
v_mov_b32 v189, 0
v_mov_b32 v190, 0
v_mov_b32 v191, 0
s_waitcnt lgkmcnt(0)
s_branch L_halfb_13
L_spare:
s_lshl_b32 s73, s3, 2
s_add_u32 s73, s73, s4
s_sub_u32 s73, s73, 28
s_mov_b32 s32, s46
s_and_b32 s33, s47, 0xffff
s_mov_b32 s34, 5120
s_mov_b32 s35, 0x20000
s_lshr_b32 s6, s4, 3
s_lshl_b32 s7, s3, 2
s_add_u32 s68, s6, s7
s_and_b32 s69, s4, 7
v_mul_u32_u24 v2, 26, v1
v_lshrrev_b32 v2, 8, v2
v_mul_u32_u24 v3, 10, v2
v_sub_u32 v3, v1, v3
s_lshl_b32 s6, s68, 6
s_lshl_b32 s7, s5, 4
s_add_u32 s6, s6, s7
s_mul_i32 s6, s6, 1280
s_mul_i32 s7, s69, 160
s_add_u32 s6, s6, s7
v_mul_u32_u24 v4, 5120, v2
v_lshl_add_u32 v4, v3, 4, v4
v_add_u32 v4, s6, v4
v_subrev_u32 v5, 3840, v4
s_mul_i32 s7, s69, 640
v_lshlrev_b32 v6, 6, v3
v_add_u32 v6, s7, v6
s_mov_b32 exec_hi, 0xff
buffer_load_dwordx4 v[8:11], v5, s[12:15], 0 offen offset:0
buffer_load_dwordx4 v[12:15], v5, s[12:15], 0 offen offset:1280
buffer_load_dwordx4 v[16:19], v5, s[12:15], 0 offen offset:2560
buffer_load_dwordx4 v[20:23], v4, s[12:15], 0 offen offset:0
buffer_load_dwordx4 v[24:27], v4, s[12:15], 0 offen offset:1280
buffer_load_dwordx4 v[28:31], v4, s[12:15], 0 offen offset:2560
buffer_load_dwordx4 v[32:35], v4, s[12:15], 0 offen offset:3840
buffer_load_dwordx4 v[52:55], v6, s[32:35], 0 offen offset:0
buffer_load_dwordx4 v[56:59], v6, s[32:35], 0 offen offset:16
buffer_load_dwordx4 v[60:63], v6, s[32:35], 0 offen offset:32
buffer_load_dwordx4 v[64:67], v6, s[32:35], 0 offen offset:48
buffer_load_dwordx4 v[36:39], v4, s[16:19], 0 offen offset:0
buffer_load_dwordx4 v[40:43], v4, s[16:19], 0 offen offset:1280
buffer_load_dwordx4 v[44:47], v4, s[16:19], 0 offen offset:2560
buffer_load_dwordx4 v[48:51], v4, s[16:19], 0 offen offset:3840
s_lshl_b32 s7, s5, 5
s_sub_u32 s7, 131192, s7
v_mul_u32_u24 v7, 1152, v3
v_lshlrev_b32 v2, 3, v2
v_sub_u32 v7, v7, v2
v_add_u32 v7, s7, v7
s_mov_b64 exec, -1
s_lshr_b32 s6, s3, 1
s_lshl_b32 s6, s6, 2
s_and_b32 s7, s4, 3
s_add_u32 s77, s6, s7
s_and_b32 s6, s3, 1
s_mul_i32 s6, s6, 7
s_lshr_b32 s7, s4, 2
s_add_u32 s78, s6, s7
s_and_b32 s82, s5, 1
s_lshr_b32 s83, s5, 1
s_lshl_b32 s6, s3, 4
s_lshr_b32 s7, s4, 1
s_add_u32 s6, s6, s7
s_mul_i32 s6, s6, 5
s_and_b32 s89, s4, 1
s_lshl_b32 s7, s89, 1
s_add_u32 s88, s6, s7
s_lshr_b32 s6, s3, 1
s_lshl_b32 s6, s6, 3
s_and_b32 s7, s4, 7
s_add_u32 s94, s6, s7
s_and_b32 s6, s3, 1
s_lshl_b32 s6, s6, 2
s_lshr_b32 s7, s4, 3
s_add_u32 s95, s6, s7
s_mul_i32 s96, s5, 14
s_cmp_eq_u32 s5, 3
s_cselect_b32 s6, 1, 0
s_sub_u32 s96, s96, s6
v_min_u32 v2, 53, v1
v_lshlrev_b32 v2, 2, v2
s_lshr_b32 s43, s95, 1
v_add_u32 v2, s43, v2
v_lshlrev_b32 v2, 7, v2
v_add_u32 v228, 0, v2
s_lshl_b32 s6, s77, 1
v_and_b32 v4, 1, v1
v_add_u32 v4, s6, v4
v_and_b32 v5, 3, v4
v_add_u32 v5, 28, v5
v_lshrrev_b32 v4, 2, v4
v_lshl_add_u32 v4, v5, 3, v4
v_lshlrev_b32 v4, 7, v4
v_add_u32 v231, 4, v4
v_and_b32 v2, 31, v1
v_and_b32 v3, 7, v2
v_lshrrev_b32 v2, 3, v2
v_lshlrev_b32 v2, 3, v2
v_add_u32 v2, s3, v2
v_lshl_add_u32 v2, v2, 3, v3
v_lshlrev_b32 v229, 7, v2
v_cmp_gt_u32 vcc, 14, v1
v_cndmask_b32 v2, 0, v1, vcc
v_cmp_lt_u32 vcc, 6, v2
v_cndmask_b32 v3, 0, 1, vcc
v_mul_u32_u24 v4, 7, v3
v_sub_u32 v2, v2, v4
s_lshr_b32 s6, s94, 1
s_and_b32 s7, s6, 3
s_lshr_b32 s6, s6, 2
s_lshl_b32 s6, s6, 1
v_lshlrev_b32 v2, 2, v2
v_add_u32 v2, s7, v2
v_add_u32 v3, s6, v3
v_lshl_add_u32 v2, v2, 3, v3
v_lshlrev_b32 v2, 7, v2
v_add_u32 v249, 16, v2
v_and_b32 v2, 31, v1
v_lshlrev_b32 v2, 3, v2
v_add_u32 v2, s95, v2
v_lshlrev_b32 v2, 7, v2
v_add_u32 v250, 20, v2
v_mov_b32 v2, 2147418112
s_cmp_lg_u32 s5, 0
s_cselect_b64 vcc, -1, 0
v_cndmask_b32 v228, v228, v2, vcc
v_cndmask_b32 v229, v229, v2, vcc
v_cndmask_b32 v231, v231, v2, vcc
v_cndmask_b32 v230, v230, v2, vcc
s_lshl_b32 s6, s73, 6
s_lshl_b32 s7, s5, 4
s_add_u32 s74, s6, s7
v_and_b32 v2, 15, v1
v_lshrrev_b32 v3, 4, v1
v_add_u32 v4, s74, v2
v_mul_u32_u24 v4, 1280, v4
v_lshl_add_u32 v211, v3, 4, v4
s_waitcnt vmcnt(4)
s_cmp_lg_u32 s5, 0
s_cbranch_scc1 L_arr_22
s_and_b32 s6, s2, 7
s_lshl_b32 s6, s6, 5
v_mov_b32 v2, s6
s_mov_b64 exec, 1
buffer_atomic_add v253, v2, s[52:55], 0 offen sc1
s_mov_b64 exec, -1
L_arr_22:
v_lshlrev_b32 v68, 16, v52
v_lshlrev_b32 v69, 16, v54
v_and_b32 v76, 0xffff0000, v52
v_and_b32 v77, 0xffff0000, v54
v_lshlrev_b32 v84, 16, v53
v_lshlrev_b32 v85, 16, v55
buffer_load_dwordx4 a[0:3], v211, s[8:11], 0 offen offset:0
v_and_b32 v92, 0xffff0000, v53
v_and_b32 v93, 0xffff0000, v55
v_lshlrev_b32 v70, 16, v56
v_lshlrev_b32 v71, 16, v58
v_and_b32 v78, 0xffff0000, v56
v_and_b32 v79, 0xffff0000, v58
buffer_load_dwordx4 a[4:7], v211, s[8:11], 0 offen offset:64
v_lshlrev_b32 v86, 16, v57
v_lshlrev_b32 v87, 16, v59
v_and_b32 v94, 0xffff0000, v57
v_and_b32 v95, 0xffff0000, v59
v_lshlrev_b32 v72, 16, v60
v_lshlrev_b32 v73, 16, v62
buffer_load_dwordx4 a[8:11], v211, s[8:11], 0 offen offset:128
v_and_b32 v80, 0xffff0000, v60
v_and_b32 v81, 0xffff0000, v62
v_lshlrev_b32 v88, 16, v61
v_lshlrev_b32 v89, 16, v63
v_and_b32 v96, 0xffff0000, v61
v_and_b32 v97, 0xffff0000, v63
buffer_load_dwordx4 a[12:15], v211, s[8:11], 0 offen offset:192
v_lshlrev_b32 v74, 16, v64
v_lshlrev_b32 v75, 16, v66
v_and_b32 v82, 0xffff0000, v64
v_and_b32 v83, 0xffff0000, v66
v_lshlrev_b32 v90, 16, v65
v_lshlrev_b32 v91, 16, v67
buffer_load_dwordx4 a[16:19], v211, s[8:11], 0 offen offset:256
v_and_b32 v98, 0xffff0000, v65
v_and_b32 v99, 0xffff0000, v67
s_waitcnt vmcnt(5)
v_lshlrev_b32 v100, 16, v8
v_and_b32 v101, 0xffff0000, v8
v_lshlrev_b32 v102, 16, v12
v_and_b32 v103, 0xffff0000, v12
v_lshlrev_b32 v104, 16, v16
v_and_b32 v105, 0xffff0000, v16
buffer_load_dwordx4 a[20:23], v211, s[8:11], 0 offen offset:320
v_lshlrev_b32 v106, 16, v20
v_and_b32 v107, 0xffff0000, v20
v_lshlrev_b32 v108, 16, v24
v_and_b32 v109, 0xffff0000, v24
v_lshlrev_b32 v110, 16, v28
v_and_b32 v111, 0xffff0000, v28
buffer_load_dwordx4 a[24:27], v211, s[8:11], 0 offen offset:384
v_lshlrev_b32 v112, 16, v32
v_and_b32 v113, 0xffff0000, v32
v_lshlrev_b32 v114, 16, v36
v_and_b32 v115, 0xffff0000, v36
v_lshlrev_b32 v116, 16, v40
v_and_b32 v117, 0xffff0000, v40
buffer_load_dwordx4 a[28:31], v211, s[8:11], 0 offen offset:448
v_lshlrev_b32 v118, 16, v44
v_and_b32 v119, 0xffff0000, v44
v_lshlrev_b32 v120, 16, v48
v_and_b32 v121, 0xffff0000, v48
v_pk_mul_f32 v[122:123], v[106:107], v[68:69]
v_pk_mul_f32 v[124:125], v[108:109], v[68:69]
buffer_load_dwordx4 a[32:35], v211, s[8:11], 0 offen offset:512
v_pk_mul_f32 v[126:127], v[110:111], v[68:69]
v_pk_mul_f32 v[128:129], v[112:113], v[68:69]
v_pk_fma_f32 v[122:123], v[104:105], v[76:77], v[122:123]
v_pk_fma_f32 v[124:125], v[106:107], v[76:77], v[124:125]
v_pk_fma_f32 v[126:127], v[108:109], v[76:77], v[126:127]
v_pk_fma_f32 v[128:129], v[110:111], v[76:77], v[128:129]
buffer_load_dwordx4 a[36:39], v211, s[8:11], 0 offen offset:576
v_pk_fma_f32 v[122:123], v[102:103], v[84:85], v[122:123]
v_pk_fma_f32 v[124:125], v[104:105], v[84:85], v[124:125]
v_pk_fma_f32 v[126:127], v[106:107], v[84:85], v[126:127]
v_pk_fma_f32 v[128:129], v[108:109], v[84:85], v[128:129]
v_pk_fma_f32 v[122:123], v[100:101], v[92:93], v[122:123]
v_pk_fma_f32 v[124:125], v[102:103], v[92:93], v[124:125]
buffer_load_dwordx4 a[40:43], v211, s[8:11], 0 offen offset:640
v_pk_fma_f32 v[126:127], v[104:105], v[92:93], v[126:127]
v_pk_fma_f32 v[128:129], v[106:107], v[92:93], v[128:129]
v_pk_mul_f32 v[122:123], v[122:123], v[114:115]
v_pk_mul_f32 v[124:125], v[124:125], v[116:117]
v_pk_mul_f32 v[126:127], v[126:127], v[118:119]
v_pk_mul_f32 v[128:129], v[128:129], v[120:121]
buffer_load_dwordx4 a[44:47], v211, s[8:11], 0 offen offset:704
s_mov_b32 exec_hi, 0xff
v_cvt_pk_bf16_f32 v100, v128, v126
v_cvt_pk_bf16_f32 v101, v124, v122
ds_write_b64 v7, v[100:101] offset:0
v_cvt_pk_bf16_f32 v102, v129, v127
v_cvt_pk_bf16_f32 v103, v125, v123
ds_write_b64 v7, v[102:103] offset:144
s_mov_b64 exec, -1
v_lshlrev_b32 v100, 16, v9
v_and_b32 v101, 0xffff0000, v9
v_lshlrev_b32 v102, 16, v13
v_and_b32 v103, 0xffff0000, v13
v_lshlrev_b32 v104, 16, v17
v_and_b32 v105, 0xffff0000, v17
buffer_load_dwordx4 a[48:51], v211, s[8:11], 0 offen offset:768
v_lshlrev_b32 v106, 16, v21
v_and_b32 v107, 0xffff0000, v21
v_lshlrev_b32 v108, 16, v25
v_and_b32 v109, 0xffff0000, v25
v_lshlrev_b32 v110, 16, v29
v_and_b32 v111, 0xffff0000, v29
buffer_load_dwordx4 a[52:55], v211, s[8:11], 0 offen offset:832
v_lshlrev_b32 v112, 16, v33
v_and_b32 v113, 0xffff0000, v33
v_lshlrev_b32 v114, 16, v37
v_and_b32 v115, 0xffff0000, v37
v_lshlrev_b32 v116, 16, v41
v_and_b32 v117, 0xffff0000, v41
buffer_load_dwordx4 a[56:59], v211, s[8:11], 0 offen offset:896
v_lshlrev_b32 v118, 16, v45
v_and_b32 v119, 0xffff0000, v45
v_lshlrev_b32 v120, 16, v49
v_and_b32 v121, 0xffff0000, v49
v_pk_mul_f32 v[122:123], v[106:107], v[70:71]
v_pk_mul_f32 v[124:125], v[108:109], v[70:71]
buffer_load_dwordx4 a[60:63], v211, s[8:11], 0 offen offset:960
v_pk_mul_f32 v[126:127], v[110:111], v[70:71]
v_pk_mul_f32 v[128:129], v[112:113], v[70:71]
v_pk_fma_f32 v[122:123], v[104:105], v[78:79], v[122:123]
v_pk_fma_f32 v[124:125], v[106:107], v[78:79], v[124:125]
v_pk_fma_f32 v[126:127], v[108:109], v[78:79], v[126:127]
v_pk_fma_f32 v[128:129], v[110:111], v[78:79], v[128:129]
buffer_load_dwordx4 a[64:67], v211, s[8:11], 0 offen offset:1024
v_pk_fma_f32 v[122:123], v[102:103], v[86:87], v[122:123]
v_pk_fma_f32 v[124:125], v[104:105], v[86:87], v[124:125]
v_pk_fma_f32 v[126:127], v[106:107], v[86:87], v[126:127]
v_pk_fma_f32 v[128:129], v[108:109], v[86:87], v[128:129]
v_pk_fma_f32 v[122:123], v[100:101], v[94:95], v[122:123]
v_pk_fma_f32 v[124:125], v[102:103], v[94:95], v[124:125]
buffer_load_dwordx4 a[68:71], v211, s[8:11], 0 offen offset:1088
v_pk_fma_f32 v[126:127], v[104:105], v[94:95], v[126:127]
v_pk_fma_f32 v[128:129], v[106:107], v[94:95], v[128:129]
v_pk_mul_f32 v[122:123], v[122:123], v[114:115]
v_pk_mul_f32 v[124:125], v[124:125], v[116:117]
v_pk_mul_f32 v[126:127], v[126:127], v[118:119]
v_pk_mul_f32 v[128:129], v[128:129], v[120:121]
buffer_load_dwordx4 a[72:75], v211, s[8:11], 0 offen offset:1152
s_mov_b32 exec_hi, 0xff
v_cvt_pk_bf16_f32 v100, v128, v126
v_cvt_pk_bf16_f32 v101, v124, v122
ds_write_b64 v7, v[100:101] offset:288
v_cvt_pk_bf16_f32 v102, v129, v127
v_cvt_pk_bf16_f32 v103, v125, v123
ds_write_b64 v7, v[102:103] offset:432
s_mov_b64 exec, -1
v_lshlrev_b32 v100, 16, v10
v_and_b32 v101, 0xffff0000, v10
v_lshlrev_b32 v102, 16, v14
v_and_b32 v103, 0xffff0000, v14
v_lshlrev_b32 v104, 16, v18
v_and_b32 v105, 0xffff0000, v18
buffer_load_dwordx4 a[76:79], v211, s[8:11], 0 offen offset:1216
v_lshlrev_b32 v106, 16, v22
v_and_b32 v107, 0xffff0000, v22
v_lshlrev_b32 v108, 16, v26
v_and_b32 v109, 0xffff0000, v26
v_lshlrev_b32 v110, 16, v30
v_and_b32 v111, 0xffff0000, v30
v_lshlrev_b32 v112, 16, v34
v_and_b32 v113, 0xffff0000, v34
v_lshlrev_b32 v114, 16, v38
v_and_b32 v115, 0xffff0000, v38
v_lshlrev_b32 v116, 16, v42
v_and_b32 v117, 0xffff0000, v42
v_lshlrev_b32 v118, 16, v46
v_and_b32 v119, 0xffff0000, v46
v_lshlrev_b32 v120, 16, v50
v_and_b32 v121, 0xffff0000, v50
v_pk_mul_f32 v[122:123], v[106:107], v[72:73]
v_pk_mul_f32 v[124:125], v[108:109], v[72:73]
v_pk_mul_f32 v[126:127], v[110:111], v[72:73]
v_pk_mul_f32 v[128:129], v[112:113], v[72:73]
v_pk_fma_f32 v[122:123], v[104:105], v[80:81], v[122:123]
v_pk_fma_f32 v[124:125], v[106:107], v[80:81], v[124:125]
v_pk_fma_f32 v[126:127], v[108:109], v[80:81], v[126:127]
v_pk_fma_f32 v[128:129], v[110:111], v[80:81], v[128:129]
v_pk_fma_f32 v[122:123], v[102:103], v[88:89], v[122:123]
v_pk_fma_f32 v[124:125], v[104:105], v[88:89], v[124:125]
v_pk_fma_f32 v[126:127], v[106:107], v[88:89], v[126:127]
v_pk_fma_f32 v[128:129], v[108:109], v[88:89], v[128:129]
v_pk_fma_f32 v[122:123], v[100:101], v[96:97], v[122:123]
v_pk_fma_f32 v[124:125], v[102:103], v[96:97], v[124:125]
v_pk_fma_f32 v[126:127], v[104:105], v[96:97], v[126:127]
v_pk_fma_f32 v[128:129], v[106:107], v[96:97], v[128:129]
v_pk_mul_f32 v[122:123], v[122:123], v[114:115]
v_pk_mul_f32 v[124:125], v[124:125], v[116:117]
v_pk_mul_f32 v[126:127], v[126:127], v[118:119]
v_pk_mul_f32 v[128:129], v[128:129], v[120:121]
s_mov_b32 exec_hi, 0xff
v_cvt_pk_bf16_f32 v100, v128, v126
v_cvt_pk_bf16_f32 v101, v124, v122
ds_write_b64 v7, v[100:101] offset:576
v_cvt_pk_bf16_f32 v102, v129, v127
v_cvt_pk_bf16_f32 v103, v125, v123
ds_write_b64 v7, v[102:103] offset:720
s_mov_b64 exec, -1
v_lshlrev_b32 v100, 16, v11
v_and_b32 v101, 0xffff0000, v11
v_lshlrev_b32 v102, 16, v15
v_and_b32 v103, 0xffff0000, v15
v_lshlrev_b32 v104, 16, v19
v_and_b32 v105, 0xffff0000, v19
v_lshlrev_b32 v106, 16, v23
v_and_b32 v107, 0xffff0000, v23
v_lshlrev_b32 v108, 16, v27
v_and_b32 v109, 0xffff0000, v27
v_lshlrev_b32 v110, 16, v31
v_and_b32 v111, 0xffff0000, v31
v_lshlrev_b32 v112, 16, v35
v_and_b32 v113, 0xffff0000, v35
v_lshlrev_b32 v114, 16, v39
v_and_b32 v115, 0xffff0000, v39
v_lshlrev_b32 v116, 16, v43
v_and_b32 v117, 0xffff0000, v43
v_lshlrev_b32 v118, 16, v47
v_and_b32 v119, 0xffff0000, v47
v_lshlrev_b32 v120, 16, v51
v_and_b32 v121, 0xffff0000, v51
v_pk_mul_f32 v[122:123], v[106:107], v[74:75]
v_pk_mul_f32 v[124:125], v[108:109], v[74:75]
v_pk_mul_f32 v[126:127], v[110:111], v[74:75]
v_pk_mul_f32 v[128:129], v[112:113], v[74:75]
v_pk_fma_f32 v[122:123], v[104:105], v[82:83], v[122:123]
v_pk_fma_f32 v[124:125], v[106:107], v[82:83], v[124:125]
v_pk_fma_f32 v[126:127], v[108:109], v[82:83], v[126:127]
v_pk_fma_f32 v[128:129], v[110:111], v[82:83], v[128:129]
v_pk_fma_f32 v[122:123], v[102:103], v[90:91], v[122:123]
v_pk_fma_f32 v[124:125], v[104:105], v[90:91], v[124:125]
v_pk_fma_f32 v[126:127], v[106:107], v[90:91], v[126:127]
v_pk_fma_f32 v[128:129], v[108:109], v[90:91], v[128:129]
v_pk_fma_f32 v[122:123], v[100:101], v[98:99], v[122:123]
v_pk_fma_f32 v[124:125], v[102:103], v[98:99], v[124:125]
v_pk_fma_f32 v[126:127], v[104:105], v[98:99], v[126:127]
v_pk_fma_f32 v[128:129], v[106:107], v[98:99], v[128:129]
v_pk_mul_f32 v[122:123], v[122:123], v[114:115]
v_pk_mul_f32 v[124:125], v[124:125], v[116:117]
v_pk_mul_f32 v[126:127], v[126:127], v[118:119]
v_pk_mul_f32 v[128:129], v[128:129], v[120:121]
s_mov_b32 exec_hi, 0xff
v_cvt_pk_bf16_f32 v100, v128, v126
v_cvt_pk_bf16_f32 v101, v124, v122
ds_write_b64 v7, v[100:101] offset:864
v_cvt_pk_bf16_f32 v102, v129, v127
v_cvt_pk_bf16_f32 v103, v125, v123
ds_write_b64 v7, v[102:103] offset:1008
s_mov_b64 exec, -1
v_lshrrev_b32 v2, 3, v1
s_mul_i32 s6, s5, 20
v_add_u32 v2, s6, v2
v_and_b32 v3, 7, v1
v_lshlrev_b32 v3, 4, v3
v_mul_u32_u24 v4, 144, v2
v_add_u32 v4, v4, v3
v_add_u32 v4, 131072, v4
v_lshl_add_u32 v5, v2, 12, v3
s_mul_i32 s6, s69, 327680
s_lshl_b32 s7, s68, 7
s_sub_u32 s6, s6, s7
s_add_u32 s70, s6, 1052544
s_add_u32 s71, s70, 32768
s_add_u32 s72, s70, 65536
s_waitcnt lgkmcnt(0)
s_barrier
ds_read_b128 v[8:11], v4
ds_read_b128 v[12:15], v4 offset:1152
ds_read_b128 v[16:19], v4 offset:2304
s_waitcnt lgkmcnt(2)
buffer_store_dwordx4 v[8:11], v5, s[24:27], s70 offen sc1
s_waitcnt lgkmcnt(1)
buffer_store_dwordx4 v[12:15], v5, s[24:27], s71 offen sc1
s_waitcnt lgkmcnt(0)
s_mov_b32 exec_hi, 0
buffer_store_dwordx4 v[16:19], v5, s[24:27], s72 offen sc1
s_mov_b64 exec, -1
v_mov_b32 v214, 0x3f803f80
v_mov_b32 v215, 0x3f803f80
v_mov_b32 v216, 0x3f803f80
v_mov_b32 v217, 0x3f803f80
v_mov_b32 v218, 0
v_mov_b32 v219, 0
v_mov_b32 v220, 0
v_mov_b32 v221, 0
v_mov_b32 v222, 0
v_mov_b32 v223, 0
v_mov_b32 v224, 0
v_mov_b32 v225, 0
s_waitcnt vmcnt(22)
v_mfma_f32_16x16x32_bf16 v[218:221], a[0:3], a[0:3], v[218:221]
v_mfma_f32_16x16x32_bf16 v[222:225], a[0:3], v[214:217], v[222:225]
s_waitcnt vmcnt(21)
v_mfma_f32_16x16x32_bf16 v[218:221], a[4:7], a[4:7], v[218:221]
v_mfma_f32_16x16x32_bf16 v[222:225], a[4:7], v[214:217], v[222:225]
s_waitcnt vmcnt(20)
v_mfma_f32_16x16x32_bf16 v[218:221], a[8:11], a[8:11], v[218:221]
v_mfma_f32_16x16x32_bf16 v[222:225], a[8:11], v[214:217], v[222:225]
s_waitcnt vmcnt(19)
v_mfma_f32_16x16x32_bf16 v[218:221], a[12:15], a[12:15], v[218:221]
v_mfma_f32_16x16x32_bf16 v[222:225], a[12:15], v[214:217], v[222:225]
s_waitcnt vmcnt(18)
v_mfma_f32_16x16x32_bf16 v[218:221], a[16:19], a[16:19], v[218:221]
v_mfma_f32_16x16x32_bf16 v[222:225], a[16:19], v[214:217], v[222:225]
s_waitcnt vmcnt(17)
v_mfma_f32_16x16x32_bf16 v[218:221], a[20:23], a[20:23], v[218:221]
v_mfma_f32_16x16x32_bf16 v[222:225], a[20:23], v[214:217], v[222:225]
s_waitcnt vmcnt(16)
v_mfma_f32_16x16x32_bf16 v[218:221], a[24:27], a[24:27], v[218:221]
v_mfma_f32_16x16x32_bf16 v[222:225], a[24:27], v[214:217], v[222:225]
s_waitcnt vmcnt(15)
v_mfma_f32_16x16x32_bf16 v[218:221], a[28:31], a[28:31], v[218:221]
v_mfma_f32_16x16x32_bf16 v[222:225], a[28:31], v[214:217], v[222:225]
s_waitcnt vmcnt(14)
v_mfma_f32_16x16x32_bf16 v[218:221], a[32:35], a[32:35], v[218:221]
v_mfma_f32_16x16x32_bf16 v[222:225], a[32:35], v[214:217], v[222:225]
s_waitcnt vmcnt(13)
v_mfma_f32_16x16x32_bf16 v[218:221], a[36:39], a[36:39], v[218:221]
v_mfma_f32_16x16x32_bf16 v[222:225], a[36:39], v[214:217], v[222:225]
s_waitcnt vmcnt(12)
v_mfma_f32_16x16x32_bf16 v[218:221], a[40:43], a[40:43], v[218:221]
v_mfma_f32_16x16x32_bf16 v[222:225], a[40:43], v[214:217], v[222:225]
s_waitcnt vmcnt(11)
v_mfma_f32_16x16x32_bf16 v[218:221], a[44:47], a[44:47], v[218:221]
v_mfma_f32_16x16x32_bf16 v[222:225], a[44:47], v[214:217], v[222:225]
s_waitcnt vmcnt(10)
v_mfma_f32_16x16x32_bf16 v[218:221], a[48:51], a[48:51], v[218:221]
v_mfma_f32_16x16x32_bf16 v[222:225], a[48:51], v[214:217], v[222:225]
s_waitcnt vmcnt(9)
v_mfma_f32_16x16x32_bf16 v[218:221], a[52:55], a[52:55], v[218:221]
v_mfma_f32_16x16x32_bf16 v[222:225], a[52:55], v[214:217], v[222:225]
s_waitcnt vmcnt(8)
v_mfma_f32_16x16x32_bf16 v[218:221], a[56:59], a[56:59], v[218:221]
v_mfma_f32_16x16x32_bf16 v[222:225], a[56:59], v[214:217], v[222:225]
s_waitcnt vmcnt(7)
v_mfma_f32_16x16x32_bf16 v[218:221], a[60:63], a[60:63], v[218:221]
v_mfma_f32_16x16x32_bf16 v[222:225], a[60:63], v[214:217], v[222:225]
s_waitcnt vmcnt(6)
v_mfma_f32_16x16x32_bf16 v[218:221], a[64:67], a[64:67], v[218:221]
v_mfma_f32_16x16x32_bf16 v[222:225], a[64:67], v[214:217], v[222:225]
s_waitcnt vmcnt(5)
v_mfma_f32_16x16x32_bf16 v[218:221], a[68:71], a[68:71], v[218:221]
v_mfma_f32_16x16x32_bf16 v[222:225], a[68:71], v[214:217], v[222:225]
s_waitcnt vmcnt(4)
v_mfma_f32_16x16x32_bf16 v[218:221], a[72:75], a[72:75], v[218:221]
v_mfma_f32_16x16x32_bf16 v[222:225], a[72:75], v[214:217], v[222:225]
s_waitcnt vmcnt(3)
v_mfma_f32_16x16x32_bf16 v[218:221], a[76:79], a[76:79], v[218:221]
v_mfma_f32_16x16x32_bf16 v[222:225], a[76:79], v[214:217], v[222:225]
v_and_b32 v5, 1, v1
v_cmp_eq_u32 vcc, 1, v5
v_and_b32 v5, 2, v1
v_cmp_eq_u32 s[6:7], 2, v5
s_nop 7
v_cndmask_b32 v2, v218, v219, vcc
v_cndmask_b32 v3, v220, v221, vcc
v_cndmask_b32 v4, v222, v223, vcc
v_cndmask_b32 v5, v224, v225, vcc
v_cndmask_b32 v2, v2, v3, s[6:7]
v_cndmask_b32 v3, v4, v5, s[6:7]
v_mul_f32 v214, 0.0015625, v3
v_mul_f32 v2, 0.0015625, v2
v_fma_f32 v2, -v214, v214, v2
v_max_f32 v2, 0, v2
v_add_f32 v2, 0x3727c5ac, v2
v_sqrt_f32 v216, v2
s_nop 0
v_rcp_f32 v215, v216
v_mov_b32 v217, 0
v_sub_f32 v3, 0, v214
v_cvt_pk_bf16_f32 v4, v216, v3
v_lshlrev_b32 v5, 16, v4
v_and_b32 v6, 0xffff0000, v4
v_sub_f32 v5, v216, v5
v_sub_f32 v6, v3, v6
v_cvt_pk_bf16_f32 v5, v5, v6
s_mov_b32 s6, 0x05040100
s_mov_b32 s7, 0x07060302
v_perm_b32 v218, v5, v4, s6
v_perm_b32 v219, v5, v4, s7
v_mov_b32 v220, v219
v_mov_b32 v221, 0
v_lshrrev_b32 v3, 4, v1
v_and_b32 v5, 3, v1
v_lshl_add_u32 v5, v3, 2, v5
v_add_u32 v5, s74, v5
v_lshlrev_b32 v5, 4, v5
s_mov_b32 s6, 65536
s_mov_b32 s7, 98304
s_mov_b32 exec_lo, 0x00f0000f
s_mov_b32 exec_hi, 0xf0000f00
buffer_store_dwordx4 v[218:221], v5, s[24:27], s6 offen sc1
buffer_store_dwordx4 v[214:217], v5, s[24:27], s7 offen sc1
s_mov_b64 exec, -1
s_waitcnt vmcnt(0)
s_barrier
s_cmp_lg_u32 s5, 0
s_cbranch_scc1 L_fl_23
s_mov_b64 exec, 1
buffer_store_dword v253, v252, s[24:27], 0 offen offset:0 sc1
s_mov_b64 exec, -1
L_fl_23:
s_cmp_lg_u32 s5, 0
s_cbranch_scc1 L_fl_24
s_mov_b64 exec, 1
buffer_store_dword v253, v252, s[24:27], 0 offen offset:4 sc1
s_mov_b64 exec, -1
L_fl_24:
buffer_load_dword v254, v230, s[52:55], 0 offen sc1
s_waitcnt vmcnt(0)
s_cmp_lg_u32 s5, 0
s_cbranch_scc1 L_back_26
v_cmp_gt_u32 vcc, 32, v254
s_cbranch_vccnz L_slow_25
L_back_26:
v_mov_b32 v60, 2147418112
s_mov_b32 s100, 0
s_mov_b32 s101, 0
s_lshl_b32 s6, s5, 2
v_lshlrev_b32 v202, 2, v1
v_add_u32 v202, s6, v202
v_subrev_u32 v202, 252, v202
v_add_u32 v203, s6, v248
v_add_u32 v203, 4, v203
s_mul_i32 s90, s5, 4416
s_add_u32 s6, s88, 0
s_lshl_b32 s6, s6, 12
s_add_u32 s32, s48, s6
s_addc_u32 s33, s49, 0
s_and_b32 s33, s33, 0xffff
s_mov_b32 s34, 4096
s_mov_b32 s35, 0x20000
s_add_u32 m0, s90, 65536
s_nop 0
buffer_load_dword v202, s[32:35], 0 offen lds
s_add_u32 m0, s90, 65792
s_nop 0
buffer_load_dwordx4 v203, s[32:35], 0 offen offset:0 lds
buffer_load_dwordx4 v203, s[32:35], 0 offen offset:1024 lds
buffer_load_dwordx4 v203, s[32:35], 0 offen offset:2048 lds
buffer_load_dwordx4 v203, s[32:35], 0 offen offset:3072 lds
s_add_u32 s6, s88, 1
s_lshl_b32 s6, s6, 12
s_add_u32 s32, s48, s6
s_addc_u32 s33, s49, 0
s_and_b32 s33, s33, 0xffff
s_mov_b32 s34, 4096
s_mov_b32 s35, 0x20000
s_add_u32 m0, s90, 95744
s_nop 0
buffer_load_dword v202, s[32:35], 0 offen lds
s_add_u32 m0, s90, 96000
s_nop 0
buffer_load_dwordx4 v203, s[32:35], 0 offen offset:0 lds
buffer_load_dwordx4 v203, s[32:35], 0 offen offset:1024 lds
buffer_load_dwordx4 v203, s[32:35], 0 offen offset:2048 lds
buffer_load_dwordx4 v203, s[32:35], 0 offen offset:3072 lds
s_add_u32 s6, s88, 2
s_lshl_b32 s6, s6, 12
s_add_u32 s32, s48, s6
s_addc_u32 s33, s49, 0
s_and_b32 s33, s33, 0xffff
s_mov_b32 s34, 4096
s_mov_b32 s35, 0x20000
s_add_u32 m0, s90, 125952
s_nop 0
buffer_load_dword v202, s[32:35], 0 offen lds
s_add_u32 m0, s90, 126208
s_nop 0
buffer_load_dwordx4 v203, s[32:35], 0 offen offset:0 lds
buffer_load_dwordx4 v203, s[32:35], 0 offen offset:1024 lds
buffer_load_dwordx4 v203, s[32:35], 0 offen offset:2048 lds
buffer_load_dwordx4 v203, s[32:35], 0 offen offset:3072 lds
buffer_load_dword v254, v228, s[24:27], 0 offen sc1
s_waitcnt vmcnt(0)
s_cmp_lg_u32 s5, 0
s_cbranch_scc1 L_back_28
v_cmp_eq_u32 vcc, 0, v254
s_cbranch_vccnz L_slow_27
L_back_28:
s_barrier
s_mul_i32 s6, s95, 54
s_add_u32 s6, s6, s96
s_mul_i32 s97, s6, 5120
s_add_u32 s97, s97, 7340032
s_add_u32 s98, s97, 4096
buffer_load_dwordx4 a[0:3], v248, s[24:27], s97 offen offset:0
buffer_load_dwordx4 a[4:7], v248, s[24:27], s97 offen offset:1024
buffer_load_dwordx4 a[8:11], v248, s[24:27], s97 offen offset:2048
buffer_load_dwordx4 a[12:15], v248, s[24:27], s97 offen offset:3072
buffer_load_dwordx4 a[16:19], v248, s[24:27], s98 offen
s_add_u32 s97, s97, 5120
s_add_u32 s98, s98, 5120
buffer_load_dwordx4 a[20:23], v248, s[24:27], s97 offen offset:0
buffer_load_dwordx4 a[24:27], v248, s[24:27], s97 offen offset:1024
buffer_load_dwordx4 a[28:31], v248, s[24:27], s97 offen offset:2048
buffer_load_dwordx4 a[32:35], v248, s[24:27], s97 offen offset:3072
buffer_load_dwordx4 a[36:39], v248, s[24:27], s98 offen
s_add_u32 s97, s97, 5120
s_add_u32 s98, s98, 5120
buffer_load_dwordx4 a[40:43], v248, s[24:27], s97 offen offset:0
buffer_load_dwordx4 a[44:47], v248, s[24:27], s97 offen offset:1024
buffer_load_dwordx4 a[48:51], v248, s[24:27], s97 offen offset:2048
buffer_load_dwordx4 a[52:55], v248, s[24:27], s97 offen offset:3072
buffer_load_dwordx4 a[56:59], v248, s[24:27], s98 offen
s_add_u32 s97, s97, 5120
s_add_u32 s98, s98, 5120
buffer_load_dwordx4 a[60:63], v248, s[24:27], s97 offen offset:0
buffer_load_dwordx4 a[64:67], v248, s[24:27], s97 offen offset:1024
buffer_load_dwordx4 a[68:71], v248, s[24:27], s97 offen offset:2048
buffer_load_dwordx4 a[72:75], v248, s[24:27], s97 offen offset:3072
buffer_load_dwordx4 a[76:79], v248, s[24:27], s98 offen
s_add_u32 s97, s97, 5120
s_add_u32 s98, s98, 5120
buffer_load_dwordx4 a[80:83], v248, s[24:27], s97 offen offset:0
buffer_load_dwordx4 a[84:87], v248, s[24:27], s97 offen offset:1024
buffer_load_dwordx4 a[88:91], v248, s[24:27], s97 offen offset:2048
buffer_load_dwordx4 a[92:95], v248, s[24:27], s97 offen offset:3072
buffer_load_dword v254, v229, s[24:27], 0 offen sc1
s_waitcnt vmcnt(0)
s_cmp_lg_u32 s5, 0
s_cbranch_scc1 L_back_30
v_cmp_eq_u32 vcc, 0, v254
s_cbranch_vccnz L_slow_29
L_back_30:
s_barrier
v_lshlrev_b32 v4, 4, v0
s_add_u32 s6, s88, 0
s_lshl_b32 s6, s6, 12
s_add_u32 s6, s6, 1048576
s_add_u32 s36, s66, s6
s_addc_u32 s37, s67, 0
s_and_b32 s37, s37, 0xffff
s_mov_b32 s38, 4096
s_mov_b32 s39, 0x20000
buffer_load_dwordx4 v[32:35], v4, s[36:39], 0 offen
buffer_load_dword v36, v4, s[36:39], 0 offen offset:16
s_add_u32 s6, s88, 1
s_lshl_b32 s6, s6, 12
s_add_u32 s6, s6, 1048576
s_add_u32 s36, s66, s6
s_addc_u32 s37, s67, 0
s_and_b32 s37, s37, 0xffff
s_mov_b32 s38, 4096
s_mov_b32 s39, 0x20000
buffer_load_dwordx4 v[38:41], v4, s[36:39], 0 offen
buffer_load_dword v42, v4, s[36:39], 0 offen offset:16
s_add_u32 s6, s88, 2
s_lshl_b32 s6, s6, 12
s_add_u32 s6, s6, 1048576
s_add_u32 s36, s66, s6
s_addc_u32 s37, s67, 0
s_and_b32 s37, s37, 0xffff
s_mov_b32 s38, 4096
s_mov_b32 s39, 0x20000
buffer_load_dwordx4 v[44:47], v4, s[36:39], 0 offen
buffer_load_dword v48, v4, s[36:39], 0 offen offset:16
v_lshlrev_b32 v5, 4, v0
v_add_u32 v5, 87552, v5
v_add_u32 v7, 60416, v5
v_mov_b32 v12, 0
v_mov_b32 v13, 0
v_mov_b32 v14, 0
v_mov_b32 v15, 0
v_cmp_gt_u32 vcc, 119, v0
s_and_saveexec_b64 s[6:7], vcc
ds_write_b128 v5, v[12:15] offset:0
ds_write_b128 v5, v[12:15] offset:6272
ds_write_b128 v5, v[12:15] offset:30208
ds_write_b128 v5, v[12:15] offset:36480
ds_write_b128 v7, v[12:15] offset:0
ds_write_b128 v7, v[12:15] offset:6272
s_mov_b64 exec, s[6:7]
v_lshrrev_b32 v4, 4, v0
v_mul_u32_u24 v4, 272, v4
v_and_b32 v5, 15, v0
v_lshl_add_u32 v4, v5, 4, v4
v_add_u32 v4, 83200, v4
v_add_u32 v6, 60416, v4
s_waitcnt vmcnt(0)
ds_write_b128 v4, v[32:35] offset:6272
v_alignbit_b32 v12, v33, v32, 16
v_alignbit_b32 v13, v34, v33, 16
v_alignbit_b32 v14, v35, v34, 16
v_alignbit_b32 v15, v36, v35, 16
ds_write_b128 v4, v[12:15] offset:0
ds_write_b128 v4, v[38:41] offset:36480
v_alignbit_b32 v12, v39, v38, 16
v_alignbit_b32 v13, v40, v39, 16
v_alignbit_b32 v14, v41, v40, 16
v_alignbit_b32 v15, v42, v41, 16
ds_write_b128 v4, v[12:15] offset:30208
ds_write_b128 v6, v[44:47] offset:6272
v_alignbit_b32 v12, v45, v44, 16
v_alignbit_b32 v13, v46, v45, 16
v_alignbit_b32 v14, v47, v46, 16
v_alignbit_b32 v15, v48, v47, 16
ds_write_b128 v6, v[12:15] offset:0
s_waitcnt vmcnt(0)
s_branch L_conv
L_slow_3:
s_add_u32 s42, s42, 1
s_cmp_gt_u32 s42, 200000
s_cbranch_scc1 L_back_4
buffer_load_dword v254, v230, s[52:55], 0 offen sc1
s_waitcnt vmcnt(0)
v_cmp_gt_u32 vcc, 32, v254
s_cbranch_vccnz L_slow_3
s_branch L_back_4
L_slow_5:
s_add_u32 s42, s42, 1
s_cmp_gt_u32 s42, 200000
s_cbranch_scc1 L_back_6
buffer_load_dword v254, v231, s[24:27], 0 offen sc1
s_waitcnt vmcnt(0)
v_cmp_eq_u32 vcc, 0, v254
s_cbranch_vccnz L_slow_5
s_branch L_back_6
L_slow_8:
s_add_u32 s42, s42, 1
s_cmp_gt_u32 s42, 200000
s_cbranch_scc1 L_back_9
buffer_load_dword v254, v228, s[24:27], 0 offen sc1
s_waitcnt vmcnt(0)
v_cmp_eq_u32 vcc, 0, v254
s_cbranch_vccnz L_slow_8
s_branch L_back_9
L_slow_10:
s_add_u32 s42, s42, 1
s_cmp_gt_u32 s42, 200000
s_cbranch_scc1 L_back_11
buffer_load_dword v251, v229, s[24:27], 0 offen sc1
s_waitcnt vmcnt(0)
v_cmp_eq_u32 vcc, 0, v251
s_cbranch_vccnz L_slow_10
s_branch L_back_11
L_slow_15:
s_add_u32 s42, s42, 1
s_cmp_gt_u32 s42, 200000
s_cbranch_scc1 L_back_16
buffer_load_dword v254, v249, s[24:27], 0 offen sc1
s_waitcnt vmcnt(0)
v_cmp_eq_u32 vcc, 0, v254
s_cbranch_vccnz L_slow_15
s_branch L_back_16
L_slow_19:
s_add_u32 s42, s42, 1
s_cmp_gt_u32 s42, 200000
s_cbranch_scc1 L_back_20
buffer_load_dword v254, v250, s[24:27], 0 offen sc1
s_waitcnt vmcnt(0)
v_cmp_eq_u32 vcc, 0, v254
s_cbranch_vccnz L_slow_19
s_branch L_back_20
L_slow_25:
s_add_u32 s42, s42, 1
s_cmp_gt_u32 s42, 200000
s_cbranch_scc1 L_back_26
buffer_load_dword v254, v230, s[52:55], 0 offen sc1
s_waitcnt vmcnt(0)
v_cmp_gt_u32 vcc, 32, v254
s_cbranch_vccnz L_slow_25
s_branch L_back_26
L_slow_27:
s_add_u32 s42, s42, 1
s_cmp_gt_u32 s42, 200000
s_cbranch_scc1 L_back_28
buffer_load_dword v254, v228, s[24:27], 0 offen sc1
s_waitcnt vmcnt(0)
v_cmp_eq_u32 vcc, 0, v254
s_cbranch_vccnz L_slow_27
s_branch L_back_28
L_slow_29:
s_add_u32 s42, s42, 1
s_cmp_gt_u32 s42, 200000
s_cbranch_scc1 L_back_30
buffer_load_dword v254, v229, s[24:27], 0 offen sc1
s_waitcnt vmcnt(0)
v_cmp_eq_u32 vcc, 0, v254
s_cbranch_vccnz L_slow_29
s_branch L_back_30
.section .rodata,"a"
.p2align 6
.amdhsa_kernel recurrent_scan__ssm_conv_h3__dense_activation_gelu__prompt_kernel
  .amdhsa_next_free_vgpr 512
  .amdhsa_next_free_sgpr 102
  .amdhsa_accum_offset 256
  .amdhsa_group_segment_fixed_size 0
  .amdhsa_kernarg_size 112
  .amdhsa_user_sgpr_count 2
  .amdhsa_user_sgpr_kernarg_segment_ptr 1
  .amdhsa_system_sgpr_workgroup_id_x 1
.end_amdhsa_kernel
```

```asm
; @launch grid=(256,1,1) block=(256,1,1) lds=163840
.amdgcn_target "amdgcn-amd-amdhsa--gfx950"
.text
.globl recurrent_scan__ssm_conv_h3__dense_activation_gelu__prompt_kernel
.p2align 8
.type recurrent_scan__ssm_conv_h3__dense_activation_gelu__prompt_kernel,@function
recurrent_scan__ssm_conv_h3__dense_activation_gelu__prompt_kernel:
s_cmp_ge_u32 s2, 256
s_cbranch_scc1 L_end
s_load_dwordx16 s[40:55], s[0:1], 0
s_load_dwordx8 s[56:63], s[0:1], 64
s_load_dwordx4 s[64:67], s[0:1], 96
s_and_b32 s3, s2, 7
s_lshr_b32 s4, s2, 3
v_lshrrev_b32 v1, 6, v0
v_and_b32 v0, 0xff, v0
v_mov_b32 v253, 1
v_readfirstlane_b32 s5, v1
v_and_b32 v1, 63, v0
s_lshl_b32 s6, s2, 7
v_mov_b32 v252, s6
v_lshlrev_b32 v248, 4, v1
v_and_b32 v230, 7, v1
v_lshlrev_b32 v230, 5, v230
v_mov_b32 v255, 0
s_cmp_ge_u32 s4, 28
s_cbranch_scc1 L_spare
s_lshr_b32 s6, s3, 1
s_lshl_b32 s6, s6, 2
s_and_b32 s7, s4, 3
s_add_u32 s77, s6, s7
s_and_b32 s6, s3, 1
s_mul_i32 s6, s6, 7
s_lshr_b32 s7, s4, 2
s_add_u32 s78, s6, s7
s_and_b32 s82, s5, 1
s_lshr_b32 s83, s5, 1
s_lshl_b32 s6, s3, 4
s_lshr_b32 s7, s4, 1
s_add_u32 s6, s6, s7
s_mul_i32 s6, s6, 5
s_and_b32 s89, s4, 1
s_lshl_b32 s7, s89, 1
s_add_u32 s88, s6, s7
s_lshr_b32 s6, s3, 1
s_lshl_b32 s6, s6, 3
s_and_b32 s7, s4, 7
s_add_u32 s94, s6, s7
s_and_b32 s6, s3, 1
s_lshl_b32 s6, s6, 2
s_lshr_b32 s7, s4, 3
s_add_u32 s95, s6, s7
s_mul_i32 s96, s5, 14
s_cmp_eq_u32 s5, 3
s_cselect_b32 s6, 1, 0
s_sub_u32 s96, s96, s6
s_lshr_b32 s6, s4, 3
s_lshl_b32 s7, s3, 2
s_add_u32 s68, s6, s7
s_and_b32 s69, s4, 7
v_mul_u32_u24 v2, 26, v1
v_lshrrev_b32 v2, 8, v2
v_mul_u32_u24 v3, 10, v2
v_sub_u32 v3, v1, v3
s_lshl_b32 s6, s68, 6
s_lshl_b32 s7, s5, 4
s_add_u32 s6, s6, s7
s_mul_i32 s6, s6, 1280
s_mul_i32 s7, s69, 160
s_add_u32 s6, s6, s7
v_mul_u32_u24 v4, 5120, v2
v_lshl_add_u32 v4, v3, 4, v4
v_add_u32 v244, s6, v4
v_subrev_u32 v245, 3840, v244
s_mul_i32 s7, s69, 640
v_lshlrev_b32 v4, 6, v3
v_add_u32 v247, s7, v4
s_lshl_b32 s7, s5, 5
s_sub_u32 s7, 131192, s7
v_mul_u32_u24 v4, 1152, v3
v_lshlrev_b32 v2, 3, v2
v_sub_u32 v4, v4, v2
v_add_u32 v202, s7, v4
v_lshrrev_b32 v2, 3, v1
s_mul_i32 s6, s5, 20
v_add_u32 v2, s6, v2
v_and_b32 v3, 7, v1
v_lshlrev_b32 v3, 4, v3
v_mul_u32_u24 v4, 144, v2
v_add_u32 v4, v4, v3
v_add_u32 v203, 131072, v4
v_lshl_add_u32 v172, v2, 12, v3
s_mul_i32 s6, s69, 327680
s_lshl_b32 s7, s68, 7
s_sub_u32 s6, s6, s7
s_add_u32 s70, s6, 1052544
s_add_u32 s71, s70, 32768
s_add_u32 s72, s70, 65536
s_lshl_b32 s79, s78, 8
s_mul_i32 s80, s77, 163840
s_lshl_b32 s81, s5, 12
v_lshrrev_b32 v2, 4, v1
v_and_b32 v3, 15, v1
v_lshlrev_b32 v4, 2, v2
v_xor_b32 v4, v3, v4
s_lshl_b32 s6, s5, 4
v_add_u32 v5, s6, v2
v_mul_u32_u24 v5, 3456, v5
v_lshl_add_u32 v208, v4, 4, v5
s_cmp_eq_u32 s78, 13
s_cselect_b32 s7, 8, 16
v_cmp_le_u32 vcc, s7, v4
v_mov_b32 v6, 2147418112
v_cndmask_b32 v208, v208, v6, vcc
v_add_u32 v209, 12800, v208
v_add_u32 v210, 25600, v208
v_add_u32 v211, 38400, v208
v_lshrrev_b32 v4, 3, v1
v_and_b32 v5, 7, v1
s_lshl_b32 s6, s5, 5
v_add_u32 v4, s6, v4
v_mul_u32_u24 v4, 1280, v4
v_add_u32 v6, 0, v2
v_xor_b32 v6, v5, v6
v_lshl_add_u32 v6, v6, 4, v4
v_add_u32 v212, 0, v6
v_add_u32 v6, 4, v2
v_xor_b32 v6, v5, v6
v_lshl_add_u32 v6, v6, 4, v4
v_add_u32 v213, 9216, v6
v_add_u32 v6, 0, v2
v_xor_b32 v6, v5, v6
v_lshl_add_u32 v6, v6, 4, v4
v_add_u32 v214, 18432, v6
v_add_u32 v6, 4, v2
v_xor_b32 v6, v5, v6
v_lshl_add_u32 v6, v6, 4, v4
v_add_u32 v215, 27648, v6
s_lshl_b32 s6, s4, 2
s_add_u32 s6, s6, s5
s_lshl_b32 s7, s6, 3
v_and_b32 v2, 7, v1
v_add_u32 v2, s7, v2
v_lshrrev_b32 v3, 3, v1
v_mul_u32_u24 v4, 4682, v2
v_lshrrev_b32 v4, 16, v4
v_mul_u32_u24 v5, 14, v4
v_sub_u32 v5, v2, v5
v_lshl_add_u32 v4, v3, 6, v4
v_mul_u32_u24 v4, 3456, v4
v_lshl_add_u32 v4, v5, 7, v4
s_and_b32 s7, s3, 1
s_mul_i32 s73, s7, 1792
v_add_u32 v4, s73, v4
s_sub_u32 s7, 13, s7
v_mov_b32 v6, 2147418112
v_cmp_lt_u32 vcc, s7, v5
v_cndmask_b32 v232, v4, v6, vcc
v_mul_u32_u24 v2, 52, v1
v_lshrrev_b32 v2, 8, v2
v_mul_u32_u24 v3, 5, v2
v_sub_u32 v3, v1, v3
s_mul_i32 s7, s6, 5
v_add_u32 v3, s7, v3
v_cmp_gt_u32 vcc, 512, v3
s_lshr_b32 s7, s3, 1
s_lshl_b32 s7, s7, 9
v_add_u32 v3, s7, v3
v_mul_u32_u24 v3, 1280, v3
v_lshl_add_u32 v3, v2, 7, v3
v_cndmask_b32 v233, v6, v3, vcc
s_lshl_b32 s6, s68, 6
s_lshl_b32 s7, s5, 4
s_add_u32 s6, s6, s7
s_mul_i32 s6, s6, 1280
s_mul_i32 s7, s69, 160
s_and_b32 s7, s7, 0xffffff80
s_add_u32 s6, s6, s7
v_lshrrev_b32 v2, 1, v1
v_mul_u32_u24 v2, 1280, v2
v_and_b32 v3, 1, v1
v_lshl_add_u32 v2, v3, 7, v2
v_add_u32 v129, s6, v2
v_subrev_u32 v128, 3840, v129
s_mul_i32 s7, s69, 640
v_lshlrev_b32 v2, 7, v1
v_add_u32 v130, s7, v2
s_waitcnt lgkmcnt(0)
s_mov_b32 s24, s66
s_and_b32 s25, s67, 0xffff
s_mov_b32 s26, 17825792
s_mov_b32 s27, 0x20000
s_lshl_b32 s6, s88, 1
s_and_b32 s6, s6, 0xfffffffc
s_load_dwordx2 s[0:1], s[50:51], s6
s_cmp_lg_u32 s5, 0
s_cbranch_scc1 L_clr_1
v_lshl_add_u32 v2, v1, 2, v252
v_mov_b32 v3, 0
s_mov_b64 exec, 0xff
buffer_store_dword v3, v2, s[24:27], 0 offen sc1
s_mov_b64 exec, -1
L_clr_1:
s_mov_b32 s12, s42
s_and_b32 s13, s43, 0xffff
s_mov_b32 s14, 2621440
s_mov_b32 s15, 0x20000
s_mov_b32 s16, s44
s_and_b32 s17, s45, 0xffff
s_mov_b32 s18, 2621440
s_mov_b32 s19, 0x20000
s_mov_b32 s32, s46
s_and_b32 s33, s47, 0xffff
s_mov_b32 s34, 5120
s_mov_b32 s35, 0x20000
s_mov_b32 exec_hi, 0xff
buffer_load_dwordx4 v[8:11], v245, s[12:15], 0 offen offset:0
buffer_load_dwordx4 v[12:15], v245, s[12:15], 0 offen offset:1280
buffer_load_dwordx4 v[16:19], v245, s[12:15], 0 offen offset:2560
buffer_load_dwordx4 v[20:23], v244, s[12:15], 0 offen offset:0
buffer_load_dwordx4 v[24:27], v244, s[12:15], 0 offen offset:1280
buffer_load_dwordx4 v[28:31], v244, s[12:15], 0 offen offset:2560
buffer_load_dwordx4 v[32:35], v244, s[12:15], 0 offen offset:3840
buffer_load_dwordx4 v[36:39], v247, s[32:35], 0 offen offset:0
buffer_load_dwordx4 v[40:43], v247, s[32:35], 0 offen offset:16
buffer_load_dwordx4 v[44:47], v247, s[32:35], 0 offen offset:32
buffer_load_dwordx4 v[48:51], v247, s[32:35], 0 offen offset:48
buffer_load_dwordx4 v[174:177], v244, s[16:19], 0 offen offset:0
buffer_load_dwordx4 v[178:181], v244, s[16:19], 0 offen offset:1280
buffer_load_dwordx4 v[182:185], v244, s[16:19], 0 offen offset:2560
buffer_load_dwordx4 v[186:189], v244, s[16:19], 0 offen offset:3840
s_mov_b64 exec, -1
s_mov_b32 s20, s54
s_and_b32 s21, s55, 0xffff
s_mov_b32 s22, 2211840
s_mov_b32 s23, 0x20000
s_mov_b32 s8, s40
s_and_b32 s9, s41, 0xffff
s_mov_b32 s10, 2621440
s_mov_b32 s11, 0x20000
s_mov_b32 exec_lo, 0xffffff
s_mov_b32 exec_hi, 0x0
buffer_load_dword v234, v232, s[20:23], 0 offen
s_mov_b64 exec, -1
s_mov_b32 exec_lo, 0x7fff
s_mov_b32 exec_hi, 0x0
buffer_load_dword v234, v233, s[8:11], 0 offen
s_mov_b64 exec, -1
s_add_u32 m0, s81, 0
s_nop 0
buffer_load_dwordx4 v208, s[20:23], s79 offen offset:0 lds
buffer_load_dwordx4 v209, s[20:23], s79 offen offset:1024 lds
buffer_load_dwordx4 v210, s[20:23], s79 offen offset:2048 lds
buffer_load_dwordx4 v211, s[20:23], s79 offen offset:3072 lds
s_add_u32 m0, s81, 16384
s_nop 0
buffer_load_dwordx4 v212, s[8:11], s80 offen offset:0 lds
buffer_load_dwordx4 v213, s[8:11], s80 offen offset:1024 lds
buffer_load_dwordx4 v214, s[8:11], s80 offen offset:2048 lds
buffer_load_dwordx4 v215, s[8:11], s80 offen offset:3072 lds
s_mov_b32 s28, s62
s_and_b32 s29, s63, 0xffff
s_mov_b32 s30, 2621440
s_mov_b32 s31, 0x20000
s_mov_b32 s52, s64
s_and_b32 s53, s65, 0xffff
s_mov_b32 s54, 256
s_mov_b32 s55, 0x20000
s_mov_b32 s42, 0
s_mov_b32 s36, s58
s_and_b32 s37, s59, 0xffff
s_mov_b32 s38, 2211840
s_mov_b32 s39, 0x20000
s_lshr_b32 s6, s2, 2
s_lshl_b32 s6, s6, 5
s_lshl_b32 s7, s5, 3
s_add_u32 s6, s6, s7
s_mul_i32 s6, s6, 1280
s_and_b32 s7, s2, 3
s_mul_i32 s7, s7, 320
s_add_u32 s6, s6, s7
s_cmp_lt_u32 s2, 216
s_cselect_b32 s6, s6, 2147418112
v_add_u32 v2, 0, v1
v_mul_u32_u24 v3, 205, v2
v_lshrrev_b32 v3, 12, v3
v_mul_u32_u24 v4, 20, v3
v_sub_u32 v2, v2, v4
v_mul_u32_u24 v3, 1280, v3
v_lshl_add_u32 v2, v2, 4, v3
v_add_u32 v2, s6, v2
v_subrev_u32 v204, 0, v2
v_add_u32 v2, 64, v1
v_mul_u32_u24 v3, 205, v2
v_lshrrev_b32 v3, 12, v3
v_mul_u32_u24 v4, 20, v3
v_sub_u32 v2, v2, v4
v_mul_u32_u24 v3, 1280, v3
v_lshl_add_u32 v2, v2, 4, v3
v_add_u32 v2, s6, v2
v_subrev_u32 v205, 1024, v2
v_add_u32 v2, 128, v1
v_mul_u32_u24 v3, 205, v2
v_lshrrev_b32 v3, 12, v3
v_mul_u32_u24 v4, 20, v3
v_sub_u32 v2, v2, v4
v_mul_u32_u24 v3, 1280, v3
v_lshl_add_u32 v2, v2, 4, v3
v_add_u32 v2, s6, v2
v_subrev_u32 v206, 2048, v2
s_mul_i32 s6, s5, 2560
s_add_u32 s74, s6, 142592
v_lshrrev_b32 v2, 4, v1
v_bfe_u32 v3, v1, 2, 2
v_lshrrev_b32 v4, 1, v2
v_lshlrev_b32 v4, 4, v4
v_and_b32 v2, 1, v2
v_lshl_add_u32 v2, v2, 2, v3
v_add_u32 v2, v2, v4
v_mul_u32_u24 v2, 320, v2
v_and_b32 v3, 3, v1
v_mul_u32_u24 v3, 40, v3
v_add_u32 v2, v2, v3
v_add_u32 v5, 142592, v2
s_and_b32 s6, s2, 3
s_lshl_b32 s6, s6, 1
s_mul_i32 s6, s6, 54
s_lshr_b32 s7, s2, 2
s_add_u32 s6, s6, s7
s_mul_i32 s84, s6, 5120
s_add_u32 s84, s84, 7340032
v_mov_b32 v207, 2147418112
s_cmp_lt_u32 s2, 216
s_cselect_b64 vcc, -1, 0
v_cndmask_b32 v207, v207, v248, vcc
s_add_u32 s6, s5, 0
s_cmp_ge_u32 s6, 5
s_cselect_b32 s7, 5, 0
s_cselect_b32 s43, 276480, 0
s_cselect_b32 s75, 160, 0
s_sub_u32 s6, s6, s7
s_lshl_b32 s7, s6, 3
s_add_u32 s75, s75, s7
v_add_u32 v200, s75, v5
s_lshl_b32 s6, s6, 10
s_add_u32 s6, s6, s43
s_add_u32 s75, s6, s84
s_add_u32 s6, s5, 4
s_cmp_ge_u32 s6, 5
s_cselect_b32 s7, 5, 0
s_cselect_b32 s43, 276480, 0
s_cselect_b32 s76, 160, 0
s_sub_u32 s6, s6, s7
s_lshl_b32 s7, s6, 3
s_add_u32 s76, s76, s7
v_add_u32 v201, s76, v5
s_lshl_b32 s6, s6, 10
s_add_u32 s6, s6, s43
s_add_u32 s76, s6, s84
s_add_u32 s6, s5, 8
s_cmp_ge_u32 s6, 5
s_cselect_b32 s7, 5, 0
s_cselect_b32 s43, 276480, 0
s_cselect_b32 s93, 160, 0
s_sub_u32 s6, s6, s7
s_lshl_b32 s7, s6, 3
s_add_u32 s93, s93, s7
v_add_u32 v246, s93, v5
s_lshl_b32 s6, s6, 10
s_add_u32 s6, s6, s43
s_add_u32 s93, s6, s84
s_cmp_ge_u32 s5, 2
s_cselect_b64 vcc, -1, 0
v_mov_b32 v3, 2147418112
v_cndmask_b32 v173, v207, v3, vcc
v_lshrrev_b32 v2, 4, v1
v_bfe_u32 v4, v1, 2, 2
v_and_b32 v5, 3, v1
v_lshrrev_b32 v6, 5, v1
v_lshl_add_u32 v6, v6, 3, v4
v_lshlrev_b32 v6, 8, v6
s_lshl_b32 s6, s82, 1
v_xor_b32 v4, s6, v4
v_lshlrev_b32 v4, 2, v4
v_and_b32 v3, 1, v2
v_lshl_or_b32 v4, v3, 1, v4
v_lshrrev_b32 v3, 1, v5
v_or_b32 v4, v4, v3
v_lshl_add_u32 v6, v4, 4, v6
v_and_b32 v5, 1, v5
v_lshl_add_u32 v216, v5, 3, v6
v_xor_b32 v217, 64, v216
v_add_u32 v218, 0x10000, v216
v_add_u32 v219, 0x10000, v217
v_and_b32 v4, 31, v1
v_bfe_u32 v5, v1, 1, 3
v_lshrrev_b32 v6, 5, v1
v_xor_b32 v5, v5, v6
s_lshl_b32 s6, s83, 6
v_add_u32 v4, s6, v4
v_lshlrev_b32 v4, 7, v4
v_lshl_add_u32 v220, v5, 4, v4
v_xor_b32 v221, 32, v220
v_xor_b32 v222, 64, v220
v_xor_b32 v223, 96, v220
v_add_u32 v224, 0x10000, v220
v_add_u32 v225, 0x10000, v221
v_add_u32 v226, 0x10000, v222
v_add_u32 v227, 0x10000, v223
v_and_b32 v2, 15, v1
v_min_u32 v2, 13, v2
v_add_u32 v2, s96, v2
v_min_u32 v2, 53, v2
v_lshlrev_b32 v2, 2, v2
s_lshr_b32 s43, s95, 1
v_add_u32 v2, s43, v2
v_lshlrev_b32 v2, 7, v2
v_add_u32 v228, 12, v2
s_lshl_b32 s6, s77, 1
v_and_b32 v4, 1, v1
v_add_u32 v4, s6, v4
v_and_b32 v5, 3, v4
v_add_u32 v5, 28, v5
v_lshrrev_b32 v4, 2, v4
v_lshl_add_u32 v4, v5, 3, v4
v_lshlrev_b32 v4, 7, v4
v_add_u32 v231, 4, v4
v_and_b32 v2, 31, v1
v_and_b32 v3, 7, v2
v_lshrrev_b32 v2, 3, v2
v_lshlrev_b32 v2, 3, v2
v_add_u32 v2, s3, v2
v_lshl_add_u32 v2, v2, 3, v3
v_lshlrev_b32 v229, 7, v2
v_cmp_gt_u32 vcc, 14, v1
v_cndmask_b32 v2, 0, v1, vcc
v_cmp_lt_u32 vcc, 6, v2
v_cndmask_b32 v3, 0, 1, vcc
v_mul_u32_u24 v4, 7, v3
v_sub_u32 v2, v2, v4
s_lshr_b32 s6, s94, 1
s_and_b32 s7, s6, 3
s_lshr_b32 s6, s6, 2
s_lshl_b32 s6, s6, 1
v_lshlrev_b32 v2, 2, v2
v_add_u32 v2, s7, v2
v_add_u32 v3, s6, v3
v_lshl_add_u32 v2, v2, 3, v3
v_lshlrev_b32 v2, 7, v2
v_add_u32 v249, 16, v2
v_and_b32 v2, 31, v1
v_lshlrev_b32 v2, 3, v2
v_add_u32 v2, s95, v2
v_lshlrev_b32 v2, 7, v2
v_add_u32 v250, 20, v2
v_mov_b32 v2, 2147418112
s_cmp_lg_u32 s5, 0
s_cselect_b64 vcc, -1, 0
v_cndmask_b32 v231, v231, v2, vcc
v_cndmask_b32 v230, v230, v2, vcc
v_and_b32 v2, 15, v1
v_bfe_u32 v3, v1, 4, 1
v_lshlrev_b32 v3, 2, v3
v_cmp_eq_u32 vcc, v2, v3
v_mov_b32 v2, 0x3f803f80
v_cndmask_b32 v160, 0, v2, vcc
v_mov_b32 v161, v160
v_mov_b32 v162, v160
v_mov_b32 v163, v160
s_waitcnt vmcnt(10)
s_cmp_lg_u32 s5, 0
s_cbranch_scc1 L_arr_2
s_and_b32 s6, s2, 7
s_lshl_b32 s6, s6, 5
v_mov_b32 v2, s6
s_mov_b64 exec, 1
buffer_atomic_add v253, v2, s[52:55], 0 offen sc1
s_mov_b64 exec, -1
L_arr_2:
v_lshlrev_b32 v194, 16, v8
v_and_b32 v195, 0xffff0000, v8
v_lshlrev_b32 v196, 16, v12
v_and_b32 v197, 0xffff0000, v12
s_mov_b32 exec_lo, 0xff000000
s_mov_b32 exec_hi, 0xffffff
buffer_load_dword v234, v232, s[20:23], 0 offen
s_mov_b64 exec, -1
s_mov_b32 exec_lo, 0xffff8000
s_mov_b32 exec_hi, 0x7
buffer_load_dword v234, v233, s[8:11], 0 offen
s_mov_b64 exec, -1
v_lshlrev_b32 v198, 16, v16
v_and_b32 v199, 0xffff0000, v16
v_lshlrev_b32 v236, 16, v20
v_and_b32 v237, 0xffff0000, v20
v_lshlrev_b32 v238, 16, v24
v_and_b32 v239, 0xffff0000, v24
v_lshlrev_b32 v240, 16, v28
v_and_b32 v241, 0xffff0000, v28
v_lshlrev_b32 v242, 16, v32
v_and_b32 v243, 0xffff0000, v32
v_lshlrev_b32 v52, 16, v36
v_lshlrev_b32 v53, 16, v38
v_and_b32 v54, 0xffff0000, v36
v_and_b32 v55, 0xffff0000, v38
v_lshlrev_b32 v56, 16, v37
v_lshlrev_b32 v57, 16, v39
v_and_b32 v58, 0xffff0000, v37
v_and_b32 v59, 0xffff0000, v39
v_pk_mul_f32 v[60:61], v[236:237], v[52:53]
v_pk_mul_f32 v[62:63], v[238:239], v[52:53]
v_pk_mul_f32 v[190:191], v[240:241], v[52:53]
v_pk_mul_f32 v[192:193], v[242:243], v[52:53]
v_pk_fma_f32 v[60:61], v[198:199], v[54:55], v[60:61]
v_pk_fma_f32 v[62:63], v[236:237], v[54:55], v[62:63]
v_pk_fma_f32 v[190:191], v[238:239], v[54:55], v[190:191]
v_pk_fma_f32 v[192:193], v[240:241], v[54:55], v[192:193]
v_pk_fma_f32 v[60:61], v[196:197], v[56:57], v[60:61]
v_pk_fma_f32 v[62:63], v[198:199], v[56:57], v[62:63]
v_pk_fma_f32 v[190:191], v[236:237], v[56:57], v[190:191]
v_pk_fma_f32 v[192:193], v[238:239], v[56:57], v[192:193]
v_pk_fma_f32 v[60:61], v[194:195], v[58:59], v[60:61]
v_pk_fma_f32 v[62:63], v[196:197], v[58:59], v[62:63]
v_pk_fma_f32 v[190:191], v[198:199], v[58:59], v[190:191]
v_pk_fma_f32 v[192:193], v[236:237], v[58:59], v[192:193]
v_lshlrev_b32 v194, 16, v174
v_and_b32 v195, 0xffff0000, v174
v_lshlrev_b32 v196, 16, v178
v_and_b32 v197, 0xffff0000, v178
v_lshlrev_b32 v198, 16, v182
v_and_b32 v199, 0xffff0000, v182
v_lshlrev_b32 v236, 16, v186
v_and_b32 v237, 0xffff0000, v186
v_pk_mul_f32 v[60:61], v[60:61], v[194:195]
v_pk_mul_f32 v[62:63], v[62:63], v[196:197]
v_pk_mul_f32 v[190:191], v[190:191], v[198:199]
v_pk_mul_f32 v[192:193], v[192:193], v[236:237]
s_mov_b32 exec_hi, 0xff
v_cvt_pk_bf16_f32 v238, v192, v190
v_cvt_pk_bf16_f32 v239, v62, v60
ds_write_b64 v202, v[238:239] offset:0
v_cvt_pk_bf16_f32 v240, v193, v191
v_cvt_pk_bf16_f32 v241, v63, v61
ds_write_b64 v202, v[240:241] offset:144
s_mov_b64 exec, -1
v_lshlrev_b32 v194, 16, v9
v_and_b32 v195, 0xffff0000, v9
v_lshlrev_b32 v196, 16, v13
v_and_b32 v197, 0xffff0000, v13
v_lshlrev_b32 v198, 16, v17
v_and_b32 v199, 0xffff0000, v17
v_lshlrev_b32 v236, 16, v21
v_and_b32 v237, 0xffff0000, v21
v_lshlrev_b32 v238, 16, v25
v_and_b32 v239, 0xffff0000, v25
v_lshlrev_b32 v240, 16, v29
v_and_b32 v241, 0xffff0000, v29
v_lshlrev_b32 v242, 16, v33
v_and_b32 v243, 0xffff0000, v33
v_lshlrev_b32 v52, 16, v40
v_lshlrev_b32 v53, 16, v42
v_and_b32 v54, 0xffff0000, v40
v_and_b32 v55, 0xffff0000, v42
v_lshlrev_b32 v56, 16, v41
v_lshlrev_b32 v57, 16, v43
v_and_b32 v58, 0xffff0000, v41
v_and_b32 v59, 0xffff0000, v43
v_pk_mul_f32 v[60:61], v[236:237], v[52:53]
v_pk_mul_f32 v[62:63], v[238:239], v[52:53]
v_pk_mul_f32 v[190:191], v[240:241], v[52:53]
v_pk_mul_f32 v[192:193], v[242:243], v[52:53]
v_pk_fma_f32 v[60:61], v[198:199], v[54:55], v[60:61]
v_pk_fma_f32 v[62:63], v[236:237], v[54:55], v[62:63]
v_pk_fma_f32 v[190:191], v[238:239], v[54:55], v[190:191]
v_pk_fma_f32 v[192:193], v[240:241], v[54:55], v[192:193]
v_pk_fma_f32 v[60:61], v[196:197], v[56:57], v[60:61]
v_pk_fma_f32 v[62:63], v[198:199], v[56:57], v[62:63]
v_pk_fma_f32 v[190:191], v[236:237], v[56:57], v[190:191]
v_pk_fma_f32 v[192:193], v[238:239], v[56:57], v[192:193]
v_pk_fma_f32 v[60:61], v[194:195], v[58:59], v[60:61]
v_pk_fma_f32 v[62:63], v[196:197], v[58:59], v[62:63]
v_pk_fma_f32 v[190:191], v[198:199], v[58:59], v[190:191]
v_pk_fma_f32 v[192:193], v[236:237], v[58:59], v[192:193]
v_lshlrev_b32 v194, 16, v175
v_and_b32 v195, 0xffff0000, v175
v_lshlrev_b32 v196, 16, v179
v_and_b32 v197, 0xffff0000, v179
v_lshlrev_b32 v198, 16, v183
v_and_b32 v199, 0xffff0000, v183
v_lshlrev_b32 v236, 16, v187
v_and_b32 v237, 0xffff0000, v187
v_pk_mul_f32 v[60:61], v[60:61], v[194:195]
v_pk_mul_f32 v[62:63], v[62:63], v[196:197]
v_pk_mul_f32 v[190:191], v[190:191], v[198:199]
v_pk_mul_f32 v[192:193], v[192:193], v[236:237]
s_mov_b32 exec_hi, 0xff
v_cvt_pk_bf16_f32 v238, v192, v190
v_cvt_pk_bf16_f32 v239, v62, v60
ds_write_b64 v202, v[238:239] offset:288
v_cvt_pk_bf16_f32 v240, v193, v191
v_cvt_pk_bf16_f32 v241, v63, v61
ds_write_b64 v202, v[240:241] offset:432
s_mov_b64 exec, -1
v_lshlrev_b32 v194, 16, v10
v_and_b32 v195, 0xffff0000, v10
v_lshlrev_b32 v196, 16, v14
v_and_b32 v197, 0xffff0000, v14
v_lshlrev_b32 v198, 16, v18
v_and_b32 v199, 0xffff0000, v18
v_lshlrev_b32 v236, 16, v22
v_and_b32 v237, 0xffff0000, v22
v_lshlrev_b32 v238, 16, v26
v_and_b32 v239, 0xffff0000, v26
v_lshlrev_b32 v240, 16, v30
v_and_b32 v241, 0xffff0000, v30
v_lshlrev_b32 v242, 16, v34
v_and_b32 v243, 0xffff0000, v34
v_lshlrev_b32 v52, 16, v44
v_lshlrev_b32 v53, 16, v46
v_and_b32 v54, 0xffff0000, v44
v_and_b32 v55, 0xffff0000, v46
v_lshlrev_b32 v56, 16, v45
v_lshlrev_b32 v57, 16, v47
s_add_u32 m0, s81, 32768
s_add_u32 s79, s79, 221184
buffer_load_dwordx4 v208, s[20:23], s79 offen offset:0 lds
v_and_b32 v58, 0xffff0000, v45
v_and_b32 v59, 0xffff0000, v47
v_pk_mul_f32 v[60:61], v[236:237], v[52:53]
v_pk_mul_f32 v[62:63], v[238:239], v[52:53]
v_pk_mul_f32 v[190:191], v[240:241], v[52:53]
v_pk_mul_f32 v[192:193], v[242:243], v[52:53]
v_pk_fma_f32 v[60:61], v[198:199], v[54:55], v[60:61]
v_pk_fma_f32 v[62:63], v[236:237], v[54:55], v[62:63]
buffer_load_dwordx4 v209, s[20:23], s79 offen offset:1024 lds
v_pk_fma_f32 v[190:191], v[238:239], v[54:55], v[190:191]
v_pk_fma_f32 v[192:193], v[240:241], v[54:55], v[192:193]
v_pk_fma_f32 v[60:61], v[196:197], v[56:57], v[60:61]
v_pk_fma_f32 v[62:63], v[198:199], v[56:57], v[62:63]
v_pk_fma_f32 v[190:191], v[236:237], v[56:57], v[190:191]
v_pk_fma_f32 v[192:193], v[238:239], v[56:57], v[192:193]
v_pk_fma_f32 v[60:61], v[194:195], v[58:59], v[60:61]
v_pk_fma_f32 v[62:63], v[196:197], v[58:59], v[62:63]
buffer_load_dwordx4 v210, s[20:23], s79 offen offset:2048 lds
v_pk_fma_f32 v[190:191], v[198:199], v[58:59], v[190:191]
v_pk_fma_f32 v[192:193], v[236:237], v[58:59], v[192:193]
v_lshlrev_b32 v194, 16, v176
v_and_b32 v195, 0xffff0000, v176
v_lshlrev_b32 v196, 16, v180
v_and_b32 v197, 0xffff0000, v180
v_lshlrev_b32 v198, 16, v184
v_and_b32 v199, 0xffff0000, v184
buffer_load_dwordx4 v211, s[20:23], s79 offen offset:3072 lds
v_lshlrev_b32 v236, 16, v188
v_and_b32 v237, 0xffff0000, v188
v_pk_mul_f32 v[60:61], v[60:61], v[194:195]
v_pk_mul_f32 v[62:63], v[62:63], v[196:197]
v_pk_mul_f32 v[190:191], v[190:191], v[198:199]
v_pk_mul_f32 v[192:193], v[192:193], v[236:237]
s_mov_b32 exec_hi, 0xff
v_cvt_pk_bf16_f32 v238, v192, v190
v_cvt_pk_bf16_f32 v239, v62, v60
ds_write_b64 v202, v[238:239] offset:576
v_cvt_pk_bf16_f32 v240, v193, v191
v_cvt_pk_bf16_f32 v241, v63, v61
ds_write_b64 v202, v[240:241] offset:720
s_mov_b64 exec, -1
v_lshlrev_b32 v194, 16, v11
v_and_b32 v195, 0xffff0000, v11
s_add_u32 m0, s81, 49152
s_add_u32 s80, s80, 128
buffer_load_dwordx4 v212, s[8:11], s80 offen offset:0 lds
v_lshlrev_b32 v196, 16, v15
v_and_b32 v197, 0xffff0000, v15
v_lshlrev_b32 v198, 16, v19
v_and_b32 v199, 0xffff0000, v19
v_lshlrev_b32 v236, 16, v23
v_and_b32 v237, 0xffff0000, v23
v_lshlrev_b32 v238, 16, v27
v_and_b32 v239, 0xffff0000, v27
buffer_load_dwordx4 v213, s[8:11], s80 offen offset:1024 lds
v_lshlrev_b32 v240, 16, v31
v_and_b32 v241, 0xffff0000, v31
v_lshlrev_b32 v242, 16, v35
v_and_b32 v243, 0xffff0000, v35
v_lshlrev_b32 v52, 16, v48
v_lshlrev_b32 v53, 16, v50
v_and_b32 v54, 0xffff0000, v48
v_and_b32 v55, 0xffff0000, v50
buffer_load_dwordx4 v214, s[8:11], s80 offen offset:2048 lds
v_lshlrev_b32 v56, 16, v49
v_lshlrev_b32 v57, 16, v51
v_and_b32 v58, 0xffff0000, v49
v_and_b32 v59, 0xffff0000, v51
v_pk_mul_f32 v[60:61], v[236:237], v[52:53]
v_pk_mul_f32 v[62:63], v[238:239], v[52:53]
v_pk_mul_f32 v[190:191], v[240:241], v[52:53]
v_pk_mul_f32 v[192:193], v[242:243], v[52:53]
buffer_load_dwordx4 v215, s[8:11], s80 offen offset:3072 lds
v_pk_fma_f32 v[60:61], v[198:199], v[54:55], v[60:61]
v_pk_fma_f32 v[62:63], v[236:237], v[54:55], v[62:63]
v_pk_fma_f32 v[190:191], v[238:239], v[54:55], v[190:191]
v_pk_fma_f32 v[192:193], v[240:241], v[54:55], v[192:193]
v_pk_fma_f32 v[60:61], v[196:197], v[56:57], v[60:61]
v_pk_fma_f32 v[62:63], v[198:199], v[56:57], v[62:63]
v_pk_fma_f32 v[190:191], v[236:237], v[56:57], v[190:191]
v_pk_fma_f32 v[192:193], v[238:239], v[56:57], v[192:193]
v_pk_fma_f32 v[60:61], v[194:195], v[58:59], v[60:61]
v_pk_fma_f32 v[62:63], v[196:197], v[58:59], v[62:63]
v_pk_fma_f32 v[190:191], v[198:199], v[58:59], v[190:191]
v_pk_fma_f32 v[192:193], v[236:237], v[58:59], v[192:193]
v_lshlrev_b32 v194, 16, v177
v_and_b32 v195, 0xffff0000, v177
v_lshlrev_b32 v196, 16, v181
v_and_b32 v197, 0xffff0000, v181
v_lshlrev_b32 v198, 16, v185
v_and_b32 v199, 0xffff0000, v185
v_lshlrev_b32 v236, 16, v189
v_and_b32 v237, 0xffff0000, v189
v_pk_mul_f32 v[60:61], v[60:61], v[194:195]
v_pk_mul_f32 v[62:63], v[62:63], v[196:197]
v_pk_mul_f32 v[190:191], v[190:191], v[198:199]
v_pk_mul_f32 v[192:193], v[192:193], v[236:237]
s_mov_b32 exec_hi, 0xff
v_cvt_pk_bf16_f32 v238, v192, v190
v_cvt_pk_bf16_f32 v239, v62, v60
ds_write_b64 v202, v[238:239] offset:864
v_cvt_pk_bf16_f32 v240, v193, v191
v_cvt_pk_bf16_f32 v241, v63, v61
ds_write_b64 v202, v[240:241] offset:1008
s_mov_b64 exec, -1
s_waitcnt vmcnt(10)
s_waitcnt lgkmcnt(0)
s_barrier
ds_read_b64_tr_b16 v[128:129], v216 offset:0
ds_read_b64_tr_b16 v[130:131], v216 offset:1024
ds_read_b128 v[136:139], v220 offset:16384
ds_read_b128 v[140:143], v220 offset:20480
ds_read_b64_tr_b16 v[132:133], v217 offset:0
ds_read_b64_tr_b16 v[134:135], v217 offset:1024
ds_read_b128 v[8:11], v203 offset:0
ds_read_b128 v[12:15], v203 offset:1152
ds_read_b128 v[16:19], v203 offset:2304
s_waitcnt lgkmcnt(6)
v_mfma_f32_32x32x16_bf16 v[64:79], v[128:131], v[136:139], 0
ds_read_b64_tr_b16 v[144:145], v216 offset:4096
ds_read_b64_tr_b16 v[146:147], v216 offset:5120
s_add_u32 m0, s81, 65536
s_add_u32 s79, s79, 221184
buffer_load_dwordx4 v208, s[20:23], s79 offen offset:0 lds
s_waitcnt lgkmcnt(7)
v_mfma_f32_32x32x16_bf16 v[80:95], v[128:131], v[140:143], 0
ds_read_b128 v[152:155], v221 offset:16384
ds_read_b128 v[156:159], v221 offset:20480
buffer_load_dwordx4 v209, s[20:23], s79 offen offset:1024 lds
v_mfma_f32_16x16x32_bf16 v[164:167], v[160:163], v[128:131], 0
s_waitcnt lgkmcnt(7)
v_mfma_f32_32x32x16_bf16 v[96:111], v[132:135], v[136:139], 0
ds_read_b64_tr_b16 v[148:149], v217 offset:4096
ds_read_b64_tr_b16 v[150:151], v217 offset:5120
buffer_load_dwordx4 v210, s[20:23], s79 offen offset:2048 lds
v_mfma_f32_32x32x16_bf16 v[112:127], v[132:135], v[140:143], 0
buffer_load_dwordx4 v211, s[20:23], s79 offen offset:3072 lds
v_mfma_f32_16x16x32_bf16 v[168:171], v[160:163], v[132:135], 0
s_waitcnt lgkmcnt(3)
v_mfma_f32_32x32x16_bf16 v[64:79], v[144:147], v[152:155], v[64:79]
ds_read_b64_tr_b16 v[128:129], v216 offset:8192
ds_read_b64_tr_b16 v[130:131], v216 offset:9216
s_add_u32 m0, s81, 81920
s_add_u32 s80, s80, 128
buffer_load_dwordx4 v212, s[8:11], s80 offen offset:0 lds
s_waitcnt lgkmcnt(4)
v_mfma_f32_32x32x16_bf16 v[80:95], v[144:147], v[156:159], v[80:95]
ds_read_b128 v[136:139], v222 offset:16384
ds_read_b128 v[140:143], v222 offset:20480
buffer_load_dwordx4 v213, s[8:11], s80 offen offset:1024 lds
v_mfma_f32_16x16x32_bf16 v[164:167], v[160:163], v[144:147], v[164:167]
s_waitcnt lgkmcnt(4)
v_mfma_f32_32x32x16_bf16 v[96:111], v[148:151], v[152:155], v[96:111]
ds_read_b64_tr_b16 v[132:133], v217 offset:8192
ds_read_b64_tr_b16 v[134:135], v217 offset:9216
buffer_load_dwordx4 v214, s[8:11], s80 offen offset:2048 lds
v_mfma_f32_32x32x16_bf16 v[112:127], v[148:151], v[156:159], v[112:127]
buffer_load_dwordx4 v215, s[8:11], s80 offen offset:3072 lds
v_mfma_f32_16x16x32_bf16 v[168:171], v[160:163], v[148:151], v[168:171]
s_waitcnt lgkmcnt(3)
v_mfma_f32_32x32x16_bf16 v[64:79], v[128:131], v[136:139], v[64:79]
ds_read_b64_tr_b16 v[144:145], v216 offset:12288
ds_read_b64_tr_b16 v[146:147], v216 offset:13312
s_waitcnt vmcnt(8)
s_cmp_eq_u32 s82, 0
s_cbranch_scc0 L_nb_3
s_barrier
L_nb_3:
s_waitcnt lgkmcnt(4)
v_mfma_f32_32x32x16_bf16 v[80:95], v[128:131], v[140:143], v[80:95]
ds_read_b128 v[152:155], v223 offset:16384
ds_read_b128 v[156:159], v223 offset:20480
s_cmp_eq_u32 s82, 1
s_cbranch_scc0 L_nb_4
s_barrier
L_nb_4:
v_mfma_f32_16x16x32_bf16 v[164:167], v[160:163], v[128:131], v[164:167]
s_waitcnt lgkmcnt(4)
v_mfma_f32_32x32x16_bf16 v[96:111], v[132:135], v[136:139], v[96:111]
ds_read_b64_tr_b16 v[148:149], v217 offset:12288
ds_read_b64_tr_b16 v[150:151], v217 offset:13312
s_add_u32 m0, s81, 98304
s_add_u32 s79, s79, 221184
buffer_load_dwordx4 v208, s[20:23], s79 offen offset:0 lds
v_mfma_f32_32x32x16_bf16 v[112:127], v[132:135], v[140:143], v[112:127]
buffer_store_dwordx4 v[8:11], v172, s[24:27], s70 offen sc1
v_mfma_f32_16x16x32_bf16 v[168:171], v[160:163], v[132:135], v[168:171]
s_waitcnt lgkmcnt(3)
v_mfma_f32_32x32x16_bf16 v[64:79], v[144:147], v[152:155], v[64:79]
ds_read_b64_tr_b16 v[128:129], v216 offset:32768
ds_read_b64_tr_b16 v[130:131], v216 offset:33792
buffer_load_dwordx4 v209, s[20:23], s79 offen offset:1024 lds
s_waitcnt lgkmcnt(4)
v_mfma_f32_32x32x16_bf16 v[80:95], v[144:147], v[156:159], v[80:95]
ds_read_b128 v[136:139], v220 offset:49152
ds_read_b128 v[140:143], v220 offset:53248
v_mfma_f32_16x16x32_bf16 v[164:167], v[160:163], v[144:147], v[164:167]
s_waitcnt lgkmcnt(4)
v_mfma_f32_32x32x16_bf16 v[96:111], v[148:151], v[152:155], v[96:111]
ds_read_b64_tr_b16 v[132:133], v217 offset:32768
ds_read_b64_tr_b16 v[134:135], v217 offset:33792
buffer_load_dwordx4 v210, s[20:23], s79 offen offset:2048 lds
v_mfma_f32_32x32x16_bf16 v[112:127], v[148:151], v[156:159], v[112:127]
v_mfma_f32_16x16x32_bf16 v[168:171], v[160:163], v[148:151], v[168:171]
s_waitcnt lgkmcnt(3)
v_mfma_f32_32x32x16_bf16 v[64:79], v[128:131], v[136:139], v[64:79]
ds_read_b64_tr_b16 v[144:145], v216 offset:36864
ds_read_b64_tr_b16 v[146:147], v216 offset:37888
buffer_load_dwordx4 v211, s[20:23], s79 offen offset:3072 lds
s_waitcnt lgkmcnt(4)
v_mfma_f32_32x32x16_bf16 v[80:95], v[128:131], v[140:143], v[80:95]
ds_read_b128 v[152:155], v221 offset:49152
ds_read_b128 v[156:159], v221 offset:53248
v_mfma_f32_16x16x32_bf16 v[164:167], v[160:163], v[128:131], v[164:167]
s_waitcnt lgkmcnt(4)
v_mfma_f32_32x32x16_bf16 v[96:111], v[132:135], v[136:139], v[96:111]
ds_read_b64_tr_b16 v[148:149], v217 offset:36864
ds_read_b64_tr_b16 v[150:151], v217 offset:37888
s_add_u32 m0, s81, 114688
s_add_u32 s80, s80, 128
buffer_load_dwordx4 v212, s[8:11], s80 offen offset:0 lds
v_mfma_f32_32x32x16_bf16 v[112:127], v[132:135], v[140:143], v[112:127]
buffer_store_dwordx4 v[12:15], v172, s[24:27], s71 offen sc1
v_mfma_f32_16x16x32_bf16 v[168:171], v[160:163], v[132:135], v[168:171]
s_waitcnt lgkmcnt(3)
v_mfma_f32_32x32x16_bf16 v[64:79], v[144:147], v[152:155], v[64:79]
ds_read_b64_tr_b16 v[128:129], v216 offset:40960
ds_read_b64_tr_b16 v[130:131], v216 offset:41984
buffer_load_dwordx4 v213, s[8:11], s80 offen offset:1024 lds
s_waitcnt lgkmcnt(4)
v_mfma_f32_32x32x16_bf16 v[80:95], v[144:147], v[156:159], v[80:95]
ds_read_b128 v[136:139], v222 offset:49152
ds_read_b128 v[140:143], v222 offset:53248
v_mfma_f32_16x16x32_bf16 v[164:167], v[160:163], v[144:147], v[164:167]
s_waitcnt lgkmcnt(4)
v_mfma_f32_32x32x16_bf16 v[96:111], v[148:151], v[152:155], v[96:111]
ds_read_b64_tr_b16 v[132:133], v217 offset:40960
ds_read_b64_tr_b16 v[134:135], v217 offset:41984
buffer_load_dwordx4 v214, s[8:11], s80 offen offset:2048 lds
v_mfma_f32_32x32x16_bf16 v[112:127], v[148:151], v[156:159], v[112:127]
v_mfma_f32_16x16x32_bf16 v[168:171], v[160:163], v[148:151], v[168:171]
s_waitcnt lgkmcnt(3)
v_mfma_f32_32x32x16_bf16 v[64:79], v[128:131], v[136:139], v[64:79]
ds_read_b64_tr_b16 v[144:145], v216 offset:45056
ds_read_b64_tr_b16 v[146:147], v216 offset:46080
s_waitcnt vmcnt(9)
s_cmp_eq_u32 s82, 0
s_cbranch_scc0 L_nb_5
s_barrier
L_nb_5:
buffer_load_dwordx4 v215, s[8:11], s80 offen offset:3072 lds
s_waitcnt lgkmcnt(4)
v_mfma_f32_32x32x16_bf16 v[80:95], v[128:131], v[140:143], v[80:95]
ds_read_b128 v[152:155], v223 offset:49152
ds_read_b128 v[156:159], v223 offset:53248
s_cmp_eq_u32 s82, 1
s_cbranch_scc0 L_nb_6
s_barrier
L_nb_6:
s_mov_b32 exec_lo, 0x0
s_mov_b32 exec_hi, 0xff000000
buffer_load_dword v234, v232, s[20:23], 0 offen
s_mov_b64 exec, -1
s_mov_b32 s6, 1769472
s_mov_b32 exec_lo, 0xffff
s_mov_b32 exec_hi, 0x0
buffer_load_dword v234, v232, s[20:23], s6 offen
s_mov_b64 exec, -1
s_mov_b32 exec_lo, 0x0
s_mov_b32 exec_hi, 0x3fff8
buffer_load_dword v234, v233, s[8:11], 0 offen
s_mov_b64 exec, -1
v_mfma_f32_16x16x32_bf16 v[164:167], v[160:163], v[128:131], v[164:167]
s_waitcnt lgkmcnt(4)
v_mfma_f32_32x32x16_bf16 v[96:111], v[132:135], v[136:139], v[96:111]
ds_read_b64_tr_b16 v[148:149], v217 offset:45056
ds_read_b64_tr_b16 v[150:151], v217 offset:46080
s_add_u32 m0, s81, 0
s_add_u32 s79, s79, 221184
buffer_load_dwordx4 v208, s[20:23], s79 offen offset:0 lds
v_mfma_f32_32x32x16_bf16 v[112:127], v[132:135], v[140:143], v[112:127]
s_mov_b32 exec_hi, 0
buffer_store_dwordx4 v[16:19], v172, s[24:27], s72 offen sc1
s_mov_b64 exec, -1
v_mfma_f32_16x16x32_bf16 v[168:171], v[160:163], v[132:135], v[168:171]
s_waitcnt lgkmcnt(3)
v_mfma_f32_32x32x16_bf16 v[64:79], v[144:147], v[152:155], v[64:79]
ds_read_b64_tr_b16 v[128:129], v218 offset:0
ds_read_b64_tr_b16 v[130:131], v218 offset:1024
buffer_load_dwordx4 v209, s[20:23], s79 offen offset:1024 lds
s_waitcnt lgkmcnt(4)
v_mfma_f32_32x32x16_bf16 v[80:95], v[144:147], v[156:159], v[80:95]
ds_read_b128 v[136:139], v224 offset:16384
ds_read_b128 v[140:143], v224 offset:20480
v_mfma_f32_16x16x32_bf16 v[164:167], v[160:163], v[144:147], v[164:167]
s_waitcnt lgkmcnt(4)
v_mfma_f32_32x32x16_bf16 v[96:111], v[148:151], v[152:155], v[96:111]
ds_read_b64_tr_b16 v[132:133], v219 offset:0
ds_read_b64_tr_b16 v[134:135], v219 offset:1024
buffer_load_dwordx4 v210, s[20:23], s79 offen offset:2048 lds
v_mfma_f32_32x32x16_bf16 v[112:127], v[148:151], v[156:159], v[112:127]
v_mfma_f32_16x16x32_bf16 v[168:171], v[160:163], v[148:151], v[168:171]
s_waitcnt lgkmcnt(3)
v_mfma_f32_32x32x16_bf16 v[64:79], v[128:131], v[136:139], v[64:79]
ds_read_b64_tr_b16 v[144:145], v218 offset:4096
ds_read_b64_tr_b16 v[146:147], v218 offset:5120
buffer_load_dwordx4 v211, s[20:23], s79 offen offset:3072 lds
s_waitcnt lgkmcnt(4)
v_mfma_f32_32x32x16_bf16 v[80:95], v[128:131], v[140:143], v[80:95]
ds_read_b128 v[152:155], v225 offset:16384
ds_read_b128 v[156:159], v225 offset:20480
v_mfma_f32_16x16x32_bf16 v[164:167], v[160:163], v[128:131], v[164:167]
s_waitcnt lgkmcnt(4)
v_mfma_f32_32x32x16_bf16 v[96:111], v[132:135], v[136:139], v[96:111]
ds_read_b64_tr_b16 v[148:149], v219 offset:4096
ds_read_b64_tr_b16 v[150:151], v219 offset:5120
s_add_u32 m0, s81, 16384
s_add_u32 s80, s80, 128
buffer_load_dwordx4 v212, s[8:11], s80 offen offset:0 lds
v_mfma_f32_32x32x16_bf16 v[112:127], v[132:135], v[140:143], v[112:127]
v_mfma_f32_16x16x32_bf16 v[168:171], v[160:163], v[132:135], v[168:171]
s_waitcnt lgkmcnt(3)
v_mfma_f32_32x32x16_bf16 v[64:79], v[144:147], v[152:155], v[64:79]
ds_read_b64_tr_b16 v[128:129], v218 offset:8192
ds_read_b64_tr_b16 v[130:131], v218 offset:9216
buffer_load_dwordx4 v213, s[8:11], s80 offen offset:1024 lds
s_waitcnt lgkmcnt(4)
v_mfma_f32_32x32x16_bf16 v[80:95], v[144:147], v[156:159], v[80:95]
ds_read_b128 v[136:139], v226 offset:16384
ds_read_b128 v[140:143], v226 offset:20480
v_mfma_f32_16x16x32_bf16 v[164:167], v[160:163], v[144:147], v[164:167]
s_waitcnt lgkmcnt(4)
v_mfma_f32_32x32x16_bf16 v[96:111], v[148:151], v[152:155], v[96:111]
ds_read_b64_tr_b16 v[132:133], v219 offset:8192
ds_read_b64_tr_b16 v[134:135], v219 offset:9216
buffer_load_dwordx4 v214, s[8:11], s80 offen offset:2048 lds
v_mfma_f32_32x32x16_bf16 v[112:127], v[148:151], v[156:159], v[112:127]
buffer_load_dword v254, v230, s[52:55], 0 offen sc1
v_mfma_f32_16x16x32_bf16 v[168:171], v[160:163], v[148:151], v[168:171]
s_waitcnt lgkmcnt(3)
v_mfma_f32_32x32x16_bf16 v[64:79], v[128:131], v[136:139], v[64:79]
ds_read_b64_tr_b16 v[144:145], v218 offset:12288
ds_read_b64_tr_b16 v[146:147], v218 offset:13312
s_waitcnt vmcnt(12)
s_cmp_eq_u32 s82, 0
s_cbranch_scc0 L_nb_7
s_barrier
L_nb_7:
buffer_load_dwordx4 v215, s[8:11], s80 offen offset:3072 lds
s_waitcnt lgkmcnt(4)
v_mfma_f32_32x32x16_bf16 v[80:95], v[128:131], v[140:143], v[80:95]
ds_read_b128 v[152:155], v227 offset:16384
ds_read_b128 v[156:159], v227 offset:20480
s_cmp_eq_u32 s82, 1
s_cbranch_scc0 L_nb_8
s_barrier
L_nb_8:
v_mfma_f32_16x16x32_bf16 v[164:167], v[160:163], v[128:131], v[164:167]
s_waitcnt lgkmcnt(4)
v_mfma_f32_32x32x16_bf16 v[96:111], v[132:135], v[136:139], v[96:111]
ds_read_b64_tr_b16 v[148:149], v219 offset:12288
ds_read_b64_tr_b16 v[150:151], v219 offset:13312
s_add_u32 m0, s81, 32768
s_add_u32 s79, s79, 221184
buffer_load_dwordx4 v208, s[20:23], s79 offen offset:0 lds
v_mfma_f32_32x32x16_bf16 v[112:127], v[132:135], v[140:143], v[112:127]
v_mfma_f32_16x16x32_bf16 v[168:171], v[160:163], v[132:135], v[168:171]
s_waitcnt lgkmcnt(3)
v_mfma_f32_32x32x16_bf16 v[64:79], v[144:147], v[152:155], v[64:79]
ds_read_b64_tr_b16 v[128:129], v218 offset:32768
ds_read_b64_tr_b16 v[130:131], v218 offset:33792
buffer_load_dwordx4 v209, s[20:23], s79 offen offset:1024 lds
s_waitcnt lgkmcnt(4)
v_mfma_f32_32x32x16_bf16 v[80:95], v[144:147], v[156:159], v[80:95]
ds_read_b128 v[136:139], v224 offset:49152
ds_read_b128 v[140:143], v224 offset:53248
v_mfma_f32_16x16x32_bf16 v[164:167], v[160:163], v[144:147], v[164:167]
s_waitcnt lgkmcnt(4)
v_mfma_f32_32x32x16_bf16 v[96:111], v[148:151], v[152:155], v[96:111]
ds_read_b64_tr_b16 v[132:133], v219 offset:32768
ds_read_b64_tr_b16 v[134:135], v219 offset:33792
buffer_load_dwordx4 v210, s[20:23], s79 offen offset:2048 lds
v_mfma_f32_32x32x16_bf16 v[112:127], v[148:151], v[156:159], v[112:127]
v_mfma_f32_16x16x32_bf16 v[168:171], v[160:163], v[148:151], v[168:171]
s_waitcnt lgkmcnt(3)
v_mfma_f32_32x32x16_bf16 v[64:79], v[128:131], v[136:139], v[64:79]
ds_read_b64_tr_b16 v[144:145], v218 offset:36864
ds_read_b64_tr_b16 v[146:147], v218 offset:37888
buffer_load_dwordx4 v211, s[20:23], s79 offen offset:3072 lds
s_waitcnt lgkmcnt(4)
v_mfma_f32_32x32x16_bf16 v[80:95], v[128:131], v[140:143], v[80:95]
ds_read_b128 v[152:155], v225 offset:49152
ds_read_b128 v[156:159], v225 offset:53248
s_mov_b32 m0, s74
s_nop 0
buffer_load_dwordx4 v204, s[36:39], 0 offen lds
s_mov_b32 m0, s74
s_nop 0
buffer_load_dwordx4 v205, s[36:39], 0 offen offset:1024 lds
s_mov_b32 m0, s74
s_mov_b32 exec_hi, 0
buffer_load_dwordx4 v206, s[36:39], 0 offen offset:2048 lds
s_mov_b64 exec, -1
v_mfma_f32_16x16x32_bf16 v[164:167], v[160:163], v[128:131], v[164:167]
s_waitcnt lgkmcnt(4)
v_mfma_f32_32x32x16_bf16 v[96:111], v[132:135], v[136:139], v[96:111]
ds_read_b64_tr_b16 v[148:149], v219 offset:36864
ds_read_b64_tr_b16 v[150:151], v219 offset:37888
s_add_u32 m0, s81, 49152
s_add_u32 s80, s80, 128
buffer_load_dwordx4 v212, s[8:11], s80 offen offset:0 lds
v_mfma_f32_32x32x16_bf16 v[112:127], v[132:135], v[140:143], v[112:127]
v_mfma_f32_16x16x32_bf16 v[168:171], v[160:163], v[132:135], v[168:171]
s_waitcnt lgkmcnt(3)
v_mfma_f32_32x32x16_bf16 v[64:79], v[144:147], v[152:155], v[64:79]
ds_read_b64_tr_b16 v[128:129], v218 offset:40960
ds_read_b64_tr_b16 v[130:131], v218 offset:41984
buffer_load_dwordx4 v213, s[8:11], s80 offen offset:1024 lds
s_waitcnt lgkmcnt(4)
v_mfma_f32_32x32x16_bf16 v[80:95], v[144:147], v[156:159], v[80:95]
ds_read_b128 v[136:139], v226 offset:49152
ds_read_b128 v[140:143], v226 offset:53248
v_mfma_f32_16x16x32_bf16 v[164:167], v[160:163], v[144:147], v[164:167]
s_waitcnt lgkmcnt(4)
v_mfma_f32_32x32x16_bf16 v[96:111], v[148:151], v[152:155], v[96:111]
ds_read_b64_tr_b16 v[132:133], v219 offset:40960
ds_read_b64_tr_b16 v[134:135], v219 offset:41984
buffer_load_dwordx4 v214, s[8:11], s80 offen offset:2048 lds
v_mfma_f32_32x32x16_bf16 v[112:127], v[148:151], v[156:159], v[112:127]
v_mfma_f32_16x16x32_bf16 v[168:171], v[160:163], v[148:151], v[168:171]
s_waitcnt lgkmcnt(3)
v_mfma_f32_32x32x16_bf16 v[64:79], v[128:131], v[136:139], v[64:79]
ds_read_b64_tr_b16 v[144:145], v218 offset:45056
ds_read_b64_tr_b16 v[146:147], v218 offset:46080
s_waitcnt vmcnt(10)
s_cmp_eq_u32 s82, 0
s_cbranch_scc0 L_nb_9
s_barrier
L_nb_9:
buffer_load_dwordx4 v215, s[8:11], s80 offen offset:3072 lds
s_waitcnt lgkmcnt(4)
v_mfma_f32_32x32x16_bf16 v[80:95], v[128:131], v[140:143], v[80:95]
ds_read_b128 v[152:155], v227 offset:49152
ds_read_b128 v[156:159], v227 offset:53248
s_cmp_eq_u32 s82, 1
s_cbranch_scc0 L_nb_10
s_barrier
L_nb_10:
v_mfma_f32_16x16x32_bf16 v[164:167], v[160:163], v[128:131], v[164:167]
s_waitcnt lgkmcnt(4)
v_mfma_f32_32x32x16_bf16 v[96:111], v[132:135], v[136:139], v[96:111]
ds_read_b64_tr_b16 v[148:149], v219 offset:45056
ds_read_b64_tr_b16 v[150:151], v219 offset:46080
s_add_u32 m0, s81, 65536
s_add_u32 s79, s79, 221184
buffer_load_dwordx4 v208, s[20:23], s79 offen offset:0 lds
v_mfma_f32_32x32x16_bf16 v[112:127], v[132:135], v[140:143], v[112:127]
v_mfma_f32_16x16x32_bf16 v[168:171], v[160:163], v[132:135], v[168:171]
s_waitcnt lgkmcnt(3)
v_mfma_f32_32x32x16_bf16 v[64:79], v[144:147], v[152:155], v[64:79]
ds_read_b64_tr_b16 v[128:129], v216 offset:0
ds_read_b64_tr_b16 v[130:131], v216 offset:1024
buffer_load_dwordx4 v209, s[20:23], s79 offen offset:1024 lds
s_waitcnt lgkmcnt(4)
v_mfma_f32_32x32x16_bf16 v[80:95], v[144:147], v[156:159], v[80:95]
ds_read_b128 v[136:139], v220 offset:16384
ds_read_b128 v[140:143], v220 offset:20480
v_mfma_f32_16x16x32_bf16 v[164:167], v[160:163], v[144:147], v[164:167]
s_waitcnt lgkmcnt(4)
v_mfma_f32_32x32x16_bf16 v[96:111], v[148:151], v[152:155], v[96:111]
ds_read_b64_tr_b16 v[132:133], v217 offset:0
ds_read_b64_tr_b16 v[134:135], v217 offset:1024
buffer_load_dwordx4 v210, s[20:23], s79 offen offset:2048 lds
v_mfma_f32_32x32x16_bf16 v[112:127], v[148:151], v[156:159], v[112:127]
v_mfma_f32_16x16x32_bf16 v[168:171], v[160:163], v[148:151], v[168:171]
s_waitcnt lgkmcnt(3)
v_mfma_f32_32x32x16_bf16 v[64:79], v[128:131], v[136:139], v[64:79]
ds_read_b64_tr_b16 v[144:145], v216 offset:4096
ds_read_b64_tr_b16 v[146:147], v216 offset:5120
buffer_load_dwordx4 v211, s[20:23], s79 offen offset:3072 lds
s_waitcnt lgkmcnt(4)
v_mfma_f32_32x32x16_bf16 v[80:95], v[128:131], v[140:143], v[80:95]
ds_read_b128 v[152:155], v221 offset:16384
ds_read_b128 v[156:159], v221 offset:20480
v_mfma_f32_16x16x32_bf16 v[164:167], v[160:163], v[128:131], v[164:167]
s_waitcnt lgkmcnt(4)
v_mfma_f32_32x32x16_bf16 v[96:111], v[132:135], v[136:139], v[96:111]
ds_read_b64_tr_b16 v[148:149], v217 offset:4096
ds_read_b64_tr_b16 v[150:151], v217 offset:5120
s_add_u32 m0, s81, 81920
s_add_u32 s80, s80, 128
buffer_load_dwordx4 v212, s[8:11], s80 offen offset:0 lds
v_mfma_f32_32x32x16_bf16 v[112:127], v[132:135], v[140:143], v[112:127]
v_mfma_f32_16x16x32_bf16 v[168:171], v[160:163], v[132:135], v[168:171]
s_waitcnt lgkmcnt(3)
v_mfma_f32_32x32x16_bf16 v[64:79], v[144:147], v[152:155], v[64:79]
ds_read_b64_tr_b16 v[128:129], v216 offset:8192
ds_read_b64_tr_b16 v[130:131], v216 offset:9216
buffer_load_dwordx4 v213, s[8:11], s80 offen offset:1024 lds
s_waitcnt lgkmcnt(4)
v_mfma_f32_32x32x16_bf16 v[80:95], v[144:147], v[156:159], v[80:95]
ds_read_b128 v[136:139], v222 offset:16384
ds_read_b128 v[140:143], v222 offset:20480
v_mfma_f32_16x16x32_bf16 v[164:167], v[160:163], v[144:147], v[164:167]
s_waitcnt lgkmcnt(4)
v_mfma_f32_32x32x16_bf16 v[96:111], v[148:151], v[152:155], v[96:111]
ds_read_b64_tr_b16 v[132:133], v217 offset:8192
ds_read_b64_tr_b16 v[134:135], v217 offset:9216
buffer_load_dwordx4 v214, s[8:11], s80 offen offset:2048 lds
v_mfma_f32_32x32x16_bf16 v[112:127], v[148:151], v[156:159], v[112:127]
v_mfma_f32_16x16x32_bf16 v[168:171], v[160:163], v[148:151], v[168:171]
s_waitcnt lgkmcnt(3)
v_mfma_f32_32x32x16_bf16 v[64:79], v[128:131], v[136:139], v[64:79]
ds_read_b64_tr_b16 v[144:145], v216 offset:12288
ds_read_b64_tr_b16 v[146:147], v216 offset:13312
s_waitcnt vmcnt(7)
s_cmp_lg_u32 s5, 0
s_cbranch_scc1 L_back_12
v_cmp_gt_u32 vcc, 32, v254
s_cbranch_vccnz L_slow_11
L_back_12:
s_cmp_eq_u32 s82, 0
s_cbranch_scc0 L_nb_13
s_barrier
L_nb_13:
buffer_load_dwordx4 v215, s[8:11], s80 offen offset:3072 lds
s_waitcnt lgkmcnt(4)
v_mfma_f32_32x32x16_bf16 v[80:95], v[128:131], v[140:143], v[80:95]
ds_read_b128 v[152:155], v223 offset:16384
ds_read_b128 v[156:159], v223 offset:20480
s_cmp_eq_u32 s82, 1
s_cbranch_scc0 L_nb_14
s_barrier
L_nb_14:
s_cmp_lg_u32 s5, 0
s_cbranch_scc1 L_fl_15
s_mov_b64 exec, 1
buffer_store_dword v253, v252, s[24:27], 0 offen offset:0 sc1
s_mov_b64 exec, -1
L_fl_15:
v_mfma_f32_16x16x32_bf16 v[164:167], v[160:163], v[128:131], v[164:167]
s_waitcnt lgkmcnt(4)
v_mfma_f32_32x32x16_bf16 v[96:111], v[132:135], v[136:139], v[96:111]
ds_read_b64_tr_b16 v[148:149], v217 offset:12288
ds_read_b64_tr_b16 v[150:151], v217 offset:13312
s_add_u32 m0, s81, 98304
s_add_u32 s79, s79, 221184
buffer_load_dwordx4 v208, s[20:23], s79 offen offset:0 lds
v_mfma_f32_32x32x16_bf16 v[112:127], v[132:135], v[140:143], v[112:127]
v_mfma_f32_16x16x32_bf16 v[168:171], v[160:163], v[132:135], v[168:171]
s_waitcnt lgkmcnt(3)
v_mfma_f32_32x32x16_bf16 v[64:79], v[144:147], v[152:155], v[64:79]
ds_read_b64_tr_b16 v[128:129], v216 offset:32768
ds_read_b64_tr_b16 v[130:131], v216 offset:33792
buffer_load_dwordx4 v209, s[20:23], s79 offen offset:1024 lds
ds_read_b64_tr_b16 v[174:175], v200
ds_read_b64_tr_b16 v[176:177], v200 offset:2560
s_waitcnt lgkmcnt(6)
v_mfma_f32_32x32x16_bf16 v[80:95], v[144:147], v[156:159], v[80:95]
ds_read_b128 v[136:139], v220 offset:49152
ds_read_b128 v[140:143], v220 offset:53248
ds_read_b64_tr_b16 v[178:179], v201
ds_read_b64_tr_b16 v[180:181], v201 offset:2560
v_mfma_f32_16x16x32_bf16 v[164:167], v[160:163], v[144:147], v[164:167]
s_waitcnt lgkmcnt(8)
v_mfma_f32_32x32x16_bf16 v[96:111], v[148:151], v[152:155], v[96:111]
ds_read_b64_tr_b16 v[132:133], v217 offset:32768
ds_read_b64_tr_b16 v[134:135], v217 offset:33792
buffer_load_dwordx4 v210, s[20:23], s79 offen offset:2048 lds
ds_read_b64_tr_b16 v[182:183], v246
ds_read_b64_tr_b16 v[184:185], v246 offset:2560
v_mfma_f32_32x32x16_bf16 v[112:127], v[148:151], v[156:159], v[112:127]
v_mfma_f32_16x16x32_bf16 v[168:171], v[160:163], v[148:151], v[168:171]
s_waitcnt lgkmcnt(7)
v_mfma_f32_32x32x16_bf16 v[64:79], v[128:131], v[136:139], v[64:79]
ds_read_b64_tr_b16 v[144:145], v216 offset:36864
ds_read_b64_tr_b16 v[146:147], v216 offset:37888
buffer_load_dwordx4 v211, s[20:23], s79 offen offset:3072 lds
s_waitcnt lgkmcnt(8)
v_mfma_f32_32x32x16_bf16 v[80:95], v[128:131], v[140:143], v[80:95]
ds_read_b128 v[152:155], v221 offset:49152
ds_read_b128 v[156:159], v221 offset:53248
v_mfma_f32_16x16x32_bf16 v[164:167], v[160:163], v[128:131], v[164:167]
s_waitcnt lgkmcnt(6)
v_mfma_f32_32x32x16_bf16 v[96:111], v[132:135], v[136:139], v[96:111]
ds_read_b64_tr_b16 v[148:149], v217 offset:36864
ds_read_b64_tr_b16 v[150:151], v217 offset:37888
s_add_u32 m0, s81, 114688
s_add_u32 s80, s80, 128
buffer_load_dwordx4 v212, s[8:11], s80 offen offset:0 lds
v_mfma_f32_32x32x16_bf16 v[112:127], v[132:135], v[140:143], v[112:127]
v_mfma_f32_16x16x32_bf16 v[168:171], v[160:163], v[132:135], v[168:171]
s_waitcnt lgkmcnt(3)
v_mfma_f32_32x32x16_bf16 v[64:79], v[144:147], v[152:155], v[64:79]
ds_read_b64_tr_b16 v[128:129], v216 offset:40960
ds_read_b64_tr_b16 v[130:131], v216 offset:41984
buffer_load_dwordx4 v213, s[8:11], s80 offen offset:1024 lds
s_waitcnt lgkmcnt(4)
v_mfma_f32_32x32x16_bf16 v[80:95], v[144:147], v[156:159], v[80:95]
ds_read_b128 v[136:139], v222 offset:49152
ds_read_b128 v[140:143], v222 offset:53248
v_mfma_f32_16x16x32_bf16 v[164:167], v[160:163], v[144:147], v[164:167]
s_waitcnt lgkmcnt(4)
v_mfma_f32_32x32x16_bf16 v[96:111], v[148:151], v[152:155], v[96:111]
ds_read_b64_tr_b16 v[132:133], v217 offset:40960
ds_read_b64_tr_b16 v[134:135], v217 offset:41984
buffer_load_dwordx4 v214, s[8:11], s80 offen offset:2048 lds
v_mfma_f32_32x32x16_bf16 v[112:127], v[148:151], v[156:159], v[112:127]
buffer_load_dword v254, v231, s[24:27], 0 offen sc1
v_mfma_f32_16x16x32_bf16 v[168:171], v[160:163], v[148:151], v[168:171]
s_waitcnt lgkmcnt(3)
v_mfma_f32_32x32x16_bf16 v[64:79], v[128:131], v[136:139], v[64:79]
ds_read_b64_tr_b16 v[144:145], v216 offset:45056
ds_read_b64_tr_b16 v[146:147], v216 offset:46080
s_waitcnt vmcnt(8)
s_cmp_eq_u32 s82, 0
s_cbranch_scc0 L_nb_16
s_barrier
L_nb_16:
buffer_load_dwordx4 v215, s[8:11], s80 offen offset:3072 lds
s_waitcnt lgkmcnt(4)
v_mfma_f32_32x32x16_bf16 v[80:95], v[128:131], v[140:143], v[80:95]
ds_read_b128 v[152:155], v223 offset:49152
ds_read_b128 v[156:159], v223 offset:53248
s_cmp_eq_u32 s82, 1
s_cbranch_scc0 L_nb_17
s_barrier
L_nb_17:
buffer_store_dwordx4 v[174:177], v207, s[24:27], s75 offen sc1
v_mfma_f32_16x16x32_bf16 v[164:167], v[160:163], v[128:131], v[164:167]
s_waitcnt lgkmcnt(4)
v_mfma_f32_32x32x16_bf16 v[96:111], v[132:135], v[136:139], v[96:111]
ds_read_b64_tr_b16 v[148:149], v217 offset:45056
ds_read_b64_tr_b16 v[150:151], v217 offset:46080
s_add_u32 m0, s81, 0
s_add_u32 s79, s79, 221184
buffer_load_dwordx4 v208, s[20:23], s79 offen offset:0 lds
buffer_store_dwordx4 v[178:181], v207, s[24:27], s76 offen sc1
v_mfma_f32_32x32x16_bf16 v[112:127], v[132:135], v[140:143], v[112:127]
v_mfma_f32_16x16x32_bf16 v[168:171], v[160:163], v[132:135], v[168:171]
s_waitcnt lgkmcnt(3)
v_mfma_f32_32x32x16_bf16 v[64:79], v[144:147], v[152:155], v[64:79]
ds_read_b64_tr_b16 v[128:129], v218 offset:0
ds_read_b64_tr_b16 v[130:131], v218 offset:1024
buffer_load_dwordx4 v209, s[20:23], s79 offen offset:1024 lds
s_waitcnt lgkmcnt(4)
v_mfma_f32_32x32x16_bf16 v[80:95], v[144:147], v[156:159], v[80:95]
ds_read_b128 v[136:139], v224 offset:16384
ds_read_b128 v[140:143], v224 offset:20480
v_mfma_f32_16x16x32_bf16 v[164:167], v[160:163], v[144:147], v[164:167]
s_waitcnt lgkmcnt(4)
v_mfma_f32_32x32x16_bf16 v[96:111], v[148:151], v[152:155], v[96:111]
ds_read_b64_tr_b16 v[132:133], v219 offset:0
ds_read_b64_tr_b16 v[134:135], v219 offset:1024
buffer_load_dwordx4 v210, s[20:23], s79 offen offset:2048 lds
v_mfma_f32_32x32x16_bf16 v[112:127], v[148:151], v[156:159], v[112:127]
v_mfma_f32_16x16x32_bf16 v[168:171], v[160:163], v[148:151], v[168:171]
s_waitcnt lgkmcnt(3)
v_mfma_f32_32x32x16_bf16 v[64:79], v[128:131], v[136:139], v[64:79]
ds_read_b64_tr_b16 v[144:145], v218 offset:4096
ds_read_b64_tr_b16 v[146:147], v218 offset:5120
buffer_load_dwordx4 v211, s[20:23], s79 offen offset:3072 lds
s_waitcnt lgkmcnt(4)
v_mfma_f32_32x32x16_bf16 v[80:95], v[128:131], v[140:143], v[80:95]
ds_read_b128 v[152:155], v225 offset:16384
ds_read_b128 v[156:159], v225 offset:20480
v_mfma_f32_16x16x32_bf16 v[164:167], v[160:163], v[128:131], v[164:167]
s_waitcnt lgkmcnt(4)
v_mfma_f32_32x32x16_bf16 v[96:111], v[132:135], v[136:139], v[96:111]
ds_read_b64_tr_b16 v[148:149], v219 offset:4096
ds_read_b64_tr_b16 v[150:151], v219 offset:5120
s_add_u32 m0, s81, 16384
s_add_u32 s80, s80, 128
buffer_load_dwordx4 v212, s[8:11], s80 offen offset:0 lds
v_mfma_f32_32x32x16_bf16 v[112:127], v[132:135], v[140:143], v[112:127]
v_mfma_f32_16x16x32_bf16 v[168:171], v[160:163], v[132:135], v[168:171]
s_waitcnt lgkmcnt(3)
v_mfma_f32_32x32x16_bf16 v[64:79], v[144:147], v[152:155], v[64:79]
ds_read_b64_tr_b16 v[128:129], v218 offset:8192
ds_read_b64_tr_b16 v[130:131], v218 offset:9216
buffer_load_dwordx4 v213, s[8:11], s80 offen offset:1024 lds
s_waitcnt lgkmcnt(4)
v_mfma_f32_32x32x16_bf16 v[80:95], v[144:147], v[156:159], v[80:95]
ds_read_b128 v[136:139], v226 offset:16384
ds_read_b128 v[140:143], v226 offset:20480
v_mfma_f32_16x16x32_bf16 v[164:167], v[160:163], v[144:147], v[164:167]
s_waitcnt lgkmcnt(4)
v_mfma_f32_32x32x16_bf16 v[96:111], v[148:151], v[152:155], v[96:111]
ds_read_b64_tr_b16 v[132:133], v219 offset:8192
ds_read_b64_tr_b16 v[134:135], v219 offset:9216
buffer_load_dwordx4 v214, s[8:11], s80 offen offset:2048 lds
v_mfma_f32_32x32x16_bf16 v[112:127], v[148:151], v[156:159], v[112:127]
v_mfma_f32_16x16x32_bf16 v[168:171], v[160:163], v[148:151], v[168:171]
s_waitcnt lgkmcnt(3)
v_mfma_f32_32x32x16_bf16 v[64:79], v[128:131], v[136:139], v[64:79]
ds_read_b64_tr_b16 v[144:145], v218 offset:12288
ds_read_b64_tr_b16 v[146:147], v218 offset:13312
s_waitcnt vmcnt(9)
s_cmp_eq_u32 s82, 0
s_cbranch_scc0 L_nb_18
s_barrier
L_nb_18:
buffer_load_dwordx4 v215, s[8:11], s80 offen offset:3072 lds
s_waitcnt lgkmcnt(4)
v_mfma_f32_32x32x16_bf16 v[80:95], v[128:131], v[140:143], v[80:95]
ds_read_b128 v[152:155], v227 offset:16384
ds_read_b128 v[156:159], v227 offset:20480
s_cmp_eq_u32 s82, 1
s_cbranch_scc0 L_nb_19
s_barrier
L_nb_19:
buffer_store_dwordx4 v[182:185], v173, s[24:27], s93 offen sc1
v_mfma_f32_16x16x32_bf16 v[164:167], v[160:163], v[128:131], v[164:167]
s_waitcnt lgkmcnt(4)
v_mfma_f32_32x32x16_bf16 v[96:111], v[132:135], v[136:139], v[96:111]
ds_read_b64_tr_b16 v[148:149], v219 offset:12288
ds_read_b64_tr_b16 v[150:151], v219 offset:13312
s_add_u32 m0, s81, 32768
s_add_u32 s79, s79, 221184
buffer_load_dwordx4 v208, s[20:23], s79 offen offset:0 lds
v_mfma_f32_32x32x16_bf16 v[112:127], v[132:135], v[140:143], v[112:127]
v_mfma_f32_16x16x32_bf16 v[168:171], v[160:163], v[132:135], v[168:171]
s_waitcnt lgkmcnt(3)
v_mfma_f32_32x32x16_bf16 v[64:79], v[144:147], v[152:155], v[64:79]
ds_read_b64_tr_b16 v[128:129], v218 offset:32768
ds_read_b64_tr_b16 v[130:131], v218 offset:33792
buffer_load_dwordx4 v209, s[20:23], s79 offen offset:1024 lds
s_waitcnt lgkmcnt(4)
v_mfma_f32_32x32x16_bf16 v[80:95], v[144:147], v[156:159], v[80:95]
ds_read_b128 v[136:139], v224 offset:49152
ds_read_b128 v[140:143], v224 offset:53248
v_mfma_f32_16x16x32_bf16 v[164:167], v[160:163], v[144:147], v[164:167]
s_waitcnt lgkmcnt(4)
v_mfma_f32_32x32x16_bf16 v[96:111], v[148:151], v[152:155], v[96:111]
ds_read_b64_tr_b16 v[132:133], v219 offset:32768
ds_read_b64_tr_b16 v[134:135], v219 offset:33792
buffer_load_dwordx4 v210, s[20:23], s79 offen offset:2048 lds
v_mfma_f32_32x32x16_bf16 v[112:127], v[148:151], v[156:159], v[112:127]
v_mfma_f32_16x16x32_bf16 v[168:171], v[160:163], v[148:151], v[168:171]
s_waitcnt lgkmcnt(3)
v_mfma_f32_32x32x16_bf16 v[64:79], v[128:131], v[136:139], v[64:79]
ds_read_b64_tr_b16 v[144:145], v218 offset:36864
ds_read_b64_tr_b16 v[146:147], v218 offset:37888
buffer_load_dwordx4 v211, s[20:23], s79 offen offset:3072 lds
s_waitcnt lgkmcnt(4)
v_mfma_f32_32x32x16_bf16 v[80:95], v[128:131], v[140:143], v[80:95]
ds_read_b128 v[152:155], v225 offset:49152
ds_read_b128 v[156:159], v225 offset:53248
v_mfma_f32_16x16x32_bf16 v[164:167], v[160:163], v[128:131], v[164:167]
s_waitcnt lgkmcnt(4)
v_mfma_f32_32x32x16_bf16 v[96:111], v[132:135], v[136:139], v[96:111]
ds_read_b64_tr_b16 v[148:149], v219 offset:36864
ds_read_b64_tr_b16 v[150:151], v219 offset:37888
s_add_u32 m0, s81, 49152
s_add_u32 s80, s80, 128
buffer_load_dwordx4 v212, s[8:11], s80 offen offset:0 lds
v_mfma_f32_32x32x16_bf16 v[112:127], v[132:135], v[140:143], v[112:127]
v_mfma_f32_16x16x32_bf16 v[168:171], v[160:163], v[132:135], v[168:171]
s_waitcnt lgkmcnt(3)
v_mfma_f32_32x32x16_bf16 v[64:79], v[144:147], v[152:155], v[64:79]
ds_read_b64_tr_b16 v[128:129], v218 offset:40960
ds_read_b64_tr_b16 v[130:131], v218 offset:41984
buffer_load_dwordx4 v213, s[8:11], s80 offen offset:1024 lds
s_waitcnt lgkmcnt(4)
v_mfma_f32_32x32x16_bf16 v[80:95], v[144:147], v[156:159], v[80:95]
ds_read_b128 v[136:139], v226 offset:49152
ds_read_b128 v[140:143], v226 offset:53248
v_mfma_f32_16x16x32_bf16 v[164:167], v[160:163], v[144:147], v[164:167]
s_waitcnt lgkmcnt(4)
v_mfma_f32_32x32x16_bf16 v[96:111], v[148:151], v[152:155], v[96:111]
ds_read_b64_tr_b16 v[132:133], v219 offset:40960
ds_read_b64_tr_b16 v[134:135], v219 offset:41984
buffer_load_dwordx4 v214, s[8:11], s80 offen offset:2048 lds
v_mfma_f32_32x32x16_bf16 v[112:127], v[148:151], v[156:159], v[112:127]
v_mfma_f32_16x16x32_bf16 v[168:171], v[160:163], v[148:151], v[168:171]
s_waitcnt lgkmcnt(3)
v_mfma_f32_32x32x16_bf16 v[64:79], v[128:131], v[136:139], v[64:79]
ds_read_b64_tr_b16 v[144:145], v218 offset:45056
ds_read_b64_tr_b16 v[146:147], v218 offset:46080
s_waitcnt vmcnt(8)
s_cmp_lg_u32 s5, 0
s_cbranch_scc1 L_back_21
v_cmp_eq_u32 vcc, 0, v254
s_cbranch_vccnz L_slow_20
L_back_21:
s_cmp_eq_u32 s82, 0
s_cbranch_scc0 L_nb_22
s_barrier
L_nb_22:
buffer_load_dwordx4 v215, s[8:11], s80 offen offset:3072 lds
s_waitcnt lgkmcnt(4)
v_mfma_f32_32x32x16_bf16 v[80:95], v[128:131], v[140:143], v[80:95]
ds_read_b128 v[152:155], v227 offset:49152
ds_read_b128 v[156:159], v227 offset:53248
s_cmp_eq_u32 s82, 1
s_cbranch_scc0 L_nb_23
s_barrier
L_nb_23:
s_mov_b32 s36, s56
s_and_b32 s37, s57, 0xffff
s_mov_b32 s38, 3456
s_mov_b32 s39, 0x20000
v_and_b32 v2, 31, v1
s_lshl_b32 s6, s78, 7
s_lshl_b32 s7, s82, 6
s_add_u32 s6, s6, s7
v_add_u32 v3, s6, v2
v_lshlrev_b32 v3, 1, v3
s_cmp_ge_u32 s6, 1728
s_cselect_b32 s101, 0, 32
s_lshl_b32 s6, s77, 7
s_lshl_b32 s7, s83, 6
s_add_u32 s6, s6, s7
v_add_u32 v4, s6, v2
v_lshlrev_b32 v4, 4, v4
v_mov_b32 v5, 2147418112
v_cmp_gt_u32 vcc, 32, v1
v_cndmask_b32 v3, v5, v3, vcc
v_cndmask_b32 v5, v5, v4, vcc
s_mov_b32 s7, 65536
s_mov_b32 s84, 98304
buffer_load_ushort v28, v3, s[36:39], 0 offen
buffer_load_ushort v32, v3, s[36:39], 0 offen offset:64
buffer_load_dwordx4 v[36:39], v5, s[24:27], s7 offen
buffer_load_dwordx4 v[40:43], v5, s[24:27], s7 offen offset:512
buffer_load_dwordx4 v[44:47], v4, s[24:27], s84 offen
buffer_load_dwordx4 v[48:51], v4, s[24:27], s84 offen offset:512
v_mfma_f32_16x16x32_bf16 v[164:167], v[160:163], v[128:131], v[164:167]
s_waitcnt lgkmcnt(4)
v_mfma_f32_32x32x16_bf16 v[96:111], v[132:135], v[136:139], v[96:111]
ds_read_b64_tr_b16 v[148:149], v219 offset:45056
ds_read_b64_tr_b16 v[150:151], v219 offset:46080
s_mov_b32 s32, s48
s_and_b32 s33, s49, 0xffff
s_mov_b32 s34, 2621440
s_mov_b32 s35, 0x20000
s_lshl_b32 s6, s88, 5
s_mul_i32 s7, s5, 24
s_add_u32 s6, s6, s7
v_add_u32 v2, s6, v1
v_lshlrev_b32 v235, 7, v2
s_mov_b32 exec_lo, 0xffffff
s_mov_b32 exec_hi, 0x0
buffer_load_dword v234, v235, s[32:35], 0 offen
s_mov_b64 exec, -1
v_mfma_f32_32x32x16_bf16 v[112:127], v[132:135], v[140:143], v[112:127]
v_mfma_f32_16x16x32_bf16 v[168:171], v[160:163], v[132:135], v[168:171]
s_waitcnt lgkmcnt(3)
v_mfma_f32_32x32x16_bf16 v[64:79], v[144:147], v[152:155], v[64:79]
ds_read_b64_tr_b16 v[128:129], v216 offset:0
ds_read_b64_tr_b16 v[130:131], v216 offset:1024
s_lshl_b32 s6, s5, 2
v_lshlrev_b32 v202, 2, v1
v_add_u32 v202, s6, v202
v_subrev_u32 v202, 252, v202
v_add_u32 v203, s6, v248
v_add_u32 v203, 4, v203
s_mul_i32 s90, s5, 4416
s_lshr_b32 s6, s4, 3
s_waitcnt lgkmcnt(4)
v_mfma_f32_32x32x16_bf16 v[80:95], v[144:147], v[156:159], v[80:95]
ds_read_b128 v[136:139], v220 offset:16384
ds_read_b128 v[140:143], v220 offset:20480
s_mul_i32 s6, s6, 14
s_and_b32 s7, s4, 7
s_mul_i32 s7, s7, 7
s_add_u32 s6, s6, s7
s_lshr_b32 s6, s6, 2
s_cmp_ge_u32 s5, 2
s_cselect_b32 s43, 13, 14
s_cmp_ge_u32 s6, s43
s_cselect_b32 s7, s43, 0
v_mfma_f32_16x16x32_bf16 v[164:167], v[160:163], v[144:147], v[164:167]
s_waitcnt lgkmcnt(4)
v_mfma_f32_32x32x16_bf16 v[96:111], v[148:151], v[152:155], v[96:111]
ds_read_b64_tr_b16 v[132:133], v217 offset:0
ds_read_b64_tr_b16 v[134:135], v217 offset:1024
s_sub_u32 s93, s6, s7
s_mov_b32 s93, 0
s_mul_i32 s6, s95, 54
s_add_u32 s6, s6, s96
s_mul_i32 s79, s6, 5120
s_add_u32 s79, s79, 7340032
s_mul_i32 s7, s43, 5120
s_add_u32 s80, s79, s7
v_mfma_f32_32x32x16_bf16 v[112:127], v[148:151], v[156:159], v[112:127]
s_mul_i32 s7, s93, 5120
s_add_u32 s97, s79, s7
s_add_u32 s98, s97, 4096
v_and_b32 v2, 15, v1
v_lshrrev_b32 v3, 3, v2
v_lshlrev_b32 v3, 3, v3
v_and_b32 v4, 1, v2
v_lshl_or_b32 v3, v4, 2, v3
v_mfma_f32_16x16x32_bf16 v[168:171], v[160:163], v[148:151], v[168:171]
s_waitcnt lgkmcnt(3)
v_mfma_f32_32x32x16_bf16 v[64:79], v[128:131], v[136:139], v[64:79]
ds_read_b64_tr_b16 v[144:145], v216 offset:4096
ds_read_b64_tr_b16 v[146:147], v216 offset:5120
v_bfe_u32 v4, v2, 1, 2
v_or_b32 v3, v3, v4
v_lshlrev_b32 v3, 4, v3
v_bfe_u32 v4, v1, 4, 1
v_lshl_or_b32 v3, v4, 10, v3
v_lshrrev_b32 v4, 5, v1
v_lshl_or_b32 v3, v4, 8, v3
v_mov_b32 v4, 2147418112
s_waitcnt lgkmcnt(4)
v_mfma_f32_32x32x16_bf16 v[80:95], v[128:131], v[140:143], v[80:95]
ds_read_b128 v[152:155], v221 offset:16384
ds_read_b128 v[156:159], v221 offset:20480
s_cmp_eq_u32 s101, 0
s_cselect_b64 vcc, -1, 0
v_cndmask_b32 v60, v3, v4, vcc
s_lshl_b32 s6, s77, 1
s_add_u32 s6, s6, s83
s_mul_i32 s6, s6, 54
s_lshl_b32 s7, s78, 2
s_add_u32 s6, s6, s7
v_mfma_f32_16x16x32_bf16 v[164:167], v[160:163], v[128:131], v[164:167]
s_waitcnt lgkmcnt(4)
v_mfma_f32_32x32x16_bf16 v[96:111], v[132:135], v[136:139], v[96:111]
ds_read_b64_tr_b16 v[148:149], v217 offset:4096
ds_read_b64_tr_b16 v[150:151], v217 offset:5120
s_lshl_b32 s7, s82, 1
s_add_u32 s6, s6, s7
s_lshl_b32 s6, s6, 12
s_add_u32 s100, s6, 10485760
s_add_u32 s101, s100, 4096
s_lshl_b32 s6, s89, 2
s_add_u32 s6, s6, s5
s_lshl_b32 s7, s6, 1
v_mfma_f32_32x32x16_bf16 v[112:127], v[132:135], v[140:143], v[112:127]
s_lshr_b32 s85, 6436, s7
s_and_b32 s85, s85, 3
s_lshr_b32 s86, 55, s6
s_and_b32 s86, s86, 1
s_lshr_b32 s87, 61311, s7
s_and_b32 s87, s87, 3
v_and_b32 v2, 3, v1
v_mul_u32_u24 v2, 4416, v2
v_mfma_f32_16x16x32_bf16 v[168:171], v[160:163], v[132:135], v[168:171]
s_waitcnt lgkmcnt(3)
v_mfma_f32_32x32x16_bf16 v[64:79], v[144:147], v[152:155], v[64:79]
ds_read_b64_tr_b16 v[128:129], v216 offset:8192
ds_read_b64_tr_b16 v[130:131], v216 offset:9216
v_bfe_u32 v3, v1, 2, 2
v_lshrrev_b32 v18, 4, v1
v_add_u32 v3, v3, v18
v_lshl_add_u32 v16, v3, 4, v2
v_and_b32 v2, 1, v1
v_mul_u32_u24 v2, 6272, v2
v_bfe_u32 v3, v1, 1, 3
s_lshl_b32 s6, s86, 3
s_waitcnt lgkmcnt(4)
v_mfma_f32_32x32x16_bf16 v[80:95], v[144:147], v[156:159], v[80:95]
ds_read_b128 v[136:139], v222 offset:16384
ds_read_b128 v[140:143], v222 offset:20480
s_sub_u32 s6, 15, s6
v_sub_u32 v5, s6, v3
v_mul_u32_u24 v5, 272, v5
v_add_u32 v2, v2, v5
v_lshl_add_u32 v17, v18, 4, v2
s_lshl_b32 s6, s86, 3
v_add_u32 v3, s6, v3
v_lshlrev_b32 v3, 8, v3
v_mfma_f32_16x16x32_bf16 v[164:167], v[160:163], v[144:147], v[164:167]
s_waitcnt lgkmcnt(4)
v_mfma_f32_32x32x16_bf16 v[96:111], v[148:151], v[152:155], v[96:111]
ds_read_b64_tr_b16 v[132:133], v217 offset:8192
ds_read_b64_tr_b16 v[134:135], v217 offset:9216
v_and_b32 v2, 1, v1
v_lshl_or_b32 v2, v18, 1, v2
v_lshl_or_b32 v11, v2, 4, v3
s_mul_i32 s6, s85, 30208
s_add_u32 s6, s6, 65536
v_add_u32 v8, s6, v16
s_add_u32 s6, s6, 17664
v_add_u32 v9, s6, v17
v_mfma_f32_32x32x16_bf16 v[112:127], v[148:151], v[156:159], v[112:127]
v_lshlrev_b32 v10, 5, v18
v_sub_u32 v10, v9, v10
v_add_u32 v10, 0, v10
s_add_u32 s91, s88, s85
v_mfma_f32_16x16x32_bf16 v[168:171], v[160:163], v[148:151], v[168:171]
s_waitcnt lgkmcnt(3)
v_mfma_f32_32x32x16_bf16 v[64:79], v[128:131], v[136:139], v[64:79]
ds_read_b64_tr_b16 v[144:145], v216 offset:12288
ds_read_b64_tr_b16 v[146:147], v216 offset:13312
s_waitcnt vmcnt(7)
s_cmp_eq_u32 s82, 0
s_cbranch_scc0 L_nb_24
s_barrier
L_nb_24:
s_waitcnt lgkmcnt(4)
v_mfma_f32_32x32x16_bf16 v[80:95], v[128:131], v[140:143], v[80:95]
ds_read_b128 v[152:155], v223 offset:16384
ds_read_b128 v[156:159], v223 offset:20480
s_cmp_eq_u32 s82, 1
s_cbranch_scc0 L_nb_25
s_barrier
L_nb_25:
s_cmp_lg_u32 s5, 0
s_cbranch_scc1 L_fl_26
s_mov_b64 exec, 1
buffer_store_dword v253, v252, s[24:27], 0 offen offset:12 sc1
s_mov_b64 exec, -1
L_fl_26:
v_mfma_f32_16x16x32_bf16 v[164:167], v[160:163], v[128:131], v[164:167]
s_waitcnt lgkmcnt(4)
v_mfma_f32_32x32x16_bf16 v[96:111], v[132:135], v[136:139], v[96:111]
ds_read_b64_tr_b16 v[148:149], v217 offset:12288
ds_read_b64_tr_b16 v[150:151], v217 offset:13312
v_mfma_f32_32x32x16_bf16 v[112:127], v[132:135], v[140:143], v[112:127]
v_mfma_f32_16x16x32_bf16 v[168:171], v[160:163], v[132:135], v[168:171]
s_waitcnt lgkmcnt(3)
v_mfma_f32_32x32x16_bf16 v[64:79], v[144:147], v[152:155], v[64:79]
ds_read_b64_tr_b16 v[128:129], v216 offset:32768
ds_read_b64_tr_b16 v[130:131], v216 offset:33792
v_lshlrev_b32 v5, 4, v0
v_add_u32 v5, 87552, v5
v_add_u32 v7, 60416, v5
v_mov_b32 v12, 0
s_waitcnt lgkmcnt(4)
v_mfma_f32_32x32x16_bf16 v[80:95], v[144:147], v[156:159], v[80:95]
ds_read_b128 v[136:139], v220 offset:49152
ds_read_b128 v[140:143], v220 offset:53248
v_mov_b32 v13, 0
v_mov_b32 v14, 0
v_mov_b32 v15, 0
v_mfma_f32_16x16x32_bf16 v[164:167], v[160:163], v[144:147], v[164:167]
s_waitcnt lgkmcnt(4)
v_mfma_f32_32x32x16_bf16 v[96:111], v[148:151], v[152:155], v[96:111]
ds_read_b64_tr_b16 v[132:133], v217 offset:32768
ds_read_b64_tr_b16 v[134:135], v217 offset:33792
v_cmp_gt_u32 vcc, 119, v0
s_and_saveexec_b64 s[6:7], vcc
ds_write_b128 v5, v[12:15] offset:0
ds_write_b128 v5, v[12:15] offset:6272
ds_write_b128 v5, v[12:15] offset:30208
ds_write_b128 v5, v[12:15] offset:36480
ds_write_b128 v7, v[12:15] offset:0
ds_write_b128 v7, v[12:15] offset:6272
s_mov_b64 exec, s[6:7]
v_mfma_f32_32x32x16_bf16 v[112:127], v[148:151], v[156:159], v[112:127]
v_mfma_f32_16x16x32_bf16 v[168:171], v[160:163], v[148:151], v[168:171]
s_waitcnt lgkmcnt(9)
v_mfma_f32_32x32x16_bf16 v[64:79], v[128:131], v[136:139], v[64:79]
ds_read_b64_tr_b16 v[144:145], v216 offset:36864
ds_read_b64_tr_b16 v[146:147], v216 offset:37888
s_waitcnt lgkmcnt(10)
v_mfma_f32_32x32x16_bf16 v[80:95], v[128:131], v[140:143], v[80:95]
ds_read_b128 v[152:155], v221 offset:49152
ds_read_b128 v[156:159], v221 offset:53248
v_mfma_f32_16x16x32_bf16 v[164:167], v[160:163], v[128:131], v[164:167]
s_waitcnt lgkmcnt(10)
v_mfma_f32_32x32x16_bf16 v[96:111], v[132:135], v[136:139], v[96:111]
ds_read_b64_tr_b16 v[148:149], v217 offset:36864
ds_read_b64_tr_b16 v[150:151], v217 offset:37888
v_mfma_f32_32x32x16_bf16 v[112:127], v[132:135], v[140:143], v[112:127]
v_mfma_f32_16x16x32_bf16 v[168:171], v[160:163], v[132:135], v[168:171]
s_waitcnt lgkmcnt(3)
v_mfma_f32_32x32x16_bf16 v[64:79], v[144:147], v[152:155], v[64:79]
ds_read_b64_tr_b16 v[128:129], v216 offset:40960
ds_read_b64_tr_b16 v[130:131], v216 offset:41984
s_waitcnt lgkmcnt(4)
v_mfma_f32_32x32x16_bf16 v[80:95], v[144:147], v[156:159], v[80:95]
ds_read_b128 v[136:139], v222 offset:49152
ds_read_b128 v[140:143], v222 offset:53248
v_mfma_f32_16x16x32_bf16 v[164:167], v[160:163], v[144:147], v[164:167]
s_waitcnt lgkmcnt(4)
v_mfma_f32_32x32x16_bf16 v[96:111], v[148:151], v[152:155], v[96:111]
ds_read_b64_tr_b16 v[132:133], v217 offset:40960
ds_read_b64_tr_b16 v[134:135], v217 offset:41984
v_mfma_f32_32x32x16_bf16 v[112:127], v[148:151], v[156:159], v[112:127]
v_mfma_f32_16x16x32_bf16 v[168:171], v[160:163], v[148:151], v[168:171]
s_waitcnt lgkmcnt(3)
v_mfma_f32_32x32x16_bf16 v[64:79], v[128:131], v[136:139], v[64:79]
ds_read_b64_tr_b16 v[144:145], v216 offset:45056
ds_read_b64_tr_b16 v[146:147], v216 offset:46080
s_waitcnt lgkmcnt(4)
v_mfma_f32_32x32x16_bf16 v[80:95], v[128:131], v[140:143], v[80:95]
ds_read_b128 v[152:155], v223 offset:49152
ds_read_b128 v[156:159], v223 offset:53248
v_mfma_f32_16x16x32_bf16 v[164:167], v[160:163], v[128:131], v[164:167]
s_waitcnt lgkmcnt(4)
v_mfma_f32_32x32x16_bf16 v[96:111], v[132:135], v[136:139], v[96:111]
ds_read_b64_tr_b16 v[148:149], v217 offset:45056
ds_read_b64_tr_b16 v[150:151], v217 offset:46080
v_mfma_f32_32x32x16_bf16 v[112:127], v[132:135], v[140:143], v[112:127]
v_mfma_f32_16x16x32_bf16 v[168:171], v[160:163], v[132:135], v[168:171]
s_waitcnt lgkmcnt(3)
v_mfma_f32_32x32x16_bf16 v[64:79], v[144:147], v[152:155], v[64:79]
s_waitcnt lgkmcnt(2)
v_mfma_f32_32x32x16_bf16 v[80:95], v[144:147], v[156:159], v[80:95]
v_mfma_f32_16x16x32_bf16 v[164:167], v[160:163], v[144:147], v[164:167]
s_waitcnt lgkmcnt(0)
v_mfma_f32_32x32x16_bf16 v[96:111], v[148:151], v[152:155], v[96:111]
v_mfma_f32_32x32x16_bf16 v[112:127], v[148:151], v[156:159], v[112:127]
v_mfma_f32_16x16x32_bf16 v[168:171], v[160:163], v[148:151], v[168:171]
s_waitcnt vmcnt(1)
s_nop 7
v_lshl_or_b32 v28, v28, 16, v28
v_cvt_pk_bf16_f32 v29, v164, v164
v_lshlrev_b32 v2, 16, v29
v_sub_f32 v2, v164, v2
v_cvt_pk_bf16_f32 v30, v2, v2
v_mov_b32 v31, 0
v_lshl_or_b32 v32, v32, 16, v32
v_cvt_pk_bf16_f32 v33, v168, v168
v_lshlrev_b32 v2, 16, v33
v_sub_f32 v2, v168, v2
v_cvt_pk_bf16_f32 v34, v2, v2
v_mov_b32 v35, 0
s_nop 1
v_mfma_f32_32x32x16_bf16 v[64:79], v[28:31], v[36:39], v[64:79]
v_mfma_f32_32x32x16_bf16 v[80:95], v[28:31], v[40:43], v[80:95]
v_mfma_f32_32x32x16_bf16 v[96:111], v[32:35], v[36:39], v[96:111]
v_mfma_f32_32x32x16_bf16 v[112:127], v[32:35], v[40:43], v[112:127]
v_mul_f32 v52, -2.302208198144325, v45
v_mul_f32 v2, v45, v45
v_mul_f32 v2, v2, v45
v_mul_f32 v53, -0.1029432395800235, v2
v_mov_b32 v54, v46
v_mov_b32 v55, v46
v_mul_f32 v56, -2.302208198144325, v49
v_mul_f32 v2, v49, v49
v_mul_f32 v2, v2, v49
v_mul_f32 v57, -0.1029432395800235, v2
v_mov_b32 v58, v50
v_mov_b32 v59, v50
s_add_u32 s6, s88, 0
s_lshl_b32 s6, s6, 12
s_add_u32 s32, s48, s6
s_addc_u32 s33, s49, 0
s_and_b32 s33, s33, 0xffff
s_mov_b32 s34, 4096
s_mov_b32 s35, 0x20000
s_add_u32 m0, s90, 65536
s_nop 0
buffer_load_dword v202, s[32:35], 0 offen lds
s_add_u32 m0, s90, 65792
s_nop 0
buffer_load_dwordx4 v203, s[32:35], 0 offen offset:0 lds
buffer_load_dwordx4 v203, s[32:35], 0 offen offset:1024 lds
buffer_load_dwordx4 v203, s[32:35], 0 offen offset:2048 lds
buffer_load_dwordx4 v203, s[32:35], 0 offen offset:3072 lds
buffer_load_dword v251, v229, s[24:27], 0 offen sc1
v_pk_mul_f32 v[160:161], v[64:65], v[64:65]
v_pk_mul_f32 v[162:163], v[66:67], v[66:67]
v_pk_mul_f32 v[164:165], v[68:69], v[68:69]
v_pk_mul_f32 v[166:167], v[70:71], v[70:71]
v_pk_fma_f32 v[160:161], v[160:161], v[52:53], v[52:53] op_sel:[0,1,0] op_sel_hi:[1,1,0]
v_pk_fma_f32 v[162:163], v[162:163], v[52:53], v[52:53] op_sel:[0,1,0] op_sel_hi:[1,1,0]
v_pk_fma_f32 v[164:165], v[164:165], v[52:53], v[52:53] op_sel:[0,1,0] op_sel_hi:[1,1,0]
v_pk_fma_f32 v[166:167], v[166:167], v[52:53], v[52:53] op_sel:[0,1,0] op_sel_hi:[1,1,0]
v_pk_mul_f32 v[160:161], v[160:161], v[64:65]
v_pk_mul_f32 v[162:163], v[162:163], v[66:67]
v_pk_mul_f32 v[164:165], v[164:165], v[68:69]
v_pk_mul_f32 v[166:167], v[166:167], v[70:71]
v_exp_f32 v160, v160
v_exp_f32 v161, v161
v_exp_f32 v162, v162
v_exp_f32 v163, v163
v_exp_f32 v164, v164
v_exp_f32 v165, v165
v_exp_f32 v166, v166
v_exp_f32 v167, v167
v_pk_fma_f32 v[160:161], v[160:161], v[54:55], v[54:55]
v_pk_fma_f32 v[162:163], v[162:163], v[54:55], v[54:55]
v_pk_fma_f32 v[164:165], v[164:165], v[54:55], v[54:55]
v_pk_fma_f32 v[166:167], v[166:167], v[54:55], v[54:55]
v_rcp_f32 v160, v160
v_rcp_f32 v161, v161
v_rcp_f32 v162, v162
v_rcp_f32 v163, v163
v_rcp_f32 v164, v164
v_rcp_f32 v165, v165
v_rcp_f32 v166, v166
v_rcp_f32 v167, v167
v_pk_mul_f32 v[160:161], v[160:161], v[64:65]
v_pk_mul_f32 v[162:163], v[162:163], v[66:67]
v_pk_mul_f32 v[164:165], v[164:165], v[68:69]
v_pk_mul_f32 v[166:167], v[166:167], v[70:71]
v_cvt_pk_bf16_f32 v64, v160, v161
v_cvt_pk_bf16_f32 v65, v162, v163
v_cvt_pk_bf16_f32 v66, v164, v165
v_cvt_pk_bf16_f32 v67, v166, v167
buffer_store_dwordx4 v[64:67], v60, s[24:27], s100 offen offset:0 sc1
s_add_u32 s6, s88, 1
s_lshl_b32 s6, s6, 12
s_add_u32 s32, s48, s6
s_addc_u32 s33, s49, 0
s_and_b32 s33, s33, 0xffff
s_mov_b32 s34, 4096
s_mov_b32 s35, 0x20000
s_add_u32 m0, s90, 95744
s_nop 0
buffer_load_dword v202, s[32:35], 0 offen lds
s_add_u32 m0, s90, 96000
s_nop 0
buffer_load_dwordx4 v203, s[32:35], 0 offen offset:0 lds
buffer_load_dwordx4 v203, s[32:35], 0 offen offset:1024 lds
buffer_load_dwordx4 v203, s[32:35], 0 offen offset:2048 lds
buffer_load_dwordx4 v203, s[32:35], 0 offen offset:3072 lds
buffer_load_dword v254, v228, s[24:27], 0 offen sc1
v_pk_mul_f32 v[160:161], v[72:73], v[72:73]
v_pk_mul_f32 v[162:163], v[74:75], v[74:75]
v_pk_mul_f32 v[164:165], v[76:77], v[76:77]
v_pk_mul_f32 v[166:167], v[78:79], v[78:79]
v_pk_fma_f32 v[160:161], v[160:161], v[52:53], v[52:53] op_sel:[0,1,0] op_sel_hi:[1,1,0]
v_pk_fma_f32 v[162:163], v[162:163], v[52:53], v[52:53] op_sel:[0,1,0] op_sel_hi:[1,1,0]
v_pk_fma_f32 v[164:165], v[164:165], v[52:53], v[52:53] op_sel:[0,1,0] op_sel_hi:[1,1,0]
v_pk_fma_f32 v[166:167], v[166:167], v[52:53], v[52:53] op_sel:[0,1,0] op_sel_hi:[1,1,0]
v_pk_mul_f32 v[160:161], v[160:161], v[72:73]
v_pk_mul_f32 v[162:163], v[162:163], v[74:75]
v_pk_mul_f32 v[164:165], v[164:165], v[76:77]
v_pk_mul_f32 v[166:167], v[166:167], v[78:79]
v_exp_f32 v160, v160
v_exp_f32 v161, v161
v_exp_f32 v162, v162
v_exp_f32 v163, v163
v_exp_f32 v164, v164
v_exp_f32 v165, v165
v_exp_f32 v166, v166
v_exp_f32 v167, v167
v_pk_fma_f32 v[160:161], v[160:161], v[54:55], v[54:55]
v_pk_fma_f32 v[162:163], v[162:163], v[54:55], v[54:55]
v_pk_fma_f32 v[164:165], v[164:165], v[54:55], v[54:55]
v_pk_fma_f32 v[166:167], v[166:167], v[54:55], v[54:55]
v_rcp_f32 v160, v160
v_rcp_f32 v161, v161
v_rcp_f32 v162, v162
v_rcp_f32 v163, v163
v_rcp_f32 v164, v164
v_rcp_f32 v165, v165
v_rcp_f32 v166, v166
v_rcp_f32 v167, v167
v_pk_mul_f32 v[160:161], v[160:161], v[72:73]
v_pk_mul_f32 v[162:163], v[162:163], v[74:75]
v_pk_mul_f32 v[164:165], v[164:165], v[76:77]
v_pk_mul_f32 v[166:167], v[166:167], v[78:79]
v_cvt_pk_bf16_f32 v72, v160, v161
v_cvt_pk_bf16_f32 v73, v162, v163
v_cvt_pk_bf16_f32 v74, v164, v165
v_cvt_pk_bf16_f32 v75, v166, v167
buffer_store_dwordx4 v[72:75], v60, s[24:27], s100 offen offset:512 sc1
s_add_u32 s6, s88, 2
s_lshl_b32 s6, s6, 12
s_add_u32 s32, s48, s6
s_addc_u32 s33, s49, 0
s_and_b32 s33, s33, 0xffff
s_mov_b32 s34, 4096
s_mov_b32 s35, 0x20000
s_add_u32 m0, s90, 125952
s_nop 0
buffer_load_dword v202, s[32:35], 0 offen lds
s_add_u32 m0, s90, 126208
s_nop 0
buffer_load_dwordx4 v203, s[32:35], 0 offen offset:0 lds
buffer_load_dwordx4 v203, s[32:35], 0 offen offset:1024 lds
buffer_load_dwordx4 v203, s[32:35], 0 offen offset:2048 lds
buffer_load_dwordx4 v203, s[32:35], 0 offen offset:3072 lds
v_pk_mul_f32 v[160:161], v[80:81], v[80:81]
v_pk_mul_f32 v[162:163], v[82:83], v[82:83]
v_pk_mul_f32 v[164:165], v[84:85], v[84:85]
v_pk_mul_f32 v[166:167], v[86:87], v[86:87]
v_pk_fma_f32 v[160:161], v[160:161], v[56:57], v[56:57] op_sel:[0,1,0] op_sel_hi:[1,1,0]
v_pk_fma_f32 v[162:163], v[162:163], v[56:57], v[56:57] op_sel:[0,1,0] op_sel_hi:[1,1,0]
v_pk_fma_f32 v[164:165], v[164:165], v[56:57], v[56:57] op_sel:[0,1,0] op_sel_hi:[1,1,0]
v_pk_fma_f32 v[166:167], v[166:167], v[56:57], v[56:57] op_sel:[0,1,0] op_sel_hi:[1,1,0]
v_pk_mul_f32 v[160:161], v[160:161], v[80:81]
v_pk_mul_f32 v[162:163], v[162:163], v[82:83]
v_pk_mul_f32 v[164:165], v[164:165], v[84:85]
v_pk_mul_f32 v[166:167], v[166:167], v[86:87]
v_exp_f32 v160, v160
v_exp_f32 v161, v161
v_exp_f32 v162, v162
v_exp_f32 v163, v163
v_exp_f32 v164, v164
v_exp_f32 v165, v165
v_exp_f32 v166, v166
v_exp_f32 v167, v167
v_pk_fma_f32 v[160:161], v[160:161], v[58:59], v[58:59]
v_pk_fma_f32 v[162:163], v[162:163], v[58:59], v[58:59]
v_pk_fma_f32 v[164:165], v[164:165], v[58:59], v[58:59]
v_pk_fma_f32 v[166:167], v[166:167], v[58:59], v[58:59]
v_rcp_f32 v160, v160
v_rcp_f32 v161, v161
v_rcp_f32 v162, v162
v_rcp_f32 v163, v163
v_rcp_f32 v164, v164
v_rcp_f32 v165, v165
v_rcp_f32 v166, v166
v_rcp_f32 v167, v167
v_pk_mul_f32 v[160:161], v[160:161], v[80:81]
v_pk_mul_f32 v[162:163], v[162:163], v[82:83]
v_pk_mul_f32 v[164:165], v[164:165], v[84:85]
v_pk_mul_f32 v[166:167], v[166:167], v[86:87]
v_cvt_pk_bf16_f32 v80, v160, v161
v_cvt_pk_bf16_f32 v81, v162, v163
v_cvt_pk_bf16_f32 v82, v164, v165
v_cvt_pk_bf16_f32 v83, v166, v167
buffer_store_dwordx4 v[80:83], v60, s[24:27], s100 offen offset:2048 sc1
s_waitcnt vmcnt(14)
v_cmp_eq_u32 vcc, 0, v251
s_cbranch_vccnz L_slow_27
L_back_28:
v_lshlrev_b32 v4, 4, v0
s_add_u32 s6, s88, 0
s_lshl_b32 s6, s6, 12
s_add_u32 s6, s6, 1048576
s_add_u32 s36, s66, s6
s_addc_u32 s37, s67, 0
s_and_b32 s37, s37, 0xffff
s_mov_b32 s38, 4096
s_mov_b32 s39, 0x20000
buffer_load_dwordx4 v[32:35], v4, s[36:39], 0 offen
buffer_load_dword v36, v4, s[36:39], 0 offen offset:16
s_add_u32 s6, s88, 1
s_lshl_b32 s6, s6, 12
s_add_u32 s6, s6, 1048576
s_add_u32 s36, s66, s6
s_addc_u32 s37, s67, 0
s_and_b32 s37, s37, 0xffff
s_mov_b32 s38, 4096
s_mov_b32 s39, 0x20000
buffer_load_dwordx4 v[38:41], v4, s[36:39], 0 offen
buffer_load_dword v42, v4, s[36:39], 0 offen offset:16
s_add_u32 s6, s88, 2
s_lshl_b32 s6, s6, 12
s_add_u32 s6, s6, 1048576
s_add_u32 s36, s66, s6
s_addc_u32 s37, s67, 0
s_and_b32 s37, s37, 0xffff
s_mov_b32 s38, 4096
s_mov_b32 s39, 0x20000
buffer_load_dwordx4 v[44:47], v4, s[36:39], 0 offen
buffer_load_dword v48, v4, s[36:39], 0 offen offset:16
v_pk_mul_f32 v[160:161], v[88:89], v[88:89]
v_pk_mul_f32 v[162:163], v[90:91], v[90:91]
v_pk_mul_f32 v[164:165], v[92:93], v[92:93]
v_pk_mul_f32 v[166:167], v[94:95], v[94:95]
v_pk_fma_f32 v[160:161], v[160:161], v[56:57], v[56:57] op_sel:[0,1,0] op_sel_hi:[1,1,0]
v_pk_fma_f32 v[162:163], v[162:163], v[56:57], v[56:57] op_sel:[0,1,0] op_sel_hi:[1,1,0]
v_pk_fma_f32 v[164:165], v[164:165], v[56:57], v[56:57] op_sel:[0,1,0] op_sel_hi:[1,1,0]
v_pk_fma_f32 v[166:167], v[166:167], v[56:57], v[56:57] op_sel:[0,1,0] op_sel_hi:[1,1,0]
v_pk_mul_f32 v[160:161], v[160:161], v[88:89]
v_pk_mul_f32 v[162:163], v[162:163], v[90:91]
v_pk_mul_f32 v[164:165], v[164:165], v[92:93]
v_pk_mul_f32 v[166:167], v[166:167], v[94:95]
v_exp_f32 v160, v160
v_exp_f32 v161, v161
v_exp_f32 v162, v162
v_exp_f32 v163, v163
v_exp_f32 v164, v164
v_exp_f32 v165, v165
v_exp_f32 v166, v166
v_exp_f32 v167, v167
v_pk_fma_f32 v[160:161], v[160:161], v[58:59], v[58:59]
v_pk_fma_f32 v[162:163], v[162:163], v[58:59], v[58:59]
v_pk_fma_f32 v[164:165], v[164:165], v[58:59], v[58:59]
v_pk_fma_f32 v[166:167], v[166:167], v[58:59], v[58:59]
v_rcp_f32 v160, v160
v_rcp_f32 v161, v161
v_rcp_f32 v162, v162
v_rcp_f32 v163, v163
v_rcp_f32 v164, v164
v_rcp_f32 v165, v165
v_rcp_f32 v166, v166
v_rcp_f32 v167, v167
v_pk_mul_f32 v[160:161], v[160:161], v[88:89]
v_pk_mul_f32 v[162:163], v[162:163], v[90:91]
v_pk_mul_f32 v[164:165], v[164:165], v[92:93]
v_pk_mul_f32 v[166:167], v[166:167], v[94:95]
v_cvt_pk_bf16_f32 v88, v160, v161
v_cvt_pk_bf16_f32 v89, v162, v163
v_cvt_pk_bf16_f32 v90, v164, v165
v_cvt_pk_bf16_f32 v91, v166, v167
buffer_store_dwordx4 v[88:91], v60, s[24:27], s100 offen offset:2560 sc1
s_waitcnt vmcnt(14)
v_cmp_eq_u32 vcc, 0, v254
s_cbranch_vccnz L_slow_29
L_back_30:
buffer_load_dwordx4 a[0:3], v248, s[24:27], s97 offen offset:0
buffer_load_dwordx4 a[4:7], v248, s[24:27], s97 offen offset:1024
buffer_load_dwordx4 a[8:11], v248, s[24:27], s97 offen offset:2048
buffer_load_dwordx4 a[12:15], v248, s[24:27], s97 offen offset:3072
buffer_load_dwordx4 a[16:19], v248, s[24:27], s98 offen
s_add_u32 s97, s97, 5120
s_cmp_eq_u32 s97, s80
s_cselect_b32 s97, s79, s97
s_add_u32 s98, s97, 4096
v_pk_mul_f32 v[160:161], v[96:97], v[96:97]
v_pk_mul_f32 v[162:163], v[98:99], v[98:99]
v_pk_mul_f32 v[164:165], v[100:101], v[100:101]
v_pk_mul_f32 v[166:167], v[102:103], v[102:103]
v_pk_fma_f32 v[160:161], v[160:161], v[52:53], v[52:53] op_sel:[0,1,0] op_sel_hi:[1,1,0]
v_pk_fma_f32 v[162:163], v[162:163], v[52:53], v[52:53] op_sel:[0,1,0] op_sel_hi:[1,1,0]
v_pk_fma_f32 v[164:165], v[164:165], v[52:53], v[52:53] op_sel:[0,1,0] op_sel_hi:[1,1,0]
v_pk_fma_f32 v[166:167], v[166:167], v[52:53], v[52:53] op_sel:[0,1,0] op_sel_hi:[1,1,0]
v_pk_mul_f32 v[160:161], v[160:161], v[96:97]
v_pk_mul_f32 v[162:163], v[162:163], v[98:99]
v_pk_mul_f32 v[164:165], v[164:165], v[100:101]
v_pk_mul_f32 v[166:167], v[166:167], v[102:103]
v_exp_f32 v160, v160
v_exp_f32 v161, v161
v_exp_f32 v162, v162
v_exp_f32 v163, v163
v_exp_f32 v164, v164
v_exp_f32 v165, v165
v_exp_f32 v166, v166
v_exp_f32 v167, v167
v_pk_fma_f32 v[160:161], v[160:161], v[54:55], v[54:55]
v_pk_fma_f32 v[162:163], v[162:163], v[54:55], v[54:55]
v_pk_fma_f32 v[164:165], v[164:165], v[54:55], v[54:55]
v_pk_fma_f32 v[166:167], v[166:167], v[54:55], v[54:55]
v_rcp_f32 v160, v160
v_rcp_f32 v161, v161
v_rcp_f32 v162, v162
v_rcp_f32 v163, v163
v_rcp_f32 v164, v164
v_rcp_f32 v165, v165
v_rcp_f32 v166, v166
v_rcp_f32 v167, v167
v_pk_mul_f32 v[160:161], v[160:161], v[96:97]
v_pk_mul_f32 v[162:163], v[162:163], v[98:99]
v_pk_mul_f32 v[164:165], v[164:165], v[100:101]
v_pk_mul_f32 v[166:167], v[166:167], v[102:103]
v_cvt_pk_bf16_f32 v96, v160, v161
v_cvt_pk_bf16_f32 v97, v162, v163
v_cvt_pk_bf16_f32 v98, v164, v165
v_cvt_pk_bf16_f32 v99, v166, v167
buffer_store_dwordx4 v[96:99], v60, s[24:27], s101 offen offset:0 sc1
buffer_load_dwordx4 a[20:23], v248, s[24:27], s97 offen offset:0
buffer_load_dwordx4 a[24:27], v248, s[24:27], s97 offen offset:1024
buffer_load_dwordx4 a[28:31], v248, s[24:27], s97 offen offset:2048
buffer_load_dwordx4 a[32:35], v248, s[24:27], s97 offen offset:3072
buffer_load_dwordx4 a[36:39], v248, s[24:27], s98 offen
s_add_u32 s97, s97, 5120
s_cmp_eq_u32 s97, s80
s_cselect_b32 s97, s79, s97
s_add_u32 s98, s97, 4096
v_pk_mul_f32 v[160:161], v[104:105], v[104:105]
v_pk_mul_f32 v[162:163], v[106:107], v[106:107]
v_pk_mul_f32 v[164:165], v[108:109], v[108:109]
v_pk_mul_f32 v[166:167], v[110:111], v[110:111]
v_pk_fma_f32 v[160:161], v[160:161], v[52:53], v[52:53] op_sel:[0,1,0] op_sel_hi:[1,1,0]
v_pk_fma_f32 v[162:163], v[162:163], v[52:53], v[52:53] op_sel:[0,1,0] op_sel_hi:[1,1,0]
v_pk_fma_f32 v[164:165], v[164:165], v[52:53], v[52:53] op_sel:[0,1,0] op_sel_hi:[1,1,0]
v_pk_fma_f32 v[166:167], v[166:167], v[52:53], v[52:53] op_sel:[0,1,0] op_sel_hi:[1,1,0]
v_pk_mul_f32 v[160:161], v[160:161], v[104:105]
v_pk_mul_f32 v[162:163], v[162:163], v[106:107]
v_pk_mul_f32 v[164:165], v[164:165], v[108:109]
v_pk_mul_f32 v[166:167], v[166:167], v[110:111]
v_exp_f32 v160, v160
v_exp_f32 v161, v161
v_exp_f32 v162, v162
v_exp_f32 v163, v163
v_exp_f32 v164, v164
v_exp_f32 v165, v165
v_exp_f32 v166, v166
v_exp_f32 v167, v167
v_pk_fma_f32 v[160:161], v[160:161], v[54:55], v[54:55]
v_pk_fma_f32 v[162:163], v[162:163], v[54:55], v[54:55]
v_pk_fma_f32 v[164:165], v[164:165], v[54:55], v[54:55]
v_pk_fma_f32 v[166:167], v[166:167], v[54:55], v[54:55]
v_rcp_f32 v160, v160
v_rcp_f32 v161, v161
v_rcp_f32 v162, v162
v_rcp_f32 v163, v163
v_rcp_f32 v164, v164
v_rcp_f32 v165, v165
v_rcp_f32 v166, v166
v_rcp_f32 v167, v167
v_pk_mul_f32 v[160:161], v[160:161], v[104:105]
v_pk_mul_f32 v[162:163], v[162:163], v[106:107]
v_pk_mul_f32 v[164:165], v[164:165], v[108:109]
v_pk_mul_f32 v[166:167], v[166:167], v[110:111]
v_cvt_pk_bf16_f32 v104, v160, v161
v_cvt_pk_bf16_f32 v105, v162, v163
v_cvt_pk_bf16_f32 v106, v164, v165
v_cvt_pk_bf16_f32 v107, v166, v167
buffer_store_dwordx4 v[104:107], v60, s[24:27], s101 offen offset:512 sc1
buffer_load_dwordx4 a[40:43], v248, s[24:27], s97 offen offset:0
buffer_load_dwordx4 a[44:47], v248, s[24:27], s97 offen offset:1024
buffer_load_dwordx4 a[48:51], v248, s[24:27], s97 offen offset:2048
buffer_load_dwordx4 a[52:55], v248, s[24:27], s97 offen offset:3072
buffer_load_dwordx4 a[56:59], v248, s[24:27], s98 offen
s_add_u32 s97, s97, 5120
s_cmp_eq_u32 s97, s80
s_cselect_b32 s97, s79, s97
s_add_u32 s98, s97, 4096
v_pk_mul_f32 v[160:161], v[112:113], v[112:113]
v_pk_mul_f32 v[162:163], v[114:115], v[114:115]
v_pk_mul_f32 v[164:165], v[116:117], v[116:117]
v_pk_mul_f32 v[166:167], v[118:119], v[118:119]
v_pk_fma_f32 v[160:161], v[160:161], v[56:57], v[56:57] op_sel:[0,1,0] op_sel_hi:[1,1,0]
v_pk_fma_f32 v[162:163], v[162:163], v[56:57], v[56:57] op_sel:[0,1,0] op_sel_hi:[1,1,0]
v_pk_fma_f32 v[164:165], v[164:165], v[56:57], v[56:57] op_sel:[0,1,0] op_sel_hi:[1,1,0]
v_pk_fma_f32 v[166:167], v[166:167], v[56:57], v[56:57] op_sel:[0,1,0] op_sel_hi:[1,1,0]
v_pk_mul_f32 v[160:161], v[160:161], v[112:113]
v_pk_mul_f32 v[162:163], v[162:163], v[114:115]
v_pk_mul_f32 v[164:165], v[164:165], v[116:117]
v_pk_mul_f32 v[166:167], v[166:167], v[118:119]
v_exp_f32 v160, v160
v_exp_f32 v161, v161
v_exp_f32 v162, v162
v_exp_f32 v163, v163
v_exp_f32 v164, v164
v_exp_f32 v165, v165
v_exp_f32 v166, v166
v_exp_f32 v167, v167
v_pk_fma_f32 v[160:161], v[160:161], v[58:59], v[58:59]
v_pk_fma_f32 v[162:163], v[162:163], v[58:59], v[58:59]
v_pk_fma_f32 v[164:165], v[164:165], v[58:59], v[58:59]
v_pk_fma_f32 v[166:167], v[166:167], v[58:59], v[58:59]
v_rcp_f32 v160, v160
v_rcp_f32 v161, v161
v_rcp_f32 v162, v162
v_rcp_f32 v163, v163
v_rcp_f32 v164, v164
v_rcp_f32 v165, v165
v_rcp_f32 v166, v166
v_rcp_f32 v167, v167
v_pk_mul_f32 v[160:161], v[160:161], v[112:113]
v_pk_mul_f32 v[162:163], v[162:163], v[114:115]
v_pk_mul_f32 v[164:165], v[164:165], v[116:117]
v_pk_mul_f32 v[166:167], v[166:167], v[118:119]
v_cvt_pk_bf16_f32 v112, v160, v161
v_cvt_pk_bf16_f32 v113, v162, v163
v_cvt_pk_bf16_f32 v114, v164, v165
v_cvt_pk_bf16_f32 v115, v166, v167
buffer_store_dwordx4 v[112:115], v60, s[24:27], s101 offen offset:2048 sc1
buffer_load_dwordx4 a[60:63], v248, s[24:27], s97 offen offset:0
buffer_load_dwordx4 a[64:67], v248, s[24:27], s97 offen offset:1024
buffer_load_dwordx4 a[68:71], v248, s[24:27], s97 offen offset:2048
buffer_load_dwordx4 a[72:75], v248, s[24:27], s97 offen offset:3072
buffer_load_dwordx4 a[76:79], v248, s[24:27], s98 offen
s_add_u32 s97, s97, 5120
s_cmp_eq_u32 s97, s80
s_cselect_b32 s97, s79, s97
s_add_u32 s98, s97, 4096
v_lshrrev_b32 v4, 4, v0
v_mul_u32_u24 v4, 272, v4
v_and_b32 v5, 15, v0
v_lshl_add_u32 v4, v5, 4, v4
v_add_u32 v4, 83200, v4
v_add_u32 v6, 60416, v4
s_waitcnt vmcnt(24)
ds_write_b128 v4, v[32:35] offset:6272
v_alignbit_b32 v12, v33, v32, 16
v_alignbit_b32 v13, v34, v33, 16
v_alignbit_b32 v14, v35, v34, 16
v_alignbit_b32 v15, v36, v35, 16
ds_write_b128 v4, v[12:15] offset:0
ds_write_b128 v4, v[38:41] offset:36480
v_alignbit_b32 v12, v39, v38, 16
v_alignbit_b32 v13, v40, v39, 16
v_alignbit_b32 v14, v41, v40, 16
v_alignbit_b32 v15, v42, v41, 16
ds_write_b128 v4, v[12:15] offset:30208
ds_write_b128 v6, v[44:47] offset:6272
v_alignbit_b32 v12, v45, v44, 16
v_alignbit_b32 v13, v46, v45, 16
v_alignbit_b32 v14, v47, v46, 16
v_alignbit_b32 v15, v48, v47, 16
ds_write_b128 v6, v[12:15] offset:0
v_pk_mul_f32 v[160:161], v[120:121], v[120:121]
v_pk_mul_f32 v[162:163], v[122:123], v[122:123]
v_pk_mul_f32 v[164:165], v[124:125], v[124:125]
v_pk_mul_f32 v[166:167], v[126:127], v[126:127]
v_pk_fma_f32 v[160:161], v[160:161], v[56:57], v[56:57] op_sel:[0,1,0] op_sel_hi:[1,1,0]
v_pk_fma_f32 v[162:163], v[162:163], v[56:57], v[56:57] op_sel:[0,1,0] op_sel_hi:[1,1,0]
v_pk_fma_f32 v[164:165], v[164:165], v[56:57], v[56:57] op_sel:[0,1,0] op_sel_hi:[1,1,0]
v_pk_fma_f32 v[166:167], v[166:167], v[56:57], v[56:57] op_sel:[0,1,0] op_sel_hi:[1,1,0]
v_pk_mul_f32 v[160:161], v[160:161], v[120:121]
v_pk_mul_f32 v[162:163], v[162:163], v[122:123]
v_pk_mul_f32 v[164:165], v[164:165], v[124:125]
v_pk_mul_f32 v[166:167], v[166:167], v[126:127]
v_exp_f32 v160, v160
v_exp_f32 v161, v161
v_exp_f32 v162, v162
v_exp_f32 v163, v163
v_exp_f32 v164, v164
v_exp_f32 v165, v165
v_exp_f32 v166, v166
v_exp_f32 v167, v167
v_pk_fma_f32 v[160:161], v[160:161], v[58:59], v[58:59]
v_pk_fma_f32 v[162:163], v[162:163], v[58:59], v[58:59]
v_pk_fma_f32 v[164:165], v[164:165], v[58:59], v[58:59]
v_pk_fma_f32 v[166:167], v[166:167], v[58:59], v[58:59]
v_rcp_f32 v160, v160
v_rcp_f32 v161, v161
v_rcp_f32 v162, v162
v_rcp_f32 v163, v163
v_rcp_f32 v164, v164
v_rcp_f32 v165, v165
v_rcp_f32 v166, v166
v_rcp_f32 v167, v167
v_pk_mul_f32 v[160:161], v[160:161], v[120:121]
v_pk_mul_f32 v[162:163], v[162:163], v[122:123]
v_pk_mul_f32 v[164:165], v[164:165], v[124:125]
v_pk_mul_f32 v[166:167], v[166:167], v[126:127]
v_cvt_pk_bf16_f32 v120, v160, v161
v_cvt_pk_bf16_f32 v121, v162, v163
v_cvt_pk_bf16_f32 v122, v164, v165
v_cvt_pk_bf16_f32 v123, v166, v167
buffer_store_dwordx4 v[120:123], v60, s[24:27], s101 offen offset:2560 sc1
L_conv:
s_waitcnt lgkmcnt(0)
s_barrier
ds_read_b128 v[128:131], v8 offset:0
ds_read_b128 v[132:135], v8 offset:64
ds_read_b128 v[136:139], v8 offset:128
ds_read_b128 v[140:143], v8 offset:192
ds_read_b128 v[144:147], v8 offset:256
ds_read_b128 v[148:151], v8 offset:320
ds_read_b128 v[152:155], v8 offset:384
ds_read_b128 v[156:159], v8 offset:448
ds_read_b128 v[160:163], v9 offset:0
ds_read_b128 v[164:167], v9 offset:64
ds_read_b128 v[168:171], v9 offset:128
v_mov_b32 v176, 0
v_mov_b32 v177, 0
v_mov_b32 v178, 0
v_mov_b32 v179, 0
v_mov_b32 v180, 0
v_mov_b32 v181, 0
v_mov_b32 v182, 0
v_mov_b32 v183, 0
v_mov_b32 v184, 0
v_mov_b32 v185, 0
v_mov_b32 v186, 0
v_mov_b32 v187, 0
v_mov_b32 v188, 0
v_mov_b32 v189, 0
v_mov_b32 v190, 0
v_mov_b32 v191, 0
s_waitcnt lgkmcnt(0)
ds_read_b128 v[128:131], v8 offset:512
ds_read_b128 v[172:175], v9 offset:192
v_mfma_f32_16x16x32_bf16 v[188:191], v[140:143], v[160:163], v[188:191]
ds_read_b128 v[132:135], v8 offset:576
ds_read_b128 v[160:163], v9 offset:272
v_mfma_f32_16x16x32_bf16 v[184:187], v[140:143], v[164:167], v[184:187]
buffer_load_dwordx4 a[80:83], v248, s[24:27], s97 offen offset:0
v_mfma_f32_16x16x32_bf16 v[188:191], v[144:147], v[164:167], v[188:191]
ds_read_b128 v[136:139], v8 offset:640
v_mfma_f32_16x16x32_bf16 v[180:183], v[140:143], v[168:171], v[180:183]
ds_read_b128 v[164:167], v9 offset:336
v_mfma_f32_16x16x32_bf16 v[184:187], v[144:147], v[168:171], v[184:187]
buffer_load_dwordx4 a[84:87], v248, s[24:27], s97 offen offset:1024
v_mfma_f32_16x16x32_bf16 v[188:191], v[148:151], v[168:171], v[188:191]
s_waitcnt lgkmcnt(4)
v_mfma_f32_16x16x32_bf16 v[176:179], v[140:143], v[172:175], v[176:179]
ds_read_b128 v[140:143], v8 offset:704
v_mfma_f32_16x16x32_bf16 v[180:183], v[144:147], v[172:175], v[180:183]
ds_read_b128 v[168:171], v9 offset:400
v_mfma_f32_16x16x32_bf16 v[184:187], v[148:151], v[172:175], v[184:187]
buffer_load_dwordx4 a[88:91], v248, s[24:27], s97 offen offset:2048
v_mfma_f32_16x16x32_bf16 v[188:191], v[152:155], v[172:175], v[188:191]
s_waitcnt lgkmcnt(4)
v_mfma_f32_16x16x32_bf16 v[176:179], v[144:147], v[160:163], v[176:179]
ds_read_b128 v[144:147], v8 offset:768
v_mfma_f32_16x16x32_bf16 v[180:183], v[148:151], v[160:163], v[180:183]
ds_read_b128 v[172:175], v9 offset:464
v_mfma_f32_16x16x32_bf16 v[184:187], v[152:155], v[160:163], v[184:187]
buffer_load_dwordx4 a[92:95], v248, s[24:27], s97 offen offset:3072
v_mfma_f32_16x16x32_bf16 v[188:191], v[156:159], v[160:163], v[188:191]
s_waitcnt lgkmcnt(4)
v_mfma_f32_16x16x32_bf16 v[176:179], v[148:151], v[164:167], v[176:179]
ds_read_b128 v[148:151], v8 offset:832
v_mfma_f32_16x16x32_bf16 v[180:183], v[152:155], v[164:167], v[180:183]
ds_read_b128 v[160:163], v9 offset:544
v_mfma_f32_16x16x32_bf16 v[184:187], v[156:159], v[164:167], v[184:187]
buffer_load_dwordx4 a[96:99], v248, s[24:27], s98 offen
v_mfma_f32_16x16x32_bf16 v[188:191], v[128:131], v[164:167], v[188:191]
s_add_u32 s97, s97, 5120
s_cmp_eq_u32 s97, s80
s_cselect_b32 s97, s79, s97
s_add_u32 s98, s97, 4096
s_waitcnt lgkmcnt(4)
v_mfma_f32_16x16x32_bf16 v[176:179], v[152:155], v[168:171], v[176:179]
ds_read_b128 v[152:155], v8 offset:896
v_mfma_f32_16x16x32_bf16 v[180:183], v[156:159], v[168:171], v[180:183]
ds_read_b128 v[164:167], v9 offset:608
v_mfma_f32_16x16x32_bf16 v[184:187], v[128:131], v[168:171], v[184:187]
v_mfma_f32_16x16x32_bf16 v[188:191], v[132:135], v[168:171], v[188:191]
s_waitcnt lgkmcnt(4)
v_mfma_f32_16x16x32_bf16 v[176:179], v[156:159], v[172:175], v[176:179]
ds_read_b128 v[156:159], v8 offset:960
v_mfma_f32_16x16x32_bf16 v[180:183], v[128:131], v[172:175], v[180:183]
ds_read_b128 v[168:171], v9 offset:672
v_mfma_f32_16x16x32_bf16 v[184:187], v[132:135], v[172:175], v[184:187]
buffer_load_dwordx4 a[100:103], v248, s[24:27], s97 offen offset:0
v_mfma_f32_16x16x32_bf16 v[188:191], v[136:139], v[172:175], v[188:191]
s_waitcnt lgkmcnt(4)
v_mfma_f32_16x16x32_bf16 v[176:179], v[128:131], v[160:163], v[176:179]
ds_read_b128 v[128:131], v8 offset:1024
v_mfma_f32_16x16x32_bf16 v[180:183], v[132:135], v[160:163], v[180:183]
ds_read_b128 v[172:175], v9 offset:736
v_mfma_f32_16x16x32_bf16 v[184:187], v[136:139], v[160:163], v[184:187]
buffer_load_dwordx4 a[104:107], v248, s[24:27], s97 offen offset:1024
v_mfma_f32_16x16x32_bf16 v[188:191], v[140:143], v[160:163], v[188:191]
s_waitcnt lgkmcnt(4)
v_mfma_f32_16x16x32_bf16 v[176:179], v[132:135], v[164:167], v[176:179]
ds_read_b128 v[132:135], v8 offset:1088
v_mfma_f32_16x16x32_bf16 v[180:183], v[136:139], v[164:167], v[180:183]
ds_read_b128 v[160:163], v9 offset:816
v_mfma_f32_16x16x32_bf16 v[184:187], v[140:143], v[164:167], v[184:187]
buffer_load_dwordx4 a[108:111], v248, s[24:27], s97 offen offset:2048
v_mfma_f32_16x16x32_bf16 v[188:191], v[144:147], v[164:167], v[188:191]
s_waitcnt lgkmcnt(4)
v_mfma_f32_16x16x32_bf16 v[176:179], v[136:139], v[168:171], v[176:179]
ds_read_b128 v[136:139], v8 offset:1152
v_mfma_f32_16x16x32_bf16 v[180:183], v[140:143], v[168:171], v[180:183]
ds_read_b128 v[164:167], v9 offset:880
v_mfma_f32_16x16x32_bf16 v[184:187], v[144:147], v[168:171], v[184:187]
buffer_load_dwordx4 a[112:115], v248, s[24:27], s97 offen offset:3072
v_mfma_f32_16x16x32_bf16 v[188:191], v[148:151], v[168:171], v[188:191]
s_waitcnt lgkmcnt(4)
v_mfma_f32_16x16x32_bf16 v[176:179], v[140:143], v[172:175], v[176:179]
ds_read_b128 v[140:143], v8 offset:1216
v_mfma_f32_16x16x32_bf16 v[180:183], v[144:147], v[172:175], v[180:183]
ds_read_b128 v[168:171], v9 offset:944
v_mfma_f32_16x16x32_bf16 v[184:187], v[148:151], v[172:175], v[184:187]
buffer_load_dwordx4 a[116:119], v248, s[24:27], s98 offen
v_mfma_f32_16x16x32_bf16 v[188:191], v[152:155], v[172:175], v[188:191]
s_add_u32 s97, s97, 5120
s_cmp_eq_u32 s97, s80
s_cselect_b32 s97, s79, s97
s_add_u32 s98, s97, 4096
s_waitcnt lgkmcnt(4)
v_mfma_f32_16x16x32_bf16 v[176:179], v[144:147], v[160:163], v[176:179]
ds_read_b128 v[144:147], v8 offset:1280
v_mfma_f32_16x16x32_bf16 v[180:183], v[148:151], v[160:163], v[180:183]
ds_read_b128 v[172:175], v9 offset:1008
v_mfma_f32_16x16x32_bf16 v[184:187], v[152:155], v[160:163], v[184:187]
v_mfma_f32_16x16x32_bf16 v[188:191], v[156:159], v[160:163], v[188:191]
s_waitcnt lgkmcnt(4)
v_mfma_f32_16x16x32_bf16 v[176:179], v[148:151], v[164:167], v[176:179]
ds_read_b128 v[148:151], v8 offset:1344
v_mfma_f32_16x16x32_bf16 v[180:183], v[152:155], v[164:167], v[180:183]
ds_read_b128 v[160:163], v9 offset:1088
v_mfma_f32_16x16x32_bf16 v[184:187], v[156:159], v[164:167], v[184:187]
buffer_load_dwordx4 a[120:123], v248, s[24:27], s97 offen offset:0
v_mfma_f32_16x16x32_bf16 v[188:191], v[128:131], v[164:167], v[188:191]
s_waitcnt vmcnt(11)
s_barrier
s_cmp_lg_u32 s5, 0
s_cbranch_scc1 L_fl_31
s_mov_b64 exec, 1
buffer_store_dword v253, v252, s[24:27], 0 offen offset:16 sc1
s_mov_b64 exec, -1
L_fl_31:
s_waitcnt lgkmcnt(4)
v_mfma_f32_16x16x32_bf16 v[176:179], v[152:155], v[168:171], v[176:179]
ds_read_b128 v[152:155], v8 offset:1408
v_mfma_f32_16x16x32_bf16 v[180:183], v[156:159], v[168:171], v[180:183]
ds_read_b128 v[164:167], v9 offset:1152
v_mfma_f32_16x16x32_bf16 v[184:187], v[128:131], v[168:171], v[184:187]
buffer_load_dwordx4 a[124:127], v248, s[24:27], s97 offen offset:1024
v_mfma_f32_16x16x32_bf16 v[188:191], v[132:135], v[168:171], v[188:191]
s_waitcnt lgkmcnt(4)
v_mfma_f32_16x16x32_bf16 v[176:179], v[156:159], v[172:175], v[176:179]
ds_read_b128 v[156:159], v8 offset:1472
v_mfma_f32_16x16x32_bf16 v[180:183], v[128:131], v[172:175], v[180:183]
ds_read_b128 v[168:171], v9 offset:1216
v_mfma_f32_16x16x32_bf16 v[184:187], v[132:135], v[172:175], v[184:187]
buffer_load_dwordx4 a[128:131], v248, s[24:27], s97 offen offset:2048
v_mfma_f32_16x16x32_bf16 v[188:191], v[136:139], v[172:175], v[188:191]
s_waitcnt lgkmcnt(4)
v_mfma_f32_16x16x32_bf16 v[176:179], v[128:131], v[160:163], v[176:179]
ds_read_b128 v[128:131], v8 offset:1536
v_mfma_f32_16x16x32_bf16 v[180:183], v[132:135], v[160:163], v[180:183]
ds_read_b128 v[172:175], v9 offset:1280
v_mfma_f32_16x16x32_bf16 v[184:187], v[136:139], v[160:163], v[184:187]
buffer_load_dwordx4 a[132:135], v248, s[24:27], s97 offen offset:3072
v_mfma_f32_16x16x32_bf16 v[188:191], v[140:143], v[160:163], v[188:191]
s_waitcnt lgkmcnt(4)
v_mfma_f32_16x16x32_bf16 v[176:179], v[132:135], v[164:167], v[176:179]
ds_read_b128 v[132:135], v8 offset:1600
v_mfma_f32_16x16x32_bf16 v[180:183], v[136:139], v[164:167], v[180:183]
ds_read_b128 v[160:163], v9 offset:1360
v_mfma_f32_16x16x32_bf16 v[184:187], v[140:143], v[164:167], v[184:187]
buffer_load_dwordx4 a[136:139], v248, s[24:27], s98 offen
v_mfma_f32_16x16x32_bf16 v[188:191], v[144:147], v[164:167], v[188:191]
s_add_u32 s97, s97, 5120
s_cmp_eq_u32 s97, s80
s_cselect_b32 s97, s79, s97
s_add_u32 s98, s97, 4096
s_waitcnt lgkmcnt(4)
v_mfma_f32_16x16x32_bf16 v[176:179], v[136:139], v[168:171], v[176:179]
ds_read_b128 v[136:139], v8 offset:1664
v_mfma_f32_16x16x32_bf16 v[180:183], v[140:143], v[168:171], v[180:183]
ds_read_b128 v[164:167], v9 offset:1424
v_mfma_f32_16x16x32_bf16 v[184:187], v[144:147], v[168:171], v[184:187]
v_mfma_f32_16x16x32_bf16 v[188:191], v[148:151], v[168:171], v[188:191]
s_waitcnt lgkmcnt(4)
v_mfma_f32_16x16x32_bf16 v[176:179], v[140:143], v[172:175], v[176:179]
ds_read_b128 v[140:143], v8 offset:1728
v_mfma_f32_16x16x32_bf16 v[180:183], v[144:147], v[172:175], v[180:183]
ds_read_b128 v[168:171], v9 offset:1488
v_mfma_f32_16x16x32_bf16 v[184:187], v[148:151], v[172:175], v[184:187]
buffer_load_dwordx4 a[140:143], v248, s[24:27], s97 offen offset:0
v_mfma_f32_16x16x32_bf16 v[188:191], v[152:155], v[172:175], v[188:191]
s_waitcnt lgkmcnt(4)
v_mfma_f32_16x16x32_bf16 v[176:179], v[144:147], v[160:163], v[176:179]
ds_read_b128 v[144:147], v8 offset:1792
v_mfma_f32_16x16x32_bf16 v[180:183], v[148:151], v[160:163], v[180:183]
ds_read_b128 v[172:175], v9 offset:1552
v_mfma_f32_16x16x32_bf16 v[184:187], v[152:155], v[160:163], v[184:187]
buffer_load_dwordx4 a[144:147], v248, s[24:27], s97 offen offset:1024
v_mfma_f32_16x16x32_bf16 v[188:191], v[156:159], v[160:163], v[188:191]
s_waitcnt lgkmcnt(4)
v_mfma_f32_16x16x32_bf16 v[176:179], v[148:151], v[164:167], v[176:179]
ds_read_b128 v[148:151], v8 offset:1856
v_mfma_f32_16x16x32_bf16 v[180:183], v[152:155], v[164:167], v[180:183]
ds_read_b128 v[160:163], v9 offset:1632
v_mfma_f32_16x16x32_bf16 v[184:187], v[156:159], v[164:167], v[184:187]
buffer_load_dwordx4 a[148:151], v248, s[24:27], s97 offen offset:2048
v_mfma_f32_16x16x32_bf16 v[188:191], v[128:131], v[164:167], v[188:191]
s_waitcnt lgkmcnt(4)
v_mfma_f32_16x16x32_bf16 v[176:179], v[152:155], v[168:171], v[176:179]
ds_read_b128 v[152:155], v8 offset:1920
v_mfma_f32_16x16x32_bf16 v[180:183], v[156:159], v[168:171], v[180:183]
ds_read_b128 v[164:167], v9 offset:1696
v_mfma_f32_16x16x32_bf16 v[184:187], v[128:131], v[168:171], v[184:187]
buffer_load_dwordx4 a[152:155], v248, s[24:27], s97 offen offset:3072
v_mfma_f32_16x16x32_bf16 v[188:191], v[132:135], v[168:171], v[188:191]
s_waitcnt lgkmcnt(4)
v_mfma_f32_16x16x32_bf16 v[176:179], v[156:159], v[172:175], v[176:179]
ds_read_b128 v[156:159], v8 offset:1984
v_mfma_f32_16x16x32_bf16 v[180:183], v[128:131], v[172:175], v[180:183]
ds_read_b128 v[168:171], v9 offset:1760
v_mfma_f32_16x16x32_bf16 v[184:187], v[132:135], v[172:175], v[184:187]
buffer_load_dwordx4 a[156:159], v248, s[24:27], s98 offen
v_mfma_f32_16x16x32_bf16 v[188:191], v[136:139], v[172:175], v[188:191]
s_add_u32 s97, s97, 5120
s_cmp_eq_u32 s97, s80
s_cselect_b32 s97, s79, s97
s_add_u32 s98, s97, 4096
s_waitcnt lgkmcnt(4)
v_mfma_f32_16x16x32_bf16 v[176:179], v[128:131], v[160:163], v[176:179]
ds_read_b128 v[128:131], v8 offset:2048
v_mfma_f32_16x16x32_bf16 v[180:183], v[132:135], v[160:163], v[180:183]
ds_read_b128 v[172:175], v9 offset:1824
v_mfma_f32_16x16x32_bf16 v[184:187], v[136:139], v[160:163], v[184:187]
v_mfma_f32_16x16x32_bf16 v[188:191], v[140:143], v[160:163], v[188:191]
s_waitcnt lgkmcnt(4)
v_mfma_f32_16x16x32_bf16 v[176:179], v[132:135], v[164:167], v[176:179]
ds_read_b128 v[132:135], v8 offset:2112
v_mfma_f32_16x16x32_bf16 v[180:183], v[136:139], v[164:167], v[180:183]
ds_read_b128 v[160:163], v9 offset:1904
v_mfma_f32_16x16x32_bf16 v[184:187], v[140:143], v[164:167], v[184:187]
buffer_load_dwordx4 a[160:163], v248, s[24:27], s97 offen offset:0
v_mfma_f32_16x16x32_bf16 v[188:191], v[144:147], v[164:167], v[188:191]
s_waitcnt lgkmcnt(4)
v_mfma_f32_16x16x32_bf16 v[176:179], v[136:139], v[168:171], v[176:179]
ds_read_b128 v[136:139], v8 offset:2176
v_mfma_f32_16x16x32_bf16 v[180:183], v[140:143], v[168:171], v[180:183]
ds_read_b128 v[164:167], v9 offset:1968
v_mfma_f32_16x16x32_bf16 v[184:187], v[144:147], v[168:171], v[184:187]
buffer_load_dwordx4 a[164:167], v248, s[24:27], s97 offen offset:1024
v_mfma_f32_16x16x32_bf16 v[188:191], v[148:151], v[168:171], v[188:191]
s_waitcnt lgkmcnt(4)
v_mfma_f32_16x16x32_bf16 v[176:179], v[140:143], v[172:175], v[176:179]
ds_read_b128 v[140:143], v8 offset:2240
v_mfma_f32_16x16x32_bf16 v[180:183], v[144:147], v[172:175], v[180:183]
ds_read_b128 v[168:171], v9 offset:2032
v_mfma_f32_16x16x32_bf16 v[184:187], v[148:151], v[172:175], v[184:187]
buffer_load_dwordx4 a[168:171], v248, s[24:27], s97 offen offset:2048
v_mfma_f32_16x16x32_bf16 v[188:191], v[152:155], v[172:175], v[188:191]
s_waitcnt lgkmcnt(4)
v_mfma_f32_16x16x32_bf16 v[176:179], v[144:147], v[160:163], v[176:179]
ds_read_b128 v[144:147], v8 offset:2304
v_mfma_f32_16x16x32_bf16 v[180:183], v[148:151], v[160:163], v[180:183]
ds_read_b128 v[172:175], v9 offset:2096
v_mfma_f32_16x16x32_bf16 v[184:187], v[152:155], v[160:163], v[184:187]
buffer_load_dwordx4 a[172:175], v248, s[24:27], s97 offen offset:3072
v_mfma_f32_16x16x32_bf16 v[188:191], v[156:159], v[160:163], v[188:191]
s_waitcnt lgkmcnt(4)
v_mfma_f32_16x16x32_bf16 v[176:179], v[148:151], v[164:167], v[176:179]
ds_read_b128 v[148:151], v8 offset:2368
v_mfma_f32_16x16x32_bf16 v[180:183], v[152:155], v[164:167], v[180:183]
ds_read_b128 v[160:163], v9 offset:2176
v_mfma_f32_16x16x32_bf16 v[184:187], v[156:159], v[164:167], v[184:187]
buffer_load_dwordx4 a[176:179], v248, s[24:27], s98 offen
v_mfma_f32_16x16x32_bf16 v[188:191], v[128:131], v[164:167], v[188:191]
s_add_u32 s97, s97, 5120
s_cmp_eq_u32 s97, s80
s_cselect_b32 s97, s79, s97
s_add_u32 s98, s97, 4096
s_waitcnt lgkmcnt(4)
v_mfma_f32_16x16x32_bf16 v[176:179], v[152:155], v[168:171], v[176:179]
ds_read_b128 v[152:155], v8 offset:2432
v_mfma_f32_16x16x32_bf16 v[180:183], v[156:159], v[168:171], v[180:183]
ds_read_b128 v[164:167], v9 offset:2240
v_mfma_f32_16x16x32_bf16 v[184:187], v[128:131], v[168:171], v[184:187]
v_mfma_f32_16x16x32_bf16 v[188:191], v[132:135], v[168:171], v[188:191]
s_waitcnt lgkmcnt(4)
v_mfma_f32_16x16x32_bf16 v[176:179], v[156:159], v[172:175], v[176:179]
ds_read_b128 v[156:159], v8 offset:2496
v_mfma_f32_16x16x32_bf16 v[180:183], v[128:131], v[172:175], v[180:183]
ds_read_b128 v[168:171], v9 offset:2304
v_mfma_f32_16x16x32_bf16 v[184:187], v[132:135], v[172:175], v[184:187]
v_mfma_f32_16x16x32_bf16 v[188:191], v[136:139], v[172:175], v[188:191]
s_cmp_eq_u32 s86, 0
s_cbranch_scc1 L_two_32
L_halfb_33:
s_waitcnt lgkmcnt(4)
v_mfma_f32_16x16x32_bf16 v[176:179], v[128:131], v[160:163], v[176:179]
ds_read_b128 v[128:131], v8 offset:2560
v_mfma_f32_16x16x32_bf16 v[180:183], v[132:135], v[160:163], v[180:183]
ds_read_b128 v[172:175], v9 offset:2368
v_mfma_f32_16x16x32_bf16 v[184:187], v[136:139], v[160:163], v[184:187]
buffer_load_dwordx4 a[180:183], v248, s[24:27], s97 offen offset:0
v_mfma_f32_16x16x32_bf16 v[188:191], v[140:143], v[160:163], v[188:191]
buffer_load_dwordx4 a[184:187], v248, s[24:27], s97 offen offset:1024
s_waitcnt lgkmcnt(4)
v_mfma_f32_16x16x32_bf16 v[176:179], v[132:135], v[164:167], v[176:179]
ds_read_b128 v[132:135], v8 offset:2624
v_mfma_f32_16x16x32_bf16 v[180:183], v[136:139], v[164:167], v[180:183]
ds_read_b128 v[160:163], v9 offset:2448
v_mfma_f32_16x16x32_bf16 v[184:187], v[140:143], v[164:167], v[184:187]
buffer_load_dwordx4 a[188:191], v248, s[24:27], s97 offen offset:2048
v_mfma_f32_16x16x32_bf16 v[188:191], v[144:147], v[164:167], v[188:191]
s_waitcnt lgkmcnt(4)
v_mfma_f32_16x16x32_bf16 v[176:179], v[136:139], v[168:171], v[176:179]
ds_read_b128 v[136:139], v8 offset:2688
v_mfma_f32_16x16x32_bf16 v[180:183], v[140:143], v[168:171], v[180:183]
ds_read_b128 v[164:167], v9 offset:2512
v_mfma_f32_16x16x32_bf16 v[184:187], v[144:147], v[168:171], v[184:187]
buffer_load_dwordx4 a[192:195], v248, s[24:27], s97 offen offset:3072
v_mfma_f32_16x16x32_bf16 v[188:191], v[148:151], v[168:171], v[188:191]
s_waitcnt lgkmcnt(4)
v_mfma_f32_16x16x32_bf16 v[176:179], v[140:143], v[172:175], v[176:179]
ds_read_b128 v[140:143], v8 offset:2752
v_mfma_f32_16x16x32_bf16 v[180:183], v[144:147], v[172:175], v[180:183]
ds_read_b128 v[168:171], v9 offset:2576
v_mfma_f32_16x16x32_bf16 v[184:187], v[148:151], v[172:175], v[184:187]
buffer_load_dwordx4 a[196:199], v248, s[24:27], s98 offen
v_mfma_f32_16x16x32_bf16 v[188:191], v[152:155], v[172:175], v[188:191]
s_add_u32 s97, s97, 5120
s_cmp_eq_u32 s97, s80
s_cselect_b32 s97, s79, s97
s_add_u32 s98, s97, 4096
s_waitcnt lgkmcnt(4)
v_mfma_f32_16x16x32_bf16 v[176:179], v[144:147], v[160:163], v[176:179]
ds_read_b128 v[144:147], v8 offset:2816
v_mfma_f32_16x16x32_bf16 v[180:183], v[148:151], v[160:163], v[180:183]
ds_read_b128 v[172:175], v9 offset:2640
v_mfma_f32_16x16x32_bf16 v[184:187], v[152:155], v[160:163], v[184:187]
buffer_load_dwordx4 a[200:203], v248, s[24:27], s97 offen offset:0
v_mfma_f32_16x16x32_bf16 v[188:191], v[156:159], v[160:163], v[188:191]
s_waitcnt lgkmcnt(4)
v_mfma_f32_16x16x32_bf16 v[176:179], v[148:151], v[164:167], v[176:179]
ds_read_b128 v[148:151], v8 offset:2880
v_mfma_f32_16x16x32_bf16 v[180:183], v[152:155], v[164:167], v[180:183]
ds_read_b128 v[160:163], v9 offset:2720
v_mfma_f32_16x16x32_bf16 v[184:187], v[156:159], v[164:167], v[184:187]
buffer_load_dwordx4 a[204:207], v248, s[24:27], s97 offen offset:1024
v_mfma_f32_16x16x32_bf16 v[188:191], v[128:131], v[164:167], v[188:191]
s_waitcnt lgkmcnt(4)
v_mfma_f32_16x16x32_bf16 v[176:179], v[152:155], v[168:171], v[176:179]
ds_read_b128 v[152:155], v8 offset:2944
v_mfma_f32_16x16x32_bf16 v[180:183], v[156:159], v[168:171], v[180:183]
ds_read_b128 v[164:167], v9 offset:2784
v_mfma_f32_16x16x32_bf16 v[184:187], v[128:131], v[168:171], v[184:187]
buffer_load_dwordx4 a[208:211], v248, s[24:27], s97 offen offset:2048
v_mfma_f32_16x16x32_bf16 v[188:191], v[132:135], v[168:171], v[188:191]
s_waitcnt lgkmcnt(4)
v_mfma_f32_16x16x32_bf16 v[176:179], v[156:159], v[172:175], v[176:179]
ds_read_b128 v[156:159], v8 offset:3008
v_mfma_f32_16x16x32_bf16 v[180:183], v[128:131], v[172:175], v[180:183]
ds_read_b128 v[168:171], v9 offset:2848
v_mfma_f32_16x16x32_bf16 v[184:187], v[132:135], v[172:175], v[184:187]
buffer_load_dwordx4 a[212:215], v248, s[24:27], s97 offen offset:3072
v_mfma_f32_16x16x32_bf16 v[188:191], v[136:139], v[172:175], v[188:191]
buffer_load_dwordx4 a[216:219], v248, s[24:27], s98 offen
s_add_u32 s97, s97, 5120
s_cmp_eq_u32 s97, s80
s_cselect_b32 s97, s79, s97
s_add_u32 s98, s97, 4096
s_waitcnt lgkmcnt(4)
v_mfma_f32_16x16x32_bf16 v[176:179], v[128:131], v[160:163], v[176:179]
ds_read_b128 v[128:131], v8 offset:3072
v_mfma_f32_16x16x32_bf16 v[180:183], v[132:135], v[160:163], v[180:183]
ds_read_b128 v[172:175], v9 offset:2912
v_mfma_f32_16x16x32_bf16 v[184:187], v[136:139], v[160:163], v[184:187]
buffer_load_dwordx4 a[220:223], v248, s[24:27], s97 offen offset:0
v_mfma_f32_16x16x32_bf16 v[188:191], v[140:143], v[160:163], v[188:191]
s_waitcnt lgkmcnt(4)
v_mfma_f32_16x16x32_bf16 v[176:179], v[132:135], v[164:167], v[176:179]
ds_read_b128 v[132:135], v8 offset:3136
v_mfma_f32_16x16x32_bf16 v[180:183], v[136:139], v[164:167], v[180:183]
ds_read_b128 v[160:163], v9 offset:2992
v_mfma_f32_16x16x32_bf16 v[184:187], v[140:143], v[164:167], v[184:187]
buffer_load_dwordx4 a[224:227], v248, s[24:27], s97 offen offset:1024
v_mfma_f32_16x16x32_bf16 v[188:191], v[144:147], v[164:167], v[188:191]
s_waitcnt lgkmcnt(4)
v_mfma_f32_16x16x32_bf16 v[176:179], v[136:139], v[168:171], v[176:179]
ds_read_b128 v[136:139], v8 offset:3200
v_mfma_f32_16x16x32_bf16 v[180:183], v[140:143], v[168:171], v[180:183]
ds_read_b128 v[164:167], v9 offset:3056
v_mfma_f32_16x16x32_bf16 v[184:187], v[144:147], v[168:171], v[184:187]
buffer_load_dwordx4 a[228:231], v248, s[24:27], s97 offen offset:2048
v_mfma_f32_16x16x32_bf16 v[188:191], v[148:151], v[168:171], v[188:191]
s_waitcnt lgkmcnt(4)
v_mfma_f32_16x16x32_bf16 v[176:179], v[140:143], v[172:175], v[176:179]
ds_read_b128 v[140:143], v8 offset:3264
v_mfma_f32_16x16x32_bf16 v[180:183], v[144:147], v[172:175], v[180:183]
ds_read_b128 v[168:171], v9 offset:3120
v_mfma_f32_16x16x32_bf16 v[184:187], v[148:151], v[172:175], v[184:187]
buffer_load_dwordx4 a[232:235], v248, s[24:27], s97 offen offset:3072
v_mfma_f32_16x16x32_bf16 v[188:191], v[152:155], v[172:175], v[188:191]
buffer_load_dword v254, v249, s[24:27], 0 offen sc1
s_waitcnt lgkmcnt(4)
v_mfma_f32_16x16x32_bf16 v[176:179], v[144:147], v[160:163], v[176:179]
ds_read_b128 v[144:147], v8 offset:3328
v_mfma_f32_16x16x32_bf16 v[180:183], v[148:151], v[160:163], v[180:183]
ds_read_b128 v[172:175], v9 offset:3184
v_mfma_f32_16x16x32_bf16 v[184:187], v[152:155], v[160:163], v[184:187]
buffer_load_dwordx4 a[236:239], v248, s[24:27], s98 offen
v_mfma_f32_16x16x32_bf16 v[188:191], v[156:159], v[160:163], v[188:191]
s_add_u32 s97, s97, 5120
s_cmp_eq_u32 s97, s80
s_cselect_b32 s97, s79, s97
s_add_u32 s98, s97, 4096
s_waitcnt lgkmcnt(4)
v_mfma_f32_16x16x32_bf16 v[176:179], v[148:151], v[164:167], v[176:179]
ds_read_b128 v[148:151], v8 offset:3392
v_mfma_f32_16x16x32_bf16 v[180:183], v[152:155], v[164:167], v[180:183]
ds_read_b128 v[160:163], v9 offset:3264
v_mfma_f32_16x16x32_bf16 v[184:187], v[156:159], v[164:167], v[184:187]
buffer_load_dwordx4 v[208:211], v248, s[24:27], s97 offen offset:0
v_mfma_f32_16x16x32_bf16 v[188:191], v[128:131], v[164:167], v[188:191]
s_waitcnt lgkmcnt(4)
v_mfma_f32_16x16x32_bf16 v[176:179], v[152:155], v[168:171], v[176:179]
ds_read_b128 v[152:155], v8 offset:3456
v_mfma_f32_16x16x32_bf16 v[180:183], v[156:159], v[168:171], v[180:183]
ds_read_b128 v[164:167], v9 offset:3328
v_mfma_f32_16x16x32_bf16 v[184:187], v[128:131], v[168:171], v[184:187]
buffer_load_dwordx4 v[212:215], v248, s[24:27], s97 offen offset:1024
v_mfma_f32_16x16x32_bf16 v[188:191], v[132:135], v[168:171], v[188:191]
buffer_load_dwordx4 v[216:219], v248, s[24:27], s97 offen offset:2048
s_waitcnt lgkmcnt(4)
v_mfma_f32_16x16x32_bf16 v[176:179], v[156:159], v[172:175], v[176:179]
ds_read_b128 v[156:159], v8 offset:3520
v_mfma_f32_16x16x32_bf16 v[180:183], v[128:131], v[172:175], v[180:183]
ds_read_b128 v[168:171], v9 offset:3392
v_mfma_f32_16x16x32_bf16 v[184:187], v[132:135], v[172:175], v[184:187]
buffer_load_dwordx4 v[220:223], v248, s[24:27], s97 offen offset:3072
v_mfma_f32_16x16x32_bf16 v[188:191], v[136:139], v[172:175], v[188:191]
s_waitcnt lgkmcnt(4)
v_mfma_f32_16x16x32_bf16 v[176:179], v[128:131], v[160:163], v[176:179]
ds_read_b128 v[128:131], v8 offset:3584
v_mfma_f32_16x16x32_bf16 v[180:183], v[132:135], v[160:163], v[180:183]
ds_read_b128 v[172:175], v9 offset:3456
v_mfma_f32_16x16x32_bf16 v[184:187], v[136:139], v[160:163], v[184:187]
buffer_load_dwordx4 v[224:227], v248, s[24:27], s98 offen
v_mfma_f32_16x16x32_bf16 v[188:191], v[140:143], v[160:163], v[188:191]
s_add_u32 s97, s97, 5120
s_cmp_eq_u32 s97, s80
s_cselect_b32 s97, s79, s97
s_add_u32 s98, s97, 4096
s_waitcnt lgkmcnt(4)
v_mfma_f32_16x16x32_bf16 v[176:179], v[132:135], v[164:167], v[176:179]
ds_read_b128 v[132:135], v8 offset:3648
v_mfma_f32_16x16x32_bf16 v[180:183], v[136:139], v[164:167], v[180:183]
ds_read_b128 v[160:163], v9 offset:3536
v_mfma_f32_16x16x32_bf16 v[184:187], v[140:143], v[164:167], v[184:187]
buffer_load_dwordx4 v[228:231], v248, s[24:27], s97 offen offset:0
v_mfma_f32_16x16x32_bf16 v[188:191], v[144:147], v[164:167], v[188:191]
s_waitcnt lgkmcnt(4)
v_mfma_f32_16x16x32_bf16 v[176:179], v[136:139], v[168:171], v[176:179]
ds_read_b128 v[136:139], v8 offset:3712
v_mfma_f32_16x16x32_bf16 v[180:183], v[140:143], v[168:171], v[180:183]
ds_read_b128 v[164:167], v9 offset:3600
v_mfma_f32_16x16x32_bf16 v[184:187], v[144:147], v[168:171], v[184:187]
buffer_load_dwordx4 v[232:235], v248, s[24:27], s97 offen offset:1024
v_mfma_f32_16x16x32_bf16 v[188:191], v[148:151], v[168:171], v[188:191]
s_waitcnt lgkmcnt(4)
v_mfma_f32_16x16x32_bf16 v[176:179], v[140:143], v[172:175], v[176:179]
ds_read_b128 v[140:143], v8 offset:3776
v_mfma_f32_16x16x32_bf16 v[180:183], v[144:147], v[172:175], v[180:183]
ds_read_b128 v[168:171], v9 offset:3664
v_mfma_f32_16x16x32_bf16 v[184:187], v[148:151], v[172:175], v[184:187]
buffer_load_dwordx4 v[236:239], v248, s[24:27], s97 offen offset:2048
v_mfma_f32_16x16x32_bf16 v[188:191], v[152:155], v[172:175], v[188:191]
s_waitcnt lgkmcnt(4)
v_mfma_f32_16x16x32_bf16 v[176:179], v[144:147], v[160:163], v[176:179]
ds_read_b128 v[144:147], v8 offset:3840
v_mfma_f32_16x16x32_bf16 v[180:183], v[148:151], v[160:163], v[180:183]
ds_read_b128 v[172:175], v9 offset:3728
v_mfma_f32_16x16x32_bf16 v[184:187], v[152:155], v[160:163], v[184:187]
buffer_load_dwordx4 v[240:243], v248, s[24:27], s97 offen offset:3072
v_mfma_f32_16x16x32_bf16 v[188:191], v[156:159], v[160:163], v[188:191]
s_waitcnt lgkmcnt(4)
v_mfma_f32_16x16x32_bf16 v[176:179], v[148:151], v[164:167], v[176:179]
ds_read_b128 v[148:151], v8 offset:3904
v_mfma_f32_16x16x32_bf16 v[180:183], v[152:155], v[164:167], v[180:183]
ds_read_b128 v[160:163], v9 offset:3808
v_mfma_f32_16x16x32_bf16 v[184:187], v[156:159], v[164:167], v[184:187]
buffer_load_dwordx4 v[244:247], v248, s[24:27], s98 offen
v_mfma_f32_16x16x32_bf16 v[188:191], v[128:131], v[164:167], v[188:191]
s_add_u32 s97, s97, 5120
s_cmp_eq_u32 s97, s80
s_cselect_b32 s97, s79, s97
s_add_u32 s98, s97, 4096
s_waitcnt vmcnt(11)
v_cmp_eq_u32 vcc, 0, v254
s_cbranch_vccnz L_slow_34
L_back_35:
s_mul_i32 s6, s94, 54
s_add_u32 s6, s6, s96
s_lshl_b32 s81, s6, 12
s_add_u32 s81, s81, 10485760
s_cmp_ge_u32 s5, 2
s_cselect_b32 s7, 13, 14
s_lshl_b32 s7, s7, 12
s_add_u32 s82, s81, s7
s_lshl_b32 s7, s93, 12
s_add_u32 s99, s81, s7
s_add_u32 s6, s5, 0
s_and_b32 s6, s6, 3
s_lshl_b32 s6, s6, 10
v_add_u32 v56, s6, v248
s_add_u32 s6, s5, 1
s_and_b32 s6, s6, 3
s_lshl_b32 s6, s6, 10
v_add_u32 v57, s6, v248
s_add_u32 s6, s5, 2
s_and_b32 s6, s6, 3
s_lshl_b32 s6, s6, 10
v_add_u32 v58, s6, v248
s_add_u32 s6, s5, 3
s_and_b32 s6, s6, 3
s_lshl_b32 s6, s6, 10
v_add_u32 v59, s6, v248
s_waitcnt lgkmcnt(4)
v_mfma_f32_16x16x32_bf16 v[176:179], v[152:155], v[168:171], v[176:179]
ds_read_b128 v[152:155], v8 offset:3968
v_mfma_f32_16x16x32_bf16 v[180:183], v[156:159], v[168:171], v[180:183]
ds_read_b128 v[164:167], v9 offset:3872
v_mfma_f32_16x16x32_bf16 v[184:187], v[128:131], v[168:171], v[184:187]
v_mfma_f32_16x16x32_bf16 v[188:191], v[132:135], v[168:171], v[188:191]
s_waitcnt lgkmcnt(4)
v_mfma_f32_16x16x32_bf16 v[176:179], v[156:159], v[172:175], v[176:179]
ds_read_b128 v[156:159], v8 offset:4032
v_mfma_f32_16x16x32_bf16 v[180:183], v[128:131], v[172:175], v[180:183]
ds_read_b128 v[168:171], v9 offset:3936
v_mfma_f32_16x16x32_bf16 v[184:187], v[132:135], v[172:175], v[184:187]
buffer_load_dwordx4 v[64:67], v56, s[24:27], s99 offen
v_mfma_f32_16x16x32_bf16 v[188:191], v[136:139], v[172:175], v[188:191]
buffer_load_dwordx4 v[68:71], v57, s[24:27], s99 offen
buffer_load_dwordx4 v[72:75], v58, s[24:27], s99 offen
buffer_load_dwordx4 v[76:79], v59, s[24:27], s99 offen
s_add_u32 s99, s99, 4096
s_cmp_eq_u32 s99, s82
s_cselect_b32 s99, s81, s99
s_waitcnt lgkmcnt(4)
v_mfma_f32_16x16x32_bf16 v[176:179], v[128:131], v[160:163], v[176:179]
ds_read_b128 v[128:131], v8 offset:4096
v_mfma_f32_16x16x32_bf16 v[180:183], v[132:135], v[160:163], v[180:183]
ds_read_b128 v[172:175], v9 offset:4000
v_mfma_f32_16x16x32_bf16 v[184:187], v[136:139], v[160:163], v[184:187]
v_mfma_f32_16x16x32_bf16 v[188:191], v[140:143], v[160:163], v[188:191]
s_waitcnt lgkmcnt(4)
v_mfma_f32_16x16x32_bf16 v[176:179], v[132:135], v[164:167], v[176:179]
ds_read_b128 v[132:135], v8 offset:4160
v_mfma_f32_16x16x32_bf16 v[180:183], v[136:139], v[164:167], v[180:183]
ds_read_b128 v[160:163], v9 offset:4080
v_mfma_f32_16x16x32_bf16 v[184:187], v[140:143], v[164:167], v[184:187]
v_mfma_f32_16x16x32_bf16 v[188:191], v[144:147], v[164:167], v[188:191]
s_waitcnt lgkmcnt(4)
v_mfma_f32_16x16x32_bf16 v[176:179], v[136:139], v[168:171], v[176:179]
ds_read_b128 v[136:139], v8 offset:4224
v_mfma_f32_16x16x32_bf16 v[180:183], v[140:143], v[168:171], v[180:183]
ds_read_b128 v[164:167], v9 offset:4144
v_mfma_f32_16x16x32_bf16 v[184:187], v[144:147], v[168:171], v[184:187]
buffer_load_dwordx4 v[80:83], v56, s[24:27], s99 offen
v_mfma_f32_16x16x32_bf16 v[188:191], v[148:151], v[168:171], v[188:191]
buffer_load_dwordx4 v[84:87], v57, s[24:27], s99 offen
buffer_load_dwordx4 v[88:91], v58, s[24:27], s99 offen
buffer_load_dwordx4 v[92:95], v59, s[24:27], s99 offen
s_add_u32 s99, s99, 4096
s_cmp_eq_u32 s99, s82
s_cselect_b32 s99, s81, s99
s_waitcnt lgkmcnt(4)
v_mfma_f32_16x16x32_bf16 v[176:179], v[140:143], v[172:175], v[176:179]
ds_read_b128 v[140:143], v8 offset:4288
v_mfma_f32_16x16x32_bf16 v[180:183], v[144:147], v[172:175], v[180:183]
ds_read_b128 v[168:171], v9 offset:4208
v_mfma_f32_16x16x32_bf16 v[184:187], v[148:151], v[172:175], v[184:187]
v_mfma_f32_16x16x32_bf16 v[188:191], v[152:155], v[172:175], v[188:191]
s_waitcnt lgkmcnt(4)
v_mfma_f32_16x16x32_bf16 v[176:179], v[144:147], v[160:163], v[176:179]
ds_read_b128 v[144:147], v8 offset:4352
v_mfma_f32_16x16x32_bf16 v[180:183], v[148:151], v[160:163], v[180:183]
ds_read_b128 v[172:175], v9 offset:4272
v_mfma_f32_16x16x32_bf16 v[184:187], v[152:155], v[160:163], v[184:187]
v_mfma_f32_16x16x32_bf16 v[188:191], v[156:159], v[160:163], v[188:191]
s_waitcnt lgkmcnt(4)
v_mfma_f32_16x16x32_bf16 v[176:179], v[148:151], v[164:167], v[176:179]
ds_read_b128 v[148:151], v8 offset:4416
v_mfma_f32_16x16x32_bf16 v[180:183], v[152:155], v[164:167], v[180:183]
ds_read_b128 v[160:163], v9 offset:4352
v_mfma_f32_16x16x32_bf16 v[184:187], v[156:159], v[164:167], v[184:187]
buffer_load_dwordx4 v[96:99], v56, s[24:27], s99 offen
v_mfma_f32_16x16x32_bf16 v[188:191], v[128:131], v[164:167], v[188:191]
buffer_load_dwordx4 v[100:103], v57, s[24:27], s99 offen
buffer_load_dwordx4 v[104:107], v58, s[24:27], s99 offen
buffer_load_dwordx4 v[108:111], v59, s[24:27], s99 offen
s_add_u32 s99, s99, 4096
s_cmp_eq_u32 s99, s82
s_cselect_b32 s99, s81, s99
s_waitcnt lgkmcnt(4)
v_mfma_f32_16x16x32_bf16 v[176:179], v[152:155], v[168:171], v[176:179]
ds_read_b128 v[152:155], v8 offset:4480
v_mfma_f32_16x16x32_bf16 v[180:183], v[156:159], v[168:171], v[180:183]
ds_read_b128 v[164:167], v9 offset:4416
v_mfma_f32_16x16x32_bf16 v[184:187], v[128:131], v[168:171], v[184:187]
v_mfma_f32_16x16x32_bf16 v[188:191], v[132:135], v[168:171], v[188:191]
s_waitcnt lgkmcnt(4)
v_mfma_f32_16x16x32_bf16 v[176:179], v[156:159], v[172:175], v[176:179]
ds_read_b128 v[156:159], v8 offset:4544
v_mfma_f32_16x16x32_bf16 v[180:183], v[128:131], v[172:175], v[180:183]
ds_read_b128 v[168:171], v9 offset:4480
v_mfma_f32_16x16x32_bf16 v[184:187], v[132:135], v[172:175], v[184:187]
v_mfma_f32_16x16x32_bf16 v[188:191], v[136:139], v[172:175], v[188:191]
s_waitcnt lgkmcnt(0)
ds_read_b128 v[128:131], v10 offset:240
ds_read_b128 v[132:135], v10 offset:176
ds_read_b128 v[136:139], v10 offset:112
ds_read_b128 v[140:143], v10 offset:48
s_and_b32 s6, s88, 0xfffffffe
s_sub_u32 s6, s91, s6
s_cmp_ge_u32 s6, 2
s_cselect_b32 s92, s1, s0
s_and_b32 s6, s6, 1
s_lshl_b32 s6, s6, 4
s_lshr_b32 s92, s92, s6
s_lshl_b32 s92, s92, 16
s_lshl_b32 s6, s91, 12
s_add_u32 s6, s6, 4194304
s_nop 4
s_waitcnt lgkmcnt(0)
v_lshlrev_b32 v131, 16, v131
v_fma_f32 v176, v131, s92, v176
v_lshlrev_b32 v130, 16, v130
v_fma_f32 v177, v130, s92, v177
v_lshlrev_b32 v129, 16, v129
v_fma_f32 v178, v129, s92, v178
v_lshlrev_b32 v128, 16, v128
v_fma_f32 v179, v128, s92, v179
v_lshlrev_b32 v135, 16, v135
v_fma_f32 v180, v135, s92, v180
v_lshlrev_b32 v134, 16, v134
v_fma_f32 v181, v134, s92, v181
v_lshlrev_b32 v133, 16, v133
v_fma_f32 v182, v133, s92, v182
v_lshlrev_b32 v132, 16, v132
v_fma_f32 v183, v132, s92, v183
v_lshlrev_b32 v139, 16, v139
v_fma_f32 v184, v139, s92, v184
v_lshlrev_b32 v138, 16, v138
v_fma_f32 v185, v138, s92, v185
v_lshlrev_b32 v137, 16, v137
v_fma_f32 v186, v137, s92, v186
v_lshlrev_b32 v136, 16, v136
v_fma_f32 v187, v136, s92, v187
v_lshlrev_b32 v143, 16, v143
v_fma_f32 v188, v143, s92, v188
v_lshlrev_b32 v142, 16, v142
v_fma_f32 v189, v142, s92, v189
v_lshlrev_b32 v141, 16, v141
v_fma_f32 v190, v141, s92, v190
v_lshlrev_b32 v140, 16, v140
v_fma_f32 v191, v140, s92, v191
v_cvt_pk_bf16_f32 v160, v176, v177
v_cvt_pk_bf16_f32 v161, v178, v179
v_cvt_pk_bf16_f32 v162, v180, v181
v_cvt_pk_bf16_f32 v163, v182, v183
buffer_store_dwordx4 v[160:163], v11, s[24:27], s6 offen offset:0 sc1
v_cvt_pk_bf16_f32 v164, v184, v185
v_cvt_pk_bf16_f32 v165, v186, v187
v_cvt_pk_bf16_f32 v166, v188, v189
v_cvt_pk_bf16_f32 v167, v190, v191
buffer_store_dwordx4 v[164:167], v11, s[24:27], s6 offen offset:128 sc1
L_gemm2:
s_waitcnt vmcnt(10)
v_mfma_f32_16x16x32_bf16 v[128:131], a[0:3], v[64:67], 0
buffer_load_dwordx4 v[112:115], v56, s[24:27], s99 offen
v_mfma_f32_16x16x32_bf16 v[148:151], a[0:3], v[68:71], 0
v_mfma_f32_16x16x32_bf16 v[168:171], a[0:3], v[72:75], 0
v_mfma_f32_16x16x32_bf16 v[188:191], a[0:3], v[76:79], 0
v_mfma_f32_16x16x32_bf16 v[132:135], a[4:7], v[64:67], 0
buffer_load_dwordx4 v[116:119], v57, s[24:27], s99 offen
v_mfma_f32_16x16x32_bf16 v[152:155], a[4:7], v[68:71], 0
v_mfma_f32_16x16x32_bf16 v[172:175], a[4:7], v[72:75], 0
v_mfma_f32_16x16x32_bf16 v[192:195], a[4:7], v[76:79], 0
v_mfma_f32_16x16x32_bf16 v[136:139], a[8:11], v[64:67], 0
buffer_load_dwordx4 v[120:123], v58, s[24:27], s99 offen
v_mfma_f32_16x16x32_bf16 v[156:159], a[8:11], v[68:71], 0
v_mfma_f32_16x16x32_bf16 v[176:179], a[8:11], v[72:75], 0
v_mfma_f32_16x16x32_bf16 v[196:199], a[8:11], v[76:79], 0
v_mfma_f32_16x16x32_bf16 v[140:143], a[12:15], v[64:67], 0
buffer_load_dwordx4 v[124:127], v59, s[24:27], s99 offen
v_mfma_f32_16x16x32_bf16 v[160:163], a[12:15], v[68:71], 0
v_mfma_f32_16x16x32_bf16 v[180:183], a[12:15], v[72:75], 0
v_mfma_f32_16x16x32_bf16 v[200:203], a[12:15], v[76:79], 0
v_mfma_f32_16x16x32_bf16 v[144:147], a[16:19], v[64:67], 0
s_add_u32 s99, s99, 4096
s_cmp_eq_u32 s99, s82
s_cselect_b32 s99, s81, s99
v_mfma_f32_16x16x32_bf16 v[164:167], a[16:19], v[68:71], 0
v_mfma_f32_16x16x32_bf16 v[184:187], a[16:19], v[72:75], 0
v_mfma_f32_16x16x32_bf16 v[204:207], a[16:19], v[76:79], 0
s_waitcnt vmcnt(10)
v_mfma_f32_16x16x32_bf16 v[128:131], a[20:23], v[80:83], v[128:131]
buffer_load_dwordx4 v[64:67], v56, s[24:27], s99 offen
v_mfma_f32_16x16x32_bf16 v[148:151], a[20:23], v[84:87], v[148:151]
v_mfma_f32_16x16x32_bf16 v[168:171], a[20:23], v[88:91], v[168:171]
v_mfma_f32_16x16x32_bf16 v[188:191], a[20:23], v[92:95], v[188:191]
v_mfma_f32_16x16x32_bf16 v[132:135], a[24:27], v[80:83], v[132:135]
buffer_load_dwordx4 v[68:71], v57, s[24:27], s99 offen
v_mfma_f32_16x16x32_bf16 v[152:155], a[24:27], v[84:87], v[152:155]
v_mfma_f32_16x16x32_bf16 v[172:175], a[24:27], v[88:91], v[172:175]
v_mfma_f32_16x16x32_bf16 v[192:195], a[24:27], v[92:95], v[192:195]
v_mfma_f32_16x16x32_bf16 v[136:139], a[28:31], v[80:83], v[136:139]
buffer_load_dwordx4 v[72:75], v58, s[24:27], s99 offen
v_mfma_f32_16x16x32_bf16 v[156:159], a[28:31], v[84:87], v[156:159]
v_mfma_f32_16x16x32_bf16 v[176:179], a[28:31], v[88:91], v[176:179]
v_mfma_f32_16x16x32_bf16 v[196:199], a[28:31], v[92:95], v[196:199]
v_mfma_f32_16x16x32_bf16 v[140:143], a[32:35], v[80:83], v[140:143]
buffer_load_dwordx4 v[76:79], v59, s[24:27], s99 offen
v_mfma_f32_16x16x32_bf16 v[160:163], a[32:35], v[84:87], v[160:163]
v_mfma_f32_16x16x32_bf16 v[180:183], a[32:35], v[88:91], v[180:183]
v_mfma_f32_16x16x32_bf16 v[200:203], a[32:35], v[92:95], v[200:203]
v_mfma_f32_16x16x32_bf16 v[144:147], a[36:39], v[80:83], v[144:147]
s_add_u32 s99, s99, 4096
s_cmp_eq_u32 s99, s82
s_cselect_b32 s99, s81, s99
v_mfma_f32_16x16x32_bf16 v[164:167], a[36:39], v[84:87], v[164:167]
v_mfma_f32_16x16x32_bf16 v[184:187], a[36:39], v[88:91], v[184:187]
v_mfma_f32_16x16x32_bf16 v[204:207], a[36:39], v[92:95], v[204:207]
s_waitcnt vmcnt(10)
v_mfma_f32_16x16x32_bf16 v[128:131], a[40:43], v[96:99], v[128:131]
buffer_load_dwordx4 v[80:83], v56, s[24:27], s99 offen
v_mfma_f32_16x16x32_bf16 v[148:151], a[40:43], v[100:103], v[148:151]
v_mfma_f32_16x16x32_bf16 v[168:171], a[40:43], v[104:107], v[168:171]
v_mfma_f32_16x16x32_bf16 v[188:191], a[40:43], v[108:111], v[188:191]
v_mfma_f32_16x16x32_bf16 v[132:135], a[44:47], v[96:99], v[132:135]
buffer_load_dwordx4 v[84:87], v57, s[24:27], s99 offen
v_mfma_f32_16x16x32_bf16 v[152:155], a[44:47], v[100:103], v[152:155]
v_mfma_f32_16x16x32_bf16 v[172:175], a[44:47], v[104:107], v[172:175]
v_mfma_f32_16x16x32_bf16 v[192:195], a[44:47], v[108:111], v[192:195]
v_mfma_f32_16x16x32_bf16 v[136:139], a[48:51], v[96:99], v[136:139]
buffer_load_dwordx4 v[88:91], v58, s[24:27], s99 offen
v_mfma_f32_16x16x32_bf16 v[156:159], a[48:51], v[100:103], v[156:159]
v_mfma_f32_16x16x32_bf16 v[176:179], a[48:51], v[104:107], v[176:179]
v_mfma_f32_16x16x32_bf16 v[196:199], a[48:51], v[108:111], v[196:199]
v_mfma_f32_16x16x32_bf16 v[140:143], a[52:55], v[96:99], v[140:143]
buffer_load_dwordx4 v[92:95], v59, s[24:27], s99 offen
v_mfma_f32_16x16x32_bf16 v[160:163], a[52:55], v[100:103], v[160:163]
v_mfma_f32_16x16x32_bf16 v[180:183], a[52:55], v[104:107], v[180:183]
v_mfma_f32_16x16x32_bf16 v[200:203], a[52:55], v[108:111], v[200:203]
v_mfma_f32_16x16x32_bf16 v[144:147], a[56:59], v[96:99], v[144:147]
s_add_u32 s99, s99, 4096
s_cmp_eq_u32 s99, s82
s_cselect_b32 s99, s81, s99
v_mfma_f32_16x16x32_bf16 v[164:167], a[56:59], v[100:103], v[164:167]
v_mfma_f32_16x16x32_bf16 v[184:187], a[56:59], v[104:107], v[184:187]
v_mfma_f32_16x16x32_bf16 v[204:207], a[56:59], v[108:111], v[204:207]
s_waitcnt vmcnt(8)
v_mfma_f32_16x16x32_bf16 v[128:131], a[60:63], v[112:115], v[128:131]
buffer_load_dwordx4 v[96:99], v56, s[24:27], s99 offen
v_mfma_f32_16x16x32_bf16 v[148:151], a[60:63], v[116:119], v[148:151]
v_mfma_f32_16x16x32_bf16 v[168:171], a[60:63], v[120:123], v[168:171]
v_mfma_f32_16x16x32_bf16 v[188:191], a[60:63], v[124:127], v[188:191]
v_mfma_f32_16x16x32_bf16 v[132:135], a[64:67], v[112:115], v[132:135]
buffer_load_dwordx4 v[100:103], v57, s[24:27], s99 offen
v_mfma_f32_16x16x32_bf16 v[152:155], a[64:67], v[116:119], v[152:155]
v_mfma_f32_16x16x32_bf16 v[172:175], a[64:67], v[120:123], v[172:175]
v_mfma_f32_16x16x32_bf16 v[192:195], a[64:67], v[124:127], v[192:195]
v_mfma_f32_16x16x32_bf16 v[136:139], a[68:71], v[112:115], v[136:139]
buffer_load_dwordx4 v[104:107], v58, s[24:27], s99 offen
v_mfma_f32_16x16x32_bf16 v[156:159], a[68:71], v[116:119], v[156:159]
v_mfma_f32_16x16x32_bf16 v[176:179], a[68:71], v[120:123], v[176:179]
v_mfma_f32_16x16x32_bf16 v[196:199], a[68:71], v[124:127], v[196:199]
v_mfma_f32_16x16x32_bf16 v[140:143], a[72:75], v[112:115], v[140:143]
buffer_load_dwordx4 v[108:111], v59, s[24:27], s99 offen
v_mfma_f32_16x16x32_bf16 v[160:163], a[72:75], v[116:119], v[160:163]
v_mfma_f32_16x16x32_bf16 v[180:183], a[72:75], v[120:123], v[180:183]
v_mfma_f32_16x16x32_bf16 v[200:203], a[72:75], v[124:127], v[200:203]
v_mfma_f32_16x16x32_bf16 v[144:147], a[76:79], v[112:115], v[144:147]
s_add_u32 s99, s99, 4096
s_cmp_eq_u32 s99, s82
s_cselect_b32 s99, s81, s99
v_mfma_f32_16x16x32_bf16 v[164:167], a[76:79], v[116:119], v[164:167]
v_mfma_f32_16x16x32_bf16 v[184:187], a[76:79], v[120:123], v[184:187]
v_mfma_f32_16x16x32_bf16 v[204:207], a[76:79], v[124:127], v[204:207]
s_barrier
s_cmp_lg_u32 s5, 0
s_cbranch_scc1 L_fl_37
s_mov_b64 exec, 1
buffer_store_dword v253, v252, s[24:27], 0 offen offset:20 sc1
s_mov_b64 exec, -1
L_fl_37:
s_waitcnt vmcnt(8)
v_mfma_f32_16x16x32_bf16 v[128:131], a[80:83], v[64:67], v[128:131]
buffer_load_dwordx4 v[112:115], v56, s[24:27], s99 offen
v_mfma_f32_16x16x32_bf16 v[148:151], a[80:83], v[68:71], v[148:151]
v_mfma_f32_16x16x32_bf16 v[168:171], a[80:83], v[72:75], v[168:171]
v_mfma_f32_16x16x32_bf16 v[188:191], a[80:83], v[76:79], v[188:191]
v_mfma_f32_16x16x32_bf16 v[132:135], a[84:87], v[64:67], v[132:135]
buffer_load_dwordx4 v[116:119], v57, s[24:27], s99 offen
v_mfma_f32_16x16x32_bf16 v[152:155], a[84:87], v[68:71], v[152:155]
v_mfma_f32_16x16x32_bf16 v[172:175], a[84:87], v[72:75], v[172:175]
v_mfma_f32_16x16x32_bf16 v[192:195], a[84:87], v[76:79], v[192:195]
v_mfma_f32_16x16x32_bf16 v[136:139], a[88:91], v[64:67], v[136:139]
buffer_load_dwordx4 v[120:123], v58, s[24:27], s99 offen
v_mfma_f32_16x16x32_bf16 v[156:159], a[88:91], v[68:71], v[156:159]
v_mfma_f32_16x16x32_bf16 v[176:179], a[88:91], v[72:75], v[176:179]
v_mfma_f32_16x16x32_bf16 v[196:199], a[88:91], v[76:79], v[196:199]
v_mfma_f32_16x16x32_bf16 v[140:143], a[92:95], v[64:67], v[140:143]
buffer_load_dwordx4 v[124:127], v59, s[24:27], s99 offen
v_mfma_f32_16x16x32_bf16 v[160:163], a[92:95], v[68:71], v[160:163]
v_mfma_f32_16x16x32_bf16 v[180:183], a[92:95], v[72:75], v[180:183]
v_mfma_f32_16x16x32_bf16 v[200:203], a[92:95], v[76:79], v[200:203]
v_mfma_f32_16x16x32_bf16 v[144:147], a[96:99], v[64:67], v[144:147]
s_add_u32 s99, s99, 4096
s_cmp_eq_u32 s99, s82
s_cselect_b32 s99, s81, s99
v_mfma_f32_16x16x32_bf16 v[164:167], a[96:99], v[68:71], v[164:167]
v_mfma_f32_16x16x32_bf16 v[184:187], a[96:99], v[72:75], v[184:187]
v_mfma_f32_16x16x32_bf16 v[204:207], a[96:99], v[76:79], v[204:207]
s_waitcnt vmcnt(8)
v_mfma_f32_16x16x32_bf16 v[128:131], a[100:103], v[80:83], v[128:131]
buffer_load_dwordx4 v[64:67], v56, s[24:27], s99 offen
v_mfma_f32_16x16x32_bf16 v[148:151], a[100:103], v[84:87], v[148:151]
v_mfma_f32_16x16x32_bf16 v[168:171], a[100:103], v[88:91], v[168:171]
v_mfma_f32_16x16x32_bf16 v[188:191], a[100:103], v[92:95], v[188:191]
v_mfma_f32_16x16x32_bf16 v[132:135], a[104:107], v[80:83], v[132:135]
buffer_load_dwordx4 v[68:71], v57, s[24:27], s99 offen
v_mfma_f32_16x16x32_bf16 v[152:155], a[104:107], v[84:87], v[152:155]
v_mfma_f32_16x16x32_bf16 v[172:175], a[104:107], v[88:91], v[172:175]
v_mfma_f32_16x16x32_bf16 v[192:195], a[104:107], v[92:95], v[192:195]
v_mfma_f32_16x16x32_bf16 v[136:139], a[108:111], v[80:83], v[136:139]
buffer_load_dwordx4 v[72:75], v58, s[24:27], s99 offen
v_mfma_f32_16x16x32_bf16 v[156:159], a[108:111], v[84:87], v[156:159]
v_mfma_f32_16x16x32_bf16 v[176:179], a[108:111], v[88:91], v[176:179]
v_mfma_f32_16x16x32_bf16 v[196:199], a[108:111], v[92:95], v[196:199]
v_mfma_f32_16x16x32_bf16 v[140:143], a[112:115], v[80:83], v[140:143]
buffer_load_dwordx4 v[76:79], v59, s[24:27], s99 offen
v_mfma_f32_16x16x32_bf16 v[160:163], a[112:115], v[84:87], v[160:163]
v_mfma_f32_16x16x32_bf16 v[180:183], a[112:115], v[88:91], v[180:183]
v_mfma_f32_16x16x32_bf16 v[200:203], a[112:115], v[92:95], v[200:203]
v_mfma_f32_16x16x32_bf16 v[144:147], a[116:119], v[80:83], v[144:147]
s_add_u32 s99, s99, 4096
s_cmp_eq_u32 s99, s82
s_cselect_b32 s99, s81, s99
v_mfma_f32_16x16x32_bf16 v[164:167], a[116:119], v[84:87], v[164:167]
v_mfma_f32_16x16x32_bf16 v[184:187], a[116:119], v[88:91], v[184:187]
v_mfma_f32_16x16x32_bf16 v[204:207], a[116:119], v[92:95], v[204:207]
s_waitcnt vmcnt(8)
v_mfma_f32_16x16x32_bf16 v[128:131], a[120:123], v[96:99], v[128:131]
buffer_load_dwordx4 v[80:83], v56, s[24:27], s99 offen
v_mfma_f32_16x16x32_bf16 v[148:151], a[120:123], v[100:103], v[148:151]
v_mfma_f32_16x16x32_bf16 v[168:171], a[120:123], v[104:107], v[168:171]
v_mfma_f32_16x16x32_bf16 v[188:191], a[120:123], v[108:111], v[188:191]
v_mfma_f32_16x16x32_bf16 v[132:135], a[124:127], v[96:99], v[132:135]
buffer_load_dwordx4 v[84:87], v57, s[24:27], s99 offen
v_mfma_f32_16x16x32_bf16 v[152:155], a[124:127], v[100:103], v[152:155]
v_mfma_f32_16x16x32_bf16 v[172:175], a[124:127], v[104:107], v[172:175]
v_mfma_f32_16x16x32_bf16 v[192:195], a[124:127], v[108:111], v[192:195]
v_mfma_f32_16x16x32_bf16 v[136:139], a[128:131], v[96:99], v[136:139]
buffer_load_dwordx4 v[88:91], v58, s[24:27], s99 offen
v_mfma_f32_16x16x32_bf16 v[156:159], a[128:131], v[100:103], v[156:159]
v_mfma_f32_16x16x32_bf16 v[176:179], a[128:131], v[104:107], v[176:179]
v_mfma_f32_16x16x32_bf16 v[196:199], a[128:131], v[108:111], v[196:199]
v_mfma_f32_16x16x32_bf16 v[140:143], a[132:135], v[96:99], v[140:143]
buffer_load_dwordx4 v[92:95], v59, s[24:27], s99 offen
v_mfma_f32_16x16x32_bf16 v[160:163], a[132:135], v[100:103], v[160:163]
v_mfma_f32_16x16x32_bf16 v[180:183], a[132:135], v[104:107], v[180:183]
v_mfma_f32_16x16x32_bf16 v[200:203], a[132:135], v[108:111], v[200:203]
v_mfma_f32_16x16x32_bf16 v[144:147], a[136:139], v[96:99], v[144:147]
s_add_u32 s99, s99, 4096
s_cmp_eq_u32 s99, s82
s_cselect_b32 s99, s81, s99
v_mfma_f32_16x16x32_bf16 v[164:167], a[136:139], v[100:103], v[164:167]
v_mfma_f32_16x16x32_bf16 v[184:187], a[136:139], v[104:107], v[184:187]
v_mfma_f32_16x16x32_bf16 v[204:207], a[136:139], v[108:111], v[204:207]
s_waitcnt vmcnt(8)
v_mfma_f32_16x16x32_bf16 v[128:131], a[140:143], v[112:115], v[128:131]
buffer_load_dwordx4 v[96:99], v56, s[24:27], s99 offen
v_mfma_f32_16x16x32_bf16 v[148:151], a[140:143], v[116:119], v[148:151]
v_mfma_f32_16x16x32_bf16 v[168:171], a[140:143], v[120:123], v[168:171]
v_mfma_f32_16x16x32_bf16 v[188:191], a[140:143], v[124:127], v[188:191]
v_mfma_f32_16x16x32_bf16 v[132:135], a[144:147], v[112:115], v[132:135]
buffer_load_dwordx4 v[100:103], v57, s[24:27], s99 offen
v_mfma_f32_16x16x32_bf16 v[152:155], a[144:147], v[116:119], v[152:155]
v_mfma_f32_16x16x32_bf16 v[172:175], a[144:147], v[120:123], v[172:175]
v_mfma_f32_16x16x32_bf16 v[192:195], a[144:147], v[124:127], v[192:195]
v_mfma_f32_16x16x32_bf16 v[136:139], a[148:151], v[112:115], v[136:139]
buffer_load_dwordx4 v[104:107], v58, s[24:27], s99 offen
v_mfma_f32_16x16x32_bf16 v[156:159], a[148:151], v[116:119], v[156:159]
v_mfma_f32_16x16x32_bf16 v[176:179], a[148:151], v[120:123], v[176:179]
v_mfma_f32_16x16x32_bf16 v[196:199], a[148:151], v[124:127], v[196:199]
v_mfma_f32_16x16x32_bf16 v[140:143], a[152:155], v[112:115], v[140:143]
buffer_load_dwordx4 v[108:111], v59, s[24:27], s99 offen
v_mfma_f32_16x16x32_bf16 v[160:163], a[152:155], v[116:119], v[160:163]
v_mfma_f32_16x16x32_bf16 v[180:183], a[152:155], v[120:123], v[180:183]
v_mfma_f32_16x16x32_bf16 v[200:203], a[152:155], v[124:127], v[200:203]
v_mfma_f32_16x16x32_bf16 v[144:147], a[156:159], v[112:115], v[144:147]
s_add_u32 s99, s99, 4096
s_cmp_eq_u32 s99, s82
s_cselect_b32 s99, s81, s99
v_mfma_f32_16x16x32_bf16 v[164:167], a[156:159], v[116:119], v[164:167]
v_mfma_f32_16x16x32_bf16 v[184:187], a[156:159], v[120:123], v[184:187]
v_mfma_f32_16x16x32_bf16 v[204:207], a[156:159], v[124:127], v[204:207]
buffer_load_dword v254, v250, s[24:27], 0 offen sc1
s_waitcnt vmcnt(9)
v_mfma_f32_16x16x32_bf16 v[128:131], a[160:163], v[64:67], v[128:131]
buffer_load_dwordx4 v[112:115], v56, s[24:27], s99 offen
v_mfma_f32_16x16x32_bf16 v[148:151], a[160:163], v[68:71], v[148:151]
v_mfma_f32_16x16x32_bf16 v[168:171], a[160:163], v[72:75], v[168:171]
v_mfma_f32_16x16x32_bf16 v[188:191], a[160:163], v[76:79], v[188:191]
v_mfma_f32_16x16x32_bf16 v[132:135], a[164:167], v[64:67], v[132:135]
buffer_load_dwordx4 v[116:119], v57, s[24:27], s99 offen
v_mfma_f32_16x16x32_bf16 v[152:155], a[164:167], v[68:71], v[152:155]
v_mfma_f32_16x16x32_bf16 v[172:175], a[164:167], v[72:75], v[172:175]
v_mfma_f32_16x16x32_bf16 v[192:195], a[164:167], v[76:79], v[192:195]
v_mfma_f32_16x16x32_bf16 v[136:139], a[168:171], v[64:67], v[136:139]
buffer_load_dwordx4 v[120:123], v58, s[24:27], s99 offen
v_mfma_f32_16x16x32_bf16 v[156:159], a[168:171], v[68:71], v[156:159]
v_mfma_f32_16x16x32_bf16 v[176:179], a[168:171], v[72:75], v[176:179]
v_mfma_f32_16x16x32_bf16 v[196:199], a[168:171], v[76:79], v[196:199]
v_mfma_f32_16x16x32_bf16 v[140:143], a[172:175], v[64:67], v[140:143]
buffer_load_dwordx4 v[124:127], v59, s[24:27], s99 offen
v_mfma_f32_16x16x32_bf16 v[160:163], a[172:175], v[68:71], v[160:163]
v_mfma_f32_16x16x32_bf16 v[180:183], a[172:175], v[72:75], v[180:183]
v_mfma_f32_16x16x32_bf16 v[200:203], a[172:175], v[76:79], v[200:203]
v_mfma_f32_16x16x32_bf16 v[144:147], a[176:179], v[64:67], v[144:147]
s_add_u32 s99, s99, 4096
s_cmp_eq_u32 s99, s82
s_cselect_b32 s99, s81, s99
v_mfma_f32_16x16x32_bf16 v[164:167], a[176:179], v[68:71], v[164:167]
v_mfma_f32_16x16x32_bf16 v[184:187], a[176:179], v[72:75], v[184:187]
v_mfma_f32_16x16x32_bf16 v[204:207], a[176:179], v[76:79], v[204:207]
s_waitcnt vmcnt(9)
v_mfma_f32_16x16x32_bf16 v[128:131], a[180:183], v[80:83], v[128:131]
buffer_load_dwordx4 v[64:67], v56, s[24:27], s99 offen
v_mfma_f32_16x16x32_bf16 v[148:151], a[180:183], v[84:87], v[148:151]
v_mfma_f32_16x16x32_bf16 v[168:171], a[180:183], v[88:91], v[168:171]
v_mfma_f32_16x16x32_bf16 v[188:191], a[180:183], v[92:95], v[188:191]
v_mfma_f32_16x16x32_bf16 v[132:135], a[184:187], v[80:83], v[132:135]
buffer_load_dwordx4 v[68:71], v57, s[24:27], s99 offen
v_mfma_f32_16x16x32_bf16 v[152:155], a[184:187], v[84:87], v[152:155]
v_mfma_f32_16x16x32_bf16 v[172:175], a[184:187], v[88:91], v[172:175]
v_mfma_f32_16x16x32_bf16 v[192:195], a[184:187], v[92:95], v[192:195]
v_mfma_f32_16x16x32_bf16 v[136:139], a[188:191], v[80:83], v[136:139]
buffer_load_dwordx4 v[72:75], v58, s[24:27], s99 offen
v_mfma_f32_16x16x32_bf16 v[156:159], a[188:191], v[84:87], v[156:159]
v_mfma_f32_16x16x32_bf16 v[176:179], a[188:191], v[88:91], v[176:179]
v_mfma_f32_16x16x32_bf16 v[196:199], a[188:191], v[92:95], v[196:199]
v_mfma_f32_16x16x32_bf16 v[140:143], a[192:195], v[80:83], v[140:143]
buffer_load_dwordx4 v[76:79], v59, s[24:27], s99 offen
v_mfma_f32_16x16x32_bf16 v[160:163], a[192:195], v[84:87], v[160:163]
v_mfma_f32_16x16x32_bf16 v[180:183], a[192:195], v[88:91], v[180:183]
v_mfma_f32_16x16x32_bf16 v[200:203], a[192:195], v[92:95], v[200:203]
v_mfma_f32_16x16x32_bf16 v[144:147], a[196:199], v[80:83], v[144:147]
s_add_u32 s99, s99, 4096
s_cmp_eq_u32 s99, s82
s_cselect_b32 s99, s81, s99
v_mfma_f32_16x16x32_bf16 v[164:167], a[196:199], v[84:87], v[164:167]
v_mfma_f32_16x16x32_bf16 v[184:187], a[196:199], v[88:91], v[184:187]
v_mfma_f32_16x16x32_bf16 v[204:207], a[196:199], v[92:95], v[204:207]
s_waitcnt vmcnt(9)
v_mfma_f32_16x16x32_bf16 v[128:131], a[200:203], v[96:99], v[128:131]
buffer_load_dwordx4 v[80:83], v56, s[24:27], s99 offen
v_mfma_f32_16x16x32_bf16 v[148:151], a[200:203], v[100:103], v[148:151]
s_mov_b32 s32, s60
s_and_b32 s33, s61, 0xffff
s_mov_b32 s34, 1280
v_mfma_f32_16x16x32_bf16 v[168:171], a[200:203], v[104:107], v[168:171]
s_mov_b32 s35, 0x20000
v_and_b32 v2, 15, v1
v_lshrrev_b32 v3, 4, v1
v_mfma_f32_16x16x32_bf16 v[188:191], a[200:203], v[108:111], v[188:191]
v_lshrrev_b32 v4, 3, v2
v_lshlrev_b32 v4, 3, v4
v_and_b32 v5, 3, v2
v_mfma_f32_16x16x32_bf16 v[132:135], a[204:207], v[96:99], v[132:135]
buffer_load_dwordx4 v[84:87], v57, s[24:27], s99 offen
v_mfma_f32_16x16x32_bf16 v[152:155], a[204:207], v[100:103], v[152:155]
v_lshl_or_b32 v4, v5, 1, v4
v_bfe_u32 v5, v2, 2, 1
v_or_b32 v4, v4, v5
v_mfma_f32_16x16x32_bf16 v[172:175], a[204:207], v[104:107], v[172:175]
s_lshl_b32 s6, s94, 6
s_lshl_b32 s7, s5, 4
s_add_u32 s6, s6, s7
v_mfma_f32_16x16x32_bf16 v[192:195], a[204:207], v[108:111], v[192:195]
v_add_u32 v4, s6, v4
v_lshlrev_b32 v5, 4, v4
v_mul_u32_u24 v4, 1280, v4
v_mfma_f32_16x16x32_bf16 v[136:139], a[208:211], v[96:99], v[136:139]
buffer_load_dwordx4 v[88:91], v58, s[24:27], s99 offen
v_mfma_f32_16x16x32_bf16 v[156:159], a[208:211], v[100:103], v[156:159]
v_mul_u32_u24 v3, 40, v3
s_mul_i32 s6, s95, 160
v_add_u32 v3, s6, v3
v_mfma_f32_16x16x32_bf16 v[176:179], a[208:211], v[104:107], v[176:179]
v_add_u32 v60, v4, v3
s_mov_b32 s7, 98304
v_mfma_f32_16x16x32_bf16 v[196:199], a[208:211], v[108:111], v[196:199]
v_mfma_f32_16x16x32_bf16 v[140:143], a[212:215], v[96:99], v[140:143]
buffer_load_dwordx4 v[92:95], v59, s[24:27], s99 offen
v_mfma_f32_16x16x32_bf16 v[160:163], a[212:215], v[100:103], v[160:163]
buffer_load_dwordx4 v[32:35], v5, s[24:27], s7 offen
v_mfma_f32_16x16x32_bf16 v[180:183], a[212:215], v[104:107], v[180:183]
v_mfma_f32_16x16x32_bf16 v[200:203], a[212:215], v[108:111], v[200:203]
buffer_load_dwordx4 v[8:11], v60, s[8:11], 0 offen
v_mfma_f32_16x16x32_bf16 v[144:147], a[216:219], v[96:99], v[144:147]
s_add_u32 s99, s99, 4096
s_cmp_eq_u32 s99, s82
s_cselect_b32 s99, s81, s99
v_mfma_f32_16x16x32_bf16 v[164:167], a[216:219], v[100:103], v[164:167]
buffer_load_dwordx4 v[12:15], v60, s[8:11], 0 offen offset:16
v_mfma_f32_16x16x32_bf16 v[184:187], a[216:219], v[104:107], v[184:187]
v_mfma_f32_16x16x32_bf16 v[204:207], a[216:219], v[108:111], v[204:207]
buffer_load_dwordx2 v[16:17], v60, s[8:11], 0 offen offset:32
s_waitcnt vmcnt(12)
v_mfma_f32_16x16x32_bf16 v[128:131], a[220:223], v[112:115], v[128:131]
v_mfma_f32_16x16x32_bf16 v[148:151], a[220:223], v[116:119], v[148:151]
buffer_load_dwordx4 v[20:23], v3, s[32:35], 0 offen
v_mfma_f32_16x16x32_bf16 v[168:171], a[220:223], v[120:123], v[168:171]
v_mfma_f32_16x16x32_bf16 v[188:191], a[220:223], v[124:127], v[188:191]
buffer_load_dwordx4 v[24:27], v3, s[32:35], 0 offen offset:16
v_mfma_f32_16x16x32_bf16 v[132:135], a[224:227], v[112:115], v[132:135]
v_mfma_f32_16x16x32_bf16 v[152:155], a[224:227], v[116:119], v[152:155]
buffer_load_dwordx2 v[28:29], v3, s[32:35], 0 offen offset:32
v_mfma_f32_16x16x32_bf16 v[172:175], a[224:227], v[120:123], v[172:175]
v_mfma_f32_16x16x32_bf16 v[192:195], a[224:227], v[124:127], v[192:195]
v_mfma_f32_16x16x32_bf16 v[136:139], a[228:231], v[112:115], v[136:139]
v_mfma_f32_16x16x32_bf16 v[156:159], a[228:231], v[116:119], v[156:159]
v_mfma_f32_16x16x32_bf16 v[176:179], a[228:231], v[120:123], v[176:179]
v_mfma_f32_16x16x32_bf16 v[196:199], a[228:231], v[124:127], v[196:199]
v_mfma_f32_16x16x32_bf16 v[140:143], a[232:235], v[112:115], v[140:143]
v_mfma_f32_16x16x32_bf16 v[160:163], a[232:235], v[116:119], v[160:163]
v_mfma_f32_16x16x32_bf16 v[180:183], a[232:235], v[120:123], v[180:183]
v_mfma_f32_16x16x32_bf16 v[200:203], a[232:235], v[124:127], v[200:203]
v_mfma_f32_16x16x32_bf16 v[144:147], a[236:239], v[112:115], v[144:147]
v_mfma_f32_16x16x32_bf16 v[164:167], a[236:239], v[116:119], v[164:167]
v_mfma_f32_16x16x32_bf16 v[184:187], a[236:239], v[120:123], v[184:187]
v_mfma_f32_16x16x32_bf16 v[204:207], a[236:239], v[124:127], v[204:207]
v_cmp_eq_u32 vcc, 0, v254
s_cbranch_vccnz L_slow_38
L_back_39:
v_lshrrev_b32 v2, 3, v1
v_and_b32 v3, 7, v1
v_lshlrev_b32 v3, 4, v3
v_lshl_add_u32 v61, v2, 12, v3
s_mul_i32 s6, s95, 80
s_lshl_b32 s7, s5, 3
s_add_u32 s6, s6, s7
s_lshl_b32 s6, s6, 12
s_lshl_b32 s7, s94, 7
s_add_u32 s6, s6, s7
s_add_u32 s6, s6, 4194304
s_lshl_b32 s7, s5, 10
s_add_u32 s7, s7, 61440
s_mov_b32 m0, s7
s_add_u32 s7, s7, 4096
buffer_load_dwordx4 v61, s[24:27], s6 offen lds
s_add_u32 s6, s6, 131072
s_mov_b32 m0, s7
s_add_u32 s7, s7, 4096
buffer_load_dwordx4 v61, s[24:27], s6 offen lds
s_add_u32 s6, s6, 131072
s_cmp_ge_u32 s5, 2
s_cbranch_scc1 L_y2skip_40
s_mov_b32 m0, s7
s_add_u32 s7, s7, 4096
buffer_load_dwordx4 v61, s[24:27], s6 offen lds
s_add_u32 s6, s6, 131072
L_y2skip_40:
s_waitcnt vmcnt(13)
v_mfma_f32_16x16x32_bf16 v[128:131], v[208:211], v[64:67], v[128:131]
v_mfma_f32_16x16x32_bf16 v[148:151], v[208:211], v[68:71], v[148:151]
v_mfma_f32_16x16x32_bf16 v[168:171], v[208:211], v[72:75], v[168:171]
v_mfma_f32_16x16x32_bf16 v[188:191], v[208:211], v[76:79], v[188:191]
v_mfma_f32_16x16x32_bf16 v[132:135], v[212:215], v[64:67], v[132:135]
v_mfma_f32_16x16x32_bf16 v[152:155], v[212:215], v[68:71], v[152:155]
v_mfma_f32_16x16x32_bf16 v[172:175], v[212:215], v[72:75], v[172:175]
v_mfma_f32_16x16x32_bf16 v[192:195], v[212:215], v[76:79], v[192:195]
v_mfma_f32_16x16x32_bf16 v[136:139], v[216:219], v[64:67], v[136:139]
v_mfma_f32_16x16x32_bf16 v[156:159], v[216:219], v[68:71], v[156:159]
v_mfma_f32_16x16x32_bf16 v[176:179], v[216:219], v[72:75], v[176:179]
v_mfma_f32_16x16x32_bf16 v[196:199], v[216:219], v[76:79], v[196:199]
v_mfma_f32_16x16x32_bf16 v[140:143], v[220:223], v[64:67], v[140:143]
v_mfma_f32_16x16x32_bf16 v[160:163], v[220:223], v[68:71], v[160:163]
v_mfma_f32_16x16x32_bf16 v[180:183], v[220:223], v[72:75], v[180:183]
v_mfma_f32_16x16x32_bf16 v[200:203], v[220:223], v[76:79], v[200:203]
v_mfma_f32_16x16x32_bf16 v[144:147], v[224:227], v[64:67], v[144:147]
v_mfma_f32_16x16x32_bf16 v[164:167], v[224:227], v[68:71], v[164:167]
v_mfma_f32_16x16x32_bf16 v[184:187], v[224:227], v[72:75], v[184:187]
v_mfma_f32_16x16x32_bf16 v[204:207], v[224:227], v[76:79], v[204:207]
s_cmp_ge_u32 s5, 2
s_cbranch_scc1 L_g2skip_36
s_waitcnt vmcnt(9)
v_mfma_f32_16x16x32_bf16 v[128:131], v[228:231], v[80:83], v[128:131]
v_mfma_f32_16x16x32_bf16 v[148:151], v[228:231], v[84:87], v[148:151]
v_mfma_f32_16x16x32_bf16 v[168:171], v[228:231], v[88:91], v[168:171]
v_mfma_f32_16x16x32_bf16 v[188:191], v[228:231], v[92:95], v[188:191]
v_mfma_f32_16x16x32_bf16 v[132:135], v[232:235], v[80:83], v[132:135]
v_mfma_f32_16x16x32_bf16 v[152:155], v[232:235], v[84:87], v[152:155]
v_mfma_f32_16x16x32_bf16 v[172:175], v[232:235], v[88:91], v[172:175]
v_mfma_f32_16x16x32_bf16 v[192:195], v[232:235], v[92:95], v[192:195]
v_mfma_f32_16x16x32_bf16 v[136:139], v[236:239], v[80:83], v[136:139]
v_mfma_f32_16x16x32_bf16 v[156:159], v[236:239], v[84:87], v[156:159]
v_mfma_f32_16x16x32_bf16 v[176:179], v[236:239], v[88:91], v[176:179]
v_mfma_f32_16x16x32_bf16 v[196:199], v[236:239], v[92:95], v[196:199]
v_mfma_f32_16x16x32_bf16 v[140:143], v[240:243], v[80:83], v[140:143]
v_mfma_f32_16x16x32_bf16 v[160:163], v[240:243], v[84:87], v[160:163]
v_mfma_f32_16x16x32_bf16 v[180:183], v[240:243], v[88:91], v[180:183]
v_mfma_f32_16x16x32_bf16 v[200:203], v[240:243], v[92:95], v[200:203]
v_mfma_f32_16x16x32_bf16 v[144:147], v[244:247], v[80:83], v[144:147]
v_mfma_f32_16x16x32_bf16 v[164:167], v[244:247], v[84:87], v[164:167]
v_mfma_f32_16x16x32_bf16 v[184:187], v[244:247], v[88:91], v[184:187]
v_mfma_f32_16x16x32_bf16 v[204:207], v[244:247], v[92:95], v[204:207]
L_g2skip_36:
s_mul_i32 s6, s5, 15360
s_add_u32 s6, s6, 0
v_add_u32 v62, s6, v248
s_add_u32 s6, s5, 1
s_and_b32 s6, s6, 3
s_mul_i32 s6, s6, 15360
s_add_u32 s6, s6, 0
v_add_u32 v57, s6, v248
s_add_u32 s6, s5, 2
s_and_b32 s6, s6, 3
s_mul_i32 s6, s6, 15360
s_add_u32 s6, s6, 5120
v_add_u32 v58, s6, v248
s_add_u32 s6, s5, 3
s_and_b32 s6, s6, 3
s_mul_i32 s6, s6, 15360
s_add_u32 s6, s6, 10240
v_add_u32 v59, s6, v248
s_nop 4
ds_write_b128 v57, v[148:151] offset:0
ds_write_b128 v57, v[152:155] offset:1024
ds_write_b128 v57, v[156:159] offset:2048
ds_write_b128 v57, v[160:163] offset:3072
ds_write_b128 v57, v[164:167] offset:4096
ds_write_b128 v58, v[168:171] offset:0
ds_write_b128 v58, v[172:175] offset:1024
ds_write_b128 v58, v[176:179] offset:2048
ds_write_b128 v58, v[180:183] offset:3072
ds_write_b128 v58, v[184:187] offset:4096
ds_write_b128 v59, v[188:191] offset:0
ds_write_b128 v59, v[192:195] offset:1024
ds_write_b128 v59, v[196:199] offset:2048
ds_write_b128 v59, v[200:203] offset:3072
ds_write_b128 v59, v[204:207] offset:4096
v_lshrrev_b32 v3, 4, v1
v_mul_u32_u24 v3, 20, v3
v_bfe_u32 v4, v1, 2, 2
v_add_u32 v3, v3, v4
v_lshlrev_b32 v3, 7, v3
v_and_b32 v4, 3, v1
v_lshl_add_u32 v3, v4, 4, v3
s_and_b32 s6, s5, 1
s_lshl_b32 s6, s6, 6
s_lshr_b32 s7, s5, 1
s_lshl_b32 s7, s7, 3
s_add_u32 s6, s6, s7
s_add_u32 s6, s6, 61440
v_add_u32 v63, s6, v3
s_waitcnt vmcnt(0) lgkmcnt(0)
s_barrier
ds_read_b128 v[64:67], v62 offset:0
ds_read_b128 v[68:71], v62 offset:1024
ds_read_b128 v[72:75], v62 offset:2048
ds_read_b128 v[76:79], v62 offset:3072
ds_read_b128 v[80:83], v62 offset:4096
ds_read_b128 v[84:87], v62 offset:5120
ds_read_b128 v[88:91], v62 offset:6144
ds_read_b128 v[92:95], v62 offset:7168
ds_read_b128 v[96:99], v62 offset:8192
ds_read_b128 v[100:103], v62 offset:9216
ds_read_b128 v[104:107], v62 offset:10240
ds_read_b128 v[108:111], v62 offset:11264
ds_read_b128 v[112:115], v62 offset:12288
ds_read_b128 v[116:119], v62 offset:13312
ds_read_b128 v[120:123], v62 offset:14336
ds_read_b64_tr_b16 v[36:37], v63 offset:0
ds_read_b64_tr_b16 v[38:39], v63 offset:512
ds_read_b64_tr_b16 v[40:41], v63 offset:1024
ds_read_b64_tr_b16 v[42:43], v63 offset:1536
ds_read_b64_tr_b16 v[44:45], v63 offset:2048
v_mul_f32 v46, v32, v33
v_sub_f32 v46, 0, v46
v_mov_b32 v47, v33
v_mov_b32 v48, -1.4426950408889634
v_mov_b32 v49, 1.0
s_waitcnt lgkmcnt(15)
v_pk_add_f32 v[128:129], v[128:129], v[64:65]
v_pk_add_f32 v[130:131], v[130:131], v[66:67]
v_pk_add_f32 v[132:133], v[132:133], v[68:69]
v_pk_add_f32 v[134:135], v[134:135], v[70:71]
v_pk_add_f32 v[136:137], v[136:137], v[72:73]
v_pk_add_f32 v[138:139], v[138:139], v[74:75]
v_pk_add_f32 v[140:141], v[140:141], v[76:77]
v_pk_add_f32 v[142:143], v[142:143], v[78:79]
v_pk_add_f32 v[144:145], v[144:145], v[80:81]
v_pk_add_f32 v[146:147], v[146:147], v[82:83]
s_waitcnt lgkmcnt(10)
v_pk_add_f32 v[128:129], v[128:129], v[84:85]
v_pk_add_f32 v[130:131], v[130:131], v[86:87]
v_pk_add_f32 v[132:133], v[132:133], v[88:89]
v_pk_add_f32 v[134:135], v[134:135], v[90:91]
v_pk_add_f32 v[136:137], v[136:137], v[92:93]
v_pk_add_f32 v[138:139], v[138:139], v[94:95]
v_pk_add_f32 v[140:141], v[140:141], v[96:97]
v_pk_add_f32 v[142:143], v[142:143], v[98:99]
v_pk_add_f32 v[144:145], v[144:145], v[100:101]
v_pk_add_f32 v[146:147], v[146:147], v[102:103]
s_waitcnt lgkmcnt(5)
v_pk_add_f32 v[128:129], v[128:129], v[104:105]
v_pk_add_f32 v[130:131], v[130:131], v[106:107]
v_pk_add_f32 v[132:133], v[132:133], v[108:109]
v_pk_add_f32 v[134:135], v[134:135], v[110:111]
v_pk_add_f32 v[136:137], v[136:137], v[112:113]
v_pk_add_f32 v[138:139], v[138:139], v[114:115]
v_pk_add_f32 v[140:141], v[140:141], v[116:117]
v_pk_add_f32 v[142:143], v[142:143], v[118:119]
v_pk_add_f32 v[144:145], v[144:145], v[120:121]
v_pk_add_f32 v[146:147], v[146:147], v[122:123]
s_waitcnt lgkmcnt(0)
v_lshlrev_b32 v64, 16, v20
v_and_b32 v65, 0xffff0000, v20
v_lshlrev_b32 v66, 16, v21
v_and_b32 v67, 0xffff0000, v21
v_lshlrev_b32 v68, 16, v22
v_and_b32 v69, 0xffff0000, v22
v_lshlrev_b32 v70, 16, v23
v_and_b32 v71, 0xffff0000, v23
v_lshlrev_b32 v72, 16, v24
v_and_b32 v73, 0xffff0000, v24
v_pk_add_f32 v[128:129], v[128:129], v[64:65]
v_pk_add_f32 v[130:131], v[130:131], v[66:67]
v_pk_add_f32 v[132:133], v[132:133], v[68:69]
v_pk_add_f32 v[134:135], v[134:135], v[70:71]
v_pk_add_f32 v[136:137], v[136:137], v[72:73]
v_pk_mul_f32 v[64:65], v[128:129], v[48:49] op_sel_hi:[1,0]
v_pk_mul_f32 v[66:67], v[130:131], v[48:49] op_sel_hi:[1,0]
v_pk_mul_f32 v[68:69], v[132:133], v[48:49] op_sel_hi:[1,0]
v_pk_mul_f32 v[70:71], v[134:135], v[48:49] op_sel_hi:[1,0]
v_pk_mul_f32 v[72:73], v[136:137], v[48:49] op_sel_hi:[1,0]
v_exp_f32 v64, v64
v_exp_f32 v65, v65
v_exp_f32 v66, v66
v_exp_f32 v67, v67
v_exp_f32 v68, v68
v_exp_f32 v69, v69
v_exp_f32 v70, v70
v_exp_f32 v71, v71
v_exp_f32 v72, v72
v_exp_f32 v73, v73
v_lshlrev_b32 v74, 16, v8
v_and_b32 v75, 0xffff0000, v8
v_lshlrev_b32 v76, 16, v9
v_and_b32 v77, 0xffff0000, v9
v_lshlrev_b32 v78, 16, v10
v_and_b32 v79, 0xffff0000, v10
v_lshlrev_b32 v80, 16, v11
v_and_b32 v81, 0xffff0000, v11
v_lshlrev_b32 v82, 16, v12
v_and_b32 v83, 0xffff0000, v12
v_pk_add_f32 v[64:65], v[64:65], v[48:49] op_sel:[0,1] op_sel_hi:[1,1]
v_pk_add_f32 v[66:67], v[66:67], v[48:49] op_sel:[0,1] op_sel_hi:[1,1]
v_pk_add_f32 v[68:69], v[68:69], v[48:49] op_sel:[0,1] op_sel_hi:[1,1]
v_pk_add_f32 v[70:71], v[70:71], v[48:49] op_sel:[0,1] op_sel_hi:[1,1]
v_pk_add_f32 v[72:73], v[72:73], v[48:49] op_sel:[0,1] op_sel_hi:[1,1]
v_rcp_f32 v64, v64
v_rcp_f32 v65, v65
v_rcp_f32 v66, v66
v_rcp_f32 v67, v67
v_rcp_f32 v68, v68
v_rcp_f32 v69, v69
v_rcp_f32 v70, v70
v_rcp_f32 v71, v71
v_rcp_f32 v72, v72
v_rcp_f32 v73, v73
v_lshlrev_b32 v84, 16, v36
v_and_b32 v85, 0xffff0000, v36
v_lshlrev_b32 v86, 16, v37
v_and_b32 v87, 0xffff0000, v37
v_lshlrev_b32 v88, 16, v38
v_and_b32 v89, 0xffff0000, v38
v_lshlrev_b32 v90, 16, v39
v_and_b32 v91, 0xffff0000, v39
v_lshlrev_b32 v92, 16, v40
v_and_b32 v93, 0xffff0000, v40
v_pk_mul_f32 v[64:65], v[64:65], v[128:129]
v_pk_mul_f32 v[66:67], v[66:67], v[130:131]
v_pk_mul_f32 v[68:69], v[68:69], v[132:133]
v_pk_mul_f32 v[70:71], v[70:71], v[134:135]
v_pk_mul_f32 v[72:73], v[72:73], v[136:137]
v_pk_fma_f32 v[128:129], v[74:75], v[46:47], v[46:47] op_sel:[0,1,0] op_sel_hi:[1,1,0]
v_pk_fma_f32 v[130:131], v[76:77], v[46:47], v[46:47] op_sel:[0,1,0] op_sel_hi:[1,1,0]
v_pk_fma_f32 v[132:133], v[78:79], v[46:47], v[46:47] op_sel:[0,1,0] op_sel_hi:[1,1,0]
v_pk_fma_f32 v[134:135], v[80:81], v[46:47], v[46:47] op_sel:[0,1,0] op_sel_hi:[1,1,0]
v_pk_fma_f32 v[136:137], v[82:83], v[46:47], v[46:47] op_sel:[0,1,0] op_sel_hi:[1,1,0]
v_pk_mul_f32 v[128:129], v[128:129], v[84:85]
v_pk_mul_f32 v[130:131], v[130:131], v[86:87]
v_pk_mul_f32 v[132:133], v[132:133], v[88:89]
v_pk_mul_f32 v[134:135], v[134:135], v[90:91]
v_pk_mul_f32 v[136:137], v[136:137], v[92:93]
v_pk_fma_f32 v[128:129], v[128:129], v[64:65], v[74:75]
v_pk_fma_f32 v[130:131], v[130:131], v[66:67], v[76:77]
v_pk_fma_f32 v[132:133], v[132:133], v[68:69], v[78:79]
v_pk_fma_f32 v[134:135], v[134:135], v[70:71], v[80:81]
v_pk_fma_f32 v[136:137], v[136:137], v[72:73], v[82:83]
v_cvt_pk_bf16_f32 v100, v128, v129
v_cvt_pk_bf16_f32 v101, v130, v131
v_cvt_pk_bf16_f32 v102, v132, v133
v_cvt_pk_bf16_f32 v103, v134, v135
v_cvt_pk_bf16_f32 v104, v136, v137
v_lshlrev_b32 v64, 16, v25
v_and_b32 v65, 0xffff0000, v25
v_lshlrev_b32 v66, 16, v26
v_and_b32 v67, 0xffff0000, v26
v_lshlrev_b32 v68, 16, v27
v_and_b32 v69, 0xffff0000, v27
v_lshlrev_b32 v70, 16, v28
v_and_b32 v71, 0xffff0000, v28
v_lshlrev_b32 v72, 16, v29
v_and_b32 v73, 0xffff0000, v29
v_pk_add_f32 v[138:139], v[138:139], v[64:65]
v_pk_add_f32 v[140:141], v[140:141], v[66:67]
v_pk_add_f32 v[142:143], v[142:143], v[68:69]
v_pk_add_f32 v[144:145], v[144:145], v[70:71]
v_pk_add_f32 v[146:147], v[146:147], v[72:73]
v_pk_mul_f32 v[64:65], v[138:139], v[48:49] op_sel_hi:[1,0]
v_pk_mul_f32 v[66:67], v[140:141], v[48:49] op_sel_hi:[1,0]
v_pk_mul_f32 v[68:69], v[142:143], v[48:49] op_sel_hi:[1,0]
v_pk_mul_f32 v[70:71], v[144:145], v[48:49] op_sel_hi:[1,0]
v_pk_mul_f32 v[72:73], v[146:147], v[48:49] op_sel_hi:[1,0]
v_exp_f32 v64, v64
v_exp_f32 v65, v65
v_exp_f32 v66, v66
v_exp_f32 v67, v67
v_exp_f32 v68, v68
v_exp_f32 v69, v69
v_exp_f32 v70, v70
v_exp_f32 v71, v71
v_exp_f32 v72, v72
v_exp_f32 v73, v73
v_lshlrev_b32 v74, 16, v13
v_and_b32 v75, 0xffff0000, v13
v_lshlrev_b32 v76, 16, v14
v_and_b32 v77, 0xffff0000, v14
v_lshlrev_b32 v78, 16, v15
v_and_b32 v79, 0xffff0000, v15
v_lshlrev_b32 v80, 16, v16
v_and_b32 v81, 0xffff0000, v16
v_lshlrev_b32 v82, 16, v17
v_and_b32 v83, 0xffff0000, v17
v_pk_add_f32 v[64:65], v[64:65], v[48:49] op_sel:[0,1] op_sel_hi:[1,1]
v_pk_add_f32 v[66:67], v[66:67], v[48:49] op_sel:[0,1] op_sel_hi:[1,1]
v_pk_add_f32 v[68:69], v[68:69], v[48:49] op_sel:[0,1] op_sel_hi:[1,1]
v_pk_add_f32 v[70:71], v[70:71], v[48:49] op_sel:[0,1] op_sel_hi:[1,1]
v_pk_add_f32 v[72:73], v[72:73], v[48:49] op_sel:[0,1] op_sel_hi:[1,1]
v_rcp_f32 v64, v64
v_rcp_f32 v65, v65
v_rcp_f32 v66, v66
v_rcp_f32 v67, v67
v_rcp_f32 v68, v68
v_rcp_f32 v69, v69
v_rcp_f32 v70, v70
v_rcp_f32 v71, v71
v_rcp_f32 v72, v72
v_rcp_f32 v73, v73
v_lshlrev_b32 v84, 16, v41
v_and_b32 v85, 0xffff0000, v41
v_lshlrev_b32 v86, 16, v42
v_and_b32 v87, 0xffff0000, v42
v_lshlrev_b32 v88, 16, v43
v_and_b32 v89, 0xffff0000, v43
v_lshlrev_b32 v90, 16, v44
v_and_b32 v91, 0xffff0000, v44
v_lshlrev_b32 v92, 16, v45
v_and_b32 v93, 0xffff0000, v45
v_pk_mul_f32 v[64:65], v[64:65], v[138:139]
v_pk_mul_f32 v[66:67], v[66:67], v[140:141]
v_pk_mul_f32 v[68:69], v[68:69], v[142:143]
v_pk_mul_f32 v[70:71], v[70:71], v[144:145]
v_pk_mul_f32 v[72:73], v[72:73], v[146:147]
v_pk_fma_f32 v[138:139], v[74:75], v[46:47], v[46:47] op_sel:[0,1,0] op_sel_hi:[1,1,0]
v_pk_fma_f32 v[140:141], v[76:77], v[46:47], v[46:47] op_sel:[0,1,0] op_sel_hi:[1,1,0]
v_pk_fma_f32 v[142:143], v[78:79], v[46:47], v[46:47] op_sel:[0,1,0] op_sel_hi:[1,1,0]
v_pk_fma_f32 v[144:145], v[80:81], v[46:47], v[46:47] op_sel:[0,1,0] op_sel_hi:[1,1,0]
v_pk_fma_f32 v[146:147], v[82:83], v[46:47], v[46:47] op_sel:[0,1,0] op_sel_hi:[1,1,0]
v_pk_mul_f32 v[138:139], v[138:139], v[84:85]
v_pk_mul_f32 v[140:141], v[140:141], v[86:87]
v_pk_mul_f32 v[142:143], v[142:143], v[88:89]
v_pk_mul_f32 v[144:145], v[144:145], v[90:91]
v_pk_mul_f32 v[146:147], v[146:147], v[92:93]
v_pk_fma_f32 v[138:139], v[138:139], v[64:65], v[74:75]
v_pk_fma_f32 v[140:141], v[140:141], v[66:67], v[76:77]
v_pk_fma_f32 v[142:143], v[142:143], v[68:69], v[78:79]
v_pk_fma_f32 v[144:145], v[144:145], v[70:71], v[80:81]
v_pk_fma_f32 v[146:147], v[146:147], v[72:73], v[82:83]
v_cvt_pk_bf16_f32 v105, v138, v139
v_cvt_pk_bf16_f32 v106, v140, v141
v_cvt_pk_bf16_f32 v107, v142, v143
v_cvt_pk_bf16_f32 v108, v144, v145
v_cvt_pk_bf16_f32 v109, v146, v147
buffer_store_dwordx4 v[100:103], v60, s[28:31], 0 offen
buffer_store_dwordx4 v[104:107], v60, s[28:31], 0 offen offset:16
buffer_store_dwordx2 v[108:109], v60, s[28:31], 0 offen offset:32
L_end:
s_endpgm
L_two_32:
s_waitcnt lgkmcnt(0)
ds_read_b128 v[128:131], v10 offset:240
ds_read_b128 v[132:135], v10 offset:176
ds_read_b128 v[136:139], v10 offset:112
ds_read_b128 v[140:143], v10 offset:48
s_and_b32 s6, s88, 0xfffffffe
s_sub_u32 s6, s91, s6
s_cmp_ge_u32 s6, 2
s_cselect_b32 s92, s1, s0
s_and_b32 s6, s6, 1
s_lshl_b32 s6, s6, 4
s_lshr_b32 s92, s92, s6
s_lshl_b32 s92, s92, 16
s_lshl_b32 s6, s91, 12
s_add_u32 s6, s6, 4194304
s_nop 4
s_waitcnt lgkmcnt(0)
v_lshlrev_b32 v131, 16, v131
v_fma_f32 v176, v131, s92, v176
v_lshlrev_b32 v130, 16, v130
v_fma_f32 v177, v130, s92, v177
v_lshlrev_b32 v129, 16, v129
v_fma_f32 v178, v129, s92, v178
v_lshlrev_b32 v128, 16, v128
v_fma_f32 v179, v128, s92, v179
v_lshlrev_b32 v135, 16, v135
v_fma_f32 v180, v135, s92, v180
v_lshlrev_b32 v134, 16, v134
v_fma_f32 v181, v134, s92, v181
v_lshlrev_b32 v133, 16, v133
v_fma_f32 v182, v133, s92, v182
v_lshlrev_b32 v132, 16, v132
v_fma_f32 v183, v132, s92, v183
v_lshlrev_b32 v139, 16, v139
v_fma_f32 v184, v139, s92, v184
v_lshlrev_b32 v138, 16, v138
v_fma_f32 v185, v138, s92, v185
v_lshlrev_b32 v137, 16, v137
v_fma_f32 v186, v137, s92, v186
v_lshlrev_b32 v136, 16, v136
v_fma_f32 v187, v136, s92, v187
v_lshlrev_b32 v143, 16, v143
v_fma_f32 v188, v143, s92, v188
v_lshlrev_b32 v142, 16, v142
v_fma_f32 v189, v142, s92, v189
v_lshlrev_b32 v141, 16, v141
v_fma_f32 v190, v141, s92, v190
v_lshlrev_b32 v140, 16, v140
v_fma_f32 v191, v140, s92, v191
v_cvt_pk_bf16_f32 v160, v176, v177
v_cvt_pk_bf16_f32 v161, v178, v179
v_cvt_pk_bf16_f32 v162, v180, v181
v_cvt_pk_bf16_f32 v163, v182, v183
buffer_store_dwordx4 v[160:163], v11, s[24:27], s6 offen offset:0 sc1
v_cvt_pk_bf16_f32 v164, v184, v185
v_cvt_pk_bf16_f32 v165, v186, v187
v_cvt_pk_bf16_f32 v166, v188, v189
v_cvt_pk_bf16_f32 v167, v190, v191
buffer_store_dwordx4 v[164:167], v11, s[24:27], s6 offen offset:128 sc1
s_cmp_eq_u32 s87, 3
s_cselect_b32 s85, s85, s87
s_cselect_b64 vcc, -1, 0
v_mov_b32 v2, 2147418112
v_cndmask_b32 v11, v11, v2, vcc
s_mul_i32 s6, s85, 30208
s_add_u32 s6, s6, 63488
v_add_u32 v8, s6, v16
s_add_u32 s6, s6, 17536
v_add_u32 v9, s6, v17
v_lshlrev_b32 v10, 5, v18
v_sub_u32 v10, v9, v10
v_add_u32 v10, 2176, v10
s_add_u32 s91, s88, s85
ds_read_b128 v[128:131], v8 offset:2048
ds_read_b128 v[132:135], v8 offset:2112
ds_read_b128 v[136:139], v8 offset:2176
ds_read_b128 v[140:143], v8 offset:2240
ds_read_b128 v[144:147], v8 offset:2304
ds_read_b128 v[148:151], v8 offset:2368
ds_read_b128 v[152:155], v8 offset:2432
ds_read_b128 v[156:159], v8 offset:2496
ds_read_b128 v[160:163], v9 offset:2176
ds_read_b128 v[164:167], v9 offset:2240
ds_read_b128 v[168:171], v9 offset:2304
v_mov_b32 v176, 0
v_mov_b32 v177, 0
v_mov_b32 v178, 0
v_mov_b32 v179, 0
v_mov_b32 v180, 0
v_mov_b32 v181, 0
v_mov_b32 v182, 0
v_mov_b32 v183, 0
v_mov_b32 v184, 0
v_mov_b32 v185, 0
v_mov_b32 v186, 0
v_mov_b32 v187, 0
v_mov_b32 v188, 0
v_mov_b32 v189, 0
v_mov_b32 v190, 0
v_mov_b32 v191, 0
s_waitcnt lgkmcnt(0)
s_branch L_halfb_33
L_spare:
s_lshl_b32 s73, s3, 2
s_add_u32 s73, s73, s4
s_sub_u32 s73, s73, 28
s_lshr_b32 s6, s3, 1
s_lshl_b32 s6, s6, 2
s_and_b32 s7, s4, 3
s_add_u32 s77, s6, s7
s_and_b32 s6, s3, 1
s_mul_i32 s6, s6, 7
s_lshr_b32 s7, s4, 2
s_add_u32 s78, s6, s7
s_and_b32 s82, s5, 1
s_lshr_b32 s83, s5, 1
s_lshl_b32 s6, s3, 4
s_lshr_b32 s7, s4, 1
s_add_u32 s6, s6, s7
s_mul_i32 s6, s6, 5
s_and_b32 s89, s4, 1
s_lshl_b32 s7, s89, 1
s_add_u32 s88, s6, s7
s_lshr_b32 s6, s3, 1
s_lshl_b32 s6, s6, 3
s_and_b32 s7, s4, 7
s_add_u32 s94, s6, s7
s_and_b32 s6, s3, 1
s_lshl_b32 s6, s6, 2
s_lshr_b32 s7, s4, 3
s_add_u32 s95, s6, s7
s_mul_i32 s96, s5, 14
s_cmp_eq_u32 s5, 3
s_cselect_b32 s6, 1, 0
s_sub_u32 s96, s96, s6
s_lshr_b32 s6, s4, 3
s_lshl_b32 s7, s3, 2
s_add_u32 s68, s6, s7
s_and_b32 s69, s4, 7
v_mul_u32_u24 v2, 26, v1
v_lshrrev_b32 v2, 8, v2
v_mul_u32_u24 v3, 10, v2
v_sub_u32 v3, v1, v3
s_lshl_b32 s6, s68, 6
s_lshl_b32 s7, s5, 4
s_add_u32 s6, s6, s7
s_mul_i32 s6, s6, 1280
s_mul_i32 s7, s69, 160
s_add_u32 s6, s6, s7
v_mul_u32_u24 v4, 5120, v2
v_lshl_add_u32 v4, v3, 4, v4
v_add_u32 v244, s6, v4
v_subrev_u32 v245, 3840, v244
s_mul_i32 s7, s69, 640
v_lshlrev_b32 v4, 6, v3
v_add_u32 v247, s7, v4
s_lshl_b32 s7, s5, 5
s_sub_u32 s7, 131192, s7
v_mul_u32_u24 v4, 1152, v3
v_lshlrev_b32 v2, 3, v2
v_sub_u32 v4, v4, v2
v_add_u32 v202, s7, v4
v_lshrrev_b32 v2, 3, v1
s_mul_i32 s6, s5, 20
v_add_u32 v2, s6, v2
v_and_b32 v3, 7, v1
v_lshlrev_b32 v3, 4, v3
v_mul_u32_u24 v4, 144, v2
v_add_u32 v4, v4, v3
v_add_u32 v203, 131072, v4
v_lshl_add_u32 v172, v2, 12, v3
s_mul_i32 s6, s69, 327680
s_lshl_b32 s7, s68, 7
s_sub_u32 s6, s6, s7
s_add_u32 s70, s6, 1052544
s_add_u32 s71, s70, 32768
s_add_u32 s72, s70, 65536
s_lshl_b32 s6, s73, 6
s_lshl_b32 s7, s5, 4
s_add_u32 s6, s6, s7
s_mul_i32 s75, s6, 1280
s_lshl_b32 s6, s73, 2
s_add_u32 s6, s6, s5
s_mul_i32 s76, s6, 20480
v_lshlrev_b32 v233, 7, v1
s_lshl_b32 s6, s73, 6
s_lshl_b32 s7, s5, 4
s_add_u32 s74, s6, s7
v_and_b32 v2, 15, v1
v_lshrrev_b32 v3, 4, v1
v_add_u32 v4, s74, v2
v_mul_u32_u24 v4, 1280, v4
v_lshl_add_u32 v211, v3, 4, v4
s_waitcnt lgkmcnt(0)
s_mov_b32 s24, s66
s_and_b32 s25, s67, 0xffff
s_mov_b32 s26, 17825792
s_mov_b32 s27, 0x20000
s_lshl_b32 s6, s88, 1
s_and_b32 s6, s6, 0xfffffffc
s_load_dwordx2 s[0:1], s[50:51], s6
s_cmp_lg_u32 s5, 0
s_cbranch_scc1 L_clr_41
v_lshl_add_u32 v2, v1, 2, v252
v_mov_b32 v3, 0
s_mov_b64 exec, 0xff
buffer_store_dword v3, v2, s[24:27], 0 offen sc1
s_mov_b64 exec, -1
L_clr_41:
s_mov_b32 s12, s42
s_and_b32 s13, s43, 0xffff
s_mov_b32 s14, 2621440
s_mov_b32 s15, 0x20000
s_mov_b32 s16, s44
s_and_b32 s17, s45, 0xffff
s_mov_b32 s18, 2621440
s_mov_b32 s19, 0x20000
s_mov_b32 s32, s46
s_and_b32 s33, s47, 0xffff
s_mov_b32 s34, 5120
s_mov_b32 s35, 0x20000
s_mov_b32 s8, s40
s_and_b32 s9, s41, 0xffff
s_mov_b32 s10, 2621440
s_mov_b32 s11, 0x20000
s_mov_b32 s28, s62
s_and_b32 s29, s63, 0xffff
s_mov_b32 s30, 2621440
s_mov_b32 s31, 0x20000
s_mov_b32 s52, s64
s_and_b32 s53, s65, 0xffff
s_mov_b32 s54, 256
s_mov_b32 s55, 0x20000
s_mov_b32 s42, 0
buffer_load_dwordx4 a[0:3], v211, s[8:11], 0 offen offset:0
buffer_load_dwordx4 a[4:7], v211, s[8:11], 0 offen offset:64
buffer_load_dwordx4 a[8:11], v211, s[8:11], 0 offen offset:128
buffer_load_dwordx4 a[12:15], v211, s[8:11], 0 offen offset:192
s_waitcnt vmcnt(4)
s_cmp_lg_u32 s5, 0
s_cbranch_scc1 L_arr_42
s_and_b32 s6, s2, 7
s_lshl_b32 s6, s6, 5
v_mov_b32 v2, s6
s_mov_b64 exec, 1
buffer_atomic_add v253, v2, s[52:55], 0 offen sc1
s_mov_b64 exec, -1
L_arr_42:
buffer_load_dwordx4 a[16:19], v211, s[8:11], 0 offen offset:256
buffer_load_dwordx4 a[20:23], v211, s[8:11], 0 offen offset:320
buffer_load_dwordx4 a[24:27], v211, s[8:11], 0 offen offset:384
buffer_load_dwordx4 a[28:31], v211, s[8:11], 0 offen offset:448
buffer_load_dwordx4 a[32:35], v211, s[8:11], 0 offen offset:512
buffer_load_dwordx4 a[36:39], v211, s[8:11], 0 offen offset:576
buffer_load_dwordx4 a[40:43], v211, s[8:11], 0 offen offset:640
buffer_load_dwordx4 a[44:47], v211, s[8:11], 0 offen offset:704
buffer_load_dwordx4 a[48:51], v211, s[8:11], 0 offen offset:768
buffer_load_dwordx4 a[52:55], v211, s[8:11], 0 offen offset:832
buffer_load_dwordx4 a[56:59], v211, s[8:11], 0 offen offset:896
buffer_load_dwordx4 a[60:63], v211, s[8:11], 0 offen offset:960
buffer_load_dwordx4 a[64:67], v211, s[8:11], 0 offen offset:1024
buffer_load_dwordx4 a[68:71], v211, s[8:11], 0 offen offset:1088
buffer_load_dwordx4 a[72:75], v211, s[8:11], 0 offen offset:1152
buffer_load_dwordx4 a[76:79], v211, s[8:11], 0 offen offset:1216
v_and_b32 v2, 15, v1
v_min_u32 v2, 13, v2
v_add_u32 v2, s96, v2
v_min_u32 v2, 53, v2
v_lshlrev_b32 v2, 2, v2
s_lshr_b32 s43, s95, 1
v_add_u32 v2, s43, v2
v_lshlrev_b32 v2, 7, v2
v_add_u32 v228, 12, v2
s_lshl_b32 s6, s77, 1
v_and_b32 v4, 1, v1
v_add_u32 v4, s6, v4
v_and_b32 v5, 3, v4
v_add_u32 v5, 28, v5
v_lshrrev_b32 v4, 2, v4
v_lshl_add_u32 v4, v5, 3, v4
v_lshlrev_b32 v4, 7, v4
v_add_u32 v231, 4, v4
v_and_b32 v2, 31, v1
v_and_b32 v3, 7, v2
v_lshrrev_b32 v2, 3, v2
v_lshlrev_b32 v2, 3, v2
v_add_u32 v2, s3, v2
v_lshl_add_u32 v2, v2, 3, v3
v_lshlrev_b32 v229, 7, v2
v_cmp_gt_u32 vcc, 14, v1
v_cndmask_b32 v2, 0, v1, vcc
v_cmp_lt_u32 vcc, 6, v2
v_cndmask_b32 v3, 0, 1, vcc
v_mul_u32_u24 v4, 7, v3
v_sub_u32 v2, v2, v4
s_lshr_b32 s6, s94, 1
s_and_b32 s7, s6, 3
s_lshr_b32 s6, s6, 2
s_lshl_b32 s6, s6, 1
v_lshlrev_b32 v2, 2, v2
v_add_u32 v2, s7, v2
v_add_u32 v3, s6, v3
v_lshl_add_u32 v2, v2, 3, v3
v_lshlrev_b32 v2, 7, v2
v_add_u32 v249, 16, v2
v_and_b32 v2, 31, v1
v_lshlrev_b32 v2, 3, v2
v_add_u32 v2, s95, v2
v_lshlrev_b32 v2, 7, v2
v_add_u32 v250, 20, v2
v_mov_b32 v2, 2147418112
s_cmp_lg_u32 s5, 0
s_cselect_b64 vcc, -1, 0
v_cndmask_b32 v231, v231, v2, vcc
v_cndmask_b32 v230, v230, v2, vcc
v_mov_b32 v214, 0x3f803f80
v_mov_b32 v215, 0x3f803f80
v_mov_b32 v216, 0x3f803f80
v_mov_b32 v217, 0x3f803f80
v_mov_b32 v218, 0
v_mov_b32 v219, 0
v_mov_b32 v220, 0
v_mov_b32 v221, 0
v_mov_b32 v222, 0
v_mov_b32 v223, 0
v_mov_b32 v224, 0
v_mov_b32 v225, 0
s_waitcnt vmcnt(19)
v_mfma_f32_16x16x32_bf16 v[218:221], a[0:3], a[0:3], v[218:221]
v_mfma_f32_16x16x32_bf16 v[222:225], a[0:3], v[214:217], v[222:225]
s_waitcnt vmcnt(18)
v_mfma_f32_16x16x32_bf16 v[218:221], a[4:7], a[4:7], v[218:221]
v_mfma_f32_16x16x32_bf16 v[222:225], a[4:7], v[214:217], v[222:225]
s_waitcnt vmcnt(17)
v_mfma_f32_16x16x32_bf16 v[218:221], a[8:11], a[8:11], v[218:221]
v_mfma_f32_16x16x32_bf16 v[222:225], a[8:11], v[214:217], v[222:225]
s_waitcnt vmcnt(16)
v_mfma_f32_16x16x32_bf16 v[218:221], a[12:15], a[12:15], v[218:221]
v_mfma_f32_16x16x32_bf16 v[222:225], a[12:15], v[214:217], v[222:225]
s_waitcnt vmcnt(15)
v_mfma_f32_16x16x32_bf16 v[218:221], a[16:19], a[16:19], v[218:221]
v_mfma_f32_16x16x32_bf16 v[222:225], a[16:19], v[214:217], v[222:225]
s_waitcnt vmcnt(14)
v_mfma_f32_16x16x32_bf16 v[218:221], a[20:23], a[20:23], v[218:221]
v_mfma_f32_16x16x32_bf16 v[222:225], a[20:23], v[214:217], v[222:225]
s_waitcnt vmcnt(13)
v_mfma_f32_16x16x32_bf16 v[218:221], a[24:27], a[24:27], v[218:221]
v_mfma_f32_16x16x32_bf16 v[222:225], a[24:27], v[214:217], v[222:225]
s_waitcnt vmcnt(12)
v_mfma_f32_16x16x32_bf16 v[218:221], a[28:31], a[28:31], v[218:221]
v_mfma_f32_16x16x32_bf16 v[222:225], a[28:31], v[214:217], v[222:225]
s_waitcnt vmcnt(11)
v_mfma_f32_16x16x32_bf16 v[218:221], a[32:35], a[32:35], v[218:221]
v_mfma_f32_16x16x32_bf16 v[222:225], a[32:35], v[214:217], v[222:225]
s_waitcnt vmcnt(10)
v_mfma_f32_16x16x32_bf16 v[218:221], a[36:39], a[36:39], v[218:221]
v_mfma_f32_16x16x32_bf16 v[222:225], a[36:39], v[214:217], v[222:225]
s_waitcnt vmcnt(9)
v_mfma_f32_16x16x32_bf16 v[218:221], a[40:43], a[40:43], v[218:221]
v_mfma_f32_16x16x32_bf16 v[222:225], a[40:43], v[214:217], v[222:225]
s_waitcnt vmcnt(8)
v_mfma_f32_16x16x32_bf16 v[218:221], a[44:47], a[44:47], v[218:221]
v_mfma_f32_16x16x32_bf16 v[222:225], a[44:47], v[214:217], v[222:225]
s_waitcnt vmcnt(7)
v_mfma_f32_16x16x32_bf16 v[218:221], a[48:51], a[48:51], v[218:221]
v_mfma_f32_16x16x32_bf16 v[222:225], a[48:51], v[214:217], v[222:225]
s_waitcnt vmcnt(6)
v_mfma_f32_16x16x32_bf16 v[218:221], a[52:55], a[52:55], v[218:221]
v_mfma_f32_16x16x32_bf16 v[222:225], a[52:55], v[214:217], v[222:225]
s_waitcnt vmcnt(5)
v_mfma_f32_16x16x32_bf16 v[218:221], a[56:59], a[56:59], v[218:221]
v_mfma_f32_16x16x32_bf16 v[222:225], a[56:59], v[214:217], v[222:225]
s_waitcnt vmcnt(4)
v_mfma_f32_16x16x32_bf16 v[218:221], a[60:63], a[60:63], v[218:221]
v_mfma_f32_16x16x32_bf16 v[222:225], a[60:63], v[214:217], v[222:225]
s_waitcnt vmcnt(3)
v_mfma_f32_16x16x32_bf16 v[218:221], a[64:67], a[64:67], v[218:221]
v_mfma_f32_16x16x32_bf16 v[222:225], a[64:67], v[214:217], v[222:225]
s_waitcnt vmcnt(2)
v_mfma_f32_16x16x32_bf16 v[218:221], a[68:71], a[68:71], v[218:221]
v_mfma_f32_16x16x32_bf16 v[222:225], a[68:71], v[214:217], v[222:225]
s_waitcnt vmcnt(1)
v_mfma_f32_16x16x32_bf16 v[218:221], a[72:75], a[72:75], v[218:221]
v_mfma_f32_16x16x32_bf16 v[222:225], a[72:75], v[214:217], v[222:225]
s_waitcnt vmcnt(0)
v_mfma_f32_16x16x32_bf16 v[218:221], a[76:79], a[76:79], v[218:221]
v_mfma_f32_16x16x32_bf16 v[222:225], a[76:79], v[214:217], v[222:225]
v_and_b32 v5, 1, v1
v_cmp_eq_u32 vcc, 1, v5
v_and_b32 v5, 2, v1
v_cmp_eq_u32 s[6:7], 2, v5
s_nop 7
v_cndmask_b32 v2, v218, v219, vcc
v_cndmask_b32 v3, v220, v221, vcc
v_cndmask_b32 v4, v222, v223, vcc
v_cndmask_b32 v5, v224, v225, vcc
v_cndmask_b32 v2, v2, v3, s[6:7]
v_cndmask_b32 v3, v4, v5, s[6:7]
v_mul_f32 v214, 0.0015625, v3
v_mul_f32 v2, 0.0015625, v2
v_fma_f32 v2, -v214, v214, v2
v_max_f32 v2, 0, v2
v_add_f32 v2, 0x3727c5ac, v2
v_sqrt_f32 v216, v2
s_nop 0
v_rcp_f32 v215, v216
v_mov_b32 v217, 0
v_sub_f32 v3, 0, v214
v_cvt_pk_bf16_f32 v4, v216, v3
v_lshlrev_b32 v5, 16, v4
v_and_b32 v6, 0xffff0000, v4
v_sub_f32 v5, v216, v5
v_sub_f32 v6, v3, v6
v_cvt_pk_bf16_f32 v5, v5, v6
s_mov_b32 s6, 0x05040100
s_mov_b32 s7, 0x07060302
v_perm_b32 v218, v5, v4, s6
v_perm_b32 v219, v5, v4, s7
v_mov_b32 v220, v219
v_mov_b32 v221, 0
v_lshrrev_b32 v3, 4, v1
v_and_b32 v5, 3, v1
v_lshl_add_u32 v5, v3, 2, v5
v_add_u32 v5, s74, v5
v_lshlrev_b32 v5, 4, v5
s_mov_b32 s6, 65536
s_mov_b32 s7, 98304
s_mov_b32 exec_lo, 0x00f0000f
s_mov_b32 exec_hi, 0xf0000f00
buffer_store_dwordx4 v[218:221], v5, s[24:27], s6 offen sc1
buffer_store_dwordx4 v[214:217], v5, s[24:27], s7 offen sc1
s_mov_b64 exec, -1
buffer_load_dword v254, v230, s[52:55], 0 offen sc1
s_mov_b32 exec_hi, 0xff
buffer_load_dwordx4 v[8:11], v245, s[12:15], 0 offen offset:0
buffer_load_dwordx4 v[12:15], v245, s[12:15], 0 offen offset:1280
buffer_load_dwordx4 v[16:19], v245, s[12:15], 0 offen offset:2560
buffer_load_dwordx4 v[20:23], v244, s[12:15], 0 offen offset:0
buffer_load_dwordx4 v[24:27], v244, s[12:15], 0 offen offset:1280
buffer_load_dwordx4 v[28:31], v244, s[12:15], 0 offen offset:2560
buffer_load_dwordx4 v[32:35], v244, s[12:15], 0 offen offset:3840
buffer_load_dwordx4 v[36:39], v247, s[32:35], 0 offen offset:0
buffer_load_dwordx4 v[40:43], v247, s[32:35], 0 offen offset:16
buffer_load_dwordx4 v[44:47], v247, s[32:35], 0 offen offset:32
buffer_load_dwordx4 v[48:51], v247, s[32:35], 0 offen offset:48
buffer_load_dwordx4 v[174:177], v244, s[16:19], 0 offen offset:0
buffer_load_dwordx4 v[178:181], v244, s[16:19], 0 offen offset:1280
buffer_load_dwordx4 v[182:185], v244, s[16:19], 0 offen offset:2560
buffer_load_dwordx4 v[186:189], v244, s[16:19], 0 offen offset:3840
s_mov_b64 exec, -1
s_mov_b32 s36, s58
s_and_b32 s37, s59, 0xffff
s_mov_b32 s38, 2211840
s_mov_b32 s39, 0x20000
s_sub_u32 s6, s4, 28
s_lshl_b32 s6, s6, 2
s_add_u32 s6, s6, s5
s_mul_i32 s79, s6, 162
s_lshr_b32 s6, s3, 2
s_lshl_b32 s80, s6, 5
s_and_b32 s7, s3, 3
s_mul_i32 s7, s7, 320
s_and_b32 s81, s7, 0xffffff80
v_add_u32 v2, s79, v1
v_add_u32 v2, 0, v2
v_mul_u32_u24 v3, 2731, v2
v_lshrrev_b32 v3, 18, v3
v_mul_u32_u24 v4, 96, v3
v_sub_u32 v4, v2, v4
v_mul_u32_u24 v5, 86, v4
v_lshrrev_b32 v5, 8, v5
v_mul_u32_u24 v6, 3, v5
v_sub_u32 v6, v4, v6
v_lshlrev_b32 v3, 6, v3
v_add_u32 v3, v3, v5
v_add_u32 v3, s80, v3
v_mul_u32_u24 v3, 1280, v3
v_lshl_add_u32 v3, v6, 7, v3
v_add_u32 v128, s81, v3
v_add_u32 v2, s79, v1
v_add_u32 v2, 64, v2
v_mul_u32_u24 v3, 2731, v2
v_lshrrev_b32 v3, 18, v3
v_mul_u32_u24 v4, 96, v3
v_sub_u32 v4, v2, v4
v_mul_u32_u24 v5, 86, v4
v_lshrrev_b32 v5, 8, v5
v_mul_u32_u24 v6, 3, v5
v_sub_u32 v6, v4, v6
v_lshlrev_b32 v3, 6, v3
v_add_u32 v3, v3, v5
v_add_u32 v3, s80, v3
v_mul_u32_u24 v3, 1280, v3
v_lshl_add_u32 v3, v6, 7, v3
v_add_u32 v129, s81, v3
v_add_u32 v2, s79, v1
v_add_u32 v2, 128, v2
v_mul_u32_u24 v3, 2731, v2
v_lshrrev_b32 v3, 18, v3
v_mul_u32_u24 v4, 96, v3
v_sub_u32 v4, v2, v4
v_mul_u32_u24 v5, 86, v4
v_lshrrev_b32 v5, 8, v5
v_mul_u32_u24 v6, 3, v5
v_sub_u32 v6, v4, v6
v_lshlrev_b32 v3, 6, v3
v_add_u32 v3, v3, v5
v_add_u32 v3, s80, v3
v_mul_u32_u24 v3, 1280, v3
v_lshl_add_u32 v3, v6, 7, v3
v_add_u32 v130, s81, v3
buffer_load_dword v234, v128, s[36:39], 0 offen
buffer_load_dword v234, v129, s[36:39], 0 offen
s_mov_b32 exec_lo, 0xffffffff
s_mov_b32 exec_hi, 0x3
buffer_load_dword v234, v130, s[36:39], 0 offen
s_mov_b64 exec, -1
s_waitcnt vmcnt(19)
s_barrier
s_cmp_lg_u32 s5, 0
s_cbranch_scc1 L_fl_43
s_mov_b64 exec, 1
buffer_store_dword v253, v252, s[24:27], 0 offen offset:4 sc1
s_mov_b64 exec, -1
L_fl_43:
s_waitcnt vmcnt(18)
s_cmp_lg_u32 s5, 0
s_cbranch_scc1 L_back_45
v_cmp_gt_u32 vcc, 32, v254
s_cbranch_vccnz L_slow_44
L_back_45:
s_waitcnt vmcnt(3)
v_lshlrev_b32 v194, 16, v8
v_and_b32 v195, 0xffff0000, v8
v_lshlrev_b32 v196, 16, v12
v_and_b32 v197, 0xffff0000, v12
v_lshlrev_b32 v198, 16, v16
v_and_b32 v199, 0xffff0000, v16
v_lshlrev_b32 v236, 16, v20
v_and_b32 v237, 0xffff0000, v20
v_lshlrev_b32 v238, 16, v24
v_and_b32 v239, 0xffff0000, v24
v_lshlrev_b32 v240, 16, v28
v_and_b32 v241, 0xffff0000, v28
v_lshlrev_b32 v242, 16, v32
v_and_b32 v243, 0xffff0000, v32
v_lshlrev_b32 v52, 16, v36
v_lshlrev_b32 v53, 16, v38
v_and_b32 v54, 0xffff0000, v36
v_and_b32 v55, 0xffff0000, v38
v_lshlrev_b32 v56, 16, v37
v_lshlrev_b32 v57, 16, v39
v_and_b32 v58, 0xffff0000, v37
v_and_b32 v59, 0xffff0000, v39
v_pk_mul_f32 v[60:61], v[236:237], v[52:53]
v_pk_mul_f32 v[62:63], v[238:239], v[52:53]
v_pk_mul_f32 v[190:191], v[240:241], v[52:53]
v_pk_mul_f32 v[192:193], v[242:243], v[52:53]
v_pk_fma_f32 v[60:61], v[198:199], v[54:55], v[60:61]
v_pk_fma_f32 v[62:63], v[236:237], v[54:55], v[62:63]
v_pk_fma_f32 v[190:191], v[238:239], v[54:55], v[190:191]
v_pk_fma_f32 v[192:193], v[240:241], v[54:55], v[192:193]
v_pk_fma_f32 v[60:61], v[196:197], v[56:57], v[60:61]
v_pk_fma_f32 v[62:63], v[198:199], v[56:57], v[62:63]
v_pk_fma_f32 v[190:191], v[236:237], v[56:57], v[190:191]
v_pk_fma_f32 v[192:193], v[238:239], v[56:57], v[192:193]
v_pk_fma_f32 v[60:61], v[194:195], v[58:59], v[60:61]
v_pk_fma_f32 v[62:63], v[196:197], v[58:59], v[62:63]
v_pk_fma_f32 v[190:191], v[198:199], v[58:59], v[190:191]
v_pk_fma_f32 v[192:193], v[236:237], v[58:59], v[192:193]
v_lshlrev_b32 v194, 16, v174
v_and_b32 v195, 0xffff0000, v174
v_lshlrev_b32 v196, 16, v178
v_and_b32 v197, 0xffff0000, v178
v_lshlrev_b32 v198, 16, v182
v_and_b32 v199, 0xffff0000, v182
v_lshlrev_b32 v236, 16, v186
v_and_b32 v237, 0xffff0000, v186
v_pk_mul_f32 v[60:61], v[60:61], v[194:195]
v_pk_mul_f32 v[62:63], v[62:63], v[196:197]
v_pk_mul_f32 v[190:191], v[190:191], v[198:199]
v_pk_mul_f32 v[192:193], v[192:193], v[236:237]
s_mov_b32 exec_hi, 0xff
v_cvt_pk_bf16_f32 v238, v192, v190
v_cvt_pk_bf16_f32 v239, v62, v60
ds_write_b64 v202, v[238:239] offset:0
v_cvt_pk_bf16_f32 v240, v193, v191
v_cvt_pk_bf16_f32 v241, v63, v61
ds_write_b64 v202, v[240:241] offset:144
s_mov_b64 exec, -1
v_lshlrev_b32 v194, 16, v9
v_and_b32 v195, 0xffff0000, v9
v_lshlrev_b32 v196, 16, v13
v_and_b32 v197, 0xffff0000, v13
v_lshlrev_b32 v198, 16, v17
v_and_b32 v199, 0xffff0000, v17
v_lshlrev_b32 v236, 16, v21
v_and_b32 v237, 0xffff0000, v21
v_lshlrev_b32 v238, 16, v25
v_and_b32 v239, 0xffff0000, v25
v_lshlrev_b32 v240, 16, v29
v_and_b32 v241, 0xffff0000, v29
v_lshlrev_b32 v242, 16, v33
v_and_b32 v243, 0xffff0000, v33
v_lshlrev_b32 v52, 16, v40
v_lshlrev_b32 v53, 16, v42
v_and_b32 v54, 0xffff0000, v40
v_and_b32 v55, 0xffff0000, v42
v_lshlrev_b32 v56, 16, v41
v_lshlrev_b32 v57, 16, v43
v_and_b32 v58, 0xffff0000, v41
v_and_b32 v59, 0xffff0000, v43
v_pk_mul_f32 v[60:61], v[236:237], v[52:53]
v_pk_mul_f32 v[62:63], v[238:239], v[52:53]
v_pk_mul_f32 v[190:191], v[240:241], v[52:53]
v_pk_mul_f32 v[192:193], v[242:243], v[52:53]
v_pk_fma_f32 v[60:61], v[198:199], v[54:55], v[60:61]
v_pk_fma_f32 v[62:63], v[236:237], v[54:55], v[62:63]
v_pk_fma_f32 v[190:191], v[238:239], v[54:55], v[190:191]
v_pk_fma_f32 v[192:193], v[240:241], v[54:55], v[192:193]
v_pk_fma_f32 v[60:61], v[196:197], v[56:57], v[60:61]
v_pk_fma_f32 v[62:63], v[198:199], v[56:57], v[62:63]
v_pk_fma_f32 v[190:191], v[236:237], v[56:57], v[190:191]
v_pk_fma_f32 v[192:193], v[238:239], v[56:57], v[192:193]
v_pk_fma_f32 v[60:61], v[194:195], v[58:59], v[60:61]
v_pk_fma_f32 v[62:63], v[196:197], v[58:59], v[62:63]
v_pk_fma_f32 v[190:191], v[198:199], v[58:59], v[190:191]
v_pk_fma_f32 v[192:193], v[236:237], v[58:59], v[192:193]
v_lshlrev_b32 v194, 16, v175
v_and_b32 v195, 0xffff0000, v175
v_lshlrev_b32 v196, 16, v179
v_and_b32 v197, 0xffff0000, v179
v_lshlrev_b32 v198, 16, v183
v_and_b32 v199, 0xffff0000, v183
v_lshlrev_b32 v236, 16, v187
v_and_b32 v237, 0xffff0000, v187
v_pk_mul_f32 v[60:61], v[60:61], v[194:195]
v_pk_mul_f32 v[62:63], v[62:63], v[196:197]
v_pk_mul_f32 v[190:191], v[190:191], v[198:199]
v_pk_mul_f32 v[192:193], v[192:193], v[236:237]
s_mov_b32 exec_hi, 0xff
v_cvt_pk_bf16_f32 v238, v192, v190
v_cvt_pk_bf16_f32 v239, v62, v60
ds_write_b64 v202, v[238:239] offset:288
v_cvt_pk_bf16_f32 v240, v193, v191
v_cvt_pk_bf16_f32 v241, v63, v61
ds_write_b64 v202, v[240:241] offset:432
s_mov_b64 exec, -1
v_lshlrev_b32 v194, 16, v10
v_and_b32 v195, 0xffff0000, v10
v_lshlrev_b32 v196, 16, v14
v_and_b32 v197, 0xffff0000, v14
v_lshlrev_b32 v198, 16, v18
v_and_b32 v199, 0xffff0000, v18
v_lshlrev_b32 v236, 16, v22
v_and_b32 v237, 0xffff0000, v22
v_lshlrev_b32 v238, 16, v26
v_and_b32 v239, 0xffff0000, v26
v_lshlrev_b32 v240, 16, v30
v_and_b32 v241, 0xffff0000, v30
v_lshlrev_b32 v242, 16, v34
v_and_b32 v243, 0xffff0000, v34
v_lshlrev_b32 v52, 16, v44
v_lshlrev_b32 v53, 16, v46
v_and_b32 v54, 0xffff0000, v44
v_and_b32 v55, 0xffff0000, v46
v_lshlrev_b32 v56, 16, v45
v_lshlrev_b32 v57, 16, v47
v_and_b32 v58, 0xffff0000, v45
v_and_b32 v59, 0xffff0000, v47
v_pk_mul_f32 v[60:61], v[236:237], v[52:53]
v_pk_mul_f32 v[62:63], v[238:239], v[52:53]
v_pk_mul_f32 v[190:191], v[240:241], v[52:53]
v_pk_mul_f32 v[192:193], v[242:243], v[52:53]
v_pk_fma_f32 v[60:61], v[198:199], v[54:55], v[60:61]
v_pk_fma_f32 v[62:63], v[236:237], v[54:55], v[62:63]
v_pk_fma_f32 v[190:191], v[238:239], v[54:55], v[190:191]
v_pk_fma_f32 v[192:193], v[240:241], v[54:55], v[192:193]
v_pk_fma_f32 v[60:61], v[196:197], v[56:57], v[60:61]
v_pk_fma_f32 v[62:63], v[198:199], v[56:57], v[62:63]
v_pk_fma_f32 v[190:191], v[236:237], v[56:57], v[190:191]
v_pk_fma_f32 v[192:193], v[238:239], v[56:57], v[192:193]
v_pk_fma_f32 v[60:61], v[194:195], v[58:59], v[60:61]
v_pk_fma_f32 v[62:63], v[196:197], v[58:59], v[62:63]
v_pk_fma_f32 v[190:191], v[198:199], v[58:59], v[190:191]
v_pk_fma_f32 v[192:193], v[236:237], v[58:59], v[192:193]
v_lshlrev_b32 v194, 16, v176
v_and_b32 v195, 0xffff0000, v176
v_lshlrev_b32 v196, 16, v180
v_and_b32 v197, 0xffff0000, v180
v_lshlrev_b32 v198, 16, v184
v_and_b32 v199, 0xffff0000, v184
v_lshlrev_b32 v236, 16, v188
v_and_b32 v237, 0xffff0000, v188
v_pk_mul_f32 v[60:61], v[60:61], v[194:195]
v_pk_mul_f32 v[62:63], v[62:63], v[196:197]
v_pk_mul_f32 v[190:191], v[190:191], v[198:199]
v_pk_mul_f32 v[192:193], v[192:193], v[236:237]
s_mov_b32 exec_hi, 0xff
v_cvt_pk_bf16_f32 v238, v192, v190
v_cvt_pk_bf16_f32 v239, v62, v60
ds_write_b64 v202, v[238:239] offset:576
v_cvt_pk_bf16_f32 v240, v193, v191
v_cvt_pk_bf16_f32 v241, v63, v61
ds_write_b64 v202, v[240:241] offset:720
s_mov_b64 exec, -1
v_lshlrev_b32 v194, 16, v11
v_and_b32 v195, 0xffff0000, v11
v_lshlrev_b32 v196, 16, v15
v_and_b32 v197, 0xffff0000, v15
v_lshlrev_b32 v198, 16, v19
v_and_b32 v199, 0xffff0000, v19
v_lshlrev_b32 v236, 16, v23
v_and_b32 v237, 0xffff0000, v23
v_lshlrev_b32 v238, 16, v27
v_and_b32 v239, 0xffff0000, v27
v_lshlrev_b32 v240, 16, v31
v_and_b32 v241, 0xffff0000, v31
v_lshlrev_b32 v242, 16, v35
v_and_b32 v243, 0xffff0000, v35
v_lshlrev_b32 v52, 16, v48
v_lshlrev_b32 v53, 16, v50
v_and_b32 v54, 0xffff0000, v48
v_and_b32 v55, 0xffff0000, v50
v_lshlrev_b32 v56, 16, v49
v_lshlrev_b32 v57, 16, v51
v_and_b32 v58, 0xffff0000, v49
v_and_b32 v59, 0xffff0000, v51
v_pk_mul_f32 v[60:61], v[236:237], v[52:53]
v_pk_mul_f32 v[62:63], v[238:239], v[52:53]
v_pk_mul_f32 v[190:191], v[240:241], v[52:53]
v_pk_mul_f32 v[192:193], v[242:243], v[52:53]
v_pk_fma_f32 v[60:61], v[198:199], v[54:55], v[60:61]
v_pk_fma_f32 v[62:63], v[236:237], v[54:55], v[62:63]
v_pk_fma_f32 v[190:191], v[238:239], v[54:55], v[190:191]
v_pk_fma_f32 v[192:193], v[240:241], v[54:55], v[192:193]
v_pk_fma_f32 v[60:61], v[196:197], v[56:57], v[60:61]
v_pk_fma_f32 v[62:63], v[198:199], v[56:57], v[62:63]
v_pk_fma_f32 v[190:191], v[236:237], v[56:57], v[190:191]
v_pk_fma_f32 v[192:193], v[238:239], v[56:57], v[192:193]
v_pk_fma_f32 v[60:61], v[194:195], v[58:59], v[60:61]
v_pk_fma_f32 v[62:63], v[196:197], v[58:59], v[62:63]
v_pk_fma_f32 v[190:191], v[198:199], v[58:59], v[190:191]
v_pk_fma_f32 v[192:193], v[236:237], v[58:59], v[192:193]
v_lshlrev_b32 v194, 16, v177
v_and_b32 v195, 0xffff0000, v177
v_lshlrev_b32 v196, 16, v181
v_and_b32 v197, 0xffff0000, v181
v_lshlrev_b32 v198, 16, v185
v_and_b32 v199, 0xffff0000, v185
v_lshlrev_b32 v236, 16, v189
v_and_b32 v237, 0xffff0000, v189
v_pk_mul_f32 v[60:61], v[60:61], v[194:195]
v_pk_mul_f32 v[62:63], v[62:63], v[196:197]
v_pk_mul_f32 v[190:191], v[190:191], v[198:199]
v_pk_mul_f32 v[192:193], v[192:193], v[236:237]
s_mov_b32 exec_hi, 0xff
v_cvt_pk_bf16_f32 v238, v192, v190
v_cvt_pk_bf16_f32 v239, v62, v60
ds_write_b64 v202, v[238:239] offset:864
v_cvt_pk_bf16_f32 v240, v193, v191
v_cvt_pk_bf16_f32 v241, v63, v61
ds_write_b64 v202, v[240:241] offset:1008
s_mov_b64 exec, -1
s_waitcnt lgkmcnt(0)
s_barrier
ds_read_b128 v[8:11], v203 offset:0
ds_read_b128 v[12:15], v203 offset:1152
ds_read_b128 v[16:19], v203 offset:2304
s_waitcnt lgkmcnt(0)
buffer_store_dwordx4 v[8:11], v172, s[24:27], s70 offen sc1
buffer_store_dwordx4 v[12:15], v172, s[24:27], s71 offen sc1
s_mov_b32 exec_hi, 0
buffer_store_dwordx4 v[16:19], v172, s[24:27], s72 offen sc1
s_mov_b64 exec, -1
buffer_load_dword v254, v229, s[24:27], 0 offen sc1
s_waitcnt vmcnt(1)
s_barrier
s_cmp_lg_u32 s5, 0
s_cbranch_scc1 L_fl_46
s_mov_b64 exec, 1
buffer_store_dword v253, v252, s[24:27], 0 offen offset:0 sc1
s_mov_b64 exec, -1
L_fl_46:
s_waitcnt vmcnt(0)
v_cmp_eq_u32 vcc, 0, v254
s_cbranch_vccnz L_slow_47
L_back_48:
v_mov_b32 v60, 2147418112
s_mov_b32 s100, 0
s_mov_b32 s101, 0
s_lshl_b32 s6, s5, 2
v_lshlrev_b32 v202, 2, v1
v_add_u32 v202, s6, v202
v_subrev_u32 v202, 252, v202
v_add_u32 v203, s6, v248
v_add_u32 v203, 4, v203
s_mul_i32 s90, s5, 4416
s_add_u32 s6, s88, 0
s_lshl_b32 s6, s6, 12
s_add_u32 s32, s48, s6
s_addc_u32 s33, s49, 0
s_and_b32 s33, s33, 0xffff
s_mov_b32 s34, 4096
s_mov_b32 s35, 0x20000
s_add_u32 m0, s90, 65536
s_nop 0
buffer_load_dword v202, s[32:35], 0 offen lds
s_add_u32 m0, s90, 65792
s_nop 0
buffer_load_dwordx4 v203, s[32:35], 0 offen offset:0 lds
buffer_load_dwordx4 v203, s[32:35], 0 offen offset:1024 lds
buffer_load_dwordx4 v203, s[32:35], 0 offen offset:2048 lds
buffer_load_dwordx4 v203, s[32:35], 0 offen offset:3072 lds
s_add_u32 s6, s88, 1
s_lshl_b32 s6, s6, 12
s_add_u32 s32, s48, s6
s_addc_u32 s33, s49, 0
s_and_b32 s33, s33, 0xffff
s_mov_b32 s34, 4096
s_mov_b32 s35, 0x20000
s_add_u32 m0, s90, 95744
s_nop 0
buffer_load_dword v202, s[32:35], 0 offen lds
s_add_u32 m0, s90, 96000
s_nop 0
buffer_load_dwordx4 v203, s[32:35], 0 offen offset:0 lds
buffer_load_dwordx4 v203, s[32:35], 0 offen offset:1024 lds
buffer_load_dwordx4 v203, s[32:35], 0 offen offset:2048 lds
buffer_load_dwordx4 v203, s[32:35], 0 offen offset:3072 lds
s_add_u32 s6, s88, 2
s_lshl_b32 s6, s6, 12
s_add_u32 s32, s48, s6
s_addc_u32 s33, s49, 0
s_and_b32 s33, s33, 0xffff
s_mov_b32 s34, 4096
s_mov_b32 s35, 0x20000
s_add_u32 m0, s90, 125952
s_nop 0
buffer_load_dword v202, s[32:35], 0 offen lds
s_add_u32 m0, s90, 126208
s_nop 0
buffer_load_dwordx4 v203, s[32:35], 0 offen offset:0 lds
buffer_load_dwordx4 v203, s[32:35], 0 offen offset:1024 lds
buffer_load_dwordx4 v203, s[32:35], 0 offen offset:2048 lds
buffer_load_dwordx4 v203, s[32:35], 0 offen offset:3072 lds
v_lshlrev_b32 v4, 4, v0
s_add_u32 s6, s88, 0
s_lshl_b32 s6, s6, 12
s_add_u32 s6, s6, 1048576
s_add_u32 s36, s66, s6
s_addc_u32 s37, s67, 0
s_and_b32 s37, s37, 0xffff
s_mov_b32 s38, 4096
s_mov_b32 s39, 0x20000
buffer_load_dwordx4 v[32:35], v4, s[36:39], 0 offen
buffer_load_dword v36, v4, s[36:39], 0 offen offset:16
s_add_u32 s6, s88, 1
s_lshl_b32 s6, s6, 12
s_add_u32 s6, s6, 1048576
s_add_u32 s36, s66, s6
s_addc_u32 s37, s67, 0
s_and_b32 s37, s37, 0xffff
s_mov_b32 s38, 4096
s_mov_b32 s39, 0x20000
buffer_load_dwordx4 v[38:41], v4, s[36:39], 0 offen
buffer_load_dword v42, v4, s[36:39], 0 offen offset:16
s_add_u32 s6, s88, 2
s_lshl_b32 s6, s6, 12
s_add_u32 s6, s6, 1048576
s_add_u32 s36, s66, s6
s_addc_u32 s37, s67, 0
s_and_b32 s37, s37, 0xffff
s_mov_b32 s38, 4096
s_mov_b32 s39, 0x20000
buffer_load_dwordx4 v[44:47], v4, s[36:39], 0 offen
buffer_load_dword v48, v4, s[36:39], 0 offen offset:16
buffer_load_dword v254, v228, s[24:27], 0 offen sc1
v_lshlrev_b32 v5, 4, v0
v_add_u32 v5, 87552, v5
v_add_u32 v7, 60416, v5
v_mov_b32 v12, 0
v_mov_b32 v13, 0
v_mov_b32 v14, 0
v_mov_b32 v15, 0
v_cmp_gt_u32 vcc, 119, v0
s_and_saveexec_b64 s[6:7], vcc
ds_write_b128 v5, v[12:15] offset:0
ds_write_b128 v5, v[12:15] offset:6272
ds_write_b128 v5, v[12:15] offset:30208
ds_write_b128 v5, v[12:15] offset:36480
ds_write_b128 v7, v[12:15] offset:0
ds_write_b128 v7, v[12:15] offset:6272
s_mov_b64 exec, s[6:7]
v_lshrrev_b32 v4, 4, v0
v_mul_u32_u24 v4, 272, v4
v_and_b32 v5, 15, v0
v_lshl_add_u32 v4, v5, 4, v4
v_add_u32 v4, 83200, v4
v_add_u32 v6, 60416, v4
s_waitcnt vmcnt(1)
ds_write_b128 v4, v[32:35] offset:6272
v_alignbit_b32 v12, v33, v32, 16
v_alignbit_b32 v13, v34, v33, 16
v_alignbit_b32 v14, v35, v34, 16
v_alignbit_b32 v15, v36, v35, 16
ds_write_b128 v4, v[12:15] offset:0
ds_write_b128 v4, v[38:41] offset:36480
v_alignbit_b32 v12, v39, v38, 16
v_alignbit_b32 v13, v40, v39, 16
v_alignbit_b32 v14, v41, v40, 16
v_alignbit_b32 v15, v42, v41, 16
ds_write_b128 v4, v[12:15] offset:30208
ds_write_b128 v6, v[44:47] offset:6272
v_alignbit_b32 v12, v45, v44, 16
v_alignbit_b32 v13, v46, v45, 16
v_alignbit_b32 v14, v47, v46, 16
v_alignbit_b32 v15, v48, v47, 16
ds_write_b128 v6, v[12:15] offset:0
s_waitcnt vmcnt(0)
v_cmp_eq_u32 vcc, 0, v254
s_cbranch_vccnz L_slow_49
L_back_50:
s_lshr_b32 s6, s4, 3
s_mul_i32 s6, s6, 14
s_and_b32 s7, s4, 7
s_mul_i32 s7, s7, 7
s_add_u32 s6, s6, s7
s_lshr_b32 s6, s6, 2
s_cmp_ge_u32 s5, 2
s_cselect_b32 s43, 13, 14
s_cmp_ge_u32 s6, s43
s_cselect_b32 s7, s43, 0
s_sub_u32 s93, s6, s7
s_mov_b32 s93, 0
s_mul_i32 s6, s95, 54
s_add_u32 s6, s6, s96
s_mul_i32 s79, s6, 5120
s_add_u32 s79, s79, 7340032
s_mul_i32 s7, s43, 5120
s_add_u32 s80, s79, s7
s_mul_i32 s7, s93, 5120
s_add_u32 s97, s79, s7
s_add_u32 s98, s97, 4096
buffer_load_dwordx4 a[0:3], v248, s[24:27], s97 offen offset:0
buffer_load_dwordx4 a[4:7], v248, s[24:27], s97 offen offset:1024
buffer_load_dwordx4 a[8:11], v248, s[24:27], s97 offen offset:2048
buffer_load_dwordx4 a[12:15], v248, s[24:27], s97 offen offset:3072
buffer_load_dwordx4 a[16:19], v248, s[24:27], s98 offen
s_add_u32 s97, s97, 5120
s_cmp_eq_u32 s97, s80
s_cselect_b32 s97, s79, s97
s_add_u32 s98, s97, 4096
buffer_load_dwordx4 a[20:23], v248, s[24:27], s97 offen offset:0
buffer_load_dwordx4 a[24:27], v248, s[24:27], s97 offen offset:1024
buffer_load_dwordx4 a[28:31], v248, s[24:27], s97 offen offset:2048
buffer_load_dwordx4 a[32:35], v248, s[24:27], s97 offen offset:3072
buffer_load_dwordx4 a[36:39], v248, s[24:27], s98 offen
s_add_u32 s97, s97, 5120
s_cmp_eq_u32 s97, s80
s_cselect_b32 s97, s79, s97
s_add_u32 s98, s97, 4096
buffer_load_dwordx4 a[40:43], v248, s[24:27], s97 offen offset:0
buffer_load_dwordx4 a[44:47], v248, s[24:27], s97 offen offset:1024
buffer_load_dwordx4 a[48:51], v248, s[24:27], s97 offen offset:2048
buffer_load_dwordx4 a[52:55], v248, s[24:27], s97 offen offset:3072
buffer_load_dwordx4 a[56:59], v248, s[24:27], s98 offen
s_add_u32 s97, s97, 5120
s_cmp_eq_u32 s97, s80
s_cselect_b32 s97, s79, s97
s_add_u32 s98, s97, 4096
buffer_load_dwordx4 a[60:63], v248, s[24:27], s97 offen offset:0
buffer_load_dwordx4 a[64:67], v248, s[24:27], s97 offen offset:1024
buffer_load_dwordx4 a[68:71], v248, s[24:27], s97 offen offset:2048
buffer_load_dwordx4 a[72:75], v248, s[24:27], s97 offen offset:3072
buffer_load_dwordx4 a[76:79], v248, s[24:27], s98 offen
s_add_u32 s97, s97, 5120
s_cmp_eq_u32 s97, s80
s_cselect_b32 s97, s79, s97
s_add_u32 s98, s97, 4096
s_lshl_b32 s6, s89, 2
s_add_u32 s6, s6, s5
s_lshl_b32 s7, s6, 1
s_lshr_b32 s85, 6436, s7
s_and_b32 s85, s85, 3
s_lshr_b32 s86, 55, s6
s_and_b32 s86, s86, 1
s_lshr_b32 s87, 61311, s7
s_and_b32 s87, s87, 3
v_and_b32 v2, 3, v1
v_mul_u32_u24 v2, 4416, v2
v_bfe_u32 v3, v1, 2, 2
v_lshrrev_b32 v18, 4, v1
v_add_u32 v3, v3, v18
v_lshl_add_u32 v16, v3, 4, v2
v_and_b32 v2, 1, v1
v_mul_u32_u24 v2, 6272, v2
v_bfe_u32 v3, v1, 1, 3
s_lshl_b32 s6, s86, 3
s_sub_u32 s6, 15, s6
v_sub_u32 v5, s6, v3
v_mul_u32_u24 v5, 272, v5
v_add_u32 v2, v2, v5
v_lshl_add_u32 v17, v18, 4, v2
s_lshl_b32 s6, s86, 3
v_add_u32 v3, s6, v3
v_lshlrev_b32 v3, 8, v3
v_and_b32 v2, 1, v1
v_lshl_or_b32 v2, v18, 1, v2
v_lshl_or_b32 v11, v2, 4, v3
s_mul_i32 s6, s85, 30208
s_add_u32 s6, s6, 65536
v_add_u32 v8, s6, v16
s_add_u32 s6, s6, 17664
v_add_u32 v9, s6, v17
v_lshlrev_b32 v10, 5, v18
v_sub_u32 v10, v9, v10
v_add_u32 v10, 0, v10
s_add_u32 s91, s88, s85
s_branch L_conv
L_slow_11:
s_add_u32 s42, s42, 1
s_cmp_gt_u32 s42, 200000
s_cbranch_scc1 L_back_12
buffer_load_dword v254, v230, s[52:55], 0 offen sc1
s_waitcnt vmcnt(0)
v_cmp_gt_u32 vcc, 32, v254
s_cbranch_vccnz L_slow_11
s_branch L_back_12
L_slow_20:
s_add_u32 s42, s42, 1
s_cmp_gt_u32 s42, 200000
s_cbranch_scc1 L_back_21
buffer_load_dword v254, v231, s[24:27], 0 offen sc1
s_waitcnt vmcnt(0)
v_cmp_eq_u32 vcc, 0, v254
s_cbranch_vccnz L_slow_20
s_branch L_back_21
L_slow_27:
s_add_u32 s42, s42, 1
s_cmp_gt_u32 s42, 200000
s_cbranch_scc1 L_back_28
buffer_load_dword v251, v229, s[24:27], 0 offen sc1
s_waitcnt vmcnt(0)
v_cmp_eq_u32 vcc, 0, v251
s_cbranch_vccnz L_slow_27
s_branch L_back_28
L_slow_29:
s_add_u32 s42, s42, 1
s_cmp_gt_u32 s42, 200000
s_cbranch_scc1 L_back_30
buffer_load_dword v254, v228, s[24:27], 0 offen sc1
s_waitcnt vmcnt(0)
v_cmp_eq_u32 vcc, 0, v254
s_cbranch_vccnz L_slow_29
s_branch L_back_30
L_slow_34:
s_add_u32 s42, s42, 1
s_cmp_gt_u32 s42, 200000
s_cbranch_scc1 L_back_35
buffer_load_dword v254, v249, s[24:27], 0 offen sc1
s_waitcnt vmcnt(0)
v_cmp_eq_u32 vcc, 0, v254
s_cbranch_vccnz L_slow_34
s_branch L_back_35
L_slow_38:
s_add_u32 s42, s42, 1
s_cmp_gt_u32 s42, 200000
s_cbranch_scc1 L_back_39
buffer_load_dword v254, v250, s[24:27], 0 offen sc1
s_waitcnt vmcnt(0)
v_cmp_eq_u32 vcc, 0, v254
s_cbranch_vccnz L_slow_38
s_branch L_back_39
L_slow_44:
s_add_u32 s42, s42, 1
s_cmp_gt_u32 s42, 200000
s_cbranch_scc1 L_back_45
buffer_load_dword v254, v230, s[52:55], 0 offen sc1
s_waitcnt vmcnt(0)
v_cmp_gt_u32 vcc, 32, v254
s_cbranch_vccnz L_slow_44
s_branch L_back_45
L_slow_47:
s_add_u32 s42, s42, 1
s_cmp_gt_u32 s42, 200000
s_cbranch_scc1 L_back_48
buffer_load_dword v254, v229, s[24:27], 0 offen sc1
s_waitcnt vmcnt(0)
v_cmp_eq_u32 vcc, 0, v254
s_cbranch_vccnz L_slow_47
s_branch L_back_48
L_slow_49:
s_add_u32 s42, s42, 1
s_cmp_gt_u32 s42, 200000
s_cbranch_scc1 L_back_50
buffer_load_dword v254, v228, s[24:27], 0 offen sc1
s_waitcnt vmcnt(0)
v_cmp_eq_u32 vcc, 0, v254
s_cbranch_vccnz L_slow_49
s_branch L_back_50
.section .rodata,"a"
.p2align 6
.amdhsa_kernel recurrent_scan__ssm_conv_h3__dense_activation_gelu__prompt_kernel
  .amdhsa_next_free_vgpr 512
  .amdhsa_next_free_sgpr 102
  .amdhsa_accum_offset 256
  .amdhsa_group_segment_fixed_size 0
  .amdhsa_kernarg_size 112
  .amdhsa_user_sgpr_count 2
  .amdhsa_user_sgpr_kernarg_segment_ptr 1
  .amdhsa_system_sgpr_workgroup_id_x 1
.end_amdhsa_kernel
```

```asm
; @launch grid=(256,1,1) block=(256,1,1) lds=163840
.amdgcn_target "amdgcn-amd-amdhsa--gfx950"
.text
.globl recurrent_scan__ssm_conv_h3__dense_activation_gelu__prompt_kernel
.p2align 8
.type recurrent_scan__ssm_conv_h3__dense_activation_gelu__prompt_kernel,@function
recurrent_scan__ssm_conv_h3__dense_activation_gelu__prompt_kernel:
s_cmp_ge_u32 s2, 256
s_cbranch_scc1 L_end
s_load_dwordx16 s[40:55], s[0:1], 0
s_load_dwordx8 s[56:63], s[0:1], 64
s_load_dwordx4 s[64:67], s[0:1], 96
s_and_b32 s3, s2, 7
s_lshr_b32 s4, s2, 3
v_lshrrev_b32 v1, 6, v0
v_and_b32 v0, 0xff, v0
v_mov_b32 v253, 1
v_readfirstlane_b32 s5, v1
v_and_b32 v1, 63, v0
s_lshl_b32 s6, s2, 7
v_mov_b32 v252, s6
v_lshlrev_b32 v248, 4, v1
v_and_b32 v230, 7, v1
v_lshlrev_b32 v230, 5, v230
v_mov_b32 v255, 0
s_cmp_ge_u32 s4, 28
s_cbranch_scc1 L_spare
s_and_b32 s6, s3, 3
s_lshl_b32 s6, s6, 2
s_and_b32 s7, s4, 3
s_add_u32 s77, s6, s7
s_lshr_b32 s6, s3, 2
s_mul_i32 s6, s6, 7
s_lshr_b32 s7, s4, 2
s_add_u32 s78, s6, s7
s_and_b32 s82, s5, 1
s_lshr_b32 s83, s5, 1
s_lshl_b32 s6, s3, 4
s_lshr_b32 s7, s4, 1
s_add_u32 s6, s6, s7
s_mul_i32 s6, s6, 5
s_and_b32 s89, s4, 1
s_lshl_b32 s7, s89, 1
s_add_u32 s88, s6, s7
s_and_b32 s6, s3, 3
s_lshl_b32 s6, s6, 3
s_and_b32 s7, s4, 7
s_add_u32 s94, s6, s7
s_lshr_b32 s6, s3, 2
s_xor_b32 s6, s6, 1
s_lshl_b32 s6, s6, 2
s_lshr_b32 s7, s4, 3
s_add_u32 s95, s6, s7
s_mul_i32 s96, s5, 14
s_cmp_eq_u32 s5, 3
s_cselect_b32 s6, 1, 0
s_sub_u32 s96, s96, s6
s_lshr_b32 s6, s4, 3
s_lshl_b32 s7, s3, 2
s_add_u32 s68, s6, s7
s_and_b32 s69, s4, 7
v_mul_u32_u24 v2, 26, v1
v_lshrrev_b32 v2, 8, v2
v_mul_u32_u24 v3, 10, v2
v_sub_u32 v3, v1, v3
s_lshl_b32 s6, s68, 6
s_lshl_b32 s7, s5, 4
s_add_u32 s6, s6, s7
s_mul_i32 s6, s6, 1280
s_mul_i32 s7, s69, 160
s_add_u32 s6, s6, s7
v_mul_u32_u24 v4, 5120, v2
v_lshl_add_u32 v4, v3, 4, v4
v_add_u32 v244, s6, v4
v_subrev_u32 v245, 3840, v244
s_mul_i32 s92, s69, 640
s_mul_i32 s7, s5, 2560
s_add_u32 s7, s7, 142592
s_mov_b32 m0, s7
v_lshl_add_u32 v247, v3, 6, s7
s_lshl_b32 s7, s5, 5
s_sub_u32 s7, 131192, s7
v_mul_u32_u24 v4, 1152, v3
v_lshlrev_b32 v2, 3, v2
v_sub_u32 v4, v4, v2
v_add_u32 v202, s7, v4
v_lshrrev_b32 v2, 3, v1
s_mul_i32 s6, s5, 20
v_add_u32 v2, s6, v2
v_and_b32 v3, 7, v1
v_lshlrev_b32 v3, 4, v3
v_mul_u32_u24 v4, 144, v2
v_add_u32 v4, v4, v3
v_add_u32 v203, 131072, v4
v_lshl_add_u32 v172, v2, 12, v3
s_mul_i32 s6, s69, 327680
s_lshl_b32 s7, s68, 7
s_sub_u32 s6, s6, s7
s_add_u32 s70, s6, 1052544
s_add_u32 s71, s70, 32768
s_add_u32 s72, s70, 65536
s_lshl_b32 s79, s78, 8
s_mul_i32 s80, s77, 163840
s_lshl_b32 s81, s5, 12
v_lshrrev_b32 v2, 4, v1
v_and_b32 v3, 15, v1
v_lshlrev_b32 v4, 2, v2
v_xor_b32 v4, v3, v4
s_lshl_b32 s6, s5, 4
v_add_u32 v5, s6, v2
v_mul_u32_u24 v5, 3456, v5
v_lshl_add_u32 v208, v4, 4, v5
s_cmp_eq_u32 s78, 13
s_cselect_b32 s7, 8, 16
v_cmp_le_u32 vcc, s7, v4
v_mov_b32 v6, 2147418112
v_cndmask_b32 v208, v208, v6, vcc
v_add_u32 v209, 12800, v208
v_add_u32 v210, 25600, v208
v_add_u32 v211, 38400, v208
v_lshrrev_b32 v4, 3, v1
v_and_b32 v5, 7, v1
s_lshl_b32 s6, s5, 5
v_add_u32 v4, s6, v4
v_mul_u32_u24 v4, 1280, v4
v_add_u32 v6, 0, v2
v_xor_b32 v6, v5, v6
v_lshl_add_u32 v6, v6, 4, v4
v_add_u32 v212, 0, v6
v_add_u32 v6, 4, v2
v_xor_b32 v6, v5, v6
v_lshl_add_u32 v6, v6, 4, v4
v_add_u32 v213, 9216, v6
v_add_u32 v6, 0, v2
v_xor_b32 v6, v5, v6
v_lshl_add_u32 v6, v6, 4, v4
v_add_u32 v214, 18432, v6
v_add_u32 v6, 4, v2
v_xor_b32 v6, v5, v6
v_lshl_add_u32 v6, v6, 4, v4
v_add_u32 v215, 27648, v6
s_lshl_b32 s6, s4, 2
s_add_u32 s6, s6, s5
s_lshl_b32 s7, s6, 3
v_and_b32 v2, 7, v1
v_add_u32 v2, s7, v2
v_lshrrev_b32 v3, 3, v1
v_mul_u32_u24 v4, 4682, v2
v_lshrrev_b32 v4, 16, v4
v_mul_u32_u24 v5, 14, v4
v_sub_u32 v5, v2, v5
v_lshl_add_u32 v4, v3, 6, v4
v_mul_u32_u24 v4, 3456, v4
v_lshl_add_u32 v4, v5, 7, v4
s_lshr_b32 s7, s3, 2
s_mul_i32 s73, s7, 1792
v_add_u32 v4, s73, v4
s_sub_u32 s7, 13, s7
v_mov_b32 v6, 2147418112
v_cmp_lt_u32 vcc, s7, v5
v_cndmask_b32 v232, v4, v6, vcc
v_mul_u32_u24 v2, 52, v1
v_lshrrev_b32 v2, 8, v2
v_mul_u32_u24 v3, 5, v2
v_sub_u32 v3, v1, v3
s_mul_i32 s7, s6, 5
v_add_u32 v3, s7, v3
v_cmp_gt_u32 vcc, 512, v3
s_and_b32 s7, s3, 3
s_lshl_b32 s7, s7, 9
v_add_u32 v3, s7, v3
v_mul_u32_u24 v3, 1280, v3
v_lshl_add_u32 v3, v2, 7, v3
v_cndmask_b32 v233, v6, v3, vcc
s_lshl_b32 s6, s68, 6
s_lshl_b32 s7, s5, 4
s_add_u32 s6, s6, s7
s_mul_i32 s6, s6, 1280
s_mul_i32 s7, s69, 160
s_and_b32 s7, s7, 0xffffff80
s_add_u32 s6, s6, s7
v_lshrrev_b32 v2, 1, v1
v_mul_u32_u24 v2, 1280, v2
v_and_b32 v3, 1, v1
v_lshl_add_u32 v2, v3, 7, v2
v_add_u32 v129, s6, v2
v_subrev_u32 v128, 3840, v129
s_mul_i32 s7, s69, 640
v_lshlrev_b32 v2, 7, v1
v_add_u32 v130, s7, v2
s_waitcnt lgkmcnt(0)
s_mov_b32 s24, s66
s_and_b32 s25, s67, 0xffff
s_mov_b32 s26, 17825792
s_mov_b32 s27, 0x20000
s_lshl_b32 s6, s88, 1
s_and_b32 s6, s6, 0xfffffffc
s_load_dwordx2 s[0:1], s[50:51], s6
s_cmp_lg_u32 s5, 0
s_cbranch_scc1 L_clr_1
v_lshl_add_u32 v2, v1, 2, v252
v_mov_b32 v3, 0
s_mov_b64 exec, 0xff
buffer_store_dword v3, v2, s[24:27], 0 offen sc1
s_mov_b64 exec, -1
L_clr_1:
s_mov_b32 s12, s42
s_and_b32 s13, s43, 0xffff
s_mov_b32 s14, 2621440
s_mov_b32 s15, 0x20000
s_mov_b32 s16, s44
s_and_b32 s17, s45, 0xffff
s_mov_b32 s18, 2621440
s_mov_b32 s19, 0x20000
s_mov_b32 s32, s46
s_and_b32 s33, s47, 0xffff
s_mov_b32 s34, 5120
s_mov_b32 s35, 0x20000
s_mov_b32 exec_hi, 0xff
buffer_load_dwordx4 v[8:11], v245, s[12:15], 0 offen offset:0
buffer_load_dwordx4 v[12:15], v245, s[12:15], 0 offen offset:1280
buffer_load_dwordx4 v[16:19], v245, s[12:15], 0 offen offset:2560
buffer_load_dwordx4 v[20:23], v244, s[12:15], 0 offen offset:0
buffer_load_dwordx4 v[24:27], v244, s[12:15], 0 offen offset:1280
buffer_load_dwordx4 v[28:31], v244, s[12:15], 0 offen offset:2560
buffer_load_dwordx4 v[32:35], v244, s[12:15], 0 offen offset:3840
buffer_load_dwordx4 v248, s[32:35], s92 offen lds
buffer_load_dwordx4 v[174:177], v244, s[16:19], 0 offen offset:0
buffer_load_dwordx4 v[178:181], v244, s[16:19], 0 offen offset:1280
buffer_load_dwordx4 v[182:185], v244, s[16:19], 0 offen offset:2560
buffer_load_dwordx4 v[186:189], v244, s[16:19], 0 offen offset:3840
s_mov_b64 exec, -1
s_mov_b32 s20, s54
s_and_b32 s21, s55, 0xffff
s_mov_b32 s22, 2211840
s_mov_b32 s23, 0x20000
s_mov_b32 s8, s40
s_and_b32 s9, s41, 0xffff
s_mov_b32 s10, 2621440
s_mov_b32 s11, 0x20000
s_mov_b32 s28, s62
s_and_b32 s29, s63, 0xffff
s_mov_b32 s30, 2621440
s_mov_b32 s31, 0x20000
s_mov_b32 s52, s64
s_and_b32 s53, s65, 0xffff
s_mov_b32 s54, 256
s_mov_b32 s55, 0x20000
s_mov_b32 s42, 0
s_mov_b32 s36, s58
s_and_b32 s37, s59, 0xffff
s_mov_b32 s38, 2211840
s_mov_b32 s39, 0x20000
s_lshr_b32 s6, s2, 2
s_lshl_b32 s6, s6, 5
s_lshl_b32 s7, s5, 3
s_add_u32 s6, s6, s7
s_mul_i32 s6, s6, 1280
s_and_b32 s7, s2, 3
s_mul_i32 s7, s7, 320
s_add_u32 s6, s6, s7
s_cmp_lt_u32 s2, 216
s_cselect_b32 s6, s6, 2147418112
v_add_u32 v2, 0, v1
v_mul_u32_u24 v3, 205, v2
v_lshrrev_b32 v3, 12, v3
v_mul_u32_u24 v4, 20, v3
v_sub_u32 v2, v2, v4
v_mul_u32_u24 v3, 1280, v3
v_lshl_add_u32 v2, v2, 4, v3
v_add_u32 v2, s6, v2
v_subrev_u32 v204, 0, v2
v_add_u32 v2, 64, v1
v_mul_u32_u24 v3, 205, v2
v_lshrrev_b32 v3, 12, v3
v_mul_u32_u24 v4, 20, v3
v_sub_u32 v2, v2, v4
v_mul_u32_u24 v3, 1280, v3
v_lshl_add_u32 v2, v2, 4, v3
v_add_u32 v2, s6, v2
v_subrev_u32 v205, 1024, v2
v_add_u32 v2, 128, v1
v_mul_u32_u24 v3, 205, v2
v_lshrrev_b32 v3, 12, v3
v_mul_u32_u24 v4, 20, v3
v_sub_u32 v2, v2, v4
v_mul_u32_u24 v3, 1280, v3
v_lshl_add_u32 v2, v2, 4, v3
v_add_u32 v2, s6, v2
v_subrev_u32 v206, 2048, v2
s_mul_i32 s6, s5, 2560
s_add_u32 s74, s6, 142592
v_lshrrev_b32 v2, 4, v1
v_bfe_u32 v3, v1, 2, 2
v_lshrrev_b32 v4, 1, v2
v_lshlrev_b32 v4, 4, v4
v_and_b32 v2, 1, v2
v_lshl_add_u32 v2, v2, 2, v3
v_add_u32 v2, v2, v4
v_mul_u32_u24 v2, 320, v2
v_and_b32 v3, 3, v1
v_mul_u32_u24 v3, 40, v3
v_add_u32 v2, v2, v3
v_add_u32 v5, 142592, v2
s_and_b32 s6, s2, 3
s_lshl_b32 s6, s6, 1
s_mul_i32 s6, s6, 54
s_lshr_b32 s7, s2, 2
s_add_u32 s6, s6, s7
s_mul_i32 s84, s6, 5120
s_add_u32 s84, s84, 7340032
v_mov_b32 v207, 2147418112
s_cmp_lt_u32 s2, 216
s_cselect_b64 vcc, -1, 0
v_cndmask_b32 v207, v207, v248, vcc
s_add_u32 s6, s5, 0
s_cmp_ge_u32 s6, 5
s_cselect_b32 s7, 5, 0
s_cselect_b32 s43, 276480, 0
s_cselect_b32 s75, 160, 0
s_sub_u32 s6, s6, s7
s_lshl_b32 s7, s6, 3
s_add_u32 s75, s75, s7
v_add_u32 v200, s75, v5
s_lshl_b32 s6, s6, 10
s_add_u32 s6, s6, s43
s_add_u32 s75, s6, s84
s_add_u32 s6, s5, 4
s_cmp_ge_u32 s6, 5
s_cselect_b32 s7, 5, 0
s_cselect_b32 s43, 276480, 0
s_cselect_b32 s76, 160, 0
s_sub_u32 s6, s6, s7
s_lshl_b32 s7, s6, 3
s_add_u32 s76, s76, s7
v_add_u32 v201, s76, v5
s_lshl_b32 s6, s6, 10
s_add_u32 s6, s6, s43
s_add_u32 s76, s6, s84
s_add_u32 s6, s5, 8
s_cmp_ge_u32 s6, 5
s_cselect_b32 s7, 5, 0
s_cselect_b32 s43, 276480, 0
s_cselect_b32 s93, 160, 0
s_sub_u32 s6, s6, s7
s_lshl_b32 s7, s6, 3
s_add_u32 s93, s93, s7
v_add_u32 v246, s93, v5
s_lshl_b32 s6, s6, 10
s_add_u32 s6, s6, s43
s_add_u32 s93, s6, s84
s_cmp_ge_u32 s5, 2
s_cselect_b64 vcc, -1, 0
v_mov_b32 v3, 2147418112
v_cndmask_b32 v173, v207, v3, vcc
s_mov_b32 exec_lo, 0xffffff
s_mov_b32 exec_hi, 0x0
buffer_load_dword v234, v232, s[20:23], 0 offen
s_mov_b64 exec, -1
s_mov_b32 exec_lo, 0x7fff
s_mov_b32 exec_hi, 0x0
buffer_load_dword v234, v233, s[8:11], 0 offen
s_mov_b64 exec, -1
v_lshrrev_b32 v2, 4, v1
v_bfe_u32 v4, v1, 2, 2
v_and_b32 v5, 3, v1
v_lshrrev_b32 v6, 5, v1
v_lshl_add_u32 v6, v6, 3, v4
v_lshlrev_b32 v6, 8, v6
s_lshl_b32 s6, s82, 1
v_xor_b32 v4, s6, v4
v_lshlrev_b32 v4, 2, v4
v_and_b32 v3, 1, v2
v_lshl_or_b32 v4, v3, 1, v4
v_lshrrev_b32 v3, 1, v5
v_or_b32 v4, v4, v3
v_lshl_add_u32 v6, v4, 4, v6
v_and_b32 v5, 1, v5
v_lshl_add_u32 v216, v5, 3, v6
v_xor_b32 v217, 64, v216
v_add_u32 v218, 0x10000, v216
v_add_u32 v219, 0x10000, v217
v_and_b32 v4, 31, v1
v_bfe_u32 v5, v1, 1, 3
v_lshrrev_b32 v6, 5, v1
v_xor_b32 v5, v5, v6
s_lshl_b32 s6, s83, 6
v_add_u32 v4, s6, v4
v_lshlrev_b32 v4, 7, v4
v_lshl_add_u32 v220, v5, 4, v4
v_xor_b32 v221, 32, v220
v_xor_b32 v222, 64, v220
v_xor_b32 v223, 96, v220
v_add_u32 v224, 0x10000, v220
v_add_u32 v225, 0x10000, v221
v_add_u32 v226, 0x10000, v222
v_add_u32 v227, 0x10000, v223
v_and_b32 v2, 15, v1
v_min_u32 v2, 13, v2
v_add_u32 v2, s96, v2
v_min_u32 v2, 53, v2
v_lshlrev_b32 v2, 2, v2
s_lshr_b32 s43, s95, 1
v_add_u32 v2, s43, v2
v_lshlrev_b32 v2, 7, v2
v_add_u32 v228, 12, v2
s_lshl_b32 s6, s77, 1
v_and_b32 v4, 1, v1
v_add_u32 v4, s6, v4
v_and_b32 v5, 3, v4
v_add_u32 v5, 28, v5
s_lshr_b32 s6, s77, 2
s_and_b32 s7, s77, 2
s_lshl_b32 s7, s7, 1
s_add_u32 s6, s6, s7
v_mov_b32 v4, s6
v_lshl_add_u32 v4, v5, 3, v4
v_lshlrev_b32 v4, 7, v4
v_add_u32 v231, 4, v4
v_and_b32 v2, 31, v1
v_and_b32 v3, 7, v2
v_lshrrev_b32 v2, 3, v2
v_lshlrev_b32 v2, 3, v2
v_add_u32 v2, s3, v2
v_lshl_add_u32 v2, v2, 3, v3
v_lshlrev_b32 v229, 7, v2
v_cmp_gt_u32 vcc, 14, v1
v_cndmask_b32 v2, 0, v1, vcc
v_cmp_lt_u32 vcc, 6, v2
v_cndmask_b32 v3, 0, 1, vcc
v_mul_u32_u24 v4, 7, v3
v_sub_u32 v2, v2, v4
s_lshr_b32 s6, s94, 1
s_and_b32 s7, s6, 3
s_lshr_b32 s6, s6, 2
v_lshlrev_b32 v3, 2, v3
v_lshlrev_b32 v2, 2, v2
v_add_u32 v2, s7, v2
v_add_u32 v3, s6, v3
v_lshl_add_u32 v2, v2, 3, v3
v_lshlrev_b32 v2, 7, v2
v_add_u32 v249, 16, v2
v_and_b32 v2, 31, v1
v_lshlrev_b32 v2, 3, v2
v_add_u32 v2, s95, v2
v_lshlrev_b32 v2, 7, v2
v_add_u32 v250, 20, v2
v_mov_b32 v2, 2147418112
s_cmp_lg_u32 s5, 0
s_cselect_b64 vcc, -1, 0
v_cndmask_b32 v231, v231, v2, vcc
v_cndmask_b32 v230, v230, v2, vcc
v_and_b32 v2, 15, v1
v_bfe_u32 v3, v1, 4, 1
v_lshlrev_b32 v3, 2, v3
v_cmp_eq_u32 vcc, v2, v3
v_mov_b32 v2, 0x3f803f80
v_cndmask_b32 v160, 0, v2, vcc
v_mov_b32 v161, v160
v_mov_b32 v162, v160
v_mov_b32 v163, v160
s_add_u32 m0, s81, 0
s_nop 0
buffer_load_dwordx4 v208, s[20:23], s79 offen offset:0 lds
buffer_load_dwordx4 v209, s[20:23], s79 offen offset:1024 lds
buffer_load_dwordx4 v210, s[20:23], s79 offen offset:2048 lds
buffer_load_dwordx4 v211, s[20:23], s79 offen offset:3072 lds
s_add_u32 m0, s81, 16384
s_nop 0
buffer_load_dwordx4 v212, s[8:11], s80 offen offset:0 lds
buffer_load_dwordx4 v213, s[8:11], s80 offen offset:1024 lds
buffer_load_dwordx4 v214, s[8:11], s80 offen offset:2048 lds
buffer_load_dwordx4 v215, s[8:11], s80 offen offset:3072 lds
s_waitcnt vmcnt(10)
ds_read_b128 v[36:39], v247 offset:0
ds_read_b128 v[40:43], v247 offset:16
ds_read_b128 v[44:47], v247 offset:32
ds_read_b128 v[48:51], v247 offset:48
s_cmp_lg_u32 s5, 0
s_cbranch_scc1 L_arr_2
s_and_b32 s6, s2, 7
s_lshl_b32 s6, s6, 5
v_mov_b32 v2, s6
s_mov_b64 exec, 1
buffer_atomic_add v253, v2, s[52:55], 0 offen sc1
s_mov_b64 exec, -1
L_arr_2:
v_lshlrev_b32 v194, 16, v8
v_and_b32 v195, 0xffff0000, v8
v_lshlrev_b32 v196, 16, v12
v_and_b32 v197, 0xffff0000, v12
s_mov_b32 exec_lo, 0xff000000
s_mov_b32 exec_hi, 0xffffff
buffer_load_dword v234, v232, s[20:23], 0 offen
s_mov_b64 exec, -1
s_mov_b32 exec_lo, 0xffff8000
s_mov_b32 exec_hi, 0x7
buffer_load_dword v234, v233, s[8:11], 0 offen
s_mov_b64 exec, -1
v_lshlrev_b32 v198, 16, v16
v_and_b32 v199, 0xffff0000, v16
v_lshlrev_b32 v236, 16, v20
v_and_b32 v237, 0xffff0000, v20
v_lshlrev_b32 v238, 16, v24
v_and_b32 v239, 0xffff0000, v24
v_lshlrev_b32 v240, 16, v28
v_and_b32 v241, 0xffff0000, v28
v_lshlrev_b32 v242, 16, v32
v_and_b32 v243, 0xffff0000, v32
s_waitcnt lgkmcnt(0)
v_lshlrev_b32 v52, 16, v36
v_lshlrev_b32 v53, 16, v38
v_and_b32 v54, 0xffff0000, v36
v_and_b32 v55, 0xffff0000, v38
v_lshlrev_b32 v56, 16, v37
v_lshlrev_b32 v57, 16, v39
v_and_b32 v58, 0xffff0000, v37
v_and_b32 v59, 0xffff0000, v39
v_pk_mul_f32 v[60:61], v[236:237], v[52:53]
v_pk_mul_f32 v[62:63], v[238:239], v[52:53]
v_pk_mul_f32 v[190:191], v[240:241], v[52:53]
v_pk_mul_f32 v[192:193], v[242:243], v[52:53]
v_pk_fma_f32 v[60:61], v[198:199], v[54:55], v[60:61]
v_pk_fma_f32 v[62:63], v[236:237], v[54:55], v[62:63]
v_pk_fma_f32 v[190:191], v[238:239], v[54:55], v[190:191]
v_pk_fma_f32 v[192:193], v[240:241], v[54:55], v[192:193]
v_pk_fma_f32 v[60:61], v[196:197], v[56:57], v[60:61]
v_pk_fma_f32 v[62:63], v[198:199], v[56:57], v[62:63]
v_pk_fma_f32 v[190:191], v[236:237], v[56:57], v[190:191]
v_pk_fma_f32 v[192:193], v[238:239], v[56:57], v[192:193]
v_pk_fma_f32 v[60:61], v[194:195], v[58:59], v[60:61]
v_pk_fma_f32 v[62:63], v[196:197], v[58:59], v[62:63]
v_pk_fma_f32 v[190:191], v[198:199], v[58:59], v[190:191]
v_pk_fma_f32 v[192:193], v[236:237], v[58:59], v[192:193]
v_lshlrev_b32 v194, 16, v174
v_and_b32 v195, 0xffff0000, v174
v_lshlrev_b32 v196, 16, v178
v_and_b32 v197, 0xffff0000, v178
v_lshlrev_b32 v198, 16, v182
v_and_b32 v199, 0xffff0000, v182
v_lshlrev_b32 v236, 16, v186
v_and_b32 v237, 0xffff0000, v186
v_pk_mul_f32 v[60:61], v[60:61], v[194:195]
v_pk_mul_f32 v[62:63], v[62:63], v[196:197]
v_pk_mul_f32 v[190:191], v[190:191], v[198:199]
v_pk_mul_f32 v[192:193], v[192:193], v[236:237]
s_mov_b32 exec_hi, 0xff
v_cvt_pk_bf16_f32 v238, v192, v190
v_cvt_pk_bf16_f32 v239, v62, v60
ds_write_b64 v202, v[238:239] offset:0
v_cvt_pk_bf16_f32 v240, v193, v191
v_cvt_pk_bf16_f32 v241, v63, v61
ds_write_b64 v202, v[240:241] offset:144
s_mov_b64 exec, -1
v_lshlrev_b32 v194, 16, v9
v_and_b32 v195, 0xffff0000, v9
v_lshlrev_b32 v196, 16, v13
v_and_b32 v197, 0xffff0000, v13
v_lshlrev_b32 v198, 16, v17
v_and_b32 v199, 0xffff0000, v17
v_lshlrev_b32 v236, 16, v21
v_and_b32 v237, 0xffff0000, v21
v_lshlrev_b32 v238, 16, v25
v_and_b32 v239, 0xffff0000, v25
v_lshlrev_b32 v240, 16, v29
v_and_b32 v241, 0xffff0000, v29
v_lshlrev_b32 v242, 16, v33
v_and_b32 v243, 0xffff0000, v33
v_lshlrev_b32 v52, 16, v40
v_lshlrev_b32 v53, 16, v42
v_and_b32 v54, 0xffff0000, v40
v_and_b32 v55, 0xffff0000, v42
v_lshlrev_b32 v56, 16, v41
v_lshlrev_b32 v57, 16, v43
v_and_b32 v58, 0xffff0000, v41
v_and_b32 v59, 0xffff0000, v43
v_pk_mul_f32 v[60:61], v[236:237], v[52:53]
v_pk_mul_f32 v[62:63], v[238:239], v[52:53]
v_pk_mul_f32 v[190:191], v[240:241], v[52:53]
v_pk_mul_f32 v[192:193], v[242:243], v[52:53]
v_pk_fma_f32 v[60:61], v[198:199], v[54:55], v[60:61]
v_pk_fma_f32 v[62:63], v[236:237], v[54:55], v[62:63]
v_pk_fma_f32 v[190:191], v[238:239], v[54:55], v[190:191]
v_pk_fma_f32 v[192:193], v[240:241], v[54:55], v[192:193]
v_pk_fma_f32 v[60:61], v[196:197], v[56:57], v[60:61]
v_pk_fma_f32 v[62:63], v[198:199], v[56:57], v[62:63]
v_pk_fma_f32 v[190:191], v[236:237], v[56:57], v[190:191]
v_pk_fma_f32 v[192:193], v[238:239], v[56:57], v[192:193]
v_pk_fma_f32 v[60:61], v[194:195], v[58:59], v[60:61]
v_pk_fma_f32 v[62:63], v[196:197], v[58:59], v[62:63]
v_pk_fma_f32 v[190:191], v[198:199], v[58:59], v[190:191]
v_pk_fma_f32 v[192:193], v[236:237], v[58:59], v[192:193]
v_lshlrev_b32 v194, 16, v175
v_and_b32 v195, 0xffff0000, v175
v_lshlrev_b32 v196, 16, v179
v_and_b32 v197, 0xffff0000, v179
v_lshlrev_b32 v198, 16, v183
v_and_b32 v199, 0xffff0000, v183
v_lshlrev_b32 v236, 16, v187
v_and_b32 v237, 0xffff0000, v187
v_pk_mul_f32 v[60:61], v[60:61], v[194:195]
v_pk_mul_f32 v[62:63], v[62:63], v[196:197]
v_pk_mul_f32 v[190:191], v[190:191], v[198:199]
v_pk_mul_f32 v[192:193], v[192:193], v[236:237]
s_mov_b32 exec_hi, 0xff
v_cvt_pk_bf16_f32 v238, v192, v190
v_cvt_pk_bf16_f32 v239, v62, v60
ds_write_b64 v202, v[238:239] offset:288
v_cvt_pk_bf16_f32 v240, v193, v191
v_cvt_pk_bf16_f32 v241, v63, v61
ds_write_b64 v202, v[240:241] offset:432
s_mov_b64 exec, -1
v_lshlrev_b32 v194, 16, v10
v_and_b32 v195, 0xffff0000, v10
v_lshlrev_b32 v196, 16, v14
v_and_b32 v197, 0xffff0000, v14
v_lshlrev_b32 v198, 16, v18
v_and_b32 v199, 0xffff0000, v18
v_lshlrev_b32 v236, 16, v22
v_and_b32 v237, 0xffff0000, v22
v_lshlrev_b32 v238, 16, v26
v_and_b32 v239, 0xffff0000, v26
v_lshlrev_b32 v240, 16, v30
v_and_b32 v241, 0xffff0000, v30
v_lshlrev_b32 v242, 16, v34
v_and_b32 v243, 0xffff0000, v34
v_lshlrev_b32 v52, 16, v44
v_lshlrev_b32 v53, 16, v46
v_and_b32 v54, 0xffff0000, v44
v_and_b32 v55, 0xffff0000, v46
v_lshlrev_b32 v56, 16, v45
v_lshlrev_b32 v57, 16, v47
v_and_b32 v58, 0xffff0000, v45
v_and_b32 v59, 0xffff0000, v47
v_pk_mul_f32 v[60:61], v[236:237], v[52:53]
v_pk_mul_f32 v[62:63], v[238:239], v[52:53]
v_pk_mul_f32 v[190:191], v[240:241], v[52:53]
v_pk_mul_f32 v[192:193], v[242:243], v[52:53]
v_pk_fma_f32 v[60:61], v[198:199], v[54:55], v[60:61]
v_pk_fma_f32 v[62:63], v[236:237], v[54:55], v[62:63]
v_pk_fma_f32 v[190:191], v[238:239], v[54:55], v[190:191]
v_pk_fma_f32 v[192:193], v[240:241], v[54:55], v[192:193]
v_pk_fma_f32 v[60:61], v[196:197], v[56:57], v[60:61]
v_pk_fma_f32 v[62:63], v[198:199], v[56:57], v[62:63]
v_pk_fma_f32 v[190:191], v[236:237], v[56:57], v[190:191]
v_pk_fma_f32 v[192:193], v[238:239], v[56:57], v[192:193]
v_pk_fma_f32 v[60:61], v[194:195], v[58:59], v[60:61]
v_pk_fma_f32 v[62:63], v[196:197], v[58:59], v[62:63]
v_pk_fma_f32 v[190:191], v[198:199], v[58:59], v[190:191]
v_pk_fma_f32 v[192:193], v[236:237], v[58:59], v[192:193]
v_lshlrev_b32 v194, 16, v176
v_and_b32 v195, 0xffff0000, v176
v_lshlrev_b32 v196, 16, v180
v_and_b32 v197, 0xffff0000, v180
v_lshlrev_b32 v198, 16, v184
v_and_b32 v199, 0xffff0000, v184
v_lshlrev_b32 v236, 16, v188
v_and_b32 v237, 0xffff0000, v188
v_pk_mul_f32 v[60:61], v[60:61], v[194:195]
v_pk_mul_f32 v[62:63], v[62:63], v[196:197]
v_pk_mul_f32 v[190:191], v[190:191], v[198:199]
v_pk_mul_f32 v[192:193], v[192:193], v[236:237]
s_mov_b32 exec_hi, 0xff
v_cvt_pk_bf16_f32 v238, v192, v190
v_cvt_pk_bf16_f32 v239, v62, v60
ds_write_b64 v202, v[238:239] offset:576
v_cvt_pk_bf16_f32 v240, v193, v191
v_cvt_pk_bf16_f32 v241, v63, v61
ds_write_b64 v202, v[240:241] offset:720
s_mov_b64 exec, -1
v_lshlrev_b32 v194, 16, v11
v_and_b32 v195, 0xffff0000, v11
v_lshlrev_b32 v196, 16, v15
v_and_b32 v197, 0xffff0000, v15
v_lshlrev_b32 v198, 16, v19
v_and_b32 v199, 0xffff0000, v19
v_lshlrev_b32 v236, 16, v23
v_and_b32 v237, 0xffff0000, v23
v_lshlrev_b32 v238, 16, v27
v_and_b32 v239, 0xffff0000, v27
v_lshlrev_b32 v240, 16, v31
v_and_b32 v241, 0xffff0000, v31
v_lshlrev_b32 v242, 16, v35
v_and_b32 v243, 0xffff0000, v35
v_lshlrev_b32 v52, 16, v48
v_lshlrev_b32 v53, 16, v50
v_and_b32 v54, 0xffff0000, v48
v_and_b32 v55, 0xffff0000, v50
v_lshlrev_b32 v56, 16, v49
v_lshlrev_b32 v57, 16, v51
v_and_b32 v58, 0xffff0000, v49
v_and_b32 v59, 0xffff0000, v51
v_pk_mul_f32 v[60:61], v[236:237], v[52:53]
v_pk_mul_f32 v[62:63], v[238:239], v[52:53]
v_pk_mul_f32 v[190:191], v[240:241], v[52:53]
v_pk_mul_f32 v[192:193], v[242:243], v[52:53]
v_pk_fma_f32 v[60:61], v[198:199], v[54:55], v[60:61]
v_pk_fma_f32 v[62:63], v[236:237], v[54:55], v[62:63]
v_pk_fma_f32 v[190:191], v[238:239], v[54:55], v[190:191]
v_pk_fma_f32 v[192:193], v[240:241], v[54:55], v[192:193]
v_pk_fma_f32 v[60:61], v[196:197], v[56:57], v[60:61]
v_pk_fma_f32 v[62:63], v[198:199], v[56:57], v[62:63]
v_pk_fma_f32 v[190:191], v[236:237], v[56:57], v[190:191]
v_pk_fma_f32 v[192:193], v[238:239], v[56:57], v[192:193]
v_pk_fma_f32 v[60:61], v[194:195], v[58:59], v[60:61]
v_pk_fma_f32 v[62:63], v[196:197], v[58:59], v[62:63]
v_pk_fma_f32 v[190:191], v[198:199], v[58:59], v[190:191]
v_pk_fma_f32 v[192:193], v[236:237], v[58:59], v[192:193]
v_lshlrev_b32 v194, 16, v177
v_and_b32 v195, 0xffff0000, v177
v_lshlrev_b32 v196, 16, v181
v_and_b32 v197, 0xffff0000, v181
v_lshlrev_b32 v198, 16, v185
v_and_b32 v199, 0xffff0000, v185
v_lshlrev_b32 v236, 16, v189
v_and_b32 v237, 0xffff0000, v189
v_pk_mul_f32 v[60:61], v[60:61], v[194:195]
v_pk_mul_f32 v[62:63], v[62:63], v[196:197]
v_pk_mul_f32 v[190:191], v[190:191], v[198:199]
v_pk_mul_f32 v[192:193], v[192:193], v[236:237]
s_mov_b32 exec_hi, 0xff
v_cvt_pk_bf16_f32 v238, v192, v190
v_cvt_pk_bf16_f32 v239, v62, v60
ds_write_b64 v202, v[238:239] offset:864
v_cvt_pk_bf16_f32 v240, v193, v191
v_cvt_pk_bf16_f32 v241, v63, v61
ds_write_b64 v202, v[240:241] offset:1008
s_mov_b64 exec, -1
s_add_u32 m0, s81, 32768
s_add_u32 s79, s79, 221184
buffer_load_dwordx4 v208, s[20:23], s79 offen offset:0 lds
buffer_load_dwordx4 v209, s[20:23], s79 offen offset:1024 lds
buffer_load_dwordx4 v210, s[20:23], s79 offen offset:2048 lds
buffer_load_dwordx4 v211, s[20:23], s79 offen offset:3072 lds
s_add_u32 m0, s81, 49152
s_add_u32 s80, s80, 128
buffer_load_dwordx4 v212, s[8:11], s80 offen offset:0 lds
buffer_load_dwordx4 v213, s[8:11], s80 offen offset:1024 lds
buffer_load_dwordx4 v214, s[8:11], s80 offen offset:2048 lds
buffer_load_dwordx4 v215, s[8:11], s80 offen offset:3072 lds
s_waitcnt vmcnt(10)
s_waitcnt lgkmcnt(0)
s_barrier
ds_read_b64_tr_b16 v[128:129], v216 offset:0
ds_read_b64_tr_b16 v[130:131], v216 offset:1024
ds_read_b128 v[136:139], v220 offset:16384
ds_read_b128 v[140:143], v220 offset:20480
ds_read_b64_tr_b16 v[132:133], v217 offset:0
ds_read_b64_tr_b16 v[134:135], v217 offset:1024
ds_read_b128 v[8:11], v203 offset:0
ds_read_b128 v[12:15], v203 offset:1152
ds_read_b128 v[16:19], v203 offset:2304
s_waitcnt lgkmcnt(6)
v_mfma_f32_32x32x16_bf16 v[64:79], v[128:131], v[136:139], 0
ds_read_b64_tr_b16 v[144:145], v216 offset:4096
ds_read_b64_tr_b16 v[146:147], v216 offset:5120
s_add_u32 m0, s81, 65536
s_add_u32 s79, s79, 221184
buffer_load_dwordx4 v208, s[20:23], s79 offen offset:0 lds
s_waitcnt lgkmcnt(7)
v_mfma_f32_32x32x16_bf16 v[80:95], v[128:131], v[140:143], 0
ds_read_b128 v[152:155], v221 offset:16384
ds_read_b128 v[156:159], v221 offset:20480
buffer_load_dwordx4 v209, s[20:23], s79 offen offset:1024 lds
v_mfma_f32_16x16x32_bf16 v[164:167], v[160:163], v[128:131], 0
s_waitcnt lgkmcnt(7)
v_mfma_f32_32x32x16_bf16 v[96:111], v[132:135], v[136:139], 0
ds_read_b64_tr_b16 v[148:149], v217 offset:4096
ds_read_b64_tr_b16 v[150:151], v217 offset:5120
buffer_load_dwordx4 v210, s[20:23], s79 offen offset:2048 lds
v_mfma_f32_32x32x16_bf16 v[112:127], v[132:135], v[140:143], 0
buffer_load_dwordx4 v211, s[20:23], s79 offen offset:3072 lds
v_mfma_f32_16x16x32_bf16 v[168:171], v[160:163], v[132:135], 0
s_waitcnt lgkmcnt(3)
v_mfma_f32_32x32x16_bf16 v[64:79], v[144:147], v[152:155], v[64:79]
ds_read_b64_tr_b16 v[128:129], v216 offset:8192
ds_read_b64_tr_b16 v[130:131], v216 offset:9216
s_add_u32 m0, s81, 81920
s_add_u32 s80, s80, 128
buffer_load_dwordx4 v212, s[8:11], s80 offen offset:0 lds
s_waitcnt lgkmcnt(4)
v_mfma_f32_32x32x16_bf16 v[80:95], v[144:147], v[156:159], v[80:95]
ds_read_b128 v[136:139], v222 offset:16384
ds_read_b128 v[140:143], v222 offset:20480
buffer_load_dwordx4 v213, s[8:11], s80 offen offset:1024 lds
v_mfma_f32_16x16x32_bf16 v[164:167], v[160:163], v[144:147], v[164:167]
s_waitcnt lgkmcnt(4)
v_mfma_f32_32x32x16_bf16 v[96:111], v[148:151], v[152:155], v[96:111]
ds_read_b64_tr_b16 v[132:133], v217 offset:8192
ds_read_b64_tr_b16 v[134:135], v217 offset:9216
buffer_load_dwordx4 v214, s[8:11], s80 offen offset:2048 lds
v_mfma_f32_32x32x16_bf16 v[112:127], v[148:151], v[156:159], v[112:127]
buffer_load_dwordx4 v215, s[8:11], s80 offen offset:3072 lds
v_mfma_f32_16x16x32_bf16 v[168:171], v[160:163], v[148:151], v[168:171]
s_waitcnt lgkmcnt(3)
v_mfma_f32_32x32x16_bf16 v[64:79], v[128:131], v[136:139], v[64:79]
ds_read_b64_tr_b16 v[144:145], v216 offset:12288
ds_read_b64_tr_b16 v[146:147], v216 offset:13312
s_waitcnt vmcnt(8)
s_cmp_eq_u32 s82, 0
s_cbranch_scc0 L_nb_3
s_barrier
L_nb_3:
s_waitcnt lgkmcnt(4)
v_mfma_f32_32x32x16_bf16 v[80:95], v[128:131], v[140:143], v[80:95]
ds_read_b128 v[152:155], v223 offset:16384
ds_read_b128 v[156:159], v223 offset:20480
s_cmp_eq_u32 s82, 1
s_cbranch_scc0 L_nb_4
s_barrier
L_nb_4:
v_mfma_f32_16x16x32_bf16 v[164:167], v[160:163], v[128:131], v[164:167]
s_waitcnt lgkmcnt(4)
v_mfma_f32_32x32x16_bf16 v[96:111], v[132:135], v[136:139], v[96:111]
ds_read_b64_tr_b16 v[148:149], v217 offset:12288
ds_read_b64_tr_b16 v[150:151], v217 offset:13312
s_add_u32 m0, s81, 98304
s_add_u32 s79, s79, 221184
buffer_load_dwordx4 v208, s[20:23], s79 offen offset:0 lds
v_mfma_f32_32x32x16_bf16 v[112:127], v[132:135], v[140:143], v[112:127]
buffer_store_dwordx4 v[8:11], v172, s[24:27], s70 offen sc1
v_mfma_f32_16x16x32_bf16 v[168:171], v[160:163], v[132:135], v[168:171]
s_waitcnt lgkmcnt(3)
v_mfma_f32_32x32x16_bf16 v[64:79], v[144:147], v[152:155], v[64:79]
ds_read_b64_tr_b16 v[128:129], v216 offset:32768
ds_read_b64_tr_b16 v[130:131], v216 offset:33792
buffer_load_dwordx4 v209, s[20:23], s79 offen offset:1024 lds
s_waitcnt lgkmcnt(4)
v_mfma_f32_32x32x16_bf16 v[80:95], v[144:147], v[156:159], v[80:95]
ds_read_b128 v[136:139], v220 offset:49152
ds_read_b128 v[140:143], v220 offset:53248
v_mfma_f32_16x16x32_bf16 v[164:167], v[160:163], v[144:147], v[164:167]
s_waitcnt lgkmcnt(4)
v_mfma_f32_32x32x16_bf16 v[96:111], v[148:151], v[152:155], v[96:111]
ds_read_b64_tr_b16 v[132:133], v217 offset:32768
ds_read_b64_tr_b16 v[134:135], v217 offset:33792
buffer_load_dwordx4 v210, s[20:23], s79 offen offset:2048 lds
v_mfma_f32_32x32x16_bf16 v[112:127], v[148:151], v[156:159], v[112:127]
v_mfma_f32_16x16x32_bf16 v[168:171], v[160:163], v[148:151], v[168:171]
s_waitcnt lgkmcnt(3)
v_mfma_f32_32x32x16_bf16 v[64:79], v[128:131], v[136:139], v[64:79]
ds_read_b64_tr_b16 v[144:145], v216 offset:36864
ds_read_b64_tr_b16 v[146:147], v216 offset:37888
buffer_load_dwordx4 v211, s[20:23], s79 offen offset:3072 lds
s_waitcnt lgkmcnt(4)
v_mfma_f32_32x32x16_bf16 v[80:95], v[128:131], v[140:143], v[80:95]
ds_read_b128 v[152:155], v221 offset:49152
ds_read_b128 v[156:159], v221 offset:53248
v_mfma_f32_16x16x32_bf16 v[164:167], v[160:163], v[128:131], v[164:167]
s_waitcnt lgkmcnt(4)
v_mfma_f32_32x32x16_bf16 v[96:111], v[132:135], v[136:139], v[96:111]
ds_read_b64_tr_b16 v[148:149], v217 offset:36864
ds_read_b64_tr_b16 v[150:151], v217 offset:37888
s_add_u32 m0, s81, 114688
s_add_u32 s80, s80, 128
buffer_load_dwordx4 v212, s[8:11], s80 offen offset:0 lds
v_mfma_f32_32x32x16_bf16 v[112:127], v[132:135], v[140:143], v[112:127]
buffer_store_dwordx4 v[12:15], v172, s[24:27], s71 offen sc1
v_mfma_f32_16x16x32_bf16 v[168:171], v[160:163], v[132:135], v[168:171]
s_waitcnt lgkmcnt(3)
v_mfma_f32_32x32x16_bf16 v[64:79], v[144:147], v[152:155], v[64:79]
ds_read_b64_tr_b16 v[128:129], v216 offset:40960
ds_read_b64_tr_b16 v[130:131], v216 offset:41984
buffer_load_dwordx4 v213, s[8:11], s80 offen offset:1024 lds
s_waitcnt lgkmcnt(4)
v_mfma_f32_32x32x16_bf16 v[80:95], v[144:147], v[156:159], v[80:95]
ds_read_b128 v[136:139], v222 offset:49152
ds_read_b128 v[140:143], v222 offset:53248
v_mfma_f32_16x16x32_bf16 v[164:167], v[160:163], v[144:147], v[164:167]
s_waitcnt lgkmcnt(4)
v_mfma_f32_32x32x16_bf16 v[96:111], v[148:151], v[152:155], v[96:111]
ds_read_b64_tr_b16 v[132:133], v217 offset:40960
ds_read_b64_tr_b16 v[134:135], v217 offset:41984
buffer_load_dwordx4 v214, s[8:11], s80 offen offset:2048 lds
v_mfma_f32_32x32x16_bf16 v[112:127], v[148:151], v[156:159], v[112:127]
v_mfma_f32_16x16x32_bf16 v[168:171], v[160:163], v[148:151], v[168:171]
s_waitcnt lgkmcnt(3)
v_mfma_f32_32x32x16_bf16 v[64:79], v[128:131], v[136:139], v[64:79]
ds_read_b64_tr_b16 v[144:145], v216 offset:45056
ds_read_b64_tr_b16 v[146:147], v216 offset:46080
s_waitcnt vmcnt(9)
s_cmp_eq_u32 s82, 0
s_cbranch_scc0 L_nb_5
s_barrier
L_nb_5:
buffer_load_dwordx4 v215, s[8:11], s80 offen offset:3072 lds
s_waitcnt lgkmcnt(4)
v_mfma_f32_32x32x16_bf16 v[80:95], v[128:131], v[140:143], v[80:95]
ds_read_b128 v[152:155], v223 offset:49152
ds_read_b128 v[156:159], v223 offset:53248
s_cmp_eq_u32 s82, 1
s_cbranch_scc0 L_nb_6
s_barrier
L_nb_6:
v_mfma_f32_16x16x32_bf16 v[164:167], v[160:163], v[128:131], v[164:167]
s_waitcnt lgkmcnt(4)
v_mfma_f32_32x32x16_bf16 v[96:111], v[132:135], v[136:139], v[96:111]
ds_read_b64_tr_b16 v[148:149], v217 offset:45056
ds_read_b64_tr_b16 v[150:151], v217 offset:46080
s_add_u32 m0, s81, 0
s_add_u32 s79, s79, 221184
buffer_load_dwordx4 v208, s[20:23], s79 offen offset:0 lds
v_mfma_f32_32x32x16_bf16 v[112:127], v[132:135], v[140:143], v[112:127]
s_mov_b32 exec_hi, 0
buffer_store_dwordx4 v[16:19], v172, s[24:27], s72 offen sc1
s_mov_b64 exec, -1
v_mfma_f32_16x16x32_bf16 v[168:171], v[160:163], v[132:135], v[168:171]
s_waitcnt lgkmcnt(3)
v_mfma_f32_32x32x16_bf16 v[64:79], v[144:147], v[152:155], v[64:79]
ds_read_b64_tr_b16 v[128:129], v218 offset:0
ds_read_b64_tr_b16 v[130:131], v218 offset:1024
buffer_load_dwordx4 v209, s[20:23], s79 offen offset:1024 lds
s_waitcnt lgkmcnt(4)
v_mfma_f32_32x32x16_bf16 v[80:95], v[144:147], v[156:159], v[80:95]
ds_read_b128 v[136:139], v224 offset:16384
ds_read_b128 v[140:143], v224 offset:20480
v_mfma_f32_16x16x32_bf16 v[164:167], v[160:163], v[144:147], v[164:167]
s_waitcnt lgkmcnt(4)
v_mfma_f32_32x32x16_bf16 v[96:111], v[148:151], v[152:155], v[96:111]
ds_read_b64_tr_b16 v[132:133], v219 offset:0
ds_read_b64_tr_b16 v[134:135], v219 offset:1024
buffer_load_dwordx4 v210, s[20:23], s79 offen offset:2048 lds
v_mfma_f32_32x32x16_bf16 v[112:127], v[148:151], v[156:159], v[112:127]
v_mfma_f32_16x16x32_bf16 v[168:171], v[160:163], v[148:151], v[168:171]
s_waitcnt lgkmcnt(3)
v_mfma_f32_32x32x16_bf16 v[64:79], v[128:131], v[136:139], v[64:79]
ds_read_b64_tr_b16 v[144:145], v218 offset:4096
ds_read_b64_tr_b16 v[146:147], v218 offset:5120
buffer_load_dwordx4 v211, s[20:23], s79 offen offset:3072 lds
s_waitcnt lgkmcnt(4)
v_mfma_f32_32x32x16_bf16 v[80:95], v[128:131], v[140:143], v[80:95]
ds_read_b128 v[152:155], v225 offset:16384
ds_read_b128 v[156:159], v225 offset:20480
v_mfma_f32_16x16x32_bf16 v[164:167], v[160:163], v[128:131], v[164:167]
s_waitcnt lgkmcnt(4)
v_mfma_f32_32x32x16_bf16 v[96:111], v[132:135], v[136:139], v[96:111]
ds_read_b64_tr_b16 v[148:149], v219 offset:4096
ds_read_b64_tr_b16 v[150:151], v219 offset:5120
s_add_u32 m0, s81, 16384
s_add_u32 s80, s80, 128
buffer_load_dwordx4 v212, s[8:11], s80 offen offset:0 lds
v_mfma_f32_32x32x16_bf16 v[112:127], v[132:135], v[140:143], v[112:127]
v_mfma_f32_16x16x32_bf16 v[168:171], v[160:163], v[132:135], v[168:171]
s_waitcnt lgkmcnt(3)
v_mfma_f32_32x32x16_bf16 v[64:79], v[144:147], v[152:155], v[64:79]
ds_read_b64_tr_b16 v[128:129], v218 offset:8192
ds_read_b64_tr_b16 v[130:131], v218 offset:9216
buffer_load_dwordx4 v213, s[8:11], s80 offen offset:1024 lds
s_waitcnt lgkmcnt(4)
v_mfma_f32_32x32x16_bf16 v[80:95], v[144:147], v[156:159], v[80:95]
ds_read_b128 v[136:139], v226 offset:16384
ds_read_b128 v[140:143], v226 offset:20480
v_mfma_f32_16x16x32_bf16 v[164:167], v[160:163], v[144:147], v[164:167]
s_waitcnt lgkmcnt(4)
v_mfma_f32_32x32x16_bf16 v[96:111], v[148:151], v[152:155], v[96:111]
ds_read_b64_tr_b16 v[132:133], v219 offset:8192
ds_read_b64_tr_b16 v[134:135], v219 offset:9216
buffer_load_dwordx4 v214, s[8:11], s80 offen offset:2048 lds
v_mfma_f32_32x32x16_bf16 v[112:127], v[148:151], v[156:159], v[112:127]
buffer_load_dword v254, v230, s[52:55], 0 offen sc1
v_mfma_f32_16x16x32_bf16 v[168:171], v[160:163], v[148:151], v[168:171]
s_waitcnt lgkmcnt(3)
v_mfma_f32_32x32x16_bf16 v[64:79], v[128:131], v[136:139], v[64:79]
ds_read_b64_tr_b16 v[144:145], v218 offset:12288
ds_read_b64_tr_b16 v[146:147], v218 offset:13312
s_waitcnt vmcnt(9)
s_cmp_eq_u32 s82, 0
s_cbranch_scc0 L_nb_7
s_barrier
L_nb_7:
buffer_load_dwordx4 v215, s[8:11], s80 offen offset:3072 lds
s_waitcnt lgkmcnt(4)
v_mfma_f32_32x32x16_bf16 v[80:95], v[128:131], v[140:143], v[80:95]
ds_read_b128 v[152:155], v227 offset:16384
ds_read_b128 v[156:159], v227 offset:20480
s_cmp_eq_u32 s82, 1
s_cbranch_scc0 L_nb_8
s_barrier
L_nb_8:
v_mfma_f32_16x16x32_bf16 v[164:167], v[160:163], v[128:131], v[164:167]
s_waitcnt lgkmcnt(4)
v_mfma_f32_32x32x16_bf16 v[96:111], v[132:135], v[136:139], v[96:111]
ds_read_b64_tr_b16 v[148:149], v219 offset:12288
ds_read_b64_tr_b16 v[150:151], v219 offset:13312
s_add_u32 m0, s81, 32768
s_add_u32 s79, s79, 221184
buffer_load_dwordx4 v208, s[20:23], s79 offen offset:0 lds
v_mfma_f32_32x32x16_bf16 v[112:127], v[132:135], v[140:143], v[112:127]
v_mfma_f32_16x16x32_bf16 v[168:171], v[160:163], v[132:135], v[168:171]
s_waitcnt lgkmcnt(3)
v_mfma_f32_32x32x16_bf16 v[64:79], v[144:147], v[152:155], v[64:79]
ds_read_b64_tr_b16 v[128:129], v218 offset:32768
ds_read_b64_tr_b16 v[130:131], v218 offset:33792
buffer_load_dwordx4 v209, s[20:23], s79 offen offset:1024 lds
s_waitcnt lgkmcnt(4)
v_mfma_f32_32x32x16_bf16 v[80:95], v[144:147], v[156:159], v[80:95]
ds_read_b128 v[136:139], v224 offset:49152
ds_read_b128 v[140:143], v224 offset:53248
v_mfma_f32_16x16x32_bf16 v[164:167], v[160:163], v[144:147], v[164:167]
s_waitcnt lgkmcnt(4)
v_mfma_f32_32x32x16_bf16 v[96:111], v[148:151], v[152:155], v[96:111]
ds_read_b64_tr_b16 v[132:133], v219 offset:32768
ds_read_b64_tr_b16 v[134:135], v219 offset:33792
buffer_load_dwordx4 v210, s[20:23], s79 offen offset:2048 lds
v_mfma_f32_32x32x16_bf16 v[112:127], v[148:151], v[156:159], v[112:127]
v_mfma_f32_16x16x32_bf16 v[168:171], v[160:163], v[148:151], v[168:171]
s_waitcnt lgkmcnt(3)
v_mfma_f32_32x32x16_bf16 v[64:79], v[128:131], v[136:139], v[64:79]
ds_read_b64_tr_b16 v[144:145], v218 offset:36864
ds_read_b64_tr_b16 v[146:147], v218 offset:37888
buffer_load_dwordx4 v211, s[20:23], s79 offen offset:3072 lds
s_waitcnt lgkmcnt(4)
v_mfma_f32_32x32x16_bf16 v[80:95], v[128:131], v[140:143], v[80:95]
ds_read_b128 v[152:155], v225 offset:49152
ds_read_b128 v[156:159], v225 offset:53248
s_mov_b32 m0, s74
s_nop 0
buffer_load_dwordx4 v204, s[36:39], 0 offen lds
s_mov_b32 m0, s74
s_nop 0
buffer_load_dwordx4 v205, s[36:39], 0 offen offset:1024 lds
s_mov_b32 m0, s74
s_mov_b32 exec_hi, 0
buffer_load_dwordx4 v206, s[36:39], 0 offen offset:2048 lds
s_mov_b64 exec, -1
v_mfma_f32_16x16x32_bf16 v[164:167], v[160:163], v[128:131], v[164:167]
s_waitcnt lgkmcnt(4)
v_mfma_f32_32x32x16_bf16 v[96:111], v[132:135], v[136:139], v[96:111]
ds_read_b64_tr_b16 v[148:149], v219 offset:36864
ds_read_b64_tr_b16 v[150:151], v219 offset:37888
s_add_u32 m0, s81, 49152
s_add_u32 s80, s80, 128
buffer_load_dwordx4 v212, s[8:11], s80 offen offset:0 lds
v_mfma_f32_32x32x16_bf16 v[112:127], v[132:135], v[140:143], v[112:127]
v_mfma_f32_16x16x32_bf16 v[168:171], v[160:163], v[132:135], v[168:171]
s_waitcnt lgkmcnt(3)
v_mfma_f32_32x32x16_bf16 v[64:79], v[144:147], v[152:155], v[64:79]
ds_read_b64_tr_b16 v[128:129], v218 offset:40960
ds_read_b64_tr_b16 v[130:131], v218 offset:41984
buffer_load_dwordx4 v213, s[8:11], s80 offen offset:1024 lds
s_waitcnt lgkmcnt(4)
v_mfma_f32_32x32x16_bf16 v[80:95], v[144:147], v[156:159], v[80:95]
ds_read_b128 v[136:139], v226 offset:49152
ds_read_b128 v[140:143], v226 offset:53248
v_mfma_f32_16x16x32_bf16 v[164:167], v[160:163], v[144:147], v[164:167]
s_waitcnt lgkmcnt(4)
v_mfma_f32_32x32x16_bf16 v[96:111], v[148:151], v[152:155], v[96:111]
ds_read_b64_tr_b16 v[132:133], v219 offset:40960
ds_read_b64_tr_b16 v[134:135], v219 offset:41984
buffer_load_dwordx4 v214, s[8:11], s80 offen offset:2048 lds
v_mfma_f32_32x32x16_bf16 v[112:127], v[148:151], v[156:159], v[112:127]
v_mfma_f32_16x16x32_bf16 v[168:171], v[160:163], v[148:151], v[168:171]
s_waitcnt lgkmcnt(3)
v_mfma_f32_32x32x16_bf16 v[64:79], v[128:131], v[136:139], v[64:79]
ds_read_b64_tr_b16 v[144:145], v218 offset:45056
ds_read_b64_tr_b16 v[146:147], v218 offset:46080
s_waitcnt vmcnt(10)
s_cmp_eq_u32 s82, 0
s_cbranch_scc0 L_nb_9
s_barrier
L_nb_9:
buffer_load_dwordx4 v215, s[8:11], s80 offen offset:3072 lds
s_waitcnt lgkmcnt(4)
v_mfma_f32_32x32x16_bf16 v[80:95], v[128:131], v[140:143], v[80:95]
ds_read_b128 v[152:155], v227 offset:49152
ds_read_b128 v[156:159], v227 offset:53248
s_cmp_eq_u32 s82, 1
s_cbranch_scc0 L_nb_10
s_barrier
L_nb_10:
s_mov_b32 exec_lo, 0x0
s_mov_b32 exec_hi, 0xff000000
buffer_load_dword v234, v232, s[20:23], 0 offen
s_mov_b64 exec, -1
s_mov_b32 s6, 1769472
s_mov_b32 exec_lo, 0xffff
s_mov_b32 exec_hi, 0x0
buffer_load_dword v234, v232, s[20:23], s6 offen
s_mov_b64 exec, -1
s_mov_b32 exec_lo, 0x0
s_mov_b32 exec_hi, 0x3fff8
buffer_load_dword v234, v233, s[8:11], 0 offen
s_mov_b64 exec, -1
v_mfma_f32_16x16x32_bf16 v[164:167], v[160:163], v[128:131], v[164:167]
s_waitcnt lgkmcnt(4)
v_mfma_f32_32x32x16_bf16 v[96:111], v[132:135], v[136:139], v[96:111]
ds_read_b64_tr_b16 v[148:149], v219 offset:45056
ds_read_b64_tr_b16 v[150:151], v219 offset:46080
s_add_u32 m0, s81, 65536
s_add_u32 s79, s79, 221184
buffer_load_dwordx4 v208, s[20:23], s79 offen offset:0 lds
v_mfma_f32_32x32x16_bf16 v[112:127], v[132:135], v[140:143], v[112:127]
v_mfma_f32_16x16x32_bf16 v[168:171], v[160:163], v[132:135], v[168:171]
s_waitcnt lgkmcnt(3)
v_mfma_f32_32x32x16_bf16 v[64:79], v[144:147], v[152:155], v[64:79]
ds_read_b64_tr_b16 v[128:129], v216 offset:0
ds_read_b64_tr_b16 v[130:131], v216 offset:1024
buffer_load_dwordx4 v209, s[20:23], s79 offen offset:1024 lds
s_waitcnt lgkmcnt(4)
v_mfma_f32_32x32x16_bf16 v[80:95], v[144:147], v[156:159], v[80:95]
ds_read_b128 v[136:139], v220 offset:16384
ds_read_b128 v[140:143], v220 offset:20480
v_mfma_f32_16x16x32_bf16 v[164:167], v[160:163], v[144:147], v[164:167]
s_waitcnt lgkmcnt(4)
v_mfma_f32_32x32x16_bf16 v[96:111], v[148:151], v[152:155], v[96:111]
ds_read_b64_tr_b16 v[132:133], v217 offset:0
ds_read_b64_tr_b16 v[134:135], v217 offset:1024
buffer_load_dwordx4 v210, s[20:23], s79 offen offset:2048 lds
v_mfma_f32_32x32x16_bf16 v[112:127], v[148:151], v[156:159], v[112:127]
v_mfma_f32_16x16x32_bf16 v[168:171], v[160:163], v[148:151], v[168:171]
s_waitcnt lgkmcnt(3)
v_mfma_f32_32x32x16_bf16 v[64:79], v[128:131], v[136:139], v[64:79]
ds_read_b64_tr_b16 v[144:145], v216 offset:4096
ds_read_b64_tr_b16 v[146:147], v216 offset:5120
buffer_load_dwordx4 v211, s[20:23], s79 offen offset:3072 lds
s_waitcnt lgkmcnt(4)
v_mfma_f32_32x32x16_bf16 v[80:95], v[128:131], v[140:143], v[80:95]
ds_read_b128 v[152:155], v221 offset:16384
ds_read_b128 v[156:159], v221 offset:20480
v_mfma_f32_16x16x32_bf16 v[164:167], v[160:163], v[128:131], v[164:167]
s_waitcnt lgkmcnt(4)
v_mfma_f32_32x32x16_bf16 v[96:111], v[132:135], v[136:139], v[96:111]
ds_read_b64_tr_b16 v[148:149], v217 offset:4096
ds_read_b64_tr_b16 v[150:151], v217 offset:5120
s_add_u32 m0, s81, 81920
s_add_u32 s80, s80, 128
buffer_load_dwordx4 v212, s[8:11], s80 offen offset:0 lds
v_mfma_f32_32x32x16_bf16 v[112:127], v[132:135], v[140:143], v[112:127]
v_mfma_f32_16x16x32_bf16 v[168:171], v[160:163], v[132:135], v[168:171]
s_waitcnt lgkmcnt(3)
v_mfma_f32_32x32x16_bf16 v[64:79], v[144:147], v[152:155], v[64:79]
ds_read_b64_tr_b16 v[128:129], v216 offset:8192
ds_read_b64_tr_b16 v[130:131], v216 offset:9216
buffer_load_dwordx4 v213, s[8:11], s80 offen offset:1024 lds
s_waitcnt lgkmcnt(4)
v_mfma_f32_32x32x16_bf16 v[80:95], v[144:147], v[156:159], v[80:95]
ds_read_b128 v[136:139], v222 offset:16384
ds_read_b128 v[140:143], v222 offset:20480
v_mfma_f32_16x16x32_bf16 v[164:167], v[160:163], v[144:147], v[164:167]
s_waitcnt lgkmcnt(4)
v_mfma_f32_32x32x16_bf16 v[96:111], v[148:151], v[152:155], v[96:111]
ds_read_b64_tr_b16 v[132:133], v217 offset:8192
ds_read_b64_tr_b16 v[134:135], v217 offset:9216
buffer_load_dwordx4 v214, s[8:11], s80 offen offset:2048 lds
v_mfma_f32_32x32x16_bf16 v[112:127], v[148:151], v[156:159], v[112:127]
v_mfma_f32_16x16x32_bf16 v[168:171], v[160:163], v[148:151], v[168:171]
s_waitcnt lgkmcnt(3)
v_mfma_f32_32x32x16_bf16 v[64:79], v[128:131], v[136:139], v[64:79]
ds_read_b64_tr_b16 v[144:145], v216 offset:12288
ds_read_b64_tr_b16 v[146:147], v216 offset:13312
s_waitcnt vmcnt(10)
s_cmp_lg_u32 s5, 0
s_cbranch_scc1 L_back_12
v_cmp_gt_u32 vcc, 32, v254
s_cbranch_vccnz L_slow_11
L_back_12:
s_cmp_eq_u32 s82, 0
s_cbranch_scc0 L_nb_13
s_barrier
L_nb_13:
buffer_load_dwordx4 v215, s[8:11], s80 offen offset:3072 lds
s_waitcnt lgkmcnt(4)
v_mfma_f32_32x32x16_bf16 v[80:95], v[128:131], v[140:143], v[80:95]
ds_read_b128 v[152:155], v223 offset:16384
ds_read_b128 v[156:159], v223 offset:20480
s_cmp_eq_u32 s82, 1
s_cbranch_scc0 L_nb_14
s_barrier
L_nb_14:
s_cmp_lg_u32 s5, 0
s_cbranch_scc1 L_fl_15
s_mov_b64 exec, 1
buffer_store_dword v253, v252, s[24:27], 0 offen offset:0 sc1
s_mov_b64 exec, -1
L_fl_15:
v_mfma_f32_16x16x32_bf16 v[164:167], v[160:163], v[128:131], v[164:167]
s_waitcnt lgkmcnt(4)
v_mfma_f32_32x32x16_bf16 v[96:111], v[132:135], v[136:139], v[96:111]
ds_read_b64_tr_b16 v[148:149], v217 offset:12288
ds_read_b64_tr_b16 v[150:151], v217 offset:13312
s_add_u32 m0, s81, 98304
s_add_u32 s79, s79, 221184
buffer_load_dwordx4 v208, s[20:23], s79 offen offset:0 lds
v_mfma_f32_32x32x16_bf16 v[112:127], v[132:135], v[140:143], v[112:127]
v_mfma_f32_16x16x32_bf16 v[168:171], v[160:163], v[132:135], v[168:171]
s_waitcnt lgkmcnt(3)
v_mfma_f32_32x32x16_bf16 v[64:79], v[144:147], v[152:155], v[64:79]
ds_read_b64_tr_b16 v[128:129], v216 offset:32768
ds_read_b64_tr_b16 v[130:131], v216 offset:33792
buffer_load_dwordx4 v209, s[20:23], s79 offen offset:1024 lds
ds_read_b64_tr_b16 v[174:175], v200
ds_read_b64_tr_b16 v[176:177], v200 offset:2560
s_waitcnt lgkmcnt(6)
v_mfma_f32_32x32x16_bf16 v[80:95], v[144:147], v[156:159], v[80:95]
ds_read_b128 v[136:139], v220 offset:49152
ds_read_b128 v[140:143], v220 offset:53248
ds_read_b64_tr_b16 v[178:179], v201
ds_read_b64_tr_b16 v[180:181], v201 offset:2560
v_mfma_f32_16x16x32_bf16 v[164:167], v[160:163], v[144:147], v[164:167]
s_waitcnt lgkmcnt(8)
v_mfma_f32_32x32x16_bf16 v[96:111], v[148:151], v[152:155], v[96:111]
ds_read_b64_tr_b16 v[132:133], v217 offset:32768
ds_read_b64_tr_b16 v[134:135], v217 offset:33792
buffer_load_dwordx4 v210, s[20:23], s79 offen offset:2048 lds
ds_read_b64_tr_b16 v[182:183], v246
ds_read_b64_tr_b16 v[184:185], v246 offset:2560
v_mfma_f32_32x32x16_bf16 v[112:127], v[148:151], v[156:159], v[112:127]
v_mfma_f32_16x16x32_bf16 v[168:171], v[160:163], v[148:151], v[168:171]
s_waitcnt lgkmcnt(7)
v_mfma_f32_32x32x16_bf16 v[64:79], v[128:131], v[136:139], v[64:79]
ds_read_b64_tr_b16 v[144:145], v216 offset:36864
ds_read_b64_tr_b16 v[146:147], v216 offset:37888
buffer_load_dwordx4 v211, s[20:23], s79 offen offset:3072 lds
s_waitcnt lgkmcnt(8)
v_mfma_f32_32x32x16_bf16 v[80:95], v[128:131], v[140:143], v[80:95]
ds_read_b128 v[152:155], v221 offset:49152
ds_read_b128 v[156:159], v221 offset:53248
v_mfma_f32_16x16x32_bf16 v[164:167], v[160:163], v[128:131], v[164:167]
s_waitcnt lgkmcnt(6)
v_mfma_f32_32x32x16_bf16 v[96:111], v[132:135], v[136:139], v[96:111]
ds_read_b64_tr_b16 v[148:149], v217 offset:36864
ds_read_b64_tr_b16 v[150:151], v217 offset:37888
s_add_u32 m0, s81, 114688
s_add_u32 s80, s80, 128
buffer_load_dwordx4 v212, s[8:11], s80 offen offset:0 lds
v_mfma_f32_32x32x16_bf16 v[112:127], v[132:135], v[140:143], v[112:127]
v_mfma_f32_16x16x32_bf16 v[168:171], v[160:163], v[132:135], v[168:171]
s_waitcnt lgkmcnt(3)
v_mfma_f32_32x32x16_bf16 v[64:79], v[144:147], v[152:155], v[64:79]
ds_read_b64_tr_b16 v[128:129], v216 offset:40960
ds_read_b64_tr_b16 v[130:131], v216 offset:41984
buffer_load_dwordx4 v213, s[8:11], s80 offen offset:1024 lds
s_waitcnt lgkmcnt(4)
v_mfma_f32_32x32x16_bf16 v[80:95], v[144:147], v[156:159], v[80:95]
ds_read_b128 v[136:139], v222 offset:49152
ds_read_b128 v[140:143], v222 offset:53248
v_mfma_f32_16x16x32_bf16 v[164:167], v[160:163], v[144:147], v[164:167]
s_waitcnt lgkmcnt(4)
v_mfma_f32_32x32x16_bf16 v[96:111], v[148:151], v[152:155], v[96:111]
ds_read_b64_tr_b16 v[132:133], v217 offset:40960
ds_read_b64_tr_b16 v[134:135], v217 offset:41984
buffer_load_dwordx4 v214, s[8:11], s80 offen offset:2048 lds
v_mfma_f32_32x32x16_bf16 v[112:127], v[148:151], v[156:159], v[112:127]
buffer_load_dword v254, v231, s[24:27], 0 offen sc1
v_mfma_f32_16x16x32_bf16 v[168:171], v[160:163], v[148:151], v[168:171]
s_waitcnt lgkmcnt(3)
v_mfma_f32_32x32x16_bf16 v[64:79], v[128:131], v[136:139], v[64:79]
ds_read_b64_tr_b16 v[144:145], v216 offset:45056
ds_read_b64_tr_b16 v[146:147], v216 offset:46080
s_waitcnt vmcnt(8)
s_cmp_eq_u32 s82, 0
s_cbranch_scc0 L_nb_16
s_barrier
L_nb_16:
buffer_load_dwordx4 v215, s[8:11], s80 offen offset:3072 lds
s_waitcnt lgkmcnt(4)
v_mfma_f32_32x32x16_bf16 v[80:95], v[128:131], v[140:143], v[80:95]
ds_read_b128 v[152:155], v223 offset:49152
ds_read_b128 v[156:159], v223 offset:53248
s_cmp_eq_u32 s82, 1
s_cbranch_scc0 L_nb_17
s_barrier
L_nb_17:
buffer_store_dwordx4 v[174:177], v207, s[24:27], s75 offen sc1
v_mfma_f32_16x16x32_bf16 v[164:167], v[160:163], v[128:131], v[164:167]
s_waitcnt lgkmcnt(4)
v_mfma_f32_32x32x16_bf16 v[96:111], v[132:135], v[136:139], v[96:111]
ds_read_b64_tr_b16 v[148:149], v217 offset:45056
ds_read_b64_tr_b16 v[150:151], v217 offset:46080
s_add_u32 m0, s81, 0
s_add_u32 s79, s79, 221184
buffer_load_dwordx4 v208, s[20:23], s79 offen offset:0 lds
buffer_store_dwordx4 v[178:181], v207, s[24:27], s76 offen sc1
v_mfma_f32_32x32x16_bf16 v[112:127], v[132:135], v[140:143], v[112:127]
v_mfma_f32_16x16x32_bf16 v[168:171], v[160:163], v[132:135], v[168:171]
s_waitcnt lgkmcnt(3)
v_mfma_f32_32x32x16_bf16 v[64:79], v[144:147], v[152:155], v[64:79]
ds_read_b64_tr_b16 v[128:129], v218 offset:0
ds_read_b64_tr_b16 v[130:131], v218 offset:1024
buffer_load_dwordx4 v209, s[20:23], s79 offen offset:1024 lds
s_waitcnt lgkmcnt(4)
v_mfma_f32_32x32x16_bf16 v[80:95], v[144:147], v[156:159], v[80:95]
ds_read_b128 v[136:139], v224 offset:16384
ds_read_b128 v[140:143], v224 offset:20480
v_mfma_f32_16x16x32_bf16 v[164:167], v[160:163], v[144:147], v[164:167]
s_waitcnt lgkmcnt(4)
v_mfma_f32_32x32x16_bf16 v[96:111], v[148:151], v[152:155], v[96:111]
ds_read_b64_tr_b16 v[132:133], v219 offset:0
ds_read_b64_tr_b16 v[134:135], v219 offset:1024
buffer_load_dwordx4 v210, s[20:23], s79 offen offset:2048 lds
v_mfma_f32_32x32x16_bf16 v[112:127], v[148:151], v[156:159], v[112:127]
v_mfma_f32_16x16x32_bf16 v[168:171], v[160:163], v[148:151], v[168:171]
s_waitcnt lgkmcnt(3)
v_mfma_f32_32x32x16_bf16 v[64:79], v[128:131], v[136:139], v[64:79]
ds_read_b64_tr_b16 v[144:145], v218 offset:4096
ds_read_b64_tr_b16 v[146:147], v218 offset:5120
buffer_load_dwordx4 v211, s[20:23], s79 offen offset:3072 lds
s_waitcnt lgkmcnt(4)
v_mfma_f32_32x32x16_bf16 v[80:95], v[128:131], v[140:143], v[80:95]
ds_read_b128 v[152:155], v225 offset:16384
ds_read_b128 v[156:159], v225 offset:20480
v_mfma_f32_16x16x32_bf16 v[164:167], v[160:163], v[128:131], v[164:167]
s_waitcnt lgkmcnt(4)
v_mfma_f32_32x32x16_bf16 v[96:111], v[132:135], v[136:139], v[96:111]
ds_read_b64_tr_b16 v[148:149], v219 offset:4096
ds_read_b64_tr_b16 v[150:151], v219 offset:5120
s_add_u32 m0, s81, 16384
s_add_u32 s80, s80, 128
buffer_load_dwordx4 v212, s[8:11], s80 offen offset:0 lds
v_mfma_f32_32x32x16_bf16 v[112:127], v[132:135], v[140:143], v[112:127]
v_mfma_f32_16x16x32_bf16 v[168:171], v[160:163], v[132:135], v[168:171]
s_waitcnt lgkmcnt(3)
v_mfma_f32_32x32x16_bf16 v[64:79], v[144:147], v[152:155], v[64:79]
ds_read_b64_tr_b16 v[128:129], v218 offset:8192
ds_read_b64_tr_b16 v[130:131], v218 offset:9216
buffer_load_dwordx4 v213, s[8:11], s80 offen offset:1024 lds
s_waitcnt lgkmcnt(4)
v_mfma_f32_32x32x16_bf16 v[80:95], v[144:147], v[156:159], v[80:95]
ds_read_b128 v[136:139], v226 offset:16384
ds_read_b128 v[140:143], v226 offset:20480
v_mfma_f32_16x16x32_bf16 v[164:167], v[160:163], v[144:147], v[164:167]
s_waitcnt lgkmcnt(4)
v_mfma_f32_32x32x16_bf16 v[96:111], v[148:151], v[152:155], v[96:111]
ds_read_b64_tr_b16 v[132:133], v219 offset:8192
ds_read_b64_tr_b16 v[134:135], v219 offset:9216
buffer_load_dwordx4 v214, s[8:11], s80 offen offset:2048 lds
v_mfma_f32_32x32x16_bf16 v[112:127], v[148:151], v[156:159], v[112:127]
v_mfma_f32_16x16x32_bf16 v[168:171], v[160:163], v[148:151], v[168:171]
s_waitcnt lgkmcnt(3)
v_mfma_f32_32x32x16_bf16 v[64:79], v[128:131], v[136:139], v[64:79]
ds_read_b64_tr_b16 v[144:145], v218 offset:12288
ds_read_b64_tr_b16 v[146:147], v218 offset:13312
s_waitcnt vmcnt(9)
s_cmp_eq_u32 s82, 0
s_cbranch_scc0 L_nb_18
s_barrier
L_nb_18:
buffer_load_dwordx4 v215, s[8:11], s80 offen offset:3072 lds
s_waitcnt lgkmcnt(4)
v_mfma_f32_32x32x16_bf16 v[80:95], v[128:131], v[140:143], v[80:95]
ds_read_b128 v[152:155], v227 offset:16384
ds_read_b128 v[156:159], v227 offset:20480
s_cmp_eq_u32 s82, 1
s_cbranch_scc0 L_nb_19
s_barrier
L_nb_19:
buffer_store_dwordx4 v[182:185], v173, s[24:27], s93 offen sc1
v_mfma_f32_16x16x32_bf16 v[164:167], v[160:163], v[128:131], v[164:167]
s_waitcnt lgkmcnt(4)
v_mfma_f32_32x32x16_bf16 v[96:111], v[132:135], v[136:139], v[96:111]
ds_read_b64_tr_b16 v[148:149], v219 offset:12288
ds_read_b64_tr_b16 v[150:151], v219 offset:13312
s_add_u32 m0, s81, 32768
s_add_u32 s79, s79, 221184
buffer_load_dwordx4 v208, s[20:23], s79 offen offset:0 lds
v_mfma_f32_32x32x16_bf16 v[112:127], v[132:135], v[140:143], v[112:127]
v_mfma_f32_16x16x32_bf16 v[168:171], v[160:163], v[132:135], v[168:171]
s_waitcnt lgkmcnt(3)
v_mfma_f32_32x32x16_bf16 v[64:79], v[144:147], v[152:155], v[64:79]
ds_read_b64_tr_b16 v[128:129], v218 offset:32768
ds_read_b64_tr_b16 v[130:131], v218 offset:33792
buffer_load_dwordx4 v209, s[20:23], s79 offen offset:1024 lds
s_waitcnt lgkmcnt(4)
v_mfma_f32_32x32x16_bf16 v[80:95], v[144:147], v[156:159], v[80:95]
ds_read_b128 v[136:139], v224 offset:49152
ds_read_b128 v[140:143], v224 offset:53248
v_mfma_f32_16x16x32_bf16 v[164:167], v[160:163], v[144:147], v[164:167]
s_waitcnt lgkmcnt(4)
v_mfma_f32_32x32x16_bf16 v[96:111], v[148:151], v[152:155], v[96:111]
ds_read_b64_tr_b16 v[132:133], v219 offset:32768
ds_read_b64_tr_b16 v[134:135], v219 offset:33792
buffer_load_dwordx4 v210, s[20:23], s79 offen offset:2048 lds
v_mfma_f32_32x32x16_bf16 v[112:127], v[148:151], v[156:159], v[112:127]
v_mfma_f32_16x16x32_bf16 v[168:171], v[160:163], v[148:151], v[168:171]
s_waitcnt lgkmcnt(3)
v_mfma_f32_32x32x16_bf16 v[64:79], v[128:131], v[136:139], v[64:79]
ds_read_b64_tr_b16 v[144:145], v218 offset:36864
ds_read_b64_tr_b16 v[146:147], v218 offset:37888
buffer_load_dwordx4 v211, s[20:23], s79 offen offset:3072 lds
s_waitcnt lgkmcnt(4)
v_mfma_f32_32x32x16_bf16 v[80:95], v[128:131], v[140:143], v[80:95]
ds_read_b128 v[152:155], v225 offset:49152
ds_read_b128 v[156:159], v225 offset:53248
v_mfma_f32_16x16x32_bf16 v[164:167], v[160:163], v[128:131], v[164:167]
s_waitcnt lgkmcnt(4)
v_mfma_f32_32x32x16_bf16 v[96:111], v[132:135], v[136:139], v[96:111]
ds_read_b64_tr_b16 v[148:149], v219 offset:36864
ds_read_b64_tr_b16 v[150:151], v219 offset:37888
s_add_u32 m0, s81, 49152
s_add_u32 s80, s80, 128
buffer_load_dwordx4 v212, s[8:11], s80 offen offset:0 lds
v_mfma_f32_32x32x16_bf16 v[112:127], v[132:135], v[140:143], v[112:127]
v_mfma_f32_16x16x32_bf16 v[168:171], v[160:163], v[132:135], v[168:171]
s_waitcnt lgkmcnt(3)
v_mfma_f32_32x32x16_bf16 v[64:79], v[144:147], v[152:155], v[64:79]
ds_read_b64_tr_b16 v[128:129], v218 offset:40960
ds_read_b64_tr_b16 v[130:131], v218 offset:41984
buffer_load_dwordx4 v213, s[8:11], s80 offen offset:1024 lds
s_waitcnt lgkmcnt(4)
v_mfma_f32_32x32x16_bf16 v[80:95], v[144:147], v[156:159], v[80:95]
ds_read_b128 v[136:139], v226 offset:49152
ds_read_b128 v[140:143], v226 offset:53248
v_mfma_f32_16x16x32_bf16 v[164:167], v[160:163], v[144:147], v[164:167]
s_waitcnt lgkmcnt(4)
v_mfma_f32_32x32x16_bf16 v[96:111], v[148:151], v[152:155], v[96:111]
ds_read_b64_tr_b16 v[132:133], v219 offset:40960
ds_read_b64_tr_b16 v[134:135], v219 offset:41984
buffer_load_dwordx4 v214, s[8:11], s80 offen offset:2048 lds
v_mfma_f32_32x32x16_bf16 v[112:127], v[148:151], v[156:159], v[112:127]
v_mfma_f32_16x16x32_bf16 v[168:171], v[160:163], v[148:151], v[168:171]
s_waitcnt lgkmcnt(3)
v_mfma_f32_32x32x16_bf16 v[64:79], v[128:131], v[136:139], v[64:79]
ds_read_b64_tr_b16 v[144:145], v218 offset:45056
ds_read_b64_tr_b16 v[146:147], v218 offset:46080
s_waitcnt vmcnt(8)
s_cmp_lg_u32 s5, 0
s_cbranch_scc1 L_back_21
v_cmp_eq_u32 vcc, 0, v254
s_cbranch_vccnz L_slow_20
L_back_21:
s_cmp_eq_u32 s82, 0
s_cbranch_scc0 L_nb_22
s_barrier
L_nb_22:
buffer_load_dwordx4 v215, s[8:11], s80 offen offset:3072 lds
s_waitcnt lgkmcnt(4)
v_mfma_f32_32x32x16_bf16 v[80:95], v[128:131], v[140:143], v[80:95]
ds_read_b128 v[152:155], v227 offset:49152
ds_read_b128 v[156:159], v227 offset:53248
s_cmp_eq_u32 s82, 1
s_cbranch_scc0 L_nb_23
s_barrier
L_nb_23:
s_mov_b32 s36, s56
s_and_b32 s37, s57, 0xffff
s_mov_b32 s38, 3456
s_mov_b32 s39, 0x20000
v_and_b32 v2, 31, v1
s_lshl_b32 s6, s78, 7
s_lshl_b32 s7, s82, 6
s_add_u32 s6, s6, s7
v_add_u32 v3, s6, v2
v_lshlrev_b32 v3, 1, v3
s_cmp_ge_u32 s6, 1728
s_cselect_b32 s101, 0, 32
s_lshl_b32 s6, s77, 7
s_lshl_b32 s7, s83, 6
s_add_u32 s6, s6, s7
v_add_u32 v4, s6, v2
v_lshlrev_b32 v4, 4, v4
v_mov_b32 v5, 2147418112
v_cmp_gt_u32 vcc, 32, v1
v_cndmask_b32 v3, v5, v3, vcc
v_cndmask_b32 v5, v5, v4, vcc
s_mov_b32 s7, 65536
s_mov_b32 s84, 98304
buffer_load_ushort v28, v3, s[36:39], 0 offen
buffer_load_ushort v32, v3, s[36:39], 0 offen offset:64
buffer_load_dwordx4 v[36:39], v5, s[24:27], s7 offen
buffer_load_dwordx4 v[40:43], v5, s[24:27], s7 offen offset:512
buffer_load_dwordx4 v[44:47], v4, s[24:27], s84 offen
buffer_load_dwordx4 v[48:51], v4, s[24:27], s84 offen offset:512
v_mfma_f32_16x16x32_bf16 v[164:167], v[160:163], v[128:131], v[164:167]
s_waitcnt lgkmcnt(4)
v_mfma_f32_32x32x16_bf16 v[96:111], v[132:135], v[136:139], v[96:111]
ds_read_b64_tr_b16 v[148:149], v219 offset:45056
ds_read_b64_tr_b16 v[150:151], v219 offset:46080
s_mov_b32 s32, s48
s_and_b32 s33, s49, 0xffff
s_mov_b32 s34, 2621440
s_mov_b32 s35, 0x20000
s_lshl_b32 s6, s88, 5
s_mul_i32 s7, s5, 24
s_add_u32 s6, s6, s7
v_add_u32 v2, s6, v1
v_lshlrev_b32 v235, 7, v2
s_mov_b32 exec_lo, 0xffffff
s_mov_b32 exec_hi, 0x0
buffer_load_dword v234, v235, s[32:35], 0 offen
s_mov_b64 exec, -1
v_mfma_f32_32x32x16_bf16 v[112:127], v[132:135], v[140:143], v[112:127]
v_mfma_f32_16x16x32_bf16 v[168:171], v[160:163], v[132:135], v[168:171]
s_waitcnt lgkmcnt(3)
v_mfma_f32_32x32x16_bf16 v[64:79], v[144:147], v[152:155], v[64:79]
ds_read_b64_tr_b16 v[128:129], v216 offset:0
ds_read_b64_tr_b16 v[130:131], v216 offset:1024
s_lshl_b32 s6, s5, 2
v_lshlrev_b32 v202, 2, v1
v_add_u32 v202, s6, v202
v_subrev_u32 v202, 252, v202
v_add_u32 v203, s6, v248
v_add_u32 v203, 4, v203
s_mul_i32 s90, s5, 4416
s_lshr_b32 s6, s4, 3
s_waitcnt lgkmcnt(4)
v_mfma_f32_32x32x16_bf16 v[80:95], v[144:147], v[156:159], v[80:95]
ds_read_b128 v[136:139], v220 offset:16384
ds_read_b128 v[140:143], v220 offset:20480
s_mul_i32 s6, s6, 14
s_and_b32 s7, s4, 7
s_mul_i32 s7, s7, 7
s_add_u32 s6, s6, s7
s_lshr_b32 s6, s6, 2
s_cmp_ge_u32 s5, 2
s_cselect_b32 s43, 13, 14
s_cmp_ge_u32 s6, s43
s_cselect_b32 s7, s43, 0
v_mfma_f32_16x16x32_bf16 v[164:167], v[160:163], v[144:147], v[164:167]
s_waitcnt lgkmcnt(4)
v_mfma_f32_32x32x16_bf16 v[96:111], v[148:151], v[152:155], v[96:111]
ds_read_b64_tr_b16 v[132:133], v217 offset:0
ds_read_b64_tr_b16 v[134:135], v217 offset:1024
s_sub_u32 s93, s6, s7
s_mov_b32 s93, 0
s_mul_i32 s6, s95, 54
s_add_u32 s6, s6, s96
s_mul_i32 s79, s6, 5120
s_add_u32 s79, s79, 7340032
s_mul_i32 s7, s43, 5120
s_add_u32 s80, s79, s7
v_mfma_f32_32x32x16_bf16 v[112:127], v[148:151], v[156:159], v[112:127]
s_mul_i32 s7, s93, 5120
s_add_u32 s97, s79, s7
s_add_u32 s98, s97, 4096
v_and_b32 v2, 15, v1
v_lshrrev_b32 v3, 3, v2
v_lshlrev_b32 v3, 3, v3
v_and_b32 v4, 1, v2
v_lshl_or_b32 v3, v4, 2, v3
v_mfma_f32_16x16x32_bf16 v[168:171], v[160:163], v[148:151], v[168:171]
s_waitcnt lgkmcnt(3)
v_mfma_f32_32x32x16_bf16 v[64:79], v[128:131], v[136:139], v[64:79]
ds_read_b64_tr_b16 v[144:145], v216 offset:4096
ds_read_b64_tr_b16 v[146:147], v216 offset:5120
v_bfe_u32 v4, v2, 1, 2
v_or_b32 v3, v3, v4
v_lshlrev_b32 v3, 4, v3
v_bfe_u32 v4, v1, 4, 1
v_lshl_or_b32 v3, v4, 10, v3
v_lshrrev_b32 v4, 5, v1
v_lshl_or_b32 v3, v4, 8, v3
v_mov_b32 v4, 2147418112
s_waitcnt lgkmcnt(4)
v_mfma_f32_32x32x16_bf16 v[80:95], v[128:131], v[140:143], v[80:95]
ds_read_b128 v[152:155], v221 offset:16384
ds_read_b128 v[156:159], v221 offset:20480
s_cmp_eq_u32 s101, 0
s_cselect_b64 vcc, -1, 0
v_cndmask_b32 v60, v3, v4, vcc
s_lshl_b32 s6, s77, 1
s_add_u32 s6, s6, s83
s_mul_i32 s6, s6, 54
s_lshl_b32 s7, s78, 2
s_add_u32 s6, s6, s7
v_mfma_f32_16x16x32_bf16 v[164:167], v[160:163], v[128:131], v[164:167]
s_waitcnt lgkmcnt(4)
v_mfma_f32_32x32x16_bf16 v[96:111], v[132:135], v[136:139], v[96:111]
ds_read_b64_tr_b16 v[148:149], v217 offset:4096
ds_read_b64_tr_b16 v[150:151], v217 offset:5120
s_lshl_b32 s7, s82, 1
s_add_u32 s6, s6, s7
s_lshl_b32 s6, s6, 12
s_add_u32 s100, s6, 10485760
s_add_u32 s101, s100, 4096
s_lshl_b32 s6, s89, 2
s_add_u32 s6, s6, s5
s_lshl_b32 s7, s6, 1
v_mfma_f32_32x32x16_bf16 v[112:127], v[132:135], v[140:143], v[112:127]
s_lshr_b32 s85, 6436, s7
s_and_b32 s85, s85, 3
s_lshr_b32 s86, 55, s6
s_and_b32 s86, s86, 1
s_lshr_b32 s87, 61311, s7
s_and_b32 s87, s87, 3
v_and_b32 v2, 3, v1
v_mul_u32_u24 v2, 4416, v2
v_mfma_f32_16x16x32_bf16 v[168:171], v[160:163], v[132:135], v[168:171]
s_waitcnt lgkmcnt(3)
v_mfma_f32_32x32x16_bf16 v[64:79], v[144:147], v[152:155], v[64:79]
ds_read_b64_tr_b16 v[128:129], v216 offset:8192
ds_read_b64_tr_b16 v[130:131], v216 offset:9216
v_bfe_u32 v3, v1, 2, 2
v_lshrrev_b32 v18, 4, v1
v_add_u32 v3, v3, v18
v_lshl_add_u32 v16, v3, 4, v2
v_and_b32 v2, 1, v1
v_mul_u32_u24 v2, 6272, v2
v_bfe_u32 v3, v1, 1, 3
s_lshl_b32 s6, s86, 3
s_waitcnt lgkmcnt(4)
v_mfma_f32_32x32x16_bf16 v[80:95], v[144:147], v[156:159], v[80:95]
ds_read_b128 v[136:139], v222 offset:16384
ds_read_b128 v[140:143], v222 offset:20480
s_sub_u32 s6, 15, s6
v_sub_u32 v5, s6, v3
v_mul_u32_u24 v5, 272, v5
v_add_u32 v2, v2, v5
v_lshl_add_u32 v17, v18, 4, v2
s_lshl_b32 s6, s86, 3
v_add_u32 v3, s6, v3
v_lshlrev_b32 v3, 8, v3
v_mfma_f32_16x16x32_bf16 v[164:167], v[160:163], v[144:147], v[164:167]
s_waitcnt lgkmcnt(4)
v_mfma_f32_32x32x16_bf16 v[96:111], v[148:151], v[152:155], v[96:111]
ds_read_b64_tr_b16 v[132:133], v217 offset:8192
ds_read_b64_tr_b16 v[134:135], v217 offset:9216
v_and_b32 v2, 1, v1
v_lshl_or_b32 v2, v18, 1, v2
v_lshl_or_b32 v11, v2, 4, v3
s_mul_i32 s6, s85, 30208
s_add_u32 s6, s6, 65536
v_add_u32 v8, s6, v16
s_add_u32 s6, s6, 17664
v_add_u32 v9, s6, v17
v_mfma_f32_32x32x16_bf16 v[112:127], v[148:151], v[156:159], v[112:127]
v_lshlrev_b32 v10, 5, v18
v_sub_u32 v10, v9, v10
v_add_u32 v10, 0, v10
s_add_u32 s91, s88, s85
v_mfma_f32_16x16x32_bf16 v[168:171], v[160:163], v[148:151], v[168:171]
s_waitcnt lgkmcnt(3)
v_mfma_f32_32x32x16_bf16 v[64:79], v[128:131], v[136:139], v[64:79]
ds_read_b64_tr_b16 v[144:145], v216 offset:12288
ds_read_b64_tr_b16 v[146:147], v216 offset:13312
s_waitcnt vmcnt(7)
s_cmp_eq_u32 s82, 0
s_cbranch_scc0 L_nb_24
s_barrier
L_nb_24:
s_waitcnt lgkmcnt(4)
v_mfma_f32_32x32x16_bf16 v[80:95], v[128:131], v[140:143], v[80:95]
ds_read_b128 v[152:155], v223 offset:16384
ds_read_b128 v[156:159], v223 offset:20480
s_cmp_eq_u32 s82, 1
s_cbranch_scc0 L_nb_25
s_barrier
L_nb_25:
s_cmp_lg_u32 s5, 0
s_cbranch_scc1 L_fl_26
s_mov_b64 exec, 1
buffer_store_dword v253, v252, s[24:27], 0 offen offset:12 sc1
s_mov_b64 exec, -1
L_fl_26:
v_mfma_f32_16x16x32_bf16 v[164:167], v[160:163], v[128:131], v[164:167]
s_waitcnt lgkmcnt(4)
v_mfma_f32_32x32x16_bf16 v[96:111], v[132:135], v[136:139], v[96:111]
ds_read_b64_tr_b16 v[148:149], v217 offset:12288
ds_read_b64_tr_b16 v[150:151], v217 offset:13312
s_add_u32 s6, s88, 0
s_lshl_b32 s6, s6, 12
s_add_u32 s32, s48, s6
s_addc_u32 s33, s49, 0
s_and_b32 s33, s33, 0xffff
s_mov_b32 s34, 4096
s_mov_b32 s35, 0x20000
s_add_u32 m0, s90, 65536
s_nop 0
buffer_load_dword v202, s[32:35], 0 offen lds
s_add_u32 m0, s90, 65792
s_nop 0
v_mfma_f32_32x32x16_bf16 v[112:127], v[132:135], v[140:143], v[112:127]
buffer_load_dwordx4 v203, s[32:35], 0 offen offset:0 lds
v_mfma_f32_16x16x32_bf16 v[168:171], v[160:163], v[132:135], v[168:171]
s_waitcnt lgkmcnt(3)
v_mfma_f32_32x32x16_bf16 v[64:79], v[144:147], v[152:155], v[64:79]
ds_read_b64_tr_b16 v[128:129], v216 offset:32768
ds_read_b64_tr_b16 v[130:131], v216 offset:33792
v_lshlrev_b32 v5, 4, v0
v_add_u32 v5, 87552, v5
v_add_u32 v7, 60416, v5
v_mov_b32 v12, 0
buffer_load_dwordx4 v203, s[32:35], 0 offen offset:1024 lds
s_waitcnt lgkmcnt(4)
v_mfma_f32_32x32x16_bf16 v[80:95], v[144:147], v[156:159], v[80:95]
ds_read_b128 v[136:139], v220 offset:49152
ds_read_b128 v[140:143], v220 offset:53248
v_mov_b32 v13, 0
v_mov_b32 v14, 0
v_mov_b32 v15, 0
buffer_load_dwordx4 v203, s[32:35], 0 offen offset:2048 lds
v_mfma_f32_16x16x32_bf16 v[164:167], v[160:163], v[144:147], v[164:167]
s_waitcnt lgkmcnt(4)
v_mfma_f32_32x32x16_bf16 v[96:111], v[148:151], v[152:155], v[96:111]
ds_read_b64_tr_b16 v[132:133], v217 offset:32768
ds_read_b64_tr_b16 v[134:135], v217 offset:33792
v_cmp_gt_u32 vcc, 119, v0
s_and_saveexec_b64 s[6:7], vcc
ds_write_b128 v5, v[12:15] offset:0
ds_write_b128 v5, v[12:15] offset:6272
ds_write_b128 v5, v[12:15] offset:30208
ds_write_b128 v5, v[12:15] offset:36480
ds_write_b128 v7, v[12:15] offset:0
ds_write_b128 v7, v[12:15] offset:6272
s_mov_b64 exec, s[6:7]
v_mfma_f32_32x32x16_bf16 v[112:127], v[148:151], v[156:159], v[112:127]
buffer_load_dwordx4 v203, s[32:35], 0 offen offset:3072 lds
v_mfma_f32_16x16x32_bf16 v[168:171], v[160:163], v[148:151], v[168:171]
s_waitcnt lgkmcnt(9)
v_mfma_f32_32x32x16_bf16 v[64:79], v[128:131], v[136:139], v[64:79]
ds_read_b64_tr_b16 v[144:145], v216 offset:36864
ds_read_b64_tr_b16 v[146:147], v216 offset:37888
s_add_u32 s6, s88, 1
s_lshl_b32 s6, s6, 12
s_add_u32 s32, s48, s6
s_addc_u32 s33, s49, 0
s_and_b32 s33, s33, 0xffff
s_mov_b32 s34, 4096
s_mov_b32 s35, 0x20000
s_add_u32 m0, s90, 95744
s_nop 0
buffer_load_dword v202, s[32:35], 0 offen lds
s_add_u32 m0, s90, 96000
s_nop 0
s_waitcnt lgkmcnt(10)
v_mfma_f32_32x32x16_bf16 v[80:95], v[128:131], v[140:143], v[80:95]
ds_read_b128 v[152:155], v221 offset:49152
ds_read_b128 v[156:159], v221 offset:53248
buffer_load_dwordx4 v203, s[32:35], 0 offen offset:0 lds
v_mfma_f32_16x16x32_bf16 v[164:167], v[160:163], v[128:131], v[164:167]
s_waitcnt lgkmcnt(10)
v_mfma_f32_32x32x16_bf16 v[96:111], v[132:135], v[136:139], v[96:111]
ds_read_b64_tr_b16 v[148:149], v217 offset:36864
ds_read_b64_tr_b16 v[150:151], v217 offset:37888
buffer_load_dwordx4 v203, s[32:35], 0 offen offset:1024 lds
v_mfma_f32_32x32x16_bf16 v[112:127], v[132:135], v[140:143], v[112:127]
buffer_load_dwordx4 v203, s[32:35], 0 offen offset:2048 lds
v_mfma_f32_16x16x32_bf16 v[168:171], v[160:163], v[132:135], v[168:171]
s_waitcnt lgkmcnt(3)
v_mfma_f32_32x32x16_bf16 v[64:79], v[144:147], v[152:155], v[64:79]
ds_read_b64_tr_b16 v[128:129], v216 offset:40960
ds_read_b64_tr_b16 v[130:131], v216 offset:41984
buffer_load_dwordx4 v203, s[32:35], 0 offen offset:3072 lds
s_waitcnt lgkmcnt(4)
v_mfma_f32_32x32x16_bf16 v[80:95], v[144:147], v[156:159], v[80:95]
ds_read_b128 v[136:139], v222 offset:49152
ds_read_b128 v[140:143], v222 offset:53248
s_add_u32 s6, s88, 2
s_lshl_b32 s6, s6, 12
s_add_u32 s32, s48, s6
s_addc_u32 s33, s49, 0
s_and_b32 s33, s33, 0xffff
s_mov_b32 s34, 4096
s_mov_b32 s35, 0x20000
s_add_u32 m0, s90, 125952
s_nop 0
buffer_load_dword v202, s[32:35], 0 offen lds
s_add_u32 m0, s90, 126208
s_nop 0
v_mfma_f32_16x16x32_bf16 v[164:167], v[160:163], v[144:147], v[164:167]
s_waitcnt lgkmcnt(4)
v_mfma_f32_32x32x16_bf16 v[96:111], v[148:151], v[152:155], v[96:111]
ds_read_b64_tr_b16 v[132:133], v217 offset:40960
ds_read_b64_tr_b16 v[134:135], v217 offset:41984
buffer_load_dwordx4 v203, s[32:35], 0 offen offset:0 lds
v_mfma_f32_32x32x16_bf16 v[112:127], v[148:151], v[156:159], v[112:127]
buffer_load_dwordx4 v203, s[32:35], 0 offen offset:1024 lds
v_mfma_f32_16x16x32_bf16 v[168:171], v[160:163], v[148:151], v[168:171]
s_waitcnt lgkmcnt(3)
v_mfma_f32_32x32x16_bf16 v[64:79], v[128:131], v[136:139], v[64:79]
ds_read_b64_tr_b16 v[144:145], v216 offset:45056
ds_read_b64_tr_b16 v[146:147], v216 offset:46080
buffer_load_dwordx4 v203, s[32:35], 0 offen offset:2048 lds
s_waitcnt lgkmcnt(4)
v_mfma_f32_32x32x16_bf16 v[80:95], v[128:131], v[140:143], v[80:95]
ds_read_b128 v[152:155], v223 offset:49152
ds_read_b128 v[156:159], v223 offset:53248
buffer_load_dwordx4 v203, s[32:35], 0 offen offset:3072 lds
v_mfma_f32_16x16x32_bf16 v[164:167], v[160:163], v[128:131], v[164:167]
s_waitcnt lgkmcnt(4)
v_mfma_f32_32x32x16_bf16 v[96:111], v[132:135], v[136:139], v[96:111]
ds_read_b64_tr_b16 v[148:149], v217 offset:45056
ds_read_b64_tr_b16 v[150:151], v217 offset:46080
v_mfma_f32_32x32x16_bf16 v[112:127], v[132:135], v[140:143], v[112:127]
v_mfma_f32_16x16x32_bf16 v[168:171], v[160:163], v[132:135], v[168:171]
s_waitcnt lgkmcnt(3)
v_mfma_f32_32x32x16_bf16 v[64:79], v[144:147], v[152:155], v[64:79]
s_waitcnt lgkmcnt(2)
v_mfma_f32_32x32x16_bf16 v[80:95], v[144:147], v[156:159], v[80:95]
v_mfma_f32_16x16x32_bf16 v[164:167], v[160:163], v[144:147], v[164:167]
s_waitcnt lgkmcnt(0)
v_mfma_f32_32x32x16_bf16 v[96:111], v[148:151], v[152:155], v[96:111]
v_mfma_f32_32x32x16_bf16 v[112:127], v[148:151], v[156:159], v[112:127]
v_mfma_f32_16x16x32_bf16 v[168:171], v[160:163], v[148:151], v[168:171]
s_waitcnt vmcnt(16)
s_nop 7
v_lshl_or_b32 v28, v28, 16, v28
v_cvt_pk_bf16_f32 v29, v164, v164
v_lshlrev_b32 v2, 16, v29
v_sub_f32 v2, v164, v2
v_cvt_pk_bf16_f32 v30, v2, v2
v_mov_b32 v31, 0
v_lshl_or_b32 v32, v32, 16, v32
v_cvt_pk_bf16_f32 v33, v168, v168
v_lshlrev_b32 v2, 16, v33
v_sub_f32 v2, v168, v2
v_cvt_pk_bf16_f32 v34, v2, v2
v_mov_b32 v35, 0
s_nop 1
v_mfma_f32_32x32x16_bf16 v[64:79], v[28:31], v[36:39], v[64:79]
v_mfma_f32_32x32x16_bf16 v[80:95], v[28:31], v[40:43], v[80:95]
v_mfma_f32_32x32x16_bf16 v[96:111], v[32:35], v[36:39], v[96:111]
v_mfma_f32_32x32x16_bf16 v[112:127], v[32:35], v[40:43], v[112:127]
v_mul_f32 v52, -2.302208198144325, v45
v_mul_f32 v2, v45, v45
v_mul_f32 v2, v2, v45
v_mul_f32 v53, -0.1029432395800235, v2
v_mov_b32 v54, v46
v_mov_b32 v55, v46
v_mul_f32 v56, -2.302208198144325, v49
v_mul_f32 v2, v49, v49
v_mul_f32 v2, v2, v49
v_mul_f32 v57, -0.1029432395800235, v2
v_mov_b32 v58, v50
v_mov_b32 v59, v50
buffer_load_dword v251, v229, s[24:27], 0 offen sc1
v_pk_mul_f32 v[160:161], v[64:65], v[64:65]
v_pk_mul_f32 v[162:163], v[66:67], v[66:67]
v_pk_mul_f32 v[164:165], v[68:69], v[68:69]
v_pk_mul_f32 v[166:167], v[70:71], v[70:71]
v_pk_fma_f32 v[160:161], v[160:161], v[52:53], v[52:53] op_sel:[0,1,0] op_sel_hi:[1,1,0]
v_pk_fma_f32 v[162:163], v[162:163], v[52:53], v[52:53] op_sel:[0,1,0] op_sel_hi:[1,1,0]
v_pk_fma_f32 v[164:165], v[164:165], v[52:53], v[52:53] op_sel:[0,1,0] op_sel_hi:[1,1,0]
v_pk_fma_f32 v[166:167], v[166:167], v[52:53], v[52:53] op_sel:[0,1,0] op_sel_hi:[1,1,0]
v_pk_mul_f32 v[160:161], v[160:161], v[64:65]
v_pk_mul_f32 v[162:163], v[162:163], v[66:67]
v_pk_mul_f32 v[164:165], v[164:165], v[68:69]
v_pk_mul_f32 v[166:167], v[166:167], v[70:71]
v_exp_f32 v160, v160
v_exp_f32 v161, v161
v_exp_f32 v162, v162
v_exp_f32 v163, v163
v_exp_f32 v164, v164
v_exp_f32 v165, v165
v_exp_f32 v166, v166
v_exp_f32 v167, v167
v_pk_fma_f32 v[160:161], v[160:161], v[54:55], v[54:55]
v_pk_fma_f32 v[162:163], v[162:163], v[54:55], v[54:55]
v_pk_fma_f32 v[164:165], v[164:165], v[54:55], v[54:55]
v_pk_fma_f32 v[166:167], v[166:167], v[54:55], v[54:55]
v_rcp_f32 v160, v160
v_rcp_f32 v161, v161
v_rcp_f32 v162, v162
v_rcp_f32 v163, v163
v_rcp_f32 v164, v164
v_rcp_f32 v165, v165
v_rcp_f32 v166, v166
v_rcp_f32 v167, v167
v_pk_mul_f32 v[160:161], v[160:161], v[64:65]
v_pk_mul_f32 v[162:163], v[162:163], v[66:67]
v_pk_mul_f32 v[164:165], v[164:165], v[68:69]
v_pk_mul_f32 v[166:167], v[166:167], v[70:71]
v_cvt_pk_bf16_f32 v64, v160, v161
v_cvt_pk_bf16_f32 v65, v162, v163
v_cvt_pk_bf16_f32 v66, v164, v165
v_cvt_pk_bf16_f32 v67, v166, v167
buffer_store_dwordx4 v[64:67], v60, s[24:27], s100 offen offset:0 sc1
buffer_load_dword v254, v228, s[24:27], 0 offen sc1
v_pk_mul_f32 v[160:161], v[72:73], v[72:73]
v_pk_mul_f32 v[162:163], v[74:75], v[74:75]
v_pk_mul_f32 v[164:165], v[76:77], v[76:77]
v_pk_mul_f32 v[166:167], v[78:79], v[78:79]
v_pk_fma_f32 v[160:161], v[160:161], v[52:53], v[52:53] op_sel:[0,1,0] op_sel_hi:[1,1,0]
v_pk_fma_f32 v[162:163], v[162:163], v[52:53], v[52:53] op_sel:[0,1,0] op_sel_hi:[1,1,0]
v_pk_fma_f32 v[164:165], v[164:165], v[52:53], v[52:53] op_sel:[0,1,0] op_sel_hi:[1,1,0]
v_pk_fma_f32 v[166:167], v[166:167], v[52:53], v[52:53] op_sel:[0,1,0] op_sel_hi:[1,1,0]
v_pk_mul_f32 v[160:161], v[160:161], v[72:73]
v_pk_mul_f32 v[162:163], v[162:163], v[74:75]
v_pk_mul_f32 v[164:165], v[164:165], v[76:77]
v_pk_mul_f32 v[166:167], v[166:167], v[78:79]
v_exp_f32 v160, v160
v_exp_f32 v161, v161
v_exp_f32 v162, v162
v_exp_f32 v163, v163
v_exp_f32 v164, v164
v_exp_f32 v165, v165
v_exp_f32 v166, v166
v_exp_f32 v167, v167
v_pk_fma_f32 v[160:161], v[160:161], v[54:55], v[54:55]
v_pk_fma_f32 v[162:163], v[162:163], v[54:55], v[54:55]
v_pk_fma_f32 v[164:165], v[164:165], v[54:55], v[54:55]
v_pk_fma_f32 v[166:167], v[166:167], v[54:55], v[54:55]
v_rcp_f32 v160, v160
v_rcp_f32 v161, v161
v_rcp_f32 v162, v162
v_rcp_f32 v163, v163
v_rcp_f32 v164, v164
v_rcp_f32 v165, v165
v_rcp_f32 v166, v166
v_rcp_f32 v167, v167
v_pk_mul_f32 v[160:161], v[160:161], v[72:73]
v_pk_mul_f32 v[162:163], v[162:163], v[74:75]
v_pk_mul_f32 v[164:165], v[164:165], v[76:77]
v_pk_mul_f32 v[166:167], v[166:167], v[78:79]
v_cvt_pk_bf16_f32 v72, v160, v161
v_cvt_pk_bf16_f32 v73, v162, v163
v_cvt_pk_bf16_f32 v74, v164, v165
v_cvt_pk_bf16_f32 v75, v166, v167
buffer_store_dwordx4 v[72:75], v60, s[24:27], s100 offen offset:512 sc1
v_pk_mul_f32 v[160:161], v[80:81], v[80:81]
v_pk_mul_f32 v[162:163], v[82:83], v[82:83]
v_pk_mul_f32 v[164:165], v[84:85], v[84:85]
v_pk_mul_f32 v[166:167], v[86:87], v[86:87]
v_pk_fma_f32 v[160:161], v[160:161], v[56:57], v[56:57] op_sel:[0,1,0] op_sel_hi:[1,1,0]
v_pk_fma_f32 v[162:163], v[162:163], v[56:57], v[56:57] op_sel:[0,1,0] op_sel_hi:[1,1,0]
v_pk_fma_f32 v[164:165], v[164:165], v[56:57], v[56:57] op_sel:[0,1,0] op_sel_hi:[1,1,0]
v_pk_fma_f32 v[166:167], v[166:167], v[56:57], v[56:57] op_sel:[0,1,0] op_sel_hi:[1,1,0]
v_pk_mul_f32 v[160:161], v[160:161], v[80:81]
v_pk_mul_f32 v[162:163], v[162:163], v[82:83]
v_pk_mul_f32 v[164:165], v[164:165], v[84:85]
v_pk_mul_f32 v[166:167], v[166:167], v[86:87]
v_exp_f32 v160, v160
v_exp_f32 v161, v161
v_exp_f32 v162, v162
v_exp_f32 v163, v163
v_exp_f32 v164, v164
v_exp_f32 v165, v165
v_exp_f32 v166, v166
v_exp_f32 v167, v167
v_pk_fma_f32 v[160:161], v[160:161], v[58:59], v[58:59]
v_pk_fma_f32 v[162:163], v[162:163], v[58:59], v[58:59]
v_pk_fma_f32 v[164:165], v[164:165], v[58:59], v[58:59]
v_pk_fma_f32 v[166:167], v[166:167], v[58:59], v[58:59]
v_rcp_f32 v160, v160
v_rcp_f32 v161, v161
v_rcp_f32 v162, v162
v_rcp_f32 v163, v163
v_rcp_f32 v164, v164
v_rcp_f32 v165, v165
v_rcp_f32 v166, v166
v_rcp_f32 v167, v167
v_pk_mul_f32 v[160:161], v[160:161], v[80:81]
v_pk_mul_f32 v[162:163], v[162:163], v[82:83]
v_pk_mul_f32 v[164:165], v[164:165], v[84:85]
v_pk_mul_f32 v[166:167], v[166:167], v[86:87]
v_cvt_pk_bf16_f32 v80, v160, v161
v_cvt_pk_bf16_f32 v81, v162, v163
v_cvt_pk_bf16_f32 v82, v164, v165
v_cvt_pk_bf16_f32 v83, v166, v167
buffer_store_dwordx4 v[80:83], v60, s[24:27], s100 offen offset:2048 sc1
s_waitcnt vmcnt(4)
v_cmp_eq_u32 vcc, 0, v251
s_cbranch_vccnz L_slow_27
L_back_28:
v_lshlrev_b32 v4, 4, v0
s_add_u32 s6, s88, 0
s_lshl_b32 s6, s6, 12
s_add_u32 s6, s6, 1048576
s_add_u32 s36, s66, s6
s_addc_u32 s37, s67, 0
s_and_b32 s37, s37, 0xffff
s_mov_b32 s38, 4096
s_mov_b32 s39, 0x20000
buffer_load_dwordx4 v[32:35], v4, s[36:39], 0 offen
buffer_load_dword v36, v4, s[36:39], 0 offen offset:16
s_add_u32 s6, s88, 1
s_lshl_b32 s6, s6, 12
s_add_u32 s6, s6, 1048576
s_add_u32 s36, s66, s6
s_addc_u32 s37, s67, 0
s_and_b32 s37, s37, 0xffff
s_mov_b32 s38, 4096
s_mov_b32 s39, 0x20000
buffer_load_dwordx4 v[38:41], v4, s[36:39], 0 offen
buffer_load_dword v42, v4, s[36:39], 0 offen offset:16
s_add_u32 s6, s88, 2
s_lshl_b32 s6, s6, 12
s_add_u32 s6, s6, 1048576
s_add_u32 s36, s66, s6
s_addc_u32 s37, s67, 0
s_and_b32 s37, s37, 0xffff
s_mov_b32 s38, 4096
s_mov_b32 s39, 0x20000
buffer_load_dwordx4 v[44:47], v4, s[36:39], 0 offen
buffer_load_dword v48, v4, s[36:39], 0 offen offset:16
v_pk_mul_f32 v[160:161], v[88:89], v[88:89]
v_pk_mul_f32 v[162:163], v[90:91], v[90:91]
v_pk_mul_f32 v[164:165], v[92:93], v[92:93]
v_pk_mul_f32 v[166:167], v[94:95], v[94:95]
v_pk_fma_f32 v[160:161], v[160:161], v[56:57], v[56:57] op_sel:[0,1,0] op_sel_hi:[1,1,0]
v_pk_fma_f32 v[162:163], v[162:163], v[56:57], v[56:57] op_sel:[0,1,0] op_sel_hi:[1,1,0]
v_pk_fma_f32 v[164:165], v[164:165], v[56:57], v[56:57] op_sel:[0,1,0] op_sel_hi:[1,1,0]
v_pk_fma_f32 v[166:167], v[166:167], v[56:57], v[56:57] op_sel:[0,1,0] op_sel_hi:[1,1,0]
v_pk_mul_f32 v[160:161], v[160:161], v[88:89]
v_pk_mul_f32 v[162:163], v[162:163], v[90:91]
v_pk_mul_f32 v[164:165], v[164:165], v[92:93]
v_pk_mul_f32 v[166:167], v[166:167], v[94:95]
v_exp_f32 v160, v160
v_exp_f32 v161, v161
v_exp_f32 v162, v162
v_exp_f32 v163, v163
v_exp_f32 v164, v164
v_exp_f32 v165, v165
v_exp_f32 v166, v166
v_exp_f32 v167, v167
v_pk_fma_f32 v[160:161], v[160:161], v[58:59], v[58:59]
v_pk_fma_f32 v[162:163], v[162:163], v[58:59], v[58:59]
v_pk_fma_f32 v[164:165], v[164:165], v[58:59], v[58:59]
v_pk_fma_f32 v[166:167], v[166:167], v[58:59], v[58:59]
v_rcp_f32 v160, v160
v_rcp_f32 v161, v161
v_rcp_f32 v162, v162
v_rcp_f32 v163, v163
v_rcp_f32 v164, v164
v_rcp_f32 v165, v165
v_rcp_f32 v166, v166
v_rcp_f32 v167, v167
v_pk_mul_f32 v[160:161], v[160:161], v[88:89]
v_pk_mul_f32 v[162:163], v[162:163], v[90:91]
v_pk_mul_f32 v[164:165], v[164:165], v[92:93]
v_pk_mul_f32 v[166:167], v[166:167], v[94:95]
v_cvt_pk_bf16_f32 v88, v160, v161
v_cvt_pk_bf16_f32 v89, v162, v163
v_cvt_pk_bf16_f32 v90, v164, v165
v_cvt_pk_bf16_f32 v91, v166, v167
buffer_store_dwordx4 v[88:91], v60, s[24:27], s100 offen offset:2560 sc1
s_waitcnt vmcnt(9)
v_cmp_eq_u32 vcc, 0, v254
s_cbranch_vccnz L_slow_29
L_back_30:
buffer_load_dwordx4 a[0:3], v248, s[24:27], s97 offen offset:0
buffer_load_dwordx4 a[4:7], v248, s[24:27], s97 offen offset:1024
buffer_load_dwordx4 a[8:11], v248, s[24:27], s97 offen offset:2048
buffer_load_dwordx4 a[12:15], v248, s[24:27], s97 offen offset:3072
buffer_load_dwordx4 a[16:19], v248, s[24:27], s98 offen
s_add_u32 s97, s97, 5120
s_cmp_eq_u32 s97, s80
s_cselect_b32 s97, s79, s97
s_add_u32 s98, s97, 4096
v_pk_mul_f32 v[160:161], v[96:97], v[96:97]
v_pk_mul_f32 v[162:163], v[98:99], v[98:99]
v_pk_mul_f32 v[164:165], v[100:101], v[100:101]
v_pk_mul_f32 v[166:167], v[102:103], v[102:103]
v_pk_fma_f32 v[160:161], v[160:161], v[52:53], v[52:53] op_sel:[0,1,0] op_sel_hi:[1,1,0]
v_pk_fma_f32 v[162:163], v[162:163], v[52:53], v[52:53] op_sel:[0,1,0] op_sel_hi:[1,1,0]
v_pk_fma_f32 v[164:165], v[164:165], v[52:53], v[52:53] op_sel:[0,1,0] op_sel_hi:[1,1,0]
v_pk_fma_f32 v[166:167], v[166:167], v[52:53], v[52:53] op_sel:[0,1,0] op_sel_hi:[1,1,0]
v_pk_mul_f32 v[160:161], v[160:161], v[96:97]
v_pk_mul_f32 v[162:163], v[162:163], v[98:99]
v_pk_mul_f32 v[164:165], v[164:165], v[100:101]
v_pk_mul_f32 v[166:167], v[166:167], v[102:103]
v_exp_f32 v160, v160
v_exp_f32 v161, v161
v_exp_f32 v162, v162
v_exp_f32 v163, v163
v_exp_f32 v164, v164
v_exp_f32 v165, v165
v_exp_f32 v166, v166
v_exp_f32 v167, v167
v_pk_fma_f32 v[160:161], v[160:161], v[54:55], v[54:55]
v_pk_fma_f32 v[162:163], v[162:163], v[54:55], v[54:55]
v_pk_fma_f32 v[164:165], v[164:165], v[54:55], v[54:55]
v_pk_fma_f32 v[166:167], v[166:167], v[54:55], v[54:55]
v_rcp_f32 v160, v160
v_rcp_f32 v161, v161
v_rcp_f32 v162, v162
v_rcp_f32 v163, v163
v_rcp_f32 v164, v164
v_rcp_f32 v165, v165
v_rcp_f32 v166, v166
v_rcp_f32 v167, v167
v_pk_mul_f32 v[160:161], v[160:161], v[96:97]
v_pk_mul_f32 v[162:163], v[162:163], v[98:99]
v_pk_mul_f32 v[164:165], v[164:165], v[100:101]
v_pk_mul_f32 v[166:167], v[166:167], v[102:103]
v_cvt_pk_bf16_f32 v96, v160, v161
v_cvt_pk_bf16_f32 v97, v162, v163
v_cvt_pk_bf16_f32 v98, v164, v165
v_cvt_pk_bf16_f32 v99, v166, v167
buffer_store_dwordx4 v[96:99], v60, s[24:27], s101 offen offset:0 sc1
buffer_load_dwordx4 a[20:23], v248, s[24:27], s97 offen offset:0
buffer_load_dwordx4 a[24:27], v248, s[24:27], s97 offen offset:1024
buffer_load_dwordx4 a[28:31], v248, s[24:27], s97 offen offset:2048
buffer_load_dwordx4 a[32:35], v248, s[24:27], s97 offen offset:3072
buffer_load_dwordx4 a[36:39], v248, s[24:27], s98 offen
s_add_u32 s97, s97, 5120
s_cmp_eq_u32 s97, s80
s_cselect_b32 s97, s79, s97
s_add_u32 s98, s97, 4096
v_pk_mul_f32 v[160:161], v[104:105], v[104:105]
v_pk_mul_f32 v[162:163], v[106:107], v[106:107]
v_pk_mul_f32 v[164:165], v[108:109], v[108:109]
v_pk_mul_f32 v[166:167], v[110:111], v[110:111]
v_pk_fma_f32 v[160:161], v[160:161], v[52:53], v[52:53] op_sel:[0,1,0] op_sel_hi:[1,1,0]
v_pk_fma_f32 v[162:163], v[162:163], v[52:53], v[52:53] op_sel:[0,1,0] op_sel_hi:[1,1,0]
v_pk_fma_f32 v[164:165], v[164:165], v[52:53], v[52:53] op_sel:[0,1,0] op_sel_hi:[1,1,0]
v_pk_fma_f32 v[166:167], v[166:167], v[52:53], v[52:53] op_sel:[0,1,0] op_sel_hi:[1,1,0]
v_pk_mul_f32 v[160:161], v[160:161], v[104:105]
v_pk_mul_f32 v[162:163], v[162:163], v[106:107]
v_pk_mul_f32 v[164:165], v[164:165], v[108:109]
v_pk_mul_f32 v[166:167], v[166:167], v[110:111]
v_exp_f32 v160, v160
v_exp_f32 v161, v161
v_exp_f32 v162, v162
v_exp_f32 v163, v163
v_exp_f32 v164, v164
v_exp_f32 v165, v165
v_exp_f32 v166, v166
v_exp_f32 v167, v167
v_pk_fma_f32 v[160:161], v[160:161], v[54:55], v[54:55]
v_pk_fma_f32 v[162:163], v[162:163], v[54:55], v[54:55]
v_pk_fma_f32 v[164:165], v[164:165], v[54:55], v[54:55]
v_pk_fma_f32 v[166:167], v[166:167], v[54:55], v[54:55]
v_rcp_f32 v160, v160
v_rcp_f32 v161, v161
v_rcp_f32 v162, v162
v_rcp_f32 v163, v163
v_rcp_f32 v164, v164
v_rcp_f32 v165, v165
v_rcp_f32 v166, v166
v_rcp_f32 v167, v167
v_pk_mul_f32 v[160:161], v[160:161], v[104:105]
v_pk_mul_f32 v[162:163], v[162:163], v[106:107]
v_pk_mul_f32 v[164:165], v[164:165], v[108:109]
v_pk_mul_f32 v[166:167], v[166:167], v[110:111]
v_cvt_pk_bf16_f32 v104, v160, v161
v_cvt_pk_bf16_f32 v105, v162, v163
v_cvt_pk_bf16_f32 v106, v164, v165
v_cvt_pk_bf16_f32 v107, v166, v167
buffer_store_dwordx4 v[104:107], v60, s[24:27], s101 offen offset:512 sc1
buffer_load_dwordx4 a[40:43], v248, s[24:27], s97 offen offset:0
buffer_load_dwordx4 a[44:47], v248, s[24:27], s97 offen offset:1024
buffer_load_dwordx4 a[48:51], v248, s[24:27], s97 offen offset:2048
buffer_load_dwordx4 a[52:55], v248, s[24:27], s97 offen offset:3072
buffer_load_dwordx4 a[56:59], v248, s[24:27], s98 offen
s_add_u32 s97, s97, 5120
s_cmp_eq_u32 s97, s80
s_cselect_b32 s97, s79, s97
s_add_u32 s98, s97, 4096
v_pk_mul_f32 v[160:161], v[112:113], v[112:113]
v_pk_mul_f32 v[162:163], v[114:115], v[114:115]
v_pk_mul_f32 v[164:165], v[116:117], v[116:117]
v_pk_mul_f32 v[166:167], v[118:119], v[118:119]
v_pk_fma_f32 v[160:161], v[160:161], v[56:57], v[56:57] op_sel:[0,1,0] op_sel_hi:[1,1,0]
v_pk_fma_f32 v[162:163], v[162:163], v[56:57], v[56:57] op_sel:[0,1,0] op_sel_hi:[1,1,0]
v_pk_fma_f32 v[164:165], v[164:165], v[56:57], v[56:57] op_sel:[0,1,0] op_sel_hi:[1,1,0]
v_pk_fma_f32 v[166:167], v[166:167], v[56:57], v[56:57] op_sel:[0,1,0] op_sel_hi:[1,1,0]
v_pk_mul_f32 v[160:161], v[160:161], v[112:113]
v_pk_mul_f32 v[162:163], v[162:163], v[114:115]
v_pk_mul_f32 v[164:165], v[164:165], v[116:117]
v_pk_mul_f32 v[166:167], v[166:167], v[118:119]
v_exp_f32 v160, v160
v_exp_f32 v161, v161
v_exp_f32 v162, v162
v_exp_f32 v163, v163
v_exp_f32 v164, v164
v_exp_f32 v165, v165
v_exp_f32 v166, v166
v_exp_f32 v167, v167
v_pk_fma_f32 v[160:161], v[160:161], v[58:59], v[58:59]
v_pk_fma_f32 v[162:163], v[162:163], v[58:59], v[58:59]
v_pk_fma_f32 v[164:165], v[164:165], v[58:59], v[58:59]
v_pk_fma_f32 v[166:167], v[166:167], v[58:59], v[58:59]
v_rcp_f32 v160, v160
v_rcp_f32 v161, v161
v_rcp_f32 v162, v162
v_rcp_f32 v163, v163
v_rcp_f32 v164, v164
v_rcp_f32 v165, v165
v_rcp_f32 v166, v166
v_rcp_f32 v167, v167
v_pk_mul_f32 v[160:161], v[160:161], v[112:113]
v_pk_mul_f32 v[162:163], v[162:163], v[114:115]
v_pk_mul_f32 v[164:165], v[164:165], v[116:117]
v_pk_mul_f32 v[166:167], v[166:167], v[118:119]
v_cvt_pk_bf16_f32 v112, v160, v161
v_cvt_pk_bf16_f32 v113, v162, v163
v_cvt_pk_bf16_f32 v114, v164, v165
v_cvt_pk_bf16_f32 v115, v166, v167
buffer_store_dwordx4 v[112:115], v60, s[24:27], s101 offen offset:2048 sc1
buffer_load_dwordx4 a[60:63], v248, s[24:27], s97 offen offset:0
buffer_load_dwordx4 a[64:67], v248, s[24:27], s97 offen offset:1024
buffer_load_dwordx4 a[68:71], v248, s[24:27], s97 offen offset:2048
buffer_load_dwordx4 a[72:75], v248, s[24:27], s97 offen offset:3072
buffer_load_dwordx4 a[76:79], v248, s[24:27], s98 offen
s_add_u32 s97, s97, 5120
s_cmp_eq_u32 s97, s80
s_cselect_b32 s97, s79, s97
s_add_u32 s98, s97, 4096
v_lshrrev_b32 v4, 4, v0
v_mul_u32_u24 v4, 272, v4
v_and_b32 v5, 15, v0
v_lshl_add_u32 v4, v5, 4, v4
v_add_u32 v4, 83200, v4
v_add_u32 v6, 60416, v4
s_waitcnt vmcnt(24)
ds_write_b128 v4, v[32:35] offset:6272
v_alignbit_b32 v12, v33, v32, 16
v_alignbit_b32 v13, v34, v33, 16
v_alignbit_b32 v14, v35, v34, 16
v_alignbit_b32 v15, v36, v35, 16
ds_write_b128 v4, v[12:15] offset:0
ds_write_b128 v4, v[38:41] offset:36480
v_alignbit_b32 v12, v39, v38, 16
v_alignbit_b32 v13, v40, v39, 16
v_alignbit_b32 v14, v41, v40, 16
v_alignbit_b32 v15, v42, v41, 16
ds_write_b128 v4, v[12:15] offset:30208
ds_write_b128 v6, v[44:47] offset:6272
v_alignbit_b32 v12, v45, v44, 16
v_alignbit_b32 v13, v46, v45, 16
v_alignbit_b32 v14, v47, v46, 16
v_alignbit_b32 v15, v48, v47, 16
ds_write_b128 v6, v[12:15] offset:0
v_pk_mul_f32 v[160:161], v[120:121], v[120:121]
v_pk_mul_f32 v[162:163], v[122:123], v[122:123]
v_pk_mul_f32 v[164:165], v[124:125], v[124:125]
v_pk_mul_f32 v[166:167], v[126:127], v[126:127]
v_pk_fma_f32 v[160:161], v[160:161], v[56:57], v[56:57] op_sel:[0,1,0] op_sel_hi:[1,1,0]
v_pk_fma_f32 v[162:163], v[162:163], v[56:57], v[56:57] op_sel:[0,1,0] op_sel_hi:[1,1,0]
v_pk_fma_f32 v[164:165], v[164:165], v[56:57], v[56:57] op_sel:[0,1,0] op_sel_hi:[1,1,0]
v_pk_fma_f32 v[166:167], v[166:167], v[56:57], v[56:57] op_sel:[0,1,0] op_sel_hi:[1,1,0]
v_pk_mul_f32 v[160:161], v[160:161], v[120:121]
v_pk_mul_f32 v[162:163], v[162:163], v[122:123]
v_pk_mul_f32 v[164:165], v[164:165], v[124:125]
v_pk_mul_f32 v[166:167], v[166:167], v[126:127]
v_exp_f32 v160, v160
v_exp_f32 v161, v161
v_exp_f32 v162, v162
v_exp_f32 v163, v163
v_exp_f32 v164, v164
v_exp_f32 v165, v165
v_exp_f32 v166, v166
v_exp_f32 v167, v167
v_pk_fma_f32 v[160:161], v[160:161], v[58:59], v[58:59]
v_pk_fma_f32 v[162:163], v[162:163], v[58:59], v[58:59]
v_pk_fma_f32 v[164:165], v[164:165], v[58:59], v[58:59]
v_pk_fma_f32 v[166:167], v[166:167], v[58:59], v[58:59]
v_rcp_f32 v160, v160
v_rcp_f32 v161, v161
v_rcp_f32 v162, v162
v_rcp_f32 v163, v163
v_rcp_f32 v164, v164
v_rcp_f32 v165, v165
v_rcp_f32 v166, v166
v_rcp_f32 v167, v167
v_pk_mul_f32 v[160:161], v[160:161], v[120:121]
v_pk_mul_f32 v[162:163], v[162:163], v[122:123]
v_pk_mul_f32 v[164:165], v[164:165], v[124:125]
v_pk_mul_f32 v[166:167], v[166:167], v[126:127]
v_cvt_pk_bf16_f32 v120, v160, v161
v_cvt_pk_bf16_f32 v121, v162, v163
v_cvt_pk_bf16_f32 v122, v164, v165
v_cvt_pk_bf16_f32 v123, v166, v167
buffer_store_dwordx4 v[120:123], v60, s[24:27], s101 offen offset:2560 sc1
L_conv:
s_waitcnt lgkmcnt(0)
s_barrier
ds_read_b128 v[128:131], v8 offset:0
ds_read_b128 v[132:135], v8 offset:64
ds_read_b128 v[136:139], v8 offset:128
ds_read_b128 v[140:143], v8 offset:192
ds_read_b128 v[144:147], v8 offset:256
ds_read_b128 v[148:151], v8 offset:320
ds_read_b128 v[152:155], v8 offset:384
ds_read_b128 v[156:159], v8 offset:448
ds_read_b128 v[160:163], v9 offset:0
ds_read_b128 v[164:167], v9 offset:64
ds_read_b128 v[168:171], v9 offset:128
v_mov_b32 v176, 0
v_mov_b32 v177, 0
v_mov_b32 v178, 0
v_mov_b32 v179, 0
v_mov_b32 v180, 0
v_mov_b32 v181, 0
v_mov_b32 v182, 0
v_mov_b32 v183, 0
v_mov_b32 v184, 0
v_mov_b32 v185, 0
v_mov_b32 v186, 0
v_mov_b32 v187, 0
v_mov_b32 v188, 0
v_mov_b32 v189, 0
v_mov_b32 v190, 0
v_mov_b32 v191, 0
s_waitcnt lgkmcnt(0)
ds_read_b128 v[128:131], v8 offset:512
ds_read_b128 v[172:175], v9 offset:192
v_mfma_f32_16x16x32_bf16 v[188:191], v[140:143], v[160:163], v[188:191]
ds_read_b128 v[132:135], v8 offset:576
ds_read_b128 v[160:163], v9 offset:272
v_mfma_f32_16x16x32_bf16 v[184:187], v[140:143], v[164:167], v[184:187]
buffer_load_dwordx4 a[80:83], v248, s[24:27], s97 offen offset:0
v_mfma_f32_16x16x32_bf16 v[188:191], v[144:147], v[164:167], v[188:191]
ds_read_b128 v[136:139], v8 offset:640
v_mfma_f32_16x16x32_bf16 v[180:183], v[140:143], v[168:171], v[180:183]
ds_read_b128 v[164:167], v9 offset:336
v_mfma_f32_16x16x32_bf16 v[184:187], v[144:147], v[168:171], v[184:187]
buffer_load_dwordx4 a[84:87], v248, s[24:27], s97 offen offset:1024
v_mfma_f32_16x16x32_bf16 v[188:191], v[148:151], v[168:171], v[188:191]
s_waitcnt lgkmcnt(4)
v_mfma_f32_16x16x32_bf16 v[176:179], v[140:143], v[172:175], v[176:179]
ds_read_b128 v[140:143], v8 offset:704
v_mfma_f32_16x16x32_bf16 v[180:183], v[144:147], v[172:175], v[180:183]
ds_read_b128 v[168:171], v9 offset:400
v_mfma_f32_16x16x32_bf16 v[184:187], v[148:151], v[172:175], v[184:187]
buffer_load_dwordx4 a[88:91], v248, s[24:27], s97 offen offset:2048
v_mfma_f32_16x16x32_bf16 v[188:191], v[152:155], v[172:175], v[188:191]
s_waitcnt lgkmcnt(4)
v_mfma_f32_16x16x32_bf16 v[176:179], v[144:147], v[160:163], v[176:179]
ds_read_b128 v[144:147], v8 offset:768
v_mfma_f32_16x16x32_bf16 v[180:183], v[148:151], v[160:163], v[180:183]
ds_read_b128 v[172:175], v9 offset:464
v_mfma_f32_16x16x32_bf16 v[184:187], v[152:155], v[160:163], v[184:187]
buffer_load_dwordx4 a[92:95], v248, s[24:27], s97 offen offset:3072
v_mfma_f32_16x16x32_bf16 v[188:191], v[156:159], v[160:163], v[188:191]
s_waitcnt lgkmcnt(4)
v_mfma_f32_16x16x32_bf16 v[176:179], v[148:151], v[164:167], v[176:179]
ds_read_b128 v[148:151], v8 offset:832
v_mfma_f32_16x16x32_bf16 v[180:183], v[152:155], v[164:167], v[180:183]
ds_read_b128 v[160:163], v9 offset:544
v_mfma_f32_16x16x32_bf16 v[184:187], v[156:159], v[164:167], v[184:187]
buffer_load_dwordx4 a[96:99], v248, s[24:27], s98 offen
v_mfma_f32_16x16x32_bf16 v[188:191], v[128:131], v[164:167], v[188:191]
s_add_u32 s97, s97, 5120
s_cmp_eq_u32 s97, s80
s_cselect_b32 s97, s79, s97
s_add_u32 s98, s97, 4096
s_waitcnt lgkmcnt(4)
v_mfma_f32_16x16x32_bf16 v[176:179], v[152:155], v[168:171], v[176:179]
ds_read_b128 v[152:155], v8 offset:896
v_mfma_f32_16x16x32_bf16 v[180:183], v[156:159], v[168:171], v[180:183]
ds_read_b128 v[164:167], v9 offset:608
v_mfma_f32_16x16x32_bf16 v[184:187], v[128:131], v[168:171], v[184:187]
v_mfma_f32_16x16x32_bf16 v[188:191], v[132:135], v[168:171], v[188:191]
s_waitcnt lgkmcnt(4)
v_mfma_f32_16x16x32_bf16 v[176:179], v[156:159], v[172:175], v[176:179]
ds_read_b128 v[156:159], v8 offset:960
v_mfma_f32_16x16x32_bf16 v[180:183], v[128:131], v[172:175], v[180:183]
ds_read_b128 v[168:171], v9 offset:672
v_mfma_f32_16x16x32_bf16 v[184:187], v[132:135], v[172:175], v[184:187]
buffer_load_dwordx4 a[100:103], v248, s[24:27], s97 offen offset:0
v_mfma_f32_16x16x32_bf16 v[188:191], v[136:139], v[172:175], v[188:191]
s_waitcnt lgkmcnt(4)
v_mfma_f32_16x16x32_bf16 v[176:179], v[128:131], v[160:163], v[176:179]
ds_read_b128 v[128:131], v8 offset:1024
v_mfma_f32_16x16x32_bf16 v[180:183], v[132:135], v[160:163], v[180:183]
ds_read_b128 v[172:175], v9 offset:736
v_mfma_f32_16x16x32_bf16 v[184:187], v[136:139], v[160:163], v[184:187]
buffer_load_dwordx4 a[104:107], v248, s[24:27], s97 offen offset:1024
v_mfma_f32_16x16x32_bf16 v[188:191], v[140:143], v[160:163], v[188:191]
s_waitcnt lgkmcnt(4)
v_mfma_f32_16x16x32_bf16 v[176:179], v[132:135], v[164:167], v[176:179]
ds_read_b128 v[132:135], v8 offset:1088
v_mfma_f32_16x16x32_bf16 v[180:183], v[136:139], v[164:167], v[180:183]
ds_read_b128 v[160:163], v9 offset:816
v_mfma_f32_16x16x32_bf16 v[184:187], v[140:143], v[164:167], v[184:187]
buffer_load_dwordx4 a[108:111], v248, s[24:27], s97 offen offset:2048
v_mfma_f32_16x16x32_bf16 v[188:191], v[144:147], v[164:167], v[188:191]
s_waitcnt lgkmcnt(4)
v_mfma_f32_16x16x32_bf16 v[176:179], v[136:139], v[168:171], v[176:179]
ds_read_b128 v[136:139], v8 offset:1152
v_mfma_f32_16x16x32_bf16 v[180:183], v[140:143], v[168:171], v[180:183]
ds_read_b128 v[164:167], v9 offset:880
v_mfma_f32_16x16x32_bf16 v[184:187], v[144:147], v[168:171], v[184:187]
buffer_load_dwordx4 a[112:115], v248, s[24:27], s97 offen offset:3072
v_mfma_f32_16x16x32_bf16 v[188:191], v[148:151], v[168:171], v[188:191]
s_waitcnt lgkmcnt(4)
v_mfma_f32_16x16x32_bf16 v[176:179], v[140:143], v[172:175], v[176:179]
ds_read_b128 v[140:143], v8 offset:1216
v_mfma_f32_16x16x32_bf16 v[180:183], v[144:147], v[172:175], v[180:183]
ds_read_b128 v[168:171], v9 offset:944
v_mfma_f32_16x16x32_bf16 v[184:187], v[148:151], v[172:175], v[184:187]
buffer_load_dwordx4 a[116:119], v248, s[24:27], s98 offen
v_mfma_f32_16x16x32_bf16 v[188:191], v[152:155], v[172:175], v[188:191]
s_add_u32 s97, s97, 5120
s_cmp_eq_u32 s97, s80
s_cselect_b32 s97, s79, s97
s_add_u32 s98, s97, 4096
s_waitcnt lgkmcnt(4)
v_mfma_f32_16x16x32_bf16 v[176:179], v[144:147], v[160:163], v[176:179]
ds_read_b128 v[144:147], v8 offset:1280
v_mfma_f32_16x16x32_bf16 v[180:183], v[148:151], v[160:163], v[180:183]
ds_read_b128 v[172:175], v9 offset:1008
v_mfma_f32_16x16x32_bf16 v[184:187], v[152:155], v[160:163], v[184:187]
v_mfma_f32_16x16x32_bf16 v[188:191], v[156:159], v[160:163], v[188:191]
s_waitcnt lgkmcnt(4)
v_mfma_f32_16x16x32_bf16 v[176:179], v[148:151], v[164:167], v[176:179]
ds_read_b128 v[148:151], v8 offset:1344
v_mfma_f32_16x16x32_bf16 v[180:183], v[152:155], v[164:167], v[180:183]
ds_read_b128 v[160:163], v9 offset:1088
v_mfma_f32_16x16x32_bf16 v[184:187], v[156:159], v[164:167], v[184:187]
buffer_load_dwordx4 a[120:123], v248, s[24:27], s97 offen offset:0
v_mfma_f32_16x16x32_bf16 v[188:191], v[128:131], v[164:167], v[188:191]
s_waitcnt vmcnt(11)
s_barrier
s_cmp_lg_u32 s5, 0
s_cbranch_scc1 L_fl_31
s_mov_b64 exec, 1
buffer_store_dword v253, v252, s[24:27], 0 offen offset:16 sc1
s_mov_b64 exec, -1
L_fl_31:
s_waitcnt lgkmcnt(4)
v_mfma_f32_16x16x32_bf16 v[176:179], v[152:155], v[168:171], v[176:179]
ds_read_b128 v[152:155], v8 offset:1408
v_mfma_f32_16x16x32_bf16 v[180:183], v[156:159], v[168:171], v[180:183]
ds_read_b128 v[164:167], v9 offset:1152
v_mfma_f32_16x16x32_bf16 v[184:187], v[128:131], v[168:171], v[184:187]
buffer_load_dwordx4 a[124:127], v248, s[24:27], s97 offen offset:1024
v_mfma_f32_16x16x32_bf16 v[188:191], v[132:135], v[168:171], v[188:191]
s_waitcnt lgkmcnt(4)
v_mfma_f32_16x16x32_bf16 v[176:179], v[156:159], v[172:175], v[176:179]
ds_read_b128 v[156:159], v8 offset:1472
v_mfma_f32_16x16x32_bf16 v[180:183], v[128:131], v[172:175], v[180:183]
ds_read_b128 v[168:171], v9 offset:1216
v_mfma_f32_16x16x32_bf16 v[184:187], v[132:135], v[172:175], v[184:187]
buffer_load_dwordx4 a[128:131], v248, s[24:27], s97 offen offset:2048
v_mfma_f32_16x16x32_bf16 v[188:191], v[136:139], v[172:175], v[188:191]
s_waitcnt lgkmcnt(4)
v_mfma_f32_16x16x32_bf16 v[176:179], v[128:131], v[160:163], v[176:179]
ds_read_b128 v[128:131], v8 offset:1536
v_mfma_f32_16x16x32_bf16 v[180:183], v[132:135], v[160:163], v[180:183]
ds_read_b128 v[172:175], v9 offset:1280
v_mfma_f32_16x16x32_bf16 v[184:187], v[136:139], v[160:163], v[184:187]
buffer_load_dwordx4 a[132:135], v248, s[24:27], s97 offen offset:3072
v_mfma_f32_16x16x32_bf16 v[188:191], v[140:143], v[160:163], v[188:191]
s_waitcnt lgkmcnt(4)
v_mfma_f32_16x16x32_bf16 v[176:179], v[132:135], v[164:167], v[176:179]
ds_read_b128 v[132:135], v8 offset:1600
v_mfma_f32_16x16x32_bf16 v[180:183], v[136:139], v[164:167], v[180:183]
ds_read_b128 v[160:163], v9 offset:1360
v_mfma_f32_16x16x32_bf16 v[184:187], v[140:143], v[164:167], v[184:187]
buffer_load_dwordx4 a[136:139], v248, s[24:27], s98 offen
v_mfma_f32_16x16x32_bf16 v[188:191], v[144:147], v[164:167], v[188:191]
s_add_u32 s97, s97, 5120
s_cmp_eq_u32 s97, s80
s_cselect_b32 s97, s79, s97
s_add_u32 s98, s97, 4096
s_waitcnt lgkmcnt(4)
v_mfma_f32_16x16x32_bf16 v[176:179], v[136:139], v[168:171], v[176:179]
ds_read_b128 v[136:139], v8 offset:1664
v_mfma_f32_16x16x32_bf16 v[180:183], v[140:143], v[168:171], v[180:183]
ds_read_b128 v[164:167], v9 offset:1424
v_mfma_f32_16x16x32_bf16 v[184:187], v[144:147], v[168:171], v[184:187]
v_mfma_f32_16x16x32_bf16 v[188:191], v[148:151], v[168:171], v[188:191]
s_waitcnt lgkmcnt(4)
v_mfma_f32_16x16x32_bf16 v[176:179], v[140:143], v[172:175], v[176:179]
ds_read_b128 v[140:143], v8 offset:1728
v_mfma_f32_16x16x32_bf16 v[180:183], v[144:147], v[172:175], v[180:183]
ds_read_b128 v[168:171], v9 offset:1488
v_mfma_f32_16x16x32_bf16 v[184:187], v[148:151], v[172:175], v[184:187]
buffer_load_dwordx4 a[140:143], v248, s[24:27], s97 offen offset:0
v_mfma_f32_16x16x32_bf16 v[188:191], v[152:155], v[172:175], v[188:191]
s_waitcnt lgkmcnt(4)
v_mfma_f32_16x16x32_bf16 v[176:179], v[144:147], v[160:163], v[176:179]
ds_read_b128 v[144:147], v8 offset:1792
v_mfma_f32_16x16x32_bf16 v[180:183], v[148:151], v[160:163], v[180:183]
ds_read_b128 v[172:175], v9 offset:1552
v_mfma_f32_16x16x32_bf16 v[184:187], v[152:155], v[160:163], v[184:187]
buffer_load_dwordx4 a[144:147], v248, s[24:27], s97 offen offset:1024
v_mfma_f32_16x16x32_bf16 v[188:191], v[156:159], v[160:163], v[188:191]
s_waitcnt lgkmcnt(4)
v_mfma_f32_16x16x32_bf16 v[176:179], v[148:151], v[164:167], v[176:179]
ds_read_b128 v[148:151], v8 offset:1856
v_mfma_f32_16x16x32_bf16 v[180:183], v[152:155], v[164:167], v[180:183]
ds_read_b128 v[160:163], v9 offset:1632
v_mfma_f32_16x16x32_bf16 v[184:187], v[156:159], v[164:167], v[184:187]
buffer_load_dwordx4 a[148:151], v248, s[24:27], s97 offen offset:2048
v_mfma_f32_16x16x32_bf16 v[188:191], v[128:131], v[164:167], v[188:191]
s_waitcnt lgkmcnt(4)
v_mfma_f32_16x16x32_bf16 v[176:179], v[152:155], v[168:171], v[176:179]
ds_read_b128 v[152:155], v8 offset:1920
v_mfma_f32_16x16x32_bf16 v[180:183], v[156:159], v[168:171], v[180:183]
ds_read_b128 v[164:167], v9 offset:1696
v_mfma_f32_16x16x32_bf16 v[184:187], v[128:131], v[168:171], v[184:187]
buffer_load_dwordx4 a[152:155], v248, s[24:27], s97 offen offset:3072
v_mfma_f32_16x16x32_bf16 v[188:191], v[132:135], v[168:171], v[188:191]
s_waitcnt lgkmcnt(4)
v_mfma_f32_16x16x32_bf16 v[176:179], v[156:159], v[172:175], v[176:179]
ds_read_b128 v[156:159], v8 offset:1984
v_mfma_f32_16x16x32_bf16 v[180:183], v[128:131], v[172:175], v[180:183]
ds_read_b128 v[168:171], v9 offset:1760
v_mfma_f32_16x16x32_bf16 v[184:187], v[132:135], v[172:175], v[184:187]
buffer_load_dwordx4 a[156:159], v248, s[24:27], s98 offen
v_mfma_f32_16x16x32_bf16 v[188:191], v[136:139], v[172:175], v[188:191]
s_add_u32 s97, s97, 5120
s_cmp_eq_u32 s97, s80
s_cselect_b32 s97, s79, s97
s_add_u32 s98, s97, 4096
s_waitcnt lgkmcnt(4)
v_mfma_f32_16x16x32_bf16 v[176:179], v[128:131], v[160:163], v[176:179]
ds_read_b128 v[128:131], v8 offset:2048
v_mfma_f32_16x16x32_bf16 v[180:183], v[132:135], v[160:163], v[180:183]
ds_read_b128 v[172:175], v9 offset:1824
v_mfma_f32_16x16x32_bf16 v[184:187], v[136:139], v[160:163], v[184:187]
v_mfma_f32_16x16x32_bf16 v[188:191], v[140:143], v[160:163], v[188:191]
s_waitcnt lgkmcnt(4)
v_mfma_f32_16x16x32_bf16 v[176:179], v[132:135], v[164:167], v[176:179]
ds_read_b128 v[132:135], v8 offset:2112
v_mfma_f32_16x16x32_bf16 v[180:183], v[136:139], v[164:167], v[180:183]
ds_read_b128 v[160:163], v9 offset:1904
v_mfma_f32_16x16x32_bf16 v[184:187], v[140:143], v[164:167], v[184:187]
buffer_load_dwordx4 a[160:163], v248, s[24:27], s97 offen offset:0
v_mfma_f32_16x16x32_bf16 v[188:191], v[144:147], v[164:167], v[188:191]
s_waitcnt lgkmcnt(4)
v_mfma_f32_16x16x32_bf16 v[176:179], v[136:139], v[168:171], v[176:179]
ds_read_b128 v[136:139], v8 offset:2176
v_mfma_f32_16x16x32_bf16 v[180:183], v[140:143], v[168:171], v[180:183]
ds_read_b128 v[164:167], v9 offset:1968
v_mfma_f32_16x16x32_bf16 v[184:187], v[144:147], v[168:171], v[184:187]
buffer_load_dwordx4 a[164:167], v248, s[24:27], s97 offen offset:1024
v_mfma_f32_16x16x32_bf16 v[188:191], v[148:151], v[168:171], v[188:191]
s_waitcnt lgkmcnt(4)
v_mfma_f32_16x16x32_bf16 v[176:179], v[140:143], v[172:175], v[176:179]
ds_read_b128 v[140:143], v8 offset:2240
v_mfma_f32_16x16x32_bf16 v[180:183], v[144:147], v[172:175], v[180:183]
ds_read_b128 v[168:171], v9 offset:2032
v_mfma_f32_16x16x32_bf16 v[184:187], v[148:151], v[172:175], v[184:187]
buffer_load_dwordx4 a[168:171], v248, s[24:27], s97 offen offset:2048
v_mfma_f32_16x16x32_bf16 v[188:191], v[152:155], v[172:175], v[188:191]
s_waitcnt lgkmcnt(4)
v_mfma_f32_16x16x32_bf16 v[176:179], v[144:147], v[160:163], v[176:179]
ds_read_b128 v[144:147], v8 offset:2304
v_mfma_f32_16x16x32_bf16 v[180:183], v[148:151], v[160:163], v[180:183]
ds_read_b128 v[172:175], v9 offset:2096
v_mfma_f32_16x16x32_bf16 v[184:187], v[152:155], v[160:163], v[184:187]
buffer_load_dwordx4 a[172:175], v248, s[24:27], s97 offen offset:3072
v_mfma_f32_16x16x32_bf16 v[188:191], v[156:159], v[160:163], v[188:191]
s_waitcnt lgkmcnt(4)
v_mfma_f32_16x16x32_bf16 v[176:179], v[148:151], v[164:167], v[176:179]
ds_read_b128 v[148:151], v8 offset:2368
v_mfma_f32_16x16x32_bf16 v[180:183], v[152:155], v[164:167], v[180:183]
ds_read_b128 v[160:163], v9 offset:2176
v_mfma_f32_16x16x32_bf16 v[184:187], v[156:159], v[164:167], v[184:187]
buffer_load_dwordx4 a[176:179], v248, s[24:27], s98 offen
v_mfma_f32_16x16x32_bf16 v[188:191], v[128:131], v[164:167], v[188:191]
s_add_u32 s97, s97, 5120
s_cmp_eq_u32 s97, s80
s_cselect_b32 s97, s79, s97
s_add_u32 s98, s97, 4096
s_waitcnt lgkmcnt(4)
v_mfma_f32_16x16x32_bf16 v[176:179], v[152:155], v[168:171], v[176:179]
ds_read_b128 v[152:155], v8 offset:2432
v_mfma_f32_16x16x32_bf16 v[180:183], v[156:159], v[168:171], v[180:183]
ds_read_b128 v[164:167], v9 offset:2240
v_mfma_f32_16x16x32_bf16 v[184:187], v[128:131], v[168:171], v[184:187]
v_mfma_f32_16x16x32_bf16 v[188:191], v[132:135], v[168:171], v[188:191]
s_waitcnt lgkmcnt(4)
v_mfma_f32_16x16x32_bf16 v[176:179], v[156:159], v[172:175], v[176:179]
ds_read_b128 v[156:159], v8 offset:2496
v_mfma_f32_16x16x32_bf16 v[180:183], v[128:131], v[172:175], v[180:183]
ds_read_b128 v[168:171], v9 offset:2304
v_mfma_f32_16x16x32_bf16 v[184:187], v[132:135], v[172:175], v[184:187]
v_mfma_f32_16x16x32_bf16 v[188:191], v[136:139], v[172:175], v[188:191]
s_cmp_eq_u32 s86, 0
s_cbranch_scc1 L_two_32
L_halfb_33:
s_waitcnt lgkmcnt(4)
v_mfma_f32_16x16x32_bf16 v[176:179], v[128:131], v[160:163], v[176:179]
ds_read_b128 v[128:131], v8 offset:2560
v_mfma_f32_16x16x32_bf16 v[180:183], v[132:135], v[160:163], v[180:183]
ds_read_b128 v[172:175], v9 offset:2368
v_mfma_f32_16x16x32_bf16 v[184:187], v[136:139], v[160:163], v[184:187]
buffer_load_dwordx4 a[180:183], v248, s[24:27], s97 offen offset:0
v_mfma_f32_16x16x32_bf16 v[188:191], v[140:143], v[160:163], v[188:191]
buffer_load_dwordx4 a[184:187], v248, s[24:27], s97 offen offset:1024
s_waitcnt lgkmcnt(4)
v_mfma_f32_16x16x32_bf16 v[176:179], v[132:135], v[164:167], v[176:179]
ds_read_b128 v[132:135], v8 offset:2624
v_mfma_f32_16x16x32_bf16 v[180:183], v[136:139], v[164:167], v[180:183]
ds_read_b128 v[160:163], v9 offset:2448
v_mfma_f32_16x16x32_bf16 v[184:187], v[140:143], v[164:167], v[184:187]
buffer_load_dwordx4 a[188:191], v248, s[24:27], s97 offen offset:2048
v_mfma_f32_16x16x32_bf16 v[188:191], v[144:147], v[164:167], v[188:191]
s_waitcnt lgkmcnt(4)
v_mfma_f32_16x16x32_bf16 v[176:179], v[136:139], v[168:171], v[176:179]
ds_read_b128 v[136:139], v8 offset:2688
v_mfma_f32_16x16x32_bf16 v[180:183], v[140:143], v[168:171], v[180:183]
ds_read_b128 v[164:167], v9 offset:2512
v_mfma_f32_16x16x32_bf16 v[184:187], v[144:147], v[168:171], v[184:187]
buffer_load_dwordx4 a[192:195], v248, s[24:27], s97 offen offset:3072
v_mfma_f32_16x16x32_bf16 v[188:191], v[148:151], v[168:171], v[188:191]
s_waitcnt lgkmcnt(4)
v_mfma_f32_16x16x32_bf16 v[176:179], v[140:143], v[172:175], v[176:179]
ds_read_b128 v[140:143], v8 offset:2752
v_mfma_f32_16x16x32_bf16 v[180:183], v[144:147], v[172:175], v[180:183]
ds_read_b128 v[168:171], v9 offset:2576
v_mfma_f32_16x16x32_bf16 v[184:187], v[148:151], v[172:175], v[184:187]
buffer_load_dwordx4 a[196:199], v248, s[24:27], s98 offen
v_mfma_f32_16x16x32_bf16 v[188:191], v[152:155], v[172:175], v[188:191]
s_add_u32 s97, s97, 5120
s_cmp_eq_u32 s97, s80
s_cselect_b32 s97, s79, s97
s_add_u32 s98, s97, 4096
s_waitcnt lgkmcnt(4)
v_mfma_f32_16x16x32_bf16 v[176:179], v[144:147], v[160:163], v[176:179]
ds_read_b128 v[144:147], v8 offset:2816
v_mfma_f32_16x16x32_bf16 v[180:183], v[148:151], v[160:163], v[180:183]
ds_read_b128 v[172:175], v9 offset:2640
v_mfma_f32_16x16x32_bf16 v[184:187], v[152:155], v[160:163], v[184:187]
buffer_load_dwordx4 a[200:203], v248, s[24:27], s97 offen offset:0
v_mfma_f32_16x16x32_bf16 v[188:191], v[156:159], v[160:163], v[188:191]
s_waitcnt lgkmcnt(4)
v_mfma_f32_16x16x32_bf16 v[176:179], v[148:151], v[164:167], v[176:179]
ds_read_b128 v[148:151], v8 offset:2880
v_mfma_f32_16x16x32_bf16 v[180:183], v[152:155], v[164:167], v[180:183]
ds_read_b128 v[160:163], v9 offset:2720
v_mfma_f32_16x16x32_bf16 v[184:187], v[156:159], v[164:167], v[184:187]
buffer_load_dwordx4 a[204:207], v248, s[24:27], s97 offen offset:1024
v_mfma_f32_16x16x32_bf16 v[188:191], v[128:131], v[164:167], v[188:191]
s_waitcnt lgkmcnt(4)
v_mfma_f32_16x16x32_bf16 v[176:179], v[152:155], v[168:171], v[176:179]
ds_read_b128 v[152:155], v8 offset:2944
v_mfma_f32_16x16x32_bf16 v[180:183], v[156:159], v[168:171], v[180:183]
ds_read_b128 v[164:167], v9 offset:2784
v_mfma_f32_16x16x32_bf16 v[184:187], v[128:131], v[168:171], v[184:187]
buffer_load_dwordx4 a[208:211], v248, s[24:27], s97 offen offset:2048
v_mfma_f32_16x16x32_bf16 v[188:191], v[132:135], v[168:171], v[188:191]
s_waitcnt lgkmcnt(4)
v_mfma_f32_16x16x32_bf16 v[176:179], v[156:159], v[172:175], v[176:179]
ds_read_b128 v[156:159], v8 offset:3008
v_mfma_f32_16x16x32_bf16 v[180:183], v[128:131], v[172:175], v[180:183]
ds_read_b128 v[168:171], v9 offset:2848
v_mfma_f32_16x16x32_bf16 v[184:187], v[132:135], v[172:175], v[184:187]
buffer_load_dwordx4 a[212:215], v248, s[24:27], s97 offen offset:3072
v_mfma_f32_16x16x32_bf16 v[188:191], v[136:139], v[172:175], v[188:191]
buffer_load_dwordx4 a[216:219], v248, s[24:27], s98 offen
s_add_u32 s97, s97, 5120
s_cmp_eq_u32 s97, s80
s_cselect_b32 s97, s79, s97
s_add_u32 s98, s97, 4096
s_waitcnt lgkmcnt(4)
v_mfma_f32_16x16x32_bf16 v[176:179], v[128:131], v[160:163], v[176:179]
ds_read_b128 v[128:131], v8 offset:3072
v_mfma_f32_16x16x32_bf16 v[180:183], v[132:135], v[160:163], v[180:183]
ds_read_b128 v[172:175], v9 offset:2912
v_mfma_f32_16x16x32_bf16 v[184:187], v[136:139], v[160:163], v[184:187]
buffer_load_dwordx4 a[220:223], v248, s[24:27], s97 offen offset:0
v_mfma_f32_16x16x32_bf16 v[188:191], v[140:143], v[160:163], v[188:191]
s_waitcnt lgkmcnt(4)
v_mfma_f32_16x16x32_bf16 v[176:179], v[132:135], v[164:167], v[176:179]
ds_read_b128 v[132:135], v8 offset:3136
v_mfma_f32_16x16x32_bf16 v[180:183], v[136:139], v[164:167], v[180:183]
ds_read_b128 v[160:163], v9 offset:2992
v_mfma_f32_16x16x32_bf16 v[184:187], v[140:143], v[164:167], v[184:187]
buffer_load_dwordx4 a[224:227], v248, s[24:27], s97 offen offset:1024
v_mfma_f32_16x16x32_bf16 v[188:191], v[144:147], v[164:167], v[188:191]
s_waitcnt lgkmcnt(4)
v_mfma_f32_16x16x32_bf16 v[176:179], v[136:139], v[168:171], v[176:179]
ds_read_b128 v[136:139], v8 offset:3200
v_mfma_f32_16x16x32_bf16 v[180:183], v[140:143], v[168:171], v[180:183]
ds_read_b128 v[164:167], v9 offset:3056
v_mfma_f32_16x16x32_bf16 v[184:187], v[144:147], v[168:171], v[184:187]
buffer_load_dwordx4 a[228:231], v248, s[24:27], s97 offen offset:2048
v_mfma_f32_16x16x32_bf16 v[188:191], v[148:151], v[168:171], v[188:191]
s_waitcnt lgkmcnt(4)
v_mfma_f32_16x16x32_bf16 v[176:179], v[140:143], v[172:175], v[176:179]
ds_read_b128 v[140:143], v8 offset:3264
v_mfma_f32_16x16x32_bf16 v[180:183], v[144:147], v[172:175], v[180:183]
ds_read_b128 v[168:171], v9 offset:3120
v_mfma_f32_16x16x32_bf16 v[184:187], v[148:151], v[172:175], v[184:187]
buffer_load_dwordx4 a[232:235], v248, s[24:27], s97 offen offset:3072
v_mfma_f32_16x16x32_bf16 v[188:191], v[152:155], v[172:175], v[188:191]
buffer_load_dword v254, v249, s[24:27], 0 offen sc1
s_waitcnt lgkmcnt(4)
v_mfma_f32_16x16x32_bf16 v[176:179], v[144:147], v[160:163], v[176:179]
ds_read_b128 v[144:147], v8 offset:3328
v_mfma_f32_16x16x32_bf16 v[180:183], v[148:151], v[160:163], v[180:183]
ds_read_b128 v[172:175], v9 offset:3184
v_mfma_f32_16x16x32_bf16 v[184:187], v[152:155], v[160:163], v[184:187]
buffer_load_dwordx4 a[236:239], v248, s[24:27], s98 offen
v_mfma_f32_16x16x32_bf16 v[188:191], v[156:159], v[160:163], v[188:191]
s_add_u32 s97, s97, 5120
s_cmp_eq_u32 s97, s80
s_cselect_b32 s97, s79, s97
s_add_u32 s98, s97, 4096
s_waitcnt lgkmcnt(4)
v_mfma_f32_16x16x32_bf16 v[176:179], v[148:151], v[164:167], v[176:179]
ds_read_b128 v[148:151], v8 offset:3392
v_mfma_f32_16x16x32_bf16 v[180:183], v[152:155], v[164:167], v[180:183]
ds_read_b128 v[160:163], v9 offset:3264
v_mfma_f32_16x16x32_bf16 v[184:187], v[156:159], v[164:167], v[184:187]
buffer_load_dwordx4 v[208:211], v248, s[24:27], s97 offen offset:0
v_mfma_f32_16x16x32_bf16 v[188:191], v[128:131], v[164:167], v[188:191]
s_waitcnt lgkmcnt(4)
v_mfma_f32_16x16x32_bf16 v[176:179], v[152:155], v[168:171], v[176:179]
ds_read_b128 v[152:155], v8 offset:3456
v_mfma_f32_16x16x32_bf16 v[180:183], v[156:159], v[168:171], v[180:183]
ds_read_b128 v[164:167], v9 offset:3328
v_mfma_f32_16x16x32_bf16 v[184:187], v[128:131], v[168:171], v[184:187]
buffer_load_dwordx4 v[212:215], v248, s[24:27], s97 offen offset:1024
v_mfma_f32_16x16x32_bf16 v[188:191], v[132:135], v[168:171], v[188:191]
buffer_load_dwordx4 v[216:219], v248, s[24:27], s97 offen offset:2048
s_waitcnt lgkmcnt(4)
v_mfma_f32_16x16x32_bf16 v[176:179], v[156:159], v[172:175], v[176:179]
ds_read_b128 v[156:159], v8 offset:3520
v_mfma_f32_16x16x32_bf16 v[180:183], v[128:131], v[172:175], v[180:183]
ds_read_b128 v[168:171], v9 offset:3392
v_mfma_f32_16x16x32_bf16 v[184:187], v[132:135], v[172:175], v[184:187]
buffer_load_dwordx4 v[220:223], v248, s[24:27], s97 offen offset:3072
v_mfma_f32_16x16x32_bf16 v[188:191], v[136:139], v[172:175], v[188:191]
s_waitcnt lgkmcnt(4)
v_mfma_f32_16x16x32_bf16 v[176:179], v[128:131], v[160:163], v[176:179]
ds_read_b128 v[128:131], v8 offset:3584
v_mfma_f32_16x16x32_bf16 v[180:183], v[132:135], v[160:163], v[180:183]
ds_read_b128 v[172:175], v9 offset:3456
v_mfma_f32_16x16x32_bf16 v[184:187], v[136:139], v[160:163], v[184:187]
buffer_load_dwordx4 v[224:227], v248, s[24:27], s98 offen
v_mfma_f32_16x16x32_bf16 v[188:191], v[140:143], v[160:163], v[188:191]
s_add_u32 s97, s97, 5120
s_cmp_eq_u32 s97, s80
s_cselect_b32 s97, s79, s97
s_add_u32 s98, s97, 4096
s_waitcnt lgkmcnt(4)
v_mfma_f32_16x16x32_bf16 v[176:179], v[132:135], v[164:167], v[176:179]
ds_read_b128 v[132:135], v8 offset:3648
v_mfma_f32_16x16x32_bf16 v[180:183], v[136:139], v[164:167], v[180:183]
ds_read_b128 v[160:163], v9 offset:3536
v_mfma_f32_16x16x32_bf16 v[184:187], v[140:143], v[164:167], v[184:187]
buffer_load_dwordx4 v[228:231], v248, s[24:27], s97 offen offset:0
v_mfma_f32_16x16x32_bf16 v[188:191], v[144:147], v[164:167], v[188:191]
s_waitcnt lgkmcnt(4)
v_mfma_f32_16x16x32_bf16 v[176:179], v[136:139], v[168:171], v[176:179]
ds_read_b128 v[136:139], v8 offset:3712
v_mfma_f32_16x16x32_bf16 v[180:183], v[140:143], v[168:171], v[180:183]
ds_read_b128 v[164:167], v9 offset:3600
v_mfma_f32_16x16x32_bf16 v[184:187], v[144:147], v[168:171], v[184:187]
buffer_load_dwordx4 v[232:235], v248, s[24:27], s97 offen offset:1024
v_mfma_f32_16x16x32_bf16 v[188:191], v[148:151], v[168:171], v[188:191]
s_waitcnt lgkmcnt(4)
v_mfma_f32_16x16x32_bf16 v[176:179], v[140:143], v[172:175], v[176:179]
ds_read_b128 v[140:143], v8 offset:3776
v_mfma_f32_16x16x32_bf16 v[180:183], v[144:147], v[172:175], v[180:183]
ds_read_b128 v[168:171], v9 offset:3664
v_mfma_f32_16x16x32_bf16 v[184:187], v[148:151], v[172:175], v[184:187]
buffer_load_dwordx4 v[236:239], v248, s[24:27], s97 offen offset:2048
v_mfma_f32_16x16x32_bf16 v[188:191], v[152:155], v[172:175], v[188:191]
s_waitcnt lgkmcnt(4)
v_mfma_f32_16x16x32_bf16 v[176:179], v[144:147], v[160:163], v[176:179]
ds_read_b128 v[144:147], v8 offset:3840
v_mfma_f32_16x16x32_bf16 v[180:183], v[148:151], v[160:163], v[180:183]
ds_read_b128 v[172:175], v9 offset:3728
v_mfma_f32_16x16x32_bf16 v[184:187], v[152:155], v[160:163], v[184:187]
buffer_load_dwordx4 v[240:243], v248, s[24:27], s97 offen offset:3072
v_mfma_f32_16x16x32_bf16 v[188:191], v[156:159], v[160:163], v[188:191]
s_waitcnt lgkmcnt(4)
v_mfma_f32_16x16x32_bf16 v[176:179], v[148:151], v[164:167], v[176:179]
ds_read_b128 v[148:151], v8 offset:3904
v_mfma_f32_16x16x32_bf16 v[180:183], v[152:155], v[164:167], v[180:183]
ds_read_b128 v[160:163], v9 offset:3808
v_mfma_f32_16x16x32_bf16 v[184:187], v[156:159], v[164:167], v[184:187]
buffer_load_dwordx4 v[244:247], v248, s[24:27], s98 offen
v_mfma_f32_16x16x32_bf16 v[188:191], v[128:131], v[164:167], v[188:191]
s_add_u32 s97, s97, 5120
s_cmp_eq_u32 s97, s80
s_cselect_b32 s97, s79, s97
s_add_u32 s98, s97, 4096
s_waitcnt vmcnt(11)
v_cmp_eq_u32 vcc, 0, v254
s_cbranch_vccnz L_slow_34
L_back_35:
s_mul_i32 s6, s94, 54
s_add_u32 s6, s6, s96
s_lshl_b32 s81, s6, 12
s_add_u32 s81, s81, 10485760
s_cmp_ge_u32 s5, 2
s_cselect_b32 s7, 13, 14
s_lshl_b32 s7, s7, 12
s_add_u32 s82, s81, s7
s_lshl_b32 s7, s93, 12
s_add_u32 s99, s81, s7
s_add_u32 s6, s5, 0
s_and_b32 s6, s6, 3
s_lshl_b32 s6, s6, 10
v_add_u32 v56, s6, v248
s_add_u32 s6, s5, 1
s_and_b32 s6, s6, 3
s_lshl_b32 s6, s6, 10
v_add_u32 v57, s6, v248
s_add_u32 s6, s5, 2
s_and_b32 s6, s6, 3
s_lshl_b32 s6, s6, 10
v_add_u32 v58, s6, v248
s_add_u32 s6, s5, 3
s_and_b32 s6, s6, 3
s_lshl_b32 s6, s6, 10
v_add_u32 v59, s6, v248
s_waitcnt lgkmcnt(4)
v_mfma_f32_16x16x32_bf16 v[176:179], v[152:155], v[168:171], v[176:179]
ds_read_b128 v[152:155], v8 offset:3968
v_mfma_f32_16x16x32_bf16 v[180:183], v[156:159], v[168:171], v[180:183]
ds_read_b128 v[164:167], v9 offset:3872
v_mfma_f32_16x16x32_bf16 v[184:187], v[128:131], v[168:171], v[184:187]
v_mfma_f32_16x16x32_bf16 v[188:191], v[132:135], v[168:171], v[188:191]
s_waitcnt lgkmcnt(4)
v_mfma_f32_16x16x32_bf16 v[176:179], v[156:159], v[172:175], v[176:179]
ds_read_b128 v[156:159], v8 offset:4032
v_mfma_f32_16x16x32_bf16 v[180:183], v[128:131], v[172:175], v[180:183]
ds_read_b128 v[168:171], v9 offset:3936
v_mfma_f32_16x16x32_bf16 v[184:187], v[132:135], v[172:175], v[184:187]
buffer_load_dwordx4 v[64:67], v56, s[24:27], s99 offen
v_mfma_f32_16x16x32_bf16 v[188:191], v[136:139], v[172:175], v[188:191]
buffer_load_dwordx4 v[68:71], v57, s[24:27], s99 offen
buffer_load_dwordx4 v[72:75], v58, s[24:27], s99 offen
buffer_load_dwordx4 v[76:79], v59, s[24:27], s99 offen
s_add_u32 s99, s99, 4096
s_cmp_eq_u32 s99, s82
s_cselect_b32 s99, s81, s99
s_waitcnt lgkmcnt(4)
v_mfma_f32_16x16x32_bf16 v[176:179], v[128:131], v[160:163], v[176:179]
ds_read_b128 v[128:131], v8 offset:4096
v_mfma_f32_16x16x32_bf16 v[180:183], v[132:135], v[160:163], v[180:183]
ds_read_b128 v[172:175], v9 offset:4000
v_mfma_f32_16x16x32_bf16 v[184:187], v[136:139], v[160:163], v[184:187]
v_mfma_f32_16x16x32_bf16 v[188:191], v[140:143], v[160:163], v[188:191]
s_waitcnt lgkmcnt(4)
v_mfma_f32_16x16x32_bf16 v[176:179], v[132:135], v[164:167], v[176:179]
ds_read_b128 v[132:135], v8 offset:4160
v_mfma_f32_16x16x32_bf16 v[180:183], v[136:139], v[164:167], v[180:183]
ds_read_b128 v[160:163], v9 offset:4080
v_mfma_f32_16x16x32_bf16 v[184:187], v[140:143], v[164:167], v[184:187]
v_mfma_f32_16x16x32_bf16 v[188:191], v[144:147], v[164:167], v[188:191]
s_waitcnt lgkmcnt(4)
v_mfma_f32_16x16x32_bf16 v[176:179], v[136:139], v[168:171], v[176:179]
ds_read_b128 v[136:139], v8 offset:4224
v_mfma_f32_16x16x32_bf16 v[180:183], v[140:143], v[168:171], v[180:183]
ds_read_b128 v[164:167], v9 offset:4144
v_mfma_f32_16x16x32_bf16 v[184:187], v[144:147], v[168:171], v[184:187]
buffer_load_dwordx4 v[80:83], v56, s[24:27], s99 offen
v_mfma_f32_16x16x32_bf16 v[188:191], v[148:151], v[168:171], v[188:191]
buffer_load_dwordx4 v[84:87], v57, s[24:27], s99 offen
buffer_load_dwordx4 v[88:91], v58, s[24:27], s99 offen
buffer_load_dwordx4 v[92:95], v59, s[24:27], s99 offen
s_add_u32 s99, s99, 4096
s_cmp_eq_u32 s99, s82
s_cselect_b32 s99, s81, s99
s_waitcnt lgkmcnt(4)
v_mfma_f32_16x16x32_bf16 v[176:179], v[140:143], v[172:175], v[176:179]
ds_read_b128 v[140:143], v8 offset:4288
v_mfma_f32_16x16x32_bf16 v[180:183], v[144:147], v[172:175], v[180:183]
ds_read_b128 v[168:171], v9 offset:4208
v_mfma_f32_16x16x32_bf16 v[184:187], v[148:151], v[172:175], v[184:187]
v_mfma_f32_16x16x32_bf16 v[188:191], v[152:155], v[172:175], v[188:191]
s_waitcnt lgkmcnt(4)
v_mfma_f32_16x16x32_bf16 v[176:179], v[144:147], v[160:163], v[176:179]
ds_read_b128 v[144:147], v8 offset:4352
v_mfma_f32_16x16x32_bf16 v[180:183], v[148:151], v[160:163], v[180:183]
ds_read_b128 v[172:175], v9 offset:4272
v_mfma_f32_16x16x32_bf16 v[184:187], v[152:155], v[160:163], v[184:187]
v_mfma_f32_16x16x32_bf16 v[188:191], v[156:159], v[160:163], v[188:191]
s_waitcnt lgkmcnt(4)
v_mfma_f32_16x16x32_bf16 v[176:179], v[148:151], v[164:167], v[176:179]
ds_read_b128 v[148:151], v8 offset:4416
v_mfma_f32_16x16x32_bf16 v[180:183], v[152:155], v[164:167], v[180:183]
ds_read_b128 v[160:163], v9 offset:4352
v_mfma_f32_16x16x32_bf16 v[184:187], v[156:159], v[164:167], v[184:187]
buffer_load_dwordx4 v[96:99], v56, s[24:27], s99 offen
v_mfma_f32_16x16x32_bf16 v[188:191], v[128:131], v[164:167], v[188:191]
buffer_load_dwordx4 v[100:103], v57, s[24:27], s99 offen
buffer_load_dwordx4 v[104:107], v58, s[24:27], s99 offen
buffer_load_dwordx4 v[108:111], v59, s[24:27], s99 offen
s_add_u32 s99, s99, 4096
s_cmp_eq_u32 s99, s82
s_cselect_b32 s99, s81, s99
s_waitcnt lgkmcnt(4)
v_mfma_f32_16x16x32_bf16 v[176:179], v[152:155], v[168:171], v[176:179]
ds_read_b128 v[152:155], v8 offset:4480
v_mfma_f32_16x16x32_bf16 v[180:183], v[156:159], v[168:171], v[180:183]
ds_read_b128 v[164:167], v9 offset:4416
v_mfma_f32_16x16x32_bf16 v[184:187], v[128:131], v[168:171], v[184:187]
v_mfma_f32_16x16x32_bf16 v[188:191], v[132:135], v[168:171], v[188:191]
s_waitcnt lgkmcnt(4)
v_mfma_f32_16x16x32_bf16 v[176:179], v[156:159], v[172:175], v[176:179]
ds_read_b128 v[156:159], v8 offset:4544
v_mfma_f32_16x16x32_bf16 v[180:183], v[128:131], v[172:175], v[180:183]
ds_read_b128 v[168:171], v9 offset:4480
v_mfma_f32_16x16x32_bf16 v[184:187], v[132:135], v[172:175], v[184:187]
v_mfma_f32_16x16x32_bf16 v[188:191], v[136:139], v[172:175], v[188:191]
s_waitcnt lgkmcnt(0)
ds_read_b128 v[128:131], v10 offset:240
ds_read_b128 v[132:135], v10 offset:176
ds_read_b128 v[136:139], v10 offset:112
ds_read_b128 v[140:143], v10 offset:48
s_and_b32 s6, s88, 0xfffffffe
s_sub_u32 s6, s91, s6
s_cmp_ge_u32 s6, 2
s_cselect_b32 s92, s1, s0
s_and_b32 s6, s6, 1
s_lshl_b32 s6, s6, 4
s_lshr_b32 s92, s92, s6
s_lshl_b32 s92, s92, 16
s_lshl_b32 s6, s91, 12
s_add_u32 s6, s6, 4194304
s_nop 4
s_waitcnt lgkmcnt(0)
v_lshlrev_b32 v131, 16, v131
v_fma_f32 v176, v131, s92, v176
v_lshlrev_b32 v130, 16, v130
v_fma_f32 v177, v130, s92, v177
v_lshlrev_b32 v129, 16, v129
v_fma_f32 v178, v129, s92, v178
v_lshlrev_b32 v128, 16, v128
v_fma_f32 v179, v128, s92, v179
v_lshlrev_b32 v135, 16, v135
v_fma_f32 v180, v135, s92, v180
v_lshlrev_b32 v134, 16, v134
v_fma_f32 v181, v134, s92, v181
v_lshlrev_b32 v133, 16, v133
v_fma_f32 v182, v133, s92, v182
v_lshlrev_b32 v132, 16, v132
v_fma_f32 v183, v132, s92, v183
v_lshlrev_b32 v139, 16, v139
v_fma_f32 v184, v139, s92, v184
v_lshlrev_b32 v138, 16, v138
v_fma_f32 v185, v138, s92, v185
v_lshlrev_b32 v137, 16, v137
v_fma_f32 v186, v137, s92, v186
v_lshlrev_b32 v136, 16, v136
v_fma_f32 v187, v136, s92, v187
v_lshlrev_b32 v143, 16, v143
v_fma_f32 v188, v143, s92, v188
v_lshlrev_b32 v142, 16, v142
v_fma_f32 v189, v142, s92, v189
v_lshlrev_b32 v141, 16, v141
v_fma_f32 v190, v141, s92, v190
v_lshlrev_b32 v140, 16, v140
v_fma_f32 v191, v140, s92, v191
v_cvt_pk_bf16_f32 v160, v176, v177
v_cvt_pk_bf16_f32 v161, v178, v179
v_cvt_pk_bf16_f32 v162, v180, v181
v_cvt_pk_bf16_f32 v163, v182, v183
buffer_store_dwordx4 v[160:163], v11, s[24:27], s6 offen offset:0 sc1
v_cvt_pk_bf16_f32 v164, v184, v185
v_cvt_pk_bf16_f32 v165, v186, v187
v_cvt_pk_bf16_f32 v166, v188, v189
v_cvt_pk_bf16_f32 v167, v190, v191
buffer_store_dwordx4 v[164:167], v11, s[24:27], s6 offen offset:128 sc1
L_gemm2:
s_waitcnt vmcnt(10)
v_mfma_f32_16x16x32_bf16 v[128:131], a[0:3], v[64:67], 0
buffer_load_dwordx4 v[112:115], v56, s[24:27], s99 offen
v_mfma_f32_16x16x32_bf16 v[148:151], a[0:3], v[68:71], 0
v_mfma_f32_16x16x32_bf16 v[168:171], a[0:3], v[72:75], 0
v_mfma_f32_16x16x32_bf16 v[188:191], a[0:3], v[76:79], 0
v_mfma_f32_16x16x32_bf16 v[132:135], a[4:7], v[64:67], 0
buffer_load_dwordx4 v[116:119], v57, s[24:27], s99 offen
v_mfma_f32_16x16x32_bf16 v[152:155], a[4:7], v[68:71], 0
v_mfma_f32_16x16x32_bf16 v[172:175], a[4:7], v[72:75], 0
v_mfma_f32_16x16x32_bf16 v[192:195], a[4:7], v[76:79], 0
v_mfma_f32_16x16x32_bf16 v[136:139], a[8:11], v[64:67], 0
buffer_load_dwordx4 v[120:123], v58, s[24:27], s99 offen
v_mfma_f32_16x16x32_bf16 v[156:159], a[8:11], v[68:71], 0
v_mfma_f32_16x16x32_bf16 v[176:179], a[8:11], v[72:75], 0
v_mfma_f32_16x16x32_bf16 v[196:199], a[8:11], v[76:79], 0
v_mfma_f32_16x16x32_bf16 v[140:143], a[12:15], v[64:67], 0
buffer_load_dwordx4 v[124:127], v59, s[24:27], s99 offen
v_mfma_f32_16x16x32_bf16 v[160:163], a[12:15], v[68:71], 0
v_mfma_f32_16x16x32_bf16 v[180:183], a[12:15], v[72:75], 0
v_mfma_f32_16x16x32_bf16 v[200:203], a[12:15], v[76:79], 0
v_mfma_f32_16x16x32_bf16 v[144:147], a[16:19], v[64:67], 0
s_add_u32 s99, s99, 4096
s_cmp_eq_u32 s99, s82
s_cselect_b32 s99, s81, s99
v_mfma_f32_16x16x32_bf16 v[164:167], a[16:19], v[68:71], 0
v_mfma_f32_16x16x32_bf16 v[184:187], a[16:19], v[72:75], 0
v_mfma_f32_16x16x32_bf16 v[204:207], a[16:19], v[76:79], 0
s_waitcnt vmcnt(10)
v_mfma_f32_16x16x32_bf16 v[128:131], a[20:23], v[80:83], v[128:131]
buffer_load_dwordx4 v[64:67], v56, s[24:27], s99 offen
v_mfma_f32_16x16x32_bf16 v[148:151], a[20:23], v[84:87], v[148:151]
v_mfma_f32_16x16x32_bf16 v[168:171], a[20:23], v[88:91], v[168:171]
v_mfma_f32_16x16x32_bf16 v[188:191], a[20:23], v[92:95], v[188:191]
v_mfma_f32_16x16x32_bf16 v[132:135], a[24:27], v[80:83], v[132:135]
buffer_load_dwordx4 v[68:71], v57, s[24:27], s99 offen
v_mfma_f32_16x16x32_bf16 v[152:155], a[24:27], v[84:87], v[152:155]
v_mfma_f32_16x16x32_bf16 v[172:175], a[24:27], v[88:91], v[172:175]
v_mfma_f32_16x16x32_bf16 v[192:195], a[24:27], v[92:95], v[192:195]
v_mfma_f32_16x16x32_bf16 v[136:139], a[28:31], v[80:83], v[136:139]
buffer_load_dwordx4 v[72:75], v58, s[24:27], s99 offen
v_mfma_f32_16x16x32_bf16 v[156:159], a[28:31], v[84:87], v[156:159]
v_mfma_f32_16x16x32_bf16 v[176:179], a[28:31], v[88:91], v[176:179]
v_mfma_f32_16x16x32_bf16 v[196:199], a[28:31], v[92:95], v[196:199]
v_mfma_f32_16x16x32_bf16 v[140:143], a[32:35], v[80:83], v[140:143]
buffer_load_dwordx4 v[76:79], v59, s[24:27], s99 offen
v_mfma_f32_16x16x32_bf16 v[160:163], a[32:35], v[84:87], v[160:163]
v_mfma_f32_16x16x32_bf16 v[180:183], a[32:35], v[88:91], v[180:183]
v_mfma_f32_16x16x32_bf16 v[200:203], a[32:35], v[92:95], v[200:203]
v_mfma_f32_16x16x32_bf16 v[144:147], a[36:39], v[80:83], v[144:147]
s_add_u32 s99, s99, 4096
s_cmp_eq_u32 s99, s82
s_cselect_b32 s99, s81, s99
v_mfma_f32_16x16x32_bf16 v[164:167], a[36:39], v[84:87], v[164:167]
v_mfma_f32_16x16x32_bf16 v[184:187], a[36:39], v[88:91], v[184:187]
v_mfma_f32_16x16x32_bf16 v[204:207], a[36:39], v[92:95], v[204:207]
s_waitcnt vmcnt(10)
v_mfma_f32_16x16x32_bf16 v[128:131], a[40:43], v[96:99], v[128:131]
buffer_load_dwordx4 v[80:83], v56, s[24:27], s99 offen
v_mfma_f32_16x16x32_bf16 v[148:151], a[40:43], v[100:103], v[148:151]
v_mfma_f32_16x16x32_bf16 v[168:171], a[40:43], v[104:107], v[168:171]
v_mfma_f32_16x16x32_bf16 v[188:191], a[40:43], v[108:111], v[188:191]
v_mfma_f32_16x16x32_bf16 v[132:135], a[44:47], v[96:99], v[132:135]
buffer_load_dwordx4 v[84:87], v57, s[24:27], s99 offen
v_mfma_f32_16x16x32_bf16 v[152:155], a[44:47], v[100:103], v[152:155]
v_mfma_f32_16x16x32_bf16 v[172:175], a[44:47], v[104:107], v[172:175]
v_mfma_f32_16x16x32_bf16 v[192:195], a[44:47], v[108:111], v[192:195]
v_mfma_f32_16x16x32_bf16 v[136:139], a[48:51], v[96:99], v[136:139]
buffer_load_dwordx4 v[88:91], v58, s[24:27], s99 offen
v_mfma_f32_16x16x32_bf16 v[156:159], a[48:51], v[100:103], v[156:159]
v_mfma_f32_16x16x32_bf16 v[176:179], a[48:51], v[104:107], v[176:179]
v_mfma_f32_16x16x32_bf16 v[196:199], a[48:51], v[108:111], v[196:199]
v_mfma_f32_16x16x32_bf16 v[140:143], a[52:55], v[96:99], v[140:143]
buffer_load_dwordx4 v[92:95], v59, s[24:27], s99 offen
v_mfma_f32_16x16x32_bf16 v[160:163], a[52:55], v[100:103], v[160:163]
v_mfma_f32_16x16x32_bf16 v[180:183], a[52:55], v[104:107], v[180:183]
v_mfma_f32_16x16x32_bf16 v[200:203], a[52:55], v[108:111], v[200:203]
v_mfma_f32_16x16x32_bf16 v[144:147], a[56:59], v[96:99], v[144:147]
s_add_u32 s99, s99, 4096
s_cmp_eq_u32 s99, s82
s_cselect_b32 s99, s81, s99
v_mfma_f32_16x16x32_bf16 v[164:167], a[56:59], v[100:103], v[164:167]
v_mfma_f32_16x16x32_bf16 v[184:187], a[56:59], v[104:107], v[184:187]
v_mfma_f32_16x16x32_bf16 v[204:207], a[56:59], v[108:111], v[204:207]
s_waitcnt vmcnt(8)
v_mfma_f32_16x16x32_bf16 v[128:131], a[60:63], v[112:115], v[128:131]
buffer_load_dwordx4 v[96:99], v56, s[24:27], s99 offen
v_mfma_f32_16x16x32_bf16 v[148:151], a[60:63], v[116:119], v[148:151]
v_mfma_f32_16x16x32_bf16 v[168:171], a[60:63], v[120:123], v[168:171]
v_mfma_f32_16x16x32_bf16 v[188:191], a[60:63], v[124:127], v[188:191]
v_mfma_f32_16x16x32_bf16 v[132:135], a[64:67], v[112:115], v[132:135]
buffer_load_dwordx4 v[100:103], v57, s[24:27], s99 offen
v_mfma_f32_16x16x32_bf16 v[152:155], a[64:67], v[116:119], v[152:155]
v_mfma_f32_16x16x32_bf16 v[172:175], a[64:67], v[120:123], v[172:175]
v_mfma_f32_16x16x32_bf16 v[192:195], a[64:67], v[124:127], v[192:195]
v_mfma_f32_16x16x32_bf16 v[136:139], a[68:71], v[112:115], v[136:139]
buffer_load_dwordx4 v[104:107], v58, s[24:27], s99 offen
v_mfma_f32_16x16x32_bf16 v[156:159], a[68:71], v[116:119], v[156:159]
v_mfma_f32_16x16x32_bf16 v[176:179], a[68:71], v[120:123], v[176:179]
v_mfma_f32_16x16x32_bf16 v[196:199], a[68:71], v[124:127], v[196:199]
v_mfma_f32_16x16x32_bf16 v[140:143], a[72:75], v[112:115], v[140:143]
buffer_load_dwordx4 v[108:111], v59, s[24:27], s99 offen
v_mfma_f32_16x16x32_bf16 v[160:163], a[72:75], v[116:119], v[160:163]
v_mfma_f32_16x16x32_bf16 v[180:183], a[72:75], v[120:123], v[180:183]
v_mfma_f32_16x16x32_bf16 v[200:203], a[72:75], v[124:127], v[200:203]
v_mfma_f32_16x16x32_bf16 v[144:147], a[76:79], v[112:115], v[144:147]
s_add_u32 s99, s99, 4096
s_cmp_eq_u32 s99, s82
s_cselect_b32 s99, s81, s99
v_mfma_f32_16x16x32_bf16 v[164:167], a[76:79], v[116:119], v[164:167]
v_mfma_f32_16x16x32_bf16 v[184:187], a[76:79], v[120:123], v[184:187]
v_mfma_f32_16x16x32_bf16 v[204:207], a[76:79], v[124:127], v[204:207]
s_barrier
s_cmp_lg_u32 s5, 0
s_cbranch_scc1 L_fl_37
s_mov_b64 exec, 1
buffer_store_dword v253, v252, s[24:27], 0 offen offset:20 sc1
s_mov_b64 exec, -1
L_fl_37:
s_waitcnt vmcnt(8)
v_mfma_f32_16x16x32_bf16 v[128:131], a[80:83], v[64:67], v[128:131]
buffer_load_dwordx4 v[112:115], v56, s[24:27], s99 offen
v_mfma_f32_16x16x32_bf16 v[148:151], a[80:83], v[68:71], v[148:151]
v_mfma_f32_16x16x32_bf16 v[168:171], a[80:83], v[72:75], v[168:171]
v_mfma_f32_16x16x32_bf16 v[188:191], a[80:83], v[76:79], v[188:191]
v_mfma_f32_16x16x32_bf16 v[132:135], a[84:87], v[64:67], v[132:135]
buffer_load_dwordx4 v[116:119], v57, s[24:27], s99 offen
v_mfma_f32_16x16x32_bf16 v[152:155], a[84:87], v[68:71], v[152:155]
v_mfma_f32_16x16x32_bf16 v[172:175], a[84:87], v[72:75], v[172:175]
v_mfma_f32_16x16x32_bf16 v[192:195], a[84:87], v[76:79], v[192:195]
v_mfma_f32_16x16x32_bf16 v[136:139], a[88:91], v[64:67], v[136:139]
buffer_load_dwordx4 v[120:123], v58, s[24:27], s99 offen
v_mfma_f32_16x16x32_bf16 v[156:159], a[88:91], v[68:71], v[156:159]
v_mfma_f32_16x16x32_bf16 v[176:179], a[88:91], v[72:75], v[176:179]
v_mfma_f32_16x16x32_bf16 v[196:199], a[88:91], v[76:79], v[196:199]
v_mfma_f32_16x16x32_bf16 v[140:143], a[92:95], v[64:67], v[140:143]
buffer_load_dwordx4 v[124:127], v59, s[24:27], s99 offen
v_mfma_f32_16x16x32_bf16 v[160:163], a[92:95], v[68:71], v[160:163]
v_mfma_f32_16x16x32_bf16 v[180:183], a[92:95], v[72:75], v[180:183]
v_mfma_f32_16x16x32_bf16 v[200:203], a[92:95], v[76:79], v[200:203]
v_mfma_f32_16x16x32_bf16 v[144:147], a[96:99], v[64:67], v[144:147]
s_add_u32 s99, s99, 4096
s_cmp_eq_u32 s99, s82
s_cselect_b32 s99, s81, s99
v_mfma_f32_16x16x32_bf16 v[164:167], a[96:99], v[68:71], v[164:167]
v_mfma_f32_16x16x32_bf16 v[184:187], a[96:99], v[72:75], v[184:187]
v_mfma_f32_16x16x32_bf16 v[204:207], a[96:99], v[76:79], v[204:207]
s_waitcnt vmcnt(8)
v_mfma_f32_16x16x32_bf16 v[128:131], a[100:103], v[80:83], v[128:131]
buffer_load_dwordx4 v[64:67], v56, s[24:27], s99 offen
v_mfma_f32_16x16x32_bf16 v[148:151], a[100:103], v[84:87], v[148:151]
v_mfma_f32_16x16x32_bf16 v[168:171], a[100:103], v[88:91], v[168:171]
v_mfma_f32_16x16x32_bf16 v[188:191], a[100:103], v[92:95], v[188:191]
v_mfma_f32_16x16x32_bf16 v[132:135], a[104:107], v[80:83], v[132:135]
buffer_load_dwordx4 v[68:71], v57, s[24:27], s99 offen
v_mfma_f32_16x16x32_bf16 v[152:155], a[104:107], v[84:87], v[152:155]
v_mfma_f32_16x16x32_bf16 v[172:175], a[104:107], v[88:91], v[172:175]
v_mfma_f32_16x16x32_bf16 v[192:195], a[104:107], v[92:95], v[192:195]
v_mfma_f32_16x16x32_bf16 v[136:139], a[108:111], v[80:83], v[136:139]
buffer_load_dwordx4 v[72:75], v58, s[24:27], s99 offen
v_mfma_f32_16x16x32_bf16 v[156:159], a[108:111], v[84:87], v[156:159]
v_mfma_f32_16x16x32_bf16 v[176:179], a[108:111], v[88:91], v[176:179]
v_mfma_f32_16x16x32_bf16 v[196:199], a[108:111], v[92:95], v[196:199]
v_mfma_f32_16x16x32_bf16 v[140:143], a[112:115], v[80:83], v[140:143]
buffer_load_dwordx4 v[76:79], v59, s[24:27], s99 offen
v_mfma_f32_16x16x32_bf16 v[160:163], a[112:115], v[84:87], v[160:163]
v_mfma_f32_16x16x32_bf16 v[180:183], a[112:115], v[88:91], v[180:183]
v_mfma_f32_16x16x32_bf16 v[200:203], a[112:115], v[92:95], v[200:203]
v_mfma_f32_16x16x32_bf16 v[144:147], a[116:119], v[80:83], v[144:147]
s_add_u32 s99, s99, 4096
s_cmp_eq_u32 s99, s82
s_cselect_b32 s99, s81, s99
v_mfma_f32_16x16x32_bf16 v[164:167], a[116:119], v[84:87], v[164:167]
v_mfma_f32_16x16x32_bf16 v[184:187], a[116:119], v[88:91], v[184:187]
v_mfma_f32_16x16x32_bf16 v[204:207], a[116:119], v[92:95], v[204:207]
s_waitcnt vmcnt(8)
v_mfma_f32_16x16x32_bf16 v[128:131], a[120:123], v[96:99], v[128:131]
buffer_load_dwordx4 v[80:83], v56, s[24:27], s99 offen
v_mfma_f32_16x16x32_bf16 v[148:151], a[120:123], v[100:103], v[148:151]
v_mfma_f32_16x16x32_bf16 v[168:171], a[120:123], v[104:107], v[168:171]
v_mfma_f32_16x16x32_bf16 v[188:191], a[120:123], v[108:111], v[188:191]
v_mfma_f32_16x16x32_bf16 v[132:135], a[124:127], v[96:99], v[132:135]
buffer_load_dwordx4 v[84:87], v57, s[24:27], s99 offen
v_mfma_f32_16x16x32_bf16 v[152:155], a[124:127], v[100:103], v[152:155]
v_mfma_f32_16x16x32_bf16 v[172:175], a[124:127], v[104:107], v[172:175]
v_mfma_f32_16x16x32_bf16 v[192:195], a[124:127], v[108:111], v[192:195]
v_mfma_f32_16x16x32_bf16 v[136:139], a[128:131], v[96:99], v[136:139]
buffer_load_dwordx4 v[88:91], v58, s[24:27], s99 offen
v_mfma_f32_16x16x32_bf16 v[156:159], a[128:131], v[100:103], v[156:159]
v_mfma_f32_16x16x32_bf16 v[176:179], a[128:131], v[104:107], v[176:179]
v_mfma_f32_16x16x32_bf16 v[196:199], a[128:131], v[108:111], v[196:199]
v_mfma_f32_16x16x32_bf16 v[140:143], a[132:135], v[96:99], v[140:143]
buffer_load_dwordx4 v[92:95], v59, s[24:27], s99 offen
v_mfma_f32_16x16x32_bf16 v[160:163], a[132:135], v[100:103], v[160:163]
v_mfma_f32_16x16x32_bf16 v[180:183], a[132:135], v[104:107], v[180:183]
v_mfma_f32_16x16x32_bf16 v[200:203], a[132:135], v[108:111], v[200:203]
v_mfma_f32_16x16x32_bf16 v[144:147], a[136:139], v[96:99], v[144:147]
s_add_u32 s99, s99, 4096
s_cmp_eq_u32 s99, s82
s_cselect_b32 s99, s81, s99
v_mfma_f32_16x16x32_bf16 v[164:167], a[136:139], v[100:103], v[164:167]
v_mfma_f32_16x16x32_bf16 v[184:187], a[136:139], v[104:107], v[184:187]
v_mfma_f32_16x16x32_bf16 v[204:207], a[136:139], v[108:111], v[204:207]
s_waitcnt vmcnt(8)
v_mfma_f32_16x16x32_bf16 v[128:131], a[140:143], v[112:115], v[128:131]
buffer_load_dwordx4 v[96:99], v56, s[24:27], s99 offen
v_mfma_f32_16x16x32_bf16 v[148:151], a[140:143], v[116:119], v[148:151]
v_mfma_f32_16x16x32_bf16 v[168:171], a[140:143], v[120:123], v[168:171]
v_mfma_f32_16x16x32_bf16 v[188:191], a[140:143], v[124:127], v[188:191]
v_mfma_f32_16x16x32_bf16 v[132:135], a[144:147], v[112:115], v[132:135]
buffer_load_dwordx4 v[100:103], v57, s[24:27], s99 offen
v_mfma_f32_16x16x32_bf16 v[152:155], a[144:147], v[116:119], v[152:155]
v_mfma_f32_16x16x32_bf16 v[172:175], a[144:147], v[120:123], v[172:175]
v_mfma_f32_16x16x32_bf16 v[192:195], a[144:147], v[124:127], v[192:195]
v_mfma_f32_16x16x32_bf16 v[136:139], a[148:151], v[112:115], v[136:139]
buffer_load_dwordx4 v[104:107], v58, s[24:27], s99 offen
v_mfma_f32_16x16x32_bf16 v[156:159], a[148:151], v[116:119], v[156:159]
v_mfma_f32_16x16x32_bf16 v[176:179], a[148:151], v[120:123], v[176:179]
v_mfma_f32_16x16x32_bf16 v[196:199], a[148:151], v[124:127], v[196:199]
v_mfma_f32_16x16x32_bf16 v[140:143], a[152:155], v[112:115], v[140:143]
buffer_load_dwordx4 v[108:111], v59, s[24:27], s99 offen
v_mfma_f32_16x16x32_bf16 v[160:163], a[152:155], v[116:119], v[160:163]
v_mfma_f32_16x16x32_bf16 v[180:183], a[152:155], v[120:123], v[180:183]
v_mfma_f32_16x16x32_bf16 v[200:203], a[152:155], v[124:127], v[200:203]
v_mfma_f32_16x16x32_bf16 v[144:147], a[156:159], v[112:115], v[144:147]
s_add_u32 s99, s99, 4096
s_cmp_eq_u32 s99, s82
s_cselect_b32 s99, s81, s99
v_mfma_f32_16x16x32_bf16 v[164:167], a[156:159], v[116:119], v[164:167]
v_mfma_f32_16x16x32_bf16 v[184:187], a[156:159], v[120:123], v[184:187]
v_mfma_f32_16x16x32_bf16 v[204:207], a[156:159], v[124:127], v[204:207]
buffer_load_dword v254, v250, s[24:27], 0 offen sc1
s_waitcnt vmcnt(9)
v_mfma_f32_16x16x32_bf16 v[128:131], a[160:163], v[64:67], v[128:131]
buffer_load_dwordx4 v[112:115], v56, s[24:27], s99 offen
v_mfma_f32_16x16x32_bf16 v[148:151], a[160:163], v[68:71], v[148:151]
v_mfma_f32_16x16x32_bf16 v[168:171], a[160:163], v[72:75], v[168:171]
v_mfma_f32_16x16x32_bf16 v[188:191], a[160:163], v[76:79], v[188:191]
v_mfma_f32_16x16x32_bf16 v[132:135], a[164:167], v[64:67], v[132:135]
buffer_load_dwordx4 v[116:119], v57, s[24:27], s99 offen
v_mfma_f32_16x16x32_bf16 v[152:155], a[164:167], v[68:71], v[152:155]
v_mfma_f32_16x16x32_bf16 v[172:175], a[164:167], v[72:75], v[172:175]
v_mfma_f32_16x16x32_bf16 v[192:195], a[164:167], v[76:79], v[192:195]
v_mfma_f32_16x16x32_bf16 v[136:139], a[168:171], v[64:67], v[136:139]
buffer_load_dwordx4 v[120:123], v58, s[24:27], s99 offen
v_mfma_f32_16x16x32_bf16 v[156:159], a[168:171], v[68:71], v[156:159]
v_mfma_f32_16x16x32_bf16 v[176:179], a[168:171], v[72:75], v[176:179]
v_mfma_f32_16x16x32_bf16 v[196:199], a[168:171], v[76:79], v[196:199]
v_mfma_f32_16x16x32_bf16 v[140:143], a[172:175], v[64:67], v[140:143]
buffer_load_dwordx4 v[124:127], v59, s[24:27], s99 offen
v_mfma_f32_16x16x32_bf16 v[160:163], a[172:175], v[68:71], v[160:163]
v_mfma_f32_16x16x32_bf16 v[180:183], a[172:175], v[72:75], v[180:183]
v_mfma_f32_16x16x32_bf16 v[200:203], a[172:175], v[76:79], v[200:203]
v_mfma_f32_16x16x32_bf16 v[144:147], a[176:179], v[64:67], v[144:147]
s_add_u32 s99, s99, 4096
s_cmp_eq_u32 s99, s82
s_cselect_b32 s99, s81, s99
v_mfma_f32_16x16x32_bf16 v[164:167], a[176:179], v[68:71], v[164:167]
v_mfma_f32_16x16x32_bf16 v[184:187], a[176:179], v[72:75], v[184:187]
v_mfma_f32_16x16x32_bf16 v[204:207], a[176:179], v[76:79], v[204:207]
s_waitcnt vmcnt(9)
v_mfma_f32_16x16x32_bf16 v[128:131], a[180:183], v[80:83], v[128:131]
buffer_load_dwordx4 v[64:67], v56, s[24:27], s99 offen
v_mfma_f32_16x16x32_bf16 v[148:151], a[180:183], v[84:87], v[148:151]
v_mfma_f32_16x16x32_bf16 v[168:171], a[180:183], v[88:91], v[168:171]
v_mfma_f32_16x16x32_bf16 v[188:191], a[180:183], v[92:95], v[188:191]
v_mfma_f32_16x16x32_bf16 v[132:135], a[184:187], v[80:83], v[132:135]
buffer_load_dwordx4 v[68:71], v57, s[24:27], s99 offen
v_mfma_f32_16x16x32_bf16 v[152:155], a[184:187], v[84:87], v[152:155]
v_mfma_f32_16x16x32_bf16 v[172:175], a[184:187], v[88:91], v[172:175]
v_mfma_f32_16x16x32_bf16 v[192:195], a[184:187], v[92:95], v[192:195]
v_mfma_f32_16x16x32_bf16 v[136:139], a[188:191], v[80:83], v[136:139]
buffer_load_dwordx4 v[72:75], v58, s[24:27], s99 offen
v_mfma_f32_16x16x32_bf16 v[156:159], a[188:191], v[84:87], v[156:159]
v_mfma_f32_16x16x32_bf16 v[176:179], a[188:191], v[88:91], v[176:179]
v_mfma_f32_16x16x32_bf16 v[196:199], a[188:191], v[92:95], v[196:199]
v_mfma_f32_16x16x32_bf16 v[140:143], a[192:195], v[80:83], v[140:143]
buffer_load_dwordx4 v[76:79], v59, s[24:27], s99 offen
v_mfma_f32_16x16x32_bf16 v[160:163], a[192:195], v[84:87], v[160:163]
v_mfma_f32_16x16x32_bf16 v[180:183], a[192:195], v[88:91], v[180:183]
v_mfma_f32_16x16x32_bf16 v[200:203], a[192:195], v[92:95], v[200:203]
v_mfma_f32_16x16x32_bf16 v[144:147], a[196:199], v[80:83], v[144:147]
s_add_u32 s99, s99, 4096
s_cmp_eq_u32 s99, s82
s_cselect_b32 s99, s81, s99
v_mfma_f32_16x16x32_bf16 v[164:167], a[196:199], v[84:87], v[164:167]
v_mfma_f32_16x16x32_bf16 v[184:187], a[196:199], v[88:91], v[184:187]
v_mfma_f32_16x16x32_bf16 v[204:207], a[196:199], v[92:95], v[204:207]
s_waitcnt vmcnt(9)
v_mfma_f32_16x16x32_bf16 v[128:131], a[200:203], v[96:99], v[128:131]
buffer_load_dwordx4 v[80:83], v56, s[24:27], s99 offen
v_mfma_f32_16x16x32_bf16 v[148:151], a[200:203], v[100:103], v[148:151]
s_mov_b32 s32, s60
s_and_b32 s33, s61, 0xffff
s_mov_b32 s34, 1280
v_mfma_f32_16x16x32_bf16 v[168:171], a[200:203], v[104:107], v[168:171]
s_mov_b32 s35, 0x20000
v_and_b32 v2, 15, v1
v_lshrrev_b32 v3, 4, v1
v_mfma_f32_16x16x32_bf16 v[188:191], a[200:203], v[108:111], v[188:191]
v_lshrrev_b32 v4, 3, v2
v_lshlrev_b32 v4, 3, v4
v_and_b32 v5, 3, v2
v_mfma_f32_16x16x32_bf16 v[132:135], a[204:207], v[96:99], v[132:135]
buffer_load_dwordx4 v[84:87], v57, s[24:27], s99 offen
v_mfma_f32_16x16x32_bf16 v[152:155], a[204:207], v[100:103], v[152:155]
v_lshl_or_b32 v4, v5, 1, v4
v_bfe_u32 v5, v2, 2, 1
v_or_b32 v4, v4, v5
v_mfma_f32_16x16x32_bf16 v[172:175], a[204:207], v[104:107], v[172:175]
s_lshl_b32 s6, s94, 6
s_lshl_b32 s7, s5, 4
s_add_u32 s6, s6, s7
v_mfma_f32_16x16x32_bf16 v[192:195], a[204:207], v[108:111], v[192:195]
v_add_u32 v4, s6, v4
v_lshlrev_b32 v5, 4, v4
v_mul_u32_u24 v4, 1280, v4
v_mfma_f32_16x16x32_bf16 v[136:139], a[208:211], v[96:99], v[136:139]
buffer_load_dwordx4 v[88:91], v58, s[24:27], s99 offen
v_mfma_f32_16x16x32_bf16 v[156:159], a[208:211], v[100:103], v[156:159]
v_mul_u32_u24 v3, 40, v3
s_mul_i32 s6, s95, 160
v_add_u32 v3, s6, v3
v_mfma_f32_16x16x32_bf16 v[176:179], a[208:211], v[104:107], v[176:179]
v_add_u32 v60, v4, v3
s_mov_b32 s7, 98304
v_mfma_f32_16x16x32_bf16 v[196:199], a[208:211], v[108:111], v[196:199]
v_mfma_f32_16x16x32_bf16 v[140:143], a[212:215], v[96:99], v[140:143]
buffer_load_dwordx4 v[92:95], v59, s[24:27], s99 offen
v_mfma_f32_16x16x32_bf16 v[160:163], a[212:215], v[100:103], v[160:163]
buffer_load_dwordx4 v[32:35], v5, s[24:27], s7 offen
v_mfma_f32_16x16x32_bf16 v[180:183], a[212:215], v[104:107], v[180:183]
v_mfma_f32_16x16x32_bf16 v[200:203], a[212:215], v[108:111], v[200:203]
buffer_load_dwordx4 v[8:11], v60, s[8:11], 0 offen
v_mfma_f32_16x16x32_bf16 v[144:147], a[216:219], v[96:99], v[144:147]
s_add_u32 s99, s99, 4096
s_cmp_eq_u32 s99, s82
s_cselect_b32 s99, s81, s99
v_mfma_f32_16x16x32_bf16 v[164:167], a[216:219], v[100:103], v[164:167]
buffer_load_dwordx4 v[12:15], v60, s[8:11], 0 offen offset:16
v_mfma_f32_16x16x32_bf16 v[184:187], a[216:219], v[104:107], v[184:187]
v_mfma_f32_16x16x32_bf16 v[204:207], a[216:219], v[108:111], v[204:207]
buffer_load_dwordx2 v[16:17], v60, s[8:11], 0 offen offset:32
s_waitcnt vmcnt(12)
v_mfma_f32_16x16x32_bf16 v[128:131], a[220:223], v[112:115], v[128:131]
v_mfma_f32_16x16x32_bf16 v[148:151], a[220:223], v[116:119], v[148:151]
buffer_load_dwordx4 v[20:23], v3, s[32:35], 0 offen
v_mfma_f32_16x16x32_bf16 v[168:171], a[220:223], v[120:123], v[168:171]
v_mfma_f32_16x16x32_bf16 v[188:191], a[220:223], v[124:127], v[188:191]
buffer_load_dwordx4 v[24:27], v3, s[32:35], 0 offen offset:16
v_mfma_f32_16x16x32_bf16 v[132:135], a[224:227], v[112:115], v[132:135]
v_mfma_f32_16x16x32_bf16 v[152:155], a[224:227], v[116:119], v[152:155]
buffer_load_dwordx2 v[28:29], v3, s[32:35], 0 offen offset:32
v_mfma_f32_16x16x32_bf16 v[172:175], a[224:227], v[120:123], v[172:175]
v_mfma_f32_16x16x32_bf16 v[192:195], a[224:227], v[124:127], v[192:195]
v_mfma_f32_16x16x32_bf16 v[136:139], a[228:231], v[112:115], v[136:139]
v_mfma_f32_16x16x32_bf16 v[156:159], a[228:231], v[116:119], v[156:159]
v_mfma_f32_16x16x32_bf16 v[176:179], a[228:231], v[120:123], v[176:179]
v_mfma_f32_16x16x32_bf16 v[196:199], a[228:231], v[124:127], v[196:199]
v_mfma_f32_16x16x32_bf16 v[140:143], a[232:235], v[112:115], v[140:143]
v_mfma_f32_16x16x32_bf16 v[160:163], a[232:235], v[116:119], v[160:163]
v_mfma_f32_16x16x32_bf16 v[180:183], a[232:235], v[120:123], v[180:183]
v_mfma_f32_16x16x32_bf16 v[200:203], a[232:235], v[124:127], v[200:203]
v_mfma_f32_16x16x32_bf16 v[144:147], a[236:239], v[112:115], v[144:147]
v_mfma_f32_16x16x32_bf16 v[164:167], a[236:239], v[116:119], v[164:167]
v_mfma_f32_16x16x32_bf16 v[184:187], a[236:239], v[120:123], v[184:187]
v_mfma_f32_16x16x32_bf16 v[204:207], a[236:239], v[124:127], v[204:207]
v_cmp_eq_u32 vcc, 0, v254
s_cbranch_vccnz L_slow_38
L_back_39:
v_lshrrev_b32 v2, 3, v1
v_and_b32 v3, 7, v1
v_lshlrev_b32 v3, 4, v3
v_lshl_add_u32 v61, v2, 12, v3
s_mul_i32 s6, s95, 80
s_lshl_b32 s7, s5, 3
s_add_u32 s6, s6, s7
s_lshl_b32 s6, s6, 12
s_lshl_b32 s7, s94, 7
s_add_u32 s6, s6, s7
s_add_u32 s6, s6, 4194304
s_lshl_b32 s7, s5, 10
s_add_u32 s7, s7, 61440
s_mov_b32 m0, s7
s_add_u32 s7, s7, 4096
buffer_load_dwordx4 v61, s[24:27], s6 offen lds
s_add_u32 s6, s6, 131072
s_mov_b32 m0, s7
s_add_u32 s7, s7, 4096
buffer_load_dwordx4 v61, s[24:27], s6 offen lds
s_add_u32 s6, s6, 131072
s_cmp_ge_u32 s5, 2
s_cbranch_scc1 L_y2skip_40
s_mov_b32 m0, s7
s_add_u32 s7, s7, 4096
buffer_load_dwordx4 v61, s[24:27], s6 offen lds
s_add_u32 s6, s6, 131072
L_y2skip_40:
s_waitcnt vmcnt(13)
v_mfma_f32_16x16x32_bf16 v[128:131], v[208:211], v[64:67], v[128:131]
v_mfma_f32_16x16x32_bf16 v[148:151], v[208:211], v[68:71], v[148:151]
v_mfma_f32_16x16x32_bf16 v[168:171], v[208:211], v[72:75], v[168:171]
v_mfma_f32_16x16x32_bf16 v[188:191], v[208:211], v[76:79], v[188:191]
v_mfma_f32_16x16x32_bf16 v[132:135], v[212:215], v[64:67], v[132:135]
v_mfma_f32_16x16x32_bf16 v[152:155], v[212:215], v[68:71], v[152:155]
v_mfma_f32_16x16x32_bf16 v[172:175], v[212:215], v[72:75], v[172:175]
v_mfma_f32_16x16x32_bf16 v[192:195], v[212:215], v[76:79], v[192:195]
v_mfma_f32_16x16x32_bf16 v[136:139], v[216:219], v[64:67], v[136:139]
v_mfma_f32_16x16x32_bf16 v[156:159], v[216:219], v[68:71], v[156:159]
v_mfma_f32_16x16x32_bf16 v[176:179], v[216:219], v[72:75], v[176:179]
v_mfma_f32_16x16x32_bf16 v[196:199], v[216:219], v[76:79], v[196:199]
v_mfma_f32_16x16x32_bf16 v[140:143], v[220:223], v[64:67], v[140:143]
v_mfma_f32_16x16x32_bf16 v[160:163], v[220:223], v[68:71], v[160:163]
v_mfma_f32_16x16x32_bf16 v[180:183], v[220:223], v[72:75], v[180:183]
v_mfma_f32_16x16x32_bf16 v[200:203], v[220:223], v[76:79], v[200:203]
v_mfma_f32_16x16x32_bf16 v[144:147], v[224:227], v[64:67], v[144:147]
v_mfma_f32_16x16x32_bf16 v[164:167], v[224:227], v[68:71], v[164:167]
v_mfma_f32_16x16x32_bf16 v[184:187], v[224:227], v[72:75], v[184:187]
v_mfma_f32_16x16x32_bf16 v[204:207], v[224:227], v[76:79], v[204:207]
s_cmp_ge_u32 s5, 2
s_cbranch_scc1 L_g2skip_36
s_waitcnt vmcnt(9)
v_mfma_f32_16x16x32_bf16 v[128:131], v[228:231], v[80:83], v[128:131]
v_mfma_f32_16x16x32_bf16 v[148:151], v[228:231], v[84:87], v[148:151]
v_mfma_f32_16x16x32_bf16 v[168:171], v[228:231], v[88:91], v[168:171]
v_mfma_f32_16x16x32_bf16 v[188:191], v[228:231], v[92:95], v[188:191]
v_mfma_f32_16x16x32_bf16 v[132:135], v[232:235], v[80:83], v[132:135]
v_mfma_f32_16x16x32_bf16 v[152:155], v[232:235], v[84:87], v[152:155]
v_mfma_f32_16x16x32_bf16 v[172:175], v[232:235], v[88:91], v[172:175]
v_mfma_f32_16x16x32_bf16 v[192:195], v[232:235], v[92:95], v[192:195]
v_mfma_f32_16x16x32_bf16 v[136:139], v[236:239], v[80:83], v[136:139]
v_mfma_f32_16x16x32_bf16 v[156:159], v[236:239], v[84:87], v[156:159]
v_mfma_f32_16x16x32_bf16 v[176:179], v[236:239], v[88:91], v[176:179]
v_mfma_f32_16x16x32_bf16 v[196:199], v[236:239], v[92:95], v[196:199]
v_mfma_f32_16x16x32_bf16 v[140:143], v[240:243], v[80:83], v[140:143]
v_mfma_f32_16x16x32_bf16 v[160:163], v[240:243], v[84:87], v[160:163]
v_mfma_f32_16x16x32_bf16 v[180:183], v[240:243], v[88:91], v[180:183]
v_mfma_f32_16x16x32_bf16 v[200:203], v[240:243], v[92:95], v[200:203]
v_mfma_f32_16x16x32_bf16 v[144:147], v[244:247], v[80:83], v[144:147]
v_mfma_f32_16x16x32_bf16 v[164:167], v[244:247], v[84:87], v[164:167]
v_mfma_f32_16x16x32_bf16 v[184:187], v[244:247], v[88:91], v[184:187]
v_mfma_f32_16x16x32_bf16 v[204:207], v[244:247], v[92:95], v[204:207]
L_g2skip_36:
s_mul_i32 s6, s5, 15360
s_add_u32 s6, s6, 0
v_add_u32 v62, s6, v248
s_add_u32 s6, s5, 1
s_and_b32 s6, s6, 3
s_mul_i32 s6, s6, 15360
s_add_u32 s6, s6, 0
v_add_u32 v57, s6, v248
s_add_u32 s6, s5, 2
s_and_b32 s6, s6, 3
s_mul_i32 s6, s6, 15360
s_add_u32 s6, s6, 5120
v_add_u32 v58, s6, v248
s_add_u32 s6, s5, 3
s_and_b32 s6, s6, 3
s_mul_i32 s6, s6, 15360
s_add_u32 s6, s6, 10240
v_add_u32 v59, s6, v248
s_nop 4
ds_write_b128 v57, v[148:151] offset:0
ds_write_b128 v57, v[152:155] offset:1024
ds_write_b128 v57, v[156:159] offset:2048
ds_write_b128 v57, v[160:163] offset:3072
ds_write_b128 v57, v[164:167] offset:4096
ds_write_b128 v58, v[168:171] offset:0
ds_write_b128 v58, v[172:175] offset:1024
ds_write_b128 v58, v[176:179] offset:2048
ds_write_b128 v58, v[180:183] offset:3072
ds_write_b128 v58, v[184:187] offset:4096
ds_write_b128 v59, v[188:191] offset:0
ds_write_b128 v59, v[192:195] offset:1024
ds_write_b128 v59, v[196:199] offset:2048
ds_write_b128 v59, v[200:203] offset:3072
ds_write_b128 v59, v[204:207] offset:4096
v_lshrrev_b32 v3, 4, v1
v_mul_u32_u24 v3, 20, v3
v_bfe_u32 v4, v1, 2, 2
v_add_u32 v3, v3, v4
v_lshlrev_b32 v3, 7, v3
v_and_b32 v4, 3, v1
v_lshl_add_u32 v3, v4, 4, v3
s_and_b32 s6, s5, 1
s_lshl_b32 s6, s6, 6
s_lshr_b32 s7, s5, 1
s_lshl_b32 s7, s7, 3
s_add_u32 s6, s6, s7
s_add_u32 s6, s6, 61440
v_add_u32 v63, s6, v3
s_waitcnt vmcnt(0) lgkmcnt(0)
s_barrier
ds_read_b128 v[64:67], v62 offset:0
ds_read_b128 v[68:71], v62 offset:1024
ds_read_b128 v[72:75], v62 offset:2048
ds_read_b128 v[76:79], v62 offset:3072
ds_read_b128 v[80:83], v62 offset:4096
ds_read_b128 v[84:87], v62 offset:5120
ds_read_b128 v[88:91], v62 offset:6144
ds_read_b128 v[92:95], v62 offset:7168
ds_read_b128 v[96:99], v62 offset:8192
ds_read_b128 v[100:103], v62 offset:9216
ds_read_b128 v[104:107], v62 offset:10240
ds_read_b128 v[108:111], v62 offset:11264
ds_read_b128 v[112:115], v62 offset:12288
ds_read_b128 v[116:119], v62 offset:13312
ds_read_b128 v[120:123], v62 offset:14336
ds_read_b64_tr_b16 v[36:37], v63 offset:0
ds_read_b64_tr_b16 v[38:39], v63 offset:512
ds_read_b64_tr_b16 v[40:41], v63 offset:1024
ds_read_b64_tr_b16 v[42:43], v63 offset:1536
ds_read_b64_tr_b16 v[44:45], v63 offset:2048
v_mul_f32 v46, v32, v33
v_sub_f32 v46, 0, v46
v_mov_b32 v47, v33
v_mov_b32 v48, -1.4426950408889634
v_mov_b32 v49, 1.0
s_waitcnt lgkmcnt(15)
v_pk_add_f32 v[128:129], v[128:129], v[64:65]
v_pk_add_f32 v[130:131], v[130:131], v[66:67]
v_pk_add_f32 v[132:133], v[132:133], v[68:69]
v_pk_add_f32 v[134:135], v[134:135], v[70:71]
v_pk_add_f32 v[136:137], v[136:137], v[72:73]
v_pk_add_f32 v[138:139], v[138:139], v[74:75]
v_pk_add_f32 v[140:141], v[140:141], v[76:77]
v_pk_add_f32 v[142:143], v[142:143], v[78:79]
v_pk_add_f32 v[144:145], v[144:145], v[80:81]
v_pk_add_f32 v[146:147], v[146:147], v[82:83]
s_waitcnt lgkmcnt(10)
v_pk_add_f32 v[128:129], v[128:129], v[84:85]
v_pk_add_f32 v[130:131], v[130:131], v[86:87]
v_pk_add_f32 v[132:133], v[132:133], v[88:89]
v_pk_add_f32 v[134:135], v[134:135], v[90:91]
v_pk_add_f32 v[136:137], v[136:137], v[92:93]
v_pk_add_f32 v[138:139], v[138:139], v[94:95]
v_pk_add_f32 v[140:141], v[140:141], v[96:97]
v_pk_add_f32 v[142:143], v[142:143], v[98:99]
v_pk_add_f32 v[144:145], v[144:145], v[100:101]
v_pk_add_f32 v[146:147], v[146:147], v[102:103]
s_waitcnt lgkmcnt(5)
v_pk_add_f32 v[128:129], v[128:129], v[104:105]
v_pk_add_f32 v[130:131], v[130:131], v[106:107]
v_pk_add_f32 v[132:133], v[132:133], v[108:109]
v_pk_add_f32 v[134:135], v[134:135], v[110:111]
v_pk_add_f32 v[136:137], v[136:137], v[112:113]
v_pk_add_f32 v[138:139], v[138:139], v[114:115]
v_pk_add_f32 v[140:141], v[140:141], v[116:117]
v_pk_add_f32 v[142:143], v[142:143], v[118:119]
v_pk_add_f32 v[144:145], v[144:145], v[120:121]
v_pk_add_f32 v[146:147], v[146:147], v[122:123]
s_waitcnt lgkmcnt(0)
v_lshlrev_b32 v64, 16, v20
v_and_b32 v65, 0xffff0000, v20
v_lshlrev_b32 v66, 16, v21
v_and_b32 v67, 0xffff0000, v21
v_lshlrev_b32 v68, 16, v22
v_and_b32 v69, 0xffff0000, v22
v_lshlrev_b32 v70, 16, v23
v_and_b32 v71, 0xffff0000, v23
v_lshlrev_b32 v72, 16, v24
v_and_b32 v73, 0xffff0000, v24
v_pk_add_f32 v[128:129], v[128:129], v[64:65]
v_pk_add_f32 v[130:131], v[130:131], v[66:67]
v_pk_add_f32 v[132:133], v[132:133], v[68:69]
v_pk_add_f32 v[134:135], v[134:135], v[70:71]
v_pk_add_f32 v[136:137], v[136:137], v[72:73]
v_pk_mul_f32 v[64:65], v[128:129], v[48:49] op_sel_hi:[1,0]
v_pk_mul_f32 v[66:67], v[130:131], v[48:49] op_sel_hi:[1,0]
v_pk_mul_f32 v[68:69], v[132:133], v[48:49] op_sel_hi:[1,0]
v_pk_mul_f32 v[70:71], v[134:135], v[48:49] op_sel_hi:[1,0]
v_pk_mul_f32 v[72:73], v[136:137], v[48:49] op_sel_hi:[1,0]
v_exp_f32 v64, v64
v_exp_f32 v65, v65
v_exp_f32 v66, v66
v_exp_f32 v67, v67
v_exp_f32 v68, v68
v_exp_f32 v69, v69
v_exp_f32 v70, v70
v_exp_f32 v71, v71
v_exp_f32 v72, v72
v_exp_f32 v73, v73
v_lshlrev_b32 v74, 16, v8
v_and_b32 v75, 0xffff0000, v8
v_lshlrev_b32 v76, 16, v9
v_and_b32 v77, 0xffff0000, v9
v_lshlrev_b32 v78, 16, v10
v_and_b32 v79, 0xffff0000, v10
v_lshlrev_b32 v80, 16, v11
v_and_b32 v81, 0xffff0000, v11
v_lshlrev_b32 v82, 16, v12
v_and_b32 v83, 0xffff0000, v12
v_pk_add_f32 v[64:65], v[64:65], v[48:49] op_sel:[0,1] op_sel_hi:[1,1]
v_pk_add_f32 v[66:67], v[66:67], v[48:49] op_sel:[0,1] op_sel_hi:[1,1]
v_pk_add_f32 v[68:69], v[68:69], v[48:49] op_sel:[0,1] op_sel_hi:[1,1]
v_pk_add_f32 v[70:71], v[70:71], v[48:49] op_sel:[0,1] op_sel_hi:[1,1]
v_pk_add_f32 v[72:73], v[72:73], v[48:49] op_sel:[0,1] op_sel_hi:[1,1]
v_rcp_f32 v64, v64
v_rcp_f32 v65, v65
v_rcp_f32 v66, v66
v_rcp_f32 v67, v67
v_rcp_f32 v68, v68
v_rcp_f32 v69, v69
v_rcp_f32 v70, v70
v_rcp_f32 v71, v71
v_rcp_f32 v72, v72
v_rcp_f32 v73, v73
v_lshlrev_b32 v84, 16, v36
v_and_b32 v85, 0xffff0000, v36
v_lshlrev_b32 v86, 16, v37
v_and_b32 v87, 0xffff0000, v37
v_lshlrev_b32 v88, 16, v38
v_and_b32 v89, 0xffff0000, v38
v_lshlrev_b32 v90, 16, v39
v_and_b32 v91, 0xffff0000, v39
v_lshlrev_b32 v92, 16, v40
v_and_b32 v93, 0xffff0000, v40
v_pk_mul_f32 v[64:65], v[64:65], v[128:129]
v_pk_mul_f32 v[66:67], v[66:67], v[130:131]
v_pk_mul_f32 v[68:69], v[68:69], v[132:133]
v_pk_mul_f32 v[70:71], v[70:71], v[134:135]
v_pk_mul_f32 v[72:73], v[72:73], v[136:137]
v_pk_fma_f32 v[128:129], v[74:75], v[46:47], v[46:47] op_sel:[0,1,0] op_sel_hi:[1,1,0]
v_pk_fma_f32 v[130:131], v[76:77], v[46:47], v[46:47] op_sel:[0,1,0] op_sel_hi:[1,1,0]
v_pk_fma_f32 v[132:133], v[78:79], v[46:47], v[46:47] op_sel:[0,1,0] op_sel_hi:[1,1,0]
v_pk_fma_f32 v[134:135], v[80:81], v[46:47], v[46:47] op_sel:[0,1,0] op_sel_hi:[1,1,0]
v_pk_fma_f32 v[136:137], v[82:83], v[46:47], v[46:47] op_sel:[0,1,0] op_sel_hi:[1,1,0]
v_pk_mul_f32 v[128:129], v[128:129], v[84:85]
v_pk_mul_f32 v[130:131], v[130:131], v[86:87]
v_pk_mul_f32 v[132:133], v[132:133], v[88:89]
v_pk_mul_f32 v[134:135], v[134:135], v[90:91]
v_pk_mul_f32 v[136:137], v[136:137], v[92:93]
v_pk_fma_f32 v[128:129], v[128:129], v[64:65], v[74:75]
v_pk_fma_f32 v[130:131], v[130:131], v[66:67], v[76:77]
v_pk_fma_f32 v[132:133], v[132:133], v[68:69], v[78:79]
v_pk_fma_f32 v[134:135], v[134:135], v[70:71], v[80:81]
v_pk_fma_f32 v[136:137], v[136:137], v[72:73], v[82:83]
v_cvt_pk_bf16_f32 v100, v128, v129
v_cvt_pk_bf16_f32 v101, v130, v131
v_cvt_pk_bf16_f32 v102, v132, v133
v_cvt_pk_bf16_f32 v103, v134, v135
v_cvt_pk_bf16_f32 v104, v136, v137
v_lshlrev_b32 v64, 16, v25
v_and_b32 v65, 0xffff0000, v25
v_lshlrev_b32 v66, 16, v26
v_and_b32 v67, 0xffff0000, v26
v_lshlrev_b32 v68, 16, v27
v_and_b32 v69, 0xffff0000, v27
v_lshlrev_b32 v70, 16, v28
v_and_b32 v71, 0xffff0000, v28
v_lshlrev_b32 v72, 16, v29
v_and_b32 v73, 0xffff0000, v29
v_pk_add_f32 v[138:139], v[138:139], v[64:65]
v_pk_add_f32 v[140:141], v[140:141], v[66:67]
v_pk_add_f32 v[142:143], v[142:143], v[68:69]
v_pk_add_f32 v[144:145], v[144:145], v[70:71]
v_pk_add_f32 v[146:147], v[146:147], v[72:73]
v_pk_mul_f32 v[64:65], v[138:139], v[48:49] op_sel_hi:[1,0]
v_pk_mul_f32 v[66:67], v[140:141], v[48:49] op_sel_hi:[1,0]
v_pk_mul_f32 v[68:69], v[142:143], v[48:49] op_sel_hi:[1,0]
v_pk_mul_f32 v[70:71], v[144:145], v[48:49] op_sel_hi:[1,0]
v_pk_mul_f32 v[72:73], v[146:147], v[48:49] op_sel_hi:[1,0]
v_exp_f32 v64, v64
v_exp_f32 v65, v65
v_exp_f32 v66, v66
v_exp_f32 v67, v67
v_exp_f32 v68, v68
v_exp_f32 v69, v69
v_exp_f32 v70, v70
v_exp_f32 v71, v71
v_exp_f32 v72, v72
v_exp_f32 v73, v73
v_lshlrev_b32 v74, 16, v13
v_and_b32 v75, 0xffff0000, v13
v_lshlrev_b32 v76, 16, v14
v_and_b32 v77, 0xffff0000, v14
v_lshlrev_b32 v78, 16, v15
v_and_b32 v79, 0xffff0000, v15
v_lshlrev_b32 v80, 16, v16
v_and_b32 v81, 0xffff0000, v16
v_lshlrev_b32 v82, 16, v17
v_and_b32 v83, 0xffff0000, v17
v_pk_add_f32 v[64:65], v[64:65], v[48:49] op_sel:[0,1] op_sel_hi:[1,1]
v_pk_add_f32 v[66:67], v[66:67], v[48:49] op_sel:[0,1] op_sel_hi:[1,1]
v_pk_add_f32 v[68:69], v[68:69], v[48:49] op_sel:[0,1] op_sel_hi:[1,1]
v_pk_add_f32 v[70:71], v[70:71], v[48:49] op_sel:[0,1] op_sel_hi:[1,1]
v_pk_add_f32 v[72:73], v[72:73], v[48:49] op_sel:[0,1] op_sel_hi:[1,1]
v_rcp_f32 v64, v64
v_rcp_f32 v65, v65
v_rcp_f32 v66, v66
v_rcp_f32 v67, v67
v_rcp_f32 v68, v68
v_rcp_f32 v69, v69
v_rcp_f32 v70, v70
v_rcp_f32 v71, v71
v_rcp_f32 v72, v72
v_rcp_f32 v73, v73
v_lshlrev_b32 v84, 16, v41
v_and_b32 v85, 0xffff0000, v41
v_lshlrev_b32 v86, 16, v42
v_and_b32 v87, 0xffff0000, v42
v_lshlrev_b32 v88, 16, v43
v_and_b32 v89, 0xffff0000, v43
v_lshlrev_b32 v90, 16, v44
v_and_b32 v91, 0xffff0000, v44
v_lshlrev_b32 v92, 16, v45
v_and_b32 v93, 0xffff0000, v45
v_pk_mul_f32 v[64:65], v[64:65], v[138:139]
v_pk_mul_f32 v[66:67], v[66:67], v[140:141]
v_pk_mul_f32 v[68:69], v[68:69], v[142:143]
v_pk_mul_f32 v[70:71], v[70:71], v[144:145]
v_pk_mul_f32 v[72:73], v[72:73], v[146:147]
v_pk_fma_f32 v[138:139], v[74:75], v[46:47], v[46:47] op_sel:[0,1,0] op_sel_hi:[1,1,0]
v_pk_fma_f32 v[140:141], v[76:77], v[46:47], v[46:47] op_sel:[0,1,0] op_sel_hi:[1,1,0]
v_pk_fma_f32 v[142:143], v[78:79], v[46:47], v[46:47] op_sel:[0,1,0] op_sel_hi:[1,1,0]
v_pk_fma_f32 v[144:145], v[80:81], v[46:47], v[46:47] op_sel:[0,1,0] op_sel_hi:[1,1,0]
v_pk_fma_f32 v[146:147], v[82:83], v[46:47], v[46:47] op_sel:[0,1,0] op_sel_hi:[1,1,0]
v_pk_mul_f32 v[138:139], v[138:139], v[84:85]
v_pk_mul_f32 v[140:141], v[140:141], v[86:87]
v_pk_mul_f32 v[142:143], v[142:143], v[88:89]
v_pk_mul_f32 v[144:145], v[144:145], v[90:91]
v_pk_mul_f32 v[146:147], v[146:147], v[92:93]
v_pk_fma_f32 v[138:139], v[138:139], v[64:65], v[74:75]
v_pk_fma_f32 v[140:141], v[140:141], v[66:67], v[76:77]
v_pk_fma_f32 v[142:143], v[142:143], v[68:69], v[78:79]
v_pk_fma_f32 v[144:145], v[144:145], v[70:71], v[80:81]
v_pk_fma_f32 v[146:147], v[146:147], v[72:73], v[82:83]
v_cvt_pk_bf16_f32 v105, v138, v139
v_cvt_pk_bf16_f32 v106, v140, v141
v_cvt_pk_bf16_f32 v107, v142, v143
v_cvt_pk_bf16_f32 v108, v144, v145
v_cvt_pk_bf16_f32 v109, v146, v147
buffer_store_dwordx4 v[100:103], v60, s[28:31], 0 offen
buffer_store_dwordx4 v[104:107], v60, s[28:31], 0 offen offset:16
buffer_store_dwordx2 v[108:109], v60, s[28:31], 0 offen offset:32
L_end:
s_endpgm
L_two_32:
s_waitcnt lgkmcnt(0)
ds_read_b128 v[128:131], v10 offset:240
ds_read_b128 v[132:135], v10 offset:176
ds_read_b128 v[136:139], v10 offset:112
ds_read_b128 v[140:143], v10 offset:48
s_and_b32 s6, s88, 0xfffffffe
s_sub_u32 s6, s91, s6
s_cmp_ge_u32 s6, 2
s_cselect_b32 s92, s1, s0
s_and_b32 s6, s6, 1
s_lshl_b32 s6, s6, 4
s_lshr_b32 s92, s92, s6
s_lshl_b32 s92, s92, 16
s_lshl_b32 s6, s91, 12
s_add_u32 s6, s6, 4194304
s_nop 4
s_waitcnt lgkmcnt(0)
v_lshlrev_b32 v131, 16, v131
v_fma_f32 v176, v131, s92, v176
v_lshlrev_b32 v130, 16, v130
v_fma_f32 v177, v130, s92, v177
v_lshlrev_b32 v129, 16, v129
v_fma_f32 v178, v129, s92, v178
v_lshlrev_b32 v128, 16, v128
v_fma_f32 v179, v128, s92, v179
v_lshlrev_b32 v135, 16, v135
v_fma_f32 v180, v135, s92, v180
v_lshlrev_b32 v134, 16, v134
v_fma_f32 v181, v134, s92, v181
v_lshlrev_b32 v133, 16, v133
v_fma_f32 v182, v133, s92, v182
v_lshlrev_b32 v132, 16, v132
v_fma_f32 v183, v132, s92, v183
v_lshlrev_b32 v139, 16, v139
v_fma_f32 v184, v139, s92, v184
v_lshlrev_b32 v138, 16, v138
v_fma_f32 v185, v138, s92, v185
v_lshlrev_b32 v137, 16, v137
v_fma_f32 v186, v137, s92, v186
v_lshlrev_b32 v136, 16, v136
v_fma_f32 v187, v136, s92, v187
v_lshlrev_b32 v143, 16, v143
v_fma_f32 v188, v143, s92, v188
v_lshlrev_b32 v142, 16, v142
v_fma_f32 v189, v142, s92, v189
v_lshlrev_b32 v141, 16, v141
v_fma_f32 v190, v141, s92, v190
v_lshlrev_b32 v140, 16, v140
v_fma_f32 v191, v140, s92, v191
v_cvt_pk_bf16_f32 v160, v176, v177
v_cvt_pk_bf16_f32 v161, v178, v179
v_cvt_pk_bf16_f32 v162, v180, v181
v_cvt_pk_bf16_f32 v163, v182, v183
buffer_store_dwordx4 v[160:163], v11, s[24:27], s6 offen offset:0 sc1
v_cvt_pk_bf16_f32 v164, v184, v185
v_cvt_pk_bf16_f32 v165, v186, v187
v_cvt_pk_bf16_f32 v166, v188, v189
v_cvt_pk_bf16_f32 v167, v190, v191
buffer_store_dwordx4 v[164:167], v11, s[24:27], s6 offen offset:128 sc1
s_cmp_eq_u32 s87, 3
s_cselect_b32 s85, s85, s87
s_cselect_b64 vcc, -1, 0
v_mov_b32 v2, 2147418112
v_cndmask_b32 v11, v11, v2, vcc
s_mul_i32 s6, s85, 30208
s_add_u32 s6, s6, 63488
v_add_u32 v8, s6, v16
s_add_u32 s6, s6, 17536
v_add_u32 v9, s6, v17
v_lshlrev_b32 v10, 5, v18
v_sub_u32 v10, v9, v10
v_add_u32 v10, 2176, v10
s_add_u32 s91, s88, s85
ds_read_b128 v[128:131], v8 offset:2048
ds_read_b128 v[132:135], v8 offset:2112
ds_read_b128 v[136:139], v8 offset:2176
ds_read_b128 v[140:143], v8 offset:2240
ds_read_b128 v[144:147], v8 offset:2304
ds_read_b128 v[148:151], v8 offset:2368
ds_read_b128 v[152:155], v8 offset:2432
ds_read_b128 v[156:159], v8 offset:2496
ds_read_b128 v[160:163], v9 offset:2176
ds_read_b128 v[164:167], v9 offset:2240
ds_read_b128 v[168:171], v9 offset:2304
v_mov_b32 v176, 0
v_mov_b32 v177, 0
v_mov_b32 v178, 0
v_mov_b32 v179, 0
v_mov_b32 v180, 0
v_mov_b32 v181, 0
v_mov_b32 v182, 0
v_mov_b32 v183, 0
v_mov_b32 v184, 0
v_mov_b32 v185, 0
v_mov_b32 v186, 0
v_mov_b32 v187, 0
v_mov_b32 v188, 0
v_mov_b32 v189, 0
v_mov_b32 v190, 0
v_mov_b32 v191, 0
s_waitcnt lgkmcnt(0)
s_branch L_halfb_33
L_spare:
s_and_b32 s6, s3, 3
s_lshr_b32 s7, s3, 2
s_lshl_b32 s6, s6, 1
s_add_u32 s73, s6, s7
s_lshl_b32 s73, s73, 2
s_add_u32 s73, s73, s4
s_sub_u32 s73, s73, 28
s_and_b32 s6, s3, 3
s_lshl_b32 s6, s6, 2
s_and_b32 s7, s4, 3
s_add_u32 s77, s6, s7
s_lshr_b32 s6, s3, 2
s_mul_i32 s6, s6, 7
s_lshr_b32 s7, s4, 2
s_add_u32 s78, s6, s7
s_and_b32 s82, s5, 1
s_lshr_b32 s83, s5, 1
s_lshl_b32 s6, s3, 4
s_lshr_b32 s7, s4, 1
s_add_u32 s6, s6, s7
s_mul_i32 s6, s6, 5
s_and_b32 s89, s4, 1
s_lshl_b32 s7, s89, 1
s_add_u32 s88, s6, s7
s_and_b32 s6, s3, 3
s_lshl_b32 s6, s6, 3
s_and_b32 s7, s4, 7
s_add_u32 s94, s6, s7
s_lshr_b32 s6, s3, 2
s_xor_b32 s6, s6, 1
s_lshl_b32 s6, s6, 2
s_lshr_b32 s7, s4, 3
s_add_u32 s95, s6, s7
s_mul_i32 s96, s5, 14
s_cmp_eq_u32 s5, 3
s_cselect_b32 s6, 1, 0
s_sub_u32 s96, s96, s6
s_lshr_b32 s6, s4, 3
s_lshl_b32 s7, s3, 2
s_add_u32 s68, s6, s7
s_and_b32 s69, s4, 7
v_mul_u32_u24 v2, 26, v1
v_lshrrev_b32 v2, 8, v2
v_mul_u32_u24 v3, 10, v2
v_sub_u32 v3, v1, v3
s_lshl_b32 s6, s68, 6
s_lshl_b32 s7, s5, 4
s_add_u32 s6, s6, s7
s_mul_i32 s6, s6, 1280
s_mul_i32 s7, s69, 160
s_add_u32 s6, s6, s7
v_mul_u32_u24 v4, 5120, v2
v_lshl_add_u32 v4, v3, 4, v4
v_add_u32 v244, s6, v4
v_subrev_u32 v245, 3840, v244
s_mul_i32 s92, s69, 640
s_mul_i32 s7, s5, 2560
s_add_u32 s7, s7, 142592
s_mov_b32 m0, s7
v_lshl_add_u32 v247, v3, 6, s7
s_lshl_b32 s7, s5, 5
s_sub_u32 s7, 131192, s7
v_mul_u32_u24 v4, 1152, v3
v_lshlrev_b32 v2, 3, v2
v_sub_u32 v4, v4, v2
v_add_u32 v202, s7, v4
v_lshrrev_b32 v2, 3, v1
s_mul_i32 s6, s5, 20
v_add_u32 v2, s6, v2
v_and_b32 v3, 7, v1
v_lshlrev_b32 v3, 4, v3
v_mul_u32_u24 v4, 144, v2
v_add_u32 v4, v4, v3
v_add_u32 v203, 131072, v4
v_lshl_add_u32 v172, v2, 12, v3
s_mul_i32 s6, s69, 327680
s_lshl_b32 s7, s68, 7
s_sub_u32 s6, s6, s7
s_add_u32 s70, s6, 1052544
s_add_u32 s71, s70, 32768
s_add_u32 s72, s70, 65536
s_lshl_b32 s6, s73, 6
s_lshl_b32 s7, s5, 4
s_add_u32 s6, s6, s7
s_mul_i32 s75, s6, 1280
s_lshl_b32 s6, s73, 2
s_add_u32 s6, s6, s5
s_mul_i32 s76, s6, 20480
v_lshlrev_b32 v233, 7, v1
s_lshl_b32 s6, s73, 6
s_lshl_b32 s7, s5, 4
s_add_u32 s74, s6, s7
v_and_b32 v2, 15, v1
v_lshrrev_b32 v3, 4, v1
v_add_u32 v4, s74, v2
v_mul_u32_u24 v4, 1280, v4
v_lshl_add_u32 v211, v3, 4, v4
s_waitcnt lgkmcnt(0)
s_mov_b32 s24, s66
s_and_b32 s25, s67, 0xffff
s_mov_b32 s26, 17825792
s_mov_b32 s27, 0x20000
s_lshl_b32 s6, s88, 1
s_and_b32 s6, s6, 0xfffffffc
s_load_dwordx2 s[0:1], s[50:51], s6
s_cmp_lg_u32 s5, 0
s_cbranch_scc1 L_clr_41
v_lshl_add_u32 v2, v1, 2, v252
v_mov_b32 v3, 0
s_mov_b64 exec, 0xff
buffer_store_dword v3, v2, s[24:27], 0 offen sc1
s_mov_b64 exec, -1
L_clr_41:
s_mov_b32 s12, s42
s_and_b32 s13, s43, 0xffff
s_mov_b32 s14, 2621440
s_mov_b32 s15, 0x20000
s_mov_b32 s16, s44
s_and_b32 s17, s45, 0xffff
s_mov_b32 s18, 2621440
s_mov_b32 s19, 0x20000
s_mov_b32 s32, s46
s_and_b32 s33, s47, 0xffff
s_mov_b32 s34, 5120
s_mov_b32 s35, 0x20000
s_mov_b32 s8, s40
s_and_b32 s9, s41, 0xffff
s_mov_b32 s10, 2621440
s_mov_b32 s11, 0x20000
s_mov_b32 s28, s62
s_and_b32 s29, s63, 0xffff
s_mov_b32 s30, 2621440
s_mov_b32 s31, 0x20000
s_mov_b32 s52, s64
s_and_b32 s53, s65, 0xffff
s_mov_b32 s54, 256
s_mov_b32 s55, 0x20000
s_mov_b32 s42, 0
buffer_load_dwordx4 a[0:3], v211, s[8:11], 0 offen offset:0
buffer_load_dwordx4 a[4:7], v211, s[8:11], 0 offen offset:64
buffer_load_dwordx4 a[8:11], v211, s[8:11], 0 offen offset:128
buffer_load_dwordx4 a[12:15], v211, s[8:11], 0 offen offset:192
s_waitcnt vmcnt(4)
s_cmp_lg_u32 s5, 0
s_cbranch_scc1 L_arr_42
s_and_b32 s6, s2, 7
s_lshl_b32 s6, s6, 5
v_mov_b32 v2, s6
s_mov_b64 exec, 1
buffer_atomic_add v253, v2, s[52:55], 0 offen sc1
s_mov_b64 exec, -1
L_arr_42:
buffer_load_dwordx4 a[16:19], v211, s[8:11], 0 offen offset:256
buffer_load_dwordx4 a[20:23], v211, s[8:11], 0 offen offset:320
buffer_load_dwordx4 a[24:27], v211, s[8:11], 0 offen offset:384
buffer_load_dwordx4 a[28:31], v211, s[8:11], 0 offen offset:448
buffer_load_dwordx4 a[32:35], v211, s[8:11], 0 offen offset:512
buffer_load_dwordx4 a[36:39], v211, s[8:11], 0 offen offset:576
buffer_load_dwordx4 a[40:43], v211, s[8:11], 0 offen offset:640
buffer_load_dwordx4 a[44:47], v211, s[8:11], 0 offen offset:704
buffer_load_dwordx4 a[48:51], v211, s[8:11], 0 offen offset:768
buffer_load_dwordx4 a[52:55], v211, s[8:11], 0 offen offset:832
buffer_load_dwordx4 a[56:59], v211, s[8:11], 0 offen offset:896
buffer_load_dwordx4 a[60:63], v211, s[8:11], 0 offen offset:960
buffer_load_dwordx4 a[64:67], v211, s[8:11], 0 offen offset:1024
buffer_load_dwordx4 a[68:71], v211, s[8:11], 0 offen offset:1088
buffer_load_dwordx4 a[72:75], v211, s[8:11], 0 offen offset:1152
buffer_load_dwordx4 a[76:79], v211, s[8:11], 0 offen offset:1216
v_and_b32 v2, 15, v1
v_min_u32 v2, 13, v2
v_add_u32 v2, s96, v2
v_min_u32 v2, 53, v2
v_lshlrev_b32 v2, 2, v2
s_lshr_b32 s43, s95, 1
v_add_u32 v2, s43, v2
v_lshlrev_b32 v2, 7, v2
v_add_u32 v228, 12, v2
s_lshl_b32 s6, s77, 1
v_and_b32 v4, 1, v1
v_add_u32 v4, s6, v4
v_and_b32 v5, 3, v4
v_add_u32 v5, 28, v5
s_lshr_b32 s6, s77, 2
s_and_b32 s7, s77, 2
s_lshl_b32 s7, s7, 1
s_add_u32 s6, s6, s7
v_mov_b32 v4, s6
v_lshl_add_u32 v4, v5, 3, v4
v_lshlrev_b32 v4, 7, v4
v_add_u32 v231, 4, v4
v_and_b32 v2, 31, v1
v_and_b32 v3, 7, v2
v_lshrrev_b32 v2, 3, v2
v_lshlrev_b32 v2, 3, v2
v_add_u32 v2, s3, v2
v_lshl_add_u32 v2, v2, 3, v3
v_lshlrev_b32 v229, 7, v2
v_cmp_gt_u32 vcc, 14, v1
v_cndmask_b32 v2, 0, v1, vcc
v_cmp_lt_u32 vcc, 6, v2
v_cndmask_b32 v3, 0, 1, vcc
v_mul_u32_u24 v4, 7, v3
v_sub_u32 v2, v2, v4
s_lshr_b32 s6, s94, 1
s_and_b32 s7, s6, 3
s_lshr_b32 s6, s6, 2
v_lshlrev_b32 v3, 2, v3
v_lshlrev_b32 v2, 2, v2
v_add_u32 v2, s7, v2
v_add_u32 v3, s6, v3
v_lshl_add_u32 v2, v2, 3, v3
v_lshlrev_b32 v2, 7, v2
v_add_u32 v249, 16, v2
v_and_b32 v2, 31, v1
v_lshlrev_b32 v2, 3, v2
v_add_u32 v2, s95, v2
v_lshlrev_b32 v2, 7, v2
v_add_u32 v250, 20, v2
v_mov_b32 v2, 2147418112
s_cmp_lg_u32 s5, 0
s_cselect_b64 vcc, -1, 0
v_cndmask_b32 v231, v231, v2, vcc
v_cndmask_b32 v230, v230, v2, vcc
v_mov_b32 v214, 0x3f803f80
v_mov_b32 v215, 0x3f803f80
v_mov_b32 v216, 0x3f803f80
v_mov_b32 v217, 0x3f803f80
v_mov_b32 v218, 0
v_mov_b32 v219, 0
v_mov_b32 v220, 0
v_mov_b32 v221, 0
v_mov_b32 v222, 0
v_mov_b32 v223, 0
v_mov_b32 v224, 0
v_mov_b32 v225, 0
s_waitcnt vmcnt(19)
v_mfma_f32_16x16x32_bf16 v[218:221], a[0:3], a[0:3], v[218:221]
v_mfma_f32_16x16x32_bf16 v[222:225], a[0:3], v[214:217], v[222:225]
s_waitcnt vmcnt(18)
v_mfma_f32_16x16x32_bf16 v[218:221], a[4:7], a[4:7], v[218:221]
v_mfma_f32_16x16x32_bf16 v[222:225], a[4:7], v[214:217], v[222:225]
s_waitcnt vmcnt(17)
v_mfma_f32_16x16x32_bf16 v[218:221], a[8:11], a[8:11], v[218:221]
v_mfma_f32_16x16x32_bf16 v[222:225], a[8:11], v[214:217], v[222:225]
s_waitcnt vmcnt(16)
v_mfma_f32_16x16x32_bf16 v[218:221], a[12:15], a[12:15], v[218:221]
v_mfma_f32_16x16x32_bf16 v[222:225], a[12:15], v[214:217], v[222:225]
s_waitcnt vmcnt(15)
v_mfma_f32_16x16x32_bf16 v[218:221], a[16:19], a[16:19], v[218:221]
v_mfma_f32_16x16x32_bf16 v[222:225], a[16:19], v[214:217], v[222:225]
s_waitcnt vmcnt(14)
v_mfma_f32_16x16x32_bf16 v[218:221], a[20:23], a[20:23], v[218:221]
v_mfma_f32_16x16x32_bf16 v[222:225], a[20:23], v[214:217], v[222:225]
s_waitcnt vmcnt(13)
v_mfma_f32_16x16x32_bf16 v[218:221], a[24:27], a[24:27], v[218:221]
v_mfma_f32_16x16x32_bf16 v[222:225], a[24:27], v[214:217], v[222:225]
s_waitcnt vmcnt(12)
v_mfma_f32_16x16x32_bf16 v[218:221], a[28:31], a[28:31], v[218:221]
v_mfma_f32_16x16x32_bf16 v[222:225], a[28:31], v[214:217], v[222:225]
s_waitcnt vmcnt(11)
v_mfma_f32_16x16x32_bf16 v[218:221], a[32:35], a[32:35], v[218:221]
v_mfma_f32_16x16x32_bf16 v[222:225], a[32:35], v[214:217], v[222:225]
s_waitcnt vmcnt(10)
v_mfma_f32_16x16x32_bf16 v[218:221], a[36:39], a[36:39], v[218:221]
v_mfma_f32_16x16x32_bf16 v[222:225], a[36:39], v[214:217], v[222:225]
s_waitcnt vmcnt(9)
v_mfma_f32_16x16x32_bf16 v[218:221], a[40:43], a[40:43], v[218:221]
v_mfma_f32_16x16x32_bf16 v[222:225], a[40:43], v[214:217], v[222:225]
s_waitcnt vmcnt(8)
v_mfma_f32_16x16x32_bf16 v[218:221], a[44:47], a[44:47], v[218:221]
v_mfma_f32_16x16x32_bf16 v[222:225], a[44:47], v[214:217], v[222:225]
s_waitcnt vmcnt(7)
v_mfma_f32_16x16x32_bf16 v[218:221], a[48:51], a[48:51], v[218:221]
v_mfma_f32_16x16x32_bf16 v[222:225], a[48:51], v[214:217], v[222:225]
s_waitcnt vmcnt(6)
v_mfma_f32_16x16x32_bf16 v[218:221], a[52:55], a[52:55], v[218:221]
v_mfma_f32_16x16x32_bf16 v[222:225], a[52:55], v[214:217], v[222:225]
s_waitcnt vmcnt(5)
v_mfma_f32_16x16x32_bf16 v[218:221], a[56:59], a[56:59], v[218:221]
v_mfma_f32_16x16x32_bf16 v[222:225], a[56:59], v[214:217], v[222:225]
s_waitcnt vmcnt(4)
v_mfma_f32_16x16x32_bf16 v[218:221], a[60:63], a[60:63], v[218:221]
v_mfma_f32_16x16x32_bf16 v[222:225], a[60:63], v[214:217], v[222:225]
s_waitcnt vmcnt(3)
v_mfma_f32_16x16x32_bf16 v[218:221], a[64:67], a[64:67], v[218:221]
v_mfma_f32_16x16x32_bf16 v[222:225], a[64:67], v[214:217], v[222:225]
s_waitcnt vmcnt(2)
v_mfma_f32_16x16x32_bf16 v[218:221], a[68:71], a[68:71], v[218:221]
v_mfma_f32_16x16x32_bf16 v[222:225], a[68:71], v[214:217], v[222:225]
s_waitcnt vmcnt(1)
v_mfma_f32_16x16x32_bf16 v[218:221], a[72:75], a[72:75], v[218:221]
v_mfma_f32_16x16x32_bf16 v[222:225], a[72:75], v[214:217], v[222:225]
s_waitcnt vmcnt(0)
v_mfma_f32_16x16x32_bf16 v[218:221], a[76:79], a[76:79], v[218:221]
v_mfma_f32_16x16x32_bf16 v[222:225], a[76:79], v[214:217], v[222:225]
v_and_b32 v5, 1, v1
v_cmp_eq_u32 vcc, 1, v5
v_and_b32 v5, 2, v1
v_cmp_eq_u32 s[6:7], 2, v5
s_nop 7
v_cndmask_b32 v2, v218, v219, vcc
v_cndmask_b32 v3, v220, v221, vcc
v_cndmask_b32 v4, v222, v223, vcc
v_cndmask_b32 v5, v224, v225, vcc
v_cndmask_b32 v2, v2, v3, s[6:7]
v_cndmask_b32 v3, v4, v5, s[6:7]
v_mul_f32 v214, 0.0015625, v3
v_mul_f32 v2, 0.0015625, v2
v_fma_f32 v2, -v214, v214, v2
v_max_f32 v2, 0, v2
v_add_f32 v2, 0x3727c5ac, v2
v_sqrt_f32 v216, v2
s_nop 0
v_rcp_f32 v215, v216
v_mov_b32 v217, 0
v_sub_f32 v3, 0, v214
v_cvt_pk_bf16_f32 v4, v216, v3
v_lshlrev_b32 v5, 16, v4
v_and_b32 v6, 0xffff0000, v4
v_sub_f32 v5, v216, v5
v_sub_f32 v6, v3, v6
v_cvt_pk_bf16_f32 v5, v5, v6
s_mov_b32 s6, 0x05040100
s_mov_b32 s7, 0x07060302
v_perm_b32 v218, v5, v4, s6
v_perm_b32 v219, v5, v4, s7
v_mov_b32 v220, v219
v_mov_b32 v221, 0
v_lshrrev_b32 v3, 4, v1
v_and_b32 v5, 3, v1
v_lshl_add_u32 v5, v3, 2, v5
v_add_u32 v5, s74, v5
v_lshlrev_b32 v5, 4, v5
s_mov_b32 s6, 65536
s_mov_b32 s7, 98304
s_mov_b32 exec_lo, 0x00f0000f
s_mov_b32 exec_hi, 0xf0000f00
buffer_store_dwordx4 v[218:221], v5, s[24:27], s6 offen sc1
buffer_store_dwordx4 v[214:217], v5, s[24:27], s7 offen sc1
s_mov_b64 exec, -1
buffer_load_dword v254, v230, s[52:55], 0 offen sc1
s_mov_b32 exec_hi, 0xff
buffer_load_dwordx4 v[8:11], v245, s[12:15], 0 offen offset:0
buffer_load_dwordx4 v[12:15], v245, s[12:15], 0 offen offset:1280
buffer_load_dwordx4 v[16:19], v245, s[12:15], 0 offen offset:2560
buffer_load_dwordx4 v[20:23], v244, s[12:15], 0 offen offset:0
buffer_load_dwordx4 v[24:27], v244, s[12:15], 0 offen offset:1280
buffer_load_dwordx4 v[28:31], v244, s[12:15], 0 offen offset:2560
buffer_load_dwordx4 v[32:35], v244, s[12:15], 0 offen offset:3840
buffer_load_dwordx4 v248, s[32:35], s92 offen lds
buffer_load_dwordx4 v[174:177], v244, s[16:19], 0 offen offset:0
buffer_load_dwordx4 v[178:181], v244, s[16:19], 0 offen offset:1280
buffer_load_dwordx4 v[182:185], v244, s[16:19], 0 offen offset:2560
buffer_load_dwordx4 v[186:189], v244, s[16:19], 0 offen offset:3840
s_mov_b64 exec, -1
s_mov_b32 s36, s58
s_and_b32 s37, s59, 0xffff
s_mov_b32 s38, 2211840
s_mov_b32 s39, 0x20000
s_sub_u32 s6, s4, 28
s_lshl_b32 s6, s6, 2
s_add_u32 s6, s6, s5
s_mul_i32 s79, s6, 162
s_lshr_b32 s6, s3, 2
s_lshl_b32 s80, s6, 5
s_and_b32 s7, s3, 3
s_mul_i32 s7, s7, 320
s_and_b32 s81, s7, 0xffffff80
v_add_u32 v2, s79, v1
v_add_u32 v2, 0, v2
v_mul_u32_u24 v3, 2731, v2
v_lshrrev_b32 v3, 18, v3
v_mul_u32_u24 v4, 96, v3
v_sub_u32 v4, v2, v4
v_mul_u32_u24 v5, 86, v4
v_lshrrev_b32 v5, 8, v5
v_mul_u32_u24 v6, 3, v5
v_sub_u32 v6, v4, v6
v_lshlrev_b32 v3, 6, v3
v_add_u32 v3, v3, v5
v_add_u32 v3, s80, v3
v_mul_u32_u24 v3, 1280, v3
v_lshl_add_u32 v3, v6, 7, v3
v_add_u32 v128, s81, v3
v_add_u32 v2, s79, v1
v_add_u32 v2, 64, v2
v_mul_u32_u24 v3, 2731, v2
v_lshrrev_b32 v3, 18, v3
v_mul_u32_u24 v4, 96, v3
v_sub_u32 v4, v2, v4
v_mul_u32_u24 v5, 86, v4
v_lshrrev_b32 v5, 8, v5
v_mul_u32_u24 v6, 3, v5
v_sub_u32 v6, v4, v6
v_lshlrev_b32 v3, 6, v3
v_add_u32 v3, v3, v5
v_add_u32 v3, s80, v3
v_mul_u32_u24 v3, 1280, v3
v_lshl_add_u32 v3, v6, 7, v3
v_add_u32 v129, s81, v3
v_add_u32 v2, s79, v1
v_add_u32 v2, 128, v2
v_mul_u32_u24 v3, 2731, v2
v_lshrrev_b32 v3, 18, v3
v_mul_u32_u24 v4, 96, v3
v_sub_u32 v4, v2, v4
v_mul_u32_u24 v5, 86, v4
v_lshrrev_b32 v5, 8, v5
v_mul_u32_u24 v6, 3, v5
v_sub_u32 v6, v4, v6
v_lshlrev_b32 v3, 6, v3
v_add_u32 v3, v3, v5
v_add_u32 v3, s80, v3
v_mul_u32_u24 v3, 1280, v3
v_lshl_add_u32 v3, v6, 7, v3
v_add_u32 v130, s81, v3
buffer_load_dword v234, v128, s[36:39], 0 offen
buffer_load_dword v234, v129, s[36:39], 0 offen
s_mov_b32 exec_lo, 0xffffffff
s_mov_b32 exec_hi, 0x3
buffer_load_dword v234, v130, s[36:39], 0 offen
s_mov_b64 exec, -1
s_waitcnt vmcnt(16)
s_barrier
s_cmp_lg_u32 s5, 0
s_cbranch_scc1 L_fl_43
s_mov_b64 exec, 1
buffer_store_dword v253, v252, s[24:27], 0 offen offset:4 sc1
s_mov_b64 exec, -1
L_fl_43:
s_waitcnt vmcnt(15)
s_cmp_lg_u32 s5, 0
s_cbranch_scc1 L_back_45
v_cmp_gt_u32 vcc, 32, v254
s_cbranch_vccnz L_slow_44
L_back_45:
s_waitcnt vmcnt(3)
ds_read_b128 v[36:39], v247 offset:0
ds_read_b128 v[40:43], v247 offset:16
ds_read_b128 v[44:47], v247 offset:32
ds_read_b128 v[48:51], v247 offset:48
v_lshlrev_b32 v194, 16, v8
v_and_b32 v195, 0xffff0000, v8
v_lshlrev_b32 v196, 16, v12
v_and_b32 v197, 0xffff0000, v12
v_lshlrev_b32 v198, 16, v16
v_and_b32 v199, 0xffff0000, v16
v_lshlrev_b32 v236, 16, v20
v_and_b32 v237, 0xffff0000, v20
v_lshlrev_b32 v238, 16, v24
v_and_b32 v239, 0xffff0000, v24
v_lshlrev_b32 v240, 16, v28
v_and_b32 v241, 0xffff0000, v28
v_lshlrev_b32 v242, 16, v32
v_and_b32 v243, 0xffff0000, v32
s_waitcnt lgkmcnt(0)
v_lshlrev_b32 v52, 16, v36
v_lshlrev_b32 v53, 16, v38
v_and_b32 v54, 0xffff0000, v36
v_and_b32 v55, 0xffff0000, v38
v_lshlrev_b32 v56, 16, v37
v_lshlrev_b32 v57, 16, v39
v_and_b32 v58, 0xffff0000, v37
v_and_b32 v59, 0xffff0000, v39
v_pk_mul_f32 v[60:61], v[236:237], v[52:53]
v_pk_mul_f32 v[62:63], v[238:239], v[52:53]
v_pk_mul_f32 v[190:191], v[240:241], v[52:53]
v_pk_mul_f32 v[192:193], v[242:243], v[52:53]
v_pk_fma_f32 v[60:61], v[198:199], v[54:55], v[60:61]
v_pk_fma_f32 v[62:63], v[236:237], v[54:55], v[62:63]
v_pk_fma_f32 v[190:191], v[238:239], v[54:55], v[190:191]
v_pk_fma_f32 v[192:193], v[240:241], v[54:55], v[192:193]
v_pk_fma_f32 v[60:61], v[196:197], v[56:57], v[60:61]
v_pk_fma_f32 v[62:63], v[198:199], v[56:57], v[62:63]
v_pk_fma_f32 v[190:191], v[236:237], v[56:57], v[190:191]
v_pk_fma_f32 v[192:193], v[238:239], v[56:57], v[192:193]
v_pk_fma_f32 v[60:61], v[194:195], v[58:59], v[60:61]
v_pk_fma_f32 v[62:63], v[196:197], v[58:59], v[62:63]
v_pk_fma_f32 v[190:191], v[198:199], v[58:59], v[190:191]
v_pk_fma_f32 v[192:193], v[236:237], v[58:59], v[192:193]
v_lshlrev_b32 v194, 16, v174
v_and_b32 v195, 0xffff0000, v174
v_lshlrev_b32 v196, 16, v178
v_and_b32 v197, 0xffff0000, v178
v_lshlrev_b32 v198, 16, v182
v_and_b32 v199, 0xffff0000, v182
v_lshlrev_b32 v236, 16, v186
v_and_b32 v237, 0xffff0000, v186
v_pk_mul_f32 v[60:61], v[60:61], v[194:195]
v_pk_mul_f32 v[62:63], v[62:63], v[196:197]
v_pk_mul_f32 v[190:191], v[190:191], v[198:199]
v_pk_mul_f32 v[192:193], v[192:193], v[236:237]
s_mov_b32 exec_hi, 0xff
v_cvt_pk_bf16_f32 v238, v192, v190
v_cvt_pk_bf16_f32 v239, v62, v60
ds_write_b64 v202, v[238:239] offset:0
v_cvt_pk_bf16_f32 v240, v193, v191
v_cvt_pk_bf16_f32 v241, v63, v61
ds_write_b64 v202, v[240:241] offset:144
s_mov_b64 exec, -1
v_lshlrev_b32 v194, 16, v9
v_and_b32 v195, 0xffff0000, v9
v_lshlrev_b32 v196, 16, v13
v_and_b32 v197, 0xffff0000, v13
v_lshlrev_b32 v198, 16, v17
v_and_b32 v199, 0xffff0000, v17
v_lshlrev_b32 v236, 16, v21
v_and_b32 v237, 0xffff0000, v21
v_lshlrev_b32 v238, 16, v25
v_and_b32 v239, 0xffff0000, v25
v_lshlrev_b32 v240, 16, v29
v_and_b32 v241, 0xffff0000, v29
v_lshlrev_b32 v242, 16, v33
v_and_b32 v243, 0xffff0000, v33
v_lshlrev_b32 v52, 16, v40
v_lshlrev_b32 v53, 16, v42
v_and_b32 v54, 0xffff0000, v40
v_and_b32 v55, 0xffff0000, v42
v_lshlrev_b32 v56, 16, v41
v_lshlrev_b32 v57, 16, v43
v_and_b32 v58, 0xffff0000, v41
v_and_b32 v59, 0xffff0000, v43
v_pk_mul_f32 v[60:61], v[236:237], v[52:53]
v_pk_mul_f32 v[62:63], v[238:239], v[52:53]
v_pk_mul_f32 v[190:191], v[240:241], v[52:53]
v_pk_mul_f32 v[192:193], v[242:243], v[52:53]
v_pk_fma_f32 v[60:61], v[198:199], v[54:55], v[60:61]
v_pk_fma_f32 v[62:63], v[236:237], v[54:55], v[62:63]
v_pk_fma_f32 v[190:191], v[238:239], v[54:55], v[190:191]
v_pk_fma_f32 v[192:193], v[240:241], v[54:55], v[192:193]
v_pk_fma_f32 v[60:61], v[196:197], v[56:57], v[60:61]
v_pk_fma_f32 v[62:63], v[198:199], v[56:57], v[62:63]
v_pk_fma_f32 v[190:191], v[236:237], v[56:57], v[190:191]
v_pk_fma_f32 v[192:193], v[238:239], v[56:57], v[192:193]
v_pk_fma_f32 v[60:61], v[194:195], v[58:59], v[60:61]
v_pk_fma_f32 v[62:63], v[196:197], v[58:59], v[62:63]
v_pk_fma_f32 v[190:191], v[198:199], v[58:59], v[190:191]
v_pk_fma_f32 v[192:193], v[236:237], v[58:59], v[192:193]
v_lshlrev_b32 v194, 16, v175
v_and_b32 v195, 0xffff0000, v175
v_lshlrev_b32 v196, 16, v179
v_and_b32 v197, 0xffff0000, v179
v_lshlrev_b32 v198, 16, v183
v_and_b32 v199, 0xffff0000, v183
v_lshlrev_b32 v236, 16, v187
v_and_b32 v237, 0xffff0000, v187
v_pk_mul_f32 v[60:61], v[60:61], v[194:195]
v_pk_mul_f32 v[62:63], v[62:63], v[196:197]
v_pk_mul_f32 v[190:191], v[190:191], v[198:199]
v_pk_mul_f32 v[192:193], v[192:193], v[236:237]
s_mov_b32 exec_hi, 0xff
v_cvt_pk_bf16_f32 v238, v192, v190
v_cvt_pk_bf16_f32 v239, v62, v60
ds_write_b64 v202, v[238:239] offset:288
v_cvt_pk_bf16_f32 v240, v193, v191
v_cvt_pk_bf16_f32 v241, v63, v61
ds_write_b64 v202, v[240:241] offset:432
s_mov_b64 exec, -1
v_lshlrev_b32 v194, 16, v10
v_and_b32 v195, 0xffff0000, v10
v_lshlrev_b32 v196, 16, v14
v_and_b32 v197, 0xffff0000, v14
v_lshlrev_b32 v198, 16, v18
v_and_b32 v199, 0xffff0000, v18
v_lshlrev_b32 v236, 16, v22
v_and_b32 v237, 0xffff0000, v22
v_lshlrev_b32 v238, 16, v26
v_and_b32 v239, 0xffff0000, v26
v_lshlrev_b32 v240, 16, v30
v_and_b32 v241, 0xffff0000, v30
v_lshlrev_b32 v242, 16, v34
v_and_b32 v243, 0xffff0000, v34
v_lshlrev_b32 v52, 16, v44
v_lshlrev_b32 v53, 16, v46
v_and_b32 v54, 0xffff0000, v44
v_and_b32 v55, 0xffff0000, v46
v_lshlrev_b32 v56, 16, v45
v_lshlrev_b32 v57, 16, v47
v_and_b32 v58, 0xffff0000, v45
v_and_b32 v59, 0xffff0000, v47
v_pk_mul_f32 v[60:61], v[236:237], v[52:53]
v_pk_mul_f32 v[62:63], v[238:239], v[52:53]
v_pk_mul_f32 v[190:191], v[240:241], v[52:53]
v_pk_mul_f32 v[192:193], v[242:243], v[52:53]
v_pk_fma_f32 v[60:61], v[198:199], v[54:55], v[60:61]
v_pk_fma_f32 v[62:63], v[236:237], v[54:55], v[62:63]
v_pk_fma_f32 v[190:191], v[238:239], v[54:55], v[190:191]
v_pk_fma_f32 v[192:193], v[240:241], v[54:55], v[192:193]
v_pk_fma_f32 v[60:61], v[196:197], v[56:57], v[60:61]
v_pk_fma_f32 v[62:63], v[198:199], v[56:57], v[62:63]
v_pk_fma_f32 v[190:191], v[236:237], v[56:57], v[190:191]
v_pk_fma_f32 v[192:193], v[238:239], v[56:57], v[192:193]
v_pk_fma_f32 v[60:61], v[194:195], v[58:59], v[60:61]
v_pk_fma_f32 v[62:63], v[196:197], v[58:59], v[62:63]
v_pk_fma_f32 v[190:191], v[198:199], v[58:59], v[190:191]
v_pk_fma_f32 v[192:193], v[236:237], v[58:59], v[192:193]
v_lshlrev_b32 v194, 16, v176
v_and_b32 v195, 0xffff0000, v176
v_lshlrev_b32 v196, 16, v180
v_and_b32 v197, 0xffff0000, v180
v_lshlrev_b32 v198, 16, v184
v_and_b32 v199, 0xffff0000, v184
v_lshlrev_b32 v236, 16, v188
v_and_b32 v237, 0xffff0000, v188
v_pk_mul_f32 v[60:61], v[60:61], v[194:195]
v_pk_mul_f32 v[62:63], v[62:63], v[196:197]
v_pk_mul_f32 v[190:191], v[190:191], v[198:199]
v_pk_mul_f32 v[192:193], v[192:193], v[236:237]
s_mov_b32 exec_hi, 0xff
v_cvt_pk_bf16_f32 v238, v192, v190
v_cvt_pk_bf16_f32 v239, v62, v60
ds_write_b64 v202, v[238:239] offset:576
v_cvt_pk_bf16_f32 v240, v193, v191
v_cvt_pk_bf16_f32 v241, v63, v61
ds_write_b64 v202, v[240:241] offset:720
s_mov_b64 exec, -1
v_lshlrev_b32 v194, 16, v11
v_and_b32 v195, 0xffff0000, v11
v_lshlrev_b32 v196, 16, v15
v_and_b32 v197, 0xffff0000, v15
v_lshlrev_b32 v198, 16, v19
v_and_b32 v199, 0xffff0000, v19
v_lshlrev_b32 v236, 16, v23
v_and_b32 v237, 0xffff0000, v23
v_lshlrev_b32 v238, 16, v27
v_and_b32 v239, 0xffff0000, v27
v_lshlrev_b32 v240, 16, v31
v_and_b32 v241, 0xffff0000, v31
v_lshlrev_b32 v242, 16, v35
v_and_b32 v243, 0xffff0000, v35
v_lshlrev_b32 v52, 16, v48
v_lshlrev_b32 v53, 16, v50
v_and_b32 v54, 0xffff0000, v48
v_and_b32 v55, 0xffff0000, v50
v_lshlrev_b32 v56, 16, v49
v_lshlrev_b32 v57, 16, v51
v_and_b32 v58, 0xffff0000, v49
v_and_b32 v59, 0xffff0000, v51
v_pk_mul_f32 v[60:61], v[236:237], v[52:53]
v_pk_mul_f32 v[62:63], v[238:239], v[52:53]
v_pk_mul_f32 v[190:191], v[240:241], v[52:53]
v_pk_mul_f32 v[192:193], v[242:243], v[52:53]
v_pk_fma_f32 v[60:61], v[198:199], v[54:55], v[60:61]
v_pk_fma_f32 v[62:63], v[236:237], v[54:55], v[62:63]
v_pk_fma_f32 v[190:191], v[238:239], v[54:55], v[190:191]
v_pk_fma_f32 v[192:193], v[240:241], v[54:55], v[192:193]
v_pk_fma_f32 v[60:61], v[196:197], v[56:57], v[60:61]
v_pk_fma_f32 v[62:63], v[198:199], v[56:57], v[62:63]
v_pk_fma_f32 v[190:191], v[236:237], v[56:57], v[190:191]
v_pk_fma_f32 v[192:193], v[238:239], v[56:57], v[192:193]
v_pk_fma_f32 v[60:61], v[194:195], v[58:59], v[60:61]
v_pk_fma_f32 v[62:63], v[196:197], v[58:59], v[62:63]
v_pk_fma_f32 v[190:191], v[198:199], v[58:59], v[190:191]
v_pk_fma_f32 v[192:193], v[236:237], v[58:59], v[192:193]
v_lshlrev_b32 v194, 16, v177
v_and_b32 v195, 0xffff0000, v177
v_lshlrev_b32 v196, 16, v181
v_and_b32 v197, 0xffff0000, v181
v_lshlrev_b32 v198, 16, v185
v_and_b32 v199, 0xffff0000, v185
v_lshlrev_b32 v236, 16, v189
v_and_b32 v237, 0xffff0000, v189
v_pk_mul_f32 v[60:61], v[60:61], v[194:195]
v_pk_mul_f32 v[62:63], v[62:63], v[196:197]
v_pk_mul_f32 v[190:191], v[190:191], v[198:199]
v_pk_mul_f32 v[192:193], v[192:193], v[236:237]
s_mov_b32 exec_hi, 0xff
v_cvt_pk_bf16_f32 v238, v192, v190
v_cvt_pk_bf16_f32 v239, v62, v60
ds_write_b64 v202, v[238:239] offset:864
v_cvt_pk_bf16_f32 v240, v193, v191
v_cvt_pk_bf16_f32 v241, v63, v61
ds_write_b64 v202, v[240:241] offset:1008
s_mov_b64 exec, -1
s_waitcnt lgkmcnt(0)
s_barrier
ds_read_b128 v[8:11], v203 offset:0
ds_read_b128 v[12:15], v203 offset:1152
ds_read_b128 v[16:19], v203 offset:2304
s_waitcnt lgkmcnt(0)
buffer_store_dwordx4 v[8:11], v172, s[24:27], s70 offen sc1
buffer_store_dwordx4 v[12:15], v172, s[24:27], s71 offen sc1
s_mov_b32 exec_hi, 0
buffer_store_dwordx4 v[16:19], v172, s[24:27], s72 offen sc1
s_mov_b64 exec, -1
buffer_load_dword v254, v229, s[24:27], 0 offen sc1
s_waitcnt vmcnt(1)
s_barrier
s_cmp_lg_u32 s5, 0
s_cbranch_scc1 L_fl_46
s_mov_b64 exec, 1
buffer_store_dword v253, v252, s[24:27], 0 offen offset:0 sc1
s_mov_b64 exec, -1
L_fl_46:
s_waitcnt vmcnt(0)
v_cmp_eq_u32 vcc, 0, v254
s_cbranch_vccnz L_slow_47
L_back_48:
v_mov_b32 v60, 2147418112
s_mov_b32 s100, 0
s_mov_b32 s101, 0
s_lshl_b32 s6, s5, 2
v_lshlrev_b32 v202, 2, v1
v_add_u32 v202, s6, v202
v_subrev_u32 v202, 252, v202
v_add_u32 v203, s6, v248
v_add_u32 v203, 4, v203
s_mul_i32 s90, s5, 4416
s_add_u32 s6, s88, 0
s_lshl_b32 s6, s6, 12
s_add_u32 s32, s48, s6
s_addc_u32 s33, s49, 0
s_and_b32 s33, s33, 0xffff
s_mov_b32 s34, 4096
s_mov_b32 s35, 0x20000
s_add_u32 m0, s90, 65536
s_nop 0
buffer_load_dword v202, s[32:35], 0 offen lds
s_add_u32 m0, s90, 65792
s_nop 0
buffer_load_dwordx4 v203, s[32:35], 0 offen offset:0 lds
buffer_load_dwordx4 v203, s[32:35], 0 offen offset:1024 lds
buffer_load_dwordx4 v203, s[32:35], 0 offen offset:2048 lds
buffer_load_dwordx4 v203, s[32:35], 0 offen offset:3072 lds
s_add_u32 s6, s88, 1
s_lshl_b32 s6, s6, 12
s_add_u32 s32, s48, s6
s_addc_u32 s33, s49, 0
s_and_b32 s33, s33, 0xffff
s_mov_b32 s34, 4096
s_mov_b32 s35, 0x20000
s_add_u32 m0, s90, 95744
s_nop 0
buffer_load_dword v202, s[32:35], 0 offen lds
s_add_u32 m0, s90, 96000
s_nop 0
buffer_load_dwordx4 v203, s[32:35], 0 offen offset:0 lds
buffer_load_dwordx4 v203, s[32:35], 0 offen offset:1024 lds
buffer_load_dwordx4 v203, s[32:35], 0 offen offset:2048 lds
buffer_load_dwordx4 v203, s[32:35], 0 offen offset:3072 lds
s_add_u32 s6, s88, 2
s_lshl_b32 s6, s6, 12
s_add_u32 s32, s48, s6
s_addc_u32 s33, s49, 0
s_and_b32 s33, s33, 0xffff
s_mov_b32 s34, 4096
s_mov_b32 s35, 0x20000
s_add_u32 m0, s90, 125952
s_nop 0
buffer_load_dword v202, s[32:35], 0 offen lds
s_add_u32 m0, s90, 126208
s_nop 0
buffer_load_dwordx4 v203, s[32:35], 0 offen offset:0 lds
buffer_load_dwordx4 v203, s[32:35], 0 offen offset:1024 lds
buffer_load_dwordx4 v203, s[32:35], 0 offen offset:2048 lds
buffer_load_dwordx4 v203, s[32:35], 0 offen offset:3072 lds
v_lshlrev_b32 v4, 4, v0
s_add_u32 s6, s88, 0
s_lshl_b32 s6, s6, 12
s_add_u32 s6, s6, 1048576
s_add_u32 s36, s66, s6
s_addc_u32 s37, s67, 0
s_and_b32 s37, s37, 0xffff
s_mov_b32 s38, 4096
s_mov_b32 s39, 0x20000
buffer_load_dwordx4 v[32:35], v4, s[36:39], 0 offen
buffer_load_dword v36, v4, s[36:39], 0 offen offset:16
s_add_u32 s6, s88, 1
s_lshl_b32 s6, s6, 12
s_add_u32 s6, s6, 1048576
s_add_u32 s36, s66, s6
s_addc_u32 s37, s67, 0
s_and_b32 s37, s37, 0xffff
s_mov_b32 s38, 4096
s_mov_b32 s39, 0x20000
buffer_load_dwordx4 v[38:41], v4, s[36:39], 0 offen
buffer_load_dword v42, v4, s[36:39], 0 offen offset:16
s_add_u32 s6, s88, 2
s_lshl_b32 s6, s6, 12
s_add_u32 s6, s6, 1048576
s_add_u32 s36, s66, s6
s_addc_u32 s37, s67, 0
s_and_b32 s37, s37, 0xffff
s_mov_b32 s38, 4096
s_mov_b32 s39, 0x20000
buffer_load_dwordx4 v[44:47], v4, s[36:39], 0 offen
buffer_load_dword v48, v4, s[36:39], 0 offen offset:16
buffer_load_dword v254, v228, s[24:27], 0 offen sc1
v_lshlrev_b32 v5, 4, v0
v_add_u32 v5, 87552, v5
v_add_u32 v7, 60416, v5
v_mov_b32 v12, 0
v_mov_b32 v13, 0
v_mov_b32 v14, 0
v_mov_b32 v15, 0
v_cmp_gt_u32 vcc, 119, v0
s_and_saveexec_b64 s[6:7], vcc
ds_write_b128 v5, v[12:15] offset:0
ds_write_b128 v5, v[12:15] offset:6272
ds_write_b128 v5, v[12:15] offset:30208
ds_write_b128 v5, v[12:15] offset:36480
ds_write_b128 v7, v[12:15] offset:0
ds_write_b128 v7, v[12:15] offset:6272
s_mov_b64 exec, s[6:7]
v_lshrrev_b32 v4, 4, v0
v_mul_u32_u24 v4, 272, v4
v_and_b32 v5, 15, v0
v_lshl_add_u32 v4, v5, 4, v4
v_add_u32 v4, 83200, v4
v_add_u32 v6, 60416, v4
s_waitcnt vmcnt(1)
ds_write_b128 v4, v[32:35] offset:6272
v_alignbit_b32 v12, v33, v32, 16
v_alignbit_b32 v13, v34, v33, 16
v_alignbit_b32 v14, v35, v34, 16
v_alignbit_b32 v15, v36, v35, 16
ds_write_b128 v4, v[12:15] offset:0
ds_write_b128 v4, v[38:41] offset:36480
v_alignbit_b32 v12, v39, v38, 16
v_alignbit_b32 v13, v40, v39, 16
v_alignbit_b32 v14, v41, v40, 16
v_alignbit_b32 v15, v42, v41, 16
ds_write_b128 v4, v[12:15] offset:30208
ds_write_b128 v6, v[44:47] offset:6272
v_alignbit_b32 v12, v45, v44, 16
v_alignbit_b32 v13, v46, v45, 16
v_alignbit_b32 v14, v47, v46, 16
v_alignbit_b32 v15, v48, v47, 16
ds_write_b128 v6, v[12:15] offset:0
s_waitcnt vmcnt(0)
v_cmp_eq_u32 vcc, 0, v254
s_cbranch_vccnz L_slow_49
L_back_50:
s_lshr_b32 s6, s4, 3
s_mul_i32 s6, s6, 14
s_and_b32 s7, s4, 7
s_mul_i32 s7, s7, 7
s_add_u32 s6, s6, s7
s_lshr_b32 s6, s6, 2
s_cmp_ge_u32 s5, 2
s_cselect_b32 s43, 13, 14
s_cmp_ge_u32 s6, s43
s_cselect_b32 s7, s43, 0
s_sub_u32 s93, s6, s7
s_mov_b32 s93, 0
s_mul_i32 s6, s95, 54
s_add_u32 s6, s6, s96
s_mul_i32 s79, s6, 5120
s_add_u32 s79, s79, 7340032
s_mul_i32 s7, s43, 5120
s_add_u32 s80, s79, s7
s_mul_i32 s7, s93, 5120
s_add_u32 s97, s79, s7
s_add_u32 s98, s97, 4096
buffer_load_dwordx4 a[0:3], v248, s[24:27], s97 offen offset:0
buffer_load_dwordx4 a[4:7], v248, s[24:27], s97 offen offset:1024
buffer_load_dwordx4 a[8:11], v248, s[24:27], s97 offen offset:2048
buffer_load_dwordx4 a[12:15], v248, s[24:27], s97 offen offset:3072
buffer_load_dwordx4 a[16:19], v248, s[24:27], s98 offen
s_add_u32 s97, s97, 5120
s_cmp_eq_u32 s97, s80
s_cselect_b32 s97, s79, s97
s_add_u32 s98, s97, 4096
buffer_load_dwordx4 a[20:23], v248, s[24:27], s97 offen offset:0
buffer_load_dwordx4 a[24:27], v248, s[24:27], s97 offen offset:1024
buffer_load_dwordx4 a[28:31], v248, s[24:27], s97 offen offset:2048
buffer_load_dwordx4 a[32:35], v248, s[24:27], s97 offen offset:3072
buffer_load_dwordx4 a[36:39], v248, s[24:27], s98 offen
s_add_u32 s97, s97, 5120
s_cmp_eq_u32 s97, s80
s_cselect_b32 s97, s79, s97
s_add_u32 s98, s97, 4096
buffer_load_dwordx4 a[40:43], v248, s[24:27], s97 offen offset:0
buffer_load_dwordx4 a[44:47], v248, s[24:27], s97 offen offset:1024
buffer_load_dwordx4 a[48:51], v248, s[24:27], s97 offen offset:2048
buffer_load_dwordx4 a[52:55], v248, s[24:27], s97 offen offset:3072
buffer_load_dwordx4 a[56:59], v248, s[24:27], s98 offen
s_add_u32 s97, s97, 5120
s_cmp_eq_u32 s97, s80
s_cselect_b32 s97, s79, s97
s_add_u32 s98, s97, 4096
buffer_load_dwordx4 a[60:63], v248, s[24:27], s97 offen offset:0
buffer_load_dwordx4 a[64:67], v248, s[24:27], s97 offen offset:1024
buffer_load_dwordx4 a[68:71], v248, s[24:27], s97 offen offset:2048
buffer_load_dwordx4 a[72:75], v248, s[24:27], s97 offen offset:3072
buffer_load_dwordx4 a[76:79], v248, s[24:27], s98 offen
s_add_u32 s97, s97, 5120
s_cmp_eq_u32 s97, s80
s_cselect_b32 s97, s79, s97
s_add_u32 s98, s97, 4096
s_lshl_b32 s6, s89, 2
s_add_u32 s6, s6, s5
s_lshl_b32 s7, s6, 1
s_lshr_b32 s85, 6436, s7
s_and_b32 s85, s85, 3
s_lshr_b32 s86, 55, s6
s_and_b32 s86, s86, 1
s_lshr_b32 s87, 61311, s7
s_and_b32 s87, s87, 3
v_and_b32 v2, 3, v1
v_mul_u32_u24 v2, 4416, v2
v_bfe_u32 v3, v1, 2, 2
v_lshrrev_b32 v18, 4, v1
v_add_u32 v3, v3, v18
v_lshl_add_u32 v16, v3, 4, v2
v_and_b32 v2, 1, v1
v_mul_u32_u24 v2, 6272, v2
v_bfe_u32 v3, v1, 1, 3
s_lshl_b32 s6, s86, 3
s_sub_u32 s6, 15, s6
v_sub_u32 v5, s6, v3
v_mul_u32_u24 v5, 272, v5
v_add_u32 v2, v2, v5
v_lshl_add_u32 v17, v18, 4, v2
s_lshl_b32 s6, s86, 3
v_add_u32 v3, s6, v3
v_lshlrev_b32 v3, 8, v3
v_and_b32 v2, 1, v1
v_lshl_or_b32 v2, v18, 1, v2
v_lshl_or_b32 v11, v2, 4, v3
s_mul_i32 s6, s85, 30208
s_add_u32 s6, s6, 65536
v_add_u32 v8, s6, v16
s_add_u32 s6, s6, 17664
v_add_u32 v9, s6, v17
v_lshlrev_b32 v10, 5, v18
v_sub_u32 v10, v9, v10
v_add_u32 v10, 0, v10
s_add_u32 s91, s88, s85
s_branch L_conv
L_slow_11:
s_add_u32 s42, s42, 1
s_cmp_gt_u32 s42, 200000
s_cbranch_scc1 L_back_12
buffer_load_dword v254, v230, s[52:55], 0 offen sc1
s_waitcnt vmcnt(0)
v_cmp_gt_u32 vcc, 32, v254
s_cbranch_vccnz L_slow_11
s_branch L_back_12
L_slow_20:
s_add_u32 s42, s42, 1
s_cmp_gt_u32 s42, 200000
s_cbranch_scc1 L_back_21
buffer_load_dword v254, v231, s[24:27], 0 offen sc1
s_waitcnt vmcnt(0)
v_cmp_eq_u32 vcc, 0, v254
s_cbranch_vccnz L_slow_20
s_branch L_back_21
L_slow_27:
s_add_u32 s42, s42, 1
s_cmp_gt_u32 s42, 200000
s_cbranch_scc1 L_back_28
buffer_load_dword v251, v229, s[24:27], 0 offen sc1
s_waitcnt vmcnt(0)
v_cmp_eq_u32 vcc, 0, v251
s_cbranch_vccnz L_slow_27
s_branch L_back_28
L_slow_29:
s_add_u32 s42, s42, 1
s_cmp_gt_u32 s42, 200000
s_cbranch_scc1 L_back_30
buffer_load_dword v254, v228, s[24:27], 0 offen sc1
s_waitcnt vmcnt(0)
v_cmp_eq_u32 vcc, 0, v254
s_cbranch_vccnz L_slow_29
s_branch L_back_30
L_slow_34:
s_add_u32 s42, s42, 1
s_cmp_gt_u32 s42, 200000
s_cbranch_scc1 L_back_35
buffer_load_dword v254, v249, s[24:27], 0 offen sc1
s_waitcnt vmcnt(0)
v_cmp_eq_u32 vcc, 0, v254
s_cbranch_vccnz L_slow_34
s_branch L_back_35
L_slow_38:
s_add_u32 s42, s42, 1
s_cmp_gt_u32 s42, 200000
s_cbranch_scc1 L_back_39
buffer_load_dword v254, v250, s[24:27], 0 offen sc1
s_waitcnt vmcnt(0)
v_cmp_eq_u32 vcc, 0, v254
s_cbranch_vccnz L_slow_38
s_branch L_back_39
L_slow_44:
s_add_u32 s42, s42, 1
s_cmp_gt_u32 s42, 200000
s_cbranch_scc1 L_back_45
buffer_load_dword v254, v230, s[52:55], 0 offen sc1
s_waitcnt vmcnt(0)
v_cmp_gt_u32 vcc, 32, v254
s_cbranch_vccnz L_slow_44
s_branch L_back_45
L_slow_47:
s_add_u32 s42, s42, 1
s_cmp_gt_u32 s42, 200000
s_cbranch_scc1 L_back_48
buffer_load_dword v254, v229, s[24:27], 0 offen sc1
s_waitcnt vmcnt(0)
v_cmp_eq_u32 vcc, 0, v254
s_cbranch_vccnz L_slow_47
s_branch L_back_48
L_slow_49:
s_add_u32 s42, s42, 1
s_cmp_gt_u32 s42, 200000
s_cbranch_scc1 L_back_50
buffer_load_dword v254, v228, s[24:27], 0 offen sc1
s_waitcnt vmcnt(0)
v_cmp_eq_u32 vcc, 0, v254
s_cbranch_vccnz L_slow_49
s_branch L_back_50
L_code_end:
.section .rodata,"a"
.p2align 6
.amdhsa_kernel recurrent_scan__ssm_conv_h3__dense_activation_gelu__prompt_kernel
  .amdhsa_next_free_vgpr 512
  .amdhsa_next_free_sgpr 102
  .amdhsa_accum_offset 256
  .amdhsa_group_segment_fixed_size 0
  .amdhsa_kernarg_size 112
  .amdhsa_user_sgpr_count 2
  .amdhsa_user_sgpr_kernarg_segment_ptr 1
  .amdhsa_system_sgpr_workgroup_id_x 1
.end_amdhsa_kernel
```

```asm
; @launch grid=(256,1,1) block=(256,1,1) lds=163840
.amdgcn_target "amdgcn-amd-amdhsa--gfx950"
.text
.globl recurrent_scan__ssm_conv_h3__dense_activation_gelu__prompt_kernel
.p2align 8
.type recurrent_scan__ssm_conv_h3__dense_activation_gelu__prompt_kernel,@function
recurrent_scan__ssm_conv_h3__dense_activation_gelu__prompt_kernel:
s_cmp_ge_u32 s2, 256
s_cbranch_scc1 L_end
s_load_dwordx16 s[40:55], s[0:1], 0
s_load_dwordx8 s[56:63], s[0:1], 64
s_load_dwordx4 s[64:67], s[0:1], 96
s_and_b32 s3, s2, 7
s_lshr_b32 s4, s2, 3
v_lshrrev_b32 v1, 6, v0
v_and_b32 v0, 0xff, v0
v_mov_b32 v253, 1
v_readfirstlane_b32 s5, v1
v_and_b32 v1, 63, v0
s_lshl_b32 s6, s2, 7
v_mov_b32 v252, s6
v_lshlrev_b32 v248, 4, v1
v_and_b32 v230, 7, v1
v_lshlrev_b32 v230, 5, v230
v_mov_b32 v255, 0
s_cmp_ge_u32 s4, 28
s_cbranch_scc1 L_spare
s_and_b32 s6, s3, 3
s_lshl_b32 s6, s6, 2
s_and_b32 s7, s4, 3
s_add_u32 s77, s6, s7
s_lshr_b32 s6, s3, 2
s_mul_i32 s6, s6, 7
s_lshr_b32 s7, s4, 2
s_add_u32 s78, s6, s7
s_and_b32 s82, s5, 1
s_lshr_b32 s83, s5, 1
s_lshl_b32 s6, s3, 4
s_lshr_b32 s7, s4, 1
s_add_u32 s6, s6, s7
s_mul_i32 s6, s6, 5
s_and_b32 s89, s4, 1
s_lshl_b32 s7, s89, 1
s_add_u32 s88, s6, s7
s_and_b32 s6, s3, 3
s_lshl_b32 s6, s6, 3
s_and_b32 s7, s4, 7
s_add_u32 s94, s6, s7
s_lshr_b32 s6, s3, 2
s_xor_b32 s6, s6, 1
s_lshl_b32 s6, s6, 2
s_lshr_b32 s7, s4, 3
s_add_u32 s95, s6, s7
s_mul_i32 s96, s5, 14
s_cmp_eq_u32 s5, 3
s_cselect_b32 s6, 1, 0
s_sub_u32 s96, s96, s6
s_lshr_b32 s6, s4, 3
s_lshl_b32 s7, s3, 2
s_add_u32 s68, s6, s7
s_and_b32 s69, s4, 7
v_mul_u32_u24 v2, 26, v1
v_lshrrev_b32 v2, 8, v2
v_mul_u32_u24 v3, 10, v2
v_sub_u32 v3, v1, v3
s_lshl_b32 s6, s68, 6
s_lshl_b32 s7, s5, 4
s_add_u32 s6, s6, s7
s_mul_i32 s6, s6, 1280
s_mul_i32 s7, s69, 160
s_add_u32 s6, s6, s7
v_mul_u32_u24 v4, 5120, v2
v_lshl_add_u32 v4, v3, 4, v4
v_add_u32 v244, s6, v4
v_subrev_u32 v245, 3840, v244
s_mul_i32 s92, s69, 640
s_mul_i32 s7, s5, 2560
s_add_u32 s7, s7, 142592
s_mov_b32 m0, s7
v_lshl_add_u32 v247, v3, 6, s7
s_lshl_b32 s7, s5, 5
s_sub_u32 s7, 131192, s7
v_mul_u32_u24 v4, 1152, v3
v_lshlrev_b32 v2, 3, v2
v_sub_u32 v4, v4, v2
v_add_u32 v202, s7, v4
v_lshrrev_b32 v2, 3, v1
s_mul_i32 s6, s5, 20
v_add_u32 v2, s6, v2
v_and_b32 v3, 7, v1
v_lshlrev_b32 v3, 4, v3
v_mul_u32_u24 v4, 144, v2
v_add_u32 v4, v4, v3
v_add_u32 v203, 131072, v4
v_lshl_add_u32 v172, v2, 12, v3
s_mul_i32 s6, s69, 327680
s_lshl_b32 s7, s68, 7
s_sub_u32 s6, s6, s7
s_add_u32 s70, s6, 1052544
s_add_u32 s71, s70, 32768
s_add_u32 s72, s70, 65536
s_lshl_b32 s79, s78, 8
s_mul_i32 s80, s77, 163840
s_lshl_b32 s81, s5, 12
v_lshrrev_b32 v2, 4, v1
v_and_b32 v3, 15, v1
v_lshlrev_b32 v4, 2, v2
v_xor_b32 v4, v3, v4
s_lshl_b32 s6, s5, 4
v_add_u32 v5, s6, v2
v_mul_u32_u24 v5, 3456, v5
v_lshl_add_u32 v208, v4, 4, v5
s_cmp_eq_u32 s78, 13
s_cselect_b32 s7, 8, 16
v_cmp_le_u32 vcc, s7, v4
v_mov_b32 v6, 2147418112
v_cndmask_b32 v208, v208, v6, vcc
v_add_u32 v209, 12800, v208
v_add_u32 v210, 25600, v208
v_add_u32 v211, 38400, v208
v_lshrrev_b32 v4, 3, v1
v_and_b32 v5, 7, v1
s_lshl_b32 s6, s5, 5
v_add_u32 v4, s6, v4
v_mul_u32_u24 v4, 1280, v4
v_add_u32 v6, 0, v2
v_xor_b32 v6, v5, v6
v_lshl_add_u32 v6, v6, 4, v4
v_add_u32 v212, 0, v6
v_add_u32 v6, 4, v2
v_xor_b32 v6, v5, v6
v_lshl_add_u32 v6, v6, 4, v4
v_add_u32 v213, 9216, v6
v_add_u32 v6, 0, v2
v_xor_b32 v6, v5, v6
v_lshl_add_u32 v6, v6, 4, v4
v_add_u32 v214, 18432, v6
v_add_u32 v6, 4, v2
v_xor_b32 v6, v5, v6
v_lshl_add_u32 v6, v6, 4, v4
v_add_u32 v215, 27648, v6
s_lshl_b32 s6, s4, 2
s_add_u32 s6, s6, s5
s_lshl_b32 s7, s6, 3
v_and_b32 v2, 7, v1
v_add_u32 v2, s7, v2
v_lshrrev_b32 v3, 3, v1
v_mul_u32_u24 v4, 4682, v2
v_lshrrev_b32 v4, 16, v4
v_mul_u32_u24 v5, 14, v4
v_sub_u32 v5, v2, v5
v_lshl_add_u32 v4, v3, 6, v4
v_mul_u32_u24 v4, 3456, v4
v_lshl_add_u32 v4, v5, 7, v4
s_lshr_b32 s7, s3, 2
s_mul_i32 s73, s7, 1792
v_add_u32 v4, s73, v4
s_sub_u32 s7, 13, s7
v_mov_b32 v6, 2147418112
v_cmp_lt_u32 vcc, s7, v5
v_cndmask_b32 v232, v4, v6, vcc
v_mul_u32_u24 v2, 52, v1
v_lshrrev_b32 v2, 8, v2
v_mul_u32_u24 v3, 5, v2
v_sub_u32 v3, v1, v3
s_mul_i32 s7, s6, 5
v_add_u32 v3, s7, v3
v_cmp_gt_u32 vcc, 512, v3
s_and_b32 s7, s3, 3
s_lshl_b32 s7, s7, 9
v_add_u32 v3, s7, v3
v_mul_u32_u24 v3, 1280, v3
v_lshl_add_u32 v3, v2, 7, v3
v_cndmask_b32 v233, v6, v3, vcc
s_lshl_b32 s6, s68, 6
s_lshl_b32 s7, s5, 4
s_add_u32 s6, s6, s7
s_mul_i32 s6, s6, 1280
s_mul_i32 s7, s69, 160
s_and_b32 s7, s7, 0xffffff80
s_add_u32 s6, s6, s7
v_lshrrev_b32 v2, 1, v1
v_mul_u32_u24 v2, 1280, v2
v_and_b32 v3, 1, v1
v_lshl_add_u32 v2, v3, 7, v2
v_add_u32 v129, s6, v2
v_subrev_u32 v128, 3840, v129
s_mul_i32 s7, s69, 640
v_lshlrev_b32 v2, 7, v1
v_add_u32 v130, s7, v2
s_waitcnt lgkmcnt(0)
s_mov_b32 s24, s66
s_and_b32 s25, s67, 0xffff
s_mov_b32 s26, 17825792
s_mov_b32 s27, 0x20000
s_lshl_b32 s6, s88, 1
s_and_b32 s6, s6, 0xfffffffc
s_load_dwordx2 s[0:1], s[50:51], s6
s_cmp_lg_u32 s5, 0
s_cbranch_scc1 L_clr_1
v_lshl_add_u32 v2, v1, 2, v252
v_mov_b32 v3, 0
s_mov_b64 exec, 0xff
buffer_store_dword v3, v2, s[24:27], 0 offen sc1
s_mov_b64 exec, -1
L_clr_1:
s_mov_b32 s12, s42
s_and_b32 s13, s43, 0xffff
s_mov_b32 s14, 2621440
s_mov_b32 s15, 0x20000
s_mov_b32 s16, s44
s_and_b32 s17, s45, 0xffff
s_mov_b32 s18, 2621440
s_mov_b32 s19, 0x20000
s_mov_b32 s32, s46
s_and_b32 s33, s47, 0xffff
s_mov_b32 s34, 5120
s_mov_b32 s35, 0x20000
s_mov_b32 exec_hi, 0xff
buffer_load_dwordx4 v[8:11], v245, s[12:15], 0 offen offset:0
buffer_load_dwordx4 v[12:15], v245, s[12:15], 0 offen offset:1280
buffer_load_dwordx4 v[16:19], v245, s[12:15], 0 offen offset:2560
buffer_load_dwordx4 v[20:23], v244, s[12:15], 0 offen offset:0
buffer_load_dwordx4 v[24:27], v244, s[12:15], 0 offen offset:1280
buffer_load_dwordx4 v[28:31], v244, s[12:15], 0 offen offset:2560
buffer_load_dwordx4 v[32:35], v244, s[12:15], 0 offen offset:3840
buffer_load_dwordx4 v248, s[32:35], s92 offen lds
buffer_load_dwordx4 v[174:177], v244, s[16:19], 0 offen offset:0
buffer_load_dwordx4 v[178:181], v244, s[16:19], 0 offen offset:1280
buffer_load_dwordx4 v[182:185], v244, s[16:19], 0 offen offset:2560
buffer_load_dwordx4 v[186:189], v244, s[16:19], 0 offen offset:3840
s_mov_b64 exec, -1
s_mov_b32 s20, s54
s_and_b32 s21, s55, 0xffff
s_mov_b32 s22, 2211840
s_mov_b32 s23, 0x20000
s_mov_b32 s8, s40
s_and_b32 s9, s41, 0xffff
s_mov_b32 s10, 2621440
s_mov_b32 s11, 0x20000
s_mov_b32 s28, s62
s_and_b32 s29, s63, 0xffff
s_mov_b32 s30, 2621440
s_mov_b32 s31, 0x20000
s_mov_b32 s52, s64
s_and_b32 s53, s65, 0xffff
s_mov_b32 s54, 256
s_mov_b32 s55, 0x20000
s_mov_b32 s42, 0
s_mov_b32 s36, s58
s_and_b32 s37, s59, 0xffff
s_mov_b32 s38, 2211840
s_mov_b32 s39, 0x20000
s_lshr_b32 s6, s2, 2
s_lshl_b32 s6, s6, 5
s_lshl_b32 s7, s5, 3
s_add_u32 s6, s6, s7
s_mul_i32 s6, s6, 1280
s_and_b32 s7, s2, 3
s_mul_i32 s7, s7, 320
s_add_u32 s6, s6, s7
s_cmp_lt_u32 s2, 216
s_cselect_b32 s6, s6, 2147418112
v_add_u32 v2, 0, v1
v_mul_u32_u24 v3, 205, v2
v_lshrrev_b32 v3, 12, v3
v_mul_u32_u24 v4, 20, v3
v_sub_u32 v2, v2, v4
v_mul_u32_u24 v3, 1280, v3
v_lshl_add_u32 v2, v2, 4, v3
v_add_u32 v2, s6, v2
v_subrev_u32 v204, 0, v2
v_add_u32 v2, 64, v1
v_mul_u32_u24 v3, 205, v2
v_lshrrev_b32 v3, 12, v3
v_mul_u32_u24 v4, 20, v3
v_sub_u32 v2, v2, v4
v_mul_u32_u24 v3, 1280, v3
v_lshl_add_u32 v2, v2, 4, v3
v_add_u32 v2, s6, v2
v_subrev_u32 v205, 1024, v2
v_add_u32 v2, 128, v1
v_mul_u32_u24 v3, 205, v2
v_lshrrev_b32 v3, 12, v3
v_mul_u32_u24 v4, 20, v3
v_sub_u32 v2, v2, v4
v_mul_u32_u24 v3, 1280, v3
v_lshl_add_u32 v2, v2, 4, v3
v_add_u32 v2, s6, v2
v_subrev_u32 v206, 2048, v2
s_mul_i32 s6, s5, 2560
s_add_u32 s74, s6, 142592
v_lshrrev_b32 v2, 4, v1
v_bfe_u32 v3, v1, 2, 2
v_lshrrev_b32 v4, 1, v2
v_lshlrev_b32 v4, 4, v4
v_and_b32 v2, 1, v2
v_lshl_add_u32 v2, v2, 2, v3
v_add_u32 v2, v2, v4
v_mul_u32_u24 v2, 320, v2
v_and_b32 v3, 3, v1
v_mul_u32_u24 v3, 40, v3
v_add_u32 v2, v2, v3
v_add_u32 v5, 142592, v2
s_and_b32 s6, s2, 3
s_lshl_b32 s6, s6, 1
s_mul_i32 s6, s6, 54
s_lshr_b32 s7, s2, 2
s_add_u32 s6, s6, s7
s_mul_i32 s84, s6, 5120
s_add_u32 s84, s84, 7340032
v_mov_b32 v207, 2147418112
s_cmp_lt_u32 s2, 216
s_cselect_b64 vcc, -1, 0
v_cndmask_b32 v207, v207, v248, vcc
s_add_u32 s6, s5, 0
s_cmp_ge_u32 s6, 5
s_cselect_b32 s7, 5, 0
s_cselect_b32 s43, 276480, 0
s_cselect_b32 s75, 160, 0
s_sub_u32 s6, s6, s7
s_lshl_b32 s7, s6, 3
s_add_u32 s75, s75, s7
v_add_u32 v200, s75, v5
s_lshl_b32 s6, s6, 10
s_add_u32 s6, s6, s43
s_add_u32 s75, s6, s84
s_add_u32 s6, s5, 4
s_cmp_ge_u32 s6, 5
s_cselect_b32 s7, 5, 0
s_cselect_b32 s43, 276480, 0
s_cselect_b32 s76, 160, 0
s_sub_u32 s6, s6, s7
s_lshl_b32 s7, s6, 3
s_add_u32 s76, s76, s7
v_add_u32 v201, s76, v5
s_lshl_b32 s6, s6, 10
s_add_u32 s6, s6, s43
s_add_u32 s76, s6, s84
s_add_u32 s6, s5, 8
s_cmp_ge_u32 s6, 5
s_cselect_b32 s7, 5, 0
s_cselect_b32 s43, 276480, 0
s_cselect_b32 s93, 160, 0
s_sub_u32 s6, s6, s7
s_lshl_b32 s7, s6, 3
s_add_u32 s93, s93, s7
v_add_u32 v246, s93, v5
s_lshl_b32 s6, s6, 10
s_add_u32 s6, s6, s43
s_add_u32 s93, s6, s84
s_cmp_ge_u32 s5, 2
s_cselect_b64 vcc, -1, 0
v_mov_b32 v3, 2147418112
v_cndmask_b32 v173, v207, v3, vcc
s_mov_b32 exec_lo, 0xffffff
s_mov_b32 exec_hi, 0x0
buffer_load_dword v234, v232, s[20:23], 0 offen
s_mov_b64 exec, -1
s_mov_b32 exec_lo, 0x7fff
s_mov_b32 exec_hi, 0x0
buffer_load_dword v234, v233, s[8:11], 0 offen
s_mov_b64 exec, -1
v_lshrrev_b32 v2, 4, v1
v_bfe_u32 v4, v1, 2, 2
v_and_b32 v5, 3, v1
v_lshrrev_b32 v6, 5, v1
v_lshl_add_u32 v6, v6, 3, v4
v_lshlrev_b32 v6, 8, v6
s_lshl_b32 s6, s82, 1
v_xor_b32 v4, s6, v4
v_lshlrev_b32 v4, 2, v4
v_and_b32 v3, 1, v2
v_lshl_or_b32 v4, v3, 1, v4
v_lshrrev_b32 v3, 1, v5
v_or_b32 v4, v4, v3
v_lshl_add_u32 v6, v4, 4, v6
v_and_b32 v5, 1, v5
v_lshl_add_u32 v216, v5, 3, v6
v_xor_b32 v217, 64, v216
v_add_u32 v218, 0x10000, v216
v_add_u32 v219, 0x10000, v217
v_and_b32 v4, 31, v1
v_bfe_u32 v5, v1, 1, 3
v_lshrrev_b32 v6, 5, v1
v_xor_b32 v5, v5, v6
s_lshl_b32 s6, s83, 6
v_add_u32 v4, s6, v4
v_lshlrev_b32 v4, 7, v4
v_lshl_add_u32 v220, v5, 4, v4
v_xor_b32 v221, 32, v220
v_xor_b32 v222, 64, v220
v_xor_b32 v223, 96, v220
v_add_u32 v224, 0x10000, v220
v_add_u32 v225, 0x10000, v221
v_add_u32 v226, 0x10000, v222
v_add_u32 v227, 0x10000, v223
v_and_b32 v2, 15, v1
v_min_u32 v2, 13, v2
v_add_u32 v2, s96, v2
v_min_u32 v2, 53, v2
v_lshlrev_b32 v2, 2, v2
s_lshr_b32 s43, s95, 1
v_add_u32 v2, s43, v2
v_lshlrev_b32 v2, 7, v2
v_add_u32 v228, 12, v2
s_lshl_b32 s6, s77, 1
v_and_b32 v4, 1, v1
v_add_u32 v4, s6, v4
v_and_b32 v5, 3, v4
v_add_u32 v5, 28, v5
s_lshr_b32 s6, s77, 2
s_and_b32 s7, s77, 2
s_lshl_b32 s7, s7, 1
s_add_u32 s6, s6, s7
v_mov_b32 v4, s6
v_lshl_add_u32 v4, v5, 3, v4
v_lshlrev_b32 v4, 7, v4
v_add_u32 v231, 4, v4
v_and_b32 v2, 31, v1
v_and_b32 v3, 7, v2
v_lshrrev_b32 v2, 3, v2
v_lshlrev_b32 v2, 3, v2
v_add_u32 v2, s3, v2
v_lshl_add_u32 v2, v2, 3, v3
v_lshlrev_b32 v229, 7, v2
v_cmp_gt_u32 vcc, 14, v1
v_cndmask_b32 v2, 0, v1, vcc
v_cmp_lt_u32 vcc, 6, v2
v_cndmask_b32 v3, 0, 1, vcc
v_mul_u32_u24 v4, 7, v3
v_sub_u32 v2, v2, v4
s_lshr_b32 s6, s94, 1
s_and_b32 s7, s6, 3
s_lshr_b32 s6, s6, 2
v_lshlrev_b32 v3, 2, v3
v_lshlrev_b32 v2, 2, v2
v_add_u32 v2, s7, v2
v_add_u32 v3, s6, v3
v_lshl_add_u32 v2, v2, 3, v3
v_lshlrev_b32 v2, 7, v2
v_add_u32 v249, 16, v2
v_and_b32 v2, 31, v1
v_lshlrev_b32 v2, 3, v2
v_add_u32 v2, s95, v2
v_lshlrev_b32 v2, 7, v2
v_add_u32 v250, 20, v2
v_mov_b32 v2, 2147418112
s_cmp_lg_u32 s5, 0
s_cselect_b64 vcc, -1, 0
v_cndmask_b32 v231, v231, v2, vcc
v_cndmask_b32 v230, v230, v2, vcc
v_and_b32 v2, 15, v1
v_bfe_u32 v3, v1, 4, 1
v_lshlrev_b32 v3, 2, v3
v_cmp_eq_u32 vcc, v2, v3
v_mov_b32 v2, 0x3f803f80
v_cndmask_b32 v160, 0, v2, vcc
v_mov_b32 v161, v160
v_mov_b32 v162, v160
v_mov_b32 v163, v160
s_add_u32 m0, s81, 0
s_nop 0
buffer_load_dwordx4 v208, s[20:23], s79 offen offset:0 lds
buffer_load_dwordx4 v209, s[20:23], s79 offen offset:1024 lds
buffer_load_dwordx4 v210, s[20:23], s79 offen offset:2048 lds
buffer_load_dwordx4 v211, s[20:23], s79 offen offset:3072 lds
s_add_u32 m0, s81, 16384
s_nop 0
buffer_load_dwordx4 v212, s[8:11], s80 offen offset:0 lds
buffer_load_dwordx4 v213, s[8:11], s80 offen offset:1024 lds
buffer_load_dwordx4 v214, s[8:11], s80 offen offset:2048 lds
buffer_load_dwordx4 v215, s[8:11], s80 offen offset:3072 lds
s_waitcnt vmcnt(10)
ds_read_b128 v[36:39], v247 offset:0
ds_read_b128 v[40:43], v247 offset:16
ds_read_b128 v[44:47], v247 offset:32
ds_read_b128 v[48:51], v247 offset:48
s_cmp_lg_u32 s5, 0
s_cbranch_scc1 L_arr_2
s_and_b32 s6, s2, 7
s_lshl_b32 s6, s6, 5
v_mov_b32 v2, s6
s_mov_b64 exec, 1
buffer_atomic_add v253, v2, s[52:55], 0 offen sc1
s_mov_b64 exec, -1
L_arr_2:
v_lshlrev_b32 v194, 16, v8
v_and_b32 v195, 0xffff0000, v8
v_lshlrev_b32 v196, 16, v12
v_and_b32 v197, 0xffff0000, v12
s_mov_b32 exec_lo, 0xff000000
s_mov_b32 exec_hi, 0xffffff
buffer_load_dword v234, v232, s[20:23], 0 offen
s_mov_b64 exec, -1
s_mov_b32 exec_lo, 0xffff8000
s_mov_b32 exec_hi, 0x7
buffer_load_dword v234, v233, s[8:11], 0 offen
s_mov_b64 exec, -1
v_lshlrev_b32 v198, 16, v16
v_and_b32 v199, 0xffff0000, v16
v_lshlrev_b32 v236, 16, v20
v_and_b32 v237, 0xffff0000, v20
v_lshlrev_b32 v238, 16, v24
v_and_b32 v239, 0xffff0000, v24
v_lshlrev_b32 v240, 16, v28
v_and_b32 v241, 0xffff0000, v28
v_lshlrev_b32 v242, 16, v32
v_and_b32 v243, 0xffff0000, v32
s_waitcnt lgkmcnt(0)
v_lshlrev_b32 v52, 16, v36
v_lshlrev_b32 v53, 16, v38
v_and_b32 v54, 0xffff0000, v36
v_and_b32 v55, 0xffff0000, v38
v_lshlrev_b32 v56, 16, v37
v_lshlrev_b32 v57, 16, v39
v_and_b32 v58, 0xffff0000, v37
v_and_b32 v59, 0xffff0000, v39
v_pk_mul_f32 v[60:61], v[236:237], v[52:53]
v_pk_mul_f32 v[62:63], v[238:239], v[52:53]
v_pk_mul_f32 v[190:191], v[240:241], v[52:53]
v_pk_mul_f32 v[192:193], v[242:243], v[52:53]
v_pk_fma_f32 v[60:61], v[198:199], v[54:55], v[60:61]
v_pk_fma_f32 v[62:63], v[236:237], v[54:55], v[62:63]
v_pk_fma_f32 v[190:191], v[238:239], v[54:55], v[190:191]
v_pk_fma_f32 v[192:193], v[240:241], v[54:55], v[192:193]
v_pk_fma_f32 v[60:61], v[196:197], v[56:57], v[60:61]
v_pk_fma_f32 v[62:63], v[198:199], v[56:57], v[62:63]
v_pk_fma_f32 v[190:191], v[236:237], v[56:57], v[190:191]
v_pk_fma_f32 v[192:193], v[238:239], v[56:57], v[192:193]
v_pk_fma_f32 v[60:61], v[194:195], v[58:59], v[60:61]
v_pk_fma_f32 v[62:63], v[196:197], v[58:59], v[62:63]
v_pk_fma_f32 v[190:191], v[198:199], v[58:59], v[190:191]
v_pk_fma_f32 v[192:193], v[236:237], v[58:59], v[192:193]
v_lshlrev_b32 v194, 16, v174
v_and_b32 v195, 0xffff0000, v174
v_lshlrev_b32 v196, 16, v178
v_and_b32 v197, 0xffff0000, v178
v_lshlrev_b32 v198, 16, v182
v_and_b32 v199, 0xffff0000, v182
v_lshlrev_b32 v236, 16, v186
v_and_b32 v237, 0xffff0000, v186
v_pk_mul_f32 v[60:61], v[60:61], v[194:195]
v_pk_mul_f32 v[62:63], v[62:63], v[196:197]
v_pk_mul_f32 v[190:191], v[190:191], v[198:199]
v_pk_mul_f32 v[192:193], v[192:193], v[236:237]
s_mov_b32 exec_hi, 0xff
v_cvt_pk_bf16_f32 v238, v192, v190
v_cvt_pk_bf16_f32 v239, v62, v60
ds_write_b64 v202, v[238:239] offset:0
v_cvt_pk_bf16_f32 v240, v193, v191
v_cvt_pk_bf16_f32 v241, v63, v61
ds_write_b64 v202, v[240:241] offset:144
s_mov_b64 exec, -1
v_lshlrev_b32 v194, 16, v9
v_and_b32 v195, 0xffff0000, v9
v_lshlrev_b32 v196, 16, v13
v_and_b32 v197, 0xffff0000, v13
v_lshlrev_b32 v198, 16, v17
v_and_b32 v199, 0xffff0000, v17
v_lshlrev_b32 v236, 16, v21
v_and_b32 v237, 0xffff0000, v21
v_lshlrev_b32 v238, 16, v25
v_and_b32 v239, 0xffff0000, v25
v_lshlrev_b32 v240, 16, v29
v_and_b32 v241, 0xffff0000, v29
v_lshlrev_b32 v242, 16, v33
v_and_b32 v243, 0xffff0000, v33
v_lshlrev_b32 v52, 16, v40
v_lshlrev_b32 v53, 16, v42
v_and_b32 v54, 0xffff0000, v40
v_and_b32 v55, 0xffff0000, v42
v_lshlrev_b32 v56, 16, v41
v_lshlrev_b32 v57, 16, v43
v_and_b32 v58, 0xffff0000, v41
v_and_b32 v59, 0xffff0000, v43
v_pk_mul_f32 v[60:61], v[236:237], v[52:53]
v_pk_mul_f32 v[62:63], v[238:239], v[52:53]
v_pk_mul_f32 v[190:191], v[240:241], v[52:53]
v_pk_mul_f32 v[192:193], v[242:243], v[52:53]
v_pk_fma_f32 v[60:61], v[198:199], v[54:55], v[60:61]
v_pk_fma_f32 v[62:63], v[236:237], v[54:55], v[62:63]
v_pk_fma_f32 v[190:191], v[238:239], v[54:55], v[190:191]
v_pk_fma_f32 v[192:193], v[240:241], v[54:55], v[192:193]
v_pk_fma_f32 v[60:61], v[196:197], v[56:57], v[60:61]
v_pk_fma_f32 v[62:63], v[198:199], v[56:57], v[62:63]
v_pk_fma_f32 v[190:191], v[236:237], v[56:57], v[190:191]
v_pk_fma_f32 v[192:193], v[238:239], v[56:57], v[192:193]
v_pk_fma_f32 v[60:61], v[194:195], v[58:59], v[60:61]
v_pk_fma_f32 v[62:63], v[196:197], v[58:59], v[62:63]
v_pk_fma_f32 v[190:191], v[198:199], v[58:59], v[190:191]
v_pk_fma_f32 v[192:193], v[236:237], v[58:59], v[192:193]
v_lshlrev_b32 v194, 16, v175
v_and_b32 v195, 0xffff0000, v175
v_lshlrev_b32 v196, 16, v179
v_and_b32 v197, 0xffff0000, v179
v_lshlrev_b32 v198, 16, v183
v_and_b32 v199, 0xffff0000, v183
v_lshlrev_b32 v236, 16, v187
v_and_b32 v237, 0xffff0000, v187
v_pk_mul_f32 v[60:61], v[60:61], v[194:195]
v_pk_mul_f32 v[62:63], v[62:63], v[196:197]
v_pk_mul_f32 v[190:191], v[190:191], v[198:199]
v_pk_mul_f32 v[192:193], v[192:193], v[236:237]
s_mov_b32 exec_hi, 0xff
v_cvt_pk_bf16_f32 v238, v192, v190
v_cvt_pk_bf16_f32 v239, v62, v60
ds_write_b64 v202, v[238:239] offset:288
v_cvt_pk_bf16_f32 v240, v193, v191
v_cvt_pk_bf16_f32 v241, v63, v61
ds_write_b64 v202, v[240:241] offset:432
s_mov_b64 exec, -1
v_lshlrev_b32 v194, 16, v10
v_and_b32 v195, 0xffff0000, v10
v_lshlrev_b32 v196, 16, v14
v_and_b32 v197, 0xffff0000, v14
v_lshlrev_b32 v198, 16, v18
v_and_b32 v199, 0xffff0000, v18
v_lshlrev_b32 v236, 16, v22
v_and_b32 v237, 0xffff0000, v22
v_lshlrev_b32 v238, 16, v26
v_and_b32 v239, 0xffff0000, v26
v_lshlrev_b32 v240, 16, v30
v_and_b32 v241, 0xffff0000, v30
v_lshlrev_b32 v242, 16, v34
v_and_b32 v243, 0xffff0000, v34
v_lshlrev_b32 v52, 16, v44
v_lshlrev_b32 v53, 16, v46
v_and_b32 v54, 0xffff0000, v44
v_and_b32 v55, 0xffff0000, v46
v_lshlrev_b32 v56, 16, v45
v_lshlrev_b32 v57, 16, v47
v_and_b32 v58, 0xffff0000, v45
v_and_b32 v59, 0xffff0000, v47
v_pk_mul_f32 v[60:61], v[236:237], v[52:53]
v_pk_mul_f32 v[62:63], v[238:239], v[52:53]
v_pk_mul_f32 v[190:191], v[240:241], v[52:53]
v_pk_mul_f32 v[192:193], v[242:243], v[52:53]
v_pk_fma_f32 v[60:61], v[198:199], v[54:55], v[60:61]
v_pk_fma_f32 v[62:63], v[236:237], v[54:55], v[62:63]
v_pk_fma_f32 v[190:191], v[238:239], v[54:55], v[190:191]
v_pk_fma_f32 v[192:193], v[240:241], v[54:55], v[192:193]
v_pk_fma_f32 v[60:61], v[196:197], v[56:57], v[60:61]
v_pk_fma_f32 v[62:63], v[198:199], v[56:57], v[62:63]
v_pk_fma_f32 v[190:191], v[236:237], v[56:57], v[190:191]
v_pk_fma_f32 v[192:193], v[238:239], v[56:57], v[192:193]
v_pk_fma_f32 v[60:61], v[194:195], v[58:59], v[60:61]
v_pk_fma_f32 v[62:63], v[196:197], v[58:59], v[62:63]
v_pk_fma_f32 v[190:191], v[198:199], v[58:59], v[190:191]
v_pk_fma_f32 v[192:193], v[236:237], v[58:59], v[192:193]
v_lshlrev_b32 v194, 16, v176
v_and_b32 v195, 0xffff0000, v176
v_lshlrev_b32 v196, 16, v180
v_and_b32 v197, 0xffff0000, v180
v_lshlrev_b32 v198, 16, v184
v_and_b32 v199, 0xffff0000, v184
v_lshlrev_b32 v236, 16, v188
v_and_b32 v237, 0xffff0000, v188
v_pk_mul_f32 v[60:61], v[60:61], v[194:195]
v_pk_mul_f32 v[62:63], v[62:63], v[196:197]
v_pk_mul_f32 v[190:191], v[190:191], v[198:199]
v_pk_mul_f32 v[192:193], v[192:193], v[236:237]
s_mov_b32 exec_hi, 0xff
v_cvt_pk_bf16_f32 v238, v192, v190
v_cvt_pk_bf16_f32 v239, v62, v60
ds_write_b64 v202, v[238:239] offset:576
v_cvt_pk_bf16_f32 v240, v193, v191
v_cvt_pk_bf16_f32 v241, v63, v61
ds_write_b64 v202, v[240:241] offset:720
s_mov_b64 exec, -1
v_lshlrev_b32 v194, 16, v11
v_and_b32 v195, 0xffff0000, v11
v_lshlrev_b32 v196, 16, v15
v_and_b32 v197, 0xffff0000, v15
v_lshlrev_b32 v198, 16, v19
v_and_b32 v199, 0xffff0000, v19
v_lshlrev_b32 v236, 16, v23
v_and_b32 v237, 0xffff0000, v23
v_lshlrev_b32 v238, 16, v27
v_and_b32 v239, 0xffff0000, v27
v_lshlrev_b32 v240, 16, v31
v_and_b32 v241, 0xffff0000, v31
v_lshlrev_b32 v242, 16, v35
v_and_b32 v243, 0xffff0000, v35
v_lshlrev_b32 v52, 16, v48
v_lshlrev_b32 v53, 16, v50
v_and_b32 v54, 0xffff0000, v48
v_and_b32 v55, 0xffff0000, v50
v_lshlrev_b32 v56, 16, v49
v_lshlrev_b32 v57, 16, v51
v_and_b32 v58, 0xffff0000, v49
v_and_b32 v59, 0xffff0000, v51
v_pk_mul_f32 v[60:61], v[236:237], v[52:53]
v_pk_mul_f32 v[62:63], v[238:239], v[52:53]
v_pk_mul_f32 v[190:191], v[240:241], v[52:53]
v_pk_mul_f32 v[192:193], v[242:243], v[52:53]
v_pk_fma_f32 v[60:61], v[198:199], v[54:55], v[60:61]
v_pk_fma_f32 v[62:63], v[236:237], v[54:55], v[62:63]
v_pk_fma_f32 v[190:191], v[238:239], v[54:55], v[190:191]
v_pk_fma_f32 v[192:193], v[240:241], v[54:55], v[192:193]
v_pk_fma_f32 v[60:61], v[196:197], v[56:57], v[60:61]
v_pk_fma_f32 v[62:63], v[198:199], v[56:57], v[62:63]
v_pk_fma_f32 v[190:191], v[236:237], v[56:57], v[190:191]
v_pk_fma_f32 v[192:193], v[238:239], v[56:57], v[192:193]
v_pk_fma_f32 v[60:61], v[194:195], v[58:59], v[60:61]
v_pk_fma_f32 v[62:63], v[196:197], v[58:59], v[62:63]
v_pk_fma_f32 v[190:191], v[198:199], v[58:59], v[190:191]
v_pk_fma_f32 v[192:193], v[236:237], v[58:59], v[192:193]
v_lshlrev_b32 v194, 16, v177
v_and_b32 v195, 0xffff0000, v177
v_lshlrev_b32 v196, 16, v181
v_and_b32 v197, 0xffff0000, v181
v_lshlrev_b32 v198, 16, v185
v_and_b32 v199, 0xffff0000, v185
v_lshlrev_b32 v236, 16, v189
v_and_b32 v237, 0xffff0000, v189
v_pk_mul_f32 v[60:61], v[60:61], v[194:195]
v_pk_mul_f32 v[62:63], v[62:63], v[196:197]
v_pk_mul_f32 v[190:191], v[190:191], v[198:199]
v_pk_mul_f32 v[192:193], v[192:193], v[236:237]
s_mov_b32 exec_hi, 0xff
v_cvt_pk_bf16_f32 v238, v192, v190
v_cvt_pk_bf16_f32 v239, v62, v60
ds_write_b64 v202, v[238:239] offset:864
v_cvt_pk_bf16_f32 v240, v193, v191
v_cvt_pk_bf16_f32 v241, v63, v61
ds_write_b64 v202, v[240:241] offset:1008
s_mov_b64 exec, -1
s_add_u32 m0, s81, 32768
s_add_u32 s79, s79, 221184
buffer_load_dwordx4 v208, s[20:23], s79 offen offset:0 lds
buffer_load_dwordx4 v209, s[20:23], s79 offen offset:1024 lds
buffer_load_dwordx4 v210, s[20:23], s79 offen offset:2048 lds
buffer_load_dwordx4 v211, s[20:23], s79 offen offset:3072 lds
s_add_u32 m0, s81, 49152
s_add_u32 s80, s80, 128
buffer_load_dwordx4 v212, s[8:11], s80 offen offset:0 lds
buffer_load_dwordx4 v213, s[8:11], s80 offen offset:1024 lds
buffer_load_dwordx4 v214, s[8:11], s80 offen offset:2048 lds
buffer_load_dwordx4 v215, s[8:11], s80 offen offset:3072 lds
s_waitcnt vmcnt(10)
s_waitcnt lgkmcnt(0)
s_barrier
ds_read_b64_tr_b16 v[128:129], v216 offset:0
ds_read_b64_tr_b16 v[130:131], v216 offset:1024
ds_read_b128 v[136:139], v220 offset:16384
ds_read_b128 v[140:143], v220 offset:20480
ds_read_b64_tr_b16 v[132:133], v217 offset:0
ds_read_b64_tr_b16 v[134:135], v217 offset:1024
ds_read_b128 v[8:11], v203 offset:0
ds_read_b128 v[12:15], v203 offset:1152
ds_read_b128 v[16:19], v203 offset:2304
s_waitcnt lgkmcnt(6)
v_mfma_f32_32x32x16_bf16 v[64:79], v[128:131], v[136:139], 0
ds_read_b64_tr_b16 v[144:145], v216 offset:4096
ds_read_b64_tr_b16 v[146:147], v216 offset:5120
s_add_u32 m0, s81, 65536
s_add_u32 s79, s79, 221184
buffer_load_dwordx4 v208, s[20:23], s79 offen offset:0 lds
s_waitcnt lgkmcnt(7)
v_mfma_f32_32x32x16_bf16 v[80:95], v[128:131], v[140:143], 0
ds_read_b128 v[152:155], v221 offset:16384
ds_read_b128 v[156:159], v221 offset:20480
buffer_load_dwordx4 v209, s[20:23], s79 offen offset:1024 lds
v_mfma_f32_16x16x32_bf16 v[164:167], v[160:163], v[128:131], 0
s_waitcnt lgkmcnt(7)
v_mfma_f32_32x32x16_bf16 v[96:111], v[132:135], v[136:139], 0
ds_read_b64_tr_b16 v[148:149], v217 offset:4096
ds_read_b64_tr_b16 v[150:151], v217 offset:5120
buffer_load_dwordx4 v210, s[20:23], s79 offen offset:2048 lds
v_mfma_f32_32x32x16_bf16 v[112:127], v[132:135], v[140:143], 0
buffer_load_dwordx4 v211, s[20:23], s79 offen offset:3072 lds
v_mfma_f32_16x16x32_bf16 v[168:171], v[160:163], v[132:135], 0
s_waitcnt lgkmcnt(3)
v_mfma_f32_32x32x16_bf16 v[64:79], v[144:147], v[152:155], v[64:79]
ds_read_b64_tr_b16 v[128:129], v216 offset:8192
ds_read_b64_tr_b16 v[130:131], v216 offset:9216
s_add_u32 m0, s81, 81920
s_add_u32 s80, s80, 128
buffer_load_dwordx4 v212, s[8:11], s80 offen offset:0 lds
s_waitcnt lgkmcnt(4)
v_mfma_f32_32x32x16_bf16 v[80:95], v[144:147], v[156:159], v[80:95]
ds_read_b128 v[136:139], v222 offset:16384
ds_read_b128 v[140:143], v222 offset:20480
buffer_load_dwordx4 v213, s[8:11], s80 offen offset:1024 lds
v_mfma_f32_16x16x32_bf16 v[164:167], v[160:163], v[144:147], v[164:167]
s_waitcnt lgkmcnt(4)
v_mfma_f32_32x32x16_bf16 v[96:111], v[148:151], v[152:155], v[96:111]
ds_read_b64_tr_b16 v[132:133], v217 offset:8192
ds_read_b64_tr_b16 v[134:135], v217 offset:9216
buffer_load_dwordx4 v214, s[8:11], s80 offen offset:2048 lds
v_mfma_f32_32x32x16_bf16 v[112:127], v[148:151], v[156:159], v[112:127]
buffer_load_dwordx4 v215, s[8:11], s80 offen offset:3072 lds
v_mfma_f32_16x16x32_bf16 v[168:171], v[160:163], v[148:151], v[168:171]
s_waitcnt lgkmcnt(3)
v_mfma_f32_32x32x16_bf16 v[64:79], v[128:131], v[136:139], v[64:79]
ds_read_b64_tr_b16 v[144:145], v216 offset:12288
ds_read_b64_tr_b16 v[146:147], v216 offset:13312
s_waitcnt vmcnt(8)
s_cmp_eq_u32 s82, 0
s_cbranch_scc0 L_nb_3
s_barrier
L_nb_3:
s_waitcnt lgkmcnt(4)
v_mfma_f32_32x32x16_bf16 v[80:95], v[128:131], v[140:143], v[80:95]
ds_read_b128 v[152:155], v223 offset:16384
ds_read_b128 v[156:159], v223 offset:20480
s_cmp_eq_u32 s82, 1
s_cbranch_scc0 L_nb_4
s_barrier
L_nb_4:
v_mfma_f32_16x16x32_bf16 v[164:167], v[160:163], v[128:131], v[164:167]
s_waitcnt lgkmcnt(4)
v_mfma_f32_32x32x16_bf16 v[96:111], v[132:135], v[136:139], v[96:111]
ds_read_b64_tr_b16 v[148:149], v217 offset:12288
ds_read_b64_tr_b16 v[150:151], v217 offset:13312
s_add_u32 m0, s81, 98304
s_add_u32 s79, s79, 221184
buffer_load_dwordx4 v208, s[20:23], s79 offen offset:0 lds
v_mfma_f32_32x32x16_bf16 v[112:127], v[132:135], v[140:143], v[112:127]
buffer_store_dwordx4 v[8:11], v172, s[24:27], s70 offen sc1
v_mfma_f32_16x16x32_bf16 v[168:171], v[160:163], v[132:135], v[168:171]
s_waitcnt lgkmcnt(3)
v_mfma_f32_32x32x16_bf16 v[64:79], v[144:147], v[152:155], v[64:79]
ds_read_b64_tr_b16 v[128:129], v216 offset:32768
ds_read_b64_tr_b16 v[130:131], v216 offset:33792
buffer_load_dwordx4 v209, s[20:23], s79 offen offset:1024 lds
s_waitcnt lgkmcnt(4)
v_mfma_f32_32x32x16_bf16 v[80:95], v[144:147], v[156:159], v[80:95]
ds_read_b128 v[136:139], v220 offset:49152
ds_read_b128 v[140:143], v220 offset:53248
v_mfma_f32_16x16x32_bf16 v[164:167], v[160:163], v[144:147], v[164:167]
s_waitcnt lgkmcnt(4)
v_mfma_f32_32x32x16_bf16 v[96:111], v[148:151], v[152:155], v[96:111]
ds_read_b64_tr_b16 v[132:133], v217 offset:32768
ds_read_b64_tr_b16 v[134:135], v217 offset:33792
buffer_load_dwordx4 v210, s[20:23], s79 offen offset:2048 lds
v_mfma_f32_32x32x16_bf16 v[112:127], v[148:151], v[156:159], v[112:127]
v_mfma_f32_16x16x32_bf16 v[168:171], v[160:163], v[148:151], v[168:171]
s_waitcnt lgkmcnt(3)
v_mfma_f32_32x32x16_bf16 v[64:79], v[128:131], v[136:139], v[64:79]
ds_read_b64_tr_b16 v[144:145], v216 offset:36864
ds_read_b64_tr_b16 v[146:147], v216 offset:37888
buffer_load_dwordx4 v211, s[20:23], s79 offen offset:3072 lds
s_waitcnt lgkmcnt(4)
v_mfma_f32_32x32x16_bf16 v[80:95], v[128:131], v[140:143], v[80:95]
ds_read_b128 v[152:155], v221 offset:49152
ds_read_b128 v[156:159], v221 offset:53248
v_mfma_f32_16x16x32_bf16 v[164:167], v[160:163], v[128:131], v[164:167]
s_waitcnt lgkmcnt(4)
v_mfma_f32_32x32x16_bf16 v[96:111], v[132:135], v[136:139], v[96:111]
ds_read_b64_tr_b16 v[148:149], v217 offset:36864
ds_read_b64_tr_b16 v[150:151], v217 offset:37888
s_add_u32 m0, s81, 114688
s_add_u32 s80, s80, 128
buffer_load_dwordx4 v212, s[8:11], s80 offen offset:0 lds
v_mfma_f32_32x32x16_bf16 v[112:127], v[132:135], v[140:143], v[112:127]
buffer_store_dwordx4 v[12:15], v172, s[24:27], s71 offen sc1
v_mfma_f32_16x16x32_bf16 v[168:171], v[160:163], v[132:135], v[168:171]
s_waitcnt lgkmcnt(3)
v_mfma_f32_32x32x16_bf16 v[64:79], v[144:147], v[152:155], v[64:79]
ds_read_b64_tr_b16 v[128:129], v216 offset:40960
ds_read_b64_tr_b16 v[130:131], v216 offset:41984
buffer_load_dwordx4 v213, s[8:11], s80 offen offset:1024 lds
s_waitcnt lgkmcnt(4)
v_mfma_f32_32x32x16_bf16 v[80:95], v[144:147], v[156:159], v[80:95]
ds_read_b128 v[136:139], v222 offset:49152
ds_read_b128 v[140:143], v222 offset:53248
v_mfma_f32_16x16x32_bf16 v[164:167], v[160:163], v[144:147], v[164:167]
s_waitcnt lgkmcnt(4)
v_mfma_f32_32x32x16_bf16 v[96:111], v[148:151], v[152:155], v[96:111]
ds_read_b64_tr_b16 v[132:133], v217 offset:40960
ds_read_b64_tr_b16 v[134:135], v217 offset:41984
buffer_load_dwordx4 v214, s[8:11], s80 offen offset:2048 lds
v_mfma_f32_32x32x16_bf16 v[112:127], v[148:151], v[156:159], v[112:127]
v_mfma_f32_16x16x32_bf16 v[168:171], v[160:163], v[148:151], v[168:171]
s_waitcnt lgkmcnt(3)
v_mfma_f32_32x32x16_bf16 v[64:79], v[128:131], v[136:139], v[64:79]
ds_read_b64_tr_b16 v[144:145], v216 offset:45056
ds_read_b64_tr_b16 v[146:147], v216 offset:46080
s_waitcnt vmcnt(9)
s_cmp_eq_u32 s82, 0
s_cbranch_scc0 L_nb_5
s_barrier
L_nb_5:
buffer_load_dwordx4 v215, s[8:11], s80 offen offset:3072 lds
s_waitcnt lgkmcnt(4)
v_mfma_f32_32x32x16_bf16 v[80:95], v[128:131], v[140:143], v[80:95]
ds_read_b128 v[152:155], v223 offset:49152
ds_read_b128 v[156:159], v223 offset:53248
s_cmp_eq_u32 s82, 1
s_cbranch_scc0 L_nb_6
s_barrier
L_nb_6:
v_mfma_f32_16x16x32_bf16 v[164:167], v[160:163], v[128:131], v[164:167]
s_waitcnt lgkmcnt(4)
v_mfma_f32_32x32x16_bf16 v[96:111], v[132:135], v[136:139], v[96:111]
ds_read_b64_tr_b16 v[148:149], v217 offset:45056
ds_read_b64_tr_b16 v[150:151], v217 offset:46080
s_add_u32 m0, s81, 0
s_add_u32 s79, s79, 221184
buffer_load_dwordx4 v208, s[20:23], s79 offen offset:0 lds
v_mfma_f32_32x32x16_bf16 v[112:127], v[132:135], v[140:143], v[112:127]
s_mov_b32 exec_hi, 0
buffer_store_dwordx4 v[16:19], v172, s[24:27], s72 offen sc1
s_mov_b64 exec, -1
v_mfma_f32_16x16x32_bf16 v[168:171], v[160:163], v[132:135], v[168:171]
s_waitcnt lgkmcnt(3)
v_mfma_f32_32x32x16_bf16 v[64:79], v[144:147], v[152:155], v[64:79]
ds_read_b64_tr_b16 v[128:129], v218 offset:0
ds_read_b64_tr_b16 v[130:131], v218 offset:1024
buffer_load_dwordx4 v209, s[20:23], s79 offen offset:1024 lds
s_waitcnt lgkmcnt(4)
v_mfma_f32_32x32x16_bf16 v[80:95], v[144:147], v[156:159], v[80:95]
ds_read_b128 v[136:139], v224 offset:16384
ds_read_b128 v[140:143], v224 offset:20480
v_mfma_f32_16x16x32_bf16 v[164:167], v[160:163], v[144:147], v[164:167]
s_waitcnt lgkmcnt(4)
v_mfma_f32_32x32x16_bf16 v[96:111], v[148:151], v[152:155], v[96:111]
ds_read_b64_tr_b16 v[132:133], v219 offset:0
ds_read_b64_tr_b16 v[134:135], v219 offset:1024
buffer_load_dwordx4 v210, s[20:23], s79 offen offset:2048 lds
v_mfma_f32_32x32x16_bf16 v[112:127], v[148:151], v[156:159], v[112:127]
v_mfma_f32_16x16x32_bf16 v[168:171], v[160:163], v[148:151], v[168:171]
s_waitcnt lgkmcnt(3)
v_mfma_f32_32x32x16_bf16 v[64:79], v[128:131], v[136:139], v[64:79]
ds_read_b64_tr_b16 v[144:145], v218 offset:4096
ds_read_b64_tr_b16 v[146:147], v218 offset:5120
buffer_load_dwordx4 v211, s[20:23], s79 offen offset:3072 lds
s_waitcnt lgkmcnt(4)
v_mfma_f32_32x32x16_bf16 v[80:95], v[128:131], v[140:143], v[80:95]
ds_read_b128 v[152:155], v225 offset:16384
ds_read_b128 v[156:159], v225 offset:20480
v_mfma_f32_16x16x32_bf16 v[164:167], v[160:163], v[128:131], v[164:167]
s_waitcnt lgkmcnt(4)
v_mfma_f32_32x32x16_bf16 v[96:111], v[132:135], v[136:139], v[96:111]
ds_read_b64_tr_b16 v[148:149], v219 offset:4096
ds_read_b64_tr_b16 v[150:151], v219 offset:5120
s_add_u32 m0, s81, 16384
s_add_u32 s80, s80, 128
buffer_load_dwordx4 v212, s[8:11], s80 offen offset:0 lds
v_mfma_f32_32x32x16_bf16 v[112:127], v[132:135], v[140:143], v[112:127]
v_mfma_f32_16x16x32_bf16 v[168:171], v[160:163], v[132:135], v[168:171]
s_waitcnt lgkmcnt(3)
v_mfma_f32_32x32x16_bf16 v[64:79], v[144:147], v[152:155], v[64:79]
ds_read_b64_tr_b16 v[128:129], v218 offset:8192
ds_read_b64_tr_b16 v[130:131], v218 offset:9216
buffer_load_dwordx4 v213, s[8:11], s80 offen offset:1024 lds
s_waitcnt lgkmcnt(4)
v_mfma_f32_32x32x16_bf16 v[80:95], v[144:147], v[156:159], v[80:95]
ds_read_b128 v[136:139], v226 offset:16384
ds_read_b128 v[140:143], v226 offset:20480
v_mfma_f32_16x16x32_bf16 v[164:167], v[160:163], v[144:147], v[164:167]
s_waitcnt lgkmcnt(4)
v_mfma_f32_32x32x16_bf16 v[96:111], v[148:151], v[152:155], v[96:111]
ds_read_b64_tr_b16 v[132:133], v219 offset:8192
ds_read_b64_tr_b16 v[134:135], v219 offset:9216
buffer_load_dwordx4 v214, s[8:11], s80 offen offset:2048 lds
v_mfma_f32_32x32x16_bf16 v[112:127], v[148:151], v[156:159], v[112:127]
buffer_load_dword v254, v230, s[52:55], 0 offen sc1
v_mfma_f32_16x16x32_bf16 v[168:171], v[160:163], v[148:151], v[168:171]
s_waitcnt lgkmcnt(3)
v_mfma_f32_32x32x16_bf16 v[64:79], v[128:131], v[136:139], v[64:79]
ds_read_b64_tr_b16 v[144:145], v218 offset:12288
ds_read_b64_tr_b16 v[146:147], v218 offset:13312
s_waitcnt vmcnt(9)
s_cmp_eq_u32 s82, 0
s_cbranch_scc0 L_nb_7
s_barrier
L_nb_7:
buffer_load_dwordx4 v215, s[8:11], s80 offen offset:3072 lds
s_waitcnt lgkmcnt(4)
v_mfma_f32_32x32x16_bf16 v[80:95], v[128:131], v[140:143], v[80:95]
ds_read_b128 v[152:155], v227 offset:16384
ds_read_b128 v[156:159], v227 offset:20480
s_cmp_eq_u32 s82, 1
s_cbranch_scc0 L_nb_8
s_barrier
L_nb_8:
v_mfma_f32_16x16x32_bf16 v[164:167], v[160:163], v[128:131], v[164:167]
s_waitcnt lgkmcnt(4)
v_mfma_f32_32x32x16_bf16 v[96:111], v[132:135], v[136:139], v[96:111]
ds_read_b64_tr_b16 v[148:149], v219 offset:12288
ds_read_b64_tr_b16 v[150:151], v219 offset:13312
s_add_u32 m0, s81, 32768
s_add_u32 s79, s79, 221184
buffer_load_dwordx4 v208, s[20:23], s79 offen offset:0 lds
v_mfma_f32_32x32x16_bf16 v[112:127], v[132:135], v[140:143], v[112:127]
v_mfma_f32_16x16x32_bf16 v[168:171], v[160:163], v[132:135], v[168:171]
s_waitcnt lgkmcnt(3)
v_mfma_f32_32x32x16_bf16 v[64:79], v[144:147], v[152:155], v[64:79]
ds_read_b64_tr_b16 v[128:129], v218 offset:32768
ds_read_b64_tr_b16 v[130:131], v218 offset:33792
buffer_load_dwordx4 v209, s[20:23], s79 offen offset:1024 lds
s_waitcnt lgkmcnt(4)
v_mfma_f32_32x32x16_bf16 v[80:95], v[144:147], v[156:159], v[80:95]
ds_read_b128 v[136:139], v224 offset:49152
ds_read_b128 v[140:143], v224 offset:53248
v_mfma_f32_16x16x32_bf16 v[164:167], v[160:163], v[144:147], v[164:167]
s_waitcnt lgkmcnt(4)
v_mfma_f32_32x32x16_bf16 v[96:111], v[148:151], v[152:155], v[96:111]
ds_read_b64_tr_b16 v[132:133], v219 offset:32768
ds_read_b64_tr_b16 v[134:135], v219 offset:33792
buffer_load_dwordx4 v210, s[20:23], s79 offen offset:2048 lds
v_mfma_f32_32x32x16_bf16 v[112:127], v[148:151], v[156:159], v[112:127]
v_mfma_f32_16x16x32_bf16 v[168:171], v[160:163], v[148:151], v[168:171]
s_waitcnt lgkmcnt(3)
v_mfma_f32_32x32x16_bf16 v[64:79], v[128:131], v[136:139], v[64:79]
ds_read_b64_tr_b16 v[144:145], v218 offset:36864
ds_read_b64_tr_b16 v[146:147], v218 offset:37888
buffer_load_dwordx4 v211, s[20:23], s79 offen offset:3072 lds
s_waitcnt lgkmcnt(4)
v_mfma_f32_32x32x16_bf16 v[80:95], v[128:131], v[140:143], v[80:95]
ds_read_b128 v[152:155], v225 offset:49152
ds_read_b128 v[156:159], v225 offset:53248
s_mov_b32 m0, s74
s_nop 0
buffer_load_dwordx4 v204, s[36:39], 0 offen lds
s_mov_b32 m0, s74
s_nop 0
buffer_load_dwordx4 v205, s[36:39], 0 offen offset:1024 lds
s_mov_b32 m0, s74
s_mov_b32 exec_hi, 0
buffer_load_dwordx4 v206, s[36:39], 0 offen offset:2048 lds
s_mov_b64 exec, -1
v_mfma_f32_16x16x32_bf16 v[164:167], v[160:163], v[128:131], v[164:167]
s_waitcnt lgkmcnt(4)
v_mfma_f32_32x32x16_bf16 v[96:111], v[132:135], v[136:139], v[96:111]
ds_read_b64_tr_b16 v[148:149], v219 offset:36864
ds_read_b64_tr_b16 v[150:151], v219 offset:37888
s_add_u32 m0, s81, 49152
s_add_u32 s80, s80, 128
buffer_load_dwordx4 v212, s[8:11], s80 offen offset:0 lds
v_mfma_f32_32x32x16_bf16 v[112:127], v[132:135], v[140:143], v[112:127]
v_mfma_f32_16x16x32_bf16 v[168:171], v[160:163], v[132:135], v[168:171]
s_waitcnt lgkmcnt(3)
v_mfma_f32_32x32x16_bf16 v[64:79], v[144:147], v[152:155], v[64:79]
ds_read_b64_tr_b16 v[128:129], v218 offset:40960
ds_read_b64_tr_b16 v[130:131], v218 offset:41984
buffer_load_dwordx4 v213, s[8:11], s80 offen offset:1024 lds
s_waitcnt lgkmcnt(4)
v_mfma_f32_32x32x16_bf16 v[80:95], v[144:147], v[156:159], v[80:95]
ds_read_b128 v[136:139], v226 offset:49152
ds_read_b128 v[140:143], v226 offset:53248
v_mfma_f32_16x16x32_bf16 v[164:167], v[160:163], v[144:147], v[164:167]
s_waitcnt lgkmcnt(4)
v_mfma_f32_32x32x16_bf16 v[96:111], v[148:151], v[152:155], v[96:111]
ds_read_b64_tr_b16 v[132:133], v219 offset:40960
ds_read_b64_tr_b16 v[134:135], v219 offset:41984
buffer_load_dwordx4 v214, s[8:11], s80 offen offset:2048 lds
v_mfma_f32_32x32x16_bf16 v[112:127], v[148:151], v[156:159], v[112:127]
v_mfma_f32_16x16x32_bf16 v[168:171], v[160:163], v[148:151], v[168:171]
s_waitcnt lgkmcnt(3)
v_mfma_f32_32x32x16_bf16 v[64:79], v[128:131], v[136:139], v[64:79]
ds_read_b64_tr_b16 v[144:145], v218 offset:45056
ds_read_b64_tr_b16 v[146:147], v218 offset:46080
s_waitcnt vmcnt(10)
s_cmp_eq_u32 s82, 0
s_cbranch_scc0 L_nb_9
s_barrier
L_nb_9:
buffer_load_dwordx4 v215, s[8:11], s80 offen offset:3072 lds
s_waitcnt lgkmcnt(4)
v_mfma_f32_32x32x16_bf16 v[80:95], v[128:131], v[140:143], v[80:95]
ds_read_b128 v[152:155], v227 offset:49152
ds_read_b128 v[156:159], v227 offset:53248
s_cmp_eq_u32 s82, 1
s_cbranch_scc0 L_nb_10
s_barrier
L_nb_10:
s_mov_b32 exec_lo, 0x0
s_mov_b32 exec_hi, 0xff000000
buffer_load_dword v234, v232, s[20:23], 0 offen
s_mov_b64 exec, -1
s_mov_b32 s6, 1769472
s_mov_b32 exec_lo, 0xffff
s_mov_b32 exec_hi, 0x0
buffer_load_dword v234, v232, s[20:23], s6 offen
s_mov_b64 exec, -1
s_mov_b32 exec_lo, 0x0
s_mov_b32 exec_hi, 0x3fff8
buffer_load_dword v234, v233, s[8:11], 0 offen
s_mov_b64 exec, -1
v_mfma_f32_16x16x32_bf16 v[164:167], v[160:163], v[128:131], v[164:167]
s_waitcnt lgkmcnt(4)
v_mfma_f32_32x32x16_bf16 v[96:111], v[132:135], v[136:139], v[96:111]
ds_read_b64_tr_b16 v[148:149], v219 offset:45056
ds_read_b64_tr_b16 v[150:151], v219 offset:46080
s_add_u32 m0, s81, 65536
s_add_u32 s79, s79, 221184
buffer_load_dwordx4 v208, s[20:23], s79 offen offset:0 lds
v_mfma_f32_32x32x16_bf16 v[112:127], v[132:135], v[140:143], v[112:127]
v_mfma_f32_16x16x32_bf16 v[168:171], v[160:163], v[132:135], v[168:171]
s_waitcnt lgkmcnt(3)
v_mfma_f32_32x32x16_bf16 v[64:79], v[144:147], v[152:155], v[64:79]
ds_read_b64_tr_b16 v[128:129], v216 offset:0
ds_read_b64_tr_b16 v[130:131], v216 offset:1024
buffer_load_dwordx4 v209, s[20:23], s79 offen offset:1024 lds
s_waitcnt lgkmcnt(4)
v_mfma_f32_32x32x16_bf16 v[80:95], v[144:147], v[156:159], v[80:95]
ds_read_b128 v[136:139], v220 offset:16384
ds_read_b128 v[140:143], v220 offset:20480
v_mfma_f32_16x16x32_bf16 v[164:167], v[160:163], v[144:147], v[164:167]
s_waitcnt lgkmcnt(4)
v_mfma_f32_32x32x16_bf16 v[96:111], v[148:151], v[152:155], v[96:111]
ds_read_b64_tr_b16 v[132:133], v217 offset:0
ds_read_b64_tr_b16 v[134:135], v217 offset:1024
buffer_load_dwordx4 v210, s[20:23], s79 offen offset:2048 lds
v_mfma_f32_32x32x16_bf16 v[112:127], v[148:151], v[156:159], v[112:127]
v_mfma_f32_16x16x32_bf16 v[168:171], v[160:163], v[148:151], v[168:171]
s_waitcnt lgkmcnt(3)
v_mfma_f32_32x32x16_bf16 v[64:79], v[128:131], v[136:139], v[64:79]
ds_read_b64_tr_b16 v[144:145], v216 offset:4096
ds_read_b64_tr_b16 v[146:147], v216 offset:5120
buffer_load_dwordx4 v211, s[20:23], s79 offen offset:3072 lds
s_waitcnt lgkmcnt(4)
v_mfma_f32_32x32x16_bf16 v[80:95], v[128:131], v[140:143], v[80:95]
ds_read_b128 v[152:155], v221 offset:16384
ds_read_b128 v[156:159], v221 offset:20480
v_mfma_f32_16x16x32_bf16 v[164:167], v[160:163], v[128:131], v[164:167]
s_waitcnt lgkmcnt(4)
v_mfma_f32_32x32x16_bf16 v[96:111], v[132:135], v[136:139], v[96:111]
ds_read_b64_tr_b16 v[148:149], v217 offset:4096
ds_read_b64_tr_b16 v[150:151], v217 offset:5120
s_add_u32 m0, s81, 81920
s_add_u32 s80, s80, 128
buffer_load_dwordx4 v212, s[8:11], s80 offen offset:0 lds
v_mfma_f32_32x32x16_bf16 v[112:127], v[132:135], v[140:143], v[112:127]
v_mfma_f32_16x16x32_bf16 v[168:171], v[160:163], v[132:135], v[168:171]
s_waitcnt lgkmcnt(3)
v_mfma_f32_32x32x16_bf16 v[64:79], v[144:147], v[152:155], v[64:79]
ds_read_b64_tr_b16 v[128:129], v216 offset:8192
ds_read_b64_tr_b16 v[130:131], v216 offset:9216
buffer_load_dwordx4 v213, s[8:11], s80 offen offset:1024 lds
s_waitcnt lgkmcnt(4)
v_mfma_f32_32x32x16_bf16 v[80:95], v[144:147], v[156:159], v[80:95]
ds_read_b128 v[136:139], v222 offset:16384
ds_read_b128 v[140:143], v222 offset:20480
v_mfma_f32_16x16x32_bf16 v[164:167], v[160:163], v[144:147], v[164:167]
s_waitcnt lgkmcnt(4)
v_mfma_f32_32x32x16_bf16 v[96:111], v[148:151], v[152:155], v[96:111]
ds_read_b64_tr_b16 v[132:133], v217 offset:8192
ds_read_b64_tr_b16 v[134:135], v217 offset:9216
buffer_load_dwordx4 v214, s[8:11], s80 offen offset:2048 lds
v_mfma_f32_32x32x16_bf16 v[112:127], v[148:151], v[156:159], v[112:127]
v_mfma_f32_16x16x32_bf16 v[168:171], v[160:163], v[148:151], v[168:171]
s_waitcnt lgkmcnt(3)
v_mfma_f32_32x32x16_bf16 v[64:79], v[128:131], v[136:139], v[64:79]
ds_read_b64_tr_b16 v[144:145], v216 offset:12288
ds_read_b64_tr_b16 v[146:147], v216 offset:13312
s_waitcnt vmcnt(10)
s_cmp_lg_u32 s5, 0
s_cbranch_scc1 L_back_12
v_cmp_gt_u32 vcc, 32, v254
s_cbranch_vccnz L_slow_11
L_back_12:
s_cmp_eq_u32 s82, 0
s_cbranch_scc0 L_nb_13
s_barrier
L_nb_13:
buffer_load_dwordx4 v215, s[8:11], s80 offen offset:3072 lds
s_waitcnt lgkmcnt(4)
v_mfma_f32_32x32x16_bf16 v[80:95], v[128:131], v[140:143], v[80:95]
ds_read_b128 v[152:155], v223 offset:16384
ds_read_b128 v[156:159], v223 offset:20480
s_cmp_eq_u32 s82, 1
s_cbranch_scc0 L_nb_14
s_barrier
L_nb_14:
s_cmp_lg_u32 s5, 0
s_cbranch_scc1 L_fl_15
s_mov_b64 exec, 1
buffer_store_dword v253, v252, s[24:27], 0 offen offset:0 sc1
s_mov_b64 exec, -1
L_fl_15:
v_mfma_f32_16x16x32_bf16 v[164:167], v[160:163], v[128:131], v[164:167]
s_waitcnt lgkmcnt(4)
v_mfma_f32_32x32x16_bf16 v[96:111], v[132:135], v[136:139], v[96:111]
ds_read_b64_tr_b16 v[148:149], v217 offset:12288
ds_read_b64_tr_b16 v[150:151], v217 offset:13312
s_add_u32 m0, s81, 98304
s_add_u32 s79, s79, 221184
buffer_load_dwordx4 v208, s[20:23], s79 offen offset:0 lds
v_mfma_f32_32x32x16_bf16 v[112:127], v[132:135], v[140:143], v[112:127]
v_mfma_f32_16x16x32_bf16 v[168:171], v[160:163], v[132:135], v[168:171]
s_waitcnt lgkmcnt(3)
v_mfma_f32_32x32x16_bf16 v[64:79], v[144:147], v[152:155], v[64:79]
ds_read_b64_tr_b16 v[128:129], v216 offset:32768
ds_read_b64_tr_b16 v[130:131], v216 offset:33792
buffer_load_dwordx4 v209, s[20:23], s79 offen offset:1024 lds
ds_read_b64_tr_b16 v[174:175], v200
ds_read_b64_tr_b16 v[176:177], v200 offset:2560
s_waitcnt lgkmcnt(6)
v_mfma_f32_32x32x16_bf16 v[80:95], v[144:147], v[156:159], v[80:95]
ds_read_b128 v[136:139], v220 offset:49152
ds_read_b128 v[140:143], v220 offset:53248
ds_read_b64_tr_b16 v[178:179], v201
ds_read_b64_tr_b16 v[180:181], v201 offset:2560
v_mfma_f32_16x16x32_bf16 v[164:167], v[160:163], v[144:147], v[164:167]
s_waitcnt lgkmcnt(8)
v_mfma_f32_32x32x16_bf16 v[96:111], v[148:151], v[152:155], v[96:111]
ds_read_b64_tr_b16 v[132:133], v217 offset:32768
ds_read_b64_tr_b16 v[134:135], v217 offset:33792
buffer_load_dwordx4 v210, s[20:23], s79 offen offset:2048 lds
ds_read_b64_tr_b16 v[182:183], v246
ds_read_b64_tr_b16 v[184:185], v246 offset:2560
v_mfma_f32_32x32x16_bf16 v[112:127], v[148:151], v[156:159], v[112:127]
v_mfma_f32_16x16x32_bf16 v[168:171], v[160:163], v[148:151], v[168:171]
s_waitcnt lgkmcnt(7)
v_mfma_f32_32x32x16_bf16 v[64:79], v[128:131], v[136:139], v[64:79]
ds_read_b64_tr_b16 v[144:145], v216 offset:36864
ds_read_b64_tr_b16 v[146:147], v216 offset:37888
buffer_load_dwordx4 v211, s[20:23], s79 offen offset:3072 lds
s_waitcnt lgkmcnt(8)
v_mfma_f32_32x32x16_bf16 v[80:95], v[128:131], v[140:143], v[80:95]
ds_read_b128 v[152:155], v221 offset:49152
ds_read_b128 v[156:159], v221 offset:53248
v_mfma_f32_16x16x32_bf16 v[164:167], v[160:163], v[128:131], v[164:167]
s_waitcnt lgkmcnt(6)
v_mfma_f32_32x32x16_bf16 v[96:111], v[132:135], v[136:139], v[96:111]
ds_read_b64_tr_b16 v[148:149], v217 offset:36864
ds_read_b64_tr_b16 v[150:151], v217 offset:37888
s_add_u32 m0, s81, 114688
s_add_u32 s80, s80, 128
buffer_load_dwordx4 v212, s[8:11], s80 offen offset:0 lds
v_mfma_f32_32x32x16_bf16 v[112:127], v[132:135], v[140:143], v[112:127]
v_mfma_f32_16x16x32_bf16 v[168:171], v[160:163], v[132:135], v[168:171]
s_waitcnt lgkmcnt(3)
v_mfma_f32_32x32x16_bf16 v[64:79], v[144:147], v[152:155], v[64:79]
ds_read_b64_tr_b16 v[128:129], v216 offset:40960
ds_read_b64_tr_b16 v[130:131], v216 offset:41984
buffer_load_dwordx4 v213, s[8:11], s80 offen offset:1024 lds
s_waitcnt lgkmcnt(4)
v_mfma_f32_32x32x16_bf16 v[80:95], v[144:147], v[156:159], v[80:95]
ds_read_b128 v[136:139], v222 offset:49152
ds_read_b128 v[140:143], v222 offset:53248
v_mfma_f32_16x16x32_bf16 v[164:167], v[160:163], v[144:147], v[164:167]
s_waitcnt lgkmcnt(4)
v_mfma_f32_32x32x16_bf16 v[96:111], v[148:151], v[152:155], v[96:111]
ds_read_b64_tr_b16 v[132:133], v217 offset:40960
ds_read_b64_tr_b16 v[134:135], v217 offset:41984
buffer_load_dwordx4 v214, s[8:11], s80 offen offset:2048 lds
v_mfma_f32_32x32x16_bf16 v[112:127], v[148:151], v[156:159], v[112:127]
buffer_load_dword v254, v231, s[24:27], 0 offen sc1
v_mfma_f32_16x16x32_bf16 v[168:171], v[160:163], v[148:151], v[168:171]
s_waitcnt lgkmcnt(3)
v_mfma_f32_32x32x16_bf16 v[64:79], v[128:131], v[136:139], v[64:79]
ds_read_b64_tr_b16 v[144:145], v216 offset:45056
ds_read_b64_tr_b16 v[146:147], v216 offset:46080
s_waitcnt vmcnt(8)
s_cmp_eq_u32 s82, 0
s_cbranch_scc0 L_nb_16
s_barrier
L_nb_16:
buffer_load_dwordx4 v215, s[8:11], s80 offen offset:3072 lds
s_waitcnt lgkmcnt(4)
v_mfma_f32_32x32x16_bf16 v[80:95], v[128:131], v[140:143], v[80:95]
ds_read_b128 v[152:155], v223 offset:49152
ds_read_b128 v[156:159], v223 offset:53248
s_cmp_eq_u32 s82, 1
s_cbranch_scc0 L_nb_17
s_barrier
L_nb_17:
buffer_store_dwordx4 v[174:177], v207, s[24:27], s75 offen sc1
v_mfma_f32_16x16x32_bf16 v[164:167], v[160:163], v[128:131], v[164:167]
s_waitcnt lgkmcnt(4)
v_mfma_f32_32x32x16_bf16 v[96:111], v[132:135], v[136:139], v[96:111]
ds_read_b64_tr_b16 v[148:149], v217 offset:45056
ds_read_b64_tr_b16 v[150:151], v217 offset:46080
s_add_u32 m0, s81, 0
s_add_u32 s79, s79, 221184
buffer_load_dwordx4 v208, s[20:23], s79 offen offset:0 lds
buffer_store_dwordx4 v[178:181], v207, s[24:27], s76 offen sc1
v_mfma_f32_32x32x16_bf16 v[112:127], v[132:135], v[140:143], v[112:127]
v_mfma_f32_16x16x32_bf16 v[168:171], v[160:163], v[132:135], v[168:171]
s_waitcnt lgkmcnt(3)
v_mfma_f32_32x32x16_bf16 v[64:79], v[144:147], v[152:155], v[64:79]
ds_read_b64_tr_b16 v[128:129], v218 offset:0
ds_read_b64_tr_b16 v[130:131], v218 offset:1024
buffer_load_dwordx4 v209, s[20:23], s79 offen offset:1024 lds
s_waitcnt lgkmcnt(4)
v_mfma_f32_32x32x16_bf16 v[80:95], v[144:147], v[156:159], v[80:95]
ds_read_b128 v[136:139], v224 offset:16384
ds_read_b128 v[140:143], v224 offset:20480
v_mfma_f32_16x16x32_bf16 v[164:167], v[160:163], v[144:147], v[164:167]
s_waitcnt lgkmcnt(4)
v_mfma_f32_32x32x16_bf16 v[96:111], v[148:151], v[152:155], v[96:111]
ds_read_b64_tr_b16 v[132:133], v219 offset:0
ds_read_b64_tr_b16 v[134:135], v219 offset:1024
buffer_load_dwordx4 v210, s[20:23], s79 offen offset:2048 lds
v_mfma_f32_32x32x16_bf16 v[112:127], v[148:151], v[156:159], v[112:127]
v_mfma_f32_16x16x32_bf16 v[168:171], v[160:163], v[148:151], v[168:171]
s_waitcnt lgkmcnt(3)
v_mfma_f32_32x32x16_bf16 v[64:79], v[128:131], v[136:139], v[64:79]
ds_read_b64_tr_b16 v[144:145], v218 offset:4096
ds_read_b64_tr_b16 v[146:147], v218 offset:5120
buffer_load_dwordx4 v211, s[20:23], s79 offen offset:3072 lds
s_waitcnt lgkmcnt(4)
v_mfma_f32_32x32x16_bf16 v[80:95], v[128:131], v[140:143], v[80:95]
ds_read_b128 v[152:155], v225 offset:16384
ds_read_b128 v[156:159], v225 offset:20480
v_mfma_f32_16x16x32_bf16 v[164:167], v[160:163], v[128:131], v[164:167]
s_waitcnt lgkmcnt(4)
v_mfma_f32_32x32x16_bf16 v[96:111], v[132:135], v[136:139], v[96:111]
ds_read_b64_tr_b16 v[148:149], v219 offset:4096
ds_read_b64_tr_b16 v[150:151], v219 offset:5120
s_add_u32 m0, s81, 16384
s_add_u32 s80, s80, 128
buffer_load_dwordx4 v212, s[8:11], s80 offen offset:0 lds
v_mfma_f32_32x32x16_bf16 v[112:127], v[132:135], v[140:143], v[112:127]
v_mfma_f32_16x16x32_bf16 v[168:171], v[160:163], v[132:135], v[168:171]
s_waitcnt lgkmcnt(3)
v_mfma_f32_32x32x16_bf16 v[64:79], v[144:147], v[152:155], v[64:79]
ds_read_b64_tr_b16 v[128:129], v218 offset:8192
ds_read_b64_tr_b16 v[130:131], v218 offset:9216
buffer_load_dwordx4 v213, s[8:11], s80 offen offset:1024 lds
s_waitcnt lgkmcnt(4)
v_mfma_f32_32x32x16_bf16 v[80:95], v[144:147], v[156:159], v[80:95]
ds_read_b128 v[136:139], v226 offset:16384
ds_read_b128 v[140:143], v226 offset:20480
v_mfma_f32_16x16x32_bf16 v[164:167], v[160:163], v[144:147], v[164:167]
s_waitcnt lgkmcnt(4)
v_mfma_f32_32x32x16_bf16 v[96:111], v[148:151], v[152:155], v[96:111]
ds_read_b64_tr_b16 v[132:133], v219 offset:8192
ds_read_b64_tr_b16 v[134:135], v219 offset:9216
buffer_load_dwordx4 v214, s[8:11], s80 offen offset:2048 lds
v_mfma_f32_32x32x16_bf16 v[112:127], v[148:151], v[156:159], v[112:127]
v_mfma_f32_16x16x32_bf16 v[168:171], v[160:163], v[148:151], v[168:171]
s_waitcnt lgkmcnt(3)
v_mfma_f32_32x32x16_bf16 v[64:79], v[128:131], v[136:139], v[64:79]
ds_read_b64_tr_b16 v[144:145], v218 offset:12288
ds_read_b64_tr_b16 v[146:147], v218 offset:13312
s_waitcnt vmcnt(9)
s_cmp_eq_u32 s82, 0
s_cbranch_scc0 L_nb_18
s_barrier
L_nb_18:
buffer_load_dwordx4 v215, s[8:11], s80 offen offset:3072 lds
s_waitcnt lgkmcnt(4)
v_mfma_f32_32x32x16_bf16 v[80:95], v[128:131], v[140:143], v[80:95]
ds_read_b128 v[152:155], v227 offset:16384
ds_read_b128 v[156:159], v227 offset:20480
s_cmp_eq_u32 s82, 1
s_cbranch_scc0 L_nb_19
s_barrier
L_nb_19:
buffer_store_dwordx4 v[182:185], v173, s[24:27], s93 offen sc1
v_mfma_f32_16x16x32_bf16 v[164:167], v[160:163], v[128:131], v[164:167]
s_waitcnt lgkmcnt(4)
v_mfma_f32_32x32x16_bf16 v[96:111], v[132:135], v[136:139], v[96:111]
ds_read_b64_tr_b16 v[148:149], v219 offset:12288
ds_read_b64_tr_b16 v[150:151], v219 offset:13312
s_add_u32 m0, s81, 32768
s_add_u32 s79, s79, 221184
buffer_load_dwordx4 v208, s[20:23], s79 offen offset:0 lds
v_mfma_f32_32x32x16_bf16 v[112:127], v[132:135], v[140:143], v[112:127]
v_mfma_f32_16x16x32_bf16 v[168:171], v[160:163], v[132:135], v[168:171]
s_waitcnt lgkmcnt(3)
v_mfma_f32_32x32x16_bf16 v[64:79], v[144:147], v[152:155], v[64:79]
ds_read_b64_tr_b16 v[128:129], v218 offset:32768
ds_read_b64_tr_b16 v[130:131], v218 offset:33792
buffer_load_dwordx4 v209, s[20:23], s79 offen offset:1024 lds
s_waitcnt lgkmcnt(4)
v_mfma_f32_32x32x16_bf16 v[80:95], v[144:147], v[156:159], v[80:95]
ds_read_b128 v[136:139], v224 offset:49152
ds_read_b128 v[140:143], v224 offset:53248
v_mfma_f32_16x16x32_bf16 v[164:167], v[160:163], v[144:147], v[164:167]
s_waitcnt lgkmcnt(4)
v_mfma_f32_32x32x16_bf16 v[96:111], v[148:151], v[152:155], v[96:111]
ds_read_b64_tr_b16 v[132:133], v219 offset:32768
ds_read_b64_tr_b16 v[134:135], v219 offset:33792
buffer_load_dwordx4 v210, s[20:23], s79 offen offset:2048 lds
v_mfma_f32_32x32x16_bf16 v[112:127], v[148:151], v[156:159], v[112:127]
v_mfma_f32_16x16x32_bf16 v[168:171], v[160:163], v[148:151], v[168:171]
s_waitcnt lgkmcnt(3)
v_mfma_f32_32x32x16_bf16 v[64:79], v[128:131], v[136:139], v[64:79]
ds_read_b64_tr_b16 v[144:145], v218 offset:36864
ds_read_b64_tr_b16 v[146:147], v218 offset:37888
buffer_load_dwordx4 v211, s[20:23], s79 offen offset:3072 lds
s_waitcnt lgkmcnt(4)
v_mfma_f32_32x32x16_bf16 v[80:95], v[128:131], v[140:143], v[80:95]
ds_read_b128 v[152:155], v225 offset:49152
ds_read_b128 v[156:159], v225 offset:53248
v_mfma_f32_16x16x32_bf16 v[164:167], v[160:163], v[128:131], v[164:167]
s_waitcnt lgkmcnt(4)
v_mfma_f32_32x32x16_bf16 v[96:111], v[132:135], v[136:139], v[96:111]
ds_read_b64_tr_b16 v[148:149], v219 offset:36864
ds_read_b64_tr_b16 v[150:151], v219 offset:37888
s_add_u32 m0, s81, 49152
s_add_u32 s80, s80, 128
buffer_load_dwordx4 v212, s[8:11], s80 offen offset:0 lds
v_mfma_f32_32x32x16_bf16 v[112:127], v[132:135], v[140:143], v[112:127]
v_mfma_f32_16x16x32_bf16 v[168:171], v[160:163], v[132:135], v[168:171]
s_waitcnt lgkmcnt(3)
v_mfma_f32_32x32x16_bf16 v[64:79], v[144:147], v[152:155], v[64:79]
ds_read_b64_tr_b16 v[128:129], v218 offset:40960
ds_read_b64_tr_b16 v[130:131], v218 offset:41984
buffer_load_dwordx4 v213, s[8:11], s80 offen offset:1024 lds
s_waitcnt lgkmcnt(4)
v_mfma_f32_32x32x16_bf16 v[80:95], v[144:147], v[156:159], v[80:95]
ds_read_b128 v[136:139], v226 offset:49152
ds_read_b128 v[140:143], v226 offset:53248
v_mfma_f32_16x16x32_bf16 v[164:167], v[160:163], v[144:147], v[164:167]
s_waitcnt lgkmcnt(4)
v_mfma_f32_32x32x16_bf16 v[96:111], v[148:151], v[152:155], v[96:111]
ds_read_b64_tr_b16 v[132:133], v219 offset:40960
ds_read_b64_tr_b16 v[134:135], v219 offset:41984
buffer_load_dwordx4 v214, s[8:11], s80 offen offset:2048 lds
v_mfma_f32_32x32x16_bf16 v[112:127], v[148:151], v[156:159], v[112:127]
v_mfma_f32_16x16x32_bf16 v[168:171], v[160:163], v[148:151], v[168:171]
s_waitcnt lgkmcnt(3)
v_mfma_f32_32x32x16_bf16 v[64:79], v[128:131], v[136:139], v[64:79]
ds_read_b64_tr_b16 v[144:145], v218 offset:45056
ds_read_b64_tr_b16 v[146:147], v218 offset:46080
s_waitcnt vmcnt(8)
s_cmp_lg_u32 s5, 0
s_cbranch_scc1 L_back_21
v_cmp_eq_u32 vcc, 0, v254
s_cbranch_vccnz L_slow_20
L_back_21:
s_cmp_eq_u32 s82, 0
s_cbranch_scc0 L_nb_22
s_barrier
L_nb_22:
buffer_load_dwordx4 v215, s[8:11], s80 offen offset:3072 lds
s_waitcnt lgkmcnt(4)
v_mfma_f32_32x32x16_bf16 v[80:95], v[128:131], v[140:143], v[80:95]
ds_read_b128 v[152:155], v227 offset:49152
ds_read_b128 v[156:159], v227 offset:53248
s_cmp_eq_u32 s82, 1
s_cbranch_scc0 L_nb_23
s_barrier
L_nb_23:
s_mov_b32 s36, s56
s_and_b32 s37, s57, 0xffff
s_mov_b32 s38, 3456
s_mov_b32 s39, 0x20000
v_and_b32 v2, 31, v1
s_lshl_b32 s6, s78, 7
s_lshl_b32 s7, s82, 6
s_add_u32 s6, s6, s7
v_add_u32 v3, s6, v2
v_lshlrev_b32 v3, 1, v3
s_cmp_ge_u32 s6, 1728
s_cselect_b32 s101, 0, 32
s_lshl_b32 s6, s77, 7
s_lshl_b32 s7, s83, 6
s_add_u32 s6, s6, s7
v_add_u32 v4, s6, v2
v_lshlrev_b32 v4, 4, v4
v_mov_b32 v5, 2147418112
v_cmp_gt_u32 vcc, 32, v1
v_cndmask_b32 v3, v5, v3, vcc
v_cndmask_b32 v5, v5, v4, vcc
s_mov_b32 s7, 65536
s_mov_b32 s84, 98304
buffer_load_ushort v28, v3, s[36:39], 0 offen
buffer_load_ushort v32, v3, s[36:39], 0 offen offset:64
buffer_load_dwordx4 v[36:39], v5, s[24:27], s7 offen
buffer_load_dwordx4 v[40:43], v5, s[24:27], s7 offen offset:512
buffer_load_dwordx4 v[44:47], v4, s[24:27], s84 offen
buffer_load_dwordx4 v[48:51], v4, s[24:27], s84 offen offset:512
v_mfma_f32_16x16x32_bf16 v[164:167], v[160:163], v[128:131], v[164:167]
s_waitcnt lgkmcnt(4)
v_mfma_f32_32x32x16_bf16 v[96:111], v[132:135], v[136:139], v[96:111]
ds_read_b64_tr_b16 v[148:149], v219 offset:45056
ds_read_b64_tr_b16 v[150:151], v219 offset:46080
s_mov_b32 s32, s48
s_and_b32 s33, s49, 0xffff
s_mov_b32 s34, 2621440
s_mov_b32 s35, 0x20000
s_lshl_b32 s6, s88, 5
s_mul_i32 s7, s5, 24
s_add_u32 s6, s6, s7
v_add_u32 v2, s6, v1
v_lshlrev_b32 v235, 7, v2
s_mov_b32 exec_lo, 0xffffff
s_mov_b32 exec_hi, 0x0
buffer_load_dword v234, v235, s[32:35], 0 offen
s_mov_b64 exec, -1
v_mfma_f32_32x32x16_bf16 v[112:127], v[132:135], v[140:143], v[112:127]
v_mfma_f32_16x16x32_bf16 v[168:171], v[160:163], v[132:135], v[168:171]
s_waitcnt lgkmcnt(3)
v_mfma_f32_32x32x16_bf16 v[64:79], v[144:147], v[152:155], v[64:79]
ds_read_b64_tr_b16 v[128:129], v216 offset:0
ds_read_b64_tr_b16 v[130:131], v216 offset:1024
s_lshl_b32 s6, s5, 2
v_lshlrev_b32 v202, 2, v1
v_add_u32 v202, s6, v202
v_subrev_u32 v202, 252, v202
v_add_u32 v203, s6, v248
v_add_u32 v203, 4, v203
s_mul_i32 s90, s5, 4416
s_lshr_b32 s6, s4, 3
s_waitcnt lgkmcnt(4)
v_mfma_f32_32x32x16_bf16 v[80:95], v[144:147], v[156:159], v[80:95]
ds_read_b128 v[136:139], v220 offset:16384
ds_read_b128 v[140:143], v220 offset:20480
s_mul_i32 s6, s6, 14
s_and_b32 s7, s4, 7
s_mul_i32 s7, s7, 7
s_add_u32 s6, s6, s7
s_lshr_b32 s6, s6, 2
s_cmp_ge_u32 s5, 2
s_cselect_b32 s43, 13, 14
s_cmp_ge_u32 s6, s43
s_cselect_b32 s7, s43, 0
v_mfma_f32_16x16x32_bf16 v[164:167], v[160:163], v[144:147], v[164:167]
s_waitcnt lgkmcnt(4)
v_mfma_f32_32x32x16_bf16 v[96:111], v[148:151], v[152:155], v[96:111]
ds_read_b64_tr_b16 v[132:133], v217 offset:0
ds_read_b64_tr_b16 v[134:135], v217 offset:1024
s_sub_u32 s93, s6, s7
s_mov_b32 s93, 0
s_mul_i32 s6, s95, 54
s_add_u32 s6, s6, s96
s_mul_i32 s79, s6, 5120
s_add_u32 s79, s79, 7340032
s_mul_i32 s7, s43, 5120
s_add_u32 s80, s79, s7
v_mfma_f32_32x32x16_bf16 v[112:127], v[148:151], v[156:159], v[112:127]
s_mul_i32 s7, s93, 5120
s_add_u32 s97, s79, s7
s_add_u32 s98, s97, 4096
v_and_b32 v2, 15, v1
v_lshrrev_b32 v3, 3, v2
v_lshlrev_b32 v3, 3, v3
v_and_b32 v4, 1, v2
v_lshl_or_b32 v3, v4, 2, v3
v_mfma_f32_16x16x32_bf16 v[168:171], v[160:163], v[148:151], v[168:171]
s_waitcnt lgkmcnt(3)
v_mfma_f32_32x32x16_bf16 v[64:79], v[128:131], v[136:139], v[64:79]
ds_read_b64_tr_b16 v[144:145], v216 offset:4096
ds_read_b64_tr_b16 v[146:147], v216 offset:5120
v_bfe_u32 v4, v2, 1, 2
v_or_b32 v3, v3, v4
v_lshlrev_b32 v3, 4, v3
v_bfe_u32 v4, v1, 4, 1
v_lshl_or_b32 v3, v4, 10, v3
v_lshrrev_b32 v4, 5, v1
v_lshl_or_b32 v3, v4, 8, v3
v_mov_b32 v4, 2147418112
s_waitcnt lgkmcnt(4)
v_mfma_f32_32x32x16_bf16 v[80:95], v[128:131], v[140:143], v[80:95]
ds_read_b128 v[152:155], v221 offset:16384
ds_read_b128 v[156:159], v221 offset:20480
s_cmp_eq_u32 s101, 0
s_cselect_b64 vcc, -1, 0
v_cndmask_b32 v60, v3, v4, vcc
s_lshl_b32 s6, s77, 1
s_add_u32 s6, s6, s83
s_mul_i32 s6, s6, 54
s_lshl_b32 s7, s78, 2
s_add_u32 s6, s6, s7
v_mfma_f32_16x16x32_bf16 v[164:167], v[160:163], v[128:131], v[164:167]
s_waitcnt lgkmcnt(4)
v_mfma_f32_32x32x16_bf16 v[96:111], v[132:135], v[136:139], v[96:111]
ds_read_b64_tr_b16 v[148:149], v217 offset:4096
ds_read_b64_tr_b16 v[150:151], v217 offset:5120
s_lshl_b32 s7, s82, 1
s_add_u32 s6, s6, s7
s_lshl_b32 s6, s6, 12
s_add_u32 s100, s6, 10485760
s_add_u32 s101, s100, 4096
s_lshl_b32 s6, s89, 2
s_add_u32 s6, s6, s5
s_lshl_b32 s7, s6, 1
v_mfma_f32_32x32x16_bf16 v[112:127], v[132:135], v[140:143], v[112:127]
s_lshr_b32 s85, 6436, s7
s_and_b32 s85, s85, 3
s_lshr_b32 s86, 55, s6
s_and_b32 s86, s86, 1
s_lshr_b32 s87, 61311, s7
s_and_b32 s87, s87, 3
v_and_b32 v2, 3, v1
v_mul_u32_u24 v2, 4416, v2
v_mfma_f32_16x16x32_bf16 v[168:171], v[160:163], v[132:135], v[168:171]
s_waitcnt lgkmcnt(3)
v_mfma_f32_32x32x16_bf16 v[64:79], v[144:147], v[152:155], v[64:79]
ds_read_b64_tr_b16 v[128:129], v216 offset:8192
ds_read_b64_tr_b16 v[130:131], v216 offset:9216
v_bfe_u32 v3, v1, 2, 2
v_lshrrev_b32 v18, 4, v1
v_add_u32 v3, v3, v18
v_lshl_add_u32 v16, v3, 4, v2
v_and_b32 v2, 1, v1
v_mul_u32_u24 v2, 6272, v2
v_bfe_u32 v3, v1, 1, 3
s_lshl_b32 s6, s86, 3
s_waitcnt lgkmcnt(4)
v_mfma_f32_32x32x16_bf16 v[80:95], v[144:147], v[156:159], v[80:95]
ds_read_b128 v[136:139], v222 offset:16384
ds_read_b128 v[140:143], v222 offset:20480
s_sub_u32 s6, 15, s6
v_sub_u32 v5, s6, v3
v_mul_u32_u24 v5, 272, v5
v_add_u32 v2, v2, v5
v_lshl_add_u32 v17, v18, 4, v2
s_lshl_b32 s6, s86, 3
v_add_u32 v3, s6, v3
v_lshlrev_b32 v3, 8, v3
v_mfma_f32_16x16x32_bf16 v[164:167], v[160:163], v[144:147], v[164:167]
s_waitcnt lgkmcnt(4)
v_mfma_f32_32x32x16_bf16 v[96:111], v[148:151], v[152:155], v[96:111]
ds_read_b64_tr_b16 v[132:133], v217 offset:8192
ds_read_b64_tr_b16 v[134:135], v217 offset:9216
v_and_b32 v2, 1, v1
v_lshl_or_b32 v2, v18, 1, v2
v_lshl_or_b32 v11, v2, 4, v3
s_mul_i32 s6, s85, 30208
s_add_u32 s6, s6, 65536
v_add_u32 v8, s6, v16
s_add_u32 s6, s6, 17664
v_add_u32 v9, s6, v17
v_mfma_f32_32x32x16_bf16 v[112:127], v[148:151], v[156:159], v[112:127]
v_lshlrev_b32 v10, 5, v18
v_sub_u32 v10, v9, v10
v_add_u32 v10, 0, v10
s_add_u32 s91, s88, s85
v_mfma_f32_16x16x32_bf16 v[168:171], v[160:163], v[148:151], v[168:171]
s_waitcnt lgkmcnt(3)
v_mfma_f32_32x32x16_bf16 v[64:79], v[128:131], v[136:139], v[64:79]
ds_read_b64_tr_b16 v[144:145], v216 offset:12288
ds_read_b64_tr_b16 v[146:147], v216 offset:13312
s_waitcnt vmcnt(7)
s_cmp_eq_u32 s82, 0
s_cbranch_scc0 L_nb_24
s_barrier
L_nb_24:
s_waitcnt lgkmcnt(4)
v_mfma_f32_32x32x16_bf16 v[80:95], v[128:131], v[140:143], v[80:95]
ds_read_b128 v[152:155], v223 offset:16384
ds_read_b128 v[156:159], v223 offset:20480
s_cmp_eq_u32 s82, 1
s_cbranch_scc0 L_nb_25
s_barrier
L_nb_25:
s_cmp_lg_u32 s5, 0
s_cbranch_scc1 L_fl_26
s_mov_b64 exec, 1
buffer_store_dword v253, v252, s[24:27], 0 offen offset:12 sc1
s_mov_b64 exec, -1
L_fl_26:
v_mfma_f32_16x16x32_bf16 v[164:167], v[160:163], v[128:131], v[164:167]
s_waitcnt lgkmcnt(4)
v_mfma_f32_32x32x16_bf16 v[96:111], v[132:135], v[136:139], v[96:111]
ds_read_b64_tr_b16 v[148:149], v217 offset:12288
ds_read_b64_tr_b16 v[150:151], v217 offset:13312
s_add_u32 s6, s88, 0
s_lshl_b32 s6, s6, 12
s_add_u32 s32, s48, s6
s_addc_u32 s33, s49, 0
s_and_b32 s33, s33, 0xffff
s_mov_b32 s34, 4096
s_mov_b32 s35, 0x20000
s_add_u32 m0, s90, 65536
s_nop 0
buffer_load_dword v202, s[32:35], 0 offen lds
s_add_u32 m0, s90, 65792
s_nop 0
v_mfma_f32_32x32x16_bf16 v[112:127], v[132:135], v[140:143], v[112:127]
buffer_load_dwordx4 v203, s[32:35], 0 offen offset:0 lds
v_mfma_f32_16x16x32_bf16 v[168:171], v[160:163], v[132:135], v[168:171]
s_waitcnt lgkmcnt(3)
v_mfma_f32_32x32x16_bf16 v[64:79], v[144:147], v[152:155], v[64:79]
ds_read_b64_tr_b16 v[128:129], v216 offset:32768
ds_read_b64_tr_b16 v[130:131], v216 offset:33792
v_lshlrev_b32 v5, 4, v0
v_add_u32 v5, 87552, v5
v_add_u32 v7, 60416, v5
v_mov_b32 v12, 0
buffer_load_dwordx4 v203, s[32:35], 0 offen offset:1024 lds
s_waitcnt lgkmcnt(4)
v_mfma_f32_32x32x16_bf16 v[80:95], v[144:147], v[156:159], v[80:95]
ds_read_b128 v[136:139], v220 offset:49152
ds_read_b128 v[140:143], v220 offset:53248
v_mov_b32 v13, 0
v_mov_b32 v14, 0
v_mov_b32 v15, 0
buffer_load_dwordx4 v203, s[32:35], 0 offen offset:2048 lds
v_mfma_f32_16x16x32_bf16 v[164:167], v[160:163], v[144:147], v[164:167]
s_waitcnt lgkmcnt(4)
v_mfma_f32_32x32x16_bf16 v[96:111], v[148:151], v[152:155], v[96:111]
ds_read_b64_tr_b16 v[132:133], v217 offset:32768
ds_read_b64_tr_b16 v[134:135], v217 offset:33792
v_cmp_gt_u32 vcc, 119, v0
s_and_saveexec_b64 s[6:7], vcc
ds_write_b128 v5, v[12:15] offset:0
ds_write_b128 v5, v[12:15] offset:6272
ds_write_b128 v5, v[12:15] offset:30208
ds_write_b128 v5, v[12:15] offset:36480
ds_write_b128 v7, v[12:15] offset:0
ds_write_b128 v7, v[12:15] offset:6272
s_mov_b64 exec, s[6:7]
v_mfma_f32_32x32x16_bf16 v[112:127], v[148:151], v[156:159], v[112:127]
buffer_load_dwordx4 v203, s[32:35], 0 offen offset:3072 lds
v_mfma_f32_16x16x32_bf16 v[168:171], v[160:163], v[148:151], v[168:171]
s_waitcnt lgkmcnt(9)
v_mfma_f32_32x32x16_bf16 v[64:79], v[128:131], v[136:139], v[64:79]
ds_read_b64_tr_b16 v[144:145], v216 offset:36864
ds_read_b64_tr_b16 v[146:147], v216 offset:37888
s_add_u32 s6, s88, 1
s_lshl_b32 s6, s6, 12
s_add_u32 s32, s48, s6
s_addc_u32 s33, s49, 0
s_and_b32 s33, s33, 0xffff
s_mov_b32 s34, 4096
s_mov_b32 s35, 0x20000
s_add_u32 m0, s90, 95744
s_nop 0
buffer_load_dword v202, s[32:35], 0 offen lds
s_add_u32 m0, s90, 96000
s_nop 0
s_waitcnt lgkmcnt(10)
v_mfma_f32_32x32x16_bf16 v[80:95], v[128:131], v[140:143], v[80:95]
ds_read_b128 v[152:155], v221 offset:49152
ds_read_b128 v[156:159], v221 offset:53248
buffer_load_dwordx4 v203, s[32:35], 0 offen offset:0 lds
v_mfma_f32_16x16x32_bf16 v[164:167], v[160:163], v[128:131], v[164:167]
s_waitcnt lgkmcnt(10)
v_mfma_f32_32x32x16_bf16 v[96:111], v[132:135], v[136:139], v[96:111]
ds_read_b64_tr_b16 v[148:149], v217 offset:36864
ds_read_b64_tr_b16 v[150:151], v217 offset:37888
buffer_load_dwordx4 v203, s[32:35], 0 offen offset:1024 lds
v_mfma_f32_32x32x16_bf16 v[112:127], v[132:135], v[140:143], v[112:127]
buffer_load_dwordx4 v203, s[32:35], 0 offen offset:2048 lds
v_mfma_f32_16x16x32_bf16 v[168:171], v[160:163], v[132:135], v[168:171]
s_waitcnt lgkmcnt(3)
v_mfma_f32_32x32x16_bf16 v[64:79], v[144:147], v[152:155], v[64:79]
ds_read_b64_tr_b16 v[128:129], v216 offset:40960
ds_read_b64_tr_b16 v[130:131], v216 offset:41984
buffer_load_dwordx4 v203, s[32:35], 0 offen offset:3072 lds
s_waitcnt lgkmcnt(4)
v_mfma_f32_32x32x16_bf16 v[80:95], v[144:147], v[156:159], v[80:95]
ds_read_b128 v[136:139], v222 offset:49152
ds_read_b128 v[140:143], v222 offset:53248
s_add_u32 s6, s88, 2
s_lshl_b32 s6, s6, 12
s_add_u32 s32, s48, s6
s_addc_u32 s33, s49, 0
s_and_b32 s33, s33, 0xffff
s_mov_b32 s34, 4096
s_mov_b32 s35, 0x20000
s_add_u32 m0, s90, 125952
s_nop 0
buffer_load_dword v202, s[32:35], 0 offen lds
s_add_u32 m0, s90, 126208
s_nop 0
v_mfma_f32_16x16x32_bf16 v[164:167], v[160:163], v[144:147], v[164:167]
s_waitcnt lgkmcnt(4)
v_mfma_f32_32x32x16_bf16 v[96:111], v[148:151], v[152:155], v[96:111]
ds_read_b64_tr_b16 v[132:133], v217 offset:40960
ds_read_b64_tr_b16 v[134:135], v217 offset:41984
buffer_load_dwordx4 v203, s[32:35], 0 offen offset:0 lds
v_mfma_f32_32x32x16_bf16 v[112:127], v[148:151], v[156:159], v[112:127]
buffer_load_dwordx4 v203, s[32:35], 0 offen offset:1024 lds
v_mfma_f32_16x16x32_bf16 v[168:171], v[160:163], v[148:151], v[168:171]
s_waitcnt lgkmcnt(3)
v_mfma_f32_32x32x16_bf16 v[64:79], v[128:131], v[136:139], v[64:79]
ds_read_b64_tr_b16 v[144:145], v216 offset:45056
ds_read_b64_tr_b16 v[146:147], v216 offset:46080
buffer_load_dwordx4 v203, s[32:35], 0 offen offset:2048 lds
s_waitcnt lgkmcnt(4)
v_mfma_f32_32x32x16_bf16 v[80:95], v[128:131], v[140:143], v[80:95]
ds_read_b128 v[152:155], v223 offset:49152
ds_read_b128 v[156:159], v223 offset:53248
buffer_load_dwordx4 v203, s[32:35], 0 offen offset:3072 lds
v_mfma_f32_16x16x32_bf16 v[164:167], v[160:163], v[128:131], v[164:167]
s_waitcnt lgkmcnt(4)
v_mfma_f32_32x32x16_bf16 v[96:111], v[132:135], v[136:139], v[96:111]
ds_read_b64_tr_b16 v[148:149], v217 offset:45056
ds_read_b64_tr_b16 v[150:151], v217 offset:46080
v_mfma_f32_32x32x16_bf16 v[112:127], v[132:135], v[140:143], v[112:127]
v_mfma_f32_16x16x32_bf16 v[168:171], v[160:163], v[132:135], v[168:171]
s_waitcnt lgkmcnt(3)
v_mfma_f32_32x32x16_bf16 v[64:79], v[144:147], v[152:155], v[64:79]
s_waitcnt lgkmcnt(2)
v_mfma_f32_32x32x16_bf16 v[80:95], v[144:147], v[156:159], v[80:95]
v_mfma_f32_16x16x32_bf16 v[164:167], v[160:163], v[144:147], v[164:167]
s_waitcnt lgkmcnt(0)
v_mfma_f32_32x32x16_bf16 v[96:111], v[148:151], v[152:155], v[96:111]
v_mfma_f32_32x32x16_bf16 v[112:127], v[148:151], v[156:159], v[112:127]
v_mfma_f32_16x16x32_bf16 v[168:171], v[160:163], v[148:151], v[168:171]
s_waitcnt vmcnt(16)
s_nop 7
v_lshl_or_b32 v28, v28, 16, v28
v_cvt_pk_bf16_f32 v29, v164, v164
v_lshlrev_b32 v2, 16, v29
v_sub_f32 v2, v164, v2
v_cvt_pk_bf16_f32 v30, v2, v2
v_mov_b32 v31, 0
v_lshl_or_b32 v32, v32, 16, v32
v_cvt_pk_bf16_f32 v33, v168, v168
v_lshlrev_b32 v2, 16, v33
v_sub_f32 v2, v168, v2
v_cvt_pk_bf16_f32 v34, v2, v2
v_mov_b32 v35, 0
s_nop 1
v_mfma_f32_32x32x16_bf16 v[64:79], v[28:31], v[36:39], v[64:79]
v_mfma_f32_32x32x16_bf16 v[80:95], v[28:31], v[40:43], v[80:95]
v_mfma_f32_32x32x16_bf16 v[96:111], v[32:35], v[36:39], v[96:111]
v_mfma_f32_32x32x16_bf16 v[112:127], v[32:35], v[40:43], v[112:127]
v_mul_f32 v52, -2.302208198144325, v45
v_mul_f32 v2, v45, v45
v_mul_f32 v2, v2, v45
v_mul_f32 v53, -0.1029432395800235, v2
v_mov_b32 v54, v46
v_mov_b32 v55, v46
v_mul_f32 v56, -2.302208198144325, v49
v_mul_f32 v2, v49, v49
v_mul_f32 v2, v2, v49
v_mul_f32 v57, -0.1029432395800235, v2
v_mov_b32 v58, v50
v_mov_b32 v59, v50
buffer_load_dword v251, v229, s[24:27], 0 offen sc1
v_pk_mul_f32 v[160:161], v[64:65], v[64:65]
v_pk_mul_f32 v[162:163], v[66:67], v[66:67]
v_pk_mul_f32 v[164:165], v[68:69], v[68:69]
v_pk_mul_f32 v[166:167], v[70:71], v[70:71]
v_pk_fma_f32 v[160:161], v[160:161], v[52:53], v[52:53] op_sel:[0,1,0] op_sel_hi:[1,1,0]
v_pk_fma_f32 v[162:163], v[162:163], v[52:53], v[52:53] op_sel:[0,1,0] op_sel_hi:[1,1,0]
v_pk_fma_f32 v[164:165], v[164:165], v[52:53], v[52:53] op_sel:[0,1,0] op_sel_hi:[1,1,0]
v_pk_fma_f32 v[166:167], v[166:167], v[52:53], v[52:53] op_sel:[0,1,0] op_sel_hi:[1,1,0]
v_pk_mul_f32 v[160:161], v[160:161], v[64:65]
v_pk_mul_f32 v[162:163], v[162:163], v[66:67]
v_pk_mul_f32 v[164:165], v[164:165], v[68:69]
v_pk_mul_f32 v[166:167], v[166:167], v[70:71]
v_exp_f32 v160, v160
v_exp_f32 v161, v161
v_exp_f32 v162, v162
v_exp_f32 v163, v163
v_exp_f32 v164, v164
v_exp_f32 v165, v165
v_exp_f32 v166, v166
v_exp_f32 v167, v167
v_pk_fma_f32 v[160:161], v[160:161], v[54:55], v[54:55]
v_pk_fma_f32 v[162:163], v[162:163], v[54:55], v[54:55]
v_pk_fma_f32 v[164:165], v[164:165], v[54:55], v[54:55]
v_pk_fma_f32 v[166:167], v[166:167], v[54:55], v[54:55]
v_rcp_f32 v160, v160
v_rcp_f32 v161, v161
v_rcp_f32 v162, v162
v_rcp_f32 v163, v163
v_rcp_f32 v164, v164
v_rcp_f32 v165, v165
v_rcp_f32 v166, v166
v_rcp_f32 v167, v167
v_pk_mul_f32 v[160:161], v[160:161], v[64:65]
v_pk_mul_f32 v[162:163], v[162:163], v[66:67]
v_pk_mul_f32 v[164:165], v[164:165], v[68:69]
v_pk_mul_f32 v[166:167], v[166:167], v[70:71]
v_cvt_pk_bf16_f32 v64, v160, v161
v_cvt_pk_bf16_f32 v65, v162, v163
v_cvt_pk_bf16_f32 v66, v164, v165
v_cvt_pk_bf16_f32 v67, v166, v167
buffer_store_dwordx4 v[64:67], v60, s[24:27], s100 offen offset:0 sc1
buffer_load_dword v254, v228, s[24:27], 0 offen sc1
v_pk_mul_f32 v[160:161], v[72:73], v[72:73]
v_pk_mul_f32 v[162:163], v[74:75], v[74:75]
v_pk_mul_f32 v[164:165], v[76:77], v[76:77]
v_pk_mul_f32 v[166:167], v[78:79], v[78:79]
v_pk_fma_f32 v[160:161], v[160:161], v[52:53], v[52:53] op_sel:[0,1,0] op_sel_hi:[1,1,0]
v_pk_fma_f32 v[162:163], v[162:163], v[52:53], v[52:53] op_sel:[0,1,0] op_sel_hi:[1,1,0]
v_pk_fma_f32 v[164:165], v[164:165], v[52:53], v[52:53] op_sel:[0,1,0] op_sel_hi:[1,1,0]
v_pk_fma_f32 v[166:167], v[166:167], v[52:53], v[52:53] op_sel:[0,1,0] op_sel_hi:[1,1,0]
v_pk_mul_f32 v[160:161], v[160:161], v[72:73]
v_pk_mul_f32 v[162:163], v[162:163], v[74:75]
v_pk_mul_f32 v[164:165], v[164:165], v[76:77]
v_pk_mul_f32 v[166:167], v[166:167], v[78:79]
v_exp_f32 v160, v160
v_exp_f32 v161, v161
v_exp_f32 v162, v162
v_exp_f32 v163, v163
v_exp_f32 v164, v164
v_exp_f32 v165, v165
v_exp_f32 v166, v166
v_exp_f32 v167, v167
v_pk_fma_f32 v[160:161], v[160:161], v[54:55], v[54:55]
v_pk_fma_f32 v[162:163], v[162:163], v[54:55], v[54:55]
v_pk_fma_f32 v[164:165], v[164:165], v[54:55], v[54:55]
v_pk_fma_f32 v[166:167], v[166:167], v[54:55], v[54:55]
v_rcp_f32 v160, v160
v_rcp_f32 v161, v161
v_rcp_f32 v162, v162
v_rcp_f32 v163, v163
v_rcp_f32 v164, v164
v_rcp_f32 v165, v165
v_rcp_f32 v166, v166
v_rcp_f32 v167, v167
v_pk_mul_f32 v[160:161], v[160:161], v[72:73]
v_pk_mul_f32 v[162:163], v[162:163], v[74:75]
v_pk_mul_f32 v[164:165], v[164:165], v[76:77]
v_pk_mul_f32 v[166:167], v[166:167], v[78:79]
v_cvt_pk_bf16_f32 v72, v160, v161
v_cvt_pk_bf16_f32 v73, v162, v163
v_cvt_pk_bf16_f32 v74, v164, v165
v_cvt_pk_bf16_f32 v75, v166, v167
buffer_store_dwordx4 v[72:75], v60, s[24:27], s100 offen offset:512 sc1
v_pk_mul_f32 v[160:161], v[80:81], v[80:81]
v_pk_mul_f32 v[162:163], v[82:83], v[82:83]
v_pk_mul_f32 v[164:165], v[84:85], v[84:85]
v_pk_mul_f32 v[166:167], v[86:87], v[86:87]
v_pk_fma_f32 v[160:161], v[160:161], v[56:57], v[56:57] op_sel:[0,1,0] op_sel_hi:[1,1,0]
v_pk_fma_f32 v[162:163], v[162:163], v[56:57], v[56:57] op_sel:[0,1,0] op_sel_hi:[1,1,0]
v_pk_fma_f32 v[164:165], v[164:165], v[56:57], v[56:57] op_sel:[0,1,0] op_sel_hi:[1,1,0]
v_pk_fma_f32 v[166:167], v[166:167], v[56:57], v[56:57] op_sel:[0,1,0] op_sel_hi:[1,1,0]
v_pk_mul_f32 v[160:161], v[160:161], v[80:81]
v_pk_mul_f32 v[162:163], v[162:163], v[82:83]
v_pk_mul_f32 v[164:165], v[164:165], v[84:85]
v_pk_mul_f32 v[166:167], v[166:167], v[86:87]
v_exp_f32 v160, v160
v_exp_f32 v161, v161
v_exp_f32 v162, v162
v_exp_f32 v163, v163
v_exp_f32 v164, v164
v_exp_f32 v165, v165
v_exp_f32 v166, v166
v_exp_f32 v167, v167
v_pk_fma_f32 v[160:161], v[160:161], v[58:59], v[58:59]
v_pk_fma_f32 v[162:163], v[162:163], v[58:59], v[58:59]
v_pk_fma_f32 v[164:165], v[164:165], v[58:59], v[58:59]
v_pk_fma_f32 v[166:167], v[166:167], v[58:59], v[58:59]
v_rcp_f32 v160, v160
v_rcp_f32 v161, v161
v_rcp_f32 v162, v162
v_rcp_f32 v163, v163
v_rcp_f32 v164, v164
v_rcp_f32 v165, v165
v_rcp_f32 v166, v166
v_rcp_f32 v167, v167
v_pk_mul_f32 v[160:161], v[160:161], v[80:81]
v_pk_mul_f32 v[162:163], v[162:163], v[82:83]
v_pk_mul_f32 v[164:165], v[164:165], v[84:85]
v_pk_mul_f32 v[166:167], v[166:167], v[86:87]
v_cvt_pk_bf16_f32 v80, v160, v161
v_cvt_pk_bf16_f32 v81, v162, v163
v_cvt_pk_bf16_f32 v82, v164, v165
v_cvt_pk_bf16_f32 v83, v166, v167
buffer_store_dwordx4 v[80:83], v60, s[24:27], s100 offen offset:2048 sc1
s_waitcnt vmcnt(4)
v_cmp_eq_u32 vcc, 0, v251
s_cbranch_vccnz L_slow_27
L_back_28:
v_lshlrev_b32 v4, 4, v0
s_add_u32 s6, s88, 0
s_lshl_b32 s6, s6, 12
s_add_u32 s6, s6, 1048576
s_add_u32 s36, s66, s6
s_addc_u32 s37, s67, 0
s_and_b32 s37, s37, 0xffff
s_mov_b32 s38, 4096
s_mov_b32 s39, 0x20000
buffer_load_dwordx4 v[32:35], v4, s[36:39], 0 offen
buffer_load_dword v36, v4, s[36:39], 0 offen offset:16
s_add_u32 s6, s88, 1
s_lshl_b32 s6, s6, 12
s_add_u32 s6, s6, 1048576
s_add_u32 s36, s66, s6
s_addc_u32 s37, s67, 0
s_and_b32 s37, s37, 0xffff
s_mov_b32 s38, 4096
s_mov_b32 s39, 0x20000
buffer_load_dwordx4 v[38:41], v4, s[36:39], 0 offen
buffer_load_dword v42, v4, s[36:39], 0 offen offset:16
s_add_u32 s6, s88, 2
s_lshl_b32 s6, s6, 12
s_add_u32 s6, s6, 1048576
s_add_u32 s36, s66, s6
s_addc_u32 s37, s67, 0
s_and_b32 s37, s37, 0xffff
s_mov_b32 s38, 4096
s_mov_b32 s39, 0x20000
buffer_load_dwordx4 v[44:47], v4, s[36:39], 0 offen
buffer_load_dword v48, v4, s[36:39], 0 offen offset:16
v_pk_mul_f32 v[160:161], v[88:89], v[88:89]
v_pk_mul_f32 v[162:163], v[90:91], v[90:91]
v_pk_mul_f32 v[164:165], v[92:93], v[92:93]
v_pk_mul_f32 v[166:167], v[94:95], v[94:95]
v_pk_fma_f32 v[160:161], v[160:161], v[56:57], v[56:57] op_sel:[0,1,0] op_sel_hi:[1,1,0]
v_pk_fma_f32 v[162:163], v[162:163], v[56:57], v[56:57] op_sel:[0,1,0] op_sel_hi:[1,1,0]
v_pk_fma_f32 v[164:165], v[164:165], v[56:57], v[56:57] op_sel:[0,1,0] op_sel_hi:[1,1,0]
v_pk_fma_f32 v[166:167], v[166:167], v[56:57], v[56:57] op_sel:[0,1,0] op_sel_hi:[1,1,0]
v_pk_mul_f32 v[160:161], v[160:161], v[88:89]
v_pk_mul_f32 v[162:163], v[162:163], v[90:91]
v_pk_mul_f32 v[164:165], v[164:165], v[92:93]
v_pk_mul_f32 v[166:167], v[166:167], v[94:95]
v_exp_f32 v160, v160
v_exp_f32 v161, v161
v_exp_f32 v162, v162
v_exp_f32 v163, v163
v_exp_f32 v164, v164
v_exp_f32 v165, v165
v_exp_f32 v166, v166
v_exp_f32 v167, v167
v_pk_fma_f32 v[160:161], v[160:161], v[58:59], v[58:59]
v_pk_fma_f32 v[162:163], v[162:163], v[58:59], v[58:59]
v_pk_fma_f32 v[164:165], v[164:165], v[58:59], v[58:59]
v_pk_fma_f32 v[166:167], v[166:167], v[58:59], v[58:59]
v_rcp_f32 v160, v160
v_rcp_f32 v161, v161
v_rcp_f32 v162, v162
v_rcp_f32 v163, v163
v_rcp_f32 v164, v164
v_rcp_f32 v165, v165
v_rcp_f32 v166, v166
v_rcp_f32 v167, v167
v_pk_mul_f32 v[160:161], v[160:161], v[88:89]
v_pk_mul_f32 v[162:163], v[162:163], v[90:91]
v_pk_mul_f32 v[164:165], v[164:165], v[92:93]
v_pk_mul_f32 v[166:167], v[166:167], v[94:95]
v_cvt_pk_bf16_f32 v88, v160, v161
v_cvt_pk_bf16_f32 v89, v162, v163
v_cvt_pk_bf16_f32 v90, v164, v165
v_cvt_pk_bf16_f32 v91, v166, v167
buffer_store_dwordx4 v[88:91], v60, s[24:27], s100 offen offset:2560 sc1
s_waitcnt vmcnt(9)
v_cmp_eq_u32 vcc, 0, v254
s_cbranch_vccnz L_slow_29
L_back_30:
buffer_load_dwordx4 a[0:3], v248, s[24:27], s97 offen offset:0
buffer_load_dwordx4 a[4:7], v248, s[24:27], s97 offen offset:1024
buffer_load_dwordx4 a[8:11], v248, s[24:27], s97 offen offset:2048
buffer_load_dwordx4 a[12:15], v248, s[24:27], s97 offen offset:3072
buffer_load_dwordx4 a[16:19], v248, s[24:27], s98 offen
s_add_u32 s97, s97, 5120
s_cmp_eq_u32 s97, s80
s_cselect_b32 s97, s79, s97
s_add_u32 s98, s97, 4096
v_pk_mul_f32 v[160:161], v[96:97], v[96:97]
v_pk_mul_f32 v[162:163], v[98:99], v[98:99]
v_pk_mul_f32 v[164:165], v[100:101], v[100:101]
v_pk_mul_f32 v[166:167], v[102:103], v[102:103]
v_pk_fma_f32 v[160:161], v[160:161], v[52:53], v[52:53] op_sel:[0,1,0] op_sel_hi:[1,1,0]
v_pk_fma_f32 v[162:163], v[162:163], v[52:53], v[52:53] op_sel:[0,1,0] op_sel_hi:[1,1,0]
v_pk_fma_f32 v[164:165], v[164:165], v[52:53], v[52:53] op_sel:[0,1,0] op_sel_hi:[1,1,0]
v_pk_fma_f32 v[166:167], v[166:167], v[52:53], v[52:53] op_sel:[0,1,0] op_sel_hi:[1,1,0]
v_pk_mul_f32 v[160:161], v[160:161], v[96:97]
v_pk_mul_f32 v[162:163], v[162:163], v[98:99]
v_pk_mul_f32 v[164:165], v[164:165], v[100:101]
v_pk_mul_f32 v[166:167], v[166:167], v[102:103]
v_exp_f32 v160, v160
v_exp_f32 v161, v161
v_exp_f32 v162, v162
v_exp_f32 v163, v163
v_exp_f32 v164, v164
v_exp_f32 v165, v165
v_exp_f32 v166, v166
v_exp_f32 v167, v167
v_pk_fma_f32 v[160:161], v[160:161], v[54:55], v[54:55]
v_pk_fma_f32 v[162:163], v[162:163], v[54:55], v[54:55]
v_pk_fma_f32 v[164:165], v[164:165], v[54:55], v[54:55]
v_pk_fma_f32 v[166:167], v[166:167], v[54:55], v[54:55]
v_rcp_f32 v160, v160
v_rcp_f32 v161, v161
v_rcp_f32 v162, v162
v_rcp_f32 v163, v163
v_rcp_f32 v164, v164
v_rcp_f32 v165, v165
v_rcp_f32 v166, v166
v_rcp_f32 v167, v167
v_pk_mul_f32 v[160:161], v[160:161], v[96:97]
v_pk_mul_f32 v[162:163], v[162:163], v[98:99]
v_pk_mul_f32 v[164:165], v[164:165], v[100:101]
v_pk_mul_f32 v[166:167], v[166:167], v[102:103]
v_cvt_pk_bf16_f32 v96, v160, v161
v_cvt_pk_bf16_f32 v97, v162, v163
v_cvt_pk_bf16_f32 v98, v164, v165
v_cvt_pk_bf16_f32 v99, v166, v167
buffer_store_dwordx4 v[96:99], v60, s[24:27], s101 offen offset:0 sc1
buffer_load_dwordx4 a[20:23], v248, s[24:27], s97 offen offset:0
buffer_load_dwordx4 a[24:27], v248, s[24:27], s97 offen offset:1024
buffer_load_dwordx4 a[28:31], v248, s[24:27], s97 offen offset:2048
buffer_load_dwordx4 a[32:35], v248, s[24:27], s97 offen offset:3072
buffer_load_dwordx4 a[36:39], v248, s[24:27], s98 offen
s_add_u32 s97, s97, 5120
s_cmp_eq_u32 s97, s80
s_cselect_b32 s97, s79, s97
s_add_u32 s98, s97, 4096
v_pk_mul_f32 v[160:161], v[104:105], v[104:105]
v_pk_mul_f32 v[162:163], v[106:107], v[106:107]
v_pk_mul_f32 v[164:165], v[108:109], v[108:109]
v_pk_mul_f32 v[166:167], v[110:111], v[110:111]
v_pk_fma_f32 v[160:161], v[160:161], v[52:53], v[52:53] op_sel:[0,1,0] op_sel_hi:[1,1,0]
v_pk_fma_f32 v[162:163], v[162:163], v[52:53], v[52:53] op_sel:[0,1,0] op_sel_hi:[1,1,0]
v_pk_fma_f32 v[164:165], v[164:165], v[52:53], v[52:53] op_sel:[0,1,0] op_sel_hi:[1,1,0]
v_pk_fma_f32 v[166:167], v[166:167], v[52:53], v[52:53] op_sel:[0,1,0] op_sel_hi:[1,1,0]
v_pk_mul_f32 v[160:161], v[160:161], v[104:105]
v_pk_mul_f32 v[162:163], v[162:163], v[106:107]
v_pk_mul_f32 v[164:165], v[164:165], v[108:109]
v_pk_mul_f32 v[166:167], v[166:167], v[110:111]
v_exp_f32 v160, v160
v_exp_f32 v161, v161
v_exp_f32 v162, v162
v_exp_f32 v163, v163
v_exp_f32 v164, v164
v_exp_f32 v165, v165
v_exp_f32 v166, v166
v_exp_f32 v167, v167
v_pk_fma_f32 v[160:161], v[160:161], v[54:55], v[54:55]
v_pk_fma_f32 v[162:163], v[162:163], v[54:55], v[54:55]
v_pk_fma_f32 v[164:165], v[164:165], v[54:55], v[54:55]
v_pk_fma_f32 v[166:167], v[166:167], v[54:55], v[54:55]
v_rcp_f32 v160, v160
v_rcp_f32 v161, v161
v_rcp_f32 v162, v162
v_rcp_f32 v163, v163
v_rcp_f32 v164, v164
v_rcp_f32 v165, v165
v_rcp_f32 v166, v166
v_rcp_f32 v167, v167
v_pk_mul_f32 v[160:161], v[160:161], v[104:105]
v_pk_mul_f32 v[162:163], v[162:163], v[106:107]
v_pk_mul_f32 v[164:165], v[164:165], v[108:109]
v_pk_mul_f32 v[166:167], v[166:167], v[110:111]
v_cvt_pk_bf16_f32 v104, v160, v161
v_cvt_pk_bf16_f32 v105, v162, v163
v_cvt_pk_bf16_f32 v106, v164, v165
v_cvt_pk_bf16_f32 v107, v166, v167
buffer_store_dwordx4 v[104:107], v60, s[24:27], s101 offen offset:512 sc1
buffer_load_dwordx4 a[40:43], v248, s[24:27], s97 offen offset:0
buffer_load_dwordx4 a[44:47], v248, s[24:27], s97 offen offset:1024
buffer_load_dwordx4 a[48:51], v248, s[24:27], s97 offen offset:2048
buffer_load_dwordx4 a[52:55], v248, s[24:27], s97 offen offset:3072
buffer_load_dwordx4 a[56:59], v248, s[24:27], s98 offen
s_add_u32 s97, s97, 5120
s_cmp_eq_u32 s97, s80
s_cselect_b32 s97, s79, s97
s_add_u32 s98, s97, 4096
v_pk_mul_f32 v[160:161], v[112:113], v[112:113]
v_pk_mul_f32 v[162:163], v[114:115], v[114:115]
v_pk_mul_f32 v[164:165], v[116:117], v[116:117]
v_pk_mul_f32 v[166:167], v[118:119], v[118:119]
v_pk_fma_f32 v[160:161], v[160:161], v[56:57], v[56:57] op_sel:[0,1,0] op_sel_hi:[1,1,0]
v_pk_fma_f32 v[162:163], v[162:163], v[56:57], v[56:57] op_sel:[0,1,0] op_sel_hi:[1,1,0]
v_pk_fma_f32 v[164:165], v[164:165], v[56:57], v[56:57] op_sel:[0,1,0] op_sel_hi:[1,1,0]
v_pk_fma_f32 v[166:167], v[166:167], v[56:57], v[56:57] op_sel:[0,1,0] op_sel_hi:[1,1,0]
v_pk_mul_f32 v[160:161], v[160:161], v[112:113]
v_pk_mul_f32 v[162:163], v[162:163], v[114:115]
v_pk_mul_f32 v[164:165], v[164:165], v[116:117]
v_pk_mul_f32 v[166:167], v[166:167], v[118:119]
v_exp_f32 v160, v160
v_exp_f32 v161, v161
v_exp_f32 v162, v162
v_exp_f32 v163, v163
v_exp_f32 v164, v164
v_exp_f32 v165, v165
v_exp_f32 v166, v166
v_exp_f32 v167, v167
v_pk_fma_f32 v[160:161], v[160:161], v[58:59], v[58:59]
v_pk_fma_f32 v[162:163], v[162:163], v[58:59], v[58:59]
v_pk_fma_f32 v[164:165], v[164:165], v[58:59], v[58:59]
v_pk_fma_f32 v[166:167], v[166:167], v[58:59], v[58:59]
v_rcp_f32 v160, v160
v_rcp_f32 v161, v161
v_rcp_f32 v162, v162
v_rcp_f32 v163, v163
v_rcp_f32 v164, v164
v_rcp_f32 v165, v165
v_rcp_f32 v166, v166
v_rcp_f32 v167, v167
v_pk_mul_f32 v[160:161], v[160:161], v[112:113]
v_pk_mul_f32 v[162:163], v[162:163], v[114:115]
v_pk_mul_f32 v[164:165], v[164:165], v[116:117]
v_pk_mul_f32 v[166:167], v[166:167], v[118:119]
v_cvt_pk_bf16_f32 v112, v160, v161
v_cvt_pk_bf16_f32 v113, v162, v163
v_cvt_pk_bf16_f32 v114, v164, v165
v_cvt_pk_bf16_f32 v115, v166, v167
buffer_store_dwordx4 v[112:115], v60, s[24:27], s101 offen offset:2048 sc1
buffer_load_dwordx4 a[60:63], v248, s[24:27], s97 offen offset:0
buffer_load_dwordx4 a[64:67], v248, s[24:27], s97 offen offset:1024
buffer_load_dwordx4 a[68:71], v248, s[24:27], s97 offen offset:2048
buffer_load_dwordx4 a[72:75], v248, s[24:27], s97 offen offset:3072
buffer_load_dwordx4 a[76:79], v248, s[24:27], s98 offen
s_add_u32 s97, s97, 5120
s_cmp_eq_u32 s97, s80
s_cselect_b32 s97, s79, s97
s_add_u32 s98, s97, 4096
v_lshrrev_b32 v4, 4, v0
v_mul_u32_u24 v4, 272, v4
v_and_b32 v5, 15, v0
v_lshl_add_u32 v4, v5, 4, v4
v_add_u32 v4, 83200, v4
v_add_u32 v6, 60416, v4
s_waitcnt vmcnt(24)
ds_write_b128 v4, v[32:35] offset:6272
v_alignbit_b32 v12, v33, v32, 16
v_alignbit_b32 v13, v34, v33, 16
v_alignbit_b32 v14, v35, v34, 16
v_alignbit_b32 v15, v36, v35, 16
ds_write_b128 v4, v[12:15] offset:0
ds_write_b128 v4, v[38:41] offset:36480
v_alignbit_b32 v12, v39, v38, 16
v_alignbit_b32 v13, v40, v39, 16
v_alignbit_b32 v14, v41, v40, 16
v_alignbit_b32 v15, v42, v41, 16
ds_write_b128 v4, v[12:15] offset:30208
ds_write_b128 v6, v[44:47] offset:6272
v_alignbit_b32 v12, v45, v44, 16
v_alignbit_b32 v13, v46, v45, 16
v_alignbit_b32 v14, v47, v46, 16
v_alignbit_b32 v15, v48, v47, 16
ds_write_b128 v6, v[12:15] offset:0
v_pk_mul_f32 v[160:161], v[120:121], v[120:121]
v_pk_mul_f32 v[162:163], v[122:123], v[122:123]
v_pk_mul_f32 v[164:165], v[124:125], v[124:125]
v_pk_mul_f32 v[166:167], v[126:127], v[126:127]
v_pk_fma_f32 v[160:161], v[160:161], v[56:57], v[56:57] op_sel:[0,1,0] op_sel_hi:[1,1,0]
v_pk_fma_f32 v[162:163], v[162:163], v[56:57], v[56:57] op_sel:[0,1,0] op_sel_hi:[1,1,0]
v_pk_fma_f32 v[164:165], v[164:165], v[56:57], v[56:57] op_sel:[0,1,0] op_sel_hi:[1,1,0]
v_pk_fma_f32 v[166:167], v[166:167], v[56:57], v[56:57] op_sel:[0,1,0] op_sel_hi:[1,1,0]
v_pk_mul_f32 v[160:161], v[160:161], v[120:121]
v_pk_mul_f32 v[162:163], v[162:163], v[122:123]
v_pk_mul_f32 v[164:165], v[164:165], v[124:125]
v_pk_mul_f32 v[166:167], v[166:167], v[126:127]
v_exp_f32 v160, v160
v_exp_f32 v161, v161
v_exp_f32 v162, v162
v_exp_f32 v163, v163
v_exp_f32 v164, v164
v_exp_f32 v165, v165
v_exp_f32 v166, v166
v_exp_f32 v167, v167
v_pk_fma_f32 v[160:161], v[160:161], v[58:59], v[58:59]
v_pk_fma_f32 v[162:163], v[162:163], v[58:59], v[58:59]
v_pk_fma_f32 v[164:165], v[164:165], v[58:59], v[58:59]
v_pk_fma_f32 v[166:167], v[166:167], v[58:59], v[58:59]
v_rcp_f32 v160, v160
v_rcp_f32 v161, v161
v_rcp_f32 v162, v162
v_rcp_f32 v163, v163
v_rcp_f32 v164, v164
v_rcp_f32 v165, v165
v_rcp_f32 v166, v166
v_rcp_f32 v167, v167
v_pk_mul_f32 v[160:161], v[160:161], v[120:121]
v_pk_mul_f32 v[162:163], v[162:163], v[122:123]
v_pk_mul_f32 v[164:165], v[164:165], v[124:125]
v_pk_mul_f32 v[166:167], v[166:167], v[126:127]
v_cvt_pk_bf16_f32 v120, v160, v161
v_cvt_pk_bf16_f32 v121, v162, v163
v_cvt_pk_bf16_f32 v122, v164, v165
v_cvt_pk_bf16_f32 v123, v166, v167
buffer_store_dwordx4 v[120:123], v60, s[24:27], s101 offen offset:2560 sc1
L_conv:
s_waitcnt lgkmcnt(0)
s_barrier
v_mov_b32 v2, 61440
v_mov_b32 v3, 0
ds_write_b32 v2, v3
ds_read_b128 v[128:131], v8 offset:0
ds_read_b128 v[132:135], v8 offset:64
ds_read_b128 v[136:139], v8 offset:128
ds_read_b128 v[140:143], v8 offset:192
ds_read_b128 v[144:147], v8 offset:256
ds_read_b128 v[148:151], v8 offset:320
ds_read_b128 v[152:155], v8 offset:384
ds_read_b128 v[156:159], v8 offset:448
ds_read_b128 v[160:163], v9 offset:0
ds_read_b128 v[164:167], v9 offset:64
ds_read_b128 v[168:171], v9 offset:128
v_mov_b32 v176, 0
v_mov_b32 v177, 0
v_mov_b32 v178, 0
v_mov_b32 v179, 0
v_mov_b32 v180, 0
v_mov_b32 v181, 0
v_mov_b32 v182, 0
v_mov_b32 v183, 0
v_mov_b32 v184, 0
v_mov_b32 v185, 0
v_mov_b32 v186, 0
v_mov_b32 v187, 0
v_mov_b32 v188, 0
v_mov_b32 v189, 0
v_mov_b32 v190, 0
v_mov_b32 v191, 0
s_waitcnt lgkmcnt(0)
ds_read_b128 v[128:131], v8 offset:512
ds_read_b128 v[172:175], v9 offset:192
v_mfma_f32_16x16x32_bf16 v[188:191], v[140:143], v[160:163], v[188:191]
ds_read_b128 v[132:135], v8 offset:576
ds_read_b128 v[160:163], v9 offset:272
v_mfma_f32_16x16x32_bf16 v[184:187], v[140:143], v[164:167], v[184:187]
buffer_load_dwordx4 a[80:83], v248, s[24:27], s97 offen offset:0
v_mfma_f32_16x16x32_bf16 v[188:191], v[144:147], v[164:167], v[188:191]
ds_read_b128 v[136:139], v8 offset:640
v_mfma_f32_16x16x32_bf16 v[180:183], v[140:143], v[168:171], v[180:183]
ds_read_b128 v[164:167], v9 offset:336
v_mfma_f32_16x16x32_bf16 v[184:187], v[144:147], v[168:171], v[184:187]
buffer_load_dwordx4 a[84:87], v248, s[24:27], s97 offen offset:1024
v_mfma_f32_16x16x32_bf16 v[188:191], v[148:151], v[168:171], v[188:191]
s_waitcnt lgkmcnt(4)
v_mfma_f32_16x16x32_bf16 v[176:179], v[140:143], v[172:175], v[176:179]
ds_read_b128 v[140:143], v8 offset:704
v_mfma_f32_16x16x32_bf16 v[180:183], v[144:147], v[172:175], v[180:183]
ds_read_b128 v[168:171], v9 offset:400
v_mfma_f32_16x16x32_bf16 v[184:187], v[148:151], v[172:175], v[184:187]
buffer_load_dwordx4 a[88:91], v248, s[24:27], s97 offen offset:2048
v_mfma_f32_16x16x32_bf16 v[188:191], v[152:155], v[172:175], v[188:191]
s_waitcnt lgkmcnt(4)
v_mfma_f32_16x16x32_bf16 v[176:179], v[144:147], v[160:163], v[176:179]
ds_read_b128 v[144:147], v8 offset:768
v_mfma_f32_16x16x32_bf16 v[180:183], v[148:151], v[160:163], v[180:183]
ds_read_b128 v[172:175], v9 offset:464
v_mfma_f32_16x16x32_bf16 v[184:187], v[152:155], v[160:163], v[184:187]
buffer_load_dwordx4 a[92:95], v248, s[24:27], s97 offen offset:3072
v_mfma_f32_16x16x32_bf16 v[188:191], v[156:159], v[160:163], v[188:191]
s_waitcnt lgkmcnt(4)
v_mfma_f32_16x16x32_bf16 v[176:179], v[148:151], v[164:167], v[176:179]
ds_read_b128 v[148:151], v8 offset:832
v_mfma_f32_16x16x32_bf16 v[180:183], v[152:155], v[164:167], v[180:183]
ds_read_b128 v[160:163], v9 offset:544
v_mfma_f32_16x16x32_bf16 v[184:187], v[156:159], v[164:167], v[184:187]
buffer_load_dwordx4 a[96:99], v248, s[24:27], s98 offen
v_mfma_f32_16x16x32_bf16 v[188:191], v[128:131], v[164:167], v[188:191]
s_add_u32 s97, s97, 5120
s_cmp_eq_u32 s97, s80
s_cselect_b32 s97, s79, s97
s_add_u32 s98, s97, 4096
s_waitcnt lgkmcnt(4)
v_mfma_f32_16x16x32_bf16 v[176:179], v[152:155], v[168:171], v[176:179]
ds_read_b128 v[152:155], v8 offset:896
v_mfma_f32_16x16x32_bf16 v[180:183], v[156:159], v[168:171], v[180:183]
ds_read_b128 v[164:167], v9 offset:608
v_mfma_f32_16x16x32_bf16 v[184:187], v[128:131], v[168:171], v[184:187]
v_mfma_f32_16x16x32_bf16 v[188:191], v[132:135], v[168:171], v[188:191]
s_waitcnt lgkmcnt(4)
v_mfma_f32_16x16x32_bf16 v[176:179], v[156:159], v[172:175], v[176:179]
ds_read_b128 v[156:159], v8 offset:960
v_mfma_f32_16x16x32_bf16 v[180:183], v[128:131], v[172:175], v[180:183]
ds_read_b128 v[168:171], v9 offset:672
v_mfma_f32_16x16x32_bf16 v[184:187], v[132:135], v[172:175], v[184:187]
buffer_load_dwordx4 a[100:103], v248, s[24:27], s97 offen offset:0
v_mfma_f32_16x16x32_bf16 v[188:191], v[136:139], v[172:175], v[188:191]
s_waitcnt lgkmcnt(4)
v_mfma_f32_16x16x32_bf16 v[176:179], v[128:131], v[160:163], v[176:179]
ds_read_b128 v[128:131], v8 offset:1024
v_mfma_f32_16x16x32_bf16 v[180:183], v[132:135], v[160:163], v[180:183]
ds_read_b128 v[172:175], v9 offset:736
v_mfma_f32_16x16x32_bf16 v[184:187], v[136:139], v[160:163], v[184:187]
buffer_load_dwordx4 a[104:107], v248, s[24:27], s97 offen offset:1024
v_mfma_f32_16x16x32_bf16 v[188:191], v[140:143], v[160:163], v[188:191]
s_waitcnt lgkmcnt(4)
v_mfma_f32_16x16x32_bf16 v[176:179], v[132:135], v[164:167], v[176:179]
ds_read_b128 v[132:135], v8 offset:1088
v_mfma_f32_16x16x32_bf16 v[180:183], v[136:139], v[164:167], v[180:183]
ds_read_b128 v[160:163], v9 offset:816
v_mfma_f32_16x16x32_bf16 v[184:187], v[140:143], v[164:167], v[184:187]
buffer_load_dwordx4 a[108:111], v248, s[24:27], s97 offen offset:2048
v_mfma_f32_16x16x32_bf16 v[188:191], v[144:147], v[164:167], v[188:191]
s_waitcnt lgkmcnt(4)
v_mfma_f32_16x16x32_bf16 v[176:179], v[136:139], v[168:171], v[176:179]
ds_read_b128 v[136:139], v8 offset:1152
v_mfma_f32_16x16x32_bf16 v[180:183], v[140:143], v[168:171], v[180:183]
ds_read_b128 v[164:167], v9 offset:880
v_mfma_f32_16x16x32_bf16 v[184:187], v[144:147], v[168:171], v[184:187]
buffer_load_dwordx4 a[112:115], v248, s[24:27], s97 offen offset:3072
v_mfma_f32_16x16x32_bf16 v[188:191], v[148:151], v[168:171], v[188:191]
s_waitcnt lgkmcnt(4)
v_mfma_f32_16x16x32_bf16 v[176:179], v[140:143], v[172:175], v[176:179]
ds_read_b128 v[140:143], v8 offset:1216
v_mfma_f32_16x16x32_bf16 v[180:183], v[144:147], v[172:175], v[180:183]
ds_read_b128 v[168:171], v9 offset:944
v_mfma_f32_16x16x32_bf16 v[184:187], v[148:151], v[172:175], v[184:187]
buffer_load_dwordx4 a[116:119], v248, s[24:27], s98 offen
v_mfma_f32_16x16x32_bf16 v[188:191], v[152:155], v[172:175], v[188:191]
s_add_u32 s97, s97, 5120
s_cmp_eq_u32 s97, s80
s_cselect_b32 s97, s79, s97
s_add_u32 s98, s97, 4096
s_waitcnt lgkmcnt(4)
v_mfma_f32_16x16x32_bf16 v[176:179], v[144:147], v[160:163], v[176:179]
ds_read_b128 v[144:147], v8 offset:1280
v_mfma_f32_16x16x32_bf16 v[180:183], v[148:151], v[160:163], v[180:183]
ds_read_b128 v[172:175], v9 offset:1008
v_mfma_f32_16x16x32_bf16 v[184:187], v[152:155], v[160:163], v[184:187]
v_mfma_f32_16x16x32_bf16 v[188:191], v[156:159], v[160:163], v[188:191]
s_waitcnt lgkmcnt(4)
v_mfma_f32_16x16x32_bf16 v[176:179], v[148:151], v[164:167], v[176:179]
ds_read_b128 v[148:151], v8 offset:1344
v_mfma_f32_16x16x32_bf16 v[180:183], v[152:155], v[164:167], v[180:183]
ds_read_b128 v[160:163], v9 offset:1088
v_mfma_f32_16x16x32_bf16 v[184:187], v[156:159], v[164:167], v[184:187]
buffer_load_dwordx4 a[120:123], v248, s[24:27], s97 offen offset:0
v_mfma_f32_16x16x32_bf16 v[188:191], v[128:131], v[164:167], v[188:191]
s_waitcnt vmcnt(11)
s_barrier
s_cmp_lg_u32 s5, 0
s_cbranch_scc1 L_fl_31
s_mov_b64 exec, 1
buffer_store_dword v253, v252, s[24:27], 0 offen offset:16 sc1
s_mov_b64 exec, -1
L_fl_31:
s_waitcnt lgkmcnt(4)
v_mfma_f32_16x16x32_bf16 v[176:179], v[152:155], v[168:171], v[176:179]
ds_read_b128 v[152:155], v8 offset:1408
v_mfma_f32_16x16x32_bf16 v[180:183], v[156:159], v[168:171], v[180:183]
ds_read_b128 v[164:167], v9 offset:1152
v_mfma_f32_16x16x32_bf16 v[184:187], v[128:131], v[168:171], v[184:187]
buffer_load_dwordx4 a[124:127], v248, s[24:27], s97 offen offset:1024
v_mfma_f32_16x16x32_bf16 v[188:191], v[132:135], v[168:171], v[188:191]
s_waitcnt lgkmcnt(4)
v_mfma_f32_16x16x32_bf16 v[176:179], v[156:159], v[172:175], v[176:179]
ds_read_b128 v[156:159], v8 offset:1472
v_mfma_f32_16x16x32_bf16 v[180:183], v[128:131], v[172:175], v[180:183]
ds_read_b128 v[168:171], v9 offset:1216
v_mfma_f32_16x16x32_bf16 v[184:187], v[132:135], v[172:175], v[184:187]
buffer_load_dwordx4 a[128:131], v248, s[24:27], s97 offen offset:2048
v_mfma_f32_16x16x32_bf16 v[188:191], v[136:139], v[172:175], v[188:191]
s_waitcnt lgkmcnt(4)
v_mfma_f32_16x16x32_bf16 v[176:179], v[128:131], v[160:163], v[176:179]
ds_read_b128 v[128:131], v8 offset:1536
v_mfma_f32_16x16x32_bf16 v[180:183], v[132:135], v[160:163], v[180:183]
ds_read_b128 v[172:175], v9 offset:1280
v_mfma_f32_16x16x32_bf16 v[184:187], v[136:139], v[160:163], v[184:187]
buffer_load_dwordx4 a[132:135], v248, s[24:27], s97 offen offset:3072
v_mfma_f32_16x16x32_bf16 v[188:191], v[140:143], v[160:163], v[188:191]
s_waitcnt lgkmcnt(4)
v_mfma_f32_16x16x32_bf16 v[176:179], v[132:135], v[164:167], v[176:179]
ds_read_b128 v[132:135], v8 offset:1600
v_mfma_f32_16x16x32_bf16 v[180:183], v[136:139], v[164:167], v[180:183]
ds_read_b128 v[160:163], v9 offset:1360
v_mfma_f32_16x16x32_bf16 v[184:187], v[140:143], v[164:167], v[184:187]
buffer_load_dwordx4 a[136:139], v248, s[24:27], s98 offen
v_mfma_f32_16x16x32_bf16 v[188:191], v[144:147], v[164:167], v[188:191]
s_add_u32 s97, s97, 5120
s_cmp_eq_u32 s97, s80
s_cselect_b32 s97, s79, s97
s_add_u32 s98, s97, 4096
s_waitcnt lgkmcnt(4)
v_mfma_f32_16x16x32_bf16 v[176:179], v[136:139], v[168:171], v[176:179]
ds_read_b128 v[136:139], v8 offset:1664
v_mfma_f32_16x16x32_bf16 v[180:183], v[140:143], v[168:171], v[180:183]
ds_read_b128 v[164:167], v9 offset:1424
v_mfma_f32_16x16x32_bf16 v[184:187], v[144:147], v[168:171], v[184:187]
v_mfma_f32_16x16x32_bf16 v[188:191], v[148:151], v[168:171], v[188:191]
s_waitcnt lgkmcnt(4)
v_mfma_f32_16x16x32_bf16 v[176:179], v[140:143], v[172:175], v[176:179]
ds_read_b128 v[140:143], v8 offset:1728
v_mfma_f32_16x16x32_bf16 v[180:183], v[144:147], v[172:175], v[180:183]
ds_read_b128 v[168:171], v9 offset:1488
v_mfma_f32_16x16x32_bf16 v[184:187], v[148:151], v[172:175], v[184:187]
buffer_load_dwordx4 a[140:143], v248, s[24:27], s97 offen offset:0
v_mfma_f32_16x16x32_bf16 v[188:191], v[152:155], v[172:175], v[188:191]
s_waitcnt lgkmcnt(4)
v_mfma_f32_16x16x32_bf16 v[176:179], v[144:147], v[160:163], v[176:179]
ds_read_b128 v[144:147], v8 offset:1792
v_mfma_f32_16x16x32_bf16 v[180:183], v[148:151], v[160:163], v[180:183]
ds_read_b128 v[172:175], v9 offset:1552
v_mfma_f32_16x16x32_bf16 v[184:187], v[152:155], v[160:163], v[184:187]
buffer_load_dwordx4 a[144:147], v248, s[24:27], s97 offen offset:1024
v_mfma_f32_16x16x32_bf16 v[188:191], v[156:159], v[160:163], v[188:191]
s_mov_b32 s32, s60
s_and_b32 s33, s61, 0xffff
s_mov_b32 s34, 1280
s_mov_b32 s35, 0x20000
v_lshrrev_b32 v19, 4, v1
v_mul_u32_u24 v19, 40, v19
s_mul_i32 s6, s95, 160
v_add_u32 v19, s6, v19
buffer_load_dwordx4 a[240:243], v19, s[32:35], 0 offen
buffer_load_dwordx4 a[244:247], v19, s[32:35], 0 offen offset:16
buffer_load_dwordx2 a[248:249], v19, s[32:35], 0 offen offset:32
s_waitcnt lgkmcnt(4)
v_mfma_f32_16x16x32_bf16 v[176:179], v[148:151], v[164:167], v[176:179]
ds_read_b128 v[148:151], v8 offset:1856
v_mfma_f32_16x16x32_bf16 v[180:183], v[152:155], v[164:167], v[180:183]
ds_read_b128 v[160:163], v9 offset:1632
v_mfma_f32_16x16x32_bf16 v[184:187], v[156:159], v[164:167], v[184:187]
buffer_load_dwordx4 a[148:151], v248, s[24:27], s97 offen offset:2048
v_mfma_f32_16x16x32_bf16 v[188:191], v[128:131], v[164:167], v[188:191]
s_waitcnt lgkmcnt(4)
v_mfma_f32_16x16x32_bf16 v[176:179], v[152:155], v[168:171], v[176:179]
ds_read_b128 v[152:155], v8 offset:1920
v_mfma_f32_16x16x32_bf16 v[180:183], v[156:159], v[168:171], v[180:183]
ds_read_b128 v[164:167], v9 offset:1696
v_mfma_f32_16x16x32_bf16 v[184:187], v[128:131], v[168:171], v[184:187]
buffer_load_dwordx4 a[152:155], v248, s[24:27], s97 offen offset:3072
v_mfma_f32_16x16x32_bf16 v[188:191], v[132:135], v[168:171], v[188:191]
s_waitcnt lgkmcnt(4)
v_mfma_f32_16x16x32_bf16 v[176:179], v[156:159], v[172:175], v[176:179]
ds_read_b128 v[156:159], v8 offset:1984
v_mfma_f32_16x16x32_bf16 v[180:183], v[128:131], v[172:175], v[180:183]
ds_read_b128 v[168:171], v9 offset:1760
v_mfma_f32_16x16x32_bf16 v[184:187], v[132:135], v[172:175], v[184:187]
buffer_load_dwordx4 a[156:159], v248, s[24:27], s98 offen
v_mfma_f32_16x16x32_bf16 v[188:191], v[136:139], v[172:175], v[188:191]
s_add_u32 s97, s97, 5120
s_cmp_eq_u32 s97, s80
s_cselect_b32 s97, s79, s97
s_add_u32 s98, s97, 4096
s_waitcnt lgkmcnt(4)
v_mfma_f32_16x16x32_bf16 v[176:179], v[128:131], v[160:163], v[176:179]
ds_read_b128 v[128:131], v8 offset:2048
v_mfma_f32_16x16x32_bf16 v[180:183], v[132:135], v[160:163], v[180:183]
ds_read_b128 v[172:175], v9 offset:1824
v_mfma_f32_16x16x32_bf16 v[184:187], v[136:139], v[160:163], v[184:187]
v_mfma_f32_16x16x32_bf16 v[188:191], v[140:143], v[160:163], v[188:191]
s_waitcnt lgkmcnt(4)
v_mfma_f32_16x16x32_bf16 v[176:179], v[132:135], v[164:167], v[176:179]
ds_read_b128 v[132:135], v8 offset:2112
v_mfma_f32_16x16x32_bf16 v[180:183], v[136:139], v[164:167], v[180:183]
ds_read_b128 v[160:163], v9 offset:1904
v_mfma_f32_16x16x32_bf16 v[184:187], v[140:143], v[164:167], v[184:187]
buffer_load_dwordx4 a[160:163], v248, s[24:27], s97 offen offset:0
v_mfma_f32_16x16x32_bf16 v[188:191], v[144:147], v[164:167], v[188:191]
s_waitcnt lgkmcnt(4)
v_mfma_f32_16x16x32_bf16 v[176:179], v[136:139], v[168:171], v[176:179]
ds_read_b128 v[136:139], v8 offset:2176
v_mfma_f32_16x16x32_bf16 v[180:183], v[140:143], v[168:171], v[180:183]
ds_read_b128 v[164:167], v9 offset:1968
v_mfma_f32_16x16x32_bf16 v[184:187], v[144:147], v[168:171], v[184:187]
buffer_load_dwordx4 a[164:167], v248, s[24:27], s97 offen offset:1024
v_mfma_f32_16x16x32_bf16 v[188:191], v[148:151], v[168:171], v[188:191]
s_waitcnt lgkmcnt(4)
v_mfma_f32_16x16x32_bf16 v[176:179], v[140:143], v[172:175], v[176:179]
ds_read_b128 v[140:143], v8 offset:2240
v_mfma_f32_16x16x32_bf16 v[180:183], v[144:147], v[172:175], v[180:183]
ds_read_b128 v[168:171], v9 offset:2032
v_mfma_f32_16x16x32_bf16 v[184:187], v[148:151], v[172:175], v[184:187]
buffer_load_dwordx4 a[168:171], v248, s[24:27], s97 offen offset:2048
v_mfma_f32_16x16x32_bf16 v[188:191], v[152:155], v[172:175], v[188:191]
s_waitcnt lgkmcnt(4)
v_mfma_f32_16x16x32_bf16 v[176:179], v[144:147], v[160:163], v[176:179]
ds_read_b128 v[144:147], v8 offset:2304
v_mfma_f32_16x16x32_bf16 v[180:183], v[148:151], v[160:163], v[180:183]
ds_read_b128 v[172:175], v9 offset:2096
v_mfma_f32_16x16x32_bf16 v[184:187], v[152:155], v[160:163], v[184:187]
buffer_load_dwordx4 a[172:175], v248, s[24:27], s97 offen offset:3072
v_mfma_f32_16x16x32_bf16 v[188:191], v[156:159], v[160:163], v[188:191]
s_waitcnt lgkmcnt(4)
v_mfma_f32_16x16x32_bf16 v[176:179], v[148:151], v[164:167], v[176:179]
ds_read_b128 v[148:151], v8 offset:2368
v_mfma_f32_16x16x32_bf16 v[180:183], v[152:155], v[164:167], v[180:183]
ds_read_b128 v[160:163], v9 offset:2176
v_mfma_f32_16x16x32_bf16 v[184:187], v[156:159], v[164:167], v[184:187]
buffer_load_dwordx4 a[176:179], v248, s[24:27], s98 offen
v_mfma_f32_16x16x32_bf16 v[188:191], v[128:131], v[164:167], v[188:191]
s_add_u32 s97, s97, 5120
s_cmp_eq_u32 s97, s80
s_cselect_b32 s97, s79, s97
s_add_u32 s98, s97, 4096
s_waitcnt lgkmcnt(4)
v_mfma_f32_16x16x32_bf16 v[176:179], v[152:155], v[168:171], v[176:179]
ds_read_b128 v[152:155], v8 offset:2432
v_mfma_f32_16x16x32_bf16 v[180:183], v[156:159], v[168:171], v[180:183]
ds_read_b128 v[164:167], v9 offset:2240
v_mfma_f32_16x16x32_bf16 v[184:187], v[128:131], v[168:171], v[184:187]
v_mfma_f32_16x16x32_bf16 v[188:191], v[132:135], v[168:171], v[188:191]
s_waitcnt lgkmcnt(4)
v_mfma_f32_16x16x32_bf16 v[176:179], v[156:159], v[172:175], v[176:179]
ds_read_b128 v[156:159], v8 offset:2496
v_mfma_f32_16x16x32_bf16 v[180:183], v[128:131], v[172:175], v[180:183]
ds_read_b128 v[168:171], v9 offset:2304
v_mfma_f32_16x16x32_bf16 v[184:187], v[132:135], v[172:175], v[184:187]
v_mfma_f32_16x16x32_bf16 v[188:191], v[136:139], v[172:175], v[188:191]
s_cmp_eq_u32 s86, 0
s_cbranch_scc1 L_two_32
L_halfb_33:
s_waitcnt lgkmcnt(4)
v_mfma_f32_16x16x32_bf16 v[176:179], v[128:131], v[160:163], v[176:179]
ds_read_b128 v[128:131], v8 offset:2560
v_mfma_f32_16x16x32_bf16 v[180:183], v[132:135], v[160:163], v[180:183]
ds_read_b128 v[172:175], v9 offset:2368
v_mfma_f32_16x16x32_bf16 v[184:187], v[136:139], v[160:163], v[184:187]
buffer_load_dwordx4 a[180:183], v248, s[24:27], s97 offen offset:0
v_mfma_f32_16x16x32_bf16 v[188:191], v[140:143], v[160:163], v[188:191]
buffer_load_dwordx4 a[184:187], v248, s[24:27], s97 offen offset:1024
s_waitcnt lgkmcnt(4)
v_mfma_f32_16x16x32_bf16 v[176:179], v[132:135], v[164:167], v[176:179]
ds_read_b128 v[132:135], v8 offset:2624
v_mfma_f32_16x16x32_bf16 v[180:183], v[136:139], v[164:167], v[180:183]
ds_read_b128 v[160:163], v9 offset:2448
v_mfma_f32_16x16x32_bf16 v[184:187], v[140:143], v[164:167], v[184:187]
buffer_load_dwordx4 a[188:191], v248, s[24:27], s97 offen offset:2048
v_mfma_f32_16x16x32_bf16 v[188:191], v[144:147], v[164:167], v[188:191]
s_waitcnt lgkmcnt(4)
v_mfma_f32_16x16x32_bf16 v[176:179], v[136:139], v[168:171], v[176:179]
ds_read_b128 v[136:139], v8 offset:2688
v_mfma_f32_16x16x32_bf16 v[180:183], v[140:143], v[168:171], v[180:183]
ds_read_b128 v[164:167], v9 offset:2512
v_mfma_f32_16x16x32_bf16 v[184:187], v[144:147], v[168:171], v[184:187]
buffer_load_dwordx4 a[192:195], v248, s[24:27], s97 offen offset:3072
v_mfma_f32_16x16x32_bf16 v[188:191], v[148:151], v[168:171], v[188:191]
s_waitcnt lgkmcnt(4)
v_mfma_f32_16x16x32_bf16 v[176:179], v[140:143], v[172:175], v[176:179]
ds_read_b128 v[140:143], v8 offset:2752
v_mfma_f32_16x16x32_bf16 v[180:183], v[144:147], v[172:175], v[180:183]
ds_read_b128 v[168:171], v9 offset:2576
v_mfma_f32_16x16x32_bf16 v[184:187], v[148:151], v[172:175], v[184:187]
buffer_load_dwordx4 a[196:199], v248, s[24:27], s98 offen
v_mfma_f32_16x16x32_bf16 v[188:191], v[152:155], v[172:175], v[188:191]
s_add_u32 s97, s97, 5120
s_cmp_eq_u32 s97, s80
s_cselect_b32 s97, s79, s97
s_add_u32 s98, s97, 4096
s_waitcnt lgkmcnt(4)
v_mfma_f32_16x16x32_bf16 v[176:179], v[144:147], v[160:163], v[176:179]
ds_read_b128 v[144:147], v8 offset:2816
v_mfma_f32_16x16x32_bf16 v[180:183], v[148:151], v[160:163], v[180:183]
ds_read_b128 v[172:175], v9 offset:2640
v_mfma_f32_16x16x32_bf16 v[184:187], v[152:155], v[160:163], v[184:187]
buffer_load_dwordx4 a[200:203], v248, s[24:27], s97 offen offset:0
v_mfma_f32_16x16x32_bf16 v[188:191], v[156:159], v[160:163], v[188:191]
s_waitcnt lgkmcnt(4)
v_mfma_f32_16x16x32_bf16 v[176:179], v[148:151], v[164:167], v[176:179]
ds_read_b128 v[148:151], v8 offset:2880
v_mfma_f32_16x16x32_bf16 v[180:183], v[152:155], v[164:167], v[180:183]
ds_read_b128 v[160:163], v9 offset:2720
v_mfma_f32_16x16x32_bf16 v[184:187], v[156:159], v[164:167], v[184:187]
buffer_load_dwordx4 a[204:207], v248, s[24:27], s97 offen offset:1024
v_mfma_f32_16x16x32_bf16 v[188:191], v[128:131], v[164:167], v[188:191]
s_waitcnt lgkmcnt(4)
v_mfma_f32_16x16x32_bf16 v[176:179], v[152:155], v[168:171], v[176:179]
ds_read_b128 v[152:155], v8 offset:2944
v_mfma_f32_16x16x32_bf16 v[180:183], v[156:159], v[168:171], v[180:183]
ds_read_b128 v[164:167], v9 offset:2784
v_mfma_f32_16x16x32_bf16 v[184:187], v[128:131], v[168:171], v[184:187]
buffer_load_dwordx4 a[208:211], v248, s[24:27], s97 offen offset:2048
v_mfma_f32_16x16x32_bf16 v[188:191], v[132:135], v[168:171], v[188:191]
s_waitcnt lgkmcnt(4)
v_mfma_f32_16x16x32_bf16 v[176:179], v[156:159], v[172:175], v[176:179]
ds_read_b128 v[156:159], v8 offset:3008
v_mfma_f32_16x16x32_bf16 v[180:183], v[128:131], v[172:175], v[180:183]
ds_read_b128 v[168:171], v9 offset:2848
v_mfma_f32_16x16x32_bf16 v[184:187], v[132:135], v[172:175], v[184:187]
buffer_load_dwordx4 a[212:215], v248, s[24:27], s97 offen offset:3072
v_mfma_f32_16x16x32_bf16 v[188:191], v[136:139], v[172:175], v[188:191]
buffer_load_dwordx4 a[216:219], v248, s[24:27], s98 offen
s_add_u32 s97, s97, 5120
s_cmp_eq_u32 s97, s80
s_cselect_b32 s97, s79, s97
s_add_u32 s98, s97, 4096
s_waitcnt lgkmcnt(4)
v_mfma_f32_16x16x32_bf16 v[176:179], v[128:131], v[160:163], v[176:179]
ds_read_b128 v[128:131], v8 offset:3072
v_mfma_f32_16x16x32_bf16 v[180:183], v[132:135], v[160:163], v[180:183]
ds_read_b128 v[172:175], v9 offset:2912
v_mfma_f32_16x16x32_bf16 v[184:187], v[136:139], v[160:163], v[184:187]
buffer_load_dwordx4 a[220:223], v248, s[24:27], s97 offen offset:0
v_mfma_f32_16x16x32_bf16 v[188:191], v[140:143], v[160:163], v[188:191]
s_waitcnt lgkmcnt(4)
v_mfma_f32_16x16x32_bf16 v[176:179], v[132:135], v[164:167], v[176:179]
ds_read_b128 v[132:135], v8 offset:3136
v_mfma_f32_16x16x32_bf16 v[180:183], v[136:139], v[164:167], v[180:183]
ds_read_b128 v[160:163], v9 offset:2992
v_mfma_f32_16x16x32_bf16 v[184:187], v[140:143], v[164:167], v[184:187]
buffer_load_dwordx4 a[224:227], v248, s[24:27], s97 offen offset:1024
v_mfma_f32_16x16x32_bf16 v[188:191], v[144:147], v[164:167], v[188:191]
s_waitcnt lgkmcnt(4)
v_mfma_f32_16x16x32_bf16 v[176:179], v[136:139], v[168:171], v[176:179]
ds_read_b128 v[136:139], v8 offset:3200
v_mfma_f32_16x16x32_bf16 v[180:183], v[140:143], v[168:171], v[180:183]
ds_read_b128 v[164:167], v9 offset:3056
v_mfma_f32_16x16x32_bf16 v[184:187], v[144:147], v[168:171], v[184:187]
buffer_load_dwordx4 a[228:231], v248, s[24:27], s97 offen offset:2048
v_mfma_f32_16x16x32_bf16 v[188:191], v[148:151], v[168:171], v[188:191]
s_waitcnt lgkmcnt(4)
v_mfma_f32_16x16x32_bf16 v[176:179], v[140:143], v[172:175], v[176:179]
ds_read_b128 v[140:143], v8 offset:3264
v_mfma_f32_16x16x32_bf16 v[180:183], v[144:147], v[172:175], v[180:183]
ds_read_b128 v[168:171], v9 offset:3120
v_mfma_f32_16x16x32_bf16 v[184:187], v[148:151], v[172:175], v[184:187]
buffer_load_dwordx4 a[232:235], v248, s[24:27], s97 offen offset:3072
v_mfma_f32_16x16x32_bf16 v[188:191], v[152:155], v[172:175], v[188:191]
buffer_load_dword v254, v249, s[24:27], 0 offen sc1
s_waitcnt lgkmcnt(4)
v_mfma_f32_16x16x32_bf16 v[176:179], v[144:147], v[160:163], v[176:179]
ds_read_b128 v[144:147], v8 offset:3328
v_mfma_f32_16x16x32_bf16 v[180:183], v[148:151], v[160:163], v[180:183]
ds_read_b128 v[172:175], v9 offset:3184
v_mfma_f32_16x16x32_bf16 v[184:187], v[152:155], v[160:163], v[184:187]
buffer_load_dwordx4 a[236:239], v248, s[24:27], s98 offen
v_mfma_f32_16x16x32_bf16 v[188:191], v[156:159], v[160:163], v[188:191]
s_add_u32 s97, s97, 5120
s_cmp_eq_u32 s97, s80
s_cselect_b32 s97, s79, s97
s_add_u32 s98, s97, 4096
s_waitcnt lgkmcnt(4)
v_mfma_f32_16x16x32_bf16 v[176:179], v[148:151], v[164:167], v[176:179]
ds_read_b128 v[148:151], v8 offset:3392
v_mfma_f32_16x16x32_bf16 v[180:183], v[152:155], v[164:167], v[180:183]
ds_read_b128 v[160:163], v9 offset:3264
v_mfma_f32_16x16x32_bf16 v[184:187], v[156:159], v[164:167], v[184:187]
buffer_load_dwordx4 v[208:211], v248, s[24:27], s97 offen offset:0
v_mfma_f32_16x16x32_bf16 v[188:191], v[128:131], v[164:167], v[188:191]
s_waitcnt lgkmcnt(4)
v_mfma_f32_16x16x32_bf16 v[176:179], v[152:155], v[168:171], v[176:179]
ds_read_b128 v[152:155], v8 offset:3456
v_mfma_f32_16x16x32_bf16 v[180:183], v[156:159], v[168:171], v[180:183]
ds_read_b128 v[164:167], v9 offset:3328
v_mfma_f32_16x16x32_bf16 v[184:187], v[128:131], v[168:171], v[184:187]
buffer_load_dwordx4 v[212:215], v248, s[24:27], s97 offen offset:1024
v_mfma_f32_16x16x32_bf16 v[188:191], v[132:135], v[168:171], v[188:191]
buffer_load_dwordx4 v[216:219], v248, s[24:27], s97 offen offset:2048
s_waitcnt lgkmcnt(4)
v_mfma_f32_16x16x32_bf16 v[176:179], v[156:159], v[172:175], v[176:179]
ds_read_b128 v[156:159], v8 offset:3520
v_mfma_f32_16x16x32_bf16 v[180:183], v[128:131], v[172:175], v[180:183]
ds_read_b128 v[168:171], v9 offset:3392
v_mfma_f32_16x16x32_bf16 v[184:187], v[132:135], v[172:175], v[184:187]
buffer_load_dwordx4 v[220:223], v248, s[24:27], s97 offen offset:3072
v_mfma_f32_16x16x32_bf16 v[188:191], v[136:139], v[172:175], v[188:191]
s_waitcnt lgkmcnt(4)
v_mfma_f32_16x16x32_bf16 v[176:179], v[128:131], v[160:163], v[176:179]
ds_read_b128 v[128:131], v8 offset:3584
v_mfma_f32_16x16x32_bf16 v[180:183], v[132:135], v[160:163], v[180:183]
ds_read_b128 v[172:175], v9 offset:3456
v_mfma_f32_16x16x32_bf16 v[184:187], v[136:139], v[160:163], v[184:187]
buffer_load_dwordx4 v[224:227], v248, s[24:27], s98 offen
v_mfma_f32_16x16x32_bf16 v[188:191], v[140:143], v[160:163], v[188:191]
s_add_u32 s97, s97, 5120
s_cmp_eq_u32 s97, s80
s_cselect_b32 s97, s79, s97
s_add_u32 s98, s97, 4096
s_waitcnt lgkmcnt(4)
v_mfma_f32_16x16x32_bf16 v[176:179], v[132:135], v[164:167], v[176:179]
ds_read_b128 v[132:135], v8 offset:3648
v_mfma_f32_16x16x32_bf16 v[180:183], v[136:139], v[164:167], v[180:183]
ds_read_b128 v[160:163], v9 offset:3536
v_mfma_f32_16x16x32_bf16 v[184:187], v[140:143], v[164:167], v[184:187]
buffer_load_dwordx4 v[228:231], v248, s[24:27], s97 offen offset:0
v_mfma_f32_16x16x32_bf16 v[188:191], v[144:147], v[164:167], v[188:191]
s_waitcnt lgkmcnt(4)
v_mfma_f32_16x16x32_bf16 v[176:179], v[136:139], v[168:171], v[176:179]
ds_read_b128 v[136:139], v8 offset:3712
v_mfma_f32_16x16x32_bf16 v[180:183], v[140:143], v[168:171], v[180:183]
ds_read_b128 v[164:167], v9 offset:3600
v_mfma_f32_16x16x32_bf16 v[184:187], v[144:147], v[168:171], v[184:187]
buffer_load_dwordx4 v[232:235], v248, s[24:27], s97 offen offset:1024
v_mfma_f32_16x16x32_bf16 v[188:191], v[148:151], v[168:171], v[188:191]
s_waitcnt lgkmcnt(4)
v_mfma_f32_16x16x32_bf16 v[176:179], v[140:143], v[172:175], v[176:179]
ds_read_b128 v[140:143], v8 offset:3776
v_mfma_f32_16x16x32_bf16 v[180:183], v[144:147], v[172:175], v[180:183]
ds_read_b128 v[168:171], v9 offset:3664
v_mfma_f32_16x16x32_bf16 v[184:187], v[148:151], v[172:175], v[184:187]
buffer_load_dwordx4 v[236:239], v248, s[24:27], s97 offen offset:2048
v_mfma_f32_16x16x32_bf16 v[188:191], v[152:155], v[172:175], v[188:191]
s_waitcnt lgkmcnt(4)
v_mfma_f32_16x16x32_bf16 v[176:179], v[144:147], v[160:163], v[176:179]
ds_read_b128 v[144:147], v8 offset:3840
v_mfma_f32_16x16x32_bf16 v[180:183], v[148:151], v[160:163], v[180:183]
ds_read_b128 v[172:175], v9 offset:3728
v_mfma_f32_16x16x32_bf16 v[184:187], v[152:155], v[160:163], v[184:187]
buffer_load_dwordx4 v[240:243], v248, s[24:27], s97 offen offset:3072
v_mfma_f32_16x16x32_bf16 v[188:191], v[156:159], v[160:163], v[188:191]
s_waitcnt lgkmcnt(4)
v_mfma_f32_16x16x32_bf16 v[176:179], v[148:151], v[164:167], v[176:179]
ds_read_b128 v[148:151], v8 offset:3904
v_mfma_f32_16x16x32_bf16 v[180:183], v[152:155], v[164:167], v[180:183]
ds_read_b128 v[160:163], v9 offset:3808
v_mfma_f32_16x16x32_bf16 v[184:187], v[156:159], v[164:167], v[184:187]
buffer_load_dwordx4 v[244:247], v248, s[24:27], s98 offen
v_mfma_f32_16x16x32_bf16 v[188:191], v[128:131], v[164:167], v[188:191]
s_add_u32 s97, s97, 5120
s_cmp_eq_u32 s97, s80
s_cselect_b32 s97, s79, s97
s_add_u32 s98, s97, 4096
s_waitcnt vmcnt(11)
v_cmp_eq_u32 vcc, 0, v254
s_cbranch_vccnz L_slow_34
L_back_35:
s_mul_i32 s6, s94, 54
s_add_u32 s6, s6, s96
s_lshl_b32 s81, s6, 12
s_add_u32 s81, s81, 10485760
s_cmp_ge_u32 s5, 2
s_cselect_b32 s7, 13, 14
s_lshl_b32 s7, s7, 12
s_add_u32 s82, s81, s7
s_lshl_b32 s7, s93, 12
s_add_u32 s99, s81, s7
s_add_u32 s6, s5, 0
s_and_b32 s6, s6, 3
s_lshl_b32 s6, s6, 10
v_add_u32 v56, s6, v248
s_add_u32 s6, s5, 1
s_and_b32 s6, s6, 3
s_lshl_b32 s6, s6, 10
v_add_u32 v57, s6, v248
s_add_u32 s6, s5, 2
s_and_b32 s6, s6, 3
s_lshl_b32 s6, s6, 10
v_add_u32 v58, s6, v248
s_add_u32 s6, s5, 3
s_and_b32 s6, s6, 3
s_lshl_b32 s6, s6, 10
v_add_u32 v59, s6, v248
s_waitcnt lgkmcnt(4)
v_mfma_f32_16x16x32_bf16 v[176:179], v[152:155], v[168:171], v[176:179]
ds_read_b128 v[152:155], v8 offset:3968
v_mfma_f32_16x16x32_bf16 v[180:183], v[156:159], v[168:171], v[180:183]
ds_read_b128 v[164:167], v9 offset:3872
v_mfma_f32_16x16x32_bf16 v[184:187], v[128:131], v[168:171], v[184:187]
v_mfma_f32_16x16x32_bf16 v[188:191], v[132:135], v[168:171], v[188:191]
s_waitcnt lgkmcnt(4)
v_mfma_f32_16x16x32_bf16 v[176:179], v[156:159], v[172:175], v[176:179]
ds_read_b128 v[156:159], v8 offset:4032
v_mfma_f32_16x16x32_bf16 v[180:183], v[128:131], v[172:175], v[180:183]
ds_read_b128 v[168:171], v9 offset:3936
v_mfma_f32_16x16x32_bf16 v[184:187], v[132:135], v[172:175], v[184:187]
buffer_load_dwordx4 v[64:67], v57, s[24:27], s99 offen
s_add_u32 s99, s99, 4096
v_mfma_f32_16x16x32_bf16 v[188:191], v[136:139], v[172:175], v[188:191]
buffer_load_dwordx4 v[68:71], v57, s[24:27], s99 offen
s_add_u32 s99, s99, 4096
s_waitcnt lgkmcnt(4)
v_mfma_f32_16x16x32_bf16 v[176:179], v[128:131], v[160:163], v[176:179]
ds_read_b128 v[128:131], v8 offset:4096
v_mfma_f32_16x16x32_bf16 v[180:183], v[132:135], v[160:163], v[180:183]
ds_read_b128 v[172:175], v9 offset:4000
v_mfma_f32_16x16x32_bf16 v[184:187], v[136:139], v[160:163], v[184:187]
buffer_load_dwordx4 v[72:75], v57, s[24:27], s99 offen
s_add_u32 s99, s99, 4096
v_mfma_f32_16x16x32_bf16 v[188:191], v[140:143], v[160:163], v[188:191]
s_waitcnt lgkmcnt(4)
v_mfma_f32_16x16x32_bf16 v[176:179], v[132:135], v[164:167], v[176:179]
ds_read_b128 v[132:135], v8 offset:4160
v_mfma_f32_16x16x32_bf16 v[180:183], v[136:139], v[164:167], v[180:183]
ds_read_b128 v[160:163], v9 offset:4080
v_mfma_f32_16x16x32_bf16 v[184:187], v[140:143], v[164:167], v[184:187]
buffer_load_dwordx4 v[76:79], v57, s[24:27], s99 offen
s_add_u32 s99, s99, 4096
v_mfma_f32_16x16x32_bf16 v[188:191], v[144:147], v[164:167], v[188:191]
s_waitcnt lgkmcnt(4)
v_mfma_f32_16x16x32_bf16 v[176:179], v[136:139], v[168:171], v[176:179]
ds_read_b128 v[136:139], v8 offset:4224
v_mfma_f32_16x16x32_bf16 v[180:183], v[140:143], v[168:171], v[180:183]
ds_read_b128 v[164:167], v9 offset:4144
v_mfma_f32_16x16x32_bf16 v[184:187], v[144:147], v[168:171], v[184:187]
buffer_load_dwordx4 v[80:83], v57, s[24:27], s99 offen
s_add_u32 s99, s99, 4096
v_mfma_f32_16x16x32_bf16 v[188:191], v[148:151], v[168:171], v[188:191]
buffer_load_dwordx4 v[84:87], v57, s[24:27], s99 offen
s_add_u32 s99, s99, 4096
s_waitcnt lgkmcnt(4)
v_mfma_f32_16x16x32_bf16 v[176:179], v[140:143], v[172:175], v[176:179]
ds_read_b128 v[140:143], v8 offset:4288
v_mfma_f32_16x16x32_bf16 v[180:183], v[144:147], v[172:175], v[180:183]
ds_read_b128 v[168:171], v9 offset:4208
v_mfma_f32_16x16x32_bf16 v[184:187], v[148:151], v[172:175], v[184:187]
buffer_load_dwordx4 v[88:91], v57, s[24:27], s99 offen
s_add_u32 s99, s99, 4096
v_mfma_f32_16x16x32_bf16 v[188:191], v[152:155], v[172:175], v[188:191]
s_waitcnt lgkmcnt(4)
v_mfma_f32_16x16x32_bf16 v[176:179], v[144:147], v[160:163], v[176:179]
ds_read_b128 v[144:147], v8 offset:4352
v_mfma_f32_16x16x32_bf16 v[180:183], v[148:151], v[160:163], v[180:183]
ds_read_b128 v[172:175], v9 offset:4272
v_mfma_f32_16x16x32_bf16 v[184:187], v[152:155], v[160:163], v[184:187]
buffer_load_dwordx4 v[92:95], v57, s[24:27], s99 offen
s_add_u32 s99, s99, 4096
v_mfma_f32_16x16x32_bf16 v[188:191], v[156:159], v[160:163], v[188:191]
s_waitcnt lgkmcnt(4)
v_mfma_f32_16x16x32_bf16 v[176:179], v[148:151], v[164:167], v[176:179]
ds_read_b128 v[148:151], v8 offset:4416
v_mfma_f32_16x16x32_bf16 v[180:183], v[152:155], v[164:167], v[180:183]
ds_read_b128 v[160:163], v9 offset:4352
v_mfma_f32_16x16x32_bf16 v[184:187], v[156:159], v[164:167], v[184:187]
buffer_load_dwordx4 v[96:99], v57, s[24:27], s99 offen
s_add_u32 s99, s99, 4096
v_mfma_f32_16x16x32_bf16 v[188:191], v[128:131], v[164:167], v[188:191]
buffer_load_dwordx4 v[100:103], v57, s[24:27], s99 offen
s_add_u32 s99, s99, 4096
s_waitcnt lgkmcnt(4)
v_mfma_f32_16x16x32_bf16 v[176:179], v[152:155], v[168:171], v[176:179]
ds_read_b128 v[152:155], v8 offset:4480
v_mfma_f32_16x16x32_bf16 v[180:183], v[156:159], v[168:171], v[180:183]
ds_read_b128 v[164:167], v9 offset:4416
v_mfma_f32_16x16x32_bf16 v[184:187], v[128:131], v[168:171], v[184:187]
buffer_load_dwordx4 v[104:107], v57, s[24:27], s99 offen
s_add_u32 s99, s99, 4096
v_mfma_f32_16x16x32_bf16 v[188:191], v[132:135], v[168:171], v[188:191]
s_waitcnt lgkmcnt(4)
v_mfma_f32_16x16x32_bf16 v[176:179], v[156:159], v[172:175], v[176:179]
ds_read_b128 v[156:159], v8 offset:4544
v_mfma_f32_16x16x32_bf16 v[180:183], v[128:131], v[172:175], v[180:183]
ds_read_b128 v[168:171], v9 offset:4480
v_mfma_f32_16x16x32_bf16 v[184:187], v[132:135], v[172:175], v[184:187]
buffer_load_dwordx4 v[108:111], v57, s[24:27], s99 offen
s_add_u32 s99, s99, 4096
v_mfma_f32_16x16x32_bf16 v[188:191], v[136:139], v[172:175], v[188:191]
s_waitcnt lgkmcnt(0)
ds_read_b128 v[128:131], v10 offset:240
ds_read_b128 v[132:135], v10 offset:176
ds_read_b128 v[136:139], v10 offset:112
ds_read_b128 v[140:143], v10 offset:48
s_and_b32 s6, s88, 0xfffffffe
s_sub_u32 s6, s91, s6
s_cmp_ge_u32 s6, 2
s_cselect_b32 s92, s1, s0
s_and_b32 s6, s6, 1
s_lshl_b32 s6, s6, 4
s_lshr_b32 s92, s92, s6
s_lshl_b32 s92, s92, 16
s_lshl_b32 s6, s91, 12
s_add_u32 s6, s6, 4194304
s_nop 4
s_waitcnt lgkmcnt(0)
v_lshlrev_b32 v131, 16, v131
v_fma_f32 v176, v131, s92, v176
v_lshlrev_b32 v130, 16, v130
v_fma_f32 v177, v130, s92, v177
v_lshlrev_b32 v129, 16, v129
v_fma_f32 v178, v129, s92, v178
v_lshlrev_b32 v128, 16, v128
v_fma_f32 v179, v128, s92, v179
v_lshlrev_b32 v135, 16, v135
v_fma_f32 v180, v135, s92, v180
v_lshlrev_b32 v134, 16, v134
v_fma_f32 v181, v134, s92, v181
v_lshlrev_b32 v133, 16, v133
v_fma_f32 v182, v133, s92, v182
v_lshlrev_b32 v132, 16, v132
v_fma_f32 v183, v132, s92, v183
v_lshlrev_b32 v139, 16, v139
v_fma_f32 v184, v139, s92, v184
v_lshlrev_b32 v138, 16, v138
v_fma_f32 v185, v138, s92, v185
v_lshlrev_b32 v137, 16, v137
v_fma_f32 v186, v137, s92, v186
v_lshlrev_b32 v136, 16, v136
v_fma_f32 v187, v136, s92, v187
v_lshlrev_b32 v143, 16, v143
v_fma_f32 v188, v143, s92, v188
v_lshlrev_b32 v142, 16, v142
v_fma_f32 v189, v142, s92, v189
v_lshlrev_b32 v141, 16, v141
v_fma_f32 v190, v141, s92, v190
v_lshlrev_b32 v140, 16, v140
v_fma_f32 v191, v140, s92, v191
v_cvt_pk_bf16_f32 v160, v176, v177
v_cvt_pk_bf16_f32 v161, v178, v179
v_cvt_pk_bf16_f32 v162, v180, v181
v_cvt_pk_bf16_f32 v163, v182, v183
buffer_store_dwordx4 v[160:163], v11, s[24:27], s6 offen offset:0 sc1
v_cvt_pk_bf16_f32 v164, v184, v185
v_cvt_pk_bf16_f32 v165, v186, v187
v_cvt_pk_bf16_f32 v166, v188, v189
v_cvt_pk_bf16_f32 v167, v190, v191
buffer_store_dwordx4 v[164:167], v11, s[24:27], s6 offen offset:128 sc1
L_gemm2:
s_waitcnt vmcnt(13)
v_mfma_f32_16x16x32_bf16 v[148:151], a[0:3], v[64:67], 0
buffer_load_dwordx4 v[112:115], v57, s[24:27], s99 offen
s_add_u32 s99, s99, 4096
v_mfma_f32_16x16x32_bf16 v[152:155], a[4:7], v[64:67], 0
v_and_b32 v50, 15, v1
v_lshrrev_b32 v51, 3, v50
v_mfma_f32_16x16x32_bf16 v[156:159], a[8:11], v[64:67], 0
v_lshlrev_b32 v51, 3, v51
v_and_b32 v52, 3, v50
v_mfma_f32_16x16x32_bf16 v[160:163], a[12:15], v[64:67], 0
v_lshl_or_b32 v51, v52, 1, v51
v_bfe_u32 v52, v50, 2, 1
v_mfma_f32_16x16x32_bf16 v[164:167], a[16:19], v[64:67], 0
v_or_b32 v51, v51, v52
v_mul_u32_u24 v51, 176, v51
s_waitcnt vmcnt(13)
v_mfma_f32_16x16x32_bf16 v[148:151], a[20:23], v[68:71], v[148:151]
buffer_load_dwordx4 v[116:119], v57, s[24:27], s99 offen
s_mov_b32 s99, s81
v_mfma_f32_16x16x32_bf16 v[152:155], a[24:27], v[68:71], v[152:155]
v_lshrrev_b32 v53, 4, v1
v_mfma_f32_16x16x32_bf16 v[156:159], a[28:31], v[68:71], v[156:159]
v_mul_u32_u24 v52, 40, v53
s_mul_i32 s86, s5, 2816
v_mfma_f32_16x16x32_bf16 v[160:163], a[32:35], v[68:71], v[160:163]
s_add_u32 s86, s86, 73728
v_add_u32 v51, v51, v52
v_mfma_f32_16x16x32_bf16 v[164:167], a[36:39], v[68:71], v[164:167]
s_and_b32 s87, s95, 1
s_lshl_b32 s87, s87, 1
s_waitcnt vmcnt(13)
v_mfma_f32_16x16x32_bf16 v[148:151], a[40:43], v[72:75], v[148:151]
buffer_load_dwordx4 v[120:123], v58, s[24:27], s99 offen
s_add_u32 s99, s99, 4096
v_mfma_f32_16x16x32_bf16 v[152:155], a[44:47], v[72:75], v[152:155]
v_subrev_u32 v52, s87, v50
v_lshlrev_b32 v52, 4, v52
v_mfma_f32_16x16x32_bf16 v[156:159], a[48:51], v[72:75], v[156:159]
v_add_u32 v50, s86, v51
v_mfma_f32_16x16x32_bf16 v[160:163], a[52:55], v[72:75], v[160:163]
v_mul_u32_u24 v51, 176, v53
v_add_u32 v51, v51, v52
v_mfma_f32_16x16x32_bf16 v[164:167], a[56:59], v[72:75], v[164:167]
v_add_u32 v51, s86, v51
s_lshl_b32 s86, s94, 6
s_waitcnt vmcnt(13)
v_mfma_f32_16x16x32_bf16 v[148:151], a[60:63], v[76:79], v[148:151]
buffer_load_dwordx4 v[124:127], v58, s[24:27], s99 offen
s_add_u32 s99, s99, 4096
v_mfma_f32_16x16x32_bf16 v[152:155], a[64:67], v[76:79], v[152:155]
s_lshl_b32 s85, s5, 4
s_add_u32 s86, s86, s85
v_mfma_f32_16x16x32_bf16 v[156:159], a[68:71], v[76:79], v[156:159]
v_add_u32 v53, s86, v53
v_mul_u32_u24 v53, 1280, v53
v_mfma_f32_16x16x32_bf16 v[160:163], a[72:75], v[76:79], v[160:163]
s_mul_i32 s86, s95, 160
v_mfma_f32_16x16x32_bf16 v[164:167], a[76:79], v[76:79], v[164:167]
v_add_u32 v52, s86, v52
v_add_u32 v52, v52, v53
s_waitcnt vmcnt(13)
v_mfma_f32_16x16x32_bf16 v[148:151], a[80:83], v[80:83], v[148:151]
buffer_load_dwordx4 v[64:67], v58, s[24:27], s99 offen
s_add_u32 s99, s99, 4096
v_mfma_f32_16x16x32_bf16 v[152:155], a[84:87], v[80:83], v[152:155]
v_add_u32 v53, 5120, v52
v_add_u32 v54, 10240, v52
v_mfma_f32_16x16x32_bf16 v[156:159], a[88:91], v[80:83], v[156:159]
v_add_u32 v55, 15360, v52
s_lshl_b32 s86, 0x03ff03ff, s87
v_mfma_f32_16x16x32_bf16 v[160:163], a[92:95], v[80:83], v[160:163]
s_mov_b32 s87, s86
s_mul_i32 s83, s5, 15360
v_mfma_f32_16x16x32_bf16 v[164:167], a[96:99], v[80:83], v[164:167]
s_add_u32 s83, s83, 10240
s_waitcnt vmcnt(13)
v_mfma_f32_16x16x32_bf16 v[148:151], a[100:103], v[84:87], v[148:151]
buffer_load_dwordx4 v[68:71], v58, s[24:27], s99 offen
s_add_u32 s99, s99, 4096
v_mfma_f32_16x16x32_bf16 v[152:155], a[104:107], v[84:87], v[152:155]
v_and_b32 v2, 15, v1
v_lshrrev_b32 v4, 3, v2
v_mfma_f32_16x16x32_bf16 v[156:159], a[108:111], v[84:87], v[156:159]
v_lshlrev_b32 v4, 3, v4
v_and_b32 v5, 3, v2
v_mfma_f32_16x16x32_bf16 v[160:163], a[112:115], v[84:87], v[160:163]
s_add_u32 m0, s83, 0
s_mov_b64 exec, s[86:87]
buffer_load_dwordx4 v52, s[8:11], 0 offen lds
s_mov_b64 exec, -1
v_mfma_f32_16x16x32_bf16 v[164:167], a[116:119], v[84:87], v[164:167]
v_lshl_or_b32 v4, v5, 1, v4
v_bfe_u32 v5, v2, 2, 1
s_waitcnt vmcnt(14)
v_mfma_f32_16x16x32_bf16 v[148:151], a[120:123], v[88:91], v[148:151]
buffer_load_dwordx4 v[72:75], v58, s[24:27], s99 offen
s_add_u32 s99, s99, 4096
v_mfma_f32_16x16x32_bf16 v[152:155], a[124:127], v[88:91], v[152:155]
v_or_b32 v4, v4, v5
s_lshl_b32 s6, s94, 6
v_mfma_f32_16x16x32_bf16 v[156:159], a[128:131], v[88:91], v[156:159]
s_lshl_b32 s7, s5, 4
s_add_u32 s6, s6, s7
v_mfma_f32_16x16x32_bf16 v[160:163], a[132:135], v[88:91], v[160:163]
s_add_u32 m0, s83, 1088
s_mov_b64 exec, s[86:87]
buffer_load_dwordx4 v53, s[8:11], 0 offen lds
s_mov_b64 exec, -1
v_mfma_f32_16x16x32_bf16 v[164:167], a[136:139], v[88:91], v[164:167]
v_add_u32 v5, s6, v4
v_lshlrev_b32 v5, 4, v5
s_waitcnt vmcnt(15)
v_mfma_f32_16x16x32_bf16 v[148:151], a[140:143], v[92:95], v[148:151]
buffer_load_dwordx4 v[76:79], v58, s[24:27], s99 offen
s_add_u32 s99, s99, 4096
v_mfma_f32_16x16x32_bf16 v[152:155], a[144:147], v[92:95], v[152:155]
v_lshrrev_b32 v3, 2, v4
v_mul_u32_u24 v3, 1088, v3
v_mfma_f32_16x16x32_bf16 v[156:159], a[148:151], v[92:95], v[156:159]
v_and_b32 v4, 3, v4
v_lshl_add_u32 v3, v4, 8, v3
v_mfma_f32_16x16x32_bf16 v[160:163], a[152:155], v[92:95], v[160:163]
s_add_u32 m0, s83, 2176
s_mov_b64 exec, s[86:87]
buffer_load_dwordx4 v54, s[8:11], 0 offen lds
s_mov_b64 exec, -1
v_mfma_f32_16x16x32_bf16 v[164:167], a[156:159], v[92:95], v[164:167]
v_lshrrev_b32 v4, 4, v1
v_mul_u32_u24 v4, 40, v4
s_waitcnt vmcnt(16)
v_mfma_f32_16x16x32_bf16 v[148:151], a[160:163], v[96:99], v[148:151]
buffer_load_dwordx4 v[80:83], v58, s[24:27], s99 offen
s_add_u32 s99, s99, 4096
v_mfma_f32_16x16x32_bf16 v[152:155], a[164:167], v[96:99], v[152:155]
v_add_u32 v3, v3, v4
s_and_b32 s6, s95, 1
v_mfma_f32_16x16x32_bf16 v[156:159], a[168:171], v[96:99], v[156:159]
s_lshl_b32 s6, s6, 5
s_add_u32 s6, s6, s83
v_mfma_f32_16x16x32_bf16 v[160:163], a[172:175], v[96:99], v[160:163]
s_add_u32 m0, s83, 3264
s_mov_b64 exec, s[86:87]
buffer_load_dwordx4 v55, s[8:11], 0 offen lds
s_mov_b64 exec, -1
v_mfma_f32_16x16x32_bf16 v[164:167], a[176:179], v[96:99], v[164:167]
v_add_u32 v7, s6, v3
s_waitcnt vmcnt(17)
v_mfma_f32_16x16x32_bf16 v[148:151], a[180:183], v[100:103], v[148:151]
buffer_load_dwordx4 v[84:87], v58, s[24:27], s99 offen
s_add_u32 s99, s99, 4096
v_mfma_f32_16x16x32_bf16 v[152:155], a[184:187], v[100:103], v[152:155]
v_mfma_f32_16x16x32_bf16 v[156:159], a[188:191], v[100:103], v[156:159]
v_mfma_f32_16x16x32_bf16 v[160:163], a[192:195], v[100:103], v[160:163]
s_mov_b32 s7, 98304
buffer_load_dwordx2 v[18:19], v5, s[24:27], s7 offen
v_mfma_f32_16x16x32_bf16 v[164:167], a[196:199], v[100:103], v[164:167]
s_waitcnt vmcnt(18)
v_mfma_f32_16x16x32_bf16 v[148:151], a[200:203], v[104:107], v[148:151]
buffer_load_dwordx4 v[88:91], v58, s[24:27], s99 offen
s_add_u32 s99, s99, 4096
v_mfma_f32_16x16x32_bf16 v[152:155], a[204:207], v[104:107], v[152:155]
v_accvgpr_read_b32 v2, a240
v_mfma_f32_16x16x32_bf16 v[156:159], a[208:211], v[104:107], v[156:159]
v_lshlrev_b32 v128, 16, v2
v_mfma_f32_16x16x32_bf16 v[160:163], a[212:215], v[104:107], v[160:163]
v_and_b32 v129, 0xffff0000, v2
v_mfma_f32_16x16x32_bf16 v[164:167], a[216:219], v[104:107], v[164:167]
v_accvgpr_read_b32 v3, a241
s_waitcnt vmcnt(18)
v_mfma_f32_16x16x32_bf16 v[148:151], a[220:223], v[108:111], v[148:151]
buffer_load_dwordx4 v[92:95], v58, s[24:27], s99 offen
s_add_u32 s99, s99, 4096
v_mfma_f32_16x16x32_bf16 v[152:155], a[224:227], v[108:111], v[152:155]
v_lshlrev_b32 v130, 16, v3
v_mfma_f32_16x16x32_bf16 v[156:159], a[228:231], v[108:111], v[156:159]
v_mfma_f32_16x16x32_bf16 v[160:163], a[232:235], v[108:111], v[160:163]
v_and_b32 v131, 0xffff0000, v3
v_mfma_f32_16x16x32_bf16 v[164:167], a[236:239], v[108:111], v[164:167]
v_accvgpr_read_b32 v4, a242
s_waitcnt vmcnt(16)
v_mfma_f32_16x16x32_bf16 v[148:151], v[208:211], v[112:115], v[148:151]
buffer_load_dwordx4 v[96:99], v58, s[24:27], s99 offen
s_add_u32 s99, s99, 4096
v_mfma_f32_16x16x32_bf16 v[152:155], v[212:215], v[112:115], v[152:155]
v_lshlrev_b32 v132, 16, v4
v_mfma_f32_16x16x32_bf16 v[156:159], v[216:219], v[112:115], v[156:159]
v_and_b32 v133, 0xffff0000, v4
v_mfma_f32_16x16x32_bf16 v[160:163], v[220:223], v[112:115], v[160:163]
v_accvgpr_read_b32 v5, a243
v_mfma_f32_16x16x32_bf16 v[164:167], v[224:227], v[112:115], v[164:167]
s_cmp_ge_u32 s5, 2
s_cbranch_scc1 L_umskip_36
s_waitcnt vmcnt(16)
v_mfma_f32_16x16x32_bf16 v[148:151], v[228:231], v[116:119], v[148:151]
v_mfma_f32_16x16x32_bf16 v[152:155], v[232:235], v[116:119], v[152:155]
v_mfma_f32_16x16x32_bf16 v[156:159], v[236:239], v[116:119], v[156:159]
v_mfma_f32_16x16x32_bf16 v[160:163], v[240:243], v[116:119], v[160:163]
v_mfma_f32_16x16x32_bf16 v[164:167], v[244:247], v[116:119], v[164:167]
L_umskip_36:
s_waitcnt vmcnt(15)
v_mfma_f32_16x16x32_bf16 v[168:171], a[0:3], v[120:123], 0
buffer_load_dwordx4 v[100:103], v58, s[24:27], s99 offen
s_add_u32 s99, s99, 4096
v_mfma_f32_16x16x32_bf16 v[172:175], a[4:7], v[120:123], 0
s_add_u32 s84, s5, 1
s_and_b32 s84, s84, 3
s_mul_i32 s84, s84, 15360
v_mfma_f32_16x16x32_bf16 v[176:179], a[8:11], v[120:123], 0
buffer_load_dwordx4 v[104:107], v58, s[24:27], s99 offen
s_add_u32 s99, s99, 4096
s_add_u32 s84, s84, 0
v_lshl_add_u32 v60, v1, 3, s84
v_mfma_f32_16x16x32_bf16 v[180:183], a[12:15], v[120:123], 0
v_lshlrev_b32 v134, 16, v5
v_mfma_f32_16x16x32_bf16 v[184:187], a[16:19], v[120:123], 0
v_and_b32 v135, 0xffff0000, v5
s_waitcnt vmcnt(16)
v_mfma_f32_16x16x32_bf16 v[168:171], a[20:23], v[124:127], v[168:171]
buffer_load_dwordx4 v[108:111], v58, s[24:27], s99 offen
s_mov_b32 s99, s81
v_mfma_f32_16x16x32_bf16 v[172:175], a[24:27], v[124:127], v[172:175]
ds_write_b64 v60, v[148:149] offset:0
v_mfma_f32_16x16x32_bf16 v[176:179], a[28:31], v[124:127], v[176:179]
v_accvgpr_read_b32 v2, a244
v_mfma_f32_16x16x32_bf16 v[180:183], a[32:35], v[124:127], v[180:183]
v_lshlrev_b32 v136, 16, v2
v_mfma_f32_16x16x32_bf16 v[184:187], a[36:39], v[124:127], v[184:187]
v_and_b32 v137, 0xffff0000, v2
v_mov_b32 v61, 61440
s_mov_b64 exec, 1
ds_add_rtn_u32 v61, v61, v253
s_mov_b64 exec, -1
s_waitcnt vmcnt(16)
v_mfma_f32_16x16x32_bf16 v[168:171], a[40:43], v[64:67], v[168:171]
buffer_load_dwordx4 v[112:115], v59, s[24:27], s99 offen
s_add_u32 s99, s99, 4096
v_mfma_f32_16x16x32_bf16 v[172:175], a[44:47], v[64:67], v[172:175]
ds_write_b64 v60, v[150:151] offset:512
v_mfma_f32_16x16x32_bf16 v[176:179], a[48:51], v[64:67], v[176:179]
v_mfma_f32_16x16x32_bf16 v[180:183], a[52:55], v[64:67], v[180:183]
v_accvgpr_read_b32 v3, a245
v_mfma_f32_16x16x32_bf16 v[184:187], a[56:59], v[64:67], v[184:187]
v_lshlrev_b32 v138, 16, v3
s_waitcnt vmcnt(16)
v_mfma_f32_16x16x32_bf16 v[168:171], a[60:63], v[68:71], v[168:171]
buffer_load_dwordx4 v[116:119], v59, s[24:27], s99 offen
s_add_u32 s99, s99, 4096
v_mfma_f32_16x16x32_bf16 v[172:175], a[64:67], v[68:71], v[172:175]
v_and_b32 v139, 0xffff0000, v3
v_mfma_f32_16x16x32_bf16 v[176:179], a[68:71], v[68:71], v[176:179]
ds_write_b64 v60, v[152:153] offset:1024
v_mfma_f32_16x16x32_bf16 v[180:183], a[72:75], v[68:71], v[180:183]
v_accvgpr_read_b32 v4, a246
v_mfma_f32_16x16x32_bf16 v[184:187], a[76:79], v[68:71], v[184:187]
v_lshlrev_b32 v140, 16, v4
s_waitcnt lgkmcnt(2)
v_readfirstlane_b32 s6, v61
s_cmp_lg_u32 s6, 3
s_cbranch_scc1 L_yfl_37
s_mov_b64 exec, 1
buffer_store_dword v253, v252, s[24:27], 0 offen offset:20 sc1
s_mov_b64 exec, -1
L_yfl_37:
s_waitcnt vmcnt(15)
v_mfma_f32_16x16x32_bf16 v[168:171], a[80:83], v[72:75], v[168:171]
buffer_load_dwordx4 v[120:123], v59, s[24:27], s99 offen
s_add_u32 s99, s99, 4096
v_mfma_f32_16x16x32_bf16 v[172:175], a[84:87], v[72:75], v[172:175]
v_mfma_f32_16x16x32_bf16 v[176:179], a[88:91], v[72:75], v[176:179]
v_and_b32 v141, 0xffff0000, v4
v_mfma_f32_16x16x32_bf16 v[180:183], a[92:95], v[72:75], v[180:183]
ds_write_b64 v60, v[154:155] offset:1536
v_mfma_f32_16x16x32_bf16 v[184:187], a[96:99], v[72:75], v[184:187]
v_accvgpr_read_b32 v5, a247
s_waitcnt vmcnt(14)
v_mfma_f32_16x16x32_bf16 v[168:171], a[100:103], v[76:79], v[168:171]
buffer_load_dwordx4 v[124:127], v59, s[24:27], s99 offen
s_add_u32 s99, s99, 4096
v_mfma_f32_16x16x32_bf16 v[172:175], a[104:107], v[76:79], v[172:175]
v_lshlrev_b32 v142, 16, v5
v_mfma_f32_16x16x32_bf16 v[176:179], a[108:111], v[76:79], v[176:179]
v_and_b32 v143, 0xffff0000, v5
v_mfma_f32_16x16x32_bf16 v[180:183], a[112:115], v[76:79], v[180:183]
v_accvgpr_read_b32 v2, a248
v_mfma_f32_16x16x32_bf16 v[184:187], a[116:119], v[76:79], v[184:187]
ds_write_b64 v60, v[156:157] offset:2048
s_waitcnt vmcnt(13)
v_mfma_f32_16x16x32_bf16 v[168:171], a[120:123], v[80:83], v[168:171]
buffer_load_dwordx4 v[64:67], v59, s[24:27], s99 offen
s_add_u32 s99, s99, 4096
v_mfma_f32_16x16x32_bf16 v[172:175], a[124:127], v[80:83], v[172:175]
v_mfma_f32_16x16x32_bf16 v[176:179], a[128:131], v[80:83], v[176:179]
v_lshlrev_b32 v144, 16, v2
v_mfma_f32_16x16x32_bf16 v[180:183], a[132:135], v[80:83], v[180:183]
v_and_b32 v145, 0xffff0000, v2
v_mfma_f32_16x16x32_bf16 v[184:187], a[136:139], v[80:83], v[184:187]
v_accvgpr_read_b32 v3, a249
s_waitcnt vmcnt(12)
v_mfma_f32_16x16x32_bf16 v[168:171], a[140:143], v[84:87], v[168:171]
buffer_load_dwordx4 v[68:71], v59, s[24:27], s99 offen
s_add_u32 s99, s99, 4096
v_mfma_f32_16x16x32_bf16 v[172:175], a[144:147], v[84:87], v[172:175]
ds_write_b64 v60, v[158:159] offset:2560
v_mfma_f32_16x16x32_bf16 v[176:179], a[148:151], v[84:87], v[176:179]
v_lshlrev_b32 v146, 16, v3
v_mfma_f32_16x16x32_bf16 v[180:183], a[152:155], v[84:87], v[180:183]
v_and_b32 v147, 0xffff0000, v3
v_mfma_f32_16x16x32_bf16 v[184:187], a[156:159], v[84:87], v[184:187]
s_waitcnt vmcnt(11)
v_mfma_f32_16x16x32_bf16 v[168:171], a[160:163], v[88:91], v[168:171]
buffer_load_dwordx4 v[72:75], v59, s[24:27], s99 offen
s_add_u32 s99, s99, 4096
v_mfma_f32_16x16x32_bf16 v[172:175], a[164:167], v[88:91], v[172:175]
ds_write_b64 v60, v[160:161] offset:3072
v_mfma_f32_16x16x32_bf16 v[176:179], a[168:171], v[88:91], v[176:179]
s_mul_i32 s82, s5, 15360
s_add_u32 s82, s82, 0
v_mfma_f32_16x16x32_bf16 v[180:183], a[172:175], v[88:91], v[180:183]
v_lshl_add_u32 v62, v1, 3, s82
v_mfma_f32_16x16x32_bf16 v[184:187], a[176:179], v[88:91], v[184:187]
v_lshrrev_b32 v2, 4, v1
v_mul_u32_u24 v2, 20, v2
s_waitcnt vmcnt(11)
v_mfma_f32_16x16x32_bf16 v[168:171], a[180:183], v[92:95], v[168:171]
buffer_load_dwordx4 v[76:79], v59, s[24:27], s99 offen
s_add_u32 s99, s99, 4096
v_mfma_f32_16x16x32_bf16 v[172:175], a[184:187], v[92:95], v[172:175]
v_bfe_u32 v3, v1, 2, 2
v_mfma_f32_16x16x32_bf16 v[176:179], a[188:191], v[92:95], v[176:179]
ds_write_b64 v60, v[162:163] offset:3584
v_mfma_f32_16x16x32_bf16 v[180:183], a[192:195], v[92:95], v[180:183]
v_add_u32 v2, v2, v3
v_lshlrev_b32 v2, 7, v2
v_mfma_f32_16x16x32_bf16 v[184:187], a[196:199], v[92:95], v[184:187]
v_and_b32 v3, 3, v1
s_waitcnt vmcnt(11)
v_mfma_f32_16x16x32_bf16 v[168:171], a[200:203], v[96:99], v[168:171]
buffer_load_dwordx4 v[80:83], v59, s[24:27], s99 offen
s_add_u32 s99, s99, 4096
v_mfma_f32_16x16x32_bf16 v[172:175], a[204:207], v[96:99], v[172:175]
ds_read_b64 v[8:9], v7 offset:0
ds_read_b64 v[10:11], v7 offset:8
v_mfma_f32_16x16x32_bf16 v[176:179], a[208:211], v[96:99], v[176:179]
ds_read_b64 v[12:13], v7 offset:16
ds_read_b64 v[14:15], v7 offset:24
v_mfma_f32_16x16x32_bf16 v[180:183], a[212:215], v[96:99], v[180:183]
ds_write_b64 v60, v[164:165] offset:4096
v_mfma_f32_16x16x32_bf16 v[184:187], a[216:219], v[96:99], v[184:187]
ds_read_b64 v[16:17], v7 offset:32
v_lshl_add_u32 v2, v3, 4, v2
s_waitcnt vmcnt(11)
v_mfma_f32_16x16x32_bf16 v[168:171], a[220:223], v[100:103], v[168:171]
buffer_load_dwordx4 v[84:87], v59, s[24:27], s99 offen
s_add_u32 s99, s99, 4096
v_mfma_f32_16x16x32_bf16 v[172:175], a[224:227], v[100:103], v[172:175]
s_and_b32 s82, s5, 1
v_mfma_f32_16x16x32_bf16 v[176:179], a[228:231], v[100:103], v[176:179]
s_lshl_b32 s82, s82, 6
v_mfma_f32_16x16x32_bf16 v[180:183], a[232:235], v[100:103], v[180:183]
s_lshr_b32 s83, s5, 1
s_lshl_b32 s83, s83, 3
v_mfma_f32_16x16x32_bf16 v[184:187], a[236:239], v[100:103], v[184:187]
ds_write_b64 v60, v[166:167] offset:4608
s_waitcnt vmcnt(11)
v_mfma_f32_16x16x32_bf16 v[168:171], v[208:211], v[104:107], v[168:171]
buffer_load_dwordx4 v[88:91], v59, s[24:27], s99 offen
s_add_u32 s99, s99, 4096
v_mfma_f32_16x16x32_bf16 v[172:175], v[212:215], v[104:107], v[172:175]
s_add_u32 s82, s82, s83
v_mfma_f32_16x16x32_bf16 v[176:179], v[216:219], v[104:107], v[176:179]
s_add_u32 s82, s82, 61440
v_add_u32 v63, s82, v2
v_mfma_f32_16x16x32_bf16 v[180:183], v[220:223], v[104:107], v[180:183]
v_mov_b32 v48, -1.4426950408889634
v_mfma_f32_16x16x32_bf16 v[184:187], v[224:227], v[104:107], v[184:187]
v_mov_b32 v49, 1.0
s_waitcnt lgkmcnt(1)
s_cmp_ge_u32 s5, 2
s_cbranch_scc1 L_umskip_38
s_waitcnt vmcnt(11)
v_mfma_f32_16x16x32_bf16 v[168:171], v[228:231], v[108:111], v[168:171]
v_mfma_f32_16x16x32_bf16 v[172:175], v[232:235], v[108:111], v[172:175]
v_mfma_f32_16x16x32_bf16 v[176:179], v[236:239], v[108:111], v[176:179]
v_mfma_f32_16x16x32_bf16 v[180:183], v[240:243], v[108:111], v[180:183]
v_mfma_f32_16x16x32_bf16 v[184:187], v[244:247], v[108:111], v[184:187]
L_umskip_38:
s_waitcnt vmcnt(10)
v_mfma_f32_16x16x32_bf16 v[188:191], a[0:3], v[112:115], 0
buffer_load_dwordx4 v[92:95], v59, s[24:27], s99 offen
s_add_u32 s99, s99, 4096
v_mfma_f32_16x16x32_bf16 v[192:195], a[4:7], v[112:115], 0
s_add_u32 s84, s5, 2
s_and_b32 s84, s84, 3
s_mul_i32 s84, s84, 15360
v_mfma_f32_16x16x32_bf16 v[196:199], a[8:11], v[112:115], 0
buffer_load_dwordx4 v[96:99], v59, s[24:27], s99 offen
s_add_u32 s99, s99, 4096
s_add_u32 s84, s84, 5120
v_lshl_add_u32 v60, v1, 3, s84
v_mfma_f32_16x16x32_bf16 v[200:203], a[12:15], v[112:115], 0
v_mul_f32 v6, v18, v19
v_mov_b32 v7, v19
v_mfma_f32_16x16x32_bf16 v[204:207], a[16:19], v[112:115], 0
v_sub_f32 v6, 0, v6
s_waitcnt vmcnt(11)
v_mfma_f32_16x16x32_bf16 v[188:191], a[20:23], v[116:119], v[188:191]
buffer_load_dwordx4 v[100:103], v59, s[24:27], s99 offen
s_mov_b32 s99, s81
v_mfma_f32_16x16x32_bf16 v[192:195], a[24:27], v[116:119], v[192:195]
ds_write_b64 v60, v[168:169] offset:0
v_mfma_f32_16x16x32_bf16 v[196:199], a[28:31], v[116:119], v[196:199]
v_lshlrev_b32 v40, 16, v8
v_and_b32 v41, 0xffff0000, v8
v_mfma_f32_16x16x32_bf16 v[200:203], a[32:35], v[116:119], v[200:203]
v_lshlrev_b32 v42, 16, v9
v_mfma_f32_16x16x32_bf16 v[204:207], a[36:39], v[116:119], v[204:207]
v_and_b32 v43, 0xffff0000, v9
v_lshlrev_b32 v44, 16, v10
s_waitcnt vmcnt(11)
v_mfma_f32_16x16x32_bf16 v[188:191], a[40:43], v[120:123], v[188:191]
buffer_load_dwordx4 v[104:107], v56, s[24:27], s99 offen
s_add_u32 s99, s99, 4096
v_mfma_f32_16x16x32_bf16 v[192:195], a[44:47], v[120:123], v[192:195]
ds_write_b64 v60, v[170:171] offset:512
v_mfma_f32_16x16x32_bf16 v[196:199], a[48:51], v[120:123], v[196:199]
v_and_b32 v45, 0xffff0000, v10
v_mfma_f32_16x16x32_bf16 v[200:203], a[52:55], v[120:123], v[200:203]
v_lshlrev_b32 v46, 16, v11
v_and_b32 v47, 0xffff0000, v11
v_mfma_f32_16x16x32_bf16 v[204:207], a[56:59], v[120:123], v[204:207]
v_lshlrev_b32 v28, 16, v12
s_waitcnt vmcnt(11)
v_mfma_f32_16x16x32_bf16 v[188:191], a[60:63], v[124:127], v[188:191]
buffer_load_dwordx4 v[108:111], v56, s[24:27], s99 offen
s_add_u32 s99, s99, 4096
v_mfma_f32_16x16x32_bf16 v[192:195], a[64:67], v[124:127], v[192:195]
v_and_b32 v29, 0xffff0000, v12
v_mfma_f32_16x16x32_bf16 v[196:199], a[68:71], v[124:127], v[196:199]
ds_write_b64 v60, v[172:173] offset:1024
v_mfma_f32_16x16x32_bf16 v[200:203], a[72:75], v[124:127], v[200:203]
v_lshlrev_b32 v30, 16, v13
v_and_b32 v31, 0xffff0000, v13
v_mfma_f32_16x16x32_bf16 v[204:207], a[76:79], v[124:127], v[204:207]
v_lshlrev_b32 v32, 16, v14
s_waitcnt vmcnt(11)
v_mfma_f32_16x16x32_bf16 v[188:191], a[80:83], v[64:67], v[188:191]
buffer_load_dwordx4 v[112:115], v56, s[24:27], s99 offen
s_add_u32 s99, s99, 4096
v_mfma_f32_16x16x32_bf16 v[192:195], a[84:87], v[64:67], v[192:195]
v_and_b32 v33, 0xffff0000, v14
v_lshlrev_b32 v34, 16, v15
v_mfma_f32_16x16x32_bf16 v[196:199], a[88:91], v[64:67], v[196:199]
v_and_b32 v35, 0xffff0000, v15
v_mfma_f32_16x16x32_bf16 v[200:203], a[92:95], v[64:67], v[200:203]
ds_write_b64 v60, v[174:175] offset:1536
v_mfma_f32_16x16x32_bf16 v[204:207], a[96:99], v[64:67], v[204:207]
v_lshlrev_b32 v36, 16, v16
v_and_b32 v37, 0xffff0000, v16
s_waitcnt vmcnt(11)
v_mfma_f32_16x16x32_bf16 v[188:191], a[100:103], v[68:71], v[188:191]
buffer_load_dwordx4 v[116:119], v56, s[24:27], s99 offen
s_add_u32 s99, s99, 4096
v_mfma_f32_16x16x32_bf16 v[192:195], a[104:107], v[68:71], v[192:195]
v_lshlrev_b32 v38, 16, v17
v_mfma_f32_16x16x32_bf16 v[196:199], a[108:111], v[68:71], v[196:199]
v_and_b32 v39, 0xffff0000, v17
v_mfma_f32_16x16x32_bf16 v[200:203], a[112:115], v[68:71], v[200:203]
v_fma_f32 v20, v40, v7, v6
v_fma_f32 v21, v41, v7, v6
v_mfma_f32_16x16x32_bf16 v[204:207], a[116:119], v[68:71], v[204:207]
ds_write_b64 v60, v[176:177] offset:2048
s_waitcnt vmcnt(11)
v_mfma_f32_16x16x32_bf16 v[188:191], a[120:123], v[72:75], v[188:191]
buffer_load_dwordx4 v[120:123], v56, s[24:27], s99 offen
s_add_u32 s99, s99, 4096
v_mfma_f32_16x16x32_bf16 v[192:195], a[124:127], v[72:75], v[192:195]
v_fma_f32 v22, v42, v7, v6
v_mfma_f32_16x16x32_bf16 v[196:199], a[128:131], v[72:75], v[196:199]
v_fma_f32 v23, v43, v7, v6
v_fma_f32 v24, v44, v7, v6
v_mfma_f32_16x16x32_bf16 v[200:203], a[132:135], v[72:75], v[200:203]
v_fma_f32 v25, v45, v7, v6
v_mfma_f32_16x16x32_bf16 v[204:207], a[136:139], v[72:75], v[204:207]
v_fma_f32 v26, v46, v7, v6
v_fma_f32 v27, v47, v7, v6
s_cmp_lg_u32 s5, 0
s_cbranch_scc1 L_ypl_39
buffer_load_dword v254, v250, s[24:27], 0 offen sc1
L_ypl_39:
s_waitcnt vmcnt(11)
v_mfma_f32_16x16x32_bf16 v[188:191], a[140:143], v[76:79], v[188:191]
buffer_load_dwordx4 v[124:127], v56, s[24:27], s99 offen
s_add_u32 s99, s99, 4096
v_mfma_f32_16x16x32_bf16 v[192:195], a[144:147], v[76:79], v[192:195]
ds_write_b64 v60, v[178:179] offset:2560
v_mfma_f32_16x16x32_bf16 v[196:199], a[148:151], v[76:79], v[196:199]
v_fma_f32 v28, v28, v7, v6
v_mfma_f32_16x16x32_bf16 v[200:203], a[152:155], v[76:79], v[200:203]
v_fma_f32 v29, v29, v7, v6
v_mfma_f32_16x16x32_bf16 v[204:207], a[156:159], v[76:79], v[204:207]
v_fma_f32 v30, v30, v7, v6
v_fma_f32 v31, v31, v7, v6
s_waitcnt vmcnt(11)
v_mfma_f32_16x16x32_bf16 v[188:191], a[160:163], v[80:83], v[188:191]
buffer_load_dwordx4 v[64:67], v56, s[24:27], s99 offen
s_add_u32 s99, s99, 4096
v_mfma_f32_16x16x32_bf16 v[192:195], a[164:167], v[80:83], v[192:195]
ds_write_b64 v60, v[180:181] offset:3072
v_mfma_f32_16x16x32_bf16 v[196:199], a[168:171], v[80:83], v[196:199]
v_fma_f32 v32, v32, v7, v6
v_mfma_f32_16x16x32_bf16 v[200:203], a[172:175], v[80:83], v[200:203]
v_fma_f32 v33, v33, v7, v6
v_fma_f32 v34, v34, v7, v6
v_mfma_f32_16x16x32_bf16 v[204:207], a[176:179], v[80:83], v[204:207]
v_fma_f32 v35, v35, v7, v6
s_waitcnt vmcnt(11)
v_mfma_f32_16x16x32_bf16 v[188:191], a[180:183], v[84:87], v[188:191]
buffer_load_dwordx4 v[68:71], v56, s[24:27], s99 offen
s_add_u32 s99, s99, 4096
v_mfma_f32_16x16x32_bf16 v[192:195], a[184:187], v[84:87], v[192:195]
v_fma_f32 v36, v36, v7, v6
v_fma_f32 v37, v37, v7, v6
v_mfma_f32_16x16x32_bf16 v[196:199], a[188:191], v[84:87], v[196:199]
ds_write_b64 v60, v[182:183] offset:3584
v_mfma_f32_16x16x32_bf16 v[200:203], a[192:195], v[84:87], v[200:203]
v_fma_f32 v38, v38, v7, v6
v_lshrrev_b32 v2, 3, v1
v_mfma_f32_16x16x32_bf16 v[204:207], a[196:199], v[84:87], v[204:207]
v_fma_f32 v39, v39, v7, v6
v_and_b32 v3, 7, v1
s_waitcnt vmcnt(11)
v_mfma_f32_16x16x32_bf16 v[188:191], a[200:203], v[88:91], v[188:191]
buffer_load_dwordx4 v[72:75], v56, s[24:27], s99 offen
s_add_u32 s99, s99, 4096
v_mfma_f32_16x16x32_bf16 v[192:195], a[204:207], v[88:91], v[192:195]
v_lshlrev_b32 v3, 4, v3
v_mfma_f32_16x16x32_bf16 v[196:199], a[208:211], v[88:91], v[196:199]
v_lshl_add_u32 v61, v2, 12, v3
s_mul_i32 s90, s95, 80
v_mfma_f32_16x16x32_bf16 v[200:203], a[212:215], v[88:91], v[200:203]
ds_write_b64 v60, v[184:185] offset:4096
v_mfma_f32_16x16x32_bf16 v[204:207], a[216:219], v[88:91], v[204:207]
s_lshl_b32 s91, s5, 3
s_waitcnt vmcnt(11)
v_mfma_f32_16x16x32_bf16 v[188:191], a[220:223], v[92:95], v[188:191]
buffer_load_dwordx4 v[76:79], v56, s[24:27], s99 offen
s_add_u32 s99, s99, 4096
v_mfma_f32_16x16x32_bf16 v[192:195], a[224:227], v[92:95], v[192:195]
s_add_u32 s90, s90, s91
v_mfma_f32_16x16x32_bf16 v[196:199], a[228:231], v[92:95], v[196:199]
s_lshl_b32 s90, s90, 12
s_lshl_b32 s91, s94, 7
v_mfma_f32_16x16x32_bf16 v[200:203], a[232:235], v[92:95], v[200:203]
s_add_u32 s90, s90, s91
v_mfma_f32_16x16x32_bf16 v[204:207], a[236:239], v[92:95], v[204:207]
ds_write_b64 v60, v[186:187] offset:4608
s_waitcnt vmcnt(11)
v_mfma_f32_16x16x32_bf16 v[188:191], v[208:211], v[96:99], v[188:191]
buffer_load_dwordx4 v[80:83], v56, s[24:27], s99 offen
s_add_u32 s99, s99, 4096
v_mfma_f32_16x16x32_bf16 v[192:195], v[212:215], v[96:99], v[192:195]
s_add_u32 s90, s90, 4194304
s_lshl_b32 s91, s5, 14
v_mfma_f32_16x16x32_bf16 v[196:199], v[216:219], v[96:99], v[196:199]
s_sub_u32 s88, s90, s91
v_mfma_f32_16x16x32_bf16 v[200:203], v[220:223], v[96:99], v[200:203]
s_add_u32 s88, s88, 262144
v_mfma_f32_16x16x32_bf16 v[204:207], v[224:227], v[96:99], v[204:207]
s_lshl_b32 s89, s5, 9
s_add_u32 s89, s89, 69632
s_cmp_ge_u32 s5, 2
s_cbranch_scc1 L_umskip_40
s_waitcnt vmcnt(11)
v_mfma_f32_16x16x32_bf16 v[188:191], v[228:231], v[100:103], v[188:191]
v_mfma_f32_16x16x32_bf16 v[192:195], v[232:235], v[100:103], v[192:195]
v_mfma_f32_16x16x32_bf16 v[196:199], v[236:239], v[100:103], v[196:199]
v_mfma_f32_16x16x32_bf16 v[200:203], v[240:243], v[100:103], v[200:203]
v_mfma_f32_16x16x32_bf16 v[204:207], v[244:247], v[100:103], v[204:207]
L_umskip_40:
s_waitcnt vmcnt(10)
v_mfma_f32_16x16x32_bf16 v[128:131], a[0:3], v[104:107], v[128:131]
buffer_load_dwordx4 v[84:87], v56, s[24:27], s99 offen
s_add_u32 s99, s99, 4096
v_mfma_f32_16x16x32_bf16 v[132:135], a[4:7], v[104:107], v[132:135]
s_add_u32 s84, s5, 3
s_and_b32 s84, s84, 3
s_mul_i32 s84, s84, 15360
v_mfma_f32_16x16x32_bf16 v[136:139], a[8:11], v[104:107], v[136:139]
buffer_load_dwordx4 v[88:91], v56, s[24:27], s99 offen
s_add_u32 s99, s99, 4096
s_add_u32 s84, s84, 10240
v_lshl_add_u32 v60, v1, 3, s84
v_mfma_f32_16x16x32_bf16 v[140:143], a[12:15], v[104:107], v[140:143]
s_lshl_b32 s91, s5, 10
v_mfma_f32_16x16x32_bf16 v[144:147], a[16:19], v[104:107], v[144:147]
s_add_u32 s91, s91, 61440
s_barrier
s_waitcnt vmcnt(11)
v_mfma_f32_16x16x32_bf16 v[128:131], a[20:23], v[108:111], v[128:131]
buffer_load_dwordx4 v[92:95], v56, s[24:27], s99 offen
s_mov_b32 s99, s81
v_mfma_f32_16x16x32_bf16 v[132:135], a[24:27], v[108:111], v[132:135]
ds_write_b64 v60, v[188:189] offset:0
v_mfma_f32_16x16x32_bf16 v[136:139], a[28:31], v[108:111], v[136:139]
ds_write_b64 v60, v[190:191] offset:512
v_mfma_f32_16x16x32_bf16 v[140:143], a[32:35], v[108:111], v[140:143]
v_mfma_f32_16x16x32_bf16 v[144:147], a[36:39], v[108:111], v[144:147]
ds_write_b64 v60, v[192:193] offset:1024
s_waitcnt vmcnt(11)
v_mfma_f32_16x16x32_bf16 v[128:131], a[40:43], v[112:115], v[128:131]
v_lshlrev_b32 v96, 16, v12
v_mfma_f32_16x16x32_bf16 v[132:135], a[44:47], v[112:115], v[132:135]
ds_write_b64 v60, v[194:195] offset:1536
v_mfma_f32_16x16x32_bf16 v[136:139], a[48:51], v[112:115], v[136:139]
v_and_b32 v97, 0xffff0000, v12
v_mfma_f32_16x16x32_bf16 v[140:143], a[52:55], v[112:115], v[140:143]
ds_write_b64 v60, v[196:197] offset:2048
v_mfma_f32_16x16x32_bf16 v[144:147], a[56:59], v[112:115], v[144:147]
v_lshlrev_b32 v98, 16, v13
s_waitcnt vmcnt(10)
v_mfma_f32_16x16x32_bf16 v[128:131], a[60:63], v[116:119], v[128:131]
v_and_b32 v99, 0xffff0000, v13
v_mfma_f32_16x16x32_bf16 v[132:135], a[64:67], v[116:119], v[132:135]
ds_write_b64 v60, v[198:199] offset:2560
v_mfma_f32_16x16x32_bf16 v[136:139], a[68:71], v[116:119], v[136:139]
ds_write_b64 v60, v[200:201] offset:3072
v_mfma_f32_16x16x32_bf16 v[140:143], a[72:75], v[116:119], v[140:143]
v_lshlrev_b32 v100, 16, v14
v_mfma_f32_16x16x32_bf16 v[144:147], a[76:79], v[116:119], v[144:147]
ds_write_b64 v60, v[202:203] offset:3584
s_waitcnt vmcnt(9)
v_mfma_f32_16x16x32_bf16 v[128:131], a[80:83], v[120:123], v[128:131]
v_and_b32 v101, 0xffff0000, v14
v_mfma_f32_16x16x32_bf16 v[132:135], a[84:87], v[120:123], v[132:135]
ds_write_b64 v60, v[204:205] offset:4096
v_mfma_f32_16x16x32_bf16 v[136:139], a[88:91], v[120:123], v[136:139]
v_lshlrev_b32 v102, 16, v15
v_mfma_f32_16x16x32_bf16 v[140:143], a[92:95], v[120:123], v[140:143]
ds_write_b64 v60, v[206:207] offset:4608
v_mfma_f32_16x16x32_bf16 v[144:147], a[96:99], v[120:123], v[144:147]
v_and_b32 v103, 0xffff0000, v15
s_waitcnt vmcnt(8)
v_mfma_f32_16x16x32_bf16 v[128:131], a[100:103], v[124:127], v[128:131]
v_lshlrev_b32 v104, 16, v16
v_mfma_f32_16x16x32_bf16 v[132:135], a[104:107], v[124:127], v[132:135]
v_and_b32 v105, 0xffff0000, v16
v_mfma_f32_16x16x32_bf16 v[136:139], a[108:111], v[124:127], v[136:139]
v_lshlrev_b32 v106, 16, v17
v_mfma_f32_16x16x32_bf16 v[140:143], a[112:115], v[124:127], v[140:143]
v_and_b32 v107, 0xffff0000, v17
v_mfma_f32_16x16x32_bf16 v[144:147], a[116:119], v[124:127], v[144:147]
s_cmp_lg_u32 s5, 0
s_cbranch_scc1 L_back_42
s_waitcnt vmcnt(9)
v_cmp_eq_u32 vcc, 0, v254
s_cbranch_vccnz L_slow_41
L_back_42:
s_waitcnt lgkmcnt(0)
s_barrier
s_mov_b32 m0, s91
s_add_u32 s91, s91, 4096
buffer_load_dwordx4 v61, s[24:27], s90 offen lds
s_add_u32 s90, s90, 131072
s_mov_b32 m0, s91
s_add_u32 s91, s91, 4096
buffer_load_dwordx4 v61, s[24:27], s90 offen lds
s_add_u32 s90, s90, 131072
s_mov_b32 m0, s89
s_mov_b32 exec_hi, 0
buffer_load_dwordx4 v61, s[24:27], s88 offen lds
s_mov_b32 exec_hi, -1
s_waitcnt vmcnt(10)
v_mfma_f32_16x16x32_bf16 v[128:131], a[120:123], v[64:67], v[128:131]
ds_read2st64_b64 v[148:151], v62 offset0:0 offset1:1
ds_read2st64_b64 v[152:155], v62 offset0:2 offset1:3
v_mfma_f32_16x16x32_bf16 v[132:135], a[124:127], v[64:67], v[132:135]
ds_read2st64_b64 v[156:159], v62 offset0:4 offset1:5
v_mfma_f32_16x16x32_bf16 v[136:139], a[128:131], v[64:67], v[136:139]
ds_read2st64_b64 v[160:163], v62 offset0:6 offset1:7
ds_read2st64_b64 v[164:167], v62 offset0:8 offset1:9
v_mfma_f32_16x16x32_bf16 v[140:143], a[132:135], v[64:67], v[140:143]
ds_read2st64_b64 v[168:171], v62 offset0:10 offset1:11
v_mfma_f32_16x16x32_bf16 v[144:147], a[136:139], v[64:67], v[144:147]
ds_read2st64_b64 v[172:175], v62 offset0:12 offset1:13
ds_read2st64_b64 v[176:179], v62 offset0:14 offset1:15
s_waitcnt vmcnt(9)
v_mfma_f32_16x16x32_bf16 v[128:131], a[140:143], v[68:71], v[128:131]
ds_read2st64_b64 v[180:183], v62 offset0:16 offset1:17
v_mfma_f32_16x16x32_bf16 v[132:135], a[144:147], v[68:71], v[132:135]
ds_read2st64_b64 v[184:187], v62 offset0:18 offset1:19
ds_read2st64_b64 v[188:191], v62 offset0:20 offset1:21
v_mfma_f32_16x16x32_bf16 v[136:139], a[148:151], v[68:71], v[136:139]
ds_read2st64_b64 v[192:195], v62 offset0:22 offset1:23
v_mfma_f32_16x16x32_bf16 v[140:143], a[152:155], v[68:71], v[140:143]
ds_read2st64_b64 v[196:199], v62 offset0:24 offset1:25
ds_read2st64_b64 v[200:203], v62 offset0:26 offset1:27
v_mfma_f32_16x16x32_bf16 v[144:147], a[156:159], v[68:71], v[144:147]
ds_read2st64_b64 v[204:207], v62 offset0:28 offset1:29
s_waitcnt vmcnt(8)
v_mfma_f32_16x16x32_bf16 v[128:131], a[160:163], v[72:75], v[128:131]
v_mfma_f32_16x16x32_bf16 v[132:135], a[164:167], v[72:75], v[132:135]
v_mfma_f32_16x16x32_bf16 v[136:139], a[168:171], v[72:75], v[136:139]
v_mfma_f32_16x16x32_bf16 v[140:143], a[172:175], v[72:75], v[140:143]
v_mfma_f32_16x16x32_bf16 v[144:147], a[176:179], v[72:75], v[144:147]
s_waitcnt lgkmcnt(5)
s_waitcnt vmcnt(7)
v_mfma_f32_16x16x32_bf16 v[128:131], a[180:183], v[76:79], v[128:131]
v_add_f32 v148, v148, v168
v_add_f32 v149, v149, v169
v_mfma_f32_16x16x32_bf16 v[132:135], a[184:187], v[76:79], v[132:135]
v_add_f32 v150, v150, v170
v_add_f32 v151, v151, v171
v_mfma_f32_16x16x32_bf16 v[136:139], a[188:191], v[76:79], v[136:139]
v_add_f32 v152, v152, v172
v_add_f32 v153, v153, v173
v_mfma_f32_16x16x32_bf16 v[140:143], a[192:195], v[76:79], v[140:143]
v_add_f32 v154, v154, v174
v_add_f32 v155, v155, v175
v_mfma_f32_16x16x32_bf16 v[144:147], a[196:199], v[76:79], v[144:147]
v_add_f32 v156, v156, v176
v_add_f32 v157, v157, v177
s_waitcnt vmcnt(6)
v_mfma_f32_16x16x32_bf16 v[128:131], a[200:203], v[80:83], v[128:131]
v_add_f32 v158, v158, v178
v_add_f32 v159, v159, v179
v_mfma_f32_16x16x32_bf16 v[132:135], a[204:207], v[80:83], v[132:135]
v_add_f32 v160, v160, v180
v_add_f32 v161, v161, v181
v_mfma_f32_16x16x32_bf16 v[136:139], a[208:211], v[80:83], v[136:139]
v_add_f32 v162, v162, v182
v_add_f32 v163, v163, v183
v_mfma_f32_16x16x32_bf16 v[140:143], a[212:215], v[80:83], v[140:143]
v_add_f32 v164, v164, v184
v_add_f32 v165, v165, v185
v_mfma_f32_16x16x32_bf16 v[144:147], a[216:219], v[80:83], v[144:147]
v_add_f32 v166, v166, v186
v_add_f32 v167, v167, v187
s_waitcnt lgkmcnt(0)
s_waitcnt vmcnt(5)
v_mfma_f32_16x16x32_bf16 v[128:131], a[220:223], v[84:87], v[128:131]
v_add_f32 v148, v148, v188
v_add_f32 v149, v149, v189
v_mfma_f32_16x16x32_bf16 v[132:135], a[224:227], v[84:87], v[132:135]
v_add_f32 v150, v150, v190
v_add_f32 v151, v151, v191
v_mfma_f32_16x16x32_bf16 v[136:139], a[228:231], v[84:87], v[136:139]
v_add_f32 v152, v152, v192
v_add_f32 v153, v153, v193
v_mfma_f32_16x16x32_bf16 v[140:143], a[232:235], v[84:87], v[140:143]
v_add_f32 v154, v154, v194
v_add_f32 v155, v155, v195
v_mfma_f32_16x16x32_bf16 v[144:147], a[236:239], v[84:87], v[144:147]
v_add_f32 v156, v156, v196
v_add_f32 v157, v157, v197
s_waitcnt vmcnt(4)
v_mfma_f32_16x16x32_bf16 v[128:131], v[208:211], v[88:91], v[128:131]
v_add_f32 v158, v158, v198
v_add_f32 v159, v159, v199
v_mfma_f32_16x16x32_bf16 v[132:135], v[212:215], v[88:91], v[132:135]
v_add_f32 v160, v160, v200
v_add_f32 v161, v161, v201
v_mfma_f32_16x16x32_bf16 v[136:139], v[216:219], v[88:91], v[136:139]
v_add_f32 v162, v162, v202
v_add_f32 v163, v163, v203
v_mfma_f32_16x16x32_bf16 v[140:143], v[220:223], v[88:91], v[140:143]
v_add_f32 v164, v164, v204
v_add_f32 v165, v165, v205
v_mfma_f32_16x16x32_bf16 v[144:147], v[224:227], v[88:91], v[144:147]
v_add_f32 v166, v166, v206
v_add_f32 v167, v167, v207
s_cmp_ge_u32 s5, 2
s_cbranch_scc1 L_umskip_43
s_waitcnt vmcnt(3)
v_mfma_f32_16x16x32_bf16 v[128:131], v[228:231], v[92:95], v[128:131]
v_mfma_f32_16x16x32_bf16 v[132:135], v[232:235], v[92:95], v[132:135]
v_mfma_f32_16x16x32_bf16 v[136:139], v[236:239], v[92:95], v[136:139]
v_mfma_f32_16x16x32_bf16 v[140:143], v[240:243], v[92:95], v[140:143]
v_mfma_f32_16x16x32_bf16 v[144:147], v[244:247], v[92:95], v[144:147]
L_umskip_43:
s_nop 7
v_pk_add_f32 v[128:129], v[128:129], v[148:149]
v_pk_add_f32 v[130:131], v[130:131], v[150:151]
v_pk_add_f32 v[132:133], v[132:133], v[152:153]
v_pk_add_f32 v[134:135], v[134:135], v[154:155]
v_pk_add_f32 v[136:137], v[136:137], v[156:157]
v_pk_add_f32 v[138:139], v[138:139], v[158:159]
v_pk_add_f32 v[140:141], v[140:141], v[160:161]
v_pk_add_f32 v[142:143], v[142:143], v[162:163]
v_pk_add_f32 v[144:145], v[144:145], v[164:165]
v_pk_add_f32 v[146:147], v[146:147], v[166:167]
v_pk_mul_f32 v[64:65], v[128:129], v[48:49] op_sel_hi:[1,0]
v_pk_mul_f32 v[66:67], v[130:131], v[48:49] op_sel_hi:[1,0]
v_pk_mul_f32 v[68:69], v[132:133], v[48:49] op_sel_hi:[1,0]
v_pk_mul_f32 v[70:71], v[134:135], v[48:49] op_sel_hi:[1,0]
v_pk_mul_f32 v[72:73], v[136:137], v[48:49] op_sel_hi:[1,0]
v_pk_mul_f32 v[74:75], v[138:139], v[48:49] op_sel_hi:[1,0]
v_pk_mul_f32 v[76:77], v[140:141], v[48:49] op_sel_hi:[1,0]
v_pk_mul_f32 v[78:79], v[142:143], v[48:49] op_sel_hi:[1,0]
v_pk_mul_f32 v[80:81], v[144:145], v[48:49] op_sel_hi:[1,0]
v_pk_mul_f32 v[82:83], v[146:147], v[48:49] op_sel_hi:[1,0]
v_exp_f32 v64, v64
v_exp_f32 v65, v65
v_exp_f32 v66, v66
v_exp_f32 v67, v67
v_exp_f32 v68, v68
v_exp_f32 v69, v69
v_exp_f32 v70, v70
v_exp_f32 v71, v71
v_exp_f32 v72, v72
v_exp_f32 v73, v73
v_exp_f32 v74, v74
v_exp_f32 v75, v75
v_exp_f32 v76, v76
v_exp_f32 v77, v77
v_exp_f32 v78, v78
v_exp_f32 v79, v79
v_exp_f32 v80, v80
v_exp_f32 v81, v81
v_exp_f32 v82, v82
v_exp_f32 v83, v83
s_waitcnt vmcnt(0) lgkmcnt(0)
s_barrier
ds_read_b64_tr_b16 v[188:189], v63 offset:0
ds_read_b64_tr_b16 v[190:191], v63 offset:512
ds_read_b64_tr_b16 v[192:193], v63 offset:1024
ds_read_b64_tr_b16 v[194:195], v63 offset:1536
ds_read_b64_tr_b16 v[196:197], v63 offset:2048
v_pk_add_f32 v[64:65], v[64:65], v[48:49] op_sel:[0,1] op_sel_hi:[1,1]
v_pk_add_f32 v[66:67], v[66:67], v[48:49] op_sel:[0,1] op_sel_hi:[1,1]
v_pk_add_f32 v[68:69], v[68:69], v[48:49] op_sel:[0,1] op_sel_hi:[1,1]
v_pk_add_f32 v[70:71], v[70:71], v[48:49] op_sel:[0,1] op_sel_hi:[1,1]
v_pk_add_f32 v[72:73], v[72:73], v[48:49] op_sel:[0,1] op_sel_hi:[1,1]
v_pk_add_f32 v[74:75], v[74:75], v[48:49] op_sel:[0,1] op_sel_hi:[1,1]
v_pk_add_f32 v[76:77], v[76:77], v[48:49] op_sel:[0,1] op_sel_hi:[1,1]
v_pk_add_f32 v[78:79], v[78:79], v[48:49] op_sel:[0,1] op_sel_hi:[1,1]
v_pk_add_f32 v[80:81], v[80:81], v[48:49] op_sel:[0,1] op_sel_hi:[1,1]
v_pk_add_f32 v[82:83], v[82:83], v[48:49] op_sel:[0,1] op_sel_hi:[1,1]
v_rcp_f32 v64, v64
v_rcp_f32 v65, v65
v_rcp_f32 v66, v66
v_rcp_f32 v67, v67
v_rcp_f32 v68, v68
v_rcp_f32 v69, v69
v_rcp_f32 v70, v70
v_rcp_f32 v71, v71
v_rcp_f32 v72, v72
v_rcp_f32 v73, v73
v_rcp_f32 v74, v74
v_rcp_f32 v75, v75
v_rcp_f32 v76, v76
v_rcp_f32 v77, v77
v_rcp_f32 v78, v78
v_rcp_f32 v79, v79
v_rcp_f32 v80, v80
v_rcp_f32 v81, v81
v_rcp_f32 v82, v82
v_rcp_f32 v83, v83
s_waitcnt lgkmcnt(0)
v_lshlrev_b32 v108, 16, v188
v_and_b32 v109, 0xffff0000, v188
v_lshlrev_b32 v110, 16, v189
v_and_b32 v111, 0xffff0000, v189
v_lshlrev_b32 v112, 16, v190
v_and_b32 v113, 0xffff0000, v190
v_lshlrev_b32 v114, 16, v191
v_and_b32 v115, 0xffff0000, v191
v_pk_mul_f32 v[64:65], v[64:65], v[128:129]
v_pk_mul_f32 v[66:67], v[66:67], v[130:131]
v_pk_mul_f32 v[68:69], v[68:69], v[132:133]
v_pk_mul_f32 v[70:71], v[70:71], v[134:135]
v_pk_mul_f32 v[108:109], v[108:109], v[20:21]
v_pk_mul_f32 v[110:111], v[110:111], v[22:23]
v_pk_mul_f32 v[112:113], v[112:113], v[24:25]
v_pk_mul_f32 v[114:115], v[114:115], v[26:27]
v_pk_fma_f32 v[108:109], v[108:109], v[64:65], v[40:41]
v_pk_fma_f32 v[110:111], v[110:111], v[66:67], v[42:43]
v_pk_fma_f32 v[112:113], v[112:113], v[68:69], v[44:45]
v_pk_fma_f32 v[114:115], v[114:115], v[70:71], v[46:47]
v_cvt_pk_bf16_f32 v188, v108, v109
v_cvt_pk_bf16_f32 v189, v110, v111
v_cvt_pk_bf16_f32 v190, v112, v113
v_cvt_pk_bf16_f32 v191, v114, v115
ds_write_b64 v50, v[188:189] offset:0
ds_write_b64 v50, v[190:191] offset:8
v_lshlrev_b32 v116, 16, v192
v_and_b32 v117, 0xffff0000, v192
v_lshlrev_b32 v118, 16, v193
v_and_b32 v119, 0xffff0000, v193
v_lshlrev_b32 v120, 16, v194
v_and_b32 v121, 0xffff0000, v194
v_lshlrev_b32 v122, 16, v195
v_and_b32 v123, 0xffff0000, v195
v_lshlrev_b32 v124, 16, v196
v_and_b32 v125, 0xffff0000, v196
v_lshlrev_b32 v126, 16, v197
v_and_b32 v127, 0xffff0000, v197
v_pk_mul_f32 v[72:73], v[72:73], v[136:137]
v_pk_mul_f32 v[74:75], v[74:75], v[138:139]
v_pk_mul_f32 v[76:77], v[76:77], v[140:141]
v_pk_mul_f32 v[78:79], v[78:79], v[142:143]
v_pk_mul_f32 v[80:81], v[80:81], v[144:145]
v_pk_mul_f32 v[82:83], v[82:83], v[146:147]
v_pk_mul_f32 v[116:117], v[116:117], v[28:29]
v_pk_mul_f32 v[118:119], v[118:119], v[30:31]
v_pk_mul_f32 v[120:121], v[120:121], v[32:33]
v_pk_mul_f32 v[122:123], v[122:123], v[34:35]
v_pk_mul_f32 v[124:125], v[124:125], v[36:37]
v_pk_mul_f32 v[126:127], v[126:127], v[38:39]
v_pk_fma_f32 v[116:117], v[116:117], v[72:73], v[96:97]
v_pk_fma_f32 v[118:119], v[118:119], v[74:75], v[98:99]
v_pk_fma_f32 v[120:121], v[120:121], v[76:77], v[100:101]
v_pk_fma_f32 v[122:123], v[122:123], v[78:79], v[102:103]
v_pk_fma_f32 v[124:125], v[124:125], v[80:81], v[104:105]
v_pk_fma_f32 v[126:127], v[126:127], v[82:83], v[106:107]
v_cvt_pk_bf16_f32 v192, v116, v117
v_cvt_pk_bf16_f32 v193, v118, v119
v_cvt_pk_bf16_f32 v194, v120, v121
v_cvt_pk_bf16_f32 v195, v122, v123
v_cvt_pk_bf16_f32 v196, v124, v125
v_cvt_pk_bf16_f32 v197, v126, v127
ds_write_b64 v50, v[192:193] offset:16
ds_write_b64 v50, v[194:195] offset:24
ds_write_b64 v50, v[196:197] offset:32
s_mov_b64 exec, s[86:87]
ds_read_b128 v[64:67], v51 offset:0
ds_read_b128 v[68:71], v51 offset:704
ds_read_b128 v[72:75], v51 offset:1408
ds_read_b128 v[76:79], v51 offset:2112
s_waitcnt lgkmcnt(3)
buffer_store_dwordx4 v[64:67], v52, s[28:31], 0 offen
s_waitcnt lgkmcnt(2)
buffer_store_dwordx4 v[68:71], v53, s[28:31], 0 offen
s_waitcnt lgkmcnt(1)
buffer_store_dwordx4 v[72:75], v54, s[28:31], 0 offen
s_waitcnt lgkmcnt(0)
buffer_store_dwordx4 v[76:79], v55, s[28:31], 0 offen
s_mov_b64 exec, -1
L_end:
s_endpgm
L_two_32:
s_waitcnt lgkmcnt(0)
ds_read_b128 v[128:131], v10 offset:240
ds_read_b128 v[132:135], v10 offset:176
ds_read_b128 v[136:139], v10 offset:112
ds_read_b128 v[140:143], v10 offset:48
s_and_b32 s6, s88, 0xfffffffe
s_sub_u32 s6, s91, s6
s_cmp_ge_u32 s6, 2
s_cselect_b32 s92, s1, s0
s_and_b32 s6, s6, 1
s_lshl_b32 s6, s6, 4
s_lshr_b32 s92, s92, s6
s_lshl_b32 s92, s92, 16
s_lshl_b32 s6, s91, 12
s_add_u32 s6, s6, 4194304
s_nop 4
s_waitcnt lgkmcnt(0)
v_lshlrev_b32 v131, 16, v131
v_fma_f32 v176, v131, s92, v176
v_lshlrev_b32 v130, 16, v130
v_fma_f32 v177, v130, s92, v177
v_lshlrev_b32 v129, 16, v129
v_fma_f32 v178, v129, s92, v178
v_lshlrev_b32 v128, 16, v128
v_fma_f32 v179, v128, s92, v179
v_lshlrev_b32 v135, 16, v135
v_fma_f32 v180, v135, s92, v180
v_lshlrev_b32 v134, 16, v134
v_fma_f32 v181, v134, s92, v181
v_lshlrev_b32 v133, 16, v133
v_fma_f32 v182, v133, s92, v182
v_lshlrev_b32 v132, 16, v132
v_fma_f32 v183, v132, s92, v183
v_lshlrev_b32 v139, 16, v139
v_fma_f32 v184, v139, s92, v184
v_lshlrev_b32 v138, 16, v138
v_fma_f32 v185, v138, s92, v185
v_lshlrev_b32 v137, 16, v137
v_fma_f32 v186, v137, s92, v186
v_lshlrev_b32 v136, 16, v136
v_fma_f32 v187, v136, s92, v187
v_lshlrev_b32 v143, 16, v143
v_fma_f32 v188, v143, s92, v188
v_lshlrev_b32 v142, 16, v142
v_fma_f32 v189, v142, s92, v189
v_lshlrev_b32 v141, 16, v141
v_fma_f32 v190, v141, s92, v190
v_lshlrev_b32 v140, 16, v140
v_fma_f32 v191, v140, s92, v191
v_cvt_pk_bf16_f32 v160, v176, v177
v_cvt_pk_bf16_f32 v161, v178, v179
v_cvt_pk_bf16_f32 v162, v180, v181
v_cvt_pk_bf16_f32 v163, v182, v183
buffer_store_dwordx4 v[160:163], v11, s[24:27], s6 offen offset:0 sc1
v_cvt_pk_bf16_f32 v164, v184, v185
v_cvt_pk_bf16_f32 v165, v186, v187
v_cvt_pk_bf16_f32 v166, v188, v189
v_cvt_pk_bf16_f32 v167, v190, v191
buffer_store_dwordx4 v[164:167], v11, s[24:27], s6 offen offset:128 sc1
s_cmp_eq_u32 s87, 3
s_cselect_b32 s85, s85, s87
s_cselect_b64 vcc, -1, 0
v_mov_b32 v2, 2147418112
v_cndmask_b32 v11, v11, v2, vcc
s_mul_i32 s6, s85, 30208
s_add_u32 s6, s6, 63488
v_add_u32 v8, s6, v16
s_add_u32 s6, s6, 17536
v_add_u32 v9, s6, v17
v_lshlrev_b32 v10, 5, v18
v_sub_u32 v10, v9, v10
v_add_u32 v10, 2176, v10
s_add_u32 s91, s88, s85
ds_read_b128 v[128:131], v8 offset:2048
ds_read_b128 v[132:135], v8 offset:2112
ds_read_b128 v[136:139], v8 offset:2176
ds_read_b128 v[140:143], v8 offset:2240
ds_read_b128 v[144:147], v8 offset:2304
ds_read_b128 v[148:151], v8 offset:2368
ds_read_b128 v[152:155], v8 offset:2432
ds_read_b128 v[156:159], v8 offset:2496
ds_read_b128 v[160:163], v9 offset:2176
ds_read_b128 v[164:167], v9 offset:2240
ds_read_b128 v[168:171], v9 offset:2304
v_mov_b32 v176, 0
v_mov_b32 v177, 0
v_mov_b32 v178, 0
v_mov_b32 v179, 0
v_mov_b32 v180, 0
v_mov_b32 v181, 0
v_mov_b32 v182, 0
v_mov_b32 v183, 0
v_mov_b32 v184, 0
v_mov_b32 v185, 0
v_mov_b32 v186, 0
v_mov_b32 v187, 0
v_mov_b32 v188, 0
v_mov_b32 v189, 0
v_mov_b32 v190, 0
v_mov_b32 v191, 0
s_waitcnt lgkmcnt(0)
s_branch L_halfb_33
L_spare:
s_and_b32 s6, s3, 3
s_lshr_b32 s7, s3, 2
s_lshl_b32 s6, s6, 1
s_add_u32 s73, s6, s7
s_lshl_b32 s73, s73, 2
s_add_u32 s73, s73, s4
s_sub_u32 s73, s73, 28
s_and_b32 s6, s3, 3
s_lshl_b32 s6, s6, 2
s_and_b32 s7, s4, 3
s_add_u32 s77, s6, s7
s_lshr_b32 s6, s3, 2
s_mul_i32 s6, s6, 7
s_lshr_b32 s7, s4, 2
s_add_u32 s78, s6, s7
s_and_b32 s82, s5, 1
s_lshr_b32 s83, s5, 1
s_lshl_b32 s6, s3, 4
s_lshr_b32 s7, s4, 1
s_add_u32 s6, s6, s7
s_mul_i32 s6, s6, 5
s_and_b32 s89, s4, 1
s_lshl_b32 s7, s89, 1
s_add_u32 s88, s6, s7
s_and_b32 s6, s3, 3
s_lshl_b32 s6, s6, 3
s_and_b32 s7, s4, 7
s_add_u32 s94, s6, s7
s_lshr_b32 s6, s3, 2
s_xor_b32 s6, s6, 1
s_lshl_b32 s6, s6, 2
s_lshr_b32 s7, s4, 3
s_add_u32 s95, s6, s7
s_mul_i32 s96, s5, 14
s_cmp_eq_u32 s5, 3
s_cselect_b32 s6, 1, 0
s_sub_u32 s96, s96, s6
s_lshr_b32 s6, s4, 3
s_lshl_b32 s7, s3, 2
s_add_u32 s68, s6, s7
s_and_b32 s69, s4, 7
v_mul_u32_u24 v2, 26, v1
v_lshrrev_b32 v2, 8, v2
v_mul_u32_u24 v3, 10, v2
v_sub_u32 v3, v1, v3
s_lshl_b32 s6, s68, 6
s_lshl_b32 s7, s5, 4
s_add_u32 s6, s6, s7
s_mul_i32 s6, s6, 1280
s_mul_i32 s7, s69, 160
s_add_u32 s6, s6, s7
v_mul_u32_u24 v4, 5120, v2
v_lshl_add_u32 v4, v3, 4, v4
v_add_u32 v244, s6, v4
v_subrev_u32 v245, 3840, v244
s_mul_i32 s92, s69, 640
s_mul_i32 s7, s5, 2560
s_add_u32 s7, s7, 142592
s_mov_b32 m0, s7
v_lshl_add_u32 v247, v3, 6, s7
s_lshl_b32 s7, s5, 5
s_sub_u32 s7, 131192, s7
v_mul_u32_u24 v4, 1152, v3
v_lshlrev_b32 v2, 3, v2
v_sub_u32 v4, v4, v2
v_add_u32 v202, s7, v4
v_lshrrev_b32 v2, 3, v1
s_mul_i32 s6, s5, 20
v_add_u32 v2, s6, v2
v_and_b32 v3, 7, v1
v_lshlrev_b32 v3, 4, v3
v_mul_u32_u24 v4, 144, v2
v_add_u32 v4, v4, v3
v_add_u32 v203, 131072, v4
v_lshl_add_u32 v172, v2, 12, v3
s_mul_i32 s6, s69, 327680
s_lshl_b32 s7, s68, 7
s_sub_u32 s6, s6, s7
s_add_u32 s70, s6, 1052544
s_add_u32 s71, s70, 32768
s_add_u32 s72, s70, 65536
s_lshl_b32 s6, s73, 6
s_lshl_b32 s7, s5, 4
s_add_u32 s6, s6, s7
s_mul_i32 s75, s6, 1280
s_lshl_b32 s6, s73, 2
s_add_u32 s6, s6, s5
s_mul_i32 s76, s6, 20480
v_lshlrev_b32 v233, 7, v1
s_lshl_b32 s6, s73, 6
s_lshl_b32 s7, s5, 4
s_add_u32 s74, s6, s7
v_and_b32 v2, 15, v1
v_lshrrev_b32 v3, 4, v1
v_add_u32 v4, s74, v2
v_mul_u32_u24 v4, 1280, v4
v_lshl_add_u32 v211, v3, 4, v4
s_waitcnt lgkmcnt(0)
s_mov_b32 s24, s66
s_and_b32 s25, s67, 0xffff
s_mov_b32 s26, 17825792
s_mov_b32 s27, 0x20000
s_lshl_b32 s6, s88, 1
s_and_b32 s6, s6, 0xfffffffc
s_load_dwordx2 s[0:1], s[50:51], s6
s_cmp_lg_u32 s5, 0
s_cbranch_scc1 L_clr_44
v_lshl_add_u32 v2, v1, 2, v252
v_mov_b32 v3, 0
s_mov_b64 exec, 0xff
buffer_store_dword v3, v2, s[24:27], 0 offen sc1
s_mov_b64 exec, -1
L_clr_44:
s_mov_b32 s12, s42
s_and_b32 s13, s43, 0xffff
s_mov_b32 s14, 2621440
s_mov_b32 s15, 0x20000
s_mov_b32 s16, s44
s_and_b32 s17, s45, 0xffff
s_mov_b32 s18, 2621440
s_mov_b32 s19, 0x20000
s_mov_b32 s32, s46
s_and_b32 s33, s47, 0xffff
s_mov_b32 s34, 5120
s_mov_b32 s35, 0x20000
s_mov_b32 s8, s40
s_and_b32 s9, s41, 0xffff
s_mov_b32 s10, 2621440
s_mov_b32 s11, 0x20000
s_mov_b32 s28, s62
s_and_b32 s29, s63, 0xffff
s_mov_b32 s30, 2621440
s_mov_b32 s31, 0x20000
s_mov_b32 s52, s64
s_and_b32 s53, s65, 0xffff
s_mov_b32 s54, 256
s_mov_b32 s55, 0x20000
s_mov_b32 s42, 0
buffer_load_dwordx4 a[0:3], v211, s[8:11], 0 offen offset:0
buffer_load_dwordx4 a[4:7], v211, s[8:11], 0 offen offset:64
buffer_load_dwordx4 a[8:11], v211, s[8:11], 0 offen offset:128
buffer_load_dwordx4 a[12:15], v211, s[8:11], 0 offen offset:192
s_waitcnt vmcnt(4)
s_cmp_lg_u32 s5, 0
s_cbranch_scc1 L_arr_45
s_and_b32 s6, s2, 7
s_lshl_b32 s6, s6, 5
v_mov_b32 v2, s6
s_mov_b64 exec, 1
buffer_atomic_add v253, v2, s[52:55], 0 offen sc1
s_mov_b64 exec, -1
L_arr_45:
buffer_load_dwordx4 a[16:19], v211, s[8:11], 0 offen offset:256
buffer_load_dwordx4 a[20:23], v211, s[8:11], 0 offen offset:320
buffer_load_dwordx4 a[24:27], v211, s[8:11], 0 offen offset:384
buffer_load_dwordx4 a[28:31], v211, s[8:11], 0 offen offset:448
buffer_load_dwordx4 a[32:35], v211, s[8:11], 0 offen offset:512
buffer_load_dwordx4 a[36:39], v211, s[8:11], 0 offen offset:576
buffer_load_dwordx4 a[40:43], v211, s[8:11], 0 offen offset:640
buffer_load_dwordx4 a[44:47], v211, s[8:11], 0 offen offset:704
buffer_load_dwordx4 a[48:51], v211, s[8:11], 0 offen offset:768
buffer_load_dwordx4 a[52:55], v211, s[8:11], 0 offen offset:832
buffer_load_dwordx4 a[56:59], v211, s[8:11], 0 offen offset:896
buffer_load_dwordx4 a[60:63], v211, s[8:11], 0 offen offset:960
buffer_load_dwordx4 a[64:67], v211, s[8:11], 0 offen offset:1024
buffer_load_dwordx4 a[68:71], v211, s[8:11], 0 offen offset:1088
buffer_load_dwordx4 a[72:75], v211, s[8:11], 0 offen offset:1152
buffer_load_dwordx4 a[76:79], v211, s[8:11], 0 offen offset:1216
v_and_b32 v2, 15, v1
v_min_u32 v2, 13, v2
v_add_u32 v2, s96, v2
v_min_u32 v2, 53, v2
v_lshlrev_b32 v2, 2, v2
s_lshr_b32 s43, s95, 1
v_add_u32 v2, s43, v2
v_lshlrev_b32 v2, 7, v2
v_add_u32 v228, 12, v2
s_lshl_b32 s6, s77, 1
v_and_b32 v4, 1, v1
v_add_u32 v4, s6, v4
v_and_b32 v5, 3, v4
v_add_u32 v5, 28, v5
s_lshr_b32 s6, s77, 2
s_and_b32 s7, s77, 2
s_lshl_b32 s7, s7, 1
s_add_u32 s6, s6, s7
v_mov_b32 v4, s6
v_lshl_add_u32 v4, v5, 3, v4
v_lshlrev_b32 v4, 7, v4
v_add_u32 v231, 4, v4
v_and_b32 v2, 31, v1
v_and_b32 v3, 7, v2
v_lshrrev_b32 v2, 3, v2
v_lshlrev_b32 v2, 3, v2
v_add_u32 v2, s3, v2
v_lshl_add_u32 v2, v2, 3, v3
v_lshlrev_b32 v229, 7, v2
v_cmp_gt_u32 vcc, 14, v1
v_cndmask_b32 v2, 0, v1, vcc
v_cmp_lt_u32 vcc, 6, v2
v_cndmask_b32 v3, 0, 1, vcc
v_mul_u32_u24 v4, 7, v3
v_sub_u32 v2, v2, v4
s_lshr_b32 s6, s94, 1
s_and_b32 s7, s6, 3
s_lshr_b32 s6, s6, 2
v_lshlrev_b32 v3, 2, v3
v_lshlrev_b32 v2, 2, v2
v_add_u32 v2, s7, v2
v_add_u32 v3, s6, v3
v_lshl_add_u32 v2, v2, 3, v3
v_lshlrev_b32 v2, 7, v2
v_add_u32 v249, 16, v2
v_and_b32 v2, 31, v1
v_lshlrev_b32 v2, 3, v2
v_add_u32 v2, s95, v2
v_lshlrev_b32 v2, 7, v2
v_add_u32 v250, 20, v2
v_mov_b32 v2, 2147418112
s_cmp_lg_u32 s5, 0
s_cselect_b64 vcc, -1, 0
v_cndmask_b32 v231, v231, v2, vcc
v_cndmask_b32 v230, v230, v2, vcc
v_mov_b32 v214, 0x3f803f80
v_mov_b32 v215, 0x3f803f80
v_mov_b32 v216, 0x3f803f80
v_mov_b32 v217, 0x3f803f80
v_mov_b32 v218, 0
v_mov_b32 v219, 0
v_mov_b32 v220, 0
v_mov_b32 v221, 0
v_mov_b32 v222, 0
v_mov_b32 v223, 0
v_mov_b32 v224, 0
v_mov_b32 v225, 0
s_waitcnt vmcnt(19)
v_mfma_f32_16x16x32_bf16 v[218:221], a[0:3], a[0:3], v[218:221]
v_mfma_f32_16x16x32_bf16 v[222:225], a[0:3], v[214:217], v[222:225]
s_waitcnt vmcnt(18)
v_mfma_f32_16x16x32_bf16 v[218:221], a[4:7], a[4:7], v[218:221]
v_mfma_f32_16x16x32_bf16 v[222:225], a[4:7], v[214:217], v[222:225]
s_waitcnt vmcnt(17)
v_mfma_f32_16x16x32_bf16 v[218:221], a[8:11], a[8:11], v[218:221]
v_mfma_f32_16x16x32_bf16 v[222:225], a[8:11], v[214:217], v[222:225]
s_waitcnt vmcnt(16)
v_mfma_f32_16x16x32_bf16 v[218:221], a[12:15], a[12:15], v[218:221]
v_mfma_f32_16x16x32_bf16 v[222:225], a[12:15], v[214:217], v[222:225]
s_waitcnt vmcnt(15)
v_mfma_f32_16x16x32_bf16 v[218:221], a[16:19], a[16:19], v[218:221]
v_mfma_f32_16x16x32_bf16 v[222:225], a[16:19], v[214:217], v[222:225]
s_waitcnt vmcnt(14)
v_mfma_f32_16x16x32_bf16 v[218:221], a[20:23], a[20:23], v[218:221]
v_mfma_f32_16x16x32_bf16 v[222:225], a[20:23], v[214:217], v[222:225]
s_waitcnt vmcnt(13)
v_mfma_f32_16x16x32_bf16 v[218:221], a[24:27], a[24:27], v[218:221]
v_mfma_f32_16x16x32_bf16 v[222:225], a[24:27], v[214:217], v[222:225]
s_waitcnt vmcnt(12)
v_mfma_f32_16x16x32_bf16 v[218:221], a[28:31], a[28:31], v[218:221]
v_mfma_f32_16x16x32_bf16 v[222:225], a[28:31], v[214:217], v[222:225]
s_waitcnt vmcnt(11)
v_mfma_f32_16x16x32_bf16 v[218:221], a[32:35], a[32:35], v[218:221]
v_mfma_f32_16x16x32_bf16 v[222:225], a[32:35], v[214:217], v[222:225]
s_waitcnt vmcnt(10)
v_mfma_f32_16x16x32_bf16 v[218:221], a[36:39], a[36:39], v[218:221]
v_mfma_f32_16x16x32_bf16 v[222:225], a[36:39], v[214:217], v[222:225]
s_waitcnt vmcnt(9)
v_mfma_f32_16x16x32_bf16 v[218:221], a[40:43], a[40:43], v[218:221]
v_mfma_f32_16x16x32_bf16 v[222:225], a[40:43], v[214:217], v[222:225]
s_waitcnt vmcnt(8)
v_mfma_f32_16x16x32_bf16 v[218:221], a[44:47], a[44:47], v[218:221]
v_mfma_f32_16x16x32_bf16 v[222:225], a[44:47], v[214:217], v[222:225]
s_waitcnt vmcnt(7)
v_mfma_f32_16x16x32_bf16 v[218:221], a[48:51], a[48:51], v[218:221]
v_mfma_f32_16x16x32_bf16 v[222:225], a[48:51], v[214:217], v[222:225]
s_waitcnt vmcnt(6)
v_mfma_f32_16x16x32_bf16 v[218:221], a[52:55], a[52:55], v[218:221]
v_mfma_f32_16x16x32_bf16 v[222:225], a[52:55], v[214:217], v[222:225]
s_waitcnt vmcnt(5)
v_mfma_f32_16x16x32_bf16 v[218:221], a[56:59], a[56:59], v[218:221]
v_mfma_f32_16x16x32_bf16 v[222:225], a[56:59], v[214:217], v[222:225]
s_waitcnt vmcnt(4)
v_mfma_f32_16x16x32_bf16 v[218:221], a[60:63], a[60:63], v[218:221]
v_mfma_f32_16x16x32_bf16 v[222:225], a[60:63], v[214:217], v[222:225]
s_waitcnt vmcnt(3)
v_mfma_f32_16x16x32_bf16 v[218:221], a[64:67], a[64:67], v[218:221]
v_mfma_f32_16x16x32_bf16 v[222:225], a[64:67], v[214:217], v[222:225]
s_waitcnt vmcnt(2)
v_mfma_f32_16x16x32_bf16 v[218:221], a[68:71], a[68:71], v[218:221]
v_mfma_f32_16x16x32_bf16 v[222:225], a[68:71], v[214:217], v[222:225]
s_waitcnt vmcnt(1)
v_mfma_f32_16x16x32_bf16 v[218:221], a[72:75], a[72:75], v[218:221]
v_mfma_f32_16x16x32_bf16 v[222:225], a[72:75], v[214:217], v[222:225]
s_waitcnt vmcnt(0)
v_mfma_f32_16x16x32_bf16 v[218:221], a[76:79], a[76:79], v[218:221]
v_mfma_f32_16x16x32_bf16 v[222:225], a[76:79], v[214:217], v[222:225]
v_and_b32 v5, 1, v1
v_cmp_eq_u32 vcc, 1, v5
v_and_b32 v5, 2, v1
v_cmp_eq_u32 s[6:7], 2, v5
s_nop 7
v_cndmask_b32 v2, v218, v219, vcc
v_cndmask_b32 v3, v220, v221, vcc
v_cndmask_b32 v4, v222, v223, vcc
v_cndmask_b32 v5, v224, v225, vcc
v_cndmask_b32 v2, v2, v3, s[6:7]
v_cndmask_b32 v3, v4, v5, s[6:7]
v_mul_f32 v214, 0.0015625, v3
v_mul_f32 v2, 0.0015625, v2
v_fma_f32 v2, -v214, v214, v2
v_max_f32 v2, 0, v2
v_add_f32 v2, 0x3727c5ac, v2
v_sqrt_f32 v216, v2
s_nop 0
v_rcp_f32 v215, v216
v_mov_b32 v217, 0
v_sub_f32 v3, 0, v214
v_cvt_pk_bf16_f32 v4, v216, v3
v_lshlrev_b32 v5, 16, v4
v_and_b32 v6, 0xffff0000, v4
v_sub_f32 v5, v216, v5
v_sub_f32 v6, v3, v6
v_cvt_pk_bf16_f32 v5, v5, v6
s_mov_b32 s6, 0x05040100
s_mov_b32 s7, 0x07060302
v_perm_b32 v218, v5, v4, s6
v_perm_b32 v219, v5, v4, s7
v_mov_b32 v220, v219
v_mov_b32 v221, 0
v_lshrrev_b32 v3, 4, v1
v_and_b32 v5, 3, v1
v_lshl_add_u32 v5, v3, 2, v5
v_add_u32 v5, s74, v5
v_lshlrev_b32 v5, 4, v5
s_mov_b32 s6, 65536
s_mov_b32 s7, 98304
s_mov_b32 exec_lo, 0x00f0000f
s_mov_b32 exec_hi, 0xf0000f00
buffer_store_dwordx4 v[218:221], v5, s[24:27], s6 offen sc1
buffer_store_dwordx4 v[214:217], v5, s[24:27], s7 offen sc1
s_mov_b64 exec, -1
buffer_load_dword v254, v230, s[52:55], 0 offen sc1
s_mov_b32 exec_hi, 0xff
buffer_load_dwordx4 v[8:11], v245, s[12:15], 0 offen offset:0
buffer_load_dwordx4 v[12:15], v245, s[12:15], 0 offen offset:1280
buffer_load_dwordx4 v[16:19], v245, s[12:15], 0 offen offset:2560
buffer_load_dwordx4 v[20:23], v244, s[12:15], 0 offen offset:0
buffer_load_dwordx4 v[24:27], v244, s[12:15], 0 offen offset:1280
buffer_load_dwordx4 v[28:31], v244, s[12:15], 0 offen offset:2560
buffer_load_dwordx4 v[32:35], v244, s[12:15], 0 offen offset:3840
buffer_load_dwordx4 v248, s[32:35], s92 offen lds
buffer_load_dwordx4 v[174:177], v244, s[16:19], 0 offen offset:0
buffer_load_dwordx4 v[178:181], v244, s[16:19], 0 offen offset:1280
buffer_load_dwordx4 v[182:185], v244, s[16:19], 0 offen offset:2560
buffer_load_dwordx4 v[186:189], v244, s[16:19], 0 offen offset:3840
s_mov_b64 exec, -1
s_mov_b32 s36, s58
s_and_b32 s37, s59, 0xffff
s_mov_b32 s38, 2211840
s_mov_b32 s39, 0x20000
s_sub_u32 s6, s4, 28
s_lshl_b32 s6, s6, 2
s_add_u32 s6, s6, s5
s_mul_i32 s79, s6, 162
s_lshr_b32 s6, s3, 2
s_lshl_b32 s80, s6, 5
s_and_b32 s7, s3, 3
s_mul_i32 s7, s7, 320
s_and_b32 s81, s7, 0xffffff80
v_add_u32 v2, s79, v1
v_add_u32 v2, 0, v2
v_mul_u32_u24 v3, 2731, v2
v_lshrrev_b32 v3, 18, v3
v_mul_u32_u24 v4, 96, v3
v_sub_u32 v4, v2, v4
v_mul_u32_u24 v5, 86, v4
v_lshrrev_b32 v5, 8, v5
v_mul_u32_u24 v6, 3, v5
v_sub_u32 v6, v4, v6
v_lshlrev_b32 v3, 6, v3
v_add_u32 v3, v3, v5
v_add_u32 v3, s80, v3
v_mul_u32_u24 v3, 1280, v3
v_lshl_add_u32 v3, v6, 7, v3
v_add_u32 v128, s81, v3
v_add_u32 v2, s79, v1
v_add_u32 v2, 64, v2
v_mul_u32_u24 v3, 2731, v2
v_lshrrev_b32 v3, 18, v3
v_mul_u32_u24 v4, 96, v3
v_sub_u32 v4, v2, v4
v_mul_u32_u24 v5, 86, v4
v_lshrrev_b32 v5, 8, v5
v_mul_u32_u24 v6, 3, v5
v_sub_u32 v6, v4, v6
v_lshlrev_b32 v3, 6, v3
v_add_u32 v3, v3, v5
v_add_u32 v3, s80, v3
v_mul_u32_u24 v3, 1280, v3
v_lshl_add_u32 v3, v6, 7, v3
v_add_u32 v129, s81, v3
v_add_u32 v2, s79, v1
v_add_u32 v2, 128, v2
v_mul_u32_u24 v3, 2731, v2
v_lshrrev_b32 v3, 18, v3
v_mul_u32_u24 v4, 96, v3
v_sub_u32 v4, v2, v4
v_mul_u32_u24 v5, 86, v4
v_lshrrev_b32 v5, 8, v5
v_mul_u32_u24 v6, 3, v5
v_sub_u32 v6, v4, v6
v_lshlrev_b32 v3, 6, v3
v_add_u32 v3, v3, v5
v_add_u32 v3, s80, v3
v_mul_u32_u24 v3, 1280, v3
v_lshl_add_u32 v3, v6, 7, v3
v_add_u32 v130, s81, v3
buffer_load_dword v234, v128, s[36:39], 0 offen
buffer_load_dword v234, v129, s[36:39], 0 offen
s_mov_b32 exec_lo, 0xffffffff
s_mov_b32 exec_hi, 0x3
buffer_load_dword v234, v130, s[36:39], 0 offen
s_mov_b64 exec, -1
s_waitcnt vmcnt(16)
s_barrier
s_cmp_lg_u32 s5, 0
s_cbranch_scc1 L_fl_46
s_mov_b64 exec, 1
buffer_store_dword v253, v252, s[24:27], 0 offen offset:4 sc1
s_mov_b64 exec, -1
L_fl_46:
s_waitcnt vmcnt(15)
s_cmp_lg_u32 s5, 0
s_cbranch_scc1 L_back_48
v_cmp_gt_u32 vcc, 32, v254
s_cbranch_vccnz L_slow_47
L_back_48:
s_waitcnt vmcnt(3)
ds_read_b128 v[36:39], v247 offset:0
ds_read_b128 v[40:43], v247 offset:16
ds_read_b128 v[44:47], v247 offset:32
ds_read_b128 v[48:51], v247 offset:48
v_lshlrev_b32 v194, 16, v8
v_and_b32 v195, 0xffff0000, v8
v_lshlrev_b32 v196, 16, v12
v_and_b32 v197, 0xffff0000, v12
v_lshlrev_b32 v198, 16, v16
v_and_b32 v199, 0xffff0000, v16
v_lshlrev_b32 v236, 16, v20
v_and_b32 v237, 0xffff0000, v20
v_lshlrev_b32 v238, 16, v24
v_and_b32 v239, 0xffff0000, v24
v_lshlrev_b32 v240, 16, v28
v_and_b32 v241, 0xffff0000, v28
v_lshlrev_b32 v242, 16, v32
v_and_b32 v243, 0xffff0000, v32
s_waitcnt lgkmcnt(0)
v_lshlrev_b32 v52, 16, v36
v_lshlrev_b32 v53, 16, v38
v_and_b32 v54, 0xffff0000, v36
v_and_b32 v55, 0xffff0000, v38
v_lshlrev_b32 v56, 16, v37
v_lshlrev_b32 v57, 16, v39
v_and_b32 v58, 0xffff0000, v37
v_and_b32 v59, 0xffff0000, v39
v_pk_mul_f32 v[60:61], v[236:237], v[52:53]
v_pk_mul_f32 v[62:63], v[238:239], v[52:53]
v_pk_mul_f32 v[190:191], v[240:241], v[52:53]
v_pk_mul_f32 v[192:193], v[242:243], v[52:53]
v_pk_fma_f32 v[60:61], v[198:199], v[54:55], v[60:61]
v_pk_fma_f32 v[62:63], v[236:237], v[54:55], v[62:63]
v_pk_fma_f32 v[190:191], v[238:239], v[54:55], v[190:191]
v_pk_fma_f32 v[192:193], v[240:241], v[54:55], v[192:193]
v_pk_fma_f32 v[60:61], v[196:197], v[56:57], v[60:61]
v_pk_fma_f32 v[62:63], v[198:199], v[56:57], v[62:63]
v_pk_fma_f32 v[190:191], v[236:237], v[56:57], v[190:191]
v_pk_fma_f32 v[192:193], v[238:239], v[56:57], v[192:193]
v_pk_fma_f32 v[60:61], v[194:195], v[58:59], v[60:61]
v_pk_fma_f32 v[62:63], v[196:197], v[58:59], v[62:63]
v_pk_fma_f32 v[190:191], v[198:199], v[58:59], v[190:191]
v_pk_fma_f32 v[192:193], v[236:237], v[58:59], v[192:193]
v_lshlrev_b32 v194, 16, v174
v_and_b32 v195, 0xffff0000, v174
v_lshlrev_b32 v196, 16, v178
v_and_b32 v197, 0xffff0000, v178
v_lshlrev_b32 v198, 16, v182
v_and_b32 v199, 0xffff0000, v182
v_lshlrev_b32 v236, 16, v186
v_and_b32 v237, 0xffff0000, v186
v_pk_mul_f32 v[60:61], v[60:61], v[194:195]
v_pk_mul_f32 v[62:63], v[62:63], v[196:197]
v_pk_mul_f32 v[190:191], v[190:191], v[198:199]
v_pk_mul_f32 v[192:193], v[192:193], v[236:237]
s_mov_b32 exec_hi, 0xff
v_cvt_pk_bf16_f32 v238, v192, v190
v_cvt_pk_bf16_f32 v239, v62, v60
ds_write_b64 v202, v[238:239] offset:0
v_cvt_pk_bf16_f32 v240, v193, v191
v_cvt_pk_bf16_f32 v241, v63, v61
ds_write_b64 v202, v[240:241] offset:144
s_mov_b64 exec, -1
v_lshlrev_b32 v194, 16, v9
v_and_b32 v195, 0xffff0000, v9
v_lshlrev_b32 v196, 16, v13
v_and_b32 v197, 0xffff0000, v13
v_lshlrev_b32 v198, 16, v17
v_and_b32 v199, 0xffff0000, v17
v_lshlrev_b32 v236, 16, v21
v_and_b32 v237, 0xffff0000, v21
v_lshlrev_b32 v238, 16, v25
v_and_b32 v239, 0xffff0000, v25
v_lshlrev_b32 v240, 16, v29
v_and_b32 v241, 0xffff0000, v29
v_lshlrev_b32 v242, 16, v33
v_and_b32 v243, 0xffff0000, v33
v_lshlrev_b32 v52, 16, v40
v_lshlrev_b32 v53, 16, v42
v_and_b32 v54, 0xffff0000, v40
v_and_b32 v55, 0xffff0000, v42
v_lshlrev_b32 v56, 16, v41
v_lshlrev_b32 v57, 16, v43
v_and_b32 v58, 0xffff0000, v41
v_and_b32 v59, 0xffff0000, v43
v_pk_mul_f32 v[60:61], v[236:237], v[52:53]
v_pk_mul_f32 v[62:63], v[238:239], v[52:53]
v_pk_mul_f32 v[190:191], v[240:241], v[52:53]
v_pk_mul_f32 v[192:193], v[242:243], v[52:53]
v_pk_fma_f32 v[60:61], v[198:199], v[54:55], v[60:61]
v_pk_fma_f32 v[62:63], v[236:237], v[54:55], v[62:63]
v_pk_fma_f32 v[190:191], v[238:239], v[54:55], v[190:191]
v_pk_fma_f32 v[192:193], v[240:241], v[54:55], v[192:193]
v_pk_fma_f32 v[60:61], v[196:197], v[56:57], v[60:61]
v_pk_fma_f32 v[62:63], v[198:199], v[56:57], v[62:63]
v_pk_fma_f32 v[190:191], v[236:237], v[56:57], v[190:191]
v_pk_fma_f32 v[192:193], v[238:239], v[56:57], v[192:193]
v_pk_fma_f32 v[60:61], v[194:195], v[58:59], v[60:61]
v_pk_fma_f32 v[62:63], v[196:197], v[58:59], v[62:63]
v_pk_fma_f32 v[190:191], v[198:199], v[58:59], v[190:191]
v_pk_fma_f32 v[192:193], v[236:237], v[58:59], v[192:193]
v_lshlrev_b32 v194, 16, v175
v_and_b32 v195, 0xffff0000, v175
v_lshlrev_b32 v196, 16, v179
v_and_b32 v197, 0xffff0000, v179
v_lshlrev_b32 v198, 16, v183
v_and_b32 v199, 0xffff0000, v183
v_lshlrev_b32 v236, 16, v187
v_and_b32 v237, 0xffff0000, v187
v_pk_mul_f32 v[60:61], v[60:61], v[194:195]
v_pk_mul_f32 v[62:63], v[62:63], v[196:197]
v_pk_mul_f32 v[190:191], v[190:191], v[198:199]
v_pk_mul_f32 v[192:193], v[192:193], v[236:237]
s_mov_b32 exec_hi, 0xff
v_cvt_pk_bf16_f32 v238, v192, v190
v_cvt_pk_bf16_f32 v239, v62, v60
ds_write_b64 v202, v[238:239] offset:288
v_cvt_pk_bf16_f32 v240, v193, v191
v_cvt_pk_bf16_f32 v241, v63, v61
ds_write_b64 v202, v[240:241] offset:432
s_mov_b64 exec, -1
v_lshlrev_b32 v194, 16, v10
v_and_b32 v195, 0xffff0000, v10
v_lshlrev_b32 v196, 16, v14
v_and_b32 v197, 0xffff0000, v14
v_lshlrev_b32 v198, 16, v18
v_and_b32 v199, 0xffff0000, v18
v_lshlrev_b32 v236, 16, v22
v_and_b32 v237, 0xffff0000, v22
v_lshlrev_b32 v238, 16, v26
v_and_b32 v239, 0xffff0000, v26
v_lshlrev_b32 v240, 16, v30
v_and_b32 v241, 0xffff0000, v30
v_lshlrev_b32 v242, 16, v34
v_and_b32 v243, 0xffff0000, v34
v_lshlrev_b32 v52, 16, v44
v_lshlrev_b32 v53, 16, v46
v_and_b32 v54, 0xffff0000, v44
v_and_b32 v55, 0xffff0000, v46
v_lshlrev_b32 v56, 16, v45
v_lshlrev_b32 v57, 16, v47
v_and_b32 v58, 0xffff0000, v45
v_and_b32 v59, 0xffff0000, v47
v_pk_mul_f32 v[60:61], v[236:237], v[52:53]
v_pk_mul_f32 v[62:63], v[238:239], v[52:53]
v_pk_mul_f32 v[190:191], v[240:241], v[52:53]
v_pk_mul_f32 v[192:193], v[242:243], v[52:53]
v_pk_fma_f32 v[60:61], v[198:199], v[54:55], v[60:61]
v_pk_fma_f32 v[62:63], v[236:237], v[54:55], v[62:63]
v_pk_fma_f32 v[190:191], v[238:239], v[54:55], v[190:191]
v_pk_fma_f32 v[192:193], v[240:241], v[54:55], v[192:193]
v_pk_fma_f32 v[60:61], v[196:197], v[56:57], v[60:61]
v_pk_fma_f32 v[62:63], v[198:199], v[56:57], v[62:63]
v_pk_fma_f32 v[190:191], v[236:237], v[56:57], v[190:191]
v_pk_fma_f32 v[192:193], v[238:239], v[56:57], v[192:193]
v_pk_fma_f32 v[60:61], v[194:195], v[58:59], v[60:61]
v_pk_fma_f32 v[62:63], v[196:197], v[58:59], v[62:63]
v_pk_fma_f32 v[190:191], v[198:199], v[58:59], v[190:191]
v_pk_fma_f32 v[192:193], v[236:237], v[58:59], v[192:193]
v_lshlrev_b32 v194, 16, v176
v_and_b32 v195, 0xffff0000, v176
v_lshlrev_b32 v196, 16, v180
v_and_b32 v197, 0xffff0000, v180
v_lshlrev_b32 v198, 16, v184
v_and_b32 v199, 0xffff0000, v184
v_lshlrev_b32 v236, 16, v188
v_and_b32 v237, 0xffff0000, v188
v_pk_mul_f32 v[60:61], v[60:61], v[194:195]
v_pk_mul_f32 v[62:63], v[62:63], v[196:197]
v_pk_mul_f32 v[190:191], v[190:191], v[198:199]
v_pk_mul_f32 v[192:193], v[192:193], v[236:237]
s_mov_b32 exec_hi, 0xff
v_cvt_pk_bf16_f32 v238, v192, v190
v_cvt_pk_bf16_f32 v239, v62, v60
ds_write_b64 v202, v[238:239] offset:576
v_cvt_pk_bf16_f32 v240, v193, v191
v_cvt_pk_bf16_f32 v241, v63, v61
ds_write_b64 v202, v[240:241] offset:720
s_mov_b64 exec, -1
v_lshlrev_b32 v194, 16, v11
v_and_b32 v195, 0xffff0000, v11
v_lshlrev_b32 v196, 16, v15
v_and_b32 v197, 0xffff0000, v15
v_lshlrev_b32 v198, 16, v19
v_and_b32 v199, 0xffff0000, v19
v_lshlrev_b32 v236, 16, v23
v_and_b32 v237, 0xffff0000, v23
v_lshlrev_b32 v238, 16, v27
v_and_b32 v239, 0xffff0000, v27
v_lshlrev_b32 v240, 16, v31
v_and_b32 v241, 0xffff0000, v31
v_lshlrev_b32 v242, 16, v35
v_and_b32 v243, 0xffff0000, v35
v_lshlrev_b32 v52, 16, v48
v_lshlrev_b32 v53, 16, v50
v_and_b32 v54, 0xffff0000, v48
v_and_b32 v55, 0xffff0000, v50
v_lshlrev_b32 v56, 16, v49
v_lshlrev_b32 v57, 16, v51
v_and_b32 v58, 0xffff0000, v49
v_and_b32 v59, 0xffff0000, v51
v_pk_mul_f32 v[60:61], v[236:237], v[52:53]
v_pk_mul_f32 v[62:63], v[238:239], v[52:53]
v_pk_mul_f32 v[190:191], v[240:241], v[52:53]
v_pk_mul_f32 v[192:193], v[242:243], v[52:53]
v_pk_fma_f32 v[60:61], v[198:199], v[54:55], v[60:61]
v_pk_fma_f32 v[62:63], v[236:237], v[54:55], v[62:63]
v_pk_fma_f32 v[190:191], v[238:239], v[54:55], v[190:191]
v_pk_fma_f32 v[192:193], v[240:241], v[54:55], v[192:193]
v_pk_fma_f32 v[60:61], v[196:197], v[56:57], v[60:61]
v_pk_fma_f32 v[62:63], v[198:199], v[56:57], v[62:63]
v_pk_fma_f32 v[190:191], v[236:237], v[56:57], v[190:191]
v_pk_fma_f32 v[192:193], v[238:239], v[56:57], v[192:193]
v_pk_fma_f32 v[60:61], v[194:195], v[58:59], v[60:61]
v_pk_fma_f32 v[62:63], v[196:197], v[58:59], v[62:63]
v_pk_fma_f32 v[190:191], v[198:199], v[58:59], v[190:191]
v_pk_fma_f32 v[192:193], v[236:237], v[58:59], v[192:193]
v_lshlrev_b32 v194, 16, v177
v_and_b32 v195, 0xffff0000, v177
v_lshlrev_b32 v196, 16, v181
v_and_b32 v197, 0xffff0000, v181
v_lshlrev_b32 v198, 16, v185
v_and_b32 v199, 0xffff0000, v185
v_lshlrev_b32 v236, 16, v189
v_and_b32 v237, 0xffff0000, v189
v_pk_mul_f32 v[60:61], v[60:61], v[194:195]
v_pk_mul_f32 v[62:63], v[62:63], v[196:197]
v_pk_mul_f32 v[190:191], v[190:191], v[198:199]
v_pk_mul_f32 v[192:193], v[192:193], v[236:237]
s_mov_b32 exec_hi, 0xff
v_cvt_pk_bf16_f32 v238, v192, v190
v_cvt_pk_bf16_f32 v239, v62, v60
ds_write_b64 v202, v[238:239] offset:864
v_cvt_pk_bf16_f32 v240, v193, v191
v_cvt_pk_bf16_f32 v241, v63, v61
ds_write_b64 v202, v[240:241] offset:1008
s_mov_b64 exec, -1
s_waitcnt lgkmcnt(0)
s_barrier
ds_read_b128 v[8:11], v203 offset:0
ds_read_b128 v[12:15], v203 offset:1152
ds_read_b128 v[16:19], v203 offset:2304
s_waitcnt lgkmcnt(0)
buffer_store_dwordx4 v[8:11], v172, s[24:27], s70 offen sc1
buffer_store_dwordx4 v[12:15], v172, s[24:27], s71 offen sc1
s_mov_b32 exec_hi, 0
buffer_store_dwordx4 v[16:19], v172, s[24:27], s72 offen sc1
s_mov_b64 exec, -1
buffer_load_dword v254, v229, s[24:27], 0 offen sc1
s_waitcnt vmcnt(1)
s_barrier
s_cmp_lg_u32 s5, 0
s_cbranch_scc1 L_fl_49
s_mov_b64 exec, 1
buffer_store_dword v253, v252, s[24:27], 0 offen offset:0 sc1
s_mov_b64 exec, -1
L_fl_49:
s_waitcnt vmcnt(0)
v_cmp_eq_u32 vcc, 0, v254
s_cbranch_vccnz L_slow_50
L_back_51:
v_mov_b32 v60, 2147418112
s_mov_b32 s100, 0
s_mov_b32 s101, 0
s_lshl_b32 s6, s5, 2
v_lshlrev_b32 v202, 2, v1
v_add_u32 v202, s6, v202
v_subrev_u32 v202, 252, v202
v_add_u32 v203, s6, v248
v_add_u32 v203, 4, v203
s_mul_i32 s90, s5, 4416
s_add_u32 s6, s88, 0
s_lshl_b32 s6, s6, 12
s_add_u32 s32, s48, s6
s_addc_u32 s33, s49, 0
s_and_b32 s33, s33, 0xffff
s_mov_b32 s34, 4096
s_mov_b32 s35, 0x20000
s_add_u32 m0, s90, 65536
s_nop 0
buffer_load_dword v202, s[32:35], 0 offen lds
s_add_u32 m0, s90, 65792
s_nop 0
buffer_load_dwordx4 v203, s[32:35], 0 offen offset:0 lds
buffer_load_dwordx4 v203, s[32:35], 0 offen offset:1024 lds
buffer_load_dwordx4 v203, s[32:35], 0 offen offset:2048 lds
buffer_load_dwordx4 v203, s[32:35], 0 offen offset:3072 lds
s_add_u32 s6, s88, 1
s_lshl_b32 s6, s6, 12
s_add_u32 s32, s48, s6
s_addc_u32 s33, s49, 0
s_and_b32 s33, s33, 0xffff
s_mov_b32 s34, 4096
s_mov_b32 s35, 0x20000
s_add_u32 m0, s90, 95744
s_nop 0
buffer_load_dword v202, s[32:35], 0 offen lds
s_add_u32 m0, s90, 96000
s_nop 0
buffer_load_dwordx4 v203, s[32:35], 0 offen offset:0 lds
buffer_load_dwordx4 v203, s[32:35], 0 offen offset:1024 lds
buffer_load_dwordx4 v203, s[32:35], 0 offen offset:2048 lds
buffer_load_dwordx4 v203, s[32:35], 0 offen offset:3072 lds
s_add_u32 s6, s88, 2
s_lshl_b32 s6, s6, 12
s_add_u32 s32, s48, s6
s_addc_u32 s33, s49, 0
s_and_b32 s33, s33, 0xffff
s_mov_b32 s34, 4096
s_mov_b32 s35, 0x20000
s_add_u32 m0, s90, 125952
s_nop 0
buffer_load_dword v202, s[32:35], 0 offen lds
s_add_u32 m0, s90, 126208
s_nop 0
buffer_load_dwordx4 v203, s[32:35], 0 offen offset:0 lds
buffer_load_dwordx4 v203, s[32:35], 0 offen offset:1024 lds
buffer_load_dwordx4 v203, s[32:35], 0 offen offset:2048 lds
buffer_load_dwordx4 v203, s[32:35], 0 offen offset:3072 lds
v_lshlrev_b32 v4, 4, v0
s_add_u32 s6, s88, 0
s_lshl_b32 s6, s6, 12
s_add_u32 s6, s6, 1048576
s_add_u32 s36, s66, s6
s_addc_u32 s37, s67, 0
s_and_b32 s37, s37, 0xffff
s_mov_b32 s38, 4096
s_mov_b32 s39, 0x20000
buffer_load_dwordx4 v[32:35], v4, s[36:39], 0 offen
buffer_load_dword v36, v4, s[36:39], 0 offen offset:16
s_add_u32 s6, s88, 1
s_lshl_b32 s6, s6, 12
s_add_u32 s6, s6, 1048576
s_add_u32 s36, s66, s6
s_addc_u32 s37, s67, 0
s_and_b32 s37, s37, 0xffff
s_mov_b32 s38, 4096
s_mov_b32 s39, 0x20000
buffer_load_dwordx4 v[38:41], v4, s[36:39], 0 offen
buffer_load_dword v42, v4, s[36:39], 0 offen offset:16
s_add_u32 s6, s88, 2
s_lshl_b32 s6, s6, 12
s_add_u32 s6, s6, 1048576
s_add_u32 s36, s66, s6
s_addc_u32 s37, s67, 0
s_and_b32 s37, s37, 0xffff
s_mov_b32 s38, 4096
s_mov_b32 s39, 0x20000
buffer_load_dwordx4 v[44:47], v4, s[36:39], 0 offen
buffer_load_dword v48, v4, s[36:39], 0 offen offset:16
buffer_load_dword v254, v228, s[24:27], 0 offen sc1
v_lshlrev_b32 v5, 4, v0
v_add_u32 v5, 87552, v5
v_add_u32 v7, 60416, v5
v_mov_b32 v12, 0
v_mov_b32 v13, 0
v_mov_b32 v14, 0
v_mov_b32 v15, 0
v_cmp_gt_u32 vcc, 119, v0
s_and_saveexec_b64 s[6:7], vcc
ds_write_b128 v5, v[12:15] offset:0
ds_write_b128 v5, v[12:15] offset:6272
ds_write_b128 v5, v[12:15] offset:30208
ds_write_b128 v5, v[12:15] offset:36480
ds_write_b128 v7, v[12:15] offset:0
ds_write_b128 v7, v[12:15] offset:6272
s_mov_b64 exec, s[6:7]
v_lshrrev_b32 v4, 4, v0
v_mul_u32_u24 v4, 272, v4
v_and_b32 v5, 15, v0
v_lshl_add_u32 v4, v5, 4, v4
v_add_u32 v4, 83200, v4
v_add_u32 v6, 60416, v4
s_waitcnt vmcnt(1)
ds_write_b128 v4, v[32:35] offset:6272
v_alignbit_b32 v12, v33, v32, 16
v_alignbit_b32 v13, v34, v33, 16
v_alignbit_b32 v14, v35, v34, 16
v_alignbit_b32 v15, v36, v35, 16
ds_write_b128 v4, v[12:15] offset:0
ds_write_b128 v4, v[38:41] offset:36480
v_alignbit_b32 v12, v39, v38, 16
v_alignbit_b32 v13, v40, v39, 16
v_alignbit_b32 v14, v41, v40, 16
v_alignbit_b32 v15, v42, v41, 16
ds_write_b128 v4, v[12:15] offset:30208
ds_write_b128 v6, v[44:47] offset:6272
v_alignbit_b32 v12, v45, v44, 16
v_alignbit_b32 v13, v46, v45, 16
v_alignbit_b32 v14, v47, v46, 16
v_alignbit_b32 v15, v48, v47, 16
ds_write_b128 v6, v[12:15] offset:0
s_waitcnt vmcnt(0)
v_cmp_eq_u32 vcc, 0, v254
s_cbranch_vccnz L_slow_52
L_back_53:
s_lshr_b32 s6, s4, 3
s_mul_i32 s6, s6, 14
s_and_b32 s7, s4, 7
s_mul_i32 s7, s7, 7
s_add_u32 s6, s6, s7
s_lshr_b32 s6, s6, 2
s_cmp_ge_u32 s5, 2
s_cselect_b32 s43, 13, 14
s_cmp_ge_u32 s6, s43
s_cselect_b32 s7, s43, 0
s_sub_u32 s93, s6, s7
s_mov_b32 s93, 0
s_mul_i32 s6, s95, 54
s_add_u32 s6, s6, s96
s_mul_i32 s79, s6, 5120
s_add_u32 s79, s79, 7340032
s_mul_i32 s7, s43, 5120
s_add_u32 s80, s79, s7
s_mul_i32 s7, s93, 5120
s_add_u32 s97, s79, s7
s_add_u32 s98, s97, 4096
buffer_load_dwordx4 a[0:3], v248, s[24:27], s97 offen offset:0
buffer_load_dwordx4 a[4:7], v248, s[24:27], s97 offen offset:1024
buffer_load_dwordx4 a[8:11], v248, s[24:27], s97 offen offset:2048
buffer_load_dwordx4 a[12:15], v248, s[24:27], s97 offen offset:3072
buffer_load_dwordx4 a[16:19], v248, s[24:27], s98 offen
s_add_u32 s97, s97, 5120
s_cmp_eq_u32 s97, s80
s_cselect_b32 s97, s79, s97
s_add_u32 s98, s97, 4096
buffer_load_dwordx4 a[20:23], v248, s[24:27], s97 offen offset:0
buffer_load_dwordx4 a[24:27], v248, s[24:27], s97 offen offset:1024
buffer_load_dwordx4 a[28:31], v248, s[24:27], s97 offen offset:2048
buffer_load_dwordx4 a[32:35], v248, s[24:27], s97 offen offset:3072
buffer_load_dwordx4 a[36:39], v248, s[24:27], s98 offen
s_add_u32 s97, s97, 5120
s_cmp_eq_u32 s97, s80
s_cselect_b32 s97, s79, s97
s_add_u32 s98, s97, 4096
buffer_load_dwordx4 a[40:43], v248, s[24:27], s97 offen offset:0
buffer_load_dwordx4 a[44:47], v248, s[24:27], s97 offen offset:1024
buffer_load_dwordx4 a[48:51], v248, s[24:27], s97 offen offset:2048
buffer_load_dwordx4 a[52:55], v248, s[24:27], s97 offen offset:3072
buffer_load_dwordx4 a[56:59], v248, s[24:27], s98 offen
s_add_u32 s97, s97, 5120
s_cmp_eq_u32 s97, s80
s_cselect_b32 s97, s79, s97
s_add_u32 s98, s97, 4096
buffer_load_dwordx4 a[60:63], v248, s[24:27], s97 offen offset:0
buffer_load_dwordx4 a[64:67], v248, s[24:27], s97 offen offset:1024
buffer_load_dwordx4 a[68:71], v248, s[24:27], s97 offen offset:2048
buffer_load_dwordx4 a[72:75], v248, s[24:27], s97 offen offset:3072
buffer_load_dwordx4 a[76:79], v248, s[24:27], s98 offen
s_add_u32 s97, s97, 5120
s_cmp_eq_u32 s97, s80
s_cselect_b32 s97, s79, s97
s_add_u32 s98, s97, 4096
s_lshl_b32 s6, s89, 2
s_add_u32 s6, s6, s5
s_lshl_b32 s7, s6, 1
s_lshr_b32 s85, 6436, s7
s_and_b32 s85, s85, 3
s_lshr_b32 s86, 55, s6
s_and_b32 s86, s86, 1
s_lshr_b32 s87, 61311, s7
s_and_b32 s87, s87, 3
v_and_b32 v2, 3, v1
v_mul_u32_u24 v2, 4416, v2
v_bfe_u32 v3, v1, 2, 2
v_lshrrev_b32 v18, 4, v1
v_add_u32 v3, v3, v18
v_lshl_add_u32 v16, v3, 4, v2
v_and_b32 v2, 1, v1
v_mul_u32_u24 v2, 6272, v2
v_bfe_u32 v3, v1, 1, 3
s_lshl_b32 s6, s86, 3
s_sub_u32 s6, 15, s6
v_sub_u32 v5, s6, v3
v_mul_u32_u24 v5, 272, v5
v_add_u32 v2, v2, v5
v_lshl_add_u32 v17, v18, 4, v2
s_lshl_b32 s6, s86, 3
v_add_u32 v3, s6, v3
v_lshlrev_b32 v3, 8, v3
v_and_b32 v2, 1, v1
v_lshl_or_b32 v2, v18, 1, v2
v_lshl_or_b32 v11, v2, 4, v3
s_mul_i32 s6, s85, 30208
s_add_u32 s6, s6, 65536
v_add_u32 v8, s6, v16
s_add_u32 s6, s6, 17664
v_add_u32 v9, s6, v17
v_lshlrev_b32 v10, 5, v18
v_sub_u32 v10, v9, v10
v_add_u32 v10, 0, v10
s_add_u32 s91, s88, s85
s_branch L_conv
L_slow_11:
s_add_u32 s42, s42, 1
s_cmp_gt_u32 s42, 200000
s_cbranch_scc1 L_back_12
buffer_load_dword v254, v230, s[52:55], 0 offen sc1
s_waitcnt vmcnt(0)
v_cmp_gt_u32 vcc, 32, v254
s_cbranch_vccnz L_slow_11
s_branch L_back_12
L_slow_20:
s_add_u32 s42, s42, 1
s_cmp_gt_u32 s42, 200000
s_cbranch_scc1 L_back_21
buffer_load_dword v254, v231, s[24:27], 0 offen sc1
s_waitcnt vmcnt(0)
v_cmp_eq_u32 vcc, 0, v254
s_cbranch_vccnz L_slow_20
s_branch L_back_21
L_slow_27:
s_add_u32 s42, s42, 1
s_cmp_gt_u32 s42, 200000
s_cbranch_scc1 L_back_28
buffer_load_dword v251, v229, s[24:27], 0 offen sc1
s_waitcnt vmcnt(0)
v_cmp_eq_u32 vcc, 0, v251
s_cbranch_vccnz L_slow_27
s_branch L_back_28
L_slow_29:
s_add_u32 s42, s42, 1
s_cmp_gt_u32 s42, 200000
s_cbranch_scc1 L_back_30
buffer_load_dword v254, v228, s[24:27], 0 offen sc1
s_waitcnt vmcnt(0)
v_cmp_eq_u32 vcc, 0, v254
s_cbranch_vccnz L_slow_29
s_branch L_back_30
L_slow_34:
s_add_u32 s42, s42, 1
s_cmp_gt_u32 s42, 200000
s_cbranch_scc1 L_back_35
buffer_load_dword v254, v249, s[24:27], 0 offen sc1
s_waitcnt vmcnt(0)
v_cmp_eq_u32 vcc, 0, v254
s_cbranch_vccnz L_slow_34
s_branch L_back_35
L_slow_41:
s_add_u32 s42, s42, 1
s_cmp_gt_u32 s42, 200000
s_cbranch_scc1 L_back_42
buffer_load_dword v254, v250, s[24:27], 0 offen sc1
s_waitcnt vmcnt(0)
v_cmp_eq_u32 vcc, 0, v254
s_cbranch_vccnz L_slow_41
s_branch L_back_42
L_slow_47:
s_add_u32 s42, s42, 1
s_cmp_gt_u32 s42, 200000
s_cbranch_scc1 L_back_48
buffer_load_dword v254, v230, s[52:55], 0 offen sc1
s_waitcnt vmcnt(0)
v_cmp_gt_u32 vcc, 32, v254
s_cbranch_vccnz L_slow_47
s_branch L_back_48
L_slow_50:
s_add_u32 s42, s42, 1
s_cmp_gt_u32 s42, 200000
s_cbranch_scc1 L_back_51
buffer_load_dword v254, v229, s[24:27], 0 offen sc1
s_waitcnt vmcnt(0)
v_cmp_eq_u32 vcc, 0, v254
s_cbranch_vccnz L_slow_50
s_branch L_back_51
L_slow_52:
s_add_u32 s42, s42, 1
s_cmp_gt_u32 s42, 200000
s_cbranch_scc1 L_back_53
buffer_load_dword v254, v228, s[24:27], 0 offen sc1
s_waitcnt vmcnt(0)
v_cmp_eq_u32 vcc, 0, v254
s_cbranch_vccnz L_slow_52
s_branch L_back_53
L_code_end:
.section .rodata,"a"
.p2align 6
.amdhsa_kernel recurrent_scan__ssm_conv_h3__dense_activation_gelu__prompt_kernel
  .amdhsa_next_free_vgpr 512
  .amdhsa_next_free_sgpr 102
  .amdhsa_accum_offset 256
  .amdhsa_group_segment_fixed_size 0
  .amdhsa_kernarg_size 112
  .amdhsa_user_sgpr_count 2
  .amdhsa_user_sgpr_kernarg_segment_ptr 1
  .amdhsa_system_sgpr_workgroup_id_x 1
.end_amdhsa_kernel
```

```asm
; @launch grid=(256,1,1) block=(256,1,1) lds=163840
.amdgcn_target "amdgcn-amd-amdhsa--gfx950"
.text
.globl recurrent_scan__ssm_conv_h3__dense_activation_gelu__prompt_kernel
.p2align 8
.type recurrent_scan__ssm_conv_h3__dense_activation_gelu__prompt_kernel,@function
recurrent_scan__ssm_conv_h3__dense_activation_gelu__prompt_kernel:
s_cmp_ge_u32 s2, 256
s_cbranch_scc1 L_end
s_load_dwordx16 s[40:55], s[0:1], 0
s_load_dwordx8 s[56:63], s[0:1], 64
s_load_dwordx4 s[64:67], s[0:1], 96
s_and_b32 s3, s2, 7
s_lshr_b32 s4, s2, 3
v_lshrrev_b32 v1, 6, v0
v_and_b32 v0, 0xff, v0
v_mov_b32 v253, 1
v_readfirstlane_b32 s5, v1
v_and_b32 v1, 63, v0
s_lshl_b32 s6, s2, 7
v_mov_b32 v252, s6
v_lshlrev_b32 v248, 4, v1
v_and_b32 v230, 7, v1
v_lshlrev_b32 v230, 5, v230
v_mov_b32 v255, 0
s_cmp_ge_u32 s4, 28
s_cbranch_scc1 L_spare
s_and_b32 s6, s3, 3
s_lshl_b32 s6, s6, 2
s_and_b32 s7, s4, 3
s_add_u32 s77, s6, s7
s_lshr_b32 s6, s3, 2
s_mul_i32 s6, s6, 7
s_lshr_b32 s7, s4, 2
s_add_u32 s78, s6, s7
s_and_b32 s82, s5, 1
s_lshr_b32 s83, s5, 1
s_lshl_b32 s6, s3, 4
s_lshr_b32 s7, s4, 1
s_add_u32 s6, s6, s7
s_mul_i32 s6, s6, 5
s_and_b32 s89, s4, 1
s_lshl_b32 s7, s89, 1
s_add_u32 s88, s6, s7
s_and_b32 s6, s3, 3
s_lshl_b32 s6, s6, 3
s_and_b32 s7, s4, 7
s_add_u32 s94, s6, s7
s_lshr_b32 s6, s3, 2
s_xor_b32 s6, s6, 1
s_lshl_b32 s6, s6, 2
s_lshr_b32 s7, s4, 3
s_add_u32 s95, s6, s7
s_mul_i32 s96, s5, 14
s_cmp_eq_u32 s5, 3
s_cselect_b32 s6, 1, 0
s_sub_u32 s96, s96, s6
s_lshr_b32 s6, s4, 3
s_lshl_b32 s7, s3, 2
s_add_u32 s68, s6, s7
s_and_b32 s69, s4, 7
v_mul_u32_u24 v2, 26, v1
v_lshrrev_b32 v2, 8, v2
v_mul_u32_u24 v3, 10, v2
v_sub_u32 v3, v1, v3
s_lshl_b32 s6, s68, 6
s_lshl_b32 s7, s5, 4
s_add_u32 s6, s6, s7
s_mul_i32 s6, s6, 1280
s_mul_i32 s7, s69, 160
s_add_u32 s6, s6, s7
v_mul_u32_u24 v4, 5120, v2
v_lshl_add_u32 v4, v3, 4, v4
v_add_u32 v244, s6, v4
v_subrev_u32 v245, 3840, v244
s_mul_i32 s92, s69, 640
s_mul_i32 s7, s5, 2560
s_add_u32 s7, s7, 142592
s_mov_b32 m0, s7
v_lshl_add_u32 v247, v3, 6, s7
s_lshl_b32 s7, s5, 5
s_sub_u32 s7, 131192, s7
v_mul_u32_u24 v4, 1152, v3
v_lshlrev_b32 v2, 3, v2
v_sub_u32 v4, v4, v2
v_add_u32 v202, s7, v4
v_lshrrev_b32 v2, 3, v1
s_mul_i32 s6, s5, 20
v_add_u32 v2, s6, v2
v_and_b32 v3, 7, v1
v_lshlrev_b32 v3, 4, v3
v_mul_u32_u24 v4, 144, v2
v_add_u32 v4, v4, v3
v_add_u32 v203, 131072, v4
v_lshl_add_u32 v172, v2, 12, v3
s_mul_i32 s6, s69, 327680
s_lshl_b32 s7, s68, 7
s_sub_u32 s6, s6, s7
s_add_u32 s70, s6, 1052544
s_add_u32 s71, s70, 32768
s_add_u32 s72, s70, 65536
s_lshl_b32 s79, s78, 8
s_mul_i32 s80, s77, 163840
s_lshl_b32 s81, s5, 12
v_lshrrev_b32 v2, 4, v1
v_and_b32 v3, 15, v1
v_lshlrev_b32 v4, 2, v2
v_xor_b32 v4, v3, v4
s_lshl_b32 s6, s5, 4
v_add_u32 v5, s6, v2
v_mul_u32_u24 v5, 3456, v5
v_lshl_add_u32 v208, v4, 4, v5
s_cmp_eq_u32 s78, 13
s_cselect_b32 s7, 8, 16
v_cmp_le_u32 vcc, s7, v4
v_mov_b32 v6, 2147418112
v_cndmask_b32 v208, v208, v6, vcc
v_add_u32 v209, 12800, v208
v_add_u32 v210, 25600, v208
v_add_u32 v211, 38400, v208
v_lshrrev_b32 v4, 3, v1
v_and_b32 v5, 7, v1
s_lshl_b32 s6, s5, 5
v_add_u32 v4, s6, v4
v_mul_u32_u24 v4, 1280, v4
v_add_u32 v6, 0, v2
v_xor_b32 v6, v5, v6
v_lshl_add_u32 v6, v6, 4, v4
v_add_u32 v212, 0, v6
v_add_u32 v6, 4, v2
v_xor_b32 v6, v5, v6
v_lshl_add_u32 v6, v6, 4, v4
v_add_u32 v213, 9216, v6
v_add_u32 v6, 0, v2
v_xor_b32 v6, v5, v6
v_lshl_add_u32 v6, v6, 4, v4
v_add_u32 v214, 18432, v6
v_add_u32 v6, 4, v2
v_xor_b32 v6, v5, v6
v_lshl_add_u32 v6, v6, 4, v4
v_add_u32 v215, 27648, v6
s_lshl_b32 s6, s4, 2
s_add_u32 s6, s6, s5
s_lshl_b32 s7, s6, 3
v_and_b32 v2, 7, v1
v_add_u32 v2, s7, v2
v_lshrrev_b32 v3, 3, v1
v_mul_u32_u24 v4, 4682, v2
v_lshrrev_b32 v4, 16, v4
v_mul_u32_u24 v5, 14, v4
v_sub_u32 v5, v2, v5
v_lshl_add_u32 v4, v3, 6, v4
v_mul_u32_u24 v4, 3456, v4
v_lshl_add_u32 v4, v5, 7, v4
s_lshr_b32 s7, s3, 2
s_mul_i32 s73, s7, 1792
v_add_u32 v4, s73, v4
s_sub_u32 s7, 13, s7
v_mov_b32 v6, 2147418112
v_cmp_lt_u32 vcc, s7, v5
v_cndmask_b32 v232, v4, v6, vcc
v_mul_u32_u24 v2, 52, v1
v_lshrrev_b32 v2, 8, v2
v_mul_u32_u24 v3, 5, v2
v_sub_u32 v3, v1, v3
s_mul_i32 s7, s6, 5
v_add_u32 v3, s7, v3
v_cmp_gt_u32 vcc, 512, v3
s_and_b32 s7, s3, 3
s_lshl_b32 s7, s7, 9
v_add_u32 v3, s7, v3
v_mul_u32_u24 v3, 1280, v3
v_lshl_add_u32 v3, v2, 7, v3
v_cndmask_b32 v233, v6, v3, vcc
s_lshl_b32 s6, s68, 6
s_lshl_b32 s7, s5, 4
s_add_u32 s6, s6, s7
s_mul_i32 s6, s6, 1280
s_mul_i32 s7, s69, 160
s_and_b32 s7, s7, 0xffffff80
s_add_u32 s6, s6, s7
v_lshrrev_b32 v2, 1, v1
v_mul_u32_u24 v2, 1280, v2
v_and_b32 v3, 1, v1
v_lshl_add_u32 v2, v3, 7, v2
v_add_u32 v129, s6, v2
v_subrev_u32 v128, 3840, v129
s_mul_i32 s7, s69, 640
v_lshlrev_b32 v2, 7, v1
v_add_u32 v130, s7, v2
s_waitcnt lgkmcnt(0)
s_mov_b32 s24, s66
s_and_b32 s25, s67, 0xffff
s_mov_b32 s26, 17825792
s_mov_b32 s27, 0x20000
s_lshl_b32 s6, s88, 1
s_and_b32 s6, s6, 0xfffffffc
s_load_dwordx2 s[0:1], s[50:51], s6
s_cmp_lg_u32 s5, 0
s_cbranch_scc1 L_clr_1
v_lshl_add_u32 v2, v1, 2, v252
v_mov_b32 v3, 0
s_mov_b64 exec, 0xff
buffer_store_dword v3, v2, s[24:27], 0 offen sc1
s_mov_b64 exec, -1
L_clr_1:
s_mov_b32 s12, s42
s_and_b32 s13, s43, 0xffff
s_mov_b32 s14, 2621440
s_mov_b32 s15, 0x20000
s_mov_b32 s16, s44
s_and_b32 s17, s45, 0xffff
s_mov_b32 s18, 2621440
s_mov_b32 s19, 0x20000
s_mov_b32 s32, s46
s_and_b32 s33, s47, 0xffff
s_mov_b32 s34, 5120
s_mov_b32 s35, 0x20000
s_mov_b32 exec_hi, 0xff
buffer_load_dwordx4 v[8:11], v245, s[12:15], 0 offen offset:0
buffer_load_dwordx4 v[12:15], v245, s[12:15], 0 offen offset:1280
buffer_load_dwordx4 v[16:19], v245, s[12:15], 0 offen offset:2560
buffer_load_dwordx4 v[20:23], v244, s[12:15], 0 offen offset:0
buffer_load_dwordx4 v[24:27], v244, s[12:15], 0 offen offset:1280
buffer_load_dwordx4 v[28:31], v244, s[12:15], 0 offen offset:2560
buffer_load_dwordx4 v[32:35], v244, s[12:15], 0 offen offset:3840
buffer_load_dwordx4 v248, s[32:35], s92 offen lds
buffer_load_dwordx4 v[174:177], v244, s[16:19], 0 offen offset:0
buffer_load_dwordx4 v[178:181], v244, s[16:19], 0 offen offset:1280
buffer_load_dwordx4 v[182:185], v244, s[16:19], 0 offen offset:2560
buffer_load_dwordx4 v[186:189], v244, s[16:19], 0 offen offset:3840
s_mov_b64 exec, -1
s_mov_b32 s20, s54
s_and_b32 s21, s55, 0xffff
s_mov_b32 s22, 2211840
s_mov_b32 s23, 0x20000
s_mov_b32 s8, s40
s_and_b32 s9, s41, 0xffff
s_mov_b32 s10, 2621440
s_mov_b32 s11, 0x20000
s_mov_b32 s28, s62
s_and_b32 s29, s63, 0xffff
s_mov_b32 s30, 2621440
s_mov_b32 s31, 0x20000
s_mov_b32 s52, s64
s_and_b32 s53, s65, 0xffff
s_mov_b32 s54, 256
s_mov_b32 s55, 0x20000
s_mov_b32 s42, 0
s_mov_b32 s36, s58
s_and_b32 s37, s59, 0xffff
s_mov_b32 s38, 2211840
s_mov_b32 s39, 0x20000
s_lshr_b32 s6, s2, 2
s_lshl_b32 s6, s6, 5
s_lshl_b32 s7, s5, 3
s_add_u32 s6, s6, s7
s_mul_i32 s6, s6, 1280
s_and_b32 s7, s2, 3
s_mul_i32 s7, s7, 320
s_add_u32 s6, s6, s7
s_cmp_lt_u32 s2, 216
s_cselect_b32 s6, s6, 2147418112
v_add_u32 v2, 0, v1
v_mul_u32_u24 v3, 205, v2
v_lshrrev_b32 v3, 12, v3
v_mul_u32_u24 v4, 20, v3
v_sub_u32 v2, v2, v4
v_mul_u32_u24 v3, 1280, v3
v_lshl_add_u32 v2, v2, 4, v3
v_add_u32 v2, s6, v2
v_subrev_u32 v204, 0, v2
v_add_u32 v2, 64, v1
v_mul_u32_u24 v3, 205, v2
v_lshrrev_b32 v3, 12, v3
v_mul_u32_u24 v4, 20, v3
v_sub_u32 v2, v2, v4
v_mul_u32_u24 v3, 1280, v3
v_lshl_add_u32 v2, v2, 4, v3
v_add_u32 v2, s6, v2
v_subrev_u32 v205, 1024, v2
v_add_u32 v2, 128, v1
v_mul_u32_u24 v3, 205, v2
v_lshrrev_b32 v3, 12, v3
v_mul_u32_u24 v4, 20, v3
v_sub_u32 v2, v2, v4
v_mul_u32_u24 v3, 1280, v3
v_lshl_add_u32 v2, v2, 4, v3
v_add_u32 v2, s6, v2
v_subrev_u32 v206, 2048, v2
s_mul_i32 s6, s5, 2560
s_add_u32 s74, s6, 142592
v_lshrrev_b32 v2, 4, v1
v_bfe_u32 v3, v1, 2, 2
v_lshrrev_b32 v4, 1, v2
v_lshlrev_b32 v4, 4, v4
v_and_b32 v2, 1, v2
v_lshl_add_u32 v2, v2, 2, v3
v_add_u32 v2, v2, v4
v_mul_u32_u24 v2, 320, v2
v_and_b32 v3, 3, v1
v_mul_u32_u24 v3, 40, v3
v_add_u32 v2, v2, v3
v_add_u32 v5, 142592, v2
s_and_b32 s6, s2, 3
s_lshl_b32 s6, s6, 1
s_mul_i32 s6, s6, 54
s_lshr_b32 s7, s2, 2
s_add_u32 s6, s6, s7
s_mul_i32 s84, s6, 5120
s_add_u32 s84, s84, 7340032
v_mov_b32 v207, 2147418112
s_cmp_lt_u32 s2, 216
s_cselect_b64 vcc, -1, 0
v_cndmask_b32 v207, v207, v248, vcc
s_add_u32 s6, s5, 0
s_cmp_ge_u32 s6, 5
s_cselect_b32 s7, 5, 0
s_cselect_b32 s43, 276480, 0
s_cselect_b32 s75, 160, 0
s_sub_u32 s6, s6, s7
s_lshl_b32 s7, s6, 3
s_add_u32 s75, s75, s7
v_add_u32 v200, s75, v5
s_lshl_b32 s6, s6, 10
s_add_u32 s6, s6, s43
s_add_u32 s75, s6, s84
s_add_u32 s6, s5, 4
s_cmp_ge_u32 s6, 5
s_cselect_b32 s7, 5, 0
s_cselect_b32 s43, 276480, 0
s_cselect_b32 s76, 160, 0
s_sub_u32 s6, s6, s7
s_lshl_b32 s7, s6, 3
s_add_u32 s76, s76, s7
v_add_u32 v201, s76, v5
s_lshl_b32 s6, s6, 10
s_add_u32 s6, s6, s43
s_add_u32 s76, s6, s84
s_add_u32 s6, s5, 8
s_cmp_ge_u32 s6, 5
s_cselect_b32 s7, 5, 0
s_cselect_b32 s43, 276480, 0
s_cselect_b32 s93, 160, 0
s_sub_u32 s6, s6, s7
s_lshl_b32 s7, s6, 3
s_add_u32 s93, s93, s7
v_add_u32 v246, s93, v5
s_lshl_b32 s6, s6, 10
s_add_u32 s6, s6, s43
s_add_u32 s93, s6, s84
s_cmp_ge_u32 s5, 2
s_cselect_b64 vcc, -1, 0
v_mov_b32 v3, 2147418112
v_cndmask_b32 v173, v207, v3, vcc
s_mov_b32 exec_lo, 0xffffff
s_mov_b32 exec_hi, 0x0
buffer_load_dword v234, v232, s[20:23], 0 offen
s_mov_b64 exec, -1
s_mov_b32 exec_lo, 0x7fff
s_mov_b32 exec_hi, 0x0
buffer_load_dword v234, v233, s[8:11], 0 offen
s_mov_b64 exec, -1
v_lshrrev_b32 v2, 4, v1
v_bfe_u32 v4, v1, 2, 2
v_and_b32 v5, 3, v1
v_lshrrev_b32 v6, 5, v1
v_lshl_add_u32 v6, v6, 3, v4
v_lshlrev_b32 v6, 8, v6
s_lshl_b32 s6, s82, 1
v_xor_b32 v4, s6, v4
v_lshlrev_b32 v4, 2, v4
v_and_b32 v3, 1, v2
v_lshl_or_b32 v4, v3, 1, v4
v_lshrrev_b32 v3, 1, v5
v_or_b32 v4, v4, v3
v_lshl_add_u32 v6, v4, 4, v6
v_and_b32 v5, 1, v5
v_lshl_add_u32 v216, v5, 3, v6
v_xor_b32 v217, 64, v216
v_add_u32 v218, 0x10000, v216
v_add_u32 v219, 0x10000, v217
v_and_b32 v4, 31, v1
v_bfe_u32 v5, v1, 1, 3
v_lshrrev_b32 v6, 5, v1
v_xor_b32 v5, v5, v6
s_lshl_b32 s6, s83, 6
v_add_u32 v4, s6, v4
v_lshlrev_b32 v4, 7, v4
v_lshl_add_u32 v220, v5, 4, v4
v_xor_b32 v221, 32, v220
v_xor_b32 v222, 64, v220
v_xor_b32 v223, 96, v220
v_add_u32 v224, 0x10000, v220
v_add_u32 v225, 0x10000, v221
v_add_u32 v226, 0x10000, v222
v_add_u32 v227, 0x10000, v223
v_and_b32 v2, 15, v1
v_min_u32 v2, 13, v2
v_add_u32 v2, s96, v2
v_min_u32 v2, 53, v2
v_lshlrev_b32 v2, 2, v2
s_lshr_b32 s43, s95, 1
v_add_u32 v2, s43, v2
v_lshlrev_b32 v2, 7, v2
v_add_u32 v228, 12, v2
s_lshl_b32 s6, s77, 1
v_and_b32 v4, 1, v1
v_add_u32 v4, s6, v4
v_and_b32 v5, 3, v4
v_add_u32 v5, 28, v5
s_lshr_b32 s6, s77, 2
s_and_b32 s7, s77, 2
s_lshl_b32 s7, s7, 1
s_add_u32 s6, s6, s7
v_mov_b32 v4, s6
v_lshl_add_u32 v4, v5, 3, v4
v_lshlrev_b32 v4, 7, v4
v_add_u32 v231, 4, v4
v_and_b32 v2, 31, v1
v_and_b32 v3, 7, v2
v_lshrrev_b32 v2, 3, v2
v_lshlrev_b32 v2, 3, v2
v_add_u32 v2, s3, v2
v_lshl_add_u32 v2, v2, 3, v3
v_lshlrev_b32 v229, 7, v2
v_cmp_gt_u32 vcc, 14, v1
v_cndmask_b32 v2, 0, v1, vcc
v_cmp_lt_u32 vcc, 6, v2
v_cndmask_b32 v3, 0, 1, vcc
v_mul_u32_u24 v4, 7, v3
v_sub_u32 v2, v2, v4
s_lshr_b32 s6, s94, 1
s_and_b32 s7, s6, 3
s_lshr_b32 s6, s6, 2
v_lshlrev_b32 v3, 2, v3
v_lshlrev_b32 v2, 2, v2
v_add_u32 v2, s7, v2
v_add_u32 v3, s6, v3
v_lshl_add_u32 v2, v2, 3, v3
v_lshlrev_b32 v2, 7, v2
v_add_u32 v249, 16, v2
v_and_b32 v2, 31, v1
v_lshlrev_b32 v2, 3, v2
v_add_u32 v2, s95, v2
v_lshlrev_b32 v2, 7, v2
v_add_u32 v250, 20, v2
v_mov_b32 v2, 2147418112
s_cmp_lg_u32 s5, 0
s_cselect_b64 vcc, -1, 0
v_cndmask_b32 v231, v231, v2, vcc
v_cndmask_b32 v230, v230, v2, vcc
v_and_b32 v2, 15, v1
v_bfe_u32 v3, v1, 4, 1
v_lshlrev_b32 v3, 2, v3
v_cmp_eq_u32 vcc, v2, v3
v_mov_b32 v2, 0x3f803f80
v_cndmask_b32 v160, 0, v2, vcc
v_mov_b32 v161, v160
v_mov_b32 v162, v160
v_mov_b32 v163, v160
s_add_u32 m0, s81, 0
s_nop 0
buffer_load_dwordx4 v208, s[20:23], s79 offen offset:0 lds
buffer_load_dwordx4 v209, s[20:23], s79 offen offset:1024 lds
buffer_load_dwordx4 v210, s[20:23], s79 offen offset:2048 lds
buffer_load_dwordx4 v211, s[20:23], s79 offen offset:3072 lds
s_add_u32 m0, s81, 16384
s_nop 0
buffer_load_dwordx4 v212, s[8:11], s80 offen offset:0 lds
buffer_load_dwordx4 v213, s[8:11], s80 offen offset:1024 lds
buffer_load_dwordx4 v214, s[8:11], s80 offen offset:2048 lds
buffer_load_dwordx4 v215, s[8:11], s80 offen offset:3072 lds
s_waitcnt vmcnt(10)
ds_read_b128 v[36:39], v247 offset:0
ds_read_b128 v[40:43], v247 offset:16
ds_read_b128 v[44:47], v247 offset:32
ds_read_b128 v[48:51], v247 offset:48
s_cmp_lg_u32 s5, 0
s_cbranch_scc1 L_arr_2
s_and_b32 s6, s2, 7
s_lshl_b32 s6, s6, 5
v_mov_b32 v2, s6
s_mov_b64 exec, 1
buffer_atomic_add v253, v2, s[52:55], 0 offen sc1
s_mov_b64 exec, -1
L_arr_2:
v_lshlrev_b32 v194, 16, v8
v_and_b32 v195, 0xffff0000, v8
v_lshlrev_b32 v196, 16, v12
v_and_b32 v197, 0xffff0000, v12
s_mov_b32 exec_lo, 0xff000000
s_mov_b32 exec_hi, 0xffffff
buffer_load_dword v234, v232, s[20:23], 0 offen
s_mov_b64 exec, -1
s_mov_b32 exec_lo, 0xffff8000
s_mov_b32 exec_hi, 0x7
buffer_load_dword v234, v233, s[8:11], 0 offen
s_mov_b64 exec, -1
v_lshlrev_b32 v198, 16, v16
v_and_b32 v199, 0xffff0000, v16
v_lshlrev_b32 v236, 16, v20
v_and_b32 v237, 0xffff0000, v20
v_lshlrev_b32 v238, 16, v24
v_and_b32 v239, 0xffff0000, v24
v_lshlrev_b32 v240, 16, v28
v_and_b32 v241, 0xffff0000, v28
v_lshlrev_b32 v242, 16, v32
v_and_b32 v243, 0xffff0000, v32
s_waitcnt lgkmcnt(0)
v_lshlrev_b32 v52, 16, v36
v_lshlrev_b32 v53, 16, v38
v_and_b32 v54, 0xffff0000, v36
v_and_b32 v55, 0xffff0000, v38
v_lshlrev_b32 v56, 16, v37
v_lshlrev_b32 v57, 16, v39
v_and_b32 v58, 0xffff0000, v37
v_and_b32 v59, 0xffff0000, v39
v_pk_mul_f32 v[60:61], v[236:237], v[52:53]
v_pk_mul_f32 v[62:63], v[238:239], v[52:53]
v_pk_mul_f32 v[190:191], v[240:241], v[52:53]
v_pk_mul_f32 v[192:193], v[242:243], v[52:53]
v_pk_fma_f32 v[60:61], v[198:199], v[54:55], v[60:61]
v_pk_fma_f32 v[62:63], v[236:237], v[54:55], v[62:63]
v_pk_fma_f32 v[190:191], v[238:239], v[54:55], v[190:191]
v_pk_fma_f32 v[192:193], v[240:241], v[54:55], v[192:193]
v_pk_fma_f32 v[60:61], v[196:197], v[56:57], v[60:61]
v_pk_fma_f32 v[62:63], v[198:199], v[56:57], v[62:63]
v_pk_fma_f32 v[190:191], v[236:237], v[56:57], v[190:191]
v_pk_fma_f32 v[192:193], v[238:239], v[56:57], v[192:193]
v_pk_fma_f32 v[60:61], v[194:195], v[58:59], v[60:61]
v_pk_fma_f32 v[62:63], v[196:197], v[58:59], v[62:63]
v_pk_fma_f32 v[190:191], v[198:199], v[58:59], v[190:191]
v_pk_fma_f32 v[192:193], v[236:237], v[58:59], v[192:193]
v_lshlrev_b32 v194, 16, v174
v_and_b32 v195, 0xffff0000, v174
v_lshlrev_b32 v196, 16, v178
v_and_b32 v197, 0xffff0000, v178
v_lshlrev_b32 v198, 16, v182
v_and_b32 v199, 0xffff0000, v182
v_lshlrev_b32 v236, 16, v186
v_and_b32 v237, 0xffff0000, v186
v_pk_mul_f32 v[60:61], v[60:61], v[194:195]
v_pk_mul_f32 v[62:63], v[62:63], v[196:197]
v_pk_mul_f32 v[190:191], v[190:191], v[198:199]
v_pk_mul_f32 v[192:193], v[192:193], v[236:237]
s_mov_b32 exec_hi, 0xff
v_cvt_pk_bf16_f32 v238, v192, v190
v_cvt_pk_bf16_f32 v239, v62, v60
ds_write_b64 v202, v[238:239] offset:0
v_cvt_pk_bf16_f32 v240, v193, v191
v_cvt_pk_bf16_f32 v241, v63, v61
ds_write_b64 v202, v[240:241] offset:144
s_mov_b64 exec, -1
v_lshlrev_b32 v194, 16, v9
v_and_b32 v195, 0xffff0000, v9
v_lshlrev_b32 v196, 16, v13
v_and_b32 v197, 0xffff0000, v13
v_lshlrev_b32 v198, 16, v17
v_and_b32 v199, 0xffff0000, v17
v_lshlrev_b32 v236, 16, v21
v_and_b32 v237, 0xffff0000, v21
v_lshlrev_b32 v238, 16, v25
v_and_b32 v239, 0xffff0000, v25
v_lshlrev_b32 v240, 16, v29
v_and_b32 v241, 0xffff0000, v29
v_lshlrev_b32 v242, 16, v33
v_and_b32 v243, 0xffff0000, v33
v_lshlrev_b32 v52, 16, v40
v_lshlrev_b32 v53, 16, v42
v_and_b32 v54, 0xffff0000, v40
v_and_b32 v55, 0xffff0000, v42
v_lshlrev_b32 v56, 16, v41
v_lshlrev_b32 v57, 16, v43
v_and_b32 v58, 0xffff0000, v41
v_and_b32 v59, 0xffff0000, v43
v_pk_mul_f32 v[60:61], v[236:237], v[52:53]
v_pk_mul_f32 v[62:63], v[238:239], v[52:53]
v_pk_mul_f32 v[190:191], v[240:241], v[52:53]
v_pk_mul_f32 v[192:193], v[242:243], v[52:53]
v_pk_fma_f32 v[60:61], v[198:199], v[54:55], v[60:61]
v_pk_fma_f32 v[62:63], v[236:237], v[54:55], v[62:63]
v_pk_fma_f32 v[190:191], v[238:239], v[54:55], v[190:191]
v_pk_fma_f32 v[192:193], v[240:241], v[54:55], v[192:193]
v_pk_fma_f32 v[60:61], v[196:197], v[56:57], v[60:61]
v_pk_fma_f32 v[62:63], v[198:199], v[56:57], v[62:63]
v_pk_fma_f32 v[190:191], v[236:237], v[56:57], v[190:191]
v_pk_fma_f32 v[192:193], v[238:239], v[56:57], v[192:193]
v_pk_fma_f32 v[60:61], v[194:195], v[58:59], v[60:61]
v_pk_fma_f32 v[62:63], v[196:197], v[58:59], v[62:63]
v_pk_fma_f32 v[190:191], v[198:199], v[58:59], v[190:191]
v_pk_fma_f32 v[192:193], v[236:237], v[58:59], v[192:193]
v_lshlrev_b32 v194, 16, v175
v_and_b32 v195, 0xffff0000, v175
v_lshlrev_b32 v196, 16, v179
v_and_b32 v197, 0xffff0000, v179
v_lshlrev_b32 v198, 16, v183
v_and_b32 v199, 0xffff0000, v183
v_lshlrev_b32 v236, 16, v187
v_and_b32 v237, 0xffff0000, v187
v_pk_mul_f32 v[60:61], v[60:61], v[194:195]
v_pk_mul_f32 v[62:63], v[62:63], v[196:197]
v_pk_mul_f32 v[190:191], v[190:191], v[198:199]
v_pk_mul_f32 v[192:193], v[192:193], v[236:237]
s_mov_b32 exec_hi, 0xff
v_cvt_pk_bf16_f32 v238, v192, v190
v_cvt_pk_bf16_f32 v239, v62, v60
ds_write_b64 v202, v[238:239] offset:288
v_cvt_pk_bf16_f32 v240, v193, v191
v_cvt_pk_bf16_f32 v241, v63, v61
ds_write_b64 v202, v[240:241] offset:432
s_mov_b64 exec, -1
v_lshlrev_b32 v194, 16, v10
v_and_b32 v195, 0xffff0000, v10
v_lshlrev_b32 v196, 16, v14
v_and_b32 v197, 0xffff0000, v14
v_lshlrev_b32 v198, 16, v18
v_and_b32 v199, 0xffff0000, v18
v_lshlrev_b32 v236, 16, v22
v_and_b32 v237, 0xffff0000, v22
v_lshlrev_b32 v238, 16, v26
v_and_b32 v239, 0xffff0000, v26
v_lshlrev_b32 v240, 16, v30
v_and_b32 v241, 0xffff0000, v30
v_lshlrev_b32 v242, 16, v34
v_and_b32 v243, 0xffff0000, v34
v_lshlrev_b32 v52, 16, v44
v_lshlrev_b32 v53, 16, v46
v_and_b32 v54, 0xffff0000, v44
v_and_b32 v55, 0xffff0000, v46
v_lshlrev_b32 v56, 16, v45
v_lshlrev_b32 v57, 16, v47
v_and_b32 v58, 0xffff0000, v45
v_and_b32 v59, 0xffff0000, v47
v_pk_mul_f32 v[60:61], v[236:237], v[52:53]
v_pk_mul_f32 v[62:63], v[238:239], v[52:53]
v_pk_mul_f32 v[190:191], v[240:241], v[52:53]
v_pk_mul_f32 v[192:193], v[242:243], v[52:53]
v_pk_fma_f32 v[60:61], v[198:199], v[54:55], v[60:61]
v_pk_fma_f32 v[62:63], v[236:237], v[54:55], v[62:63]
v_pk_fma_f32 v[190:191], v[238:239], v[54:55], v[190:191]
v_pk_fma_f32 v[192:193], v[240:241], v[54:55], v[192:193]
v_pk_fma_f32 v[60:61], v[196:197], v[56:57], v[60:61]
v_pk_fma_f32 v[62:63], v[198:199], v[56:57], v[62:63]
v_pk_fma_f32 v[190:191], v[236:237], v[56:57], v[190:191]
v_pk_fma_f32 v[192:193], v[238:239], v[56:57], v[192:193]
v_pk_fma_f32 v[60:61], v[194:195], v[58:59], v[60:61]
v_pk_fma_f32 v[62:63], v[196:197], v[58:59], v[62:63]
v_pk_fma_f32 v[190:191], v[198:199], v[58:59], v[190:191]
v_pk_fma_f32 v[192:193], v[236:237], v[58:59], v[192:193]
v_lshlrev_b32 v194, 16, v176
v_and_b32 v195, 0xffff0000, v176
v_lshlrev_b32 v196, 16, v180
v_and_b32 v197, 0xffff0000, v180
v_lshlrev_b32 v198, 16, v184
v_and_b32 v199, 0xffff0000, v184
v_lshlrev_b32 v236, 16, v188
v_and_b32 v237, 0xffff0000, v188
v_pk_mul_f32 v[60:61], v[60:61], v[194:195]
v_pk_mul_f32 v[62:63], v[62:63], v[196:197]
v_pk_mul_f32 v[190:191], v[190:191], v[198:199]
v_pk_mul_f32 v[192:193], v[192:193], v[236:237]
s_mov_b32 exec_hi, 0xff
v_cvt_pk_bf16_f32 v238, v192, v190
v_cvt_pk_bf16_f32 v239, v62, v60
ds_write_b64 v202, v[238:239] offset:576
v_cvt_pk_bf16_f32 v240, v193, v191
v_cvt_pk_bf16_f32 v241, v63, v61
ds_write_b64 v202, v[240:241] offset:720
s_mov_b64 exec, -1
v_lshlrev_b32 v194, 16, v11
v_and_b32 v195, 0xffff0000, v11
v_lshlrev_b32 v196, 16, v15
v_and_b32 v197, 0xffff0000, v15
v_lshlrev_b32 v198, 16, v19
v_and_b32 v199, 0xffff0000, v19
v_lshlrev_b32 v236, 16, v23
v_and_b32 v237, 0xffff0000, v23
v_lshlrev_b32 v238, 16, v27
v_and_b32 v239, 0xffff0000, v27
v_lshlrev_b32 v240, 16, v31
v_and_b32 v241, 0xffff0000, v31
v_lshlrev_b32 v242, 16, v35
v_and_b32 v243, 0xffff0000, v35
v_lshlrev_b32 v52, 16, v48
v_lshlrev_b32 v53, 16, v50
v_and_b32 v54, 0xffff0000, v48
v_and_b32 v55, 0xffff0000, v50
v_lshlrev_b32 v56, 16, v49
v_lshlrev_b32 v57, 16, v51
v_and_b32 v58, 0xffff0000, v49
v_and_b32 v59, 0xffff0000, v51
v_pk_mul_f32 v[60:61], v[236:237], v[52:53]
v_pk_mul_f32 v[62:63], v[238:239], v[52:53]
v_pk_mul_f32 v[190:191], v[240:241], v[52:53]
v_pk_mul_f32 v[192:193], v[242:243], v[52:53]
v_pk_fma_f32 v[60:61], v[198:199], v[54:55], v[60:61]
v_pk_fma_f32 v[62:63], v[236:237], v[54:55], v[62:63]
v_pk_fma_f32 v[190:191], v[238:239], v[54:55], v[190:191]
v_pk_fma_f32 v[192:193], v[240:241], v[54:55], v[192:193]
v_pk_fma_f32 v[60:61], v[196:197], v[56:57], v[60:61]
v_pk_fma_f32 v[62:63], v[198:199], v[56:57], v[62:63]
v_pk_fma_f32 v[190:191], v[236:237], v[56:57], v[190:191]
v_pk_fma_f32 v[192:193], v[238:239], v[56:57], v[192:193]
v_pk_fma_f32 v[60:61], v[194:195], v[58:59], v[60:61]
v_pk_fma_f32 v[62:63], v[196:197], v[58:59], v[62:63]
v_pk_fma_f32 v[190:191], v[198:199], v[58:59], v[190:191]
v_pk_fma_f32 v[192:193], v[236:237], v[58:59], v[192:193]
v_lshlrev_b32 v194, 16, v177
v_and_b32 v195, 0xffff0000, v177
v_lshlrev_b32 v196, 16, v181
v_and_b32 v197, 0xffff0000, v181
v_lshlrev_b32 v198, 16, v185
v_and_b32 v199, 0xffff0000, v185
v_lshlrev_b32 v236, 16, v189
v_and_b32 v237, 0xffff0000, v189
v_pk_mul_f32 v[60:61], v[60:61], v[194:195]
v_pk_mul_f32 v[62:63], v[62:63], v[196:197]
v_pk_mul_f32 v[190:191], v[190:191], v[198:199]
v_pk_mul_f32 v[192:193], v[192:193], v[236:237]
s_mov_b32 exec_hi, 0xff
v_cvt_pk_bf16_f32 v238, v192, v190
v_cvt_pk_bf16_f32 v239, v62, v60
ds_write_b64 v202, v[238:239] offset:864
v_cvt_pk_bf16_f32 v240, v193, v191
v_cvt_pk_bf16_f32 v241, v63, v61
ds_write_b64 v202, v[240:241] offset:1008
s_mov_b64 exec, -1
s_add_u32 m0, s81, 32768
s_add_u32 s79, s79, 221184
buffer_load_dwordx4 v208, s[20:23], s79 offen offset:0 lds
buffer_load_dwordx4 v209, s[20:23], s79 offen offset:1024 lds
buffer_load_dwordx4 v210, s[20:23], s79 offen offset:2048 lds
buffer_load_dwordx4 v211, s[20:23], s79 offen offset:3072 lds
s_add_u32 m0, s81, 49152
s_add_u32 s80, s80, 128
buffer_load_dwordx4 v212, s[8:11], s80 offen offset:0 lds
buffer_load_dwordx4 v213, s[8:11], s80 offen offset:1024 lds
buffer_load_dwordx4 v214, s[8:11], s80 offen offset:2048 lds
buffer_load_dwordx4 v215, s[8:11], s80 offen offset:3072 lds
s_waitcnt vmcnt(10)
s_waitcnt lgkmcnt(0)
s_barrier
ds_read_b64_tr_b16 v[128:129], v216 offset:0
ds_read_b64_tr_b16 v[130:131], v216 offset:1024
ds_read_b128 v[136:139], v220 offset:16384
ds_read_b128 v[140:143], v220 offset:20480
ds_read_b64_tr_b16 v[132:133], v217 offset:0
ds_read_b64_tr_b16 v[134:135], v217 offset:1024
ds_read_b128 v[8:11], v203 offset:0
ds_read_b128 v[12:15], v203 offset:1152
ds_read_b128 v[16:19], v203 offset:2304
s_waitcnt lgkmcnt(6)
v_mfma_f32_32x32x16_bf16 v[64:79], v[128:131], v[136:139], 0
ds_read_b64_tr_b16 v[144:145], v216 offset:4096
ds_read_b64_tr_b16 v[146:147], v216 offset:5120
s_add_u32 m0, s81, 65536
s_add_u32 s79, s79, 221184
buffer_load_dwordx4 v208, s[20:23], s79 offen offset:0 lds
s_waitcnt lgkmcnt(7)
v_mfma_f32_32x32x16_bf16 v[80:95], v[128:131], v[140:143], 0
ds_read_b128 v[152:155], v221 offset:16384
ds_read_b128 v[156:159], v221 offset:20480
buffer_load_dwordx4 v209, s[20:23], s79 offen offset:1024 lds
v_mfma_f32_16x16x32_bf16 v[164:167], v[160:163], v[128:131], 0
s_waitcnt lgkmcnt(7)
v_mfma_f32_32x32x16_bf16 v[96:111], v[132:135], v[136:139], 0
ds_read_b64_tr_b16 v[148:149], v217 offset:4096
ds_read_b64_tr_b16 v[150:151], v217 offset:5120
buffer_load_dwordx4 v210, s[20:23], s79 offen offset:2048 lds
v_mfma_f32_32x32x16_bf16 v[112:127], v[132:135], v[140:143], 0
buffer_load_dwordx4 v211, s[20:23], s79 offen offset:3072 lds
v_mfma_f32_16x16x32_bf16 v[168:171], v[160:163], v[132:135], 0
s_waitcnt lgkmcnt(3)
v_mfma_f32_32x32x16_bf16 v[64:79], v[144:147], v[152:155], v[64:79]
ds_read_b64_tr_b16 v[128:129], v216 offset:8192
ds_read_b64_tr_b16 v[130:131], v216 offset:9216
s_add_u32 m0, s81, 81920
s_add_u32 s80, s80, 128
buffer_load_dwordx4 v212, s[8:11], s80 offen offset:0 lds
s_waitcnt lgkmcnt(4)
v_mfma_f32_32x32x16_bf16 v[80:95], v[144:147], v[156:159], v[80:95]
ds_read_b128 v[136:139], v222 offset:16384
ds_read_b128 v[140:143], v222 offset:20480
buffer_load_dwordx4 v213, s[8:11], s80 offen offset:1024 lds
v_mfma_f32_16x16x32_bf16 v[164:167], v[160:163], v[144:147], v[164:167]
s_waitcnt lgkmcnt(4)
v_mfma_f32_32x32x16_bf16 v[96:111], v[148:151], v[152:155], v[96:111]
ds_read_b64_tr_b16 v[132:133], v217 offset:8192
ds_read_b64_tr_b16 v[134:135], v217 offset:9216
buffer_load_dwordx4 v214, s[8:11], s80 offen offset:2048 lds
v_mfma_f32_32x32x16_bf16 v[112:127], v[148:151], v[156:159], v[112:127]
buffer_load_dwordx4 v215, s[8:11], s80 offen offset:3072 lds
v_mfma_f32_16x16x32_bf16 v[168:171], v[160:163], v[148:151], v[168:171]
s_waitcnt lgkmcnt(3)
v_mfma_f32_32x32x16_bf16 v[64:79], v[128:131], v[136:139], v[64:79]
ds_read_b64_tr_b16 v[144:145], v216 offset:12288
ds_read_b64_tr_b16 v[146:147], v216 offset:13312
s_waitcnt vmcnt(8)
s_cmp_eq_u32 s82, 0
s_cbranch_scc0 L_nb_3
s_barrier
L_nb_3:
s_waitcnt lgkmcnt(4)
v_mfma_f32_32x32x16_bf16 v[80:95], v[128:131], v[140:143], v[80:95]
ds_read_b128 v[152:155], v223 offset:16384
ds_read_b128 v[156:159], v223 offset:20480
s_cmp_eq_u32 s82, 1
s_cbranch_scc0 L_nb_4
s_barrier
L_nb_4:
v_mfma_f32_16x16x32_bf16 v[164:167], v[160:163], v[128:131], v[164:167]
s_waitcnt lgkmcnt(4)
v_mfma_f32_32x32x16_bf16 v[96:111], v[132:135], v[136:139], v[96:111]
ds_read_b64_tr_b16 v[148:149], v217 offset:12288
ds_read_b64_tr_b16 v[150:151], v217 offset:13312
s_add_u32 m0, s81, 98304
s_add_u32 s79, s79, 221184
buffer_load_dwordx4 v208, s[20:23], s79 offen offset:0 lds
v_mfma_f32_32x32x16_bf16 v[112:127], v[132:135], v[140:143], v[112:127]
buffer_store_dwordx4 v[8:11], v172, s[24:27], s70 offen sc1
v_mfma_f32_16x16x32_bf16 v[168:171], v[160:163], v[132:135], v[168:171]
s_waitcnt lgkmcnt(3)
v_mfma_f32_32x32x16_bf16 v[64:79], v[144:147], v[152:155], v[64:79]
ds_read_b64_tr_b16 v[128:129], v216 offset:32768
ds_read_b64_tr_b16 v[130:131], v216 offset:33792
buffer_load_dwordx4 v209, s[20:23], s79 offen offset:1024 lds
s_waitcnt lgkmcnt(4)
v_mfma_f32_32x32x16_bf16 v[80:95], v[144:147], v[156:159], v[80:95]
ds_read_b128 v[136:139], v220 offset:49152
ds_read_b128 v[140:143], v220 offset:53248
v_mfma_f32_16x16x32_bf16 v[164:167], v[160:163], v[144:147], v[164:167]
s_waitcnt lgkmcnt(4)
v_mfma_f32_32x32x16_bf16 v[96:111], v[148:151], v[152:155], v[96:111]
ds_read_b64_tr_b16 v[132:133], v217 offset:32768
ds_read_b64_tr_b16 v[134:135], v217 offset:33792
buffer_load_dwordx4 v210, s[20:23], s79 offen offset:2048 lds
v_mfma_f32_32x32x16_bf16 v[112:127], v[148:151], v[156:159], v[112:127]
v_mfma_f32_16x16x32_bf16 v[168:171], v[160:163], v[148:151], v[168:171]
s_waitcnt lgkmcnt(3)
v_mfma_f32_32x32x16_bf16 v[64:79], v[128:131], v[136:139], v[64:79]
ds_read_b64_tr_b16 v[144:145], v216 offset:36864
ds_read_b64_tr_b16 v[146:147], v216 offset:37888
buffer_load_dwordx4 v211, s[20:23], s79 offen offset:3072 lds
s_waitcnt lgkmcnt(4)
v_mfma_f32_32x32x16_bf16 v[80:95], v[128:131], v[140:143], v[80:95]
ds_read_b128 v[152:155], v221 offset:49152
ds_read_b128 v[156:159], v221 offset:53248
v_mfma_f32_16x16x32_bf16 v[164:167], v[160:163], v[128:131], v[164:167]
s_waitcnt lgkmcnt(4)
v_mfma_f32_32x32x16_bf16 v[96:111], v[132:135], v[136:139], v[96:111]
ds_read_b64_tr_b16 v[148:149], v217 offset:36864
ds_read_b64_tr_b16 v[150:151], v217 offset:37888
s_add_u32 m0, s81, 114688
s_add_u32 s80, s80, 128
buffer_load_dwordx4 v212, s[8:11], s80 offen offset:0 lds
v_mfma_f32_32x32x16_bf16 v[112:127], v[132:135], v[140:143], v[112:127]
buffer_store_dwordx4 v[12:15], v172, s[24:27], s71 offen sc1
v_mfma_f32_16x16x32_bf16 v[168:171], v[160:163], v[132:135], v[168:171]
s_waitcnt lgkmcnt(3)
v_mfma_f32_32x32x16_bf16 v[64:79], v[144:147], v[152:155], v[64:79]
ds_read_b64_tr_b16 v[128:129], v216 offset:40960
ds_read_b64_tr_b16 v[130:131], v216 offset:41984
buffer_load_dwordx4 v213, s[8:11], s80 offen offset:1024 lds
s_waitcnt lgkmcnt(4)
v_mfma_f32_32x32x16_bf16 v[80:95], v[144:147], v[156:159], v[80:95]
ds_read_b128 v[136:139], v222 offset:49152
ds_read_b128 v[140:143], v222 offset:53248
v_mfma_f32_16x16x32_bf16 v[164:167], v[160:163], v[144:147], v[164:167]
s_waitcnt lgkmcnt(4)
v_mfma_f32_32x32x16_bf16 v[96:111], v[148:151], v[152:155], v[96:111]
ds_read_b64_tr_b16 v[132:133], v217 offset:40960
ds_read_b64_tr_b16 v[134:135], v217 offset:41984
buffer_load_dwordx4 v214, s[8:11], s80 offen offset:2048 lds
v_mfma_f32_32x32x16_bf16 v[112:127], v[148:151], v[156:159], v[112:127]
v_mfma_f32_16x16x32_bf16 v[168:171], v[160:163], v[148:151], v[168:171]
s_waitcnt lgkmcnt(3)
v_mfma_f32_32x32x16_bf16 v[64:79], v[128:131], v[136:139], v[64:79]
ds_read_b64_tr_b16 v[144:145], v216 offset:45056
ds_read_b64_tr_b16 v[146:147], v216 offset:46080
s_waitcnt vmcnt(9)
s_cmp_eq_u32 s82, 0
s_cbranch_scc0 L_nb_5
s_barrier
L_nb_5:
buffer_load_dwordx4 v215, s[8:11], s80 offen offset:3072 lds
s_waitcnt lgkmcnt(4)
v_mfma_f32_32x32x16_bf16 v[80:95], v[128:131], v[140:143], v[80:95]
ds_read_b128 v[152:155], v223 offset:49152
ds_read_b128 v[156:159], v223 offset:53248
s_cmp_eq_u32 s82, 1
s_cbranch_scc0 L_nb_6
s_barrier
L_nb_6:
v_mfma_f32_16x16x32_bf16 v[164:167], v[160:163], v[128:131], v[164:167]
s_waitcnt lgkmcnt(4)
v_mfma_f32_32x32x16_bf16 v[96:111], v[132:135], v[136:139], v[96:111]
ds_read_b64_tr_b16 v[148:149], v217 offset:45056
ds_read_b64_tr_b16 v[150:151], v217 offset:46080
s_add_u32 m0, s81, 0
s_add_u32 s79, s79, 221184
buffer_load_dwordx4 v208, s[20:23], s79 offen offset:0 lds
v_mfma_f32_32x32x16_bf16 v[112:127], v[132:135], v[140:143], v[112:127]
s_mov_b32 exec_hi, 0
buffer_store_dwordx4 v[16:19], v172, s[24:27], s72 offen sc1
s_mov_b64 exec, -1
v_mfma_f32_16x16x32_bf16 v[168:171], v[160:163], v[132:135], v[168:171]
s_waitcnt lgkmcnt(3)
v_mfma_f32_32x32x16_bf16 v[64:79], v[144:147], v[152:155], v[64:79]
ds_read_b64_tr_b16 v[128:129], v218 offset:0
ds_read_b64_tr_b16 v[130:131], v218 offset:1024
buffer_load_dwordx4 v209, s[20:23], s79 offen offset:1024 lds
s_waitcnt lgkmcnt(4)
v_mfma_f32_32x32x16_bf16 v[80:95], v[144:147], v[156:159], v[80:95]
ds_read_b128 v[136:139], v224 offset:16384
ds_read_b128 v[140:143], v224 offset:20480
v_mfma_f32_16x16x32_bf16 v[164:167], v[160:163], v[144:147], v[164:167]
s_waitcnt lgkmcnt(4)
v_mfma_f32_32x32x16_bf16 v[96:111], v[148:151], v[152:155], v[96:111]
ds_read_b64_tr_b16 v[132:133], v219 offset:0
ds_read_b64_tr_b16 v[134:135], v219 offset:1024
buffer_load_dwordx4 v210, s[20:23], s79 offen offset:2048 lds
v_mfma_f32_32x32x16_bf16 v[112:127], v[148:151], v[156:159], v[112:127]
v_mfma_f32_16x16x32_bf16 v[168:171], v[160:163], v[148:151], v[168:171]
s_waitcnt lgkmcnt(3)
v_mfma_f32_32x32x16_bf16 v[64:79], v[128:131], v[136:139], v[64:79]
ds_read_b64_tr_b16 v[144:145], v218 offset:4096
ds_read_b64_tr_b16 v[146:147], v218 offset:5120
buffer_load_dwordx4 v211, s[20:23], s79 offen offset:3072 lds
s_waitcnt lgkmcnt(4)
v_mfma_f32_32x32x16_bf16 v[80:95], v[128:131], v[140:143], v[80:95]
ds_read_b128 v[152:155], v225 offset:16384
ds_read_b128 v[156:159], v225 offset:20480
v_mfma_f32_16x16x32_bf16 v[164:167], v[160:163], v[128:131], v[164:167]
s_waitcnt lgkmcnt(4)
v_mfma_f32_32x32x16_bf16 v[96:111], v[132:135], v[136:139], v[96:111]
ds_read_b64_tr_b16 v[148:149], v219 offset:4096
ds_read_b64_tr_b16 v[150:151], v219 offset:5120
s_add_u32 m0, s81, 16384
s_add_u32 s80, s80, 128
buffer_load_dwordx4 v212, s[8:11], s80 offen offset:0 lds
v_mfma_f32_32x32x16_bf16 v[112:127], v[132:135], v[140:143], v[112:127]
v_mfma_f32_16x16x32_bf16 v[168:171], v[160:163], v[132:135], v[168:171]
s_waitcnt lgkmcnt(3)
v_mfma_f32_32x32x16_bf16 v[64:79], v[144:147], v[152:155], v[64:79]
ds_read_b64_tr_b16 v[128:129], v218 offset:8192
ds_read_b64_tr_b16 v[130:131], v218 offset:9216
buffer_load_dwordx4 v213, s[8:11], s80 offen offset:1024 lds
s_waitcnt lgkmcnt(4)
v_mfma_f32_32x32x16_bf16 v[80:95], v[144:147], v[156:159], v[80:95]
ds_read_b128 v[136:139], v226 offset:16384
ds_read_b128 v[140:143], v226 offset:20480
v_mfma_f32_16x16x32_bf16 v[164:167], v[160:163], v[144:147], v[164:167]
s_waitcnt lgkmcnt(4)
v_mfma_f32_32x32x16_bf16 v[96:111], v[148:151], v[152:155], v[96:111]
ds_read_b64_tr_b16 v[132:133], v219 offset:8192
ds_read_b64_tr_b16 v[134:135], v219 offset:9216
buffer_load_dwordx4 v214, s[8:11], s80 offen offset:2048 lds
v_mfma_f32_32x32x16_bf16 v[112:127], v[148:151], v[156:159], v[112:127]
buffer_load_dword v254, v230, s[52:55], 0 offen sc1
v_mfma_f32_16x16x32_bf16 v[168:171], v[160:163], v[148:151], v[168:171]
s_waitcnt lgkmcnt(3)
v_mfma_f32_32x32x16_bf16 v[64:79], v[128:131], v[136:139], v[64:79]
ds_read_b64_tr_b16 v[144:145], v218 offset:12288
ds_read_b64_tr_b16 v[146:147], v218 offset:13312
s_waitcnt vmcnt(9)
s_cmp_eq_u32 s82, 0
s_cbranch_scc0 L_nb_7
s_barrier
L_nb_7:
buffer_load_dwordx4 v215, s[8:11], s80 offen offset:3072 lds
s_waitcnt lgkmcnt(4)
v_mfma_f32_32x32x16_bf16 v[80:95], v[128:131], v[140:143], v[80:95]
ds_read_b128 v[152:155], v227 offset:16384
ds_read_b128 v[156:159], v227 offset:20480
s_cmp_eq_u32 s82, 1
s_cbranch_scc0 L_nb_8
s_barrier
L_nb_8:
v_mfma_f32_16x16x32_bf16 v[164:167], v[160:163], v[128:131], v[164:167]
s_waitcnt lgkmcnt(4)
v_mfma_f32_32x32x16_bf16 v[96:111], v[132:135], v[136:139], v[96:111]
ds_read_b64_tr_b16 v[148:149], v219 offset:12288
ds_read_b64_tr_b16 v[150:151], v219 offset:13312
s_add_u32 m0, s81, 32768
s_add_u32 s79, s79, 221184
buffer_load_dwordx4 v208, s[20:23], s79 offen offset:0 lds
v_mfma_f32_32x32x16_bf16 v[112:127], v[132:135], v[140:143], v[112:127]
v_mfma_f32_16x16x32_bf16 v[168:171], v[160:163], v[132:135], v[168:171]
s_waitcnt lgkmcnt(3)
v_mfma_f32_32x32x16_bf16 v[64:79], v[144:147], v[152:155], v[64:79]
ds_read_b64_tr_b16 v[128:129], v218 offset:32768
ds_read_b64_tr_b16 v[130:131], v218 offset:33792
buffer_load_dwordx4 v209, s[20:23], s79 offen offset:1024 lds
s_waitcnt lgkmcnt(4)
v_mfma_f32_32x32x16_bf16 v[80:95], v[144:147], v[156:159], v[80:95]
ds_read_b128 v[136:139], v224 offset:49152
ds_read_b128 v[140:143], v224 offset:53248
v_mfma_f32_16x16x32_bf16 v[164:167], v[160:163], v[144:147], v[164:167]
s_waitcnt lgkmcnt(4)
v_mfma_f32_32x32x16_bf16 v[96:111], v[148:151], v[152:155], v[96:111]
ds_read_b64_tr_b16 v[132:133], v219 offset:32768
ds_read_b64_tr_b16 v[134:135], v219 offset:33792
buffer_load_dwordx4 v210, s[20:23], s79 offen offset:2048 lds
v_mfma_f32_32x32x16_bf16 v[112:127], v[148:151], v[156:159], v[112:127]
v_mfma_f32_16x16x32_bf16 v[168:171], v[160:163], v[148:151], v[168:171]
s_waitcnt lgkmcnt(3)
v_mfma_f32_32x32x16_bf16 v[64:79], v[128:131], v[136:139], v[64:79]
ds_read_b64_tr_b16 v[144:145], v218 offset:36864
ds_read_b64_tr_b16 v[146:147], v218 offset:37888
buffer_load_dwordx4 v211, s[20:23], s79 offen offset:3072 lds
s_waitcnt lgkmcnt(4)
v_mfma_f32_32x32x16_bf16 v[80:95], v[128:131], v[140:143], v[80:95]
ds_read_b128 v[152:155], v225 offset:49152
ds_read_b128 v[156:159], v225 offset:53248
s_mov_b32 m0, s74
s_nop 0
buffer_load_dwordx4 v204, s[36:39], 0 offen lds
s_mov_b32 m0, s74
s_nop 0
buffer_load_dwordx4 v205, s[36:39], 0 offen offset:1024 lds
s_mov_b32 m0, s74
s_mov_b32 exec_hi, 0
buffer_load_dwordx4 v206, s[36:39], 0 offen offset:2048 lds
s_mov_b64 exec, -1
v_mfma_f32_16x16x32_bf16 v[164:167], v[160:163], v[128:131], v[164:167]
s_waitcnt lgkmcnt(4)
v_mfma_f32_32x32x16_bf16 v[96:111], v[132:135], v[136:139], v[96:111]
ds_read_b64_tr_b16 v[148:149], v219 offset:36864
ds_read_b64_tr_b16 v[150:151], v219 offset:37888
s_add_u32 m0, s81, 49152
s_add_u32 s80, s80, 128
buffer_load_dwordx4 v212, s[8:11], s80 offen offset:0 lds
v_mfma_f32_32x32x16_bf16 v[112:127], v[132:135], v[140:143], v[112:127]
v_mfma_f32_16x16x32_bf16 v[168:171], v[160:163], v[132:135], v[168:171]
s_waitcnt lgkmcnt(3)
v_mfma_f32_32x32x16_bf16 v[64:79], v[144:147], v[152:155], v[64:79]
ds_read_b64_tr_b16 v[128:129], v218 offset:40960
ds_read_b64_tr_b16 v[130:131], v218 offset:41984
buffer_load_dwordx4 v213, s[8:11], s80 offen offset:1024 lds
s_waitcnt lgkmcnt(4)
v_mfma_f32_32x32x16_bf16 v[80:95], v[144:147], v[156:159], v[80:95]
ds_read_b128 v[136:139], v226 offset:49152
ds_read_b128 v[140:143], v226 offset:53248
v_mfma_f32_16x16x32_bf16 v[164:167], v[160:163], v[144:147], v[164:167]
s_waitcnt lgkmcnt(4)
v_mfma_f32_32x32x16_bf16 v[96:111], v[148:151], v[152:155], v[96:111]
ds_read_b64_tr_b16 v[132:133], v219 offset:40960
ds_read_b64_tr_b16 v[134:135], v219 offset:41984
buffer_load_dwordx4 v214, s[8:11], s80 offen offset:2048 lds
v_mfma_f32_32x32x16_bf16 v[112:127], v[148:151], v[156:159], v[112:127]
v_mfma_f32_16x16x32_bf16 v[168:171], v[160:163], v[148:151], v[168:171]
s_waitcnt lgkmcnt(3)
v_mfma_f32_32x32x16_bf16 v[64:79], v[128:131], v[136:139], v[64:79]
ds_read_b64_tr_b16 v[144:145], v218 offset:45056
ds_read_b64_tr_b16 v[146:147], v218 offset:46080
s_waitcnt vmcnt(10)
s_cmp_eq_u32 s82, 0
s_cbranch_scc0 L_nb_9
s_barrier
L_nb_9:
buffer_load_dwordx4 v215, s[8:11], s80 offen offset:3072 lds
s_waitcnt lgkmcnt(4)
v_mfma_f32_32x32x16_bf16 v[80:95], v[128:131], v[140:143], v[80:95]
ds_read_b128 v[152:155], v227 offset:49152
ds_read_b128 v[156:159], v227 offset:53248
s_cmp_eq_u32 s82, 1
s_cbranch_scc0 L_nb_10
s_barrier
L_nb_10:
s_mov_b32 exec_lo, 0x0
s_mov_b32 exec_hi, 0xff000000
buffer_load_dword v234, v232, s[20:23], 0 offen
s_mov_b64 exec, -1
s_mov_b32 s6, 1769472
s_mov_b32 exec_lo, 0xffff
s_mov_b32 exec_hi, 0x0
buffer_load_dword v234, v232, s[20:23], s6 offen
s_mov_b64 exec, -1
s_mov_b32 exec_lo, 0x0
s_mov_b32 exec_hi, 0x3fff8
buffer_load_dword v234, v233, s[8:11], 0 offen
s_mov_b64 exec, -1
v_mfma_f32_16x16x32_bf16 v[164:167], v[160:163], v[128:131], v[164:167]
s_waitcnt lgkmcnt(4)
v_mfma_f32_32x32x16_bf16 v[96:111], v[132:135], v[136:139], v[96:111]
ds_read_b64_tr_b16 v[148:149], v219 offset:45056
ds_read_b64_tr_b16 v[150:151], v219 offset:46080
s_add_u32 m0, s81, 65536
s_add_u32 s79, s79, 221184
buffer_load_dwordx4 v208, s[20:23], s79 offen offset:0 lds
v_mfma_f32_32x32x16_bf16 v[112:127], v[132:135], v[140:143], v[112:127]
v_mfma_f32_16x16x32_bf16 v[168:171], v[160:163], v[132:135], v[168:171]
s_waitcnt lgkmcnt(3)
v_mfma_f32_32x32x16_bf16 v[64:79], v[144:147], v[152:155], v[64:79]
ds_read_b64_tr_b16 v[128:129], v216 offset:0
ds_read_b64_tr_b16 v[130:131], v216 offset:1024
buffer_load_dwordx4 v209, s[20:23], s79 offen offset:1024 lds
s_waitcnt lgkmcnt(4)
v_mfma_f32_32x32x16_bf16 v[80:95], v[144:147], v[156:159], v[80:95]
ds_read_b128 v[136:139], v220 offset:16384
ds_read_b128 v[140:143], v220 offset:20480
v_mfma_f32_16x16x32_bf16 v[164:167], v[160:163], v[144:147], v[164:167]
s_waitcnt lgkmcnt(4)
v_mfma_f32_32x32x16_bf16 v[96:111], v[148:151], v[152:155], v[96:111]
ds_read_b64_tr_b16 v[132:133], v217 offset:0
ds_read_b64_tr_b16 v[134:135], v217 offset:1024
buffer_load_dwordx4 v210, s[20:23], s79 offen offset:2048 lds
v_mfma_f32_32x32x16_bf16 v[112:127], v[148:151], v[156:159], v[112:127]
v_mfma_f32_16x16x32_bf16 v[168:171], v[160:163], v[148:151], v[168:171]
s_waitcnt lgkmcnt(3)
v_mfma_f32_32x32x16_bf16 v[64:79], v[128:131], v[136:139], v[64:79]
ds_read_b64_tr_b16 v[144:145], v216 offset:4096
ds_read_b64_tr_b16 v[146:147], v216 offset:5120
buffer_load_dwordx4 v211, s[20:23], s79 offen offset:3072 lds
s_waitcnt lgkmcnt(4)
v_mfma_f32_32x32x16_bf16 v[80:95], v[128:131], v[140:143], v[80:95]
ds_read_b128 v[152:155], v221 offset:16384
ds_read_b128 v[156:159], v221 offset:20480
v_mfma_f32_16x16x32_bf16 v[164:167], v[160:163], v[128:131], v[164:167]
s_waitcnt lgkmcnt(4)
v_mfma_f32_32x32x16_bf16 v[96:111], v[132:135], v[136:139], v[96:111]
ds_read_b64_tr_b16 v[148:149], v217 offset:4096
ds_read_b64_tr_b16 v[150:151], v217 offset:5120
s_add_u32 m0, s81, 81920
s_add_u32 s80, s80, 128
buffer_load_dwordx4 v212, s[8:11], s80 offen offset:0 lds
v_mfma_f32_32x32x16_bf16 v[112:127], v[132:135], v[140:143], v[112:127]
v_mfma_f32_16x16x32_bf16 v[168:171], v[160:163], v[132:135], v[168:171]
s_waitcnt lgkmcnt(3)
v_mfma_f32_32x32x16_bf16 v[64:79], v[144:147], v[152:155], v[64:79]
ds_read_b64_tr_b16 v[128:129], v216 offset:8192
ds_read_b64_tr_b16 v[130:131], v216 offset:9216
buffer_load_dwordx4 v213, s[8:11], s80 offen offset:1024 lds
s_waitcnt lgkmcnt(4)
v_mfma_f32_32x32x16_bf16 v[80:95], v[144:147], v[156:159], v[80:95]
ds_read_b128 v[136:139], v222 offset:16384
ds_read_b128 v[140:143], v222 offset:20480
v_mfma_f32_16x16x32_bf16 v[164:167], v[160:163], v[144:147], v[164:167]
s_waitcnt lgkmcnt(4)
v_mfma_f32_32x32x16_bf16 v[96:111], v[148:151], v[152:155], v[96:111]
ds_read_b64_tr_b16 v[132:133], v217 offset:8192
ds_read_b64_tr_b16 v[134:135], v217 offset:9216
buffer_load_dwordx4 v214, s[8:11], s80 offen offset:2048 lds
v_mfma_f32_32x32x16_bf16 v[112:127], v[148:151], v[156:159], v[112:127]
v_mfma_f32_16x16x32_bf16 v[168:171], v[160:163], v[148:151], v[168:171]
s_waitcnt lgkmcnt(3)
v_mfma_f32_32x32x16_bf16 v[64:79], v[128:131], v[136:139], v[64:79]
ds_read_b64_tr_b16 v[144:145], v216 offset:12288
ds_read_b64_tr_b16 v[146:147], v216 offset:13312
s_waitcnt vmcnt(10)
s_cmp_lg_u32 s5, 0
s_cbranch_scc1 L_back_12
v_cmp_gt_u32 vcc, 32, v254
s_cbranch_vccnz L_slow_11
L_back_12:
s_cmp_eq_u32 s82, 0
s_cbranch_scc0 L_nb_13
s_barrier
L_nb_13:
buffer_load_dwordx4 v215, s[8:11], s80 offen offset:3072 lds
s_waitcnt lgkmcnt(4)
v_mfma_f32_32x32x16_bf16 v[80:95], v[128:131], v[140:143], v[80:95]
ds_read_b128 v[152:155], v223 offset:16384
ds_read_b128 v[156:159], v223 offset:20480
s_cmp_eq_u32 s82, 1
s_cbranch_scc0 L_nb_14
s_barrier
L_nb_14:
s_cmp_lg_u32 s5, 0
s_cbranch_scc1 L_fl_15
s_mov_b64 exec, 1
buffer_store_dword v253, v252, s[24:27], 0 offen offset:0 sc1
s_mov_b64 exec, -1
L_fl_15:
v_mfma_f32_16x16x32_bf16 v[164:167], v[160:163], v[128:131], v[164:167]
s_waitcnt lgkmcnt(4)
v_mfma_f32_32x32x16_bf16 v[96:111], v[132:135], v[136:139], v[96:111]
ds_read_b64_tr_b16 v[148:149], v217 offset:12288
ds_read_b64_tr_b16 v[150:151], v217 offset:13312
s_add_u32 m0, s81, 98304
s_add_u32 s79, s79, 221184
buffer_load_dwordx4 v208, s[20:23], s79 offen offset:0 lds
v_mfma_f32_32x32x16_bf16 v[112:127], v[132:135], v[140:143], v[112:127]
v_mfma_f32_16x16x32_bf16 v[168:171], v[160:163], v[132:135], v[168:171]
s_waitcnt lgkmcnt(3)
v_mfma_f32_32x32x16_bf16 v[64:79], v[144:147], v[152:155], v[64:79]
ds_read_b64_tr_b16 v[128:129], v216 offset:32768
ds_read_b64_tr_b16 v[130:131], v216 offset:33792
buffer_load_dwordx4 v209, s[20:23], s79 offen offset:1024 lds
ds_read_b64_tr_b16 v[174:175], v200
ds_read_b64_tr_b16 v[176:177], v200 offset:2560
s_waitcnt lgkmcnt(6)
v_mfma_f32_32x32x16_bf16 v[80:95], v[144:147], v[156:159], v[80:95]
ds_read_b128 v[136:139], v220 offset:49152
ds_read_b128 v[140:143], v220 offset:53248
ds_read_b64_tr_b16 v[178:179], v201
ds_read_b64_tr_b16 v[180:181], v201 offset:2560
v_mfma_f32_16x16x32_bf16 v[164:167], v[160:163], v[144:147], v[164:167]
s_waitcnt lgkmcnt(8)
v_mfma_f32_32x32x16_bf16 v[96:111], v[148:151], v[152:155], v[96:111]
ds_read_b64_tr_b16 v[132:133], v217 offset:32768
ds_read_b64_tr_b16 v[134:135], v217 offset:33792
buffer_load_dwordx4 v210, s[20:23], s79 offen offset:2048 lds
ds_read_b64_tr_b16 v[182:183], v246
ds_read_b64_tr_b16 v[184:185], v246 offset:2560
v_mfma_f32_32x32x16_bf16 v[112:127], v[148:151], v[156:159], v[112:127]
v_mfma_f32_16x16x32_bf16 v[168:171], v[160:163], v[148:151], v[168:171]
s_waitcnt lgkmcnt(7)
v_mfma_f32_32x32x16_bf16 v[64:79], v[128:131], v[136:139], v[64:79]
ds_read_b64_tr_b16 v[144:145], v216 offset:36864
ds_read_b64_tr_b16 v[146:147], v216 offset:37888
buffer_load_dwordx4 v211, s[20:23], s79 offen offset:3072 lds
s_waitcnt lgkmcnt(8)
v_mfma_f32_32x32x16_bf16 v[80:95], v[128:131], v[140:143], v[80:95]
ds_read_b128 v[152:155], v221 offset:49152
ds_read_b128 v[156:159], v221 offset:53248
v_mfma_f32_16x16x32_bf16 v[164:167], v[160:163], v[128:131], v[164:167]
s_waitcnt lgkmcnt(6)
v_mfma_f32_32x32x16_bf16 v[96:111], v[132:135], v[136:139], v[96:111]
ds_read_b64_tr_b16 v[148:149], v217 offset:36864
ds_read_b64_tr_b16 v[150:151], v217 offset:37888
s_add_u32 m0, s81, 114688
s_add_u32 s80, s80, 128
buffer_load_dwordx4 v212, s[8:11], s80 offen offset:0 lds
v_mfma_f32_32x32x16_bf16 v[112:127], v[132:135], v[140:143], v[112:127]
v_mfma_f32_16x16x32_bf16 v[168:171], v[160:163], v[132:135], v[168:171]
s_waitcnt lgkmcnt(3)
v_mfma_f32_32x32x16_bf16 v[64:79], v[144:147], v[152:155], v[64:79]
ds_read_b64_tr_b16 v[128:129], v216 offset:40960
ds_read_b64_tr_b16 v[130:131], v216 offset:41984
buffer_load_dwordx4 v213, s[8:11], s80 offen offset:1024 lds
s_waitcnt lgkmcnt(4)
v_mfma_f32_32x32x16_bf16 v[80:95], v[144:147], v[156:159], v[80:95]
ds_read_b128 v[136:139], v222 offset:49152
ds_read_b128 v[140:143], v222 offset:53248
v_mfma_f32_16x16x32_bf16 v[164:167], v[160:163], v[144:147], v[164:167]
s_waitcnt lgkmcnt(4)
v_mfma_f32_32x32x16_bf16 v[96:111], v[148:151], v[152:155], v[96:111]
ds_read_b64_tr_b16 v[132:133], v217 offset:40960
ds_read_b64_tr_b16 v[134:135], v217 offset:41984
buffer_load_dwordx4 v214, s[8:11], s80 offen offset:2048 lds
v_mfma_f32_32x32x16_bf16 v[112:127], v[148:151], v[156:159], v[112:127]
buffer_load_dword v254, v231, s[24:27], 0 offen sc1
v_mfma_f32_16x16x32_bf16 v[168:171], v[160:163], v[148:151], v[168:171]
s_waitcnt lgkmcnt(3)
v_mfma_f32_32x32x16_bf16 v[64:79], v[128:131], v[136:139], v[64:79]
ds_read_b64_tr_b16 v[144:145], v216 offset:45056
ds_read_b64_tr_b16 v[146:147], v216 offset:46080
s_waitcnt vmcnt(8)
s_cmp_eq_u32 s82, 0
s_cbranch_scc0 L_nb_16
s_barrier
L_nb_16:
buffer_load_dwordx4 v215, s[8:11], s80 offen offset:3072 lds
s_waitcnt lgkmcnt(4)
v_mfma_f32_32x32x16_bf16 v[80:95], v[128:131], v[140:143], v[80:95]
ds_read_b128 v[152:155], v223 offset:49152
ds_read_b128 v[156:159], v223 offset:53248
s_cmp_eq_u32 s82, 1
s_cbranch_scc0 L_nb_17
s_barrier
L_nb_17:
buffer_store_dwordx4 v[174:177], v207, s[24:27], s75 offen sc1
v_mfma_f32_16x16x32_bf16 v[164:167], v[160:163], v[128:131], v[164:167]
s_waitcnt lgkmcnt(4)
v_mfma_f32_32x32x16_bf16 v[96:111], v[132:135], v[136:139], v[96:111]
ds_read_b64_tr_b16 v[148:149], v217 offset:45056
ds_read_b64_tr_b16 v[150:151], v217 offset:46080
s_add_u32 m0, s81, 0
s_add_u32 s79, s79, 221184
buffer_load_dwordx4 v208, s[20:23], s79 offen offset:0 lds
buffer_store_dwordx4 v[178:181], v207, s[24:27], s76 offen sc1
v_mfma_f32_32x32x16_bf16 v[112:127], v[132:135], v[140:143], v[112:127]
v_mfma_f32_16x16x32_bf16 v[168:171], v[160:163], v[132:135], v[168:171]
s_waitcnt lgkmcnt(3)
v_mfma_f32_32x32x16_bf16 v[64:79], v[144:147], v[152:155], v[64:79]
ds_read_b64_tr_b16 v[128:129], v218 offset:0
ds_read_b64_tr_b16 v[130:131], v218 offset:1024
buffer_load_dwordx4 v209, s[20:23], s79 offen offset:1024 lds
s_waitcnt lgkmcnt(4)
v_mfma_f32_32x32x16_bf16 v[80:95], v[144:147], v[156:159], v[80:95]
ds_read_b128 v[136:139], v224 offset:16384
ds_read_b128 v[140:143], v224 offset:20480
v_mfma_f32_16x16x32_bf16 v[164:167], v[160:163], v[144:147], v[164:167]
s_waitcnt lgkmcnt(4)
v_mfma_f32_32x32x16_bf16 v[96:111], v[148:151], v[152:155], v[96:111]
ds_read_b64_tr_b16 v[132:133], v219 offset:0
ds_read_b64_tr_b16 v[134:135], v219 offset:1024
buffer_load_dwordx4 v210, s[20:23], s79 offen offset:2048 lds
v_mfma_f32_32x32x16_bf16 v[112:127], v[148:151], v[156:159], v[112:127]
v_mfma_f32_16x16x32_bf16 v[168:171], v[160:163], v[148:151], v[168:171]
s_waitcnt lgkmcnt(3)
v_mfma_f32_32x32x16_bf16 v[64:79], v[128:131], v[136:139], v[64:79]
ds_read_b64_tr_b16 v[144:145], v218 offset:4096
ds_read_b64_tr_b16 v[146:147], v218 offset:5120
buffer_load_dwordx4 v211, s[20:23], s79 offen offset:3072 lds
s_waitcnt lgkmcnt(4)
v_mfma_f32_32x32x16_bf16 v[80:95], v[128:131], v[140:143], v[80:95]
ds_read_b128 v[152:155], v225 offset:16384
ds_read_b128 v[156:159], v225 offset:20480
v_mfma_f32_16x16x32_bf16 v[164:167], v[160:163], v[128:131], v[164:167]
s_waitcnt lgkmcnt(4)
v_mfma_f32_32x32x16_bf16 v[96:111], v[132:135], v[136:139], v[96:111]
ds_read_b64_tr_b16 v[148:149], v219 offset:4096
ds_read_b64_tr_b16 v[150:151], v219 offset:5120
s_add_u32 m0, s81, 16384
s_add_u32 s80, s80, 128
buffer_load_dwordx4 v212, s[8:11], s80 offen offset:0 lds
v_mfma_f32_32x32x16_bf16 v[112:127], v[132:135], v[140:143], v[112:127]
v_mfma_f32_16x16x32_bf16 v[168:171], v[160:163], v[132:135], v[168:171]
s_waitcnt lgkmcnt(3)
v_mfma_f32_32x32x16_bf16 v[64:79], v[144:147], v[152:155], v[64:79]
ds_read_b64_tr_b16 v[128:129], v218 offset:8192
ds_read_b64_tr_b16 v[130:131], v218 offset:9216
buffer_load_dwordx4 v213, s[8:11], s80 offen offset:1024 lds
s_waitcnt lgkmcnt(4)
v_mfma_f32_32x32x16_bf16 v[80:95], v[144:147], v[156:159], v[80:95]
ds_read_b128 v[136:139], v226 offset:16384
ds_read_b128 v[140:143], v226 offset:20480
v_mfma_f32_16x16x32_bf16 v[164:167], v[160:163], v[144:147], v[164:167]
s_waitcnt lgkmcnt(4)
v_mfma_f32_32x32x16_bf16 v[96:111], v[148:151], v[152:155], v[96:111]
ds_read_b64_tr_b16 v[132:133], v219 offset:8192
ds_read_b64_tr_b16 v[134:135], v219 offset:9216
buffer_load_dwordx4 v214, s[8:11], s80 offen offset:2048 lds
v_mfma_f32_32x32x16_bf16 v[112:127], v[148:151], v[156:159], v[112:127]
v_mfma_f32_16x16x32_bf16 v[168:171], v[160:163], v[148:151], v[168:171]
s_waitcnt lgkmcnt(3)
v_mfma_f32_32x32x16_bf16 v[64:79], v[128:131], v[136:139], v[64:79]
ds_read_b64_tr_b16 v[144:145], v218 offset:12288
ds_read_b64_tr_b16 v[146:147], v218 offset:13312
s_waitcnt vmcnt(9)
s_cmp_eq_u32 s82, 0
s_cbranch_scc0 L_nb_18
s_barrier
L_nb_18:
buffer_load_dwordx4 v215, s[8:11], s80 offen offset:3072 lds
s_waitcnt lgkmcnt(4)
v_mfma_f32_32x32x16_bf16 v[80:95], v[128:131], v[140:143], v[80:95]
ds_read_b128 v[152:155], v227 offset:16384
ds_read_b128 v[156:159], v227 offset:20480
s_cmp_eq_u32 s82, 1
s_cbranch_scc0 L_nb_19
s_barrier
L_nb_19:
buffer_store_dwordx4 v[182:185], v173, s[24:27], s93 offen sc1
v_mfma_f32_16x16x32_bf16 v[164:167], v[160:163], v[128:131], v[164:167]
s_waitcnt lgkmcnt(4)
v_mfma_f32_32x32x16_bf16 v[96:111], v[132:135], v[136:139], v[96:111]
ds_read_b64_tr_b16 v[148:149], v219 offset:12288
ds_read_b64_tr_b16 v[150:151], v219 offset:13312
s_add_u32 m0, s81, 32768
s_add_u32 s79, s79, 221184
buffer_load_dwordx4 v208, s[20:23], s79 offen offset:0 lds
v_mfma_f32_32x32x16_bf16 v[112:127], v[132:135], v[140:143], v[112:127]
v_mfma_f32_16x16x32_bf16 v[168:171], v[160:163], v[132:135], v[168:171]
s_waitcnt lgkmcnt(3)
v_mfma_f32_32x32x16_bf16 v[64:79], v[144:147], v[152:155], v[64:79]
ds_read_b64_tr_b16 v[128:129], v218 offset:32768
ds_read_b64_tr_b16 v[130:131], v218 offset:33792
buffer_load_dwordx4 v209, s[20:23], s79 offen offset:1024 lds
s_waitcnt lgkmcnt(4)
v_mfma_f32_32x32x16_bf16 v[80:95], v[144:147], v[156:159], v[80:95]
ds_read_b128 v[136:139], v224 offset:49152
ds_read_b128 v[140:143], v224 offset:53248
v_mfma_f32_16x16x32_bf16 v[164:167], v[160:163], v[144:147], v[164:167]
s_waitcnt lgkmcnt(4)
v_mfma_f32_32x32x16_bf16 v[96:111], v[148:151], v[152:155], v[96:111]
ds_read_b64_tr_b16 v[132:133], v219 offset:32768
ds_read_b64_tr_b16 v[134:135], v219 offset:33792
buffer_load_dwordx4 v210, s[20:23], s79 offen offset:2048 lds
v_mfma_f32_32x32x16_bf16 v[112:127], v[148:151], v[156:159], v[112:127]
v_mfma_f32_16x16x32_bf16 v[168:171], v[160:163], v[148:151], v[168:171]
s_waitcnt lgkmcnt(3)
v_mfma_f32_32x32x16_bf16 v[64:79], v[128:131], v[136:139], v[64:79]
ds_read_b64_tr_b16 v[144:145], v218 offset:36864
ds_read_b64_tr_b16 v[146:147], v218 offset:37888
buffer_load_dwordx4 v211, s[20:23], s79 offen offset:3072 lds
s_waitcnt lgkmcnt(4)
v_mfma_f32_32x32x16_bf16 v[80:95], v[128:131], v[140:143], v[80:95]
ds_read_b128 v[152:155], v225 offset:49152
ds_read_b128 v[156:159], v225 offset:53248
v_mfma_f32_16x16x32_bf16 v[164:167], v[160:163], v[128:131], v[164:167]
s_waitcnt lgkmcnt(4)
v_mfma_f32_32x32x16_bf16 v[96:111], v[132:135], v[136:139], v[96:111]
ds_read_b64_tr_b16 v[148:149], v219 offset:36864
ds_read_b64_tr_b16 v[150:151], v219 offset:37888
s_add_u32 m0, s81, 49152
s_add_u32 s80, s80, 128
buffer_load_dwordx4 v212, s[8:11], s80 offen offset:0 lds
v_mfma_f32_32x32x16_bf16 v[112:127], v[132:135], v[140:143], v[112:127]
v_mfma_f32_16x16x32_bf16 v[168:171], v[160:163], v[132:135], v[168:171]
s_waitcnt lgkmcnt(3)
v_mfma_f32_32x32x16_bf16 v[64:79], v[144:147], v[152:155], v[64:79]
ds_read_b64_tr_b16 v[128:129], v218 offset:40960
ds_read_b64_tr_b16 v[130:131], v218 offset:41984
buffer_load_dwordx4 v213, s[8:11], s80 offen offset:1024 lds
s_waitcnt lgkmcnt(4)
v_mfma_f32_32x32x16_bf16 v[80:95], v[144:147], v[156:159], v[80:95]
ds_read_b128 v[136:139], v226 offset:49152
ds_read_b128 v[140:143], v226 offset:53248
v_mfma_f32_16x16x32_bf16 v[164:167], v[160:163], v[144:147], v[164:167]
s_waitcnt lgkmcnt(4)
v_mfma_f32_32x32x16_bf16 v[96:111], v[148:151], v[152:155], v[96:111]
ds_read_b64_tr_b16 v[132:133], v219 offset:40960
ds_read_b64_tr_b16 v[134:135], v219 offset:41984
buffer_load_dwordx4 v214, s[8:11], s80 offen offset:2048 lds
v_mfma_f32_32x32x16_bf16 v[112:127], v[148:151], v[156:159], v[112:127]
v_mfma_f32_16x16x32_bf16 v[168:171], v[160:163], v[148:151], v[168:171]
s_waitcnt lgkmcnt(3)
v_mfma_f32_32x32x16_bf16 v[64:79], v[128:131], v[136:139], v[64:79]
ds_read_b64_tr_b16 v[144:145], v218 offset:45056
ds_read_b64_tr_b16 v[146:147], v218 offset:46080
s_waitcnt vmcnt(8)
s_cmp_lg_u32 s5, 0
s_cbranch_scc1 L_back_21
v_cmp_eq_u32 vcc, 0, v254
s_cbranch_vccnz L_slow_20
L_back_21:
s_cmp_eq_u32 s82, 0
s_cbranch_scc0 L_nb_22
s_barrier
L_nb_22:
buffer_load_dwordx4 v215, s[8:11], s80 offen offset:3072 lds
s_waitcnt lgkmcnt(4)
v_mfma_f32_32x32x16_bf16 v[80:95], v[128:131], v[140:143], v[80:95]
ds_read_b128 v[152:155], v227 offset:49152
ds_read_b128 v[156:159], v227 offset:53248
s_cmp_eq_u32 s82, 1
s_cbranch_scc0 L_nb_23
s_barrier
L_nb_23:
s_mov_b32 s36, s56
s_and_b32 s37, s57, 0xffff
s_mov_b32 s38, 3456
s_mov_b32 s39, 0x20000
v_and_b32 v2, 31, v1
s_lshl_b32 s6, s78, 7
s_lshl_b32 s7, s82, 6
s_add_u32 s6, s6, s7
v_add_u32 v3, s6, v2
v_lshlrev_b32 v3, 1, v3
s_cmp_ge_u32 s6, 1728
s_cselect_b32 s101, 0, 32
s_lshl_b32 s6, s77, 7
s_lshl_b32 s7, s83, 6
s_add_u32 s6, s6, s7
v_add_u32 v4, s6, v2
v_lshlrev_b32 v4, 4, v4
v_mov_b32 v5, 2147418112
v_cmp_gt_u32 vcc, 32, v1
v_cndmask_b32 v3, v5, v3, vcc
v_cndmask_b32 v5, v5, v4, vcc
s_mov_b32 s7, 65536
s_mov_b32 s84, 98304
buffer_load_ushort v28, v3, s[36:39], 0 offen
buffer_load_ushort v32, v3, s[36:39], 0 offen offset:64
buffer_load_dwordx4 v[36:39], v5, s[24:27], s7 offen
buffer_load_dwordx4 v[40:43], v5, s[24:27], s7 offen offset:512
buffer_load_dwordx4 v[44:47], v4, s[24:27], s84 offen
buffer_load_dwordx4 v[48:51], v4, s[24:27], s84 offen offset:512
v_mfma_f32_16x16x32_bf16 v[164:167], v[160:163], v[128:131], v[164:167]
s_waitcnt lgkmcnt(4)
v_mfma_f32_32x32x16_bf16 v[96:111], v[132:135], v[136:139], v[96:111]
ds_read_b64_tr_b16 v[148:149], v219 offset:45056
ds_read_b64_tr_b16 v[150:151], v219 offset:46080
s_mov_b32 s32, s48
s_and_b32 s33, s49, 0xffff
s_mov_b32 s34, 2621440
s_mov_b32 s35, 0x20000
s_lshl_b32 s6, s88, 5
s_mul_i32 s7, s5, 24
s_add_u32 s6, s6, s7
v_add_u32 v2, s6, v1
v_lshlrev_b32 v235, 7, v2
s_mov_b32 exec_lo, 0xffffff
s_mov_b32 exec_hi, 0x0
buffer_load_dword v234, v235, s[32:35], 0 offen
s_mov_b64 exec, -1
v_mfma_f32_32x32x16_bf16 v[112:127], v[132:135], v[140:143], v[112:127]
v_mfma_f32_16x16x32_bf16 v[168:171], v[160:163], v[132:135], v[168:171]
s_waitcnt lgkmcnt(3)
v_mfma_f32_32x32x16_bf16 v[64:79], v[144:147], v[152:155], v[64:79]
ds_read_b64_tr_b16 v[128:129], v216 offset:0
ds_read_b64_tr_b16 v[130:131], v216 offset:1024
s_lshl_b32 s6, s5, 2
v_lshlrev_b32 v202, 2, v1
v_add_u32 v202, s6, v202
v_subrev_u32 v202, 252, v202
v_add_u32 v203, s6, v248
v_add_u32 v203, 4, v203
s_mul_i32 s90, s5, 4416
s_lshr_b32 s6, s4, 3
s_waitcnt lgkmcnt(4)
v_mfma_f32_32x32x16_bf16 v[80:95], v[144:147], v[156:159], v[80:95]
ds_read_b128 v[136:139], v220 offset:16384
ds_read_b128 v[140:143], v220 offset:20480
s_mul_i32 s6, s6, 14
s_and_b32 s7, s4, 7
s_mul_i32 s7, s7, 7
s_add_u32 s6, s6, s7
s_lshr_b32 s6, s6, 2
s_cmp_ge_u32 s5, 2
s_cselect_b32 s43, 13, 14
s_cmp_ge_u32 s6, s43
s_cselect_b32 s7, s43, 0
v_mfma_f32_16x16x32_bf16 v[164:167], v[160:163], v[144:147], v[164:167]
s_waitcnt lgkmcnt(4)
v_mfma_f32_32x32x16_bf16 v[96:111], v[148:151], v[152:155], v[96:111]
ds_read_b64_tr_b16 v[132:133], v217 offset:0
ds_read_b64_tr_b16 v[134:135], v217 offset:1024
s_sub_u32 s93, s6, s7
s_mov_b32 s93, 0
s_mul_i32 s6, s95, 54
s_add_u32 s6, s6, s96
s_mul_i32 s79, s6, 5120
s_add_u32 s79, s79, 7340032
s_mul_i32 s7, s43, 5120
s_add_u32 s80, s79, s7
v_mfma_f32_32x32x16_bf16 v[112:127], v[148:151], v[156:159], v[112:127]
s_mul_i32 s7, s93, 5120
s_add_u32 s97, s79, s7
s_add_u32 s98, s97, 4096
v_and_b32 v2, 15, v1
v_lshrrev_b32 v3, 3, v2
v_lshlrev_b32 v3, 3, v3
v_and_b32 v4, 1, v2
v_lshl_or_b32 v3, v4, 2, v3
v_mfma_f32_16x16x32_bf16 v[168:171], v[160:163], v[148:151], v[168:171]
s_waitcnt lgkmcnt(3)
v_mfma_f32_32x32x16_bf16 v[64:79], v[128:131], v[136:139], v[64:79]
ds_read_b64_tr_b16 v[144:145], v216 offset:4096
ds_read_b64_tr_b16 v[146:147], v216 offset:5120
v_bfe_u32 v4, v2, 1, 2
v_or_b32 v3, v3, v4
v_lshlrev_b32 v3, 4, v3
v_bfe_u32 v4, v1, 4, 1
v_lshl_or_b32 v3, v4, 10, v3
v_lshrrev_b32 v4, 5, v1
v_lshl_or_b32 v3, v4, 8, v3
v_mov_b32 v4, 2147418112
s_waitcnt lgkmcnt(4)
v_mfma_f32_32x32x16_bf16 v[80:95], v[128:131], v[140:143], v[80:95]
ds_read_b128 v[152:155], v221 offset:16384
ds_read_b128 v[156:159], v221 offset:20480
s_cmp_eq_u32 s101, 0
s_cselect_b64 vcc, -1, 0
v_cndmask_b32 v60, v3, v4, vcc
s_lshl_b32 s6, s77, 1
s_add_u32 s6, s6, s83
s_mul_i32 s6, s6, 54
s_lshl_b32 s7, s78, 2
s_add_u32 s6, s6, s7
v_mfma_f32_16x16x32_bf16 v[164:167], v[160:163], v[128:131], v[164:167]
s_waitcnt lgkmcnt(4)
v_mfma_f32_32x32x16_bf16 v[96:111], v[132:135], v[136:139], v[96:111]
ds_read_b64_tr_b16 v[148:149], v217 offset:4096
ds_read_b64_tr_b16 v[150:151], v217 offset:5120
s_lshl_b32 s7, s82, 1
s_add_u32 s6, s6, s7
s_lshl_b32 s6, s6, 12
s_add_u32 s100, s6, 10485760
s_add_u32 s101, s100, 4096
s_lshl_b32 s6, s89, 2
s_add_u32 s6, s6, s5
s_lshl_b32 s7, s6, 1
v_mfma_f32_32x32x16_bf16 v[112:127], v[132:135], v[140:143], v[112:127]
s_lshr_b32 s85, 6436, s7
s_and_b32 s85, s85, 3
s_lshr_b32 s86, 55, s6
s_and_b32 s86, s86, 1
s_lshr_b32 s87, 61311, s7
s_and_b32 s87, s87, 3
v_and_b32 v2, 3, v1
v_mul_u32_u24 v2, 4416, v2
v_mfma_f32_16x16x32_bf16 v[168:171], v[160:163], v[132:135], v[168:171]
s_waitcnt lgkmcnt(3)
v_mfma_f32_32x32x16_bf16 v[64:79], v[144:147], v[152:155], v[64:79]
ds_read_b64_tr_b16 v[128:129], v216 offset:8192
ds_read_b64_tr_b16 v[130:131], v216 offset:9216
v_bfe_u32 v3, v1, 2, 2
v_lshrrev_b32 v18, 4, v1
v_add_u32 v3, v3, v18
v_lshl_add_u32 v16, v3, 4, v2
v_and_b32 v2, 1, v1
v_mul_u32_u24 v2, 6272, v2
v_bfe_u32 v3, v1, 1, 3
s_lshl_b32 s6, s86, 3
s_waitcnt lgkmcnt(4)
v_mfma_f32_32x32x16_bf16 v[80:95], v[144:147], v[156:159], v[80:95]
ds_read_b128 v[136:139], v222 offset:16384
ds_read_b128 v[140:143], v222 offset:20480
s_sub_u32 s6, 15, s6
v_sub_u32 v5, s6, v3
v_mul_u32_u24 v5, 272, v5
v_add_u32 v2, v2, v5
v_lshl_add_u32 v17, v18, 4, v2
s_lshl_b32 s6, s86, 3
v_add_u32 v3, s6, v3
v_lshlrev_b32 v3, 8, v3
v_mfma_f32_16x16x32_bf16 v[164:167], v[160:163], v[144:147], v[164:167]
s_waitcnt lgkmcnt(4)
v_mfma_f32_32x32x16_bf16 v[96:111], v[148:151], v[152:155], v[96:111]
ds_read_b64_tr_b16 v[132:133], v217 offset:8192
ds_read_b64_tr_b16 v[134:135], v217 offset:9216
v_and_b32 v2, 1, v1
v_lshl_or_b32 v2, v18, 1, v2
v_lshl_or_b32 v11, v2, 4, v3
s_mul_i32 s6, s85, 30208
s_add_u32 s6, s6, 65536
v_add_u32 v8, s6, v16
s_add_u32 s6, s6, 17664
v_add_u32 v9, s6, v17
v_mfma_f32_32x32x16_bf16 v[112:127], v[148:151], v[156:159], v[112:127]
v_lshlrev_b32 v10, 5, v18
v_sub_u32 v10, v9, v10
v_add_u32 v10, 0, v10
s_add_u32 s91, s88, s85
v_mfma_f32_16x16x32_bf16 v[168:171], v[160:163], v[148:151], v[168:171]
s_waitcnt lgkmcnt(3)
v_mfma_f32_32x32x16_bf16 v[64:79], v[128:131], v[136:139], v[64:79]
ds_read_b64_tr_b16 v[144:145], v216 offset:12288
ds_read_b64_tr_b16 v[146:147], v216 offset:13312
s_waitcnt vmcnt(7)
s_cmp_eq_u32 s82, 0
s_cbranch_scc0 L_nb_24
s_barrier
L_nb_24:
s_waitcnt lgkmcnt(4)
v_mfma_f32_32x32x16_bf16 v[80:95], v[128:131], v[140:143], v[80:95]
ds_read_b128 v[152:155], v223 offset:16384
ds_read_b128 v[156:159], v223 offset:20480
s_cmp_eq_u32 s82, 1
s_cbranch_scc0 L_nb_25
s_barrier
L_nb_25:
s_cmp_lg_u32 s5, 0
s_cbranch_scc1 L_fl_26
s_mov_b64 exec, 1
buffer_store_dword v253, v252, s[24:27], 0 offen offset:12 sc1
s_mov_b64 exec, -1
L_fl_26:
v_mfma_f32_16x16x32_bf16 v[164:167], v[160:163], v[128:131], v[164:167]
s_waitcnt lgkmcnt(4)
v_mfma_f32_32x32x16_bf16 v[96:111], v[132:135], v[136:139], v[96:111]
ds_read_b64_tr_b16 v[148:149], v217 offset:12288
ds_read_b64_tr_b16 v[150:151], v217 offset:13312
s_add_u32 s6, s88, 0
s_lshl_b32 s6, s6, 12
s_add_u32 s32, s48, s6
s_addc_u32 s33, s49, 0
s_and_b32 s33, s33, 0xffff
s_mov_b32 s34, 4096
s_mov_b32 s35, 0x20000
s_add_u32 m0, s90, 65536
s_nop 0
buffer_load_dword v202, s[32:35], 0 offen lds
s_add_u32 m0, s90, 65792
s_nop 0
v_mfma_f32_32x32x16_bf16 v[112:127], v[132:135], v[140:143], v[112:127]
buffer_load_dwordx4 v203, s[32:35], 0 offen offset:0 lds
v_mfma_f32_16x16x32_bf16 v[168:171], v[160:163], v[132:135], v[168:171]
s_waitcnt lgkmcnt(3)
v_mfma_f32_32x32x16_bf16 v[64:79], v[144:147], v[152:155], v[64:79]
ds_read_b64_tr_b16 v[128:129], v216 offset:32768
ds_read_b64_tr_b16 v[130:131], v216 offset:33792
v_lshlrev_b32 v5, 4, v0
v_add_u32 v5, 87552, v5
v_add_u32 v7, 60416, v5
v_mov_b32 v12, 0
buffer_load_dwordx4 v203, s[32:35], 0 offen offset:1024 lds
s_waitcnt lgkmcnt(4)
v_mfma_f32_32x32x16_bf16 v[80:95], v[144:147], v[156:159], v[80:95]
ds_read_b128 v[136:139], v220 offset:49152
ds_read_b128 v[140:143], v220 offset:53248
v_mov_b32 v13, 0
v_mov_b32 v14, 0
v_mov_b32 v15, 0
buffer_load_dwordx4 v203, s[32:35], 0 offen offset:2048 lds
v_mfma_f32_16x16x32_bf16 v[164:167], v[160:163], v[144:147], v[164:167]
s_waitcnt lgkmcnt(4)
v_mfma_f32_32x32x16_bf16 v[96:111], v[148:151], v[152:155], v[96:111]
ds_read_b64_tr_b16 v[132:133], v217 offset:32768
ds_read_b64_tr_b16 v[134:135], v217 offset:33792
v_cmp_gt_u32 vcc, 119, v0
s_and_saveexec_b64 s[6:7], vcc
ds_write_b128 v5, v[12:15] offset:0
ds_write_b128 v5, v[12:15] offset:6272
ds_write_b128 v5, v[12:15] offset:30208
ds_write_b128 v5, v[12:15] offset:36480
ds_write_b128 v7, v[12:15] offset:0
ds_write_b128 v7, v[12:15] offset:6272
s_mov_b64 exec, s[6:7]
v_mfma_f32_32x32x16_bf16 v[112:127], v[148:151], v[156:159], v[112:127]
buffer_load_dwordx4 v203, s[32:35], 0 offen offset:3072 lds
v_mfma_f32_16x16x32_bf16 v[168:171], v[160:163], v[148:151], v[168:171]
s_waitcnt lgkmcnt(9)
v_mfma_f32_32x32x16_bf16 v[64:79], v[128:131], v[136:139], v[64:79]
ds_read_b64_tr_b16 v[144:145], v216 offset:36864
ds_read_b64_tr_b16 v[146:147], v216 offset:37888
s_and_b32 s46, s88, 0xfffffffe
s_sub_u32 s46, s91, s46
s_cmp_ge_u32 s46, 2
s_cselect_b32 s47, s1, s0
s_add_u32 s6, s88, 1
s_lshl_b32 s6, s6, 12
s_add_u32 s32, s48, s6
s_addc_u32 s33, s49, 0
s_and_b32 s33, s33, 0xffff
s_mov_b32 s34, 4096
s_mov_b32 s35, 0x20000
s_add_u32 m0, s90, 95744
s_nop 0
buffer_load_dword v202, s[32:35], 0 offen lds
s_add_u32 m0, s90, 96000
s_nop 0
s_waitcnt lgkmcnt(10)
v_mfma_f32_32x32x16_bf16 v[80:95], v[128:131], v[140:143], v[80:95]
ds_read_b128 v[152:155], v221 offset:49152
ds_read_b128 v[156:159], v221 offset:53248
s_and_b32 s46, s46, 1
s_lshl_b32 s46, s46, 4
s_lshr_b32 s47, s47, s46
buffer_load_dwordx4 v203, s[32:35], 0 offen offset:0 lds
v_mfma_f32_16x16x32_bf16 v[164:167], v[160:163], v[128:131], v[164:167]
s_waitcnt lgkmcnt(10)
v_mfma_f32_32x32x16_bf16 v[96:111], v[132:135], v[136:139], v[96:111]
ds_read_b64_tr_b16 v[148:149], v217 offset:36864
ds_read_b64_tr_b16 v[150:151], v217 offset:37888
s_and_b32 s47, s47, 0xffff
v_mov_b32 v61, s47
v_and_b32 v19, 15, v1
buffer_load_dwordx4 v203, s[32:35], 0 offen offset:1024 lds
v_mfma_f32_32x32x16_bf16 v[112:127], v[132:135], v[140:143], v[112:127]
v_lshl_add_u32 v19, v18, 2, v19
v_sub_u32 v19, 15, v19
v_cmp_eq_u32 vcc, 0, v19
v_cndmask_b32 v192, 0, v61, vcc
buffer_load_dwordx4 v203, s[32:35], 0 offen offset:2048 lds
v_mfma_f32_16x16x32_bf16 v[168:171], v[160:163], v[132:135], v[168:171]
s_waitcnt lgkmcnt(3)
v_mfma_f32_32x32x16_bf16 v[64:79], v[144:147], v[152:155], v[64:79]
ds_read_b64_tr_b16 v[128:129], v216 offset:40960
ds_read_b64_tr_b16 v[130:131], v216 offset:41984
v_cmp_eq_u32 vcc, 1, v19
v_cndmask_b32 v193, 0, v61, vcc
v_cmp_eq_u32 vcc, 2, v19
v_cndmask_b32 v194, 0, v61, vcc
buffer_load_dwordx4 v203, s[32:35], 0 offen offset:3072 lds
s_waitcnt lgkmcnt(4)
v_mfma_f32_32x32x16_bf16 v[80:95], v[144:147], v[156:159], v[80:95]
ds_read_b128 v[136:139], v222 offset:49152
ds_read_b128 v[140:143], v222 offset:53248
v_cmp_eq_u32 vcc, 3, v19
v_cndmask_b32 v195, 0, v61, vcc
s_lshl_b32 s92, s91, 12
s_add_u32 s6, s88, 2
s_lshl_b32 s6, s6, 12
s_add_u32 s32, s48, s6
s_addc_u32 s33, s49, 0
s_and_b32 s33, s33, 0xffff
s_mov_b32 s34, 4096
s_mov_b32 s35, 0x20000
s_add_u32 m0, s90, 125952
s_nop 0
buffer_load_dword v202, s[32:35], 0 offen lds
s_add_u32 m0, s90, 126208
s_nop 0
v_mfma_f32_16x16x32_bf16 v[164:167], v[160:163], v[144:147], v[164:167]
s_waitcnt lgkmcnt(4)
v_mfma_f32_32x32x16_bf16 v[96:111], v[148:151], v[152:155], v[96:111]
ds_read_b64_tr_b16 v[132:133], v217 offset:40960
ds_read_b64_tr_b16 v[134:135], v217 offset:41984
s_add_u32 s92, s92, 4194304
buffer_load_dwordx4 v203, s[32:35], 0 offen offset:0 lds
v_mfma_f32_32x32x16_bf16 v[112:127], v[148:151], v[156:159], v[112:127]
buffer_load_dwordx4 v203, s[32:35], 0 offen offset:1024 lds
v_mfma_f32_16x16x32_bf16 v[168:171], v[160:163], v[148:151], v[168:171]
s_waitcnt lgkmcnt(3)
v_mfma_f32_32x32x16_bf16 v[64:79], v[128:131], v[136:139], v[64:79]
ds_read_b64_tr_b16 v[144:145], v216 offset:45056
ds_read_b64_tr_b16 v[146:147], v216 offset:46080
buffer_load_dwordx4 v203, s[32:35], 0 offen offset:2048 lds
s_waitcnt lgkmcnt(4)
v_mfma_f32_32x32x16_bf16 v[80:95], v[128:131], v[140:143], v[80:95]
ds_read_b128 v[152:155], v223 offset:49152
ds_read_b128 v[156:159], v223 offset:53248
buffer_load_dwordx4 v203, s[32:35], 0 offen offset:3072 lds
v_mfma_f32_16x16x32_bf16 v[164:167], v[160:163], v[128:131], v[164:167]
s_waitcnt lgkmcnt(4)
v_mfma_f32_32x32x16_bf16 v[96:111], v[132:135], v[136:139], v[96:111]
ds_read_b64_tr_b16 v[148:149], v217 offset:45056
ds_read_b64_tr_b16 v[150:151], v217 offset:46080
v_mfma_f32_32x32x16_bf16 v[112:127], v[132:135], v[140:143], v[112:127]
v_mfma_f32_16x16x32_bf16 v[168:171], v[160:163], v[132:135], v[168:171]
s_waitcnt lgkmcnt(3)
v_mfma_f32_32x32x16_bf16 v[64:79], v[144:147], v[152:155], v[64:79]
s_waitcnt lgkmcnt(2)
v_mfma_f32_32x32x16_bf16 v[80:95], v[144:147], v[156:159], v[80:95]
v_mfma_f32_16x16x32_bf16 v[164:167], v[160:163], v[144:147], v[164:167]
s_waitcnt lgkmcnt(0)
v_mfma_f32_32x32x16_bf16 v[96:111], v[148:151], v[152:155], v[96:111]
v_mfma_f32_32x32x16_bf16 v[112:127], v[148:151], v[156:159], v[112:127]
v_mfma_f32_16x16x32_bf16 v[168:171], v[160:163], v[148:151], v[168:171]
s_waitcnt vmcnt(16)
s_nop 7
v_lshl_or_b32 v28, v28, 16, v28
v_cvt_pk_bf16_f32 v29, v164, v164
v_lshlrev_b32 v2, 16, v29
v_sub_f32 v2, v164, v2
v_cvt_pk_bf16_f32 v30, v2, v2
v_mov_b32 v31, 0
v_lshl_or_b32 v32, v32, 16, v32
v_cvt_pk_bf16_f32 v33, v168, v168
v_lshlrev_b32 v2, 16, v33
v_sub_f32 v2, v168, v2
v_cvt_pk_bf16_f32 v34, v2, v2
v_mov_b32 v35, 0
s_nop 1
v_mfma_f32_32x32x16_bf16 v[64:79], v[28:31], v[36:39], v[64:79]
v_mfma_f32_32x32x16_bf16 v[80:95], v[28:31], v[40:43], v[80:95]
v_mfma_f32_32x32x16_bf16 v[96:111], v[32:35], v[36:39], v[96:111]
v_mfma_f32_32x32x16_bf16 v[112:127], v[32:35], v[40:43], v[112:127]
v_mul_f32 v52, -2.302208198144325, v45
v_mul_f32 v2, v45, v45
v_mul_f32 v2, v2, v45
v_mul_f32 v53, -0.1029432395800235, v2
v_mov_b32 v54, v46
v_mov_b32 v55, v46
v_mul_f32 v56, -2.302208198144325, v49
v_mul_f32 v2, v49, v49
v_mul_f32 v2, v2, v49
v_mul_f32 v57, -0.1029432395800235, v2
v_mov_b32 v58, v50
v_mov_b32 v59, v50
buffer_load_dword v251, v229, s[24:27], 0 offen sc1
v_pk_mul_f32 v[160:161], v[64:65], v[64:65]
v_pk_mul_f32 v[162:163], v[66:67], v[66:67]
v_pk_mul_f32 v[164:165], v[68:69], v[68:69]
v_pk_mul_f32 v[166:167], v[70:71], v[70:71]
v_pk_fma_f32 v[160:161], v[160:161], v[52:53], v[52:53] op_sel:[0,1,0] op_sel_hi:[1,1,0]
v_pk_fma_f32 v[162:163], v[162:163], v[52:53], v[52:53] op_sel:[0,1,0] op_sel_hi:[1,1,0]
v_pk_fma_f32 v[164:165], v[164:165], v[52:53], v[52:53] op_sel:[0,1,0] op_sel_hi:[1,1,0]
v_pk_fma_f32 v[166:167], v[166:167], v[52:53], v[52:53] op_sel:[0,1,0] op_sel_hi:[1,1,0]
v_pk_mul_f32 v[160:161], v[160:161], v[64:65]
v_pk_mul_f32 v[162:163], v[162:163], v[66:67]
v_pk_mul_f32 v[164:165], v[164:165], v[68:69]
v_pk_mul_f32 v[166:167], v[166:167], v[70:71]
v_exp_f32 v160, v160
v_exp_f32 v161, v161
v_exp_f32 v162, v162
v_exp_f32 v163, v163
v_exp_f32 v164, v164
v_exp_f32 v165, v165
v_exp_f32 v166, v166
v_exp_f32 v167, v167
v_pk_fma_f32 v[160:161], v[160:161], v[54:55], v[54:55]
v_pk_fma_f32 v[162:163], v[162:163], v[54:55], v[54:55]
v_pk_fma_f32 v[164:165], v[164:165], v[54:55], v[54:55]
v_pk_fma_f32 v[166:167], v[166:167], v[54:55], v[54:55]
v_rcp_f32 v160, v160
v_rcp_f32 v161, v161
v_rcp_f32 v162, v162
v_rcp_f32 v163, v163
v_rcp_f32 v164, v164
v_rcp_f32 v165, v165
v_rcp_f32 v166, v166
v_rcp_f32 v167, v167
v_pk_mul_f32 v[160:161], v[160:161], v[64:65]
v_pk_mul_f32 v[162:163], v[162:163], v[66:67]
v_pk_mul_f32 v[164:165], v[164:165], v[68:69]
v_pk_mul_f32 v[166:167], v[166:167], v[70:71]
v_cvt_pk_bf16_f32 v64, v160, v161
v_cvt_pk_bf16_f32 v65, v162, v163
v_cvt_pk_bf16_f32 v66, v164, v165
v_cvt_pk_bf16_f32 v67, v166, v167
buffer_store_dwordx4 v[64:67], v60, s[24:27], s100 offen offset:0 sc1
buffer_load_dword v254, v228, s[24:27], 0 offen sc1
v_pk_mul_f32 v[160:161], v[72:73], v[72:73]
v_pk_mul_f32 v[162:163], v[74:75], v[74:75]
v_pk_mul_f32 v[164:165], v[76:77], v[76:77]
v_pk_mul_f32 v[166:167], v[78:79], v[78:79]
v_pk_fma_f32 v[160:161], v[160:161], v[52:53], v[52:53] op_sel:[0,1,0] op_sel_hi:[1,1,0]
v_pk_fma_f32 v[162:163], v[162:163], v[52:53], v[52:53] op_sel:[0,1,0] op_sel_hi:[1,1,0]
v_pk_fma_f32 v[164:165], v[164:165], v[52:53], v[52:53] op_sel:[0,1,0] op_sel_hi:[1,1,0]
v_pk_fma_f32 v[166:167], v[166:167], v[52:53], v[52:53] op_sel:[0,1,0] op_sel_hi:[1,1,0]
v_pk_mul_f32 v[160:161], v[160:161], v[72:73]
v_pk_mul_f32 v[162:163], v[162:163], v[74:75]
v_pk_mul_f32 v[164:165], v[164:165], v[76:77]
v_pk_mul_f32 v[166:167], v[166:167], v[78:79]
v_exp_f32 v160, v160
v_exp_f32 v161, v161
v_exp_f32 v162, v162
v_exp_f32 v163, v163
v_exp_f32 v164, v164
v_exp_f32 v165, v165
v_exp_f32 v166, v166
v_exp_f32 v167, v167
v_pk_fma_f32 v[160:161], v[160:161], v[54:55], v[54:55]
v_pk_fma_f32 v[162:163], v[162:163], v[54:55], v[54:55]
v_pk_fma_f32 v[164:165], v[164:165], v[54:55], v[54:55]
v_pk_fma_f32 v[166:167], v[166:167], v[54:55], v[54:55]
v_rcp_f32 v160, v160
v_rcp_f32 v161, v161
v_rcp_f32 v162, v162
v_rcp_f32 v163, v163
v_rcp_f32 v164, v164
v_rcp_f32 v165, v165
v_rcp_f32 v166, v166
v_rcp_f32 v167, v167
v_pk_mul_f32 v[160:161], v[160:161], v[72:73]
v_pk_mul_f32 v[162:163], v[162:163], v[74:75]
v_pk_mul_f32 v[164:165], v[164:165], v[76:77]
v_pk_mul_f32 v[166:167], v[166:167], v[78:79]
v_cvt_pk_bf16_f32 v72, v160, v161
v_cvt_pk_bf16_f32 v73, v162, v163
v_cvt_pk_bf16_f32 v74, v164, v165
v_cvt_pk_bf16_f32 v75, v166, v167
buffer_store_dwordx4 v[72:75], v60, s[24:27], s100 offen offset:512 sc1
v_pk_mul_f32 v[160:161], v[80:81], v[80:81]
v_pk_mul_f32 v[162:163], v[82:83], v[82:83]
v_pk_mul_f32 v[164:165], v[84:85], v[84:85]
v_pk_mul_f32 v[166:167], v[86:87], v[86:87]
v_pk_fma_f32 v[160:161], v[160:161], v[56:57], v[56:57] op_sel:[0,1,0] op_sel_hi:[1,1,0]
v_pk_fma_f32 v[162:163], v[162:163], v[56:57], v[56:57] op_sel:[0,1,0] op_sel_hi:[1,1,0]
v_pk_fma_f32 v[164:165], v[164:165], v[56:57], v[56:57] op_sel:[0,1,0] op_sel_hi:[1,1,0]
v_pk_fma_f32 v[166:167], v[166:167], v[56:57], v[56:57] op_sel:[0,1,0] op_sel_hi:[1,1,0]
v_pk_mul_f32 v[160:161], v[160:161], v[80:81]
v_pk_mul_f32 v[162:163], v[162:163], v[82:83]
v_pk_mul_f32 v[164:165], v[164:165], v[84:85]
v_pk_mul_f32 v[166:167], v[166:167], v[86:87]
v_exp_f32 v160, v160
v_exp_f32 v161, v161
v_exp_f32 v162, v162
v_exp_f32 v163, v163
v_exp_f32 v164, v164
v_exp_f32 v165, v165
v_exp_f32 v166, v166
v_exp_f32 v167, v167
v_pk_fma_f32 v[160:161], v[160:161], v[58:59], v[58:59]
v_pk_fma_f32 v[162:163], v[162:163], v[58:59], v[58:59]
v_pk_fma_f32 v[164:165], v[164:165], v[58:59], v[58:59]
v_pk_fma_f32 v[166:167], v[166:167], v[58:59], v[58:59]
v_rcp_f32 v160, v160
v_rcp_f32 v161, v161
v_rcp_f32 v162, v162
v_rcp_f32 v163, v163
v_rcp_f32 v164, v164
v_rcp_f32 v165, v165
v_rcp_f32 v166, v166
v_rcp_f32 v167, v167
v_pk_mul_f32 v[160:161], v[160:161], v[80:81]
v_pk_mul_f32 v[162:163], v[162:163], v[82:83]
v_pk_mul_f32 v[164:165], v[164:165], v[84:85]
v_pk_mul_f32 v[166:167], v[166:167], v[86:87]
v_cvt_pk_bf16_f32 v80, v160, v161
v_cvt_pk_bf16_f32 v81, v162, v163
v_cvt_pk_bf16_f32 v82, v164, v165
v_cvt_pk_bf16_f32 v83, v166, v167
buffer_store_dwordx4 v[80:83], v60, s[24:27], s100 offen offset:2048 sc1
s_waitcnt vmcnt(4)
v_cmp_eq_u32 vcc, 0, v251
s_cbranch_vccnz L_slow_27
L_back_28:
v_lshlrev_b32 v4, 4, v0
s_add_u32 s6, s88, 0
s_lshl_b32 s6, s6, 12
s_add_u32 s6, s6, 1048576
s_add_u32 s36, s66, s6
s_addc_u32 s37, s67, 0
s_and_b32 s37, s37, 0xffff
s_mov_b32 s38, 4096
s_mov_b32 s39, 0x20000
buffer_load_dwordx4 v[32:35], v4, s[36:39], 0 offen
buffer_load_dword v36, v4, s[36:39], 0 offen offset:16
s_add_u32 s6, s88, 1
s_lshl_b32 s6, s6, 12
s_add_u32 s6, s6, 1048576
s_add_u32 s36, s66, s6
s_addc_u32 s37, s67, 0
s_and_b32 s37, s37, 0xffff
s_mov_b32 s38, 4096
s_mov_b32 s39, 0x20000
buffer_load_dwordx4 v[38:41], v4, s[36:39], 0 offen
buffer_load_dword v42, v4, s[36:39], 0 offen offset:16
s_add_u32 s6, s88, 2
s_lshl_b32 s6, s6, 12
s_add_u32 s6, s6, 1048576
s_add_u32 s36, s66, s6
s_addc_u32 s37, s67, 0
s_and_b32 s37, s37, 0xffff
s_mov_b32 s38, 4096
s_mov_b32 s39, 0x20000
buffer_load_dwordx4 v[44:47], v4, s[36:39], 0 offen
buffer_load_dword v48, v4, s[36:39], 0 offen offset:16
v_pk_mul_f32 v[160:161], v[88:89], v[88:89]
v_pk_mul_f32 v[162:163], v[90:91], v[90:91]
v_pk_mul_f32 v[164:165], v[92:93], v[92:93]
v_pk_mul_f32 v[166:167], v[94:95], v[94:95]
v_pk_fma_f32 v[160:161], v[160:161], v[56:57], v[56:57] op_sel:[0,1,0] op_sel_hi:[1,1,0]
v_pk_fma_f32 v[162:163], v[162:163], v[56:57], v[56:57] op_sel:[0,1,0] op_sel_hi:[1,1,0]
v_pk_fma_f32 v[164:165], v[164:165], v[56:57], v[56:57] op_sel:[0,1,0] op_sel_hi:[1,1,0]
v_pk_fma_f32 v[166:167], v[166:167], v[56:57], v[56:57] op_sel:[0,1,0] op_sel_hi:[1,1,0]
v_pk_mul_f32 v[160:161], v[160:161], v[88:89]
v_pk_mul_f32 v[162:163], v[162:163], v[90:91]
v_pk_mul_f32 v[164:165], v[164:165], v[92:93]
v_pk_mul_f32 v[166:167], v[166:167], v[94:95]
v_exp_f32 v160, v160
v_exp_f32 v161, v161
v_exp_f32 v162, v162
v_exp_f32 v163, v163
v_exp_f32 v164, v164
v_exp_f32 v165, v165
v_exp_f32 v166, v166
v_exp_f32 v167, v167
v_pk_fma_f32 v[160:161], v[160:161], v[58:59], v[58:59]
v_pk_fma_f32 v[162:163], v[162:163], v[58:59], v[58:59]
v_pk_fma_f32 v[164:165], v[164:165], v[58:59], v[58:59]
v_pk_fma_f32 v[166:167], v[166:167], v[58:59], v[58:59]
v_rcp_f32 v160, v160
v_rcp_f32 v161, v161
v_rcp_f32 v162, v162
v_rcp_f32 v163, v163
v_rcp_f32 v164, v164
v_rcp_f32 v165, v165
v_rcp_f32 v166, v166
v_rcp_f32 v167, v167
v_pk_mul_f32 v[160:161], v[160:161], v[88:89]
v_pk_mul_f32 v[162:163], v[162:163], v[90:91]
v_pk_mul_f32 v[164:165], v[164:165], v[92:93]
v_pk_mul_f32 v[166:167], v[166:167], v[94:95]
v_cvt_pk_bf16_f32 v88, v160, v161
v_cvt_pk_bf16_f32 v89, v162, v163
v_cvt_pk_bf16_f32 v90, v164, v165
v_cvt_pk_bf16_f32 v91, v166, v167
buffer_store_dwordx4 v[88:91], v60, s[24:27], s100 offen offset:2560 sc1
s_waitcnt vmcnt(9)
v_cmp_eq_u32 vcc, 0, v254
s_cbranch_vccnz L_slow_29
L_back_30:
v_pk_mul_f32 v[160:161], v[96:97], v[96:97]
v_pk_mul_f32 v[162:163], v[98:99], v[98:99]
v_pk_mul_f32 v[164:165], v[100:101], v[100:101]
v_pk_mul_f32 v[166:167], v[102:103], v[102:103]
buffer_load_dwordx4 a[0:3], v248, s[24:27], s97 offen offset:0
v_pk_fma_f32 v[160:161], v[160:161], v[52:53], v[52:53] op_sel:[0,1,0] op_sel_hi:[1,1,0]
v_pk_fma_f32 v[162:163], v[162:163], v[52:53], v[52:53] op_sel:[0,1,0] op_sel_hi:[1,1,0]
v_pk_fma_f32 v[164:165], v[164:165], v[52:53], v[52:53] op_sel:[0,1,0] op_sel_hi:[1,1,0]
v_pk_fma_f32 v[166:167], v[166:167], v[52:53], v[52:53] op_sel:[0,1,0] op_sel_hi:[1,1,0]
v_pk_mul_f32 v[160:161], v[160:161], v[96:97]
v_pk_mul_f32 v[162:163], v[162:163], v[98:99]
v_pk_mul_f32 v[164:165], v[164:165], v[100:101]
v_pk_mul_f32 v[166:167], v[166:167], v[102:103]
buffer_load_dwordx4 a[4:7], v248, s[24:27], s97 offen offset:1024
v_exp_f32 v160, v160
v_exp_f32 v161, v161
v_exp_f32 v162, v162
v_exp_f32 v163, v163
v_exp_f32 v164, v164
v_exp_f32 v165, v165
v_exp_f32 v166, v166
v_exp_f32 v167, v167
buffer_load_dwordx4 a[8:11], v248, s[24:27], s97 offen offset:2048
v_pk_fma_f32 v[160:161], v[160:161], v[54:55], v[54:55]
v_pk_fma_f32 v[162:163], v[162:163], v[54:55], v[54:55]
v_pk_fma_f32 v[164:165], v[164:165], v[54:55], v[54:55]
v_pk_fma_f32 v[166:167], v[166:167], v[54:55], v[54:55]
v_rcp_f32 v160, v160
v_rcp_f32 v161, v161
v_rcp_f32 v162, v162
v_rcp_f32 v163, v163
buffer_load_dwordx4 a[12:15], v248, s[24:27], s97 offen offset:3072
v_rcp_f32 v164, v164
v_rcp_f32 v165, v165
v_rcp_f32 v166, v166
v_rcp_f32 v167, v167
v_pk_mul_f32 v[160:161], v[160:161], v[96:97]
v_pk_mul_f32 v[162:163], v[162:163], v[98:99]
v_pk_mul_f32 v[164:165], v[164:165], v[100:101]
v_pk_mul_f32 v[166:167], v[166:167], v[102:103]
buffer_load_dwordx4 a[16:19], v248, s[24:27], s98 offen
s_add_u32 s97, s97, 5120
s_cmp_eq_u32 s97, s80
s_cselect_b32 s97, s79, s97
s_add_u32 s98, s97, 4096
v_cvt_pk_bf16_f32 v96, v160, v161
v_cvt_pk_bf16_f32 v97, v162, v163
v_cvt_pk_bf16_f32 v98, v164, v165
v_cvt_pk_bf16_f32 v99, v166, v167
buffer_store_dwordx4 v[96:99], v60, s[24:27], s101 offen offset:0 sc1
v_pk_mul_f32 v[160:161], v[104:105], v[104:105]
v_pk_mul_f32 v[162:163], v[106:107], v[106:107]
v_pk_mul_f32 v[164:165], v[108:109], v[108:109]
v_pk_mul_f32 v[166:167], v[110:111], v[110:111]
buffer_load_dwordx4 a[20:23], v248, s[24:27], s97 offen offset:0
v_pk_fma_f32 v[160:161], v[160:161], v[52:53], v[52:53] op_sel:[0,1,0] op_sel_hi:[1,1,0]
v_pk_fma_f32 v[162:163], v[162:163], v[52:53], v[52:53] op_sel:[0,1,0] op_sel_hi:[1,1,0]
v_pk_fma_f32 v[164:165], v[164:165], v[52:53], v[52:53] op_sel:[0,1,0] op_sel_hi:[1,1,0]
v_pk_fma_f32 v[166:167], v[166:167], v[52:53], v[52:53] op_sel:[0,1,0] op_sel_hi:[1,1,0]
v_pk_mul_f32 v[160:161], v[160:161], v[104:105]
v_pk_mul_f32 v[162:163], v[162:163], v[106:107]
v_pk_mul_f32 v[164:165], v[164:165], v[108:109]
v_pk_mul_f32 v[166:167], v[166:167], v[110:111]
buffer_load_dwordx4 a[24:27], v248, s[24:27], s97 offen offset:1024
v_exp_f32 v160, v160
v_exp_f32 v161, v161
v_exp_f32 v162, v162
v_exp_f32 v163, v163
v_exp_f32 v164, v164
v_exp_f32 v165, v165
v_exp_f32 v166, v166
v_exp_f32 v167, v167
buffer_load_dwordx4 a[28:31], v248, s[24:27], s97 offen offset:2048
v_pk_fma_f32 v[160:161], v[160:161], v[54:55], v[54:55]
v_pk_fma_f32 v[162:163], v[162:163], v[54:55], v[54:55]
v_pk_fma_f32 v[164:165], v[164:165], v[54:55], v[54:55]
v_pk_fma_f32 v[166:167], v[166:167], v[54:55], v[54:55]
v_rcp_f32 v160, v160
v_rcp_f32 v161, v161
v_rcp_f32 v162, v162
v_rcp_f32 v163, v163
buffer_load_dwordx4 a[32:35], v248, s[24:27], s97 offen offset:3072
v_rcp_f32 v164, v164
v_rcp_f32 v165, v165
v_rcp_f32 v166, v166
v_rcp_f32 v167, v167
v_pk_mul_f32 v[160:161], v[160:161], v[104:105]
v_pk_mul_f32 v[162:163], v[162:163], v[106:107]
v_pk_mul_f32 v[164:165], v[164:165], v[108:109]
v_pk_mul_f32 v[166:167], v[166:167], v[110:111]
buffer_load_dwordx4 a[36:39], v248, s[24:27], s98 offen
s_add_u32 s97, s97, 5120
s_cmp_eq_u32 s97, s80
s_cselect_b32 s97, s79, s97
s_add_u32 s98, s97, 4096
v_cvt_pk_bf16_f32 v104, v160, v161
v_cvt_pk_bf16_f32 v105, v162, v163
v_cvt_pk_bf16_f32 v106, v164, v165
v_cvt_pk_bf16_f32 v107, v166, v167
buffer_store_dwordx4 v[104:107], v60, s[24:27], s101 offen offset:512 sc1
v_pk_mul_f32 v[160:161], v[112:113], v[112:113]
v_pk_mul_f32 v[162:163], v[114:115], v[114:115]
v_lshrrev_b32 v4, 4, v0
v_mul_u32_u24 v4, 272, v4
v_and_b32 v5, 15, v0
v_lshl_add_u32 v4, v5, 4, v4
v_add_u32 v4, 83200, v4
v_add_u32 v6, 60416, v4
s_waitcnt vmcnt(13)
v_pk_mul_f32 v[164:165], v[116:117], v[116:117]
v_pk_mul_f32 v[166:167], v[118:119], v[118:119]
v_pk_fma_f32 v[160:161], v[160:161], v[56:57], v[56:57] op_sel:[0,1,0] op_sel_hi:[1,1,0]
v_pk_fma_f32 v[162:163], v[162:163], v[56:57], v[56:57] op_sel:[0,1,0] op_sel_hi:[1,1,0]
buffer_load_dwordx4 a[40:43], v248, s[24:27], s97 offen offset:0
v_pk_fma_f32 v[164:165], v[164:165], v[56:57], v[56:57] op_sel:[0,1,0] op_sel_hi:[1,1,0]
v_pk_fma_f32 v[166:167], v[166:167], v[56:57], v[56:57] op_sel:[0,1,0] op_sel_hi:[1,1,0]
v_pk_mul_f32 v[160:161], v[160:161], v[112:113]
v_pk_mul_f32 v[162:163], v[162:163], v[114:115]
ds_write_b128 v4, v[32:35] offset:6272
v_pk_mul_f32 v[164:165], v[164:165], v[116:117]
v_pk_mul_f32 v[166:167], v[166:167], v[118:119]
v_exp_f32 v160, v160
v_exp_f32 v161, v161
buffer_load_dwordx4 a[44:47], v248, s[24:27], s97 offen offset:1024
v_exp_f32 v162, v162
v_exp_f32 v163, v163
v_exp_f32 v164, v164
v_exp_f32 v165, v165
v_alignbit_b32 v12, v33, v32, 16
v_alignbit_b32 v13, v34, v33, 16
v_alignbit_b32 v14, v35, v34, 16
v_alignbit_b32 v15, v36, v35, 16
v_exp_f32 v166, v166
v_exp_f32 v167, v167
v_pk_fma_f32 v[160:161], v[160:161], v[58:59], v[58:59]
v_pk_fma_f32 v[162:163], v[162:163], v[58:59], v[58:59]
buffer_load_dwordx4 a[48:51], v248, s[24:27], s97 offen offset:2048
v_pk_fma_f32 v[164:165], v[164:165], v[58:59], v[58:59]
v_pk_fma_f32 v[166:167], v[166:167], v[58:59], v[58:59]
v_rcp_f32 v160, v160
v_rcp_f32 v161, v161
ds_write_b128 v4, v[12:15] offset:0
v_rcp_f32 v162, v162
v_rcp_f32 v163, v163
v_rcp_f32 v164, v164
v_rcp_f32 v165, v165
buffer_load_dwordx4 a[52:55], v248, s[24:27], s97 offen offset:3072
v_rcp_f32 v166, v166
v_rcp_f32 v167, v167
v_pk_mul_f32 v[160:161], v[160:161], v[112:113]
v_pk_mul_f32 v[162:163], v[162:163], v[114:115]
ds_write_b128 v4, v[38:41] offset:36480
v_pk_mul_f32 v[164:165], v[164:165], v[116:117]
v_pk_mul_f32 v[166:167], v[166:167], v[118:119]
v_cvt_pk_bf16_f32 v112, v160, v161
v_cvt_pk_bf16_f32 v113, v162, v163
buffer_load_dwordx4 a[56:59], v248, s[24:27], s98 offen
s_add_u32 s97, s97, 5120
s_cmp_eq_u32 s97, s80
s_cselect_b32 s97, s79, s97
s_add_u32 s98, s97, 4096
v_cvt_pk_bf16_f32 v114, v164, v165
v_cvt_pk_bf16_f32 v115, v166, v167
buffer_store_dwordx4 v[112:115], v60, s[24:27], s101 offen offset:2048 sc1
v_pk_mul_f32 v[160:161], v[120:121], v[120:121]
v_pk_mul_f32 v[162:163], v[122:123], v[122:123]
v_alignbit_b32 v12, v39, v38, 16
v_alignbit_b32 v13, v40, v39, 16
v_alignbit_b32 v14, v41, v40, 16
v_alignbit_b32 v15, v42, v41, 16
v_pk_mul_f32 v[164:165], v[124:125], v[124:125]
v_pk_mul_f32 v[166:167], v[126:127], v[126:127]
v_pk_fma_f32 v[160:161], v[160:161], v[56:57], v[56:57] op_sel:[0,1,0] op_sel_hi:[1,1,0]
v_pk_fma_f32 v[162:163], v[162:163], v[56:57], v[56:57] op_sel:[0,1,0] op_sel_hi:[1,1,0]
buffer_load_dwordx4 a[60:63], v248, s[24:27], s97 offen offset:0
v_pk_fma_f32 v[164:165], v[164:165], v[56:57], v[56:57] op_sel:[0,1,0] op_sel_hi:[1,1,0]
v_pk_fma_f32 v[166:167], v[166:167], v[56:57], v[56:57] op_sel:[0,1,0] op_sel_hi:[1,1,0]
v_pk_mul_f32 v[160:161], v[160:161], v[120:121]
v_pk_mul_f32 v[162:163], v[162:163], v[122:123]
ds_write_b128 v4, v[12:15] offset:30208
v_pk_mul_f32 v[164:165], v[164:165], v[124:125]
v_pk_mul_f32 v[166:167], v[166:167], v[126:127]
v_exp_f32 v160, v160
v_exp_f32 v161, v161
buffer_load_dwordx4 a[64:67], v248, s[24:27], s97 offen offset:1024
v_exp_f32 v162, v162
v_exp_f32 v163, v163
v_exp_f32 v164, v164
v_exp_f32 v165, v165
ds_write_b128 v6, v[44:47] offset:6272
v_exp_f32 v166, v166
v_exp_f32 v167, v167
v_pk_fma_f32 v[160:161], v[160:161], v[58:59], v[58:59]
v_pk_fma_f32 v[162:163], v[162:163], v[58:59], v[58:59]
buffer_load_dwordx4 a[68:71], v248, s[24:27], s97 offen offset:2048
v_pk_fma_f32 v[164:165], v[164:165], v[58:59], v[58:59]
v_pk_fma_f32 v[166:167], v[166:167], v[58:59], v[58:59]
v_rcp_f32 v160, v160
v_rcp_f32 v161, v161
v_alignbit_b32 v12, v45, v44, 16
v_alignbit_b32 v13, v46, v45, 16
v_alignbit_b32 v14, v47, v46, 16
v_alignbit_b32 v15, v48, v47, 16
v_rcp_f32 v162, v162
v_rcp_f32 v163, v163
v_rcp_f32 v164, v164
v_rcp_f32 v165, v165
buffer_load_dwordx4 a[72:75], v248, s[24:27], s97 offen offset:3072
v_rcp_f32 v166, v166
v_rcp_f32 v167, v167
v_pk_mul_f32 v[160:161], v[160:161], v[120:121]
v_pk_mul_f32 v[162:163], v[162:163], v[122:123]
ds_write_b128 v6, v[12:15] offset:0
v_pk_mul_f32 v[164:165], v[164:165], v[124:125]
v_pk_mul_f32 v[166:167], v[166:167], v[126:127]
v_cvt_pk_bf16_f32 v120, v160, v161
v_cvt_pk_bf16_f32 v121, v162, v163
buffer_load_dwordx4 a[76:79], v248, s[24:27], s98 offen
s_add_u32 s97, s97, 5120
s_cmp_eq_u32 s97, s80
s_cselect_b32 s97, s79, s97
s_add_u32 s98, s97, 4096
v_cvt_pk_bf16_f32 v122, v164, v165
v_cvt_pk_bf16_f32 v123, v166, v167
buffer_store_dwordx4 v[120:123], v60, s[24:27], s101 offen offset:2560 sc1
L_conv:
s_waitcnt lgkmcnt(0)
s_barrier
v_mov_b32 v2, 61440
v_mov_b32 v3, 0
ds_write_b32 v2, v3
ds_read_b128 v[140:143], v8 offset:192
ds_read_b128 v[160:163], v9 offset:0
ds_read_b128 v[144:147], v8 offset:256
ds_read_b128 v[164:167], v9 offset:64
ds_read_b128 v[148:151], v8 offset:320
ds_read_b128 v[168:171], v9 offset:128
ds_read_b128 v[152:155], v8 offset:384
ds_read_b128 v[156:159], v8 offset:448
s_waitcnt lgkmcnt(6)
v_mfma_f32_16x16x32_bf16 v[188:191], v[192:195], v[160:163], 0
ds_read_b128 v[128:131], v8 offset:512
v_mfma_f32_16x16x32_bf16 v[188:191], v[140:143], v[160:163], v[188:191]
ds_read_b128 v[172:175], v9 offset:192
s_waitcnt lgkmcnt(6)
v_mfma_f32_16x16x32_bf16 v[184:187], v[192:195], v[164:167], 0
ds_read_b128 v[132:135], v8 offset:576
v_mfma_f32_16x16x32_bf16 v[188:191], v[144:147], v[164:167], v[188:191]
ds_read_b128 v[160:163], v9 offset:272
v_mfma_f32_16x16x32_bf16 v[184:187], v[140:143], v[164:167], v[184:187]
buffer_load_dwordx4 a[80:83], v248, s[24:27], s97 offen offset:0
s_waitcnt lgkmcnt(6)
v_mfma_f32_16x16x32_bf16 v[180:183], v[192:195], v[168:171], 0
ds_read_b128 v[136:139], v8 offset:640
v_mfma_f32_16x16x32_bf16 v[184:187], v[144:147], v[168:171], v[184:187]
ds_read_b128 v[164:167], v9 offset:336
v_mfma_f32_16x16x32_bf16 v[188:191], v[148:151], v[168:171], v[188:191]
buffer_load_dwordx4 a[84:87], v248, s[24:27], s97 offen offset:1024
v_mfma_f32_16x16x32_bf16 v[180:183], v[140:143], v[168:171], v[180:183]
s_waitcnt lgkmcnt(4)
v_mfma_f32_16x16x32_bf16 v[176:179], v[192:195], v[172:175], 0
v_mfma_f32_16x16x32_bf16 v[180:183], v[144:147], v[172:175], v[180:183]
v_mfma_f32_16x16x32_bf16 v[176:179], v[140:143], v[172:175], v[176:179]
ds_read_b128 v[140:143], v8 offset:704
buffer_load_dwordx4 a[88:91], v248, s[24:27], s97 offen offset:2048
v_mfma_f32_16x16x32_bf16 v[184:187], v[148:151], v[172:175], v[184:187]
ds_read_b128 v[168:171], v9 offset:400
v_mfma_f32_16x16x32_bf16 v[188:191], v[152:155], v[172:175], v[188:191]
s_waitcnt lgkmcnt(4)
v_mfma_f32_16x16x32_bf16 v[176:179], v[144:147], v[160:163], v[176:179]
ds_read_b128 v[144:147], v8 offset:768
v_mfma_f32_16x16x32_bf16 v[180:183], v[148:151], v[160:163], v[180:183]
ds_read_b128 v[172:175], v9 offset:464
v_mfma_f32_16x16x32_bf16 v[184:187], v[152:155], v[160:163], v[184:187]
buffer_load_dwordx4 a[92:95], v248, s[24:27], s97 offen offset:3072
v_mfma_f32_16x16x32_bf16 v[188:191], v[156:159], v[160:163], v[188:191]
s_waitcnt lgkmcnt(4)
v_mfma_f32_16x16x32_bf16 v[176:179], v[148:151], v[164:167], v[176:179]
ds_read_b128 v[148:151], v8 offset:832
v_mfma_f32_16x16x32_bf16 v[180:183], v[152:155], v[164:167], v[180:183]
ds_read_b128 v[160:163], v9 offset:544
v_mfma_f32_16x16x32_bf16 v[184:187], v[156:159], v[164:167], v[184:187]
buffer_load_dwordx4 a[96:99], v248, s[24:27], s98 offen
v_mfma_f32_16x16x32_bf16 v[188:191], v[128:131], v[164:167], v[188:191]
s_add_u32 s97, s97, 5120
s_cmp_eq_u32 s97, s80
s_cselect_b32 s97, s79, s97
s_add_u32 s98, s97, 4096
s_waitcnt lgkmcnt(4)
v_mfma_f32_16x16x32_bf16 v[176:179], v[152:155], v[168:171], v[176:179]
ds_read_b128 v[152:155], v8 offset:896
v_mfma_f32_16x16x32_bf16 v[180:183], v[156:159], v[168:171], v[180:183]
ds_read_b128 v[164:167], v9 offset:608
v_mfma_f32_16x16x32_bf16 v[184:187], v[128:131], v[168:171], v[184:187]
v_mfma_f32_16x16x32_bf16 v[188:191], v[132:135], v[168:171], v[188:191]
s_waitcnt lgkmcnt(4)
v_mfma_f32_16x16x32_bf16 v[176:179], v[156:159], v[172:175], v[176:179]
ds_read_b128 v[156:159], v8 offset:960
v_mfma_f32_16x16x32_bf16 v[180:183], v[128:131], v[172:175], v[180:183]
ds_read_b128 v[168:171], v9 offset:672
v_mfma_f32_16x16x32_bf16 v[184:187], v[132:135], v[172:175], v[184:187]
buffer_load_dwordx4 a[100:103], v248, s[24:27], s97 offen offset:0
v_mfma_f32_16x16x32_bf16 v[188:191], v[136:139], v[172:175], v[188:191]
s_waitcnt lgkmcnt(4)
v_mfma_f32_16x16x32_bf16 v[176:179], v[128:131], v[160:163], v[176:179]
ds_read_b128 v[128:131], v8 offset:1024
v_mfma_f32_16x16x32_bf16 v[180:183], v[132:135], v[160:163], v[180:183]
ds_read_b128 v[172:175], v9 offset:736
v_mfma_f32_16x16x32_bf16 v[184:187], v[136:139], v[160:163], v[184:187]
buffer_load_dwordx4 a[104:107], v248, s[24:27], s97 offen offset:1024
v_mfma_f32_16x16x32_bf16 v[188:191], v[140:143], v[160:163], v[188:191]
s_waitcnt lgkmcnt(4)
v_mfma_f32_16x16x32_bf16 v[176:179], v[132:135], v[164:167], v[176:179]
ds_read_b128 v[132:135], v8 offset:1088
v_mfma_f32_16x16x32_bf16 v[180:183], v[136:139], v[164:167], v[180:183]
ds_read_b128 v[160:163], v9 offset:816
v_mfma_f32_16x16x32_bf16 v[184:187], v[140:143], v[164:167], v[184:187]
buffer_load_dwordx4 a[108:111], v248, s[24:27], s97 offen offset:2048
v_mfma_f32_16x16x32_bf16 v[188:191], v[144:147], v[164:167], v[188:191]
s_waitcnt lgkmcnt(4)
v_mfma_f32_16x16x32_bf16 v[176:179], v[136:139], v[168:171], v[176:179]
ds_read_b128 v[136:139], v8 offset:1152
v_mfma_f32_16x16x32_bf16 v[180:183], v[140:143], v[168:171], v[180:183]
ds_read_b128 v[164:167], v9 offset:880
v_mfma_f32_16x16x32_bf16 v[184:187], v[144:147], v[168:171], v[184:187]
buffer_load_dwordx4 a[112:115], v248, s[24:27], s97 offen offset:3072
v_mfma_f32_16x16x32_bf16 v[188:191], v[148:151], v[168:171], v[188:191]
s_waitcnt lgkmcnt(4)
v_mfma_f32_16x16x32_bf16 v[176:179], v[140:143], v[172:175], v[176:179]
ds_read_b128 v[140:143], v8 offset:1216
v_mfma_f32_16x16x32_bf16 v[180:183], v[144:147], v[172:175], v[180:183]
ds_read_b128 v[168:171], v9 offset:944
v_mfma_f32_16x16x32_bf16 v[184:187], v[148:151], v[172:175], v[184:187]
buffer_load_dwordx4 a[116:119], v248, s[24:27], s98 offen
v_mfma_f32_16x16x32_bf16 v[188:191], v[152:155], v[172:175], v[188:191]
s_add_u32 s97, s97, 5120
s_cmp_eq_u32 s97, s80
s_cselect_b32 s97, s79, s97
s_add_u32 s98, s97, 4096
s_waitcnt lgkmcnt(4)
v_mfma_f32_16x16x32_bf16 v[176:179], v[144:147], v[160:163], v[176:179]
ds_read_b128 v[144:147], v8 offset:1280
v_mfma_f32_16x16x32_bf16 v[180:183], v[148:151], v[160:163], v[180:183]
ds_read_b128 v[172:175], v9 offset:1008
v_mfma_f32_16x16x32_bf16 v[184:187], v[152:155], v[160:163], v[184:187]
v_mfma_f32_16x16x32_bf16 v[188:191], v[156:159], v[160:163], v[188:191]
s_waitcnt lgkmcnt(4)
v_mfma_f32_16x16x32_bf16 v[176:179], v[148:151], v[164:167], v[176:179]
ds_read_b128 v[148:151], v8 offset:1344
v_mfma_f32_16x16x32_bf16 v[180:183], v[152:155], v[164:167], v[180:183]
ds_read_b128 v[160:163], v9 offset:1088
v_mfma_f32_16x16x32_bf16 v[184:187], v[156:159], v[164:167], v[184:187]
buffer_load_dwordx4 a[120:123], v248, s[24:27], s97 offen offset:0
v_mfma_f32_16x16x32_bf16 v[188:191], v[128:131], v[164:167], v[188:191]
s_waitcnt vmcnt(11)
s_barrier
s_cmp_lg_u32 s5, 0
s_cbranch_scc1 L_fl_33
s_mov_b64 exec, 1
buffer_store_dword v253, v252, s[24:27], 0 offen offset:16 sc1
s_mov_b64 exec, -1
L_fl_33:
s_waitcnt lgkmcnt(4)
v_mfma_f32_16x16x32_bf16 v[176:179], v[152:155], v[168:171], v[176:179]
ds_read_b128 v[152:155], v8 offset:1408
v_mfma_f32_16x16x32_bf16 v[180:183], v[156:159], v[168:171], v[180:183]
ds_read_b128 v[164:167], v9 offset:1152
v_mfma_f32_16x16x32_bf16 v[184:187], v[128:131], v[168:171], v[184:187]
buffer_load_dwordx4 a[124:127], v248, s[24:27], s97 offen offset:1024
v_mfma_f32_16x16x32_bf16 v[188:191], v[132:135], v[168:171], v[188:191]
s_waitcnt lgkmcnt(4)
v_mfma_f32_16x16x32_bf16 v[176:179], v[156:159], v[172:175], v[176:179]
ds_read_b128 v[156:159], v8 offset:1472
v_mfma_f32_16x16x32_bf16 v[180:183], v[128:131], v[172:175], v[180:183]
ds_read_b128 v[168:171], v9 offset:1216
v_mfma_f32_16x16x32_bf16 v[184:187], v[132:135], v[172:175], v[184:187]
buffer_load_dwordx4 a[128:131], v248, s[24:27], s97 offen offset:2048
v_mfma_f32_16x16x32_bf16 v[188:191], v[136:139], v[172:175], v[188:191]
s_waitcnt lgkmcnt(4)
v_mfma_f32_16x16x32_bf16 v[176:179], v[128:131], v[160:163], v[176:179]
ds_read_b128 v[128:131], v8 offset:1536
v_mfma_f32_16x16x32_bf16 v[180:183], v[132:135], v[160:163], v[180:183]
ds_read_b128 v[172:175], v9 offset:1280
v_mfma_f32_16x16x32_bf16 v[184:187], v[136:139], v[160:163], v[184:187]
buffer_load_dwordx4 a[132:135], v248, s[24:27], s97 offen offset:3072
v_mfma_f32_16x16x32_bf16 v[188:191], v[140:143], v[160:163], v[188:191]
s_waitcnt lgkmcnt(4)
v_mfma_f32_16x16x32_bf16 v[176:179], v[132:135], v[164:167], v[176:179]
ds_read_b128 v[132:135], v8 offset:1600
v_mfma_f32_16x16x32_bf16 v[180:183], v[136:139], v[164:167], v[180:183]
ds_read_b128 v[160:163], v9 offset:1360
v_mfma_f32_16x16x32_bf16 v[184:187], v[140:143], v[164:167], v[184:187]
buffer_load_dwordx4 a[136:139], v248, s[24:27], s98 offen
v_mfma_f32_16x16x32_bf16 v[188:191], v[144:147], v[164:167], v[188:191]
s_add_u32 s97, s97, 5120
s_cmp_eq_u32 s97, s80
s_cselect_b32 s97, s79, s97
s_add_u32 s98, s97, 4096
s_waitcnt lgkmcnt(4)
v_mfma_f32_16x16x32_bf16 v[176:179], v[136:139], v[168:171], v[176:179]
ds_read_b128 v[136:139], v8 offset:1664
v_mfma_f32_16x16x32_bf16 v[180:183], v[140:143], v[168:171], v[180:183]
ds_read_b128 v[164:167], v9 offset:1424
v_mfma_f32_16x16x32_bf16 v[184:187], v[144:147], v[168:171], v[184:187]
v_mfma_f32_16x16x32_bf16 v[188:191], v[148:151], v[168:171], v[188:191]
s_waitcnt lgkmcnt(4)
v_mfma_f32_16x16x32_bf16 v[176:179], v[140:143], v[172:175], v[176:179]
ds_read_b128 v[140:143], v8 offset:1728
v_mfma_f32_16x16x32_bf16 v[180:183], v[144:147], v[172:175], v[180:183]
ds_read_b128 v[168:171], v9 offset:1488
v_mfma_f32_16x16x32_bf16 v[184:187], v[148:151], v[172:175], v[184:187]
buffer_load_dwordx4 a[140:143], v248, s[24:27], s97 offen offset:0
v_mfma_f32_16x16x32_bf16 v[188:191], v[152:155], v[172:175], v[188:191]
s_waitcnt lgkmcnt(4)
v_mfma_f32_16x16x32_bf16 v[176:179], v[144:147], v[160:163], v[176:179]
ds_read_b128 v[144:147], v8 offset:1792
v_mfma_f32_16x16x32_bf16 v[180:183], v[148:151], v[160:163], v[180:183]
ds_read_b128 v[172:175], v9 offset:1552
v_mfma_f32_16x16x32_bf16 v[184:187], v[152:155], v[160:163], v[184:187]
buffer_load_dwordx4 a[144:147], v248, s[24:27], s97 offen offset:1024
v_mfma_f32_16x16x32_bf16 v[188:191], v[156:159], v[160:163], v[188:191]
s_mov_b32 s32, s60
s_and_b32 s33, s61, 0xffff
s_mov_b32 s34, 1280
s_mov_b32 s35, 0x20000
v_lshrrev_b32 v19, 4, v1
v_mul_u32_u24 v19, 40, v19
s_mul_i32 s6, s95, 160
v_add_u32 v19, s6, v19
buffer_load_dwordx4 a[240:243], v19, s[32:35], 0 offen
buffer_load_dwordx4 a[244:247], v19, s[32:35], 0 offen offset:16
buffer_load_dwordx2 a[248:249], v19, s[32:35], 0 offen offset:32
s_waitcnt lgkmcnt(4)
v_mfma_f32_16x16x32_bf16 v[176:179], v[148:151], v[164:167], v[176:179]
ds_read_b128 v[148:151], v8 offset:1856
v_mfma_f32_16x16x32_bf16 v[180:183], v[152:155], v[164:167], v[180:183]
ds_read_b128 v[160:163], v9 offset:1632
v_mfma_f32_16x16x32_bf16 v[184:187], v[156:159], v[164:167], v[184:187]
buffer_load_dwordx4 a[148:151], v248, s[24:27], s97 offen offset:2048
v_mfma_f32_16x16x32_bf16 v[188:191], v[128:131], v[164:167], v[188:191]
s_waitcnt lgkmcnt(4)
v_mfma_f32_16x16x32_bf16 v[176:179], v[152:155], v[168:171], v[176:179]
ds_read_b128 v[152:155], v8 offset:1920
v_mfma_f32_16x16x32_bf16 v[180:183], v[156:159], v[168:171], v[180:183]
ds_read_b128 v[164:167], v9 offset:1696
v_mfma_f32_16x16x32_bf16 v[184:187], v[128:131], v[168:171], v[184:187]
buffer_load_dwordx4 a[152:155], v248, s[24:27], s97 offen offset:3072
v_mfma_f32_16x16x32_bf16 v[188:191], v[132:135], v[168:171], v[188:191]
s_waitcnt lgkmcnt(4)
v_mfma_f32_16x16x32_bf16 v[176:179], v[156:159], v[172:175], v[176:179]
ds_read_b128 v[156:159], v8 offset:1984
v_mfma_f32_16x16x32_bf16 v[180:183], v[128:131], v[172:175], v[180:183]
ds_read_b128 v[168:171], v9 offset:1760
v_mfma_f32_16x16x32_bf16 v[184:187], v[132:135], v[172:175], v[184:187]
buffer_load_dwordx4 a[156:159], v248, s[24:27], s98 offen
v_mfma_f32_16x16x32_bf16 v[188:191], v[136:139], v[172:175], v[188:191]
s_add_u32 s97, s97, 5120
s_cmp_eq_u32 s97, s80
s_cselect_b32 s97, s79, s97
s_add_u32 s98, s97, 4096
s_waitcnt lgkmcnt(4)
v_mfma_f32_16x16x32_bf16 v[176:179], v[128:131], v[160:163], v[176:179]
ds_read_b128 v[128:131], v8 offset:2048
v_mfma_f32_16x16x32_bf16 v[180:183], v[132:135], v[160:163], v[180:183]
ds_read_b128 v[172:175], v9 offset:1824
v_mfma_f32_16x16x32_bf16 v[184:187], v[136:139], v[160:163], v[184:187]
v_mfma_f32_16x16x32_bf16 v[188:191], v[140:143], v[160:163], v[188:191]
s_waitcnt lgkmcnt(4)
v_mfma_f32_16x16x32_bf16 v[176:179], v[132:135], v[164:167], v[176:179]
ds_read_b128 v[132:135], v8 offset:2112
v_mfma_f32_16x16x32_bf16 v[180:183], v[136:139], v[164:167], v[180:183]
ds_read_b128 v[160:163], v9 offset:1904
v_mfma_f32_16x16x32_bf16 v[184:187], v[140:143], v[164:167], v[184:187]
buffer_load_dwordx4 a[160:163], v248, s[24:27], s97 offen offset:0
v_mfma_f32_16x16x32_bf16 v[188:191], v[144:147], v[164:167], v[188:191]
s_waitcnt lgkmcnt(4)
v_mfma_f32_16x16x32_bf16 v[176:179], v[136:139], v[168:171], v[176:179]
ds_read_b128 v[136:139], v8 offset:2176
v_mfma_f32_16x16x32_bf16 v[180:183], v[140:143], v[168:171], v[180:183]
ds_read_b128 v[164:167], v9 offset:1968
v_mfma_f32_16x16x32_bf16 v[184:187], v[144:147], v[168:171], v[184:187]
buffer_load_dwordx4 a[164:167], v248, s[24:27], s97 offen offset:1024
v_mfma_f32_16x16x32_bf16 v[188:191], v[148:151], v[168:171], v[188:191]
s_cmp_lg_u32 s86, 0
s_cbranch_scc1 L_stay_35
s_cmp_eq_u32 s87, 3
s_cselect_b32 s85, s85, s87
s_mul_i32 s84, s85, 30208
s_add_u32 s84, s84, 63488
v_add_u32 v8, s84, v16
s_waitcnt lgkmcnt(4)
v_mfma_f32_16x16x32_bf16 v[176:179], v[140:143], v[172:175], v[176:179]
ds_read_b128 v[140:143], v8 offset:2240
v_mfma_f32_16x16x32_bf16 v[180:183], v[144:147], v[172:175], v[180:183]
ds_read_b128 v[168:171], v9 offset:2032
s_add_u32 s84, s84, 17536
s_add_u32 s91, s88, s85
v_mfma_f32_16x16x32_bf16 v[184:187], v[148:151], v[172:175], v[184:187]
buffer_load_dwordx4 a[168:171], v248, s[24:27], s97 offen offset:2048
v_mfma_f32_16x16x32_bf16 v[188:191], v[152:155], v[172:175], v[188:191]
s_waitcnt lgkmcnt(4)
v_mfma_f32_16x16x32_bf16 v[176:179], v[144:147], v[160:163], v[176:179]
ds_read_b128 v[144:147], v8 offset:2304
s_and_b32 s89, s88, 0xfffffffe
s_sub_u32 s89, s91, s89
s_cmp_ge_u32 s89, 2
s_cselect_b32 s90, s1, s0
v_mfma_f32_16x16x32_bf16 v[180:183], v[148:151], v[160:163], v[180:183]
ds_read_b128 v[172:175], v9 offset:2096
s_and_b32 s89, s89, 1
s_lshl_b32 s89, s89, 4
s_lshr_b32 s90, s90, s89
s_and_b32 s90, s90, 0xffff
v_mfma_f32_16x16x32_bf16 v[184:187], v[152:155], v[160:163], v[184:187]
buffer_load_dwordx4 a[172:175], v248, s[24:27], s97 offen offset:3072
v_mfma_f32_16x16x32_bf16 v[188:191], v[156:159], v[160:163], v[188:191]
v_add_u32 v9, s84, v17
s_waitcnt lgkmcnt(4)
v_mfma_f32_16x16x32_bf16 v[176:179], v[148:151], v[164:167], v[176:179]
ds_read_b128 v[148:151], v8 offset:2368
v_mov_b32 v3, s90
v_and_b32 v2, 15, v1
v_mfma_f32_16x16x32_bf16 v[180:183], v[152:155], v[164:167], v[180:183]
ds_read_b128 v[160:163], v9 offset:2176
v_lshl_add_u32 v2, v18, 2, v2
v_sub_u32 v2, 15, v2
v_mfma_f32_16x16x32_bf16 v[184:187], v[156:159], v[164:167], v[184:187]
buffer_load_dwordx4 a[176:179], v248, s[24:27], s98 offen
v_mfma_f32_16x16x32_bf16 v[188:191], v[128:131], v[164:167], v[188:191]
s_add_u32 s97, s97, 5120
s_cmp_eq_u32 s97, s80
s_cselect_b32 s97, s79, s97
s_add_u32 s98, s97, 4096
s_waitcnt lgkmcnt(4)
v_mfma_f32_16x16x32_bf16 v[176:179], v[152:155], v[168:171], v[176:179]
ds_read_b128 v[152:155], v8 offset:2432
v_cmp_eq_u32 vcc, 0, v2
v_cndmask_b32 v192, 0, v3, vcc
v_mfma_f32_16x16x32_bf16 v[180:183], v[156:159], v[168:171], v[180:183]
ds_read_b128 v[164:167], v9 offset:2240
v_cmp_eq_u32 vcc, 1, v2
v_cndmask_b32 v193, 0, v3, vcc
v_mfma_f32_16x16x32_bf16 v[184:187], v[128:131], v[168:171], v[184:187]
v_cmp_eq_u32 vcc, 2, v2
v_cndmask_b32 v194, 0, v3, vcc
v_mfma_f32_16x16x32_bf16 v[188:191], v[132:135], v[168:171], v[188:191]
v_cmp_eq_u32 vcc, 3, v2
v_cndmask_b32 v195, 0, v3, vcc
s_waitcnt lgkmcnt(4)
v_mfma_f32_16x16x32_bf16 v[188:191], v[136:139], v[172:175], v[188:191]
v_mfma_f32_16x16x32_bf16 v[184:187], v[132:135], v[172:175], v[184:187]
ds_read_b128 v[168:171], v9 offset:2304
v_mfma_f32_16x16x32_bf16 v[180:183], v[128:131], v[172:175], v[180:183]
v_mfma_f32_16x16x32_bf16 v[176:179], v[156:159], v[172:175], v[176:179]
ds_read_b128 v[156:159], v8 offset:2496
v_cvt_pk_bf16_f32 v26, v188, v189
v_cvt_pk_bf16_f32 v27, v190, v191
s_waitcnt lgkmcnt(4)
v_mfma_f32_16x16x32_bf16 v[188:191], v[192:195], v[160:163], 0
ds_read_b128 v[128:131], v8 offset:2560
v_cvt_pk_bf16_f32 v24, v184, v185
v_cvt_pk_bf16_f32 v25, v186, v187
v_mfma_f32_16x16x32_bf16 v[188:191], v[140:143], v[160:163], v[188:191]
ds_read_b128 v[172:175], v9 offset:2368
buffer_store_dwordx4 v[24:27], v11, s[24:27], s92 offen offset:128 sc1
buffer_load_dwordx4 a[180:183], v248, s[24:27], s97 offen offset:0
buffer_load_dwordx4 a[184:187], v248, s[24:27], s97 offen offset:1024
s_waitcnt lgkmcnt(4)
v_mfma_f32_16x16x32_bf16 v[184:187], v[192:195], v[164:167], 0
ds_read_b128 v[132:135], v8 offset:2624
v_cvt_pk_bf16_f32 v22, v180, v181
v_cvt_pk_bf16_f32 v23, v182, v183
v_mfma_f32_16x16x32_bf16 v[188:191], v[144:147], v[164:167], v[188:191]
ds_read_b128 v[160:163], v9 offset:2448
v_cvt_pk_bf16_f32 v20, v176, v177
v_cvt_pk_bf16_f32 v21, v178, v179
v_mfma_f32_16x16x32_bf16 v[184:187], v[140:143], v[164:167], v[184:187]
buffer_store_dwordx4 v[20:23], v11, s[24:27], s92 offen offset:0 sc1
buffer_load_dwordx4 a[188:191], v248, s[24:27], s97 offen offset:2048
s_waitcnt lgkmcnt(5)
v_mfma_f32_16x16x32_bf16 v[180:183], v[192:195], v[168:171], 0
ds_read_b128 v[136:139], v8 offset:2688
v_mfma_f32_16x16x32_bf16 v[184:187], v[144:147], v[168:171], v[184:187]
ds_read_b128 v[164:167], v9 offset:2512
s_lshl_b32 s92, s91, 12
s_add_u32 s92, s92, 4194304
s_cmp_eq_u32 s87, 3
s_cselect_b64 vcc, -1, 0
v_mfma_f32_16x16x32_bf16 v[188:191], v[148:151], v[168:171], v[188:191]
v_mov_b32 v2, 2147418112
v_cndmask_b32 v11, v11, v2, vcc
buffer_load_dwordx4 a[192:195], v248, s[24:27], s97 offen offset:3072
v_mfma_f32_16x16x32_bf16 v[180:183], v[140:143], v[168:171], v[180:183]
s_waitcnt lgkmcnt(4)
v_mfma_f32_16x16x32_bf16 v[176:179], v[192:195], v[172:175], 0
v_mfma_f32_16x16x32_bf16 v[180:183], v[144:147], v[172:175], v[180:183]
v_mfma_f32_16x16x32_bf16 v[176:179], v[140:143], v[172:175], v[176:179]
ds_read_b128 v[140:143], v8 offset:2752
buffer_load_dwordx4 a[196:199], v248, s[24:27], s98 offen
v_mfma_f32_16x16x32_bf16 v[184:187], v[148:151], v[172:175], v[184:187]
ds_read_b128 v[168:171], v9 offset:2576
s_add_u32 s97, s97, 5120
s_cmp_eq_u32 s97, s80
s_cselect_b32 s97, s79, s97
s_add_u32 s98, s97, 4096
v_mfma_f32_16x16x32_bf16 v[188:191], v[152:155], v[172:175], v[188:191]
s_branch L_join_36
L_stay_35:
s_waitcnt lgkmcnt(4)
v_mfma_f32_16x16x32_bf16 v[176:179], v[140:143], v[172:175], v[176:179]
ds_read_b128 v[140:143], v8 offset:2240
v_mfma_f32_16x16x32_bf16 v[180:183], v[144:147], v[172:175], v[180:183]
ds_read_b128 v[168:171], v9 offset:2032
v_mfma_f32_16x16x32_bf16 v[184:187], v[148:151], v[172:175], v[184:187]
buffer_load_dwordx4 a[168:171], v248, s[24:27], s97 offen offset:2048
v_mfma_f32_16x16x32_bf16 v[188:191], v[152:155], v[172:175], v[188:191]
s_waitcnt lgkmcnt(4)
v_mfma_f32_16x16x32_bf16 v[176:179], v[144:147], v[160:163], v[176:179]
ds_read_b128 v[144:147], v8 offset:2304
v_mfma_f32_16x16x32_bf16 v[180:183], v[148:151], v[160:163], v[180:183]
ds_read_b128 v[172:175], v9 offset:2096
v_mfma_f32_16x16x32_bf16 v[184:187], v[152:155], v[160:163], v[184:187]
buffer_load_dwordx4 a[172:175], v248, s[24:27], s97 offen offset:3072
v_mfma_f32_16x16x32_bf16 v[188:191], v[156:159], v[160:163], v[188:191]
s_waitcnt lgkmcnt(4)
v_mfma_f32_16x16x32_bf16 v[176:179], v[148:151], v[164:167], v[176:179]
ds_read_b128 v[148:151], v8 offset:2368
v_mfma_f32_16x16x32_bf16 v[180:183], v[152:155], v[164:167], v[180:183]
ds_read_b128 v[160:163], v9 offset:2176
v_mfma_f32_16x16x32_bf16 v[184:187], v[156:159], v[164:167], v[184:187]
buffer_load_dwordx4 a[176:179], v248, s[24:27], s98 offen
v_mfma_f32_16x16x32_bf16 v[188:191], v[128:131], v[164:167], v[188:191]
s_add_u32 s97, s97, 5120
s_cmp_eq_u32 s97, s80
s_cselect_b32 s97, s79, s97
s_add_u32 s98, s97, 4096
s_waitcnt lgkmcnt(4)
v_mfma_f32_16x16x32_bf16 v[176:179], v[152:155], v[168:171], v[176:179]
ds_read_b128 v[152:155], v8 offset:2432
v_mfma_f32_16x16x32_bf16 v[180:183], v[156:159], v[168:171], v[180:183]
ds_read_b128 v[164:167], v9 offset:2240
v_mfma_f32_16x16x32_bf16 v[184:187], v[128:131], v[168:171], v[184:187]
v_mfma_f32_16x16x32_bf16 v[188:191], v[132:135], v[168:171], v[188:191]
s_waitcnt lgkmcnt(4)
v_mfma_f32_16x16x32_bf16 v[176:179], v[156:159], v[172:175], v[176:179]
ds_read_b128 v[156:159], v8 offset:2496
v_mfma_f32_16x16x32_bf16 v[180:183], v[128:131], v[172:175], v[180:183]
ds_read_b128 v[168:171], v9 offset:2304
v_mfma_f32_16x16x32_bf16 v[184:187], v[132:135], v[172:175], v[184:187]
v_mfma_f32_16x16x32_bf16 v[188:191], v[136:139], v[172:175], v[188:191]
s_waitcnt lgkmcnt(4)
v_mfma_f32_16x16x32_bf16 v[176:179], v[128:131], v[160:163], v[176:179]
ds_read_b128 v[128:131], v8 offset:2560
v_mfma_f32_16x16x32_bf16 v[180:183], v[132:135], v[160:163], v[180:183]
ds_read_b128 v[172:175], v9 offset:2368
v_mfma_f32_16x16x32_bf16 v[184:187], v[136:139], v[160:163], v[184:187]
buffer_load_dwordx4 a[180:183], v248, s[24:27], s97 offen offset:0
v_mfma_f32_16x16x32_bf16 v[188:191], v[140:143], v[160:163], v[188:191]
buffer_load_dwordx4 a[184:187], v248, s[24:27], s97 offen offset:1024
s_waitcnt lgkmcnt(4)
v_mfma_f32_16x16x32_bf16 v[176:179], v[132:135], v[164:167], v[176:179]
ds_read_b128 v[132:135], v8 offset:2624
v_mfma_f32_16x16x32_bf16 v[180:183], v[136:139], v[164:167], v[180:183]
ds_read_b128 v[160:163], v9 offset:2448
v_mfma_f32_16x16x32_bf16 v[184:187], v[140:143], v[164:167], v[184:187]
buffer_load_dwordx4 a[188:191], v248, s[24:27], s97 offen offset:2048
v_mfma_f32_16x16x32_bf16 v[188:191], v[144:147], v[164:167], v[188:191]
s_waitcnt lgkmcnt(4)
v_mfma_f32_16x16x32_bf16 v[176:179], v[136:139], v[168:171], v[176:179]
ds_read_b128 v[136:139], v8 offset:2688
v_mfma_f32_16x16x32_bf16 v[180:183], v[140:143], v[168:171], v[180:183]
ds_read_b128 v[164:167], v9 offset:2512
v_mfma_f32_16x16x32_bf16 v[184:187], v[144:147], v[168:171], v[184:187]
buffer_load_dwordx4 a[192:195], v248, s[24:27], s97 offen offset:3072
v_mfma_f32_16x16x32_bf16 v[188:191], v[148:151], v[168:171], v[188:191]
s_waitcnt lgkmcnt(4)
v_mfma_f32_16x16x32_bf16 v[176:179], v[140:143], v[172:175], v[176:179]
ds_read_b128 v[140:143], v8 offset:2752
v_mfma_f32_16x16x32_bf16 v[180:183], v[144:147], v[172:175], v[180:183]
ds_read_b128 v[168:171], v9 offset:2576
v_mfma_f32_16x16x32_bf16 v[184:187], v[148:151], v[172:175], v[184:187]
buffer_load_dwordx4 a[196:199], v248, s[24:27], s98 offen
v_mfma_f32_16x16x32_bf16 v[188:191], v[152:155], v[172:175], v[188:191]
s_add_u32 s97, s97, 5120
s_cmp_eq_u32 s97, s80
s_cselect_b32 s97, s79, s97
s_add_u32 s98, s97, 4096
L_join_36:
s_waitcnt lgkmcnt(4)
v_mfma_f32_16x16x32_bf16 v[176:179], v[144:147], v[160:163], v[176:179]
ds_read_b128 v[144:147], v8 offset:2816
v_mfma_f32_16x16x32_bf16 v[180:183], v[148:151], v[160:163], v[180:183]
ds_read_b128 v[172:175], v9 offset:2640
v_mfma_f32_16x16x32_bf16 v[184:187], v[152:155], v[160:163], v[184:187]
buffer_load_dwordx4 a[200:203], v248, s[24:27], s97 offen offset:0
v_mfma_f32_16x16x32_bf16 v[188:191], v[156:159], v[160:163], v[188:191]
s_waitcnt lgkmcnt(4)
v_mfma_f32_16x16x32_bf16 v[176:179], v[148:151], v[164:167], v[176:179]
ds_read_b128 v[148:151], v8 offset:2880
v_mfma_f32_16x16x32_bf16 v[180:183], v[152:155], v[164:167], v[180:183]
ds_read_b128 v[160:163], v9 offset:2720
v_mfma_f32_16x16x32_bf16 v[184:187], v[156:159], v[164:167], v[184:187]
buffer_load_dwordx4 a[204:207], v248, s[24:27], s97 offen offset:1024
v_mfma_f32_16x16x32_bf16 v[188:191], v[128:131], v[164:167], v[188:191]
s_waitcnt lgkmcnt(4)
v_mfma_f32_16x16x32_bf16 v[176:179], v[152:155], v[168:171], v[176:179]
ds_read_b128 v[152:155], v8 offset:2944
v_mfma_f32_16x16x32_bf16 v[180:183], v[156:159], v[168:171], v[180:183]
ds_read_b128 v[164:167], v9 offset:2784
v_mfma_f32_16x16x32_bf16 v[184:187], v[128:131], v[168:171], v[184:187]
buffer_load_dwordx4 a[208:211], v248, s[24:27], s97 offen offset:2048
v_mfma_f32_16x16x32_bf16 v[188:191], v[132:135], v[168:171], v[188:191]
s_waitcnt lgkmcnt(4)
v_mfma_f32_16x16x32_bf16 v[176:179], v[156:159], v[172:175], v[176:179]
ds_read_b128 v[156:159], v8 offset:3008
v_mfma_f32_16x16x32_bf16 v[180:183], v[128:131], v[172:175], v[180:183]
ds_read_b128 v[168:171], v9 offset:2848
v_mfma_f32_16x16x32_bf16 v[184:187], v[132:135], v[172:175], v[184:187]
buffer_load_dwordx4 a[212:215], v248, s[24:27], s97 offen offset:3072
v_mfma_f32_16x16x32_bf16 v[188:191], v[136:139], v[172:175], v[188:191]
buffer_load_dwordx4 a[216:219], v248, s[24:27], s98 offen
s_add_u32 s97, s97, 5120
s_cmp_eq_u32 s97, s80
s_cselect_b32 s97, s79, s97
s_add_u32 s98, s97, 4096
s_waitcnt lgkmcnt(4)
v_mfma_f32_16x16x32_bf16 v[176:179], v[128:131], v[160:163], v[176:179]
ds_read_b128 v[128:131], v8 offset:3072
v_mfma_f32_16x16x32_bf16 v[180:183], v[132:135], v[160:163], v[180:183]
ds_read_b128 v[172:175], v9 offset:2912
v_mfma_f32_16x16x32_bf16 v[184:187], v[136:139], v[160:163], v[184:187]
buffer_load_dwordx4 a[220:223], v248, s[24:27], s97 offen offset:0
v_mfma_f32_16x16x32_bf16 v[188:191], v[140:143], v[160:163], v[188:191]
s_waitcnt lgkmcnt(4)
v_mfma_f32_16x16x32_bf16 v[176:179], v[132:135], v[164:167], v[176:179]
ds_read_b128 v[132:135], v8 offset:3136
v_mfma_f32_16x16x32_bf16 v[180:183], v[136:139], v[164:167], v[180:183]
ds_read_b128 v[160:163], v9 offset:2992
v_mfma_f32_16x16x32_bf16 v[184:187], v[140:143], v[164:167], v[184:187]
buffer_load_dwordx4 a[224:227], v248, s[24:27], s97 offen offset:1024
v_mfma_f32_16x16x32_bf16 v[188:191], v[144:147], v[164:167], v[188:191]
s_waitcnt lgkmcnt(4)
v_mfma_f32_16x16x32_bf16 v[176:179], v[136:139], v[168:171], v[176:179]
ds_read_b128 v[136:139], v8 offset:3200
v_mfma_f32_16x16x32_bf16 v[180:183], v[140:143], v[168:171], v[180:183]
ds_read_b128 v[164:167], v9 offset:3056
v_mfma_f32_16x16x32_bf16 v[184:187], v[144:147], v[168:171], v[184:187]
buffer_load_dwordx4 a[228:231], v248, s[24:27], s97 offen offset:2048
v_mfma_f32_16x16x32_bf16 v[188:191], v[148:151], v[168:171], v[188:191]
s_waitcnt lgkmcnt(4)
v_mfma_f32_16x16x32_bf16 v[176:179], v[140:143], v[172:175], v[176:179]
ds_read_b128 v[140:143], v8 offset:3264
v_mfma_f32_16x16x32_bf16 v[180:183], v[144:147], v[172:175], v[180:183]
ds_read_b128 v[168:171], v9 offset:3120
v_mfma_f32_16x16x32_bf16 v[184:187], v[148:151], v[172:175], v[184:187]
buffer_load_dwordx4 a[232:235], v248, s[24:27], s97 offen offset:3072
v_mfma_f32_16x16x32_bf16 v[188:191], v[152:155], v[172:175], v[188:191]
buffer_load_dword v254, v249, s[24:27], 0 offen sc1
s_waitcnt lgkmcnt(4)
v_mfma_f32_16x16x32_bf16 v[176:179], v[144:147], v[160:163], v[176:179]
ds_read_b128 v[144:147], v8 offset:3328
v_mfma_f32_16x16x32_bf16 v[180:183], v[148:151], v[160:163], v[180:183]
ds_read_b128 v[172:175], v9 offset:3184
v_mfma_f32_16x16x32_bf16 v[184:187], v[152:155], v[160:163], v[184:187]
buffer_load_dwordx4 a[236:239], v248, s[24:27], s98 offen
v_mfma_f32_16x16x32_bf16 v[188:191], v[156:159], v[160:163], v[188:191]
s_add_u32 s97, s97, 5120
s_cmp_eq_u32 s97, s80
s_cselect_b32 s97, s79, s97
s_add_u32 s98, s97, 4096
s_waitcnt lgkmcnt(4)
v_mfma_f32_16x16x32_bf16 v[176:179], v[148:151], v[164:167], v[176:179]
ds_read_b128 v[148:151], v8 offset:3392
v_mfma_f32_16x16x32_bf16 v[180:183], v[152:155], v[164:167], v[180:183]
ds_read_b128 v[160:163], v9 offset:3264
v_mfma_f32_16x16x32_bf16 v[184:187], v[156:159], v[164:167], v[184:187]
buffer_load_dwordx4 v[208:211], v248, s[24:27], s97 offen offset:0
v_mfma_f32_16x16x32_bf16 v[188:191], v[128:131], v[164:167], v[188:191]
s_waitcnt lgkmcnt(4)
v_mfma_f32_16x16x32_bf16 v[176:179], v[152:155], v[168:171], v[176:179]
ds_read_b128 v[152:155], v8 offset:3456
v_mfma_f32_16x16x32_bf16 v[180:183], v[156:159], v[168:171], v[180:183]
ds_read_b128 v[164:167], v9 offset:3328
v_mfma_f32_16x16x32_bf16 v[184:187], v[128:131], v[168:171], v[184:187]
buffer_load_dwordx4 v[212:215], v248, s[24:27], s97 offen offset:1024
v_mfma_f32_16x16x32_bf16 v[188:191], v[132:135], v[168:171], v[188:191]
buffer_load_dwordx4 v[216:219], v248, s[24:27], s97 offen offset:2048
s_waitcnt lgkmcnt(4)
v_mfma_f32_16x16x32_bf16 v[176:179], v[156:159], v[172:175], v[176:179]
ds_read_b128 v[156:159], v8 offset:3520
v_mfma_f32_16x16x32_bf16 v[180:183], v[128:131], v[172:175], v[180:183]
ds_read_b128 v[168:171], v9 offset:3392
v_mfma_f32_16x16x32_bf16 v[184:187], v[132:135], v[172:175], v[184:187]
buffer_load_dwordx4 v[220:223], v248, s[24:27], s97 offen offset:3072
v_mfma_f32_16x16x32_bf16 v[188:191], v[136:139], v[172:175], v[188:191]
s_waitcnt lgkmcnt(4)
v_mfma_f32_16x16x32_bf16 v[176:179], v[128:131], v[160:163], v[176:179]
ds_read_b128 v[128:131], v8 offset:3584
v_mfma_f32_16x16x32_bf16 v[180:183], v[132:135], v[160:163], v[180:183]
ds_read_b128 v[172:175], v9 offset:3456
v_mfma_f32_16x16x32_bf16 v[184:187], v[136:139], v[160:163], v[184:187]
buffer_load_dwordx4 v[224:227], v248, s[24:27], s98 offen
v_mfma_f32_16x16x32_bf16 v[188:191], v[140:143], v[160:163], v[188:191]
s_add_u32 s97, s97, 5120
s_cmp_eq_u32 s97, s80
s_cselect_b32 s97, s79, s97
s_add_u32 s98, s97, 4096
s_waitcnt lgkmcnt(4)
v_mfma_f32_16x16x32_bf16 v[176:179], v[132:135], v[164:167], v[176:179]
ds_read_b128 v[132:135], v8 offset:3648
v_mfma_f32_16x16x32_bf16 v[180:183], v[136:139], v[164:167], v[180:183]
ds_read_b128 v[160:163], v9 offset:3536
v_mfma_f32_16x16x32_bf16 v[184:187], v[140:143], v[164:167], v[184:187]
buffer_load_dwordx4 v[228:231], v248, s[24:27], s97 offen offset:0
v_mfma_f32_16x16x32_bf16 v[188:191], v[144:147], v[164:167], v[188:191]
s_waitcnt lgkmcnt(4)
v_mfma_f32_16x16x32_bf16 v[176:179], v[136:139], v[168:171], v[176:179]
ds_read_b128 v[136:139], v8 offset:3712
v_mfma_f32_16x16x32_bf16 v[180:183], v[140:143], v[168:171], v[180:183]
ds_read_b128 v[164:167], v9 offset:3600
v_mfma_f32_16x16x32_bf16 v[184:187], v[144:147], v[168:171], v[184:187]
buffer_load_dwordx4 v[232:235], v248, s[24:27], s97 offen offset:1024
v_mfma_f32_16x16x32_bf16 v[188:191], v[148:151], v[168:171], v[188:191]
s_waitcnt lgkmcnt(4)
v_mfma_f32_16x16x32_bf16 v[176:179], v[140:143], v[172:175], v[176:179]
ds_read_b128 v[140:143], v8 offset:3776
v_mfma_f32_16x16x32_bf16 v[180:183], v[144:147], v[172:175], v[180:183]
ds_read_b128 v[168:171], v9 offset:3664
v_mfma_f32_16x16x32_bf16 v[184:187], v[148:151], v[172:175], v[184:187]
buffer_load_dwordx4 v[236:239], v248, s[24:27], s97 offen offset:2048
v_mfma_f32_16x16x32_bf16 v[188:191], v[152:155], v[172:175], v[188:191]
s_waitcnt lgkmcnt(4)
v_mfma_f32_16x16x32_bf16 v[176:179], v[144:147], v[160:163], v[176:179]
ds_read_b128 v[144:147], v8 offset:3840
v_mfma_f32_16x16x32_bf16 v[180:183], v[148:151], v[160:163], v[180:183]
ds_read_b128 v[172:175], v9 offset:3728
v_mfma_f32_16x16x32_bf16 v[184:187], v[152:155], v[160:163], v[184:187]
buffer_load_dwordx4 v[240:243], v248, s[24:27], s97 offen offset:3072
v_mfma_f32_16x16x32_bf16 v[188:191], v[156:159], v[160:163], v[188:191]
s_waitcnt lgkmcnt(4)
v_mfma_f32_16x16x32_bf16 v[176:179], v[148:151], v[164:167], v[176:179]
ds_read_b128 v[148:151], v8 offset:3904
v_mfma_f32_16x16x32_bf16 v[180:183], v[152:155], v[164:167], v[180:183]
ds_read_b128 v[160:163], v9 offset:3808
v_mfma_f32_16x16x32_bf16 v[184:187], v[156:159], v[164:167], v[184:187]
buffer_load_dwordx4 v[244:247], v248, s[24:27], s98 offen
v_mfma_f32_16x16x32_bf16 v[188:191], v[128:131], v[164:167], v[188:191]
s_add_u32 s97, s97, 5120
s_cmp_eq_u32 s97, s80
s_cselect_b32 s97, s79, s97
s_add_u32 s98, s97, 4096
s_waitcnt vmcnt(11)
v_cmp_eq_u32 vcc, 0, v254
s_cbranch_vccnz L_slow_37
L_back_38:
s_mul_i32 s6, s94, 54
s_add_u32 s6, s6, s96
s_lshl_b32 s81, s6, 12
s_add_u32 s81, s81, 10485760
s_cmp_ge_u32 s5, 2
s_cselect_b32 s7, 13, 14
s_lshl_b32 s7, s7, 12
s_add_u32 s82, s81, s7
s_lshl_b32 s7, s93, 12
s_add_u32 s99, s81, s7
s_add_u32 s6, s5, 0
s_and_b32 s6, s6, 3
s_lshl_b32 s6, s6, 10
v_add_u32 v56, s6, v248
s_add_u32 s6, s5, 1
s_and_b32 s6, s6, 3
s_lshl_b32 s6, s6, 10
v_add_u32 v57, s6, v248
s_add_u32 s6, s5, 2
s_and_b32 s6, s6, 3
s_lshl_b32 s6, s6, 10
v_add_u32 v58, s6, v248
s_add_u32 s6, s5, 3
s_and_b32 s6, s6, 3
s_lshl_b32 s6, s6, 10
v_add_u32 v59, s6, v248
s_waitcnt lgkmcnt(4)
v_mfma_f32_16x16x32_bf16 v[176:179], v[152:155], v[168:171], v[176:179]
ds_read_b128 v[152:155], v8 offset:3968
v_mfma_f32_16x16x32_bf16 v[180:183], v[156:159], v[168:171], v[180:183]
ds_read_b128 v[164:167], v9 offset:3872
v_mfma_f32_16x16x32_bf16 v[184:187], v[128:131], v[168:171], v[184:187]
v_mfma_f32_16x16x32_bf16 v[188:191], v[132:135], v[168:171], v[188:191]
s_waitcnt lgkmcnt(4)
v_mfma_f32_16x16x32_bf16 v[176:179], v[156:159], v[172:175], v[176:179]
ds_read_b128 v[156:159], v8 offset:4032
v_mfma_f32_16x16x32_bf16 v[180:183], v[128:131], v[172:175], v[180:183]
ds_read_b128 v[168:171], v9 offset:3936
v_mfma_f32_16x16x32_bf16 v[184:187], v[132:135], v[172:175], v[184:187]
buffer_load_dwordx4 v[64:67], v57, s[24:27], s99 offen
s_add_u32 s99, s99, 4096
v_mfma_f32_16x16x32_bf16 v[188:191], v[136:139], v[172:175], v[188:191]
buffer_load_dwordx4 v[68:71], v57, s[24:27], s99 offen
s_add_u32 s99, s99, 4096
s_waitcnt lgkmcnt(4)
v_mfma_f32_16x16x32_bf16 v[176:179], v[128:131], v[160:163], v[176:179]
ds_read_b128 v[128:131], v8 offset:4096
v_mfma_f32_16x16x32_bf16 v[180:183], v[132:135], v[160:163], v[180:183]
ds_read_b128 v[172:175], v9 offset:4000
v_mfma_f32_16x16x32_bf16 v[184:187], v[136:139], v[160:163], v[184:187]
buffer_load_dwordx4 v[72:75], v57, s[24:27], s99 offen
s_add_u32 s99, s99, 4096
v_mfma_f32_16x16x32_bf16 v[188:191], v[140:143], v[160:163], v[188:191]
s_waitcnt lgkmcnt(4)
v_mfma_f32_16x16x32_bf16 v[176:179], v[132:135], v[164:167], v[176:179]
ds_read_b128 v[132:135], v8 offset:4160
v_mfma_f32_16x16x32_bf16 v[180:183], v[136:139], v[164:167], v[180:183]
ds_read_b128 v[160:163], v9 offset:4080
v_mfma_f32_16x16x32_bf16 v[184:187], v[140:143], v[164:167], v[184:187]
buffer_load_dwordx4 v[76:79], v57, s[24:27], s99 offen
s_add_u32 s99, s99, 4096
v_mfma_f32_16x16x32_bf16 v[188:191], v[144:147], v[164:167], v[188:191]
s_waitcnt lgkmcnt(4)
v_mfma_f32_16x16x32_bf16 v[176:179], v[136:139], v[168:171], v[176:179]
ds_read_b128 v[136:139], v8 offset:4224
v_mfma_f32_16x16x32_bf16 v[180:183], v[140:143], v[168:171], v[180:183]
ds_read_b128 v[164:167], v9 offset:4144
v_mfma_f32_16x16x32_bf16 v[184:187], v[144:147], v[168:171], v[184:187]
buffer_load_dwordx4 v[80:83], v57, s[24:27], s99 offen
s_add_u32 s99, s99, 4096
v_mfma_f32_16x16x32_bf16 v[188:191], v[148:151], v[168:171], v[188:191]
buffer_load_dwordx4 v[84:87], v57, s[24:27], s99 offen
s_add_u32 s99, s99, 4096
s_waitcnt lgkmcnt(4)
v_mfma_f32_16x16x32_bf16 v[176:179], v[140:143], v[172:175], v[176:179]
v_mfma_f32_16x16x32_bf16 v[180:183], v[144:147], v[172:175], v[180:183]
ds_read_b128 v[168:171], v9 offset:4208
v_mfma_f32_16x16x32_bf16 v[184:187], v[148:151], v[172:175], v[184:187]
buffer_load_dwordx4 v[88:91], v57, s[24:27], s99 offen
s_add_u32 s99, s99, 4096
v_mfma_f32_16x16x32_bf16 v[188:191], v[152:155], v[172:175], v[188:191]
s_waitcnt lgkmcnt(3)
v_mfma_f32_16x16x32_bf16 v[176:179], v[144:147], v[160:163], v[176:179]
v_mfma_f32_16x16x32_bf16 v[180:183], v[148:151], v[160:163], v[180:183]
ds_read_b128 v[172:175], v9 offset:4272
v_mfma_f32_16x16x32_bf16 v[184:187], v[152:155], v[160:163], v[184:187]
buffer_load_dwordx4 v[92:95], v57, s[24:27], s99 offen
s_add_u32 s99, s99, 4096
v_mfma_f32_16x16x32_bf16 v[188:191], v[156:159], v[160:163], v[188:191]
s_waitcnt lgkmcnt(2)
v_mfma_f32_16x16x32_bf16 v[176:179], v[148:151], v[164:167], v[176:179]
v_mfma_f32_16x16x32_bf16 v[180:183], v[152:155], v[164:167], v[180:183]
v_mfma_f32_16x16x32_bf16 v[184:187], v[156:159], v[164:167], v[184:187]
buffer_load_dwordx4 v[96:99], v57, s[24:27], s99 offen
s_add_u32 s99, s99, 4096
v_mfma_f32_16x16x32_bf16 v[188:191], v[128:131], v[164:167], v[188:191]
buffer_load_dwordx4 v[100:103], v57, s[24:27], s99 offen
s_add_u32 s99, s99, 4096
s_waitcnt lgkmcnt(1)
v_mfma_f32_16x16x32_bf16 v[176:179], v[152:155], v[168:171], v[176:179]
v_mfma_f32_16x16x32_bf16 v[180:183], v[156:159], v[168:171], v[180:183]
v_mfma_f32_16x16x32_bf16 v[184:187], v[128:131], v[168:171], v[184:187]
buffer_load_dwordx4 v[104:107], v57, s[24:27], s99 offen
s_add_u32 s99, s99, 4096
v_mfma_f32_16x16x32_bf16 v[188:191], v[132:135], v[168:171], v[188:191]
s_waitcnt lgkmcnt(0)
v_mfma_f32_16x16x32_bf16 v[176:179], v[156:159], v[172:175], v[176:179]
v_mfma_f32_16x16x32_bf16 v[180:183], v[128:131], v[172:175], v[180:183]
v_mfma_f32_16x16x32_bf16 v[184:187], v[132:135], v[172:175], v[184:187]
buffer_load_dwordx4 v[108:111], v57, s[24:27], s99 offen
s_add_u32 s99, s99, 4096
v_mfma_f32_16x16x32_bf16 v[188:191], v[136:139], v[172:175], v[188:191]
s_nop 3
v_cvt_pk_bf16_f32 v20, v176, v177
v_cvt_pk_bf16_f32 v21, v178, v179
v_cvt_pk_bf16_f32 v22, v180, v181
v_cvt_pk_bf16_f32 v23, v182, v183
buffer_store_dwordx4 v[20:23], v11, s[24:27], s92 offen offset:0 sc1
v_cvt_pk_bf16_f32 v24, v184, v185
v_cvt_pk_bf16_f32 v25, v186, v187
v_cvt_pk_bf16_f32 v26, v188, v189
v_cvt_pk_bf16_f32 v27, v190, v191
buffer_store_dwordx4 v[24:27], v11, s[24:27], s92 offen offset:128 sc1
L_gemm2:
s_waitcnt vmcnt(13)
v_mfma_f32_16x16x32_bf16 v[148:151], a[0:3], v[64:67], 0
buffer_load_dwordx4 v[112:115], v57, s[24:27], s99 offen
v_mfma_f32_16x16x32_bf16 v[152:155], a[4:7], v[64:67], 0
s_add_u32 s99, s99, 4096
v_and_b32 v50, 15, v1
v_mfma_f32_16x16x32_bf16 v[156:159], a[8:11], v[64:67], 0
v_lshrrev_b32 v51, 3, v50
v_lshlrev_b32 v51, 3, v51
v_mfma_f32_16x16x32_bf16 v[160:163], a[12:15], v[64:67], 0
v_and_b32 v52, 3, v50
v_mfma_f32_16x16x32_bf16 v[164:167], a[16:19], v[64:67], 0
v_lshl_or_b32 v51, v52, 1, v51
v_bfe_u32 v52, v50, 2, 1
s_waitcnt vmcnt(13)
v_mfma_f32_16x16x32_bf16 v[148:151], a[20:23], v[68:71], v[148:151]
buffer_load_dwordx4 v[116:119], v57, s[24:27], s99 offen
v_mfma_f32_16x16x32_bf16 v[152:155], a[24:27], v[68:71], v[152:155]
s_mov_b32 s99, s81
v_mfma_f32_16x16x32_bf16 v[156:159], a[28:31], v[68:71], v[156:159]
v_or_b32 v51, v51, v52
v_mul_u32_u24 v51, 176, v51
v_mfma_f32_16x16x32_bf16 v[160:163], a[32:35], v[68:71], v[160:163]
v_lshrrev_b32 v53, 4, v1
v_mfma_f32_16x16x32_bf16 v[164:167], a[36:39], v[68:71], v[164:167]
v_mul_u32_u24 v52, 40, v53
s_mul_i32 s86, s5, 2816
s_waitcnt vmcnt(13)
v_mfma_f32_16x16x32_bf16 v[148:151], a[40:43], v[72:75], v[148:151]
buffer_load_dwordx4 v[120:123], v58, s[24:27], s99 offen
v_mfma_f32_16x16x32_bf16 v[152:155], a[44:47], v[72:75], v[152:155]
s_add_u32 s99, s99, 4096
s_add_u32 s86, s86, 73728
v_mfma_f32_16x16x32_bf16 v[156:159], a[48:51], v[72:75], v[156:159]
v_add_u32 v51, v51, v52
v_mfma_f32_16x16x32_bf16 v[160:163], a[52:55], v[72:75], v[160:163]
s_and_b32 s87, s95, 1
v_mfma_f32_16x16x32_bf16 v[164:167], a[56:59], v[72:75], v[164:167]
s_lshl_b32 s87, s87, 1
v_subrev_u32 v52, s87, v50
s_waitcnt vmcnt(13)
v_mfma_f32_16x16x32_bf16 v[148:151], a[60:63], v[76:79], v[148:151]
buffer_load_dwordx4 v[124:127], v58, s[24:27], s99 offen
v_mfma_f32_16x16x32_bf16 v[152:155], a[64:67], v[76:79], v[152:155]
s_add_u32 s99, s99, 4096
v_lshlrev_b32 v52, 4, v52
v_mfma_f32_16x16x32_bf16 v[156:159], a[68:71], v[76:79], v[156:159]
v_add_u32 v50, s86, v51
v_mfma_f32_16x16x32_bf16 v[160:163], a[72:75], v[76:79], v[160:163]
v_mul_u32_u24 v51, 176, v53
v_add_u32 v51, v51, v52
v_mfma_f32_16x16x32_bf16 v[164:167], a[76:79], v[76:79], v[164:167]
v_add_u32 v51, s86, v51
s_waitcnt vmcnt(13)
v_mfma_f32_16x16x32_bf16 v[148:151], a[80:83], v[80:83], v[148:151]
buffer_load_dwordx4 v[64:67], v58, s[24:27], s99 offen
v_mfma_f32_16x16x32_bf16 v[152:155], a[84:87], v[80:83], v[152:155]
s_add_u32 s99, s99, 4096
s_lshl_b32 s86, s94, 6
v_mfma_f32_16x16x32_bf16 v[156:159], a[88:91], v[80:83], v[156:159]
s_lshl_b32 s85, s5, 4
v_mfma_f32_16x16x32_bf16 v[160:163], a[92:95], v[80:83], v[160:163]
s_add_u32 s86, s86, s85
v_add_u32 v53, s86, v53
v_mfma_f32_16x16x32_bf16 v[164:167], a[96:99], v[80:83], v[164:167]
v_mul_u32_u24 v53, 1280, v53
s_waitcnt vmcnt(13)
v_mfma_f32_16x16x32_bf16 v[148:151], a[100:103], v[84:87], v[148:151]
buffer_load_dwordx4 v[68:71], v58, s[24:27], s99 offen
v_mfma_f32_16x16x32_bf16 v[152:155], a[104:107], v[84:87], v[152:155]
s_add_u32 s99, s99, 4096
s_mul_i32 s86, s95, 160
v_mfma_f32_16x16x32_bf16 v[156:159], a[108:111], v[84:87], v[156:159]
v_add_u32 v52, s86, v52
v_mfma_f32_16x16x32_bf16 v[160:163], a[112:115], v[84:87], v[160:163]
v_add_u32 v52, v52, v53
v_add_u32 v53, 5120, v52
v_mfma_f32_16x16x32_bf16 v[164:167], a[116:119], v[84:87], v[164:167]
v_add_u32 v54, 10240, v52
s_waitcnt vmcnt(13)
v_mfma_f32_16x16x32_bf16 v[148:151], a[120:123], v[88:91], v[148:151]
buffer_load_dwordx4 v[72:75], v58, s[24:27], s99 offen
v_mfma_f32_16x16x32_bf16 v[152:155], a[124:127], v[88:91], v[152:155]
s_add_u32 s99, s99, 4096
v_add_u32 v55, 15360, v52
v_mfma_f32_16x16x32_bf16 v[156:159], a[128:131], v[88:91], v[156:159]
s_lshl_b32 s86, 0x03ff03ff, s87
s_mov_b32 s87, s86
v_mfma_f32_16x16x32_bf16 v[160:163], a[132:135], v[88:91], v[160:163]
s_mul_i32 s83, s5, 15360
v_mfma_f32_16x16x32_bf16 v[164:167], a[136:139], v[88:91], v[164:167]
s_add_u32 s83, s83, 10240
s_waitcnt vmcnt(13)
v_mfma_f32_16x16x32_bf16 v[148:151], a[140:143], v[92:95], v[148:151]
buffer_load_dwordx4 v[76:79], v58, s[24:27], s99 offen
v_mfma_f32_16x16x32_bf16 v[152:155], a[144:147], v[92:95], v[152:155]
s_add_u32 s99, s99, 4096
v_and_b32 v2, 15, v1
v_mfma_f32_16x16x32_bf16 v[156:159], a[148:151], v[92:95], v[156:159]
v_lshrrev_b32 v4, 3, v2
v_lshlrev_b32 v4, 3, v4
v_mfma_f32_16x16x32_bf16 v[160:163], a[152:155], v[92:95], v[160:163]
s_add_u32 m0, s83, 0
s_mov_b64 exec, s[86:87]
buffer_load_dwordx4 v52, s[8:11], 0 offen lds
s_mov_b64 exec, -1
v_mfma_f32_16x16x32_bf16 v[164:167], a[156:159], v[92:95], v[164:167]
v_and_b32 v5, 3, v2
v_lshl_or_b32 v4, v5, 1, v4
s_waitcnt vmcnt(14)
v_mfma_f32_16x16x32_bf16 v[148:151], a[160:163], v[96:99], v[148:151]
buffer_load_dwordx4 v[80:83], v58, s[24:27], s99 offen
v_mfma_f32_16x16x32_bf16 v[152:155], a[164:167], v[96:99], v[152:155]
s_add_u32 s99, s99, 4096
v_bfe_u32 v5, v2, 2, 1
v_mfma_f32_16x16x32_bf16 v[156:159], a[168:171], v[96:99], v[156:159]
v_or_b32 v4, v4, v5
s_lshl_b32 s6, s94, 6
v_mfma_f32_16x16x32_bf16 v[160:163], a[172:175], v[96:99], v[160:163]
s_add_u32 m0, s83, 1088
s_mov_b64 exec, s[86:87]
buffer_load_dwordx4 v53, s[8:11], 0 offen lds
s_mov_b64 exec, -1
v_mfma_f32_16x16x32_bf16 v[164:167], a[176:179], v[96:99], v[164:167]
s_lshl_b32 s7, s5, 4
s_add_u32 s6, s6, s7
s_waitcnt vmcnt(15)
v_mfma_f32_16x16x32_bf16 v[148:151], a[180:183], v[100:103], v[148:151]
buffer_load_dwordx4 v[84:87], v58, s[24:27], s99 offen
v_mfma_f32_16x16x32_bf16 v[152:155], a[184:187], v[100:103], v[152:155]
s_add_u32 s99, s99, 4096
v_add_u32 v5, s6, v4
v_mfma_f32_16x16x32_bf16 v[156:159], a[188:191], v[100:103], v[156:159]
v_lshlrev_b32 v5, 4, v5
v_lshrrev_b32 v3, 2, v4
v_mfma_f32_16x16x32_bf16 v[160:163], a[192:195], v[100:103], v[160:163]
s_add_u32 m0, s83, 2176
s_mov_b64 exec, s[86:87]
buffer_load_dwordx4 v54, s[8:11], 0 offen lds
s_mov_b64 exec, -1
v_mfma_f32_16x16x32_bf16 v[164:167], a[196:199], v[100:103], v[164:167]
v_mul_u32_u24 v3, 1088, v3
v_and_b32 v4, 3, v4
s_waitcnt vmcnt(16)
v_mfma_f32_16x16x32_bf16 v[148:151], a[200:203], v[104:107], v[148:151]
buffer_load_dwordx4 v[88:91], v58, s[24:27], s99 offen
v_mfma_f32_16x16x32_bf16 v[152:155], a[204:207], v[104:107], v[152:155]
s_add_u32 s99, s99, 4096
v_lshl_add_u32 v3, v4, 8, v3
v_mfma_f32_16x16x32_bf16 v[156:159], a[208:211], v[104:107], v[156:159]
v_lshrrev_b32 v4, 4, v1
v_mul_u32_u24 v4, 40, v4
v_mfma_f32_16x16x32_bf16 v[160:163], a[212:215], v[104:107], v[160:163]
s_add_u32 m0, s83, 3264
s_mov_b64 exec, s[86:87]
buffer_load_dwordx4 v55, s[8:11], 0 offen lds
s_mov_b64 exec, -1
v_mfma_f32_16x16x32_bf16 v[164:167], a[216:219], v[104:107], v[164:167]
v_add_u32 v3, v3, v4
s_and_b32 s6, s95, 1
s_lshl_b32 s6, s6, 5
s_add_u32 s6, s6, s83
v_add_u32 v7, s6, v3
s_waitcnt vmcnt(17)
v_mfma_f32_16x16x32_bf16 v[148:151], a[220:223], v[108:111], v[148:151]
buffer_load_dwordx4 v[92:95], v58, s[24:27], s99 offen
v_mfma_f32_16x16x32_bf16 v[152:155], a[224:227], v[108:111], v[152:155]
s_add_u32 s99, s99, 4096
v_mfma_f32_16x16x32_bf16 v[156:159], a[228:231], v[108:111], v[156:159]
v_mfma_f32_16x16x32_bf16 v[160:163], a[232:235], v[108:111], v[160:163]
s_mov_b32 s7, 98304
buffer_load_dwordx2 v[18:19], v5, s[24:27], s7 offen
v_mfma_f32_16x16x32_bf16 v[164:167], a[236:239], v[108:111], v[164:167]
s_waitcnt vmcnt(17)
v_mov_b32 v61, 61440
s_mov_b64 exec, 1
ds_add_rtn_u32 v61, v61, v253
s_mov_b64 exec, -1
s_waitcnt vmcnt(16)
v_mfma_f32_16x16x32_bf16 v[148:151], v[208:211], v[112:115], v[148:151]
buffer_load_dwordx4 v[96:99], v58, s[24:27], s99 offen
v_mfma_f32_16x16x32_bf16 v[152:155], v[212:215], v[112:115], v[152:155]
s_add_u32 s99, s99, 4096
v_accvgpr_read_b32 v2, a240
v_mfma_f32_16x16x32_bf16 v[156:159], v[216:219], v[112:115], v[156:159]
v_lshlrev_b32 v128, 16, v2
v_mfma_f32_16x16x32_bf16 v[160:163], v[220:223], v[112:115], v[160:163]
v_and_b32 v129, 0xffff0000, v2
v_accvgpr_read_b32 v3, a241
v_mfma_f32_16x16x32_bf16 v[164:167], v[224:227], v[112:115], v[164:167]
v_lshlrev_b32 v130, 16, v3
s_cmp_ge_u32 s5, 2
s_cbranch_scc1 L_umskip_39
s_waitcnt vmcnt(16)
v_mfma_f32_16x16x32_bf16 v[148:151], v[228:231], v[116:119], v[148:151]
v_mfma_f32_16x16x32_bf16 v[152:155], v[232:235], v[116:119], v[152:155]
v_mfma_f32_16x16x32_bf16 v[156:159], v[236:239], v[116:119], v[156:159]
v_mfma_f32_16x16x32_bf16 v[160:163], v[240:243], v[116:119], v[160:163]
v_mfma_f32_16x16x32_bf16 v[164:167], v[244:247], v[116:119], v[164:167]
L_umskip_39:
s_waitcnt lgkmcnt(0)
v_readfirstlane_b32 s6, v61
s_cmp_lg_u32 s6, 3
s_cbranch_scc1 L_yfl_40
s_mov_b64 exec, 1
buffer_store_dword v253, v252, s[24:27], 0 offen offset:20 sc1
s_mov_b64 exec, -1
L_yfl_40:
s_waitcnt vmcnt(15)
v_mfma_f32_16x16x32_bf16 v[168:171], a[0:3], v[120:123], 0
buffer_load_dwordx4 v[100:103], v58, s[24:27], s99 offen
v_mfma_f32_16x16x32_bf16 v[172:175], a[4:7], v[120:123], 0
s_add_u32 s99, s99, 4096
s_add_u32 s84, s5, 1
s_and_b32 s84, s84, 3
s_mul_i32 s84, s84, 15360
v_mfma_f32_16x16x32_bf16 v[176:179], a[8:11], v[120:123], 0
buffer_load_dwordx4 v[104:107], v58, s[24:27], s99 offen
s_add_u32 s84, s84, 0
v_lshl_add_u32 v60, v1, 3, s84
v_mfma_f32_16x16x32_bf16 v[180:183], a[12:15], v[120:123], 0
s_add_u32 s99, s99, 4096
v_and_b32 v131, 0xffff0000, v3
v_mfma_f32_16x16x32_bf16 v[184:187], a[16:19], v[120:123], 0
v_accvgpr_read_b32 v4, a242
s_waitcnt vmcnt(16)
v_mfma_f32_16x16x32_bf16 v[168:171], a[20:23], v[124:127], v[168:171]
buffer_load_dwordx4 v[108:111], v58, s[24:27], s99 offen
v_mfma_f32_16x16x32_bf16 v[172:175], a[24:27], v[124:127], v[172:175]
s_mov_b32 s99, s81
v_lshlrev_b32 v132, 16, v4
v_mfma_f32_16x16x32_bf16 v[176:179], a[28:31], v[124:127], v[176:179]
ds_write_b64 v60, v[148:149] offset:0
v_mfma_f32_16x16x32_bf16 v[180:183], a[32:35], v[124:127], v[180:183]
v_and_b32 v133, 0xffff0000, v4
v_mfma_f32_16x16x32_bf16 v[184:187], a[36:39], v[124:127], v[184:187]
v_accvgpr_read_b32 v5, a243
s_waitcnt vmcnt(16)
v_mfma_f32_16x16x32_bf16 v[168:171], a[40:43], v[64:67], v[168:171]
buffer_load_dwordx4 v[112:115], v59, s[24:27], s99 offen
v_mfma_f32_16x16x32_bf16 v[172:175], a[44:47], v[64:67], v[172:175]
s_add_u32 s99, s99, 4096
v_lshlrev_b32 v134, 16, v5
v_mfma_f32_16x16x32_bf16 v[176:179], a[48:51], v[64:67], v[176:179]
ds_write_b64 v60, v[150:151] offset:512
v_mfma_f32_16x16x32_bf16 v[180:183], a[52:55], v[64:67], v[180:183]
v_and_b32 v135, 0xffff0000, v5
v_mfma_f32_16x16x32_bf16 v[184:187], a[56:59], v[64:67], v[184:187]
v_accvgpr_read_b32 v2, a244
s_waitcnt vmcnt(16)
v_mfma_f32_16x16x32_bf16 v[168:171], a[60:63], v[68:71], v[168:171]
buffer_load_dwordx4 v[116:119], v59, s[24:27], s99 offen
v_mfma_f32_16x16x32_bf16 v[172:175], a[64:67], v[68:71], v[172:175]
s_add_u32 s99, s99, 4096
v_lshlrev_b32 v136, 16, v2
v_mfma_f32_16x16x32_bf16 v[176:179], a[68:71], v[68:71], v[176:179]
ds_write_b64 v60, v[152:153] offset:1024
v_mfma_f32_16x16x32_bf16 v[180:183], a[72:75], v[68:71], v[180:183]
v_and_b32 v137, 0xffff0000, v2
v_mfma_f32_16x16x32_bf16 v[184:187], a[76:79], v[68:71], v[184:187]
v_accvgpr_read_b32 v3, a245
s_waitcnt vmcnt(16)
v_mfma_f32_16x16x32_bf16 v[168:171], a[80:83], v[72:75], v[168:171]
buffer_load_dwordx4 v[120:123], v59, s[24:27], s99 offen
v_mfma_f32_16x16x32_bf16 v[172:175], a[84:87], v[72:75], v[172:175]
s_add_u32 s99, s99, 4096
v_lshlrev_b32 v138, 16, v3
v_mfma_f32_16x16x32_bf16 v[176:179], a[88:91], v[72:75], v[176:179]
v_and_b32 v139, 0xffff0000, v3
v_mfma_f32_16x16x32_bf16 v[180:183], a[92:95], v[72:75], v[180:183]
ds_write_b64 v60, v[154:155] offset:1536
v_mfma_f32_16x16x32_bf16 v[184:187], a[96:99], v[72:75], v[184:187]
v_accvgpr_read_b32 v4, a246
v_lshlrev_b32 v140, 16, v4
s_waitcnt vmcnt(16)
v_mfma_f32_16x16x32_bf16 v[168:171], a[100:103], v[76:79], v[168:171]
buffer_load_dwordx4 v[124:127], v59, s[24:27], s99 offen
v_mfma_f32_16x16x32_bf16 v[172:175], a[104:107], v[76:79], v[172:175]
s_add_u32 s99, s99, 4096
v_mfma_f32_16x16x32_bf16 v[176:179], a[108:111], v[76:79], v[176:179]
v_and_b32 v141, 0xffff0000, v4
v_accvgpr_read_b32 v5, a247
v_mfma_f32_16x16x32_bf16 v[180:183], a[112:115], v[76:79], v[180:183]
v_lshlrev_b32 v142, 16, v5
v_mfma_f32_16x16x32_bf16 v[184:187], a[116:119], v[76:79], v[184:187]
ds_write_b64 v60, v[156:157] offset:2048
s_waitcnt vmcnt(15)
v_mfma_f32_16x16x32_bf16 v[168:171], a[120:123], v[80:83], v[168:171]
buffer_load_dwordx4 v[64:67], v59, s[24:27], s99 offen
v_mfma_f32_16x16x32_bf16 v[172:175], a[124:127], v[80:83], v[172:175]
s_add_u32 s99, s99, 4096
v_mfma_f32_16x16x32_bf16 v[176:179], a[128:131], v[80:83], v[176:179]
v_and_b32 v143, 0xffff0000, v5
v_accvgpr_read_b32 v2, a248
v_mfma_f32_16x16x32_bf16 v[180:183], a[132:135], v[80:83], v[180:183]
v_lshlrev_b32 v144, 16, v2
v_mfma_f32_16x16x32_bf16 v[184:187], a[136:139], v[80:83], v[184:187]
v_and_b32 v145, 0xffff0000, v2
s_waitcnt vmcnt(14)
v_mfma_f32_16x16x32_bf16 v[168:171], a[140:143], v[84:87], v[168:171]
buffer_load_dwordx4 v[68:71], v59, s[24:27], s99 offen
v_mfma_f32_16x16x32_bf16 v[172:175], a[144:147], v[84:87], v[172:175]
s_add_u32 s99, s99, 4096
v_accvgpr_read_b32 v3, a249
v_mfma_f32_16x16x32_bf16 v[176:179], a[148:151], v[84:87], v[176:179]
ds_write_b64 v60, v[158:159] offset:2560
v_mfma_f32_16x16x32_bf16 v[180:183], a[152:155], v[84:87], v[180:183]
v_lshlrev_b32 v146, 16, v3
v_mfma_f32_16x16x32_bf16 v[184:187], a[156:159], v[84:87], v[184:187]
v_and_b32 v147, 0xffff0000, v3
s_waitcnt vmcnt(13)
v_mfma_f32_16x16x32_bf16 v[168:171], a[160:163], v[88:91], v[168:171]
buffer_load_dwordx4 v[72:75], v59, s[24:27], s99 offen
v_mfma_f32_16x16x32_bf16 v[172:175], a[164:167], v[88:91], v[172:175]
s_add_u32 s99, s99, 4096
s_mul_i32 s82, s5, 15360
v_mfma_f32_16x16x32_bf16 v[176:179], a[168:171], v[88:91], v[176:179]
ds_write_b64 v60, v[160:161] offset:3072
v_mfma_f32_16x16x32_bf16 v[180:183], a[172:175], v[88:91], v[180:183]
s_add_u32 s82, s82, 0
v_lshl_add_u32 v62, v1, 3, s82
v_mfma_f32_16x16x32_bf16 v[184:187], a[176:179], v[88:91], v[184:187]
v_lshrrev_b32 v2, 4, v1
v_mul_u32_u24 v2, 20, v2
s_waitcnt vmcnt(12)
v_mfma_f32_16x16x32_bf16 v[168:171], a[180:183], v[92:95], v[168:171]
buffer_load_dwordx4 v[76:79], v59, s[24:27], s99 offen
v_mfma_f32_16x16x32_bf16 v[172:175], a[184:187], v[92:95], v[172:175]
s_add_u32 s99, s99, 4096
v_bfe_u32 v3, v1, 2, 2
v_mfma_f32_16x16x32_bf16 v[176:179], a[188:191], v[92:95], v[176:179]
ds_write_b64 v60, v[162:163] offset:3584
v_mfma_f32_16x16x32_bf16 v[180:183], a[192:195], v[92:95], v[180:183]
v_add_u32 v2, v2, v3
v_mfma_f32_16x16x32_bf16 v[184:187], a[196:199], v[92:95], v[184:187]
v_lshlrev_b32 v2, 7, v2
v_and_b32 v3, 3, v1
s_waitcnt vmcnt(11)
v_mfma_f32_16x16x32_bf16 v[168:171], a[200:203], v[96:99], v[168:171]
buffer_load_dwordx4 v[80:83], v59, s[24:27], s99 offen
v_mfma_f32_16x16x32_bf16 v[172:175], a[204:207], v[96:99], v[172:175]
s_add_u32 s99, s99, 4096
v_lshl_add_u32 v2, v3, 4, v2
v_mfma_f32_16x16x32_bf16 v[176:179], a[208:211], v[96:99], v[176:179]
s_and_b32 s82, s5, 1
s_lshl_b32 s82, s82, 6
v_mfma_f32_16x16x32_bf16 v[180:183], a[212:215], v[96:99], v[180:183]
ds_write_b64 v60, v[164:165] offset:4096
v_mfma_f32_16x16x32_bf16 v[184:187], a[216:219], v[96:99], v[184:187]
s_lshr_b32 s83, s5, 1
s_waitcnt vmcnt(11)
v_mfma_f32_16x16x32_bf16 v[168:171], a[220:223], v[100:103], v[168:171]
buffer_load_dwordx4 v[84:87], v59, s[24:27], s99 offen
v_mfma_f32_16x16x32_bf16 v[172:175], a[224:227], v[100:103], v[172:175]
s_add_u32 s99, s99, 4096
ds_read_b64 v[8:9], v7 offset:0
v_mfma_f32_16x16x32_bf16 v[176:179], a[228:231], v[100:103], v[176:179]
ds_read_b64 v[10:11], v7 offset:8
ds_read_b64 v[12:13], v7 offset:16
v_mfma_f32_16x16x32_bf16 v[180:183], a[232:235], v[100:103], v[180:183]
ds_read_b64 v[14:15], v7 offset:24
ds_read_b64 v[16:17], v7 offset:32
v_mfma_f32_16x16x32_bf16 v[184:187], a[236:239], v[100:103], v[184:187]
ds_write_b64 v60, v[166:167] offset:4608
s_waitcnt vmcnt(11)
v_mfma_f32_16x16x32_bf16 v[168:171], v[208:211], v[104:107], v[168:171]
buffer_load_dwordx4 v[88:91], v59, s[24:27], s99 offen
v_mfma_f32_16x16x32_bf16 v[172:175], v[212:215], v[104:107], v[172:175]
s_add_u32 s99, s99, 4096
s_lshl_b32 s83, s83, 3
v_mfma_f32_16x16x32_bf16 v[176:179], v[216:219], v[104:107], v[176:179]
s_add_u32 s82, s82, s83
s_add_u32 s82, s82, 61440
v_mfma_f32_16x16x32_bf16 v[180:183], v[220:223], v[104:107], v[180:183]
v_add_u32 v63, s82, v2
v_mov_b32 v48, -1.4426950408889634
v_mfma_f32_16x16x32_bf16 v[184:187], v[224:227], v[104:107], v[184:187]
v_mov_b32 v49, 1.0
s_cmp_ge_u32 s5, 2
s_cbranch_scc1 L_umskip_41
s_waitcnt vmcnt(11)
v_mfma_f32_16x16x32_bf16 v[168:171], v[228:231], v[108:111], v[168:171]
v_mfma_f32_16x16x32_bf16 v[172:175], v[232:235], v[108:111], v[172:175]
v_mfma_f32_16x16x32_bf16 v[176:179], v[236:239], v[108:111], v[176:179]
v_mfma_f32_16x16x32_bf16 v[180:183], v[240:243], v[108:111], v[180:183]
v_mfma_f32_16x16x32_bf16 v[184:187], v[244:247], v[108:111], v[184:187]
L_umskip_41:
s_waitcnt lgkmcnt(1)
s_waitcnt vmcnt(10)
v_mfma_f32_16x16x32_bf16 v[188:191], a[0:3], v[112:115], 0
buffer_load_dwordx4 v[92:95], v59, s[24:27], s99 offen
v_mfma_f32_16x16x32_bf16 v[192:195], a[4:7], v[112:115], 0
s_add_u32 s99, s99, 4096
s_add_u32 s84, s5, 2
s_and_b32 s84, s84, 3
s_mul_i32 s84, s84, 15360
v_mfma_f32_16x16x32_bf16 v[196:199], a[8:11], v[112:115], 0
buffer_load_dwordx4 v[96:99], v59, s[24:27], s99 offen
s_add_u32 s84, s84, 5120
v_lshl_add_u32 v60, v1, 3, s84
v_mfma_f32_16x16x32_bf16 v[200:203], a[12:15], v[112:115], 0
s_add_u32 s99, s99, 4096
v_mul_f32 v6, v18, v19
v_mfma_f32_16x16x32_bf16 v[204:207], a[16:19], v[112:115], 0
v_mov_b32 v7, v19
v_sub_f32 v6, 0, v6
s_waitcnt vmcnt(11)
v_mfma_f32_16x16x32_bf16 v[188:191], a[20:23], v[116:119], v[188:191]
buffer_load_dwordx4 v[100:103], v59, s[24:27], s99 offen
v_mfma_f32_16x16x32_bf16 v[192:195], a[24:27], v[116:119], v[192:195]
s_mov_b32 s99, s81
v_lshlrev_b32 v40, 16, v8
v_mfma_f32_16x16x32_bf16 v[196:199], a[28:31], v[116:119], v[196:199]
ds_write_b64 v60, v[168:169] offset:0
v_mfma_f32_16x16x32_bf16 v[200:203], a[32:35], v[116:119], v[200:203]
v_and_b32 v41, 0xffff0000, v8
v_lshlrev_b32 v42, 16, v9
v_mfma_f32_16x16x32_bf16 v[204:207], a[36:39], v[116:119], v[204:207]
v_and_b32 v43, 0xffff0000, v9
s_waitcnt vmcnt(11)
v_mfma_f32_16x16x32_bf16 v[188:191], a[40:43], v[120:123], v[188:191]
buffer_load_dwordx4 v[104:107], v56, s[24:27], s99 offen
v_mfma_f32_16x16x32_bf16 v[192:195], a[44:47], v[120:123], v[192:195]
s_add_u32 s99, s99, 4096
v_lshlrev_b32 v44, 16, v10
v_mfma_f32_16x16x32_bf16 v[196:199], a[48:51], v[120:123], v[196:199]
ds_write_b64 v60, v[170:171] offset:512
v_mfma_f32_16x16x32_bf16 v[200:203], a[52:55], v[120:123], v[200:203]
v_and_b32 v45, 0xffff0000, v10
v_lshlrev_b32 v46, 16, v11
v_mfma_f32_16x16x32_bf16 v[204:207], a[56:59], v[120:123], v[204:207]
v_and_b32 v47, 0xffff0000, v11
v_lshlrev_b32 v28, 16, v12
s_waitcnt vmcnt(11)
v_mfma_f32_16x16x32_bf16 v[188:191], a[60:63], v[124:127], v[188:191]
buffer_load_dwordx4 v[108:111], v56, s[24:27], s99 offen
v_mfma_f32_16x16x32_bf16 v[192:195], a[64:67], v[124:127], v[192:195]
s_add_u32 s99, s99, 4096
v_and_b32 v29, 0xffff0000, v12
v_mfma_f32_16x16x32_bf16 v[196:199], a[68:71], v[124:127], v[196:199]
ds_write_b64 v60, v[172:173] offset:1024
v_mfma_f32_16x16x32_bf16 v[200:203], a[72:75], v[124:127], v[200:203]
v_lshlrev_b32 v30, 16, v13
v_mfma_f32_16x16x32_bf16 v[204:207], a[76:79], v[124:127], v[204:207]
v_and_b32 v31, 0xffff0000, v13
v_lshlrev_b32 v32, 16, v14
s_waitcnt vmcnt(11)
v_mfma_f32_16x16x32_bf16 v[188:191], a[80:83], v[64:67], v[188:191]
buffer_load_dwordx4 v[112:115], v56, s[24:27], s99 offen
v_mfma_f32_16x16x32_bf16 v[192:195], a[84:87], v[64:67], v[192:195]
s_add_u32 s99, s99, 4096
v_and_b32 v33, 0xffff0000, v14
v_mfma_f32_16x16x32_bf16 v[196:199], a[88:91], v[64:67], v[196:199]
v_lshlrev_b32 v34, 16, v15
v_and_b32 v35, 0xffff0000, v15
v_mfma_f32_16x16x32_bf16 v[200:203], a[92:95], v[64:67], v[200:203]
ds_write_b64 v60, v[174:175] offset:1536
v_mfma_f32_16x16x32_bf16 v[204:207], a[96:99], v[64:67], v[204:207]
v_lshlrev_b32 v36, 16, v16
s_waitcnt vmcnt(11)
v_mfma_f32_16x16x32_bf16 v[188:191], a[100:103], v[68:71], v[188:191]
buffer_load_dwordx4 v[116:119], v56, s[24:27], s99 offen
v_mfma_f32_16x16x32_bf16 v[192:195], a[104:107], v[68:71], v[192:195]
s_add_u32 s99, s99, 4096
v_and_b32 v37, 0xffff0000, v16
v_mfma_f32_16x16x32_bf16 v[196:199], a[108:111], v[68:71], v[196:199]
v_lshlrev_b32 v38, 16, v17
v_and_b32 v39, 0xffff0000, v17
v_mfma_f32_16x16x32_bf16 v[200:203], a[112:115], v[68:71], v[200:203]
v_fma_f32 v20, v40, v7, v6
v_fma_f32 v21, v41, v7, v6
v_mfma_f32_16x16x32_bf16 v[204:207], a[116:119], v[68:71], v[204:207]
ds_write_b64 v60, v[176:177] offset:2048
s_waitcnt vmcnt(11)
v_mfma_f32_16x16x32_bf16 v[188:191], a[120:123], v[72:75], v[188:191]
buffer_load_dwordx4 v[120:123], v56, s[24:27], s99 offen
v_mfma_f32_16x16x32_bf16 v[192:195], a[124:127], v[72:75], v[192:195]
s_add_u32 s99, s99, 4096
v_mfma_f32_16x16x32_bf16 v[196:199], a[128:131], v[72:75], v[196:199]
v_fma_f32 v22, v42, v7, v6
v_fma_f32 v23, v43, v7, v6
v_mfma_f32_16x16x32_bf16 v[200:203], a[132:135], v[72:75], v[200:203]
v_fma_f32 v24, v44, v7, v6
v_fma_f32 v25, v45, v7, v6
v_mfma_f32_16x16x32_bf16 v[204:207], a[136:139], v[72:75], v[204:207]
v_fma_f32 v26, v46, v7, v6
v_fma_f32 v27, v47, v7, v6
s_cmp_lg_u32 s5, 0
s_cbranch_scc1 L_ypl_42
buffer_load_dword v254, v250, s[24:27], 0 offen sc1
L_ypl_42:
s_waitcnt vmcnt(11)
v_mfma_f32_16x16x32_bf16 v[188:191], a[140:143], v[76:79], v[188:191]
buffer_load_dwordx4 v[124:127], v56, s[24:27], s99 offen
v_mfma_f32_16x16x32_bf16 v[192:195], a[144:147], v[76:79], v[192:195]
s_add_u32 s99, s99, 4096
v_mfma_f32_16x16x32_bf16 v[196:199], a[148:151], v[76:79], v[196:199]
ds_write_b64 v60, v[178:179] offset:2560
v_mfma_f32_16x16x32_bf16 v[200:203], a[152:155], v[76:79], v[200:203]
v_fma_f32 v28, v28, v7, v6
v_fma_f32 v29, v29, v7, v6
v_mfma_f32_16x16x32_bf16 v[204:207], a[156:159], v[76:79], v[204:207]
v_fma_f32 v30, v30, v7, v6
v_fma_f32 v31, v31, v7, v6
s_waitcnt vmcnt(11)
v_mfma_f32_16x16x32_bf16 v[188:191], a[160:163], v[80:83], v[188:191]
buffer_load_dwordx4 v[64:67], v56, s[24:27], s99 offen
v_mfma_f32_16x16x32_bf16 v[192:195], a[164:167], v[80:83], v[192:195]
s_add_u32 s99, s99, 4096
v_fma_f32 v32, v32, v7, v6
v_mfma_f32_16x16x32_bf16 v[196:199], a[168:171], v[80:83], v[196:199]
ds_write_b64 v60, v[180:181] offset:3072
v_mfma_f32_16x16x32_bf16 v[200:203], a[172:175], v[80:83], v[200:203]
v_fma_f32 v33, v33, v7, v6
v_mfma_f32_16x16x32_bf16 v[204:207], a[176:179], v[80:83], v[204:207]
v_fma_f32 v34, v34, v7, v6
v_fma_f32 v35, v35, v7, v6
s_waitcnt vmcnt(11)
v_mfma_f32_16x16x32_bf16 v[188:191], a[180:183], v[84:87], v[188:191]
buffer_load_dwordx4 v[68:71], v56, s[24:27], s99 offen
v_mfma_f32_16x16x32_bf16 v[192:195], a[184:187], v[84:87], v[192:195]
s_add_u32 s99, s99, 4096
v_fma_f32 v36, v36, v7, v6
v_mfma_f32_16x16x32_bf16 v[196:199], a[188:191], v[84:87], v[196:199]
ds_write_b64 v60, v[182:183] offset:3584
v_mfma_f32_16x16x32_bf16 v[200:203], a[192:195], v[84:87], v[200:203]
v_fma_f32 v37, v37, v7, v6
v_fma_f32 v38, v38, v7, v6
v_mfma_f32_16x16x32_bf16 v[204:207], a[196:199], v[84:87], v[204:207]
v_fma_f32 v39, v39, v7, v6
v_lshrrev_b32 v2, 3, v1
s_waitcnt vmcnt(11)
v_mfma_f32_16x16x32_bf16 v[188:191], a[200:203], v[88:91], v[188:191]
buffer_load_dwordx4 v[72:75], v56, s[24:27], s99 offen
v_mfma_f32_16x16x32_bf16 v[192:195], a[204:207], v[88:91], v[192:195]
s_add_u32 s99, s99, 4096
v_and_b32 v3, 7, v1
v_mfma_f32_16x16x32_bf16 v[196:199], a[208:211], v[88:91], v[196:199]
v_lshlrev_b32 v3, 4, v3
v_lshl_add_u32 v61, v2, 12, v3
v_mfma_f32_16x16x32_bf16 v[200:203], a[212:215], v[88:91], v[200:203]
ds_write_b64 v60, v[184:185] offset:4096
v_mfma_f32_16x16x32_bf16 v[204:207], a[216:219], v[88:91], v[204:207]
s_mul_i32 s90, s95, 80
s_lshl_b32 s91, s5, 3
s_waitcnt vmcnt(11)
v_mfma_f32_16x16x32_bf16 v[188:191], a[220:223], v[92:95], v[188:191]
buffer_load_dwordx4 v[76:79], v56, s[24:27], s99 offen
v_mfma_f32_16x16x32_bf16 v[192:195], a[224:227], v[92:95], v[192:195]
s_add_u32 s99, s99, 4096
v_mfma_f32_16x16x32_bf16 v[196:199], a[228:231], v[92:95], v[196:199]
s_add_u32 s90, s90, s91
s_lshl_b32 s90, s90, 12
v_mfma_f32_16x16x32_bf16 v[200:203], a[232:235], v[92:95], v[200:203]
s_lshl_b32 s91, s94, 7
s_add_u32 s90, s90, s91
v_mfma_f32_16x16x32_bf16 v[204:207], a[236:239], v[92:95], v[204:207]
ds_write_b64 v60, v[186:187] offset:4608
s_waitcnt vmcnt(11)
v_mfma_f32_16x16x32_bf16 v[188:191], v[208:211], v[96:99], v[188:191]
buffer_load_dwordx4 v[80:83], v56, s[24:27], s99 offen
v_mfma_f32_16x16x32_bf16 v[192:195], v[212:215], v[96:99], v[192:195]
s_add_u32 s99, s99, 4096
s_add_u32 s90, s90, 4194304
v_mfma_f32_16x16x32_bf16 v[196:199], v[216:219], v[96:99], v[196:199]
s_lshl_b32 s91, s5, 14
v_mfma_f32_16x16x32_bf16 v[200:203], v[220:223], v[96:99], v[200:203]
s_sub_u32 s88, s90, s91
s_add_u32 s88, s88, 262144
v_mfma_f32_16x16x32_bf16 v[204:207], v[224:227], v[96:99], v[204:207]
s_lshl_b32 s89, s5, 9
s_add_u32 s89, s89, 69632
s_cmp_ge_u32 s5, 2
s_cbranch_scc1 L_umskip_43
s_waitcnt vmcnt(11)
v_mfma_f32_16x16x32_bf16 v[188:191], v[228:231], v[100:103], v[188:191]
v_mfma_f32_16x16x32_bf16 v[192:195], v[232:235], v[100:103], v[192:195]
v_mfma_f32_16x16x32_bf16 v[196:199], v[236:239], v[100:103], v[196:199]
v_mfma_f32_16x16x32_bf16 v[200:203], v[240:243], v[100:103], v[200:203]
v_mfma_f32_16x16x32_bf16 v[204:207], v[244:247], v[100:103], v[204:207]
L_umskip_43:
s_waitcnt vmcnt(10)
v_mfma_f32_16x16x32_bf16 v[128:131], a[0:3], v[104:107], v[128:131]
buffer_load_dwordx4 v[84:87], v56, s[24:27], s99 offen
v_mfma_f32_16x16x32_bf16 v[132:135], a[4:7], v[104:107], v[132:135]
s_add_u32 s99, s99, 4096
s_add_u32 s84, s5, 3
s_and_b32 s84, s84, 3
s_mul_i32 s84, s84, 15360
v_mfma_f32_16x16x32_bf16 v[136:139], a[8:11], v[104:107], v[136:139]
buffer_load_dwordx4 v[88:91], v56, s[24:27], s99 offen
s_add_u32 s84, s84, 10240
v_lshl_add_u32 v60, v1, 3, s84
v_mfma_f32_16x16x32_bf16 v[140:143], a[12:15], v[104:107], v[140:143]
s_add_u32 s99, s99, 4096
s_lshl_b32 s91, s5, 10
v_mfma_f32_16x16x32_bf16 v[144:147], a[16:19], v[104:107], v[144:147]
s_add_u32 s91, s91, 61440
s_barrier
s_waitcnt vmcnt(11)
v_mfma_f32_16x16x32_bf16 v[128:131], a[20:23], v[108:111], v[128:131]
buffer_load_dwordx4 v[92:95], v56, s[24:27], s99 offen
v_mfma_f32_16x16x32_bf16 v[132:135], a[24:27], v[108:111], v[132:135]
s_mov_b32 s99, s81
v_mfma_f32_16x16x32_bf16 v[136:139], a[28:31], v[108:111], v[136:139]
ds_write_b64 v60, v[188:189] offset:0
v_mfma_f32_16x16x32_bf16 v[140:143], a[32:35], v[108:111], v[140:143]
ds_write_b64 v60, v[190:191] offset:512
v_mfma_f32_16x16x32_bf16 v[144:147], a[36:39], v[108:111], v[144:147]
ds_write_b64 v60, v[192:193] offset:1024
s_waitcnt vmcnt(11)
v_mfma_f32_16x16x32_bf16 v[128:131], a[40:43], v[112:115], v[128:131]
v_lshlrev_b32 v96, 16, v12
v_and_b32 v97, 0xffff0000, v12
v_mfma_f32_16x16x32_bf16 v[132:135], a[44:47], v[112:115], v[132:135]
v_lshlrev_b32 v98, 16, v13
v_mfma_f32_16x16x32_bf16 v[136:139], a[48:51], v[112:115], v[136:139]
ds_write_b64 v60, v[194:195] offset:1536
v_mfma_f32_16x16x32_bf16 v[140:143], a[52:55], v[112:115], v[140:143]
ds_write_b64 v60, v[196:197] offset:2048
v_mfma_f32_16x16x32_bf16 v[144:147], a[56:59], v[112:115], v[144:147]
v_and_b32 v99, 0xffff0000, v13
v_lshlrev_b32 v100, 16, v14
s_waitcnt vmcnt(10)
v_mfma_f32_16x16x32_bf16 v[128:131], a[60:63], v[116:119], v[128:131]
v_and_b32 v101, 0xffff0000, v14
v_mfma_f32_16x16x32_bf16 v[132:135], a[64:67], v[116:119], v[132:135]
ds_write_b64 v60, v[198:199] offset:2560
v_mfma_f32_16x16x32_bf16 v[136:139], a[68:71], v[116:119], v[136:139]
ds_write_b64 v60, v[200:201] offset:3072
v_mfma_f32_16x16x32_bf16 v[140:143], a[72:75], v[116:119], v[140:143]
v_lshlrev_b32 v102, 16, v15
v_and_b32 v103, 0xffff0000, v15
v_mfma_f32_16x16x32_bf16 v[144:147], a[76:79], v[116:119], v[144:147]
ds_write_b64 v60, v[202:203] offset:3584
s_waitcnt vmcnt(9)
v_mfma_f32_16x16x32_bf16 v[128:131], a[80:83], v[120:123], v[128:131]
v_lshlrev_b32 v104, 16, v16
v_mfma_f32_16x16x32_bf16 v[132:135], a[84:87], v[120:123], v[132:135]
ds_write_b64 v60, v[204:205] offset:4096
v_mfma_f32_16x16x32_bf16 v[136:139], a[88:91], v[120:123], v[136:139]
v_and_b32 v105, 0xffff0000, v16
v_lshlrev_b32 v106, 16, v17
v_mfma_f32_16x16x32_bf16 v[140:143], a[92:95], v[120:123], v[140:143]
ds_write_b64 v60, v[206:207] offset:4608
v_mfma_f32_16x16x32_bf16 v[144:147], a[96:99], v[120:123], v[144:147]
v_and_b32 v107, 0xffff0000, v17
s_cmp_lg_u32 s5, 0
s_cbranch_scc1 L_back_45
s_waitcnt vmcnt(9)
v_cmp_eq_u32 vcc, 0, v254
s_cbranch_vccnz L_slow_44
L_back_45:
s_waitcnt lgkmcnt(0)
s_barrier
s_mov_b32 m0, s91
s_add_u32 s91, s91, 4096
buffer_load_dwordx4 v61, s[24:27], s90 offen lds
s_add_u32 s90, s90, 131072
s_mov_b32 m0, s91
s_add_u32 s91, s91, 4096
buffer_load_dwordx4 v61, s[24:27], s90 offen lds
s_add_u32 s90, s90, 131072
s_mov_b32 m0, s89
s_mov_b32 exec_hi, 0
buffer_load_dwordx4 v61, s[24:27], s88 offen lds
s_mov_b32 exec_hi, -1
s_waitcnt vmcnt(11)
v_mfma_f32_16x16x32_bf16 v[128:131], a[100:103], v[124:127], v[128:131]
ds_read2st64_b64 v[148:151], v62 offset0:0 offset1:1
v_mfma_f32_16x16x32_bf16 v[132:135], a[104:107], v[124:127], v[132:135]
ds_read2st64_b64 v[152:155], v62 offset0:2 offset1:3
v_mfma_f32_16x16x32_bf16 v[136:139], a[108:111], v[124:127], v[136:139]
ds_read2st64_b64 v[156:159], v62 offset0:4 offset1:5
v_mfma_f32_16x16x32_bf16 v[140:143], a[112:115], v[124:127], v[140:143]
ds_read2st64_b64 v[160:163], v62 offset0:6 offset1:7
v_mfma_f32_16x16x32_bf16 v[144:147], a[116:119], v[124:127], v[144:147]
ds_read2st64_b64 v[164:167], v62 offset0:8 offset1:9
s_waitcnt vmcnt(10)
v_mfma_f32_16x16x32_bf16 v[128:131], a[120:123], v[64:67], v[128:131]
ds_read2st64_b64 v[168:171], v62 offset0:10 offset1:11
v_mfma_f32_16x16x32_bf16 v[132:135], a[124:127], v[64:67], v[132:135]
ds_read2st64_b64 v[172:175], v62 offset0:12 offset1:13
v_mfma_f32_16x16x32_bf16 v[136:139], a[128:131], v[64:67], v[136:139]
ds_read2st64_b64 v[176:179], v62 offset0:14 offset1:15
v_mfma_f32_16x16x32_bf16 v[140:143], a[132:135], v[64:67], v[140:143]
ds_read2st64_b64 v[180:183], v62 offset0:16 offset1:17
v_mfma_f32_16x16x32_bf16 v[144:147], a[136:139], v[64:67], v[144:147]
ds_read2st64_b64 v[184:187], v62 offset0:18 offset1:19
s_waitcnt vmcnt(9)
v_mfma_f32_16x16x32_bf16 v[128:131], a[140:143], v[68:71], v[128:131]
ds_read2st64_b64 v[188:191], v62 offset0:20 offset1:21
v_mfma_f32_16x16x32_bf16 v[132:135], a[144:147], v[68:71], v[132:135]
ds_read2st64_b64 v[192:195], v62 offset0:22 offset1:23
v_mfma_f32_16x16x32_bf16 v[136:139], a[148:151], v[68:71], v[136:139]
ds_read2st64_b64 v[196:199], v62 offset0:24 offset1:25
v_mfma_f32_16x16x32_bf16 v[140:143], a[152:155], v[68:71], v[140:143]
ds_read2st64_b64 v[200:203], v62 offset0:26 offset1:27
v_mfma_f32_16x16x32_bf16 v[144:147], a[156:159], v[68:71], v[144:147]
ds_read2st64_b64 v[204:207], v62 offset0:28 offset1:29
s_waitcnt vmcnt(8)
v_mfma_f32_16x16x32_bf16 v[128:131], a[160:163], v[72:75], v[128:131]
v_mfma_f32_16x16x32_bf16 v[132:135], a[164:167], v[72:75], v[132:135]
v_mfma_f32_16x16x32_bf16 v[136:139], a[168:171], v[72:75], v[136:139]
v_mfma_f32_16x16x32_bf16 v[140:143], a[172:175], v[72:75], v[140:143]
v_mfma_f32_16x16x32_bf16 v[144:147], a[176:179], v[72:75], v[144:147]
s_waitcnt lgkmcnt(5)
s_waitcnt vmcnt(7)
v_mfma_f32_16x16x32_bf16 v[128:131], a[180:183], v[76:79], v[128:131]
v_add_f32 v148, v148, v168
v_add_f32 v149, v149, v169
v_mfma_f32_16x16x32_bf16 v[132:135], a[184:187], v[76:79], v[132:135]
v_add_f32 v150, v150, v170
v_add_f32 v151, v151, v171
v_mfma_f32_16x16x32_bf16 v[136:139], a[188:191], v[76:79], v[136:139]
v_add_f32 v152, v152, v172
v_add_f32 v153, v153, v173
v_mfma_f32_16x16x32_bf16 v[140:143], a[192:195], v[76:79], v[140:143]
v_add_f32 v154, v154, v174
v_add_f32 v155, v155, v175
v_mfma_f32_16x16x32_bf16 v[144:147], a[196:199], v[76:79], v[144:147]
v_add_f32 v156, v156, v176
v_add_f32 v157, v157, v177
s_waitcnt vmcnt(6)
v_mfma_f32_16x16x32_bf16 v[128:131], a[200:203], v[80:83], v[128:131]
v_add_f32 v158, v158, v178
v_add_f32 v159, v159, v179
v_mfma_f32_16x16x32_bf16 v[132:135], a[204:207], v[80:83], v[132:135]
v_add_f32 v160, v160, v180
v_add_f32 v161, v161, v181
v_mfma_f32_16x16x32_bf16 v[136:139], a[208:211], v[80:83], v[136:139]
v_add_f32 v162, v162, v182
v_add_f32 v163, v163, v183
v_mfma_f32_16x16x32_bf16 v[140:143], a[212:215], v[80:83], v[140:143]
v_add_f32 v164, v164, v184
v_add_f32 v165, v165, v185
v_mfma_f32_16x16x32_bf16 v[144:147], a[216:219], v[80:83], v[144:147]
v_add_f32 v166, v166, v186
v_add_f32 v167, v167, v187
s_waitcnt lgkmcnt(0)
s_waitcnt vmcnt(5)
v_mfma_f32_16x16x32_bf16 v[128:131], a[220:223], v[84:87], v[128:131]
v_add_f32 v148, v148, v188
v_add_f32 v149, v149, v189
v_mfma_f32_16x16x32_bf16 v[132:135], a[224:227], v[84:87], v[132:135]
v_add_f32 v150, v150, v190
v_add_f32 v151, v151, v191
v_mfma_f32_16x16x32_bf16 v[136:139], a[228:231], v[84:87], v[136:139]
v_add_f32 v152, v152, v192
v_add_f32 v153, v153, v193
v_mfma_f32_16x16x32_bf16 v[140:143], a[232:235], v[84:87], v[140:143]
v_add_f32 v154, v154, v194
v_add_f32 v155, v155, v195
v_mfma_f32_16x16x32_bf16 v[144:147], a[236:239], v[84:87], v[144:147]
v_add_f32 v156, v156, v196
v_add_f32 v157, v157, v197
s_waitcnt vmcnt(4)
v_mfma_f32_16x16x32_bf16 v[128:131], v[208:211], v[88:91], v[128:131]
v_add_f32 v158, v158, v198
v_add_f32 v159, v159, v199
v_mfma_f32_16x16x32_bf16 v[132:135], v[212:215], v[88:91], v[132:135]
v_add_f32 v160, v160, v200
v_add_f32 v161, v161, v201
v_mfma_f32_16x16x32_bf16 v[136:139], v[216:219], v[88:91], v[136:139]
v_add_f32 v162, v162, v202
v_add_f32 v163, v163, v203
v_mfma_f32_16x16x32_bf16 v[140:143], v[220:223], v[88:91], v[140:143]
v_add_f32 v164, v164, v204
v_add_f32 v165, v165, v205
v_mfma_f32_16x16x32_bf16 v[144:147], v[224:227], v[88:91], v[144:147]
v_add_f32 v166, v166, v206
v_add_f32 v167, v167, v207
s_cmp_ge_u32 s5, 2
s_cbranch_scc1 L_umskip_46
s_waitcnt vmcnt(3)
v_mfma_f32_16x16x32_bf16 v[128:131], v[228:231], v[92:95], v[128:131]
v_mfma_f32_16x16x32_bf16 v[132:135], v[232:235], v[92:95], v[132:135]
v_mfma_f32_16x16x32_bf16 v[136:139], v[236:239], v[92:95], v[136:139]
v_mfma_f32_16x16x32_bf16 v[140:143], v[240:243], v[92:95], v[140:143]
v_mfma_f32_16x16x32_bf16 v[144:147], v[244:247], v[92:95], v[144:147]
L_umskip_46:
s_nop 7
v_pk_add_f32 v[128:129], v[128:129], v[148:149]
v_pk_add_f32 v[130:131], v[130:131], v[150:151]
v_pk_add_f32 v[132:133], v[132:133], v[152:153]
v_pk_add_f32 v[134:135], v[134:135], v[154:155]
v_pk_add_f32 v[136:137], v[136:137], v[156:157]
v_pk_add_f32 v[138:139], v[138:139], v[158:159]
v_pk_add_f32 v[140:141], v[140:141], v[160:161]
v_pk_add_f32 v[142:143], v[142:143], v[162:163]
v_pk_add_f32 v[144:145], v[144:145], v[164:165]
v_pk_add_f32 v[146:147], v[146:147], v[166:167]
v_pk_mul_f32 v[64:65], v[128:129], v[48:49] op_sel_hi:[1,0]
v_pk_mul_f32 v[66:67], v[130:131], v[48:49] op_sel_hi:[1,0]
v_pk_mul_f32 v[68:69], v[132:133], v[48:49] op_sel_hi:[1,0]
v_pk_mul_f32 v[70:71], v[134:135], v[48:49] op_sel_hi:[1,0]
v_pk_mul_f32 v[72:73], v[136:137], v[48:49] op_sel_hi:[1,0]
v_pk_mul_f32 v[74:75], v[138:139], v[48:49] op_sel_hi:[1,0]
v_pk_mul_f32 v[76:77], v[140:141], v[48:49] op_sel_hi:[1,0]
v_pk_mul_f32 v[78:79], v[142:143], v[48:49] op_sel_hi:[1,0]
v_pk_mul_f32 v[80:81], v[144:145], v[48:49] op_sel_hi:[1,0]
v_pk_mul_f32 v[82:83], v[146:147], v[48:49] op_sel_hi:[1,0]
v_exp_f32 v64, v64
v_exp_f32 v65, v65
v_exp_f32 v66, v66
v_exp_f32 v67, v67
v_exp_f32 v68, v68
v_exp_f32 v69, v69
v_exp_f32 v70, v70
v_exp_f32 v71, v71
v_exp_f32 v72, v72
v_exp_f32 v73, v73
v_exp_f32 v74, v74
v_exp_f32 v75, v75
v_exp_f32 v76, v76
v_exp_f32 v77, v77
v_exp_f32 v78, v78
v_exp_f32 v79, v79
v_exp_f32 v80, v80
v_exp_f32 v81, v81
v_exp_f32 v82, v82
v_exp_f32 v83, v83
s_waitcnt vmcnt(0) lgkmcnt(0)
s_barrier
ds_read_b64_tr_b16 v[188:189], v63 offset:0
ds_read_b64_tr_b16 v[190:191], v63 offset:512
ds_read_b64_tr_b16 v[192:193], v63 offset:1024
ds_read_b64_tr_b16 v[194:195], v63 offset:1536
ds_read_b64_tr_b16 v[196:197], v63 offset:2048
v_pk_add_f32 v[64:65], v[64:65], v[48:49] op_sel:[0,1] op_sel_hi:[1,1]
v_pk_add_f32 v[66:67], v[66:67], v[48:49] op_sel:[0,1] op_sel_hi:[1,1]
v_pk_add_f32 v[68:69], v[68:69], v[48:49] op_sel:[0,1] op_sel_hi:[1,1]
v_pk_add_f32 v[70:71], v[70:71], v[48:49] op_sel:[0,1] op_sel_hi:[1,1]
v_pk_add_f32 v[72:73], v[72:73], v[48:49] op_sel:[0,1] op_sel_hi:[1,1]
v_pk_add_f32 v[74:75], v[74:75], v[48:49] op_sel:[0,1] op_sel_hi:[1,1]
v_pk_add_f32 v[76:77], v[76:77], v[48:49] op_sel:[0,1] op_sel_hi:[1,1]
v_pk_add_f32 v[78:79], v[78:79], v[48:49] op_sel:[0,1] op_sel_hi:[1,1]
v_pk_add_f32 v[80:81], v[80:81], v[48:49] op_sel:[0,1] op_sel_hi:[1,1]
v_pk_add_f32 v[82:83], v[82:83], v[48:49] op_sel:[0,1] op_sel_hi:[1,1]
v_rcp_f32 v64, v64
v_rcp_f32 v65, v65
v_rcp_f32 v66, v66
v_rcp_f32 v67, v67
v_rcp_f32 v68, v68
v_rcp_f32 v69, v69
v_rcp_f32 v70, v70
v_rcp_f32 v71, v71
v_rcp_f32 v72, v72
v_rcp_f32 v73, v73
v_rcp_f32 v74, v74
v_rcp_f32 v75, v75
v_rcp_f32 v76, v76
v_rcp_f32 v77, v77
v_rcp_f32 v78, v78
v_rcp_f32 v79, v79
v_rcp_f32 v80, v80
v_rcp_f32 v81, v81
v_rcp_f32 v82, v82
v_rcp_f32 v83, v83
s_waitcnt lgkmcnt(0)
v_lshlrev_b32 v108, 16, v188
v_and_b32 v109, 0xffff0000, v188
v_lshlrev_b32 v110, 16, v189
v_and_b32 v111, 0xffff0000, v189
v_lshlrev_b32 v112, 16, v190
v_and_b32 v113, 0xffff0000, v190
v_lshlrev_b32 v114, 16, v191
v_and_b32 v115, 0xffff0000, v191
v_pk_mul_f32 v[64:65], v[64:65], v[128:129]
v_pk_mul_f32 v[66:67], v[66:67], v[130:131]
v_pk_mul_f32 v[68:69], v[68:69], v[132:133]
v_pk_mul_f32 v[70:71], v[70:71], v[134:135]
v_pk_mul_f32 v[108:109], v[108:109], v[20:21]
v_pk_mul_f32 v[110:111], v[110:111], v[22:23]
v_pk_mul_f32 v[112:113], v[112:113], v[24:25]
v_pk_mul_f32 v[114:115], v[114:115], v[26:27]
v_pk_fma_f32 v[108:109], v[108:109], v[64:65], v[40:41]
v_pk_fma_f32 v[110:111], v[110:111], v[66:67], v[42:43]
v_pk_fma_f32 v[112:113], v[112:113], v[68:69], v[44:45]
v_pk_fma_f32 v[114:115], v[114:115], v[70:71], v[46:47]
v_cvt_pk_bf16_f32 v188, v108, v109
v_cvt_pk_bf16_f32 v189, v110, v111
v_cvt_pk_bf16_f32 v190, v112, v113
v_cvt_pk_bf16_f32 v191, v114, v115
ds_write_b64 v50, v[188:189] offset:0
ds_write_b64 v50, v[190:191] offset:8
v_lshlrev_b32 v116, 16, v192
v_and_b32 v117, 0xffff0000, v192
v_lshlrev_b32 v118, 16, v193
v_and_b32 v119, 0xffff0000, v193
v_lshlrev_b32 v120, 16, v194
v_and_b32 v121, 0xffff0000, v194
v_lshlrev_b32 v122, 16, v195
v_and_b32 v123, 0xffff0000, v195
v_lshlrev_b32 v124, 16, v196
v_and_b32 v125, 0xffff0000, v196
v_lshlrev_b32 v126, 16, v197
v_and_b32 v127, 0xffff0000, v197
v_pk_mul_f32 v[72:73], v[72:73], v[136:137]
v_pk_mul_f32 v[74:75], v[74:75], v[138:139]
v_pk_mul_f32 v[76:77], v[76:77], v[140:141]
v_pk_mul_f32 v[78:79], v[78:79], v[142:143]
v_pk_mul_f32 v[80:81], v[80:81], v[144:145]
v_pk_mul_f32 v[82:83], v[82:83], v[146:147]
v_pk_mul_f32 v[116:117], v[116:117], v[28:29]
v_pk_mul_f32 v[118:119], v[118:119], v[30:31]
v_pk_mul_f32 v[120:121], v[120:121], v[32:33]
v_pk_mul_f32 v[122:123], v[122:123], v[34:35]
v_pk_mul_f32 v[124:125], v[124:125], v[36:37]
v_pk_mul_f32 v[126:127], v[126:127], v[38:39]
v_pk_fma_f32 v[116:117], v[116:117], v[72:73], v[96:97]
v_pk_fma_f32 v[118:119], v[118:119], v[74:75], v[98:99]
v_pk_fma_f32 v[120:121], v[120:121], v[76:77], v[100:101]
v_pk_fma_f32 v[122:123], v[122:123], v[78:79], v[102:103]
v_pk_fma_f32 v[124:125], v[124:125], v[80:81], v[104:105]
v_pk_fma_f32 v[126:127], v[126:127], v[82:83], v[106:107]
v_cvt_pk_bf16_f32 v192, v116, v117
v_cvt_pk_bf16_f32 v193, v118, v119
v_cvt_pk_bf16_f32 v194, v120, v121
v_cvt_pk_bf16_f32 v195, v122, v123
v_cvt_pk_bf16_f32 v196, v124, v125
v_cvt_pk_bf16_f32 v197, v126, v127
ds_write_b64 v50, v[192:193] offset:16
ds_write_b64 v50, v[194:195] offset:24
ds_write_b64 v50, v[196:197] offset:32
s_mov_b64 exec, s[86:87]
ds_read_b128 v[64:67], v51 offset:0
ds_read_b128 v[68:71], v51 offset:704
ds_read_b128 v[72:75], v51 offset:1408
ds_read_b128 v[76:79], v51 offset:2112
s_waitcnt lgkmcnt(3)
buffer_store_dwordx4 v[64:67], v52, s[28:31], 0 offen
s_waitcnt lgkmcnt(2)
buffer_store_dwordx4 v[68:71], v53, s[28:31], 0 offen
s_waitcnt lgkmcnt(1)
buffer_store_dwordx4 v[72:75], v54, s[28:31], 0 offen
s_waitcnt lgkmcnt(0)
buffer_store_dwordx4 v[76:79], v55, s[28:31], 0 offen
s_mov_b64 exec, -1
L_end:
s_endpgm
L_spare:
s_and_b32 s6, s3, 3
s_lshr_b32 s7, s3, 2
s_lshl_b32 s6, s6, 1
s_add_u32 s73, s6, s7
s_lshl_b32 s73, s73, 2
s_add_u32 s73, s73, s4
s_sub_u32 s73, s73, 28
s_and_b32 s6, s3, 3
s_lshl_b32 s6, s6, 2
s_and_b32 s7, s4, 3
s_add_u32 s77, s6, s7
s_lshr_b32 s6, s3, 2
s_mul_i32 s6, s6, 7
s_lshr_b32 s7, s4, 2
s_add_u32 s78, s6, s7
s_and_b32 s82, s5, 1
s_lshr_b32 s83, s5, 1
s_lshl_b32 s6, s3, 4
s_lshr_b32 s7, s4, 1
s_add_u32 s6, s6, s7
s_mul_i32 s6, s6, 5
s_and_b32 s89, s4, 1
s_lshl_b32 s7, s89, 1
s_add_u32 s88, s6, s7
s_and_b32 s6, s3, 3
s_lshl_b32 s6, s6, 3
s_and_b32 s7, s4, 7
s_add_u32 s94, s6, s7
s_lshr_b32 s6, s3, 2
s_xor_b32 s6, s6, 1
s_lshl_b32 s6, s6, 2
s_lshr_b32 s7, s4, 3
s_add_u32 s95, s6, s7
s_mul_i32 s96, s5, 14
s_cmp_eq_u32 s5, 3
s_cselect_b32 s6, 1, 0
s_sub_u32 s96, s96, s6
s_lshr_b32 s6, s4, 3
s_lshl_b32 s7, s3, 2
s_add_u32 s68, s6, s7
s_and_b32 s69, s4, 7
v_mul_u32_u24 v2, 26, v1
v_lshrrev_b32 v2, 8, v2
v_mul_u32_u24 v3, 10, v2
v_sub_u32 v3, v1, v3
s_lshl_b32 s6, s68, 6
s_lshl_b32 s7, s5, 4
s_add_u32 s6, s6, s7
s_mul_i32 s6, s6, 1280
s_mul_i32 s7, s69, 160
s_add_u32 s6, s6, s7
v_mul_u32_u24 v4, 5120, v2
v_lshl_add_u32 v4, v3, 4, v4
v_add_u32 v244, s6, v4
v_subrev_u32 v245, 3840, v244
s_mul_i32 s92, s69, 640
s_mul_i32 s7, s5, 2560
s_add_u32 s7, s7, 142592
s_mov_b32 m0, s7
v_lshl_add_u32 v247, v3, 6, s7
s_lshl_b32 s7, s5, 5
s_sub_u32 s7, 131192, s7
v_mul_u32_u24 v4, 1152, v3
v_lshlrev_b32 v2, 3, v2
v_sub_u32 v4, v4, v2
v_add_u32 v202, s7, v4
v_lshrrev_b32 v2, 3, v1
s_mul_i32 s6, s5, 20
v_add_u32 v2, s6, v2
v_and_b32 v3, 7, v1
v_lshlrev_b32 v3, 4, v3
v_mul_u32_u24 v4, 144, v2
v_add_u32 v4, v4, v3
v_add_u32 v203, 131072, v4
v_lshl_add_u32 v172, v2, 12, v3
s_mul_i32 s6, s69, 327680
s_lshl_b32 s7, s68, 7
s_sub_u32 s6, s6, s7
s_add_u32 s70, s6, 1052544
s_add_u32 s71, s70, 32768
s_add_u32 s72, s70, 65536
s_lshl_b32 s6, s73, 6
s_lshl_b32 s7, s5, 4
s_add_u32 s6, s6, s7
s_mul_i32 s75, s6, 1280
s_lshl_b32 s6, s73, 2
s_add_u32 s6, s6, s5
s_mul_i32 s76, s6, 20480
v_lshlrev_b32 v233, 7, v1
s_lshl_b32 s6, s73, 6
s_lshl_b32 s7, s5, 4
s_add_u32 s74, s6, s7
v_and_b32 v2, 15, v1
v_lshrrev_b32 v3, 4, v1
v_add_u32 v4, s74, v2
v_mul_u32_u24 v4, 1280, v4
v_lshl_add_u32 v211, v3, 4, v4
s_waitcnt lgkmcnt(0)
s_mov_b32 s24, s66
s_and_b32 s25, s67, 0xffff
s_mov_b32 s26, 17825792
s_mov_b32 s27, 0x20000
s_lshl_b32 s6, s88, 1
s_and_b32 s6, s6, 0xfffffffc
s_load_dwordx2 s[0:1], s[50:51], s6
s_cmp_lg_u32 s5, 0
s_cbranch_scc1 L_clr_47
v_lshl_add_u32 v2, v1, 2, v252
v_mov_b32 v3, 0
s_mov_b64 exec, 0xff
buffer_store_dword v3, v2, s[24:27], 0 offen sc1
s_mov_b64 exec, -1
L_clr_47:
s_mov_b32 s12, s42
s_and_b32 s13, s43, 0xffff
s_mov_b32 s14, 2621440
s_mov_b32 s15, 0x20000
s_mov_b32 s16, s44
s_and_b32 s17, s45, 0xffff
s_mov_b32 s18, 2621440
s_mov_b32 s19, 0x20000
s_mov_b32 s32, s46
s_and_b32 s33, s47, 0xffff
s_mov_b32 s34, 5120
s_mov_b32 s35, 0x20000
s_mov_b32 s8, s40
s_and_b32 s9, s41, 0xffff
s_mov_b32 s10, 2621440
s_mov_b32 s11, 0x20000
s_mov_b32 s28, s62
s_and_b32 s29, s63, 0xffff
s_mov_b32 s30, 2621440
s_mov_b32 s31, 0x20000
s_mov_b32 s52, s64
s_and_b32 s53, s65, 0xffff
s_mov_b32 s54, 256
s_mov_b32 s55, 0x20000
s_mov_b32 s42, 0
buffer_load_dwordx4 a[0:3], v211, s[8:11], 0 offen offset:0
buffer_load_dwordx4 a[4:7], v211, s[8:11], 0 offen offset:64
buffer_load_dwordx4 a[8:11], v211, s[8:11], 0 offen offset:128
buffer_load_dwordx4 a[12:15], v211, s[8:11], 0 offen offset:192
s_waitcnt vmcnt(4)
s_cmp_lg_u32 s5, 0
s_cbranch_scc1 L_arr_48
s_and_b32 s6, s2, 7
s_lshl_b32 s6, s6, 5
v_mov_b32 v2, s6
s_mov_b64 exec, 1
buffer_atomic_add v253, v2, s[52:55], 0 offen sc1
s_mov_b64 exec, -1
L_arr_48:
buffer_load_dwordx4 a[16:19], v211, s[8:11], 0 offen offset:256
buffer_load_dwordx4 a[20:23], v211, s[8:11], 0 offen offset:320
buffer_load_dwordx4 a[24:27], v211, s[8:11], 0 offen offset:384
buffer_load_dwordx4 a[28:31], v211, s[8:11], 0 offen offset:448
buffer_load_dwordx4 a[32:35], v211, s[8:11], 0 offen offset:512
buffer_load_dwordx4 a[36:39], v211, s[8:11], 0 offen offset:576
buffer_load_dwordx4 a[40:43], v211, s[8:11], 0 offen offset:640
buffer_load_dwordx4 a[44:47], v211, s[8:11], 0 offen offset:704
buffer_load_dwordx4 a[48:51], v211, s[8:11], 0 offen offset:768
buffer_load_dwordx4 a[52:55], v211, s[8:11], 0 offen offset:832
buffer_load_dwordx4 a[56:59], v211, s[8:11], 0 offen offset:896
buffer_load_dwordx4 a[60:63], v211, s[8:11], 0 offen offset:960
buffer_load_dwordx4 a[64:67], v211, s[8:11], 0 offen offset:1024
buffer_load_dwordx4 a[68:71], v211, s[8:11], 0 offen offset:1088
buffer_load_dwordx4 a[72:75], v211, s[8:11], 0 offen offset:1152
buffer_load_dwordx4 a[76:79], v211, s[8:11], 0 offen offset:1216
v_and_b32 v2, 15, v1
v_min_u32 v2, 13, v2
v_add_u32 v2, s96, v2
v_min_u32 v2, 53, v2
v_lshlrev_b32 v2, 2, v2
s_lshr_b32 s43, s95, 1
v_add_u32 v2, s43, v2
v_lshlrev_b32 v2, 7, v2
v_add_u32 v228, 12, v2
s_lshl_b32 s6, s77, 1
v_and_b32 v4, 1, v1
v_add_u32 v4, s6, v4
v_and_b32 v5, 3, v4
v_add_u32 v5, 28, v5
s_lshr_b32 s6, s77, 2
s_and_b32 s7, s77, 2
s_lshl_b32 s7, s7, 1
s_add_u32 s6, s6, s7
v_mov_b32 v4, s6
v_lshl_add_u32 v4, v5, 3, v4
v_lshlrev_b32 v4, 7, v4
v_add_u32 v231, 4, v4
v_and_b32 v2, 31, v1
v_and_b32 v3, 7, v2
v_lshrrev_b32 v2, 3, v2
v_lshlrev_b32 v2, 3, v2
v_add_u32 v2, s3, v2
v_lshl_add_u32 v2, v2, 3, v3
v_lshlrev_b32 v229, 7, v2
v_cmp_gt_u32 vcc, 14, v1
v_cndmask_b32 v2, 0, v1, vcc
v_cmp_lt_u32 vcc, 6, v2
v_cndmask_b32 v3, 0, 1, vcc
v_mul_u32_u24 v4, 7, v3
v_sub_u32 v2, v2, v4
s_lshr_b32 s6, s94, 1
s_and_b32 s7, s6, 3
s_lshr_b32 s6, s6, 2
v_lshlrev_b32 v3, 2, v3
v_lshlrev_b32 v2, 2, v2
v_add_u32 v2, s7, v2
v_add_u32 v3, s6, v3
v_lshl_add_u32 v2, v2, 3, v3
v_lshlrev_b32 v2, 7, v2
v_add_u32 v249, 16, v2
v_and_b32 v2, 31, v1
v_lshlrev_b32 v2, 3, v2
v_add_u32 v2, s95, v2
v_lshlrev_b32 v2, 7, v2
v_add_u32 v250, 20, v2
v_mov_b32 v2, 2147418112
s_cmp_lg_u32 s5, 0
s_cselect_b64 vcc, -1, 0
v_cndmask_b32 v231, v231, v2, vcc
v_cndmask_b32 v230, v230, v2, vcc
v_mov_b32 v214, 0x3f803f80
v_mov_b32 v215, 0x3f803f80
v_mov_b32 v216, 0x3f803f80
v_mov_b32 v217, 0x3f803f80
v_mov_b32 v218, 0
v_mov_b32 v219, 0
v_mov_b32 v220, 0
v_mov_b32 v221, 0
v_mov_b32 v222, 0
v_mov_b32 v223, 0
v_mov_b32 v224, 0
v_mov_b32 v225, 0
s_waitcnt vmcnt(19)
v_mfma_f32_16x16x32_bf16 v[218:221], a[0:3], a[0:3], v[218:221]
v_mfma_f32_16x16x32_bf16 v[222:225], a[0:3], v[214:217], v[222:225]
s_waitcnt vmcnt(18)
v_mfma_f32_16x16x32_bf16 v[218:221], a[4:7], a[4:7], v[218:221]
v_mfma_f32_16x16x32_bf16 v[222:225], a[4:7], v[214:217], v[222:225]
s_waitcnt vmcnt(17)
v_mfma_f32_16x16x32_bf16 v[218:221], a[8:11], a[8:11], v[218:221]
v_mfma_f32_16x16x32_bf16 v[222:225], a[8:11], v[214:217], v[222:225]
s_waitcnt vmcnt(16)
v_mfma_f32_16x16x32_bf16 v[218:221], a[12:15], a[12:15], v[218:221]
v_mfma_f32_16x16x32_bf16 v[222:225], a[12:15], v[214:217], v[222:225]
s_waitcnt vmcnt(15)
v_mfma_f32_16x16x32_bf16 v[218:221], a[16:19], a[16:19], v[218:221]
v_mfma_f32_16x16x32_bf16 v[222:225], a[16:19], v[214:217], v[222:225]
s_waitcnt vmcnt(14)
v_mfma_f32_16x16x32_bf16 v[218:221], a[20:23], a[20:23], v[218:221]
v_mfma_f32_16x16x32_bf16 v[222:225], a[20:23], v[214:217], v[222:225]
s_waitcnt vmcnt(13)
v_mfma_f32_16x16x32_bf16 v[218:221], a[24:27], a[24:27], v[218:221]
v_mfma_f32_16x16x32_bf16 v[222:225], a[24:27], v[214:217], v[222:225]
s_waitcnt vmcnt(12)
v_mfma_f32_16x16x32_bf16 v[218:221], a[28:31], a[28:31], v[218:221]
v_mfma_f32_16x16x32_bf16 v[222:225], a[28:31], v[214:217], v[222:225]
s_waitcnt vmcnt(11)
v_mfma_f32_16x16x32_bf16 v[218:221], a[32:35], a[32:35], v[218:221]
v_mfma_f32_16x16x32_bf16 v[222:225], a[32:35], v[214:217], v[222:225]
s_waitcnt vmcnt(10)
v_mfma_f32_16x16x32_bf16 v[218:221], a[36:39], a[36:39], v[218:221]
v_mfma_f32_16x16x32_bf16 v[222:225], a[36:39], v[214:217], v[222:225]
s_waitcnt vmcnt(9)
v_mfma_f32_16x16x32_bf16 v[218:221], a[40:43], a[40:43], v[218:221]
v_mfma_f32_16x16x32_bf16 v[222:225], a[40:43], v[214:217], v[222:225]
s_waitcnt vmcnt(8)
v_mfma_f32_16x16x32_bf16 v[218:221], a[44:47], a[44:47], v[218:221]
v_mfma_f32_16x16x32_bf16 v[222:225], a[44:47], v[214:217], v[222:225]
s_waitcnt vmcnt(7)
v_mfma_f32_16x16x32_bf16 v[218:221], a[48:51], a[48:51], v[218:221]
v_mfma_f32_16x16x32_bf16 v[222:225], a[48:51], v[214:217], v[222:225]
s_waitcnt vmcnt(6)
v_mfma_f32_16x16x32_bf16 v[218:221], a[52:55], a[52:55], v[218:221]
v_mfma_f32_16x16x32_bf16 v[222:225], a[52:55], v[214:217], v[222:225]
s_waitcnt vmcnt(5)
v_mfma_f32_16x16x32_bf16 v[218:221], a[56:59], a[56:59], v[218:221]
v_mfma_f32_16x16x32_bf16 v[222:225], a[56:59], v[214:217], v[222:225]
s_waitcnt vmcnt(4)
v_mfma_f32_16x16x32_bf16 v[218:221], a[60:63], a[60:63], v[218:221]
v_mfma_f32_16x16x32_bf16 v[222:225], a[60:63], v[214:217], v[222:225]
s_waitcnt vmcnt(3)
v_mfma_f32_16x16x32_bf16 v[218:221], a[64:67], a[64:67], v[218:221]
v_mfma_f32_16x16x32_bf16 v[222:225], a[64:67], v[214:217], v[222:225]
s_waitcnt vmcnt(2)
v_mfma_f32_16x16x32_bf16 v[218:221], a[68:71], a[68:71], v[218:221]
v_mfma_f32_16x16x32_bf16 v[222:225], a[68:71], v[214:217], v[222:225]
s_waitcnt vmcnt(1)
v_mfma_f32_16x16x32_bf16 v[218:221], a[72:75], a[72:75], v[218:221]
v_mfma_f32_16x16x32_bf16 v[222:225], a[72:75], v[214:217], v[222:225]
s_waitcnt vmcnt(0)
v_mfma_f32_16x16x32_bf16 v[218:221], a[76:79], a[76:79], v[218:221]
v_mfma_f32_16x16x32_bf16 v[222:225], a[76:79], v[214:217], v[222:225]
v_and_b32 v5, 1, v1
v_cmp_eq_u32 vcc, 1, v5
v_and_b32 v5, 2, v1
v_cmp_eq_u32 s[6:7], 2, v5
s_nop 7
v_cndmask_b32 v2, v218, v219, vcc
v_cndmask_b32 v3, v220, v221, vcc
v_cndmask_b32 v4, v222, v223, vcc
v_cndmask_b32 v5, v224, v225, vcc
v_cndmask_b32 v2, v2, v3, s[6:7]
v_cndmask_b32 v3, v4, v5, s[6:7]
v_mul_f32 v214, 0.0015625, v3
v_mul_f32 v2, 0.0015625, v2
v_fma_f32 v2, -v214, v214, v2
v_max_f32 v2, 0, v2
v_add_f32 v2, 0x3727c5ac, v2
v_sqrt_f32 v216, v2
s_nop 0
v_rcp_f32 v215, v216
v_mov_b32 v217, 0
v_sub_f32 v3, 0, v214
v_cvt_pk_bf16_f32 v4, v216, v3
v_lshlrev_b32 v5, 16, v4
v_and_b32 v6, 0xffff0000, v4
v_sub_f32 v5, v216, v5
v_sub_f32 v6, v3, v6
v_cvt_pk_bf16_f32 v5, v5, v6
s_mov_b32 s6, 0x05040100
s_mov_b32 s7, 0x07060302
v_perm_b32 v218, v5, v4, s6
v_perm_b32 v219, v5, v4, s7
v_mov_b32 v220, v219
v_mov_b32 v221, 0
v_lshrrev_b32 v3, 4, v1
v_and_b32 v5, 3, v1
v_lshl_add_u32 v5, v3, 2, v5
v_add_u32 v5, s74, v5
v_lshlrev_b32 v5, 4, v5
s_mov_b32 s6, 65536
s_mov_b32 s7, 98304
s_mov_b32 exec_lo, 0x00f0000f
s_mov_b32 exec_hi, 0xf0000f00
buffer_store_dwordx4 v[218:221], v5, s[24:27], s6 offen sc1
buffer_store_dwordx4 v[214:217], v5, s[24:27], s7 offen sc1
s_mov_b64 exec, -1
buffer_load_dword v254, v230, s[52:55], 0 offen sc1
s_mov_b32 exec_hi, 0xff
buffer_load_dwordx4 v[8:11], v245, s[12:15], 0 offen offset:0
buffer_load_dwordx4 v[12:15], v245, s[12:15], 0 offen offset:1280
buffer_load_dwordx4 v[16:19], v245, s[12:15], 0 offen offset:2560
buffer_load_dwordx4 v[20:23], v244, s[12:15], 0 offen offset:0
buffer_load_dwordx4 v[24:27], v244, s[12:15], 0 offen offset:1280
buffer_load_dwordx4 v[28:31], v244, s[12:15], 0 offen offset:2560
buffer_load_dwordx4 v[32:35], v244, s[12:15], 0 offen offset:3840
buffer_load_dwordx4 v248, s[32:35], s92 offen lds
buffer_load_dwordx4 v[174:177], v244, s[16:19], 0 offen offset:0
buffer_load_dwordx4 v[178:181], v244, s[16:19], 0 offen offset:1280
buffer_load_dwordx4 v[182:185], v244, s[16:19], 0 offen offset:2560
buffer_load_dwordx4 v[186:189], v244, s[16:19], 0 offen offset:3840
s_mov_b64 exec, -1
s_mov_b32 s36, s58
s_and_b32 s37, s59, 0xffff
s_mov_b32 s38, 2211840
s_mov_b32 s39, 0x20000
s_sub_u32 s6, s4, 28
s_lshl_b32 s6, s6, 2
s_add_u32 s6, s6, s5
s_mul_i32 s79, s6, 162
s_lshr_b32 s6, s3, 2
s_lshl_b32 s80, s6, 5
s_and_b32 s7, s3, 3
s_mul_i32 s7, s7, 320
s_and_b32 s81, s7, 0xffffff80
v_add_u32 v2, s79, v1
v_add_u32 v2, 0, v2
v_mul_u32_u24 v3, 2731, v2
v_lshrrev_b32 v3, 18, v3
v_mul_u32_u24 v4, 96, v3
v_sub_u32 v4, v2, v4
v_mul_u32_u24 v5, 86, v4
v_lshrrev_b32 v5, 8, v5
v_mul_u32_u24 v6, 3, v5
v_sub_u32 v6, v4, v6
v_lshlrev_b32 v3, 6, v3
v_add_u32 v3, v3, v5
v_add_u32 v3, s80, v3
v_mul_u32_u24 v3, 1280, v3
v_lshl_add_u32 v3, v6, 7, v3
v_add_u32 v128, s81, v3
v_add_u32 v2, s79, v1
v_add_u32 v2, 64, v2
v_mul_u32_u24 v3, 2731, v2
v_lshrrev_b32 v3, 18, v3
v_mul_u32_u24 v4, 96, v3
v_sub_u32 v4, v2, v4
v_mul_u32_u24 v5, 86, v4
v_lshrrev_b32 v5, 8, v5
v_mul_u32_u24 v6, 3, v5
v_sub_u32 v6, v4, v6
v_lshlrev_b32 v3, 6, v3
v_add_u32 v3, v3, v5
v_add_u32 v3, s80, v3
v_mul_u32_u24 v3, 1280, v3
v_lshl_add_u32 v3, v6, 7, v3
v_add_u32 v129, s81, v3
v_add_u32 v2, s79, v1
v_add_u32 v2, 128, v2
v_mul_u32_u24 v3, 2731, v2
v_lshrrev_b32 v3, 18, v3
v_mul_u32_u24 v4, 96, v3
v_sub_u32 v4, v2, v4
v_mul_u32_u24 v5, 86, v4
v_lshrrev_b32 v5, 8, v5
v_mul_u32_u24 v6, 3, v5
v_sub_u32 v6, v4, v6
v_lshlrev_b32 v3, 6, v3
v_add_u32 v3, v3, v5
v_add_u32 v3, s80, v3
v_mul_u32_u24 v3, 1280, v3
v_lshl_add_u32 v3, v6, 7, v3
v_add_u32 v130, s81, v3
buffer_load_dword v234, v128, s[36:39], 0 offen
buffer_load_dword v234, v129, s[36:39], 0 offen
s_mov_b32 exec_lo, 0xffffffff
s_mov_b32 exec_hi, 0x3
buffer_load_dword v234, v130, s[36:39], 0 offen
s_mov_b64 exec, -1
s_waitcnt vmcnt(16)
s_barrier
s_cmp_lg_u32 s5, 0
s_cbranch_scc1 L_fl_49
s_mov_b64 exec, 1
buffer_store_dword v253, v252, s[24:27], 0 offen offset:4 sc1
s_mov_b64 exec, -1
L_fl_49:
s_waitcnt vmcnt(15)
s_cmp_lg_u32 s5, 0
s_cbranch_scc1 L_back_51
v_cmp_gt_u32 vcc, 32, v254
s_cbranch_vccnz L_slow_50
L_back_51:
s_waitcnt vmcnt(3)
ds_read_b128 v[36:39], v247 offset:0
ds_read_b128 v[40:43], v247 offset:16
ds_read_b128 v[44:47], v247 offset:32
ds_read_b128 v[48:51], v247 offset:48
v_lshlrev_b32 v194, 16, v8
v_and_b32 v195, 0xffff0000, v8
v_lshlrev_b32 v196, 16, v12
v_and_b32 v197, 0xffff0000, v12
v_lshlrev_b32 v198, 16, v16
v_and_b32 v199, 0xffff0000, v16
v_lshlrev_b32 v236, 16, v20
v_and_b32 v237, 0xffff0000, v20
v_lshlrev_b32 v238, 16, v24
v_and_b32 v239, 0xffff0000, v24
v_lshlrev_b32 v240, 16, v28
v_and_b32 v241, 0xffff0000, v28
v_lshlrev_b32 v242, 16, v32
v_and_b32 v243, 0xffff0000, v32
s_waitcnt lgkmcnt(0)
v_lshlrev_b32 v52, 16, v36
v_lshlrev_b32 v53, 16, v38
v_and_b32 v54, 0xffff0000, v36
v_and_b32 v55, 0xffff0000, v38
v_lshlrev_b32 v56, 16, v37
v_lshlrev_b32 v57, 16, v39
v_and_b32 v58, 0xffff0000, v37
v_and_b32 v59, 0xffff0000, v39
v_pk_mul_f32 v[60:61], v[236:237], v[52:53]
v_pk_mul_f32 v[62:63], v[238:239], v[52:53]
v_pk_mul_f32 v[190:191], v[240:241], v[52:53]
v_pk_mul_f32 v[192:193], v[242:243], v[52:53]
v_pk_fma_f32 v[60:61], v[198:199], v[54:55], v[60:61]
v_pk_fma_f32 v[62:63], v[236:237], v[54:55], v[62:63]
v_pk_fma_f32 v[190:191], v[238:239], v[54:55], v[190:191]
v_pk_fma_f32 v[192:193], v[240:241], v[54:55], v[192:193]
v_pk_fma_f32 v[60:61], v[196:197], v[56:57], v[60:61]
v_pk_fma_f32 v[62:63], v[198:199], v[56:57], v[62:63]
v_pk_fma_f32 v[190:191], v[236:237], v[56:57], v[190:191]
v_pk_fma_f32 v[192:193], v[238:239], v[56:57], v[192:193]
v_pk_fma_f32 v[60:61], v[194:195], v[58:59], v[60:61]
v_pk_fma_f32 v[62:63], v[196:197], v[58:59], v[62:63]
v_pk_fma_f32 v[190:191], v[198:199], v[58:59], v[190:191]
v_pk_fma_f32 v[192:193], v[236:237], v[58:59], v[192:193]
v_lshlrev_b32 v194, 16, v174
v_and_b32 v195, 0xffff0000, v174
v_lshlrev_b32 v196, 16, v178
v_and_b32 v197, 0xffff0000, v178
v_lshlrev_b32 v198, 16, v182
v_and_b32 v199, 0xffff0000, v182
v_lshlrev_b32 v236, 16, v186
v_and_b32 v237, 0xffff0000, v186
v_pk_mul_f32 v[60:61], v[60:61], v[194:195]
v_pk_mul_f32 v[62:63], v[62:63], v[196:197]
v_pk_mul_f32 v[190:191], v[190:191], v[198:199]
v_pk_mul_f32 v[192:193], v[192:193], v[236:237]
s_mov_b32 exec_hi, 0xff
v_cvt_pk_bf16_f32 v238, v192, v190
v_cvt_pk_bf16_f32 v239, v62, v60
ds_write_b64 v202, v[238:239] offset:0
v_cvt_pk_bf16_f32 v240, v193, v191
v_cvt_pk_bf16_f32 v241, v63, v61
ds_write_b64 v202, v[240:241] offset:144
s_mov_b64 exec, -1
v_lshlrev_b32 v194, 16, v9
v_and_b32 v195, 0xffff0000, v9
v_lshlrev_b32 v196, 16, v13
v_and_b32 v197, 0xffff0000, v13
v_lshlrev_b32 v198, 16, v17
v_and_b32 v199, 0xffff0000, v17
v_lshlrev_b32 v236, 16, v21
v_and_b32 v237, 0xffff0000, v21
v_lshlrev_b32 v238, 16, v25
v_and_b32 v239, 0xffff0000, v25
v_lshlrev_b32 v240, 16, v29
v_and_b32 v241, 0xffff0000, v29
v_lshlrev_b32 v242, 16, v33
v_and_b32 v243, 0xffff0000, v33
v_lshlrev_b32 v52, 16, v40
v_lshlrev_b32 v53, 16, v42
v_and_b32 v54, 0xffff0000, v40
v_and_b32 v55, 0xffff0000, v42
v_lshlrev_b32 v56, 16, v41
v_lshlrev_b32 v57, 16, v43
v_and_b32 v58, 0xffff0000, v41
v_and_b32 v59, 0xffff0000, v43
v_pk_mul_f32 v[60:61], v[236:237], v[52:53]
v_pk_mul_f32 v[62:63], v[238:239], v[52:53]
v_pk_mul_f32 v[190:191], v[240:241], v[52:53]
v_pk_mul_f32 v[192:193], v[242:243], v[52:53]
v_pk_fma_f32 v[60:61], v[198:199], v[54:55], v[60:61]
v_pk_fma_f32 v[62:63], v[236:237], v[54:55], v[62:63]
v_pk_fma_f32 v[190:191], v[238:239], v[54:55], v[190:191]
v_pk_fma_f32 v[192:193], v[240:241], v[54:55], v[192:193]
v_pk_fma_f32 v[60:61], v[196:197], v[56:57], v[60:61]
v_pk_fma_f32 v[62:63], v[198:199], v[56:57], v[62:63]
v_pk_fma_f32 v[190:191], v[236:237], v[56:57], v[190:191]
v_pk_fma_f32 v[192:193], v[238:239], v[56:57], v[192:193]
v_pk_fma_f32 v[60:61], v[194:195], v[58:59], v[60:61]
v_pk_fma_f32 v[62:63], v[196:197], v[58:59], v[62:63]
v_pk_fma_f32 v[190:191], v[198:199], v[58:59], v[190:191]
v_pk_fma_f32 v[192:193], v[236:237], v[58:59], v[192:193]
v_lshlrev_b32 v194, 16, v175
v_and_b32 v195, 0xffff0000, v175
v_lshlrev_b32 v196, 16, v179
v_and_b32 v197, 0xffff0000, v179
v_lshlrev_b32 v198, 16, v183
v_and_b32 v199, 0xffff0000, v183
v_lshlrev_b32 v236, 16, v187
v_and_b32 v237, 0xffff0000, v187
v_pk_mul_f32 v[60:61], v[60:61], v[194:195]
v_pk_mul_f32 v[62:63], v[62:63], v[196:197]
v_pk_mul_f32 v[190:191], v[190:191], v[198:199]
v_pk_mul_f32 v[192:193], v[192:193], v[236:237]
s_mov_b32 exec_hi, 0xff
v_cvt_pk_bf16_f32 v238, v192, v190
v_cvt_pk_bf16_f32 v239, v62, v60
ds_write_b64 v202, v[238:239] offset:288
v_cvt_pk_bf16_f32 v240, v193, v191
v_cvt_pk_bf16_f32 v241, v63, v61
ds_write_b64 v202, v[240:241] offset:432
s_mov_b64 exec, -1
v_lshlrev_b32 v194, 16, v10
v_and_b32 v195, 0xffff0000, v10
v_lshlrev_b32 v196, 16, v14
v_and_b32 v197, 0xffff0000, v14
v_lshlrev_b32 v198, 16, v18
v_and_b32 v199, 0xffff0000, v18
v_lshlrev_b32 v236, 16, v22
v_and_b32 v237, 0xffff0000, v22
v_lshlrev_b32 v238, 16, v26
v_and_b32 v239, 0xffff0000, v26
v_lshlrev_b32 v240, 16, v30
v_and_b32 v241, 0xffff0000, v30
v_lshlrev_b32 v242, 16, v34
v_and_b32 v243, 0xffff0000, v34
v_lshlrev_b32 v52, 16, v44
v_lshlrev_b32 v53, 16, v46
v_and_b32 v54, 0xffff0000, v44
v_and_b32 v55, 0xffff0000, v46
v_lshlrev_b32 v56, 16, v45
v_lshlrev_b32 v57, 16, v47
v_and_b32 v58, 0xffff0000, v45
v_and_b32 v59, 0xffff0000, v47
v_pk_mul_f32 v[60:61], v[236:237], v[52:53]
v_pk_mul_f32 v[62:63], v[238:239], v[52:53]
v_pk_mul_f32 v[190:191], v[240:241], v[52:53]
v_pk_mul_f32 v[192:193], v[242:243], v[52:53]
v_pk_fma_f32 v[60:61], v[198:199], v[54:55], v[60:61]
v_pk_fma_f32 v[62:63], v[236:237], v[54:55], v[62:63]
v_pk_fma_f32 v[190:191], v[238:239], v[54:55], v[190:191]
v_pk_fma_f32 v[192:193], v[240:241], v[54:55], v[192:193]
v_pk_fma_f32 v[60:61], v[196:197], v[56:57], v[60:61]
v_pk_fma_f32 v[62:63], v[198:199], v[56:57], v[62:63]
v_pk_fma_f32 v[190:191], v[236:237], v[56:57], v[190:191]
v_pk_fma_f32 v[192:193], v[238:239], v[56:57], v[192:193]
v_pk_fma_f32 v[60:61], v[194:195], v[58:59], v[60:61]
v_pk_fma_f32 v[62:63], v[196:197], v[58:59], v[62:63]
v_pk_fma_f32 v[190:191], v[198:199], v[58:59], v[190:191]
v_pk_fma_f32 v[192:193], v[236:237], v[58:59], v[192:193]
v_lshlrev_b32 v194, 16, v176
v_and_b32 v195, 0xffff0000, v176
v_lshlrev_b32 v196, 16, v180
v_and_b32 v197, 0xffff0000, v180
v_lshlrev_b32 v198, 16, v184
v_and_b32 v199, 0xffff0000, v184
v_lshlrev_b32 v236, 16, v188
v_and_b32 v237, 0xffff0000, v188
v_pk_mul_f32 v[60:61], v[60:61], v[194:195]
v_pk_mul_f32 v[62:63], v[62:63], v[196:197]
v_pk_mul_f32 v[190:191], v[190:191], v[198:199]
v_pk_mul_f32 v[192:193], v[192:193], v[236:237]
s_mov_b32 exec_hi, 0xff
v_cvt_pk_bf16_f32 v238, v192, v190
v_cvt_pk_bf16_f32 v239, v62, v60
ds_write_b64 v202, v[238:239] offset:576
v_cvt_pk_bf16_f32 v240, v193, v191
v_cvt_pk_bf16_f32 v241, v63, v61
ds_write_b64 v202, v[240:241] offset:720
s_mov_b64 exec, -1
v_lshlrev_b32 v194, 16, v11
v_and_b32 v195, 0xffff0000, v11
v_lshlrev_b32 v196, 16, v15
v_and_b32 v197, 0xffff0000, v15
v_lshlrev_b32 v198, 16, v19
v_and_b32 v199, 0xffff0000, v19
v_lshlrev_b32 v236, 16, v23
v_and_b32 v237, 0xffff0000, v23
v_lshlrev_b32 v238, 16, v27
v_and_b32 v239, 0xffff0000, v27
v_lshlrev_b32 v240, 16, v31
v_and_b32 v241, 0xffff0000, v31
v_lshlrev_b32 v242, 16, v35
v_and_b32 v243, 0xffff0000, v35
v_lshlrev_b32 v52, 16, v48
v_lshlrev_b32 v53, 16, v50
v_and_b32 v54, 0xffff0000, v48
v_and_b32 v55, 0xffff0000, v50
v_lshlrev_b32 v56, 16, v49
v_lshlrev_b32 v57, 16, v51
v_and_b32 v58, 0xffff0000, v49
v_and_b32 v59, 0xffff0000, v51
v_pk_mul_f32 v[60:61], v[236:237], v[52:53]
v_pk_mul_f32 v[62:63], v[238:239], v[52:53]
v_pk_mul_f32 v[190:191], v[240:241], v[52:53]
v_pk_mul_f32 v[192:193], v[242:243], v[52:53]
v_pk_fma_f32 v[60:61], v[198:199], v[54:55], v[60:61]
v_pk_fma_f32 v[62:63], v[236:237], v[54:55], v[62:63]
v_pk_fma_f32 v[190:191], v[238:239], v[54:55], v[190:191]
v_pk_fma_f32 v[192:193], v[240:241], v[54:55], v[192:193]
v_pk_fma_f32 v[60:61], v[196:197], v[56:57], v[60:61]
v_pk_fma_f32 v[62:63], v[198:199], v[56:57], v[62:63]
v_pk_fma_f32 v[190:191], v[236:237], v[56:57], v[190:191]
v_pk_fma_f32 v[192:193], v[238:239], v[56:57], v[192:193]
v_pk_fma_f32 v[60:61], v[194:195], v[58:59], v[60:61]
v_pk_fma_f32 v[62:63], v[196:197], v[58:59], v[62:63]
v_pk_fma_f32 v[190:191], v[198:199], v[58:59], v[190:191]
v_pk_fma_f32 v[192:193], v[236:237], v[58:59], v[192:193]
v_lshlrev_b32 v194, 16, v177
v_and_b32 v195, 0xffff0000, v177
v_lshlrev_b32 v196, 16, v181
v_and_b32 v197, 0xffff0000, v181
v_lshlrev_b32 v198, 16, v185
v_and_b32 v199, 0xffff0000, v185
v_lshlrev_b32 v236, 16, v189
v_and_b32 v237, 0xffff0000, v189
v_pk_mul_f32 v[60:61], v[60:61], v[194:195]
v_pk_mul_f32 v[62:63], v[62:63], v[196:197]
v_pk_mul_f32 v[190:191], v[190:191], v[198:199]
v_pk_mul_f32 v[192:193], v[192:193], v[236:237]
s_mov_b32 exec_hi, 0xff
v_cvt_pk_bf16_f32 v238, v192, v190
v_cvt_pk_bf16_f32 v239, v62, v60
ds_write_b64 v202, v[238:239] offset:864
v_cvt_pk_bf16_f32 v240, v193, v191
v_cvt_pk_bf16_f32 v241, v63, v61
ds_write_b64 v202, v[240:241] offset:1008
s_mov_b64 exec, -1
s_waitcnt lgkmcnt(0)
s_barrier
ds_read_b128 v[8:11], v203 offset:0
ds_read_b128 v[12:15], v203 offset:1152
ds_read_b128 v[16:19], v203 offset:2304
s_waitcnt lgkmcnt(0)
buffer_store_dwordx4 v[8:11], v172, s[24:27], s70 offen sc1
buffer_store_dwordx4 v[12:15], v172, s[24:27], s71 offen sc1
s_mov_b32 exec_hi, 0
buffer_store_dwordx4 v[16:19], v172, s[24:27], s72 offen sc1
s_mov_b64 exec, -1
buffer_load_dword v254, v229, s[24:27], 0 offen sc1
s_waitcnt vmcnt(1)
s_barrier
s_cmp_lg_u32 s5, 0
s_cbranch_scc1 L_fl_52
s_mov_b64 exec, 1
buffer_store_dword v253, v252, s[24:27], 0 offen offset:0 sc1
s_mov_b64 exec, -1
L_fl_52:
s_waitcnt vmcnt(0)
v_cmp_eq_u32 vcc, 0, v254
s_cbranch_vccnz L_slow_53
L_back_54:
v_mov_b32 v60, 2147418112
s_mov_b32 s100, 0
s_mov_b32 s101, 0
s_lshl_b32 s6, s5, 2
v_lshlrev_b32 v202, 2, v1
v_add_u32 v202, s6, v202
v_subrev_u32 v202, 252, v202
v_add_u32 v203, s6, v248
v_add_u32 v203, 4, v203
s_mul_i32 s90, s5, 4416
s_add_u32 s6, s88, 0
s_lshl_b32 s6, s6, 12
s_add_u32 s32, s48, s6
s_addc_u32 s33, s49, 0
s_and_b32 s33, s33, 0xffff
s_mov_b32 s34, 4096
s_mov_b32 s35, 0x20000
s_add_u32 m0, s90, 65536
s_nop 0
buffer_load_dword v202, s[32:35], 0 offen lds
s_add_u32 m0, s90, 65792
s_nop 0
buffer_load_dwordx4 v203, s[32:35], 0 offen offset:0 lds
buffer_load_dwordx4 v203, s[32:35], 0 offen offset:1024 lds
buffer_load_dwordx4 v203, s[32:35], 0 offen offset:2048 lds
buffer_load_dwordx4 v203, s[32:35], 0 offen offset:3072 lds
s_add_u32 s6, s88, 1
s_lshl_b32 s6, s6, 12
s_add_u32 s32, s48, s6
s_addc_u32 s33, s49, 0
s_and_b32 s33, s33, 0xffff
s_mov_b32 s34, 4096
s_mov_b32 s35, 0x20000
s_add_u32 m0, s90, 95744
s_nop 0
buffer_load_dword v202, s[32:35], 0 offen lds
s_add_u32 m0, s90, 96000
s_nop 0
buffer_load_dwordx4 v203, s[32:35], 0 offen offset:0 lds
buffer_load_dwordx4 v203, s[32:35], 0 offen offset:1024 lds
buffer_load_dwordx4 v203, s[32:35], 0 offen offset:2048 lds
buffer_load_dwordx4 v203, s[32:35], 0 offen offset:3072 lds
s_add_u32 s6, s88, 2
s_lshl_b32 s6, s6, 12
s_add_u32 s32, s48, s6
s_addc_u32 s33, s49, 0
s_and_b32 s33, s33, 0xffff
s_mov_b32 s34, 4096
s_mov_b32 s35, 0x20000
s_add_u32 m0, s90, 125952
s_nop 0
buffer_load_dword v202, s[32:35], 0 offen lds
s_add_u32 m0, s90, 126208
s_nop 0
buffer_load_dwordx4 v203, s[32:35], 0 offen offset:0 lds
buffer_load_dwordx4 v203, s[32:35], 0 offen offset:1024 lds
buffer_load_dwordx4 v203, s[32:35], 0 offen offset:2048 lds
buffer_load_dwordx4 v203, s[32:35], 0 offen offset:3072 lds
v_lshlrev_b32 v4, 4, v0
s_add_u32 s6, s88, 0
s_lshl_b32 s6, s6, 12
s_add_u32 s6, s6, 1048576
s_add_u32 s36, s66, s6
s_addc_u32 s37, s67, 0
s_and_b32 s37, s37, 0xffff
s_mov_b32 s38, 4096
s_mov_b32 s39, 0x20000
buffer_load_dwordx4 v[32:35], v4, s[36:39], 0 offen
buffer_load_dword v36, v4, s[36:39], 0 offen offset:16
s_add_u32 s6, s88, 1
s_lshl_b32 s6, s6, 12
s_add_u32 s6, s6, 1048576
s_add_u32 s36, s66, s6
s_addc_u32 s37, s67, 0
s_and_b32 s37, s37, 0xffff
s_mov_b32 s38, 4096
s_mov_b32 s39, 0x20000
buffer_load_dwordx4 v[38:41], v4, s[36:39], 0 offen
buffer_load_dword v42, v4, s[36:39], 0 offen offset:16
s_add_u32 s6, s88, 2
s_lshl_b32 s6, s6, 12
s_add_u32 s6, s6, 1048576
s_add_u32 s36, s66, s6
s_addc_u32 s37, s67, 0
s_and_b32 s37, s37, 0xffff
s_mov_b32 s38, 4096
s_mov_b32 s39, 0x20000
buffer_load_dwordx4 v[44:47], v4, s[36:39], 0 offen
buffer_load_dword v48, v4, s[36:39], 0 offen offset:16
buffer_load_dword v254, v228, s[24:27], 0 offen sc1
v_lshlrev_b32 v5, 4, v0
v_add_u32 v5, 87552, v5
v_add_u32 v7, 60416, v5
v_mov_b32 v12, 0
v_mov_b32 v13, 0
v_mov_b32 v14, 0
v_mov_b32 v15, 0
v_cmp_gt_u32 vcc, 119, v0
s_and_saveexec_b64 s[6:7], vcc
ds_write_b128 v5, v[12:15] offset:0
ds_write_b128 v5, v[12:15] offset:6272
ds_write_b128 v5, v[12:15] offset:30208
ds_write_b128 v5, v[12:15] offset:36480
ds_write_b128 v7, v[12:15] offset:0
ds_write_b128 v7, v[12:15] offset:6272
s_mov_b64 exec, s[6:7]
v_lshrrev_b32 v4, 4, v0
v_mul_u32_u24 v4, 272, v4
v_and_b32 v5, 15, v0
v_lshl_add_u32 v4, v5, 4, v4
v_add_u32 v4, 83200, v4
v_add_u32 v6, 60416, v4
s_waitcnt vmcnt(1)
ds_write_b128 v4, v[32:35] offset:6272
v_alignbit_b32 v12, v33, v32, 16
v_alignbit_b32 v13, v34, v33, 16
v_alignbit_b32 v14, v35, v34, 16
v_alignbit_b32 v15, v36, v35, 16
ds_write_b128 v4, v[12:15] offset:0
ds_write_b128 v4, v[38:41] offset:36480
v_alignbit_b32 v12, v39, v38, 16
v_alignbit_b32 v13, v40, v39, 16
v_alignbit_b32 v14, v41, v40, 16
v_alignbit_b32 v15, v42, v41, 16
ds_write_b128 v4, v[12:15] offset:30208
ds_write_b128 v6, v[44:47] offset:6272
v_alignbit_b32 v12, v45, v44, 16
v_alignbit_b32 v13, v46, v45, 16
v_alignbit_b32 v14, v47, v46, 16
v_alignbit_b32 v15, v48, v47, 16
ds_write_b128 v6, v[12:15] offset:0
s_waitcnt vmcnt(0)
v_cmp_eq_u32 vcc, 0, v254
s_cbranch_vccnz L_slow_55
L_back_56:
s_lshr_b32 s6, s4, 3
s_mul_i32 s6, s6, 14
s_and_b32 s7, s4, 7
s_mul_i32 s7, s7, 7
s_add_u32 s6, s6, s7
s_lshr_b32 s6, s6, 2
s_cmp_ge_u32 s5, 2
s_cselect_b32 s43, 13, 14
s_cmp_ge_u32 s6, s43
s_cselect_b32 s7, s43, 0
s_sub_u32 s93, s6, s7
s_mov_b32 s93, 0
s_mul_i32 s6, s95, 54
s_add_u32 s6, s6, s96
s_mul_i32 s79, s6, 5120
s_add_u32 s79, s79, 7340032
s_mul_i32 s7, s43, 5120
s_add_u32 s80, s79, s7
s_mul_i32 s7, s93, 5120
s_add_u32 s97, s79, s7
s_add_u32 s98, s97, 4096
buffer_load_dwordx4 a[0:3], v248, s[24:27], s97 offen offset:0
buffer_load_dwordx4 a[4:7], v248, s[24:27], s97 offen offset:1024
buffer_load_dwordx4 a[8:11], v248, s[24:27], s97 offen offset:2048
buffer_load_dwordx4 a[12:15], v248, s[24:27], s97 offen offset:3072
buffer_load_dwordx4 a[16:19], v248, s[24:27], s98 offen
s_add_u32 s97, s97, 5120
s_cmp_eq_u32 s97, s80
s_cselect_b32 s97, s79, s97
s_add_u32 s98, s97, 4096
buffer_load_dwordx4 a[20:23], v248, s[24:27], s97 offen offset:0
buffer_load_dwordx4 a[24:27], v248, s[24:27], s97 offen offset:1024
buffer_load_dwordx4 a[28:31], v248, s[24:27], s97 offen offset:2048
buffer_load_dwordx4 a[32:35], v248, s[24:27], s97 offen offset:3072
buffer_load_dwordx4 a[36:39], v248, s[24:27], s98 offen
s_add_u32 s97, s97, 5120
s_cmp_eq_u32 s97, s80
s_cselect_b32 s97, s79, s97
s_add_u32 s98, s97, 4096
buffer_load_dwordx4 a[40:43], v248, s[24:27], s97 offen offset:0
buffer_load_dwordx4 a[44:47], v248, s[24:27], s97 offen offset:1024
buffer_load_dwordx4 a[48:51], v248, s[24:27], s97 offen offset:2048
buffer_load_dwordx4 a[52:55], v248, s[24:27], s97 offen offset:3072
buffer_load_dwordx4 a[56:59], v248, s[24:27], s98 offen
s_add_u32 s97, s97, 5120
s_cmp_eq_u32 s97, s80
s_cselect_b32 s97, s79, s97
s_add_u32 s98, s97, 4096
buffer_load_dwordx4 a[60:63], v248, s[24:27], s97 offen offset:0
buffer_load_dwordx4 a[64:67], v248, s[24:27], s97 offen offset:1024
buffer_load_dwordx4 a[68:71], v248, s[24:27], s97 offen offset:2048
buffer_load_dwordx4 a[72:75], v248, s[24:27], s97 offen offset:3072
buffer_load_dwordx4 a[76:79], v248, s[24:27], s98 offen
s_add_u32 s97, s97, 5120
s_cmp_eq_u32 s97, s80
s_cselect_b32 s97, s79, s97
s_add_u32 s98, s97, 4096
s_lshl_b32 s6, s89, 2
s_add_u32 s6, s6, s5
s_lshl_b32 s7, s6, 1
s_lshr_b32 s85, 6436, s7
s_and_b32 s85, s85, 3
s_lshr_b32 s86, 55, s6
s_and_b32 s86, s86, 1
s_lshr_b32 s87, 61311, s7
s_and_b32 s87, s87, 3
v_and_b32 v2, 3, v1
v_mul_u32_u24 v2, 4416, v2
v_bfe_u32 v3, v1, 2, 2
v_lshrrev_b32 v18, 4, v1
v_add_u32 v3, v3, v18
v_lshl_add_u32 v16, v3, 4, v2
v_and_b32 v2, 1, v1
v_mul_u32_u24 v2, 6272, v2
v_bfe_u32 v3, v1, 1, 3
s_lshl_b32 s6, s86, 3
s_sub_u32 s6, 15, s6
v_sub_u32 v5, s6, v3
v_mul_u32_u24 v5, 272, v5
v_add_u32 v2, v2, v5
v_lshl_add_u32 v17, v18, 4, v2
s_lshl_b32 s6, s86, 3
v_add_u32 v3, s6, v3
v_lshlrev_b32 v3, 8, v3
v_and_b32 v2, 1, v1
v_lshl_or_b32 v2, v18, 1, v2
v_lshl_or_b32 v11, v2, 4, v3
s_mul_i32 s6, s85, 30208
s_add_u32 s6, s6, 65536
v_add_u32 v8, s6, v16
s_add_u32 s6, s6, 17664
v_add_u32 v9, s6, v17
v_lshlrev_b32 v10, 5, v18
v_sub_u32 v10, v9, v10
v_add_u32 v10, 0, v10
s_add_u32 s91, s88, s85
s_and_b32 s46, s88, 0xfffffffe
s_sub_u32 s46, s91, s46
s_cmp_ge_u32 s46, 2
s_cselect_b32 s47, s1, s0
s_and_b32 s46, s46, 1
s_lshl_b32 s46, s46, 4
s_lshr_b32 s47, s47, s46
s_and_b32 s47, s47, 0xffff
v_mov_b32 v61, s47
v_and_b32 v19, 15, v1
v_lshl_add_u32 v19, v18, 2, v19
v_sub_u32 v19, 15, v19
v_cmp_eq_u32 vcc, 0, v19
v_cndmask_b32 v192, 0, v61, vcc
v_cmp_eq_u32 vcc, 1, v19
v_cndmask_b32 v193, 0, v61, vcc
v_cmp_eq_u32 vcc, 2, v19
v_cndmask_b32 v194, 0, v61, vcc
v_cmp_eq_u32 vcc, 3, v19
v_cndmask_b32 v195, 0, v61, vcc
s_lshl_b32 s92, s91, 12
s_add_u32 s92, s92, 4194304
s_branch L_conv
L_slow_11:
s_add_u32 s42, s42, 1
s_cmp_gt_u32 s42, 200000
s_cbranch_scc1 L_back_12
buffer_load_dword v254, v230, s[52:55], 0 offen sc1
s_waitcnt vmcnt(0)
v_cmp_gt_u32 vcc, 32, v254
s_cbranch_vccnz L_slow_11
s_branch L_back_12
L_slow_20:
s_add_u32 s42, s42, 1
s_cmp_gt_u32 s42, 200000
s_cbranch_scc1 L_back_21
buffer_load_dword v254, v231, s[24:27], 0 offen sc1
s_waitcnt vmcnt(0)
v_cmp_eq_u32 vcc, 0, v254
s_cbranch_vccnz L_slow_20
s_branch L_back_21
L_slow_27:
s_add_u32 s42, s42, 1
s_cmp_gt_u32 s42, 200000
s_cbranch_scc1 L_back_28
buffer_load_dword v251, v229, s[24:27], 0 offen sc1
s_waitcnt vmcnt(0)
v_cmp_eq_u32 vcc, 0, v251
s_cbranch_vccnz L_slow_27
s_branch L_back_28
L_slow_29:
s_add_u32 s42, s42, 1
s_cmp_gt_u32 s42, 200000
s_cbranch_scc1 L_back_30
buffer_load_dword v254, v228, s[24:27], 0 offen sc1
s_waitcnt vmcnt(0)
v_cmp_eq_u32 vcc, 0, v254
s_cbranch_vccnz L_slow_29
s_branch L_back_30
L_slow_37:
s_add_u32 s42, s42, 1
s_cmp_gt_u32 s42, 200000
s_cbranch_scc1 L_back_38
buffer_load_dword v254, v249, s[24:27], 0 offen sc1
s_waitcnt vmcnt(0)
v_cmp_eq_u32 vcc, 0, v254
s_cbranch_vccnz L_slow_37
s_branch L_back_38
L_slow_44:
s_add_u32 s42, s42, 1
s_cmp_gt_u32 s42, 200000
s_cbranch_scc1 L_back_45
buffer_load_dword v254, v250, s[24:27], 0 offen sc1
s_waitcnt vmcnt(0)
v_cmp_eq_u32 vcc, 0, v254
s_cbranch_vccnz L_slow_44
s_branch L_back_45
L_slow_50:
s_add_u32 s42, s42, 1
s_cmp_gt_u32 s42, 200000
s_cbranch_scc1 L_back_51
buffer_load_dword v254, v230, s[52:55], 0 offen sc1
s_waitcnt vmcnt(0)
v_cmp_gt_u32 vcc, 32, v254
s_cbranch_vccnz L_slow_50
s_branch L_back_51
L_slow_53:
s_add_u32 s42, s42, 1
s_cmp_gt_u32 s42, 200000
s_cbranch_scc1 L_back_54
buffer_load_dword v254, v229, s[24:27], 0 offen sc1
s_waitcnt vmcnt(0)
v_cmp_eq_u32 vcc, 0, v254
s_cbranch_vccnz L_slow_53
s_branch L_back_54
L_slow_55:
s_add_u32 s42, s42, 1
s_cmp_gt_u32 s42, 200000
s_cbranch_scc1 L_back_56
buffer_load_dword v254, v228, s[24:27], 0 offen sc1
s_waitcnt vmcnt(0)
v_cmp_eq_u32 vcc, 0, v254
s_cbranch_vccnz L_slow_55
s_branch L_back_56
L_code_end:
.section .rodata,"a"
.p2align 6
.amdhsa_kernel recurrent_scan__ssm_conv_h3__dense_activation_gelu__prompt_kernel
  .amdhsa_next_free_vgpr 512
  .amdhsa_next_free_sgpr 102
  .amdhsa_accum_offset 256
  .amdhsa_group_segment_fixed_size 0
  .amdhsa_kernarg_size 112
  .amdhsa_user_sgpr_count 2
  .amdhsa_user_sgpr_kernarg_segment_ptr 1
  .amdhsa_system_sgpr_workgroup_id_x 1
.end_amdhsa_kernel
```

```asm
; @launch grid=(256,1,1) block=(256,1,1) lds=163840
.amdgcn_target "amdgcn-amd-amdhsa--gfx950"
.text
.globl recurrent_scan__ssm_conv_h3__dense_activation_gelu__prompt_kernel
.p2align 8
.type recurrent_scan__ssm_conv_h3__dense_activation_gelu__prompt_kernel,@function
recurrent_scan__ssm_conv_h3__dense_activation_gelu__prompt_kernel:
s_cmp_ge_u32 s2, 256
s_cbranch_scc1 L_end
s_load_dwordx16 s[40:55], s[0:1], 0
s_load_dwordx8 s[56:63], s[0:1], 64
s_load_dwordx4 s[64:67], s[0:1], 96
s_and_b32 s3, s2, 7
s_lshr_b32 s4, s2, 3
v_lshrrev_b32 v1, 6, v0
v_and_b32 v0, 0xff, v0
v_mov_b32 v253, 1
v_readfirstlane_b32 s5, v1
v_and_b32 v1, 63, v0
s_lshl_b32 s6, s2, 7
v_mov_b32 v252, s6
v_lshlrev_b32 v248, 4, v1
v_and_b32 v230, 7, v1
v_lshlrev_b32 v230, 5, v230
v_mov_b32 v255, 0
s_cmp_ge_u32 s4, 28
s_cbranch_scc1 L_spare
s_and_b32 s6, s3, 3
s_lshl_b32 s6, s6, 2
s_and_b32 s7, s4, 3
s_add_u32 s77, s6, s7
s_lshr_b32 s6, s3, 2
s_mul_i32 s6, s6, 7
s_lshr_b32 s7, s4, 2
s_add_u32 s78, s6, s7
s_and_b32 s82, s5, 1
s_lshr_b32 s83, s5, 1
s_lshl_b32 s6, s3, 4
s_lshr_b32 s7, s4, 1
s_add_u32 s6, s6, s7
s_mul_i32 s6, s6, 5
s_and_b32 s89, s4, 1
s_lshl_b32 s7, s89, 1
s_add_u32 s88, s6, s7
s_and_b32 s6, s3, 3
s_lshl_b32 s6, s6, 3
s_and_b32 s7, s4, 7
s_add_u32 s94, s6, s7
s_lshr_b32 s6, s3, 2
s_xor_b32 s6, s6, 1
s_lshl_b32 s6, s6, 2
s_lshr_b32 s7, s4, 3
s_add_u32 s95, s6, s7
s_mul_i32 s96, s5, 14
s_cmp_eq_u32 s5, 3
s_cselect_b32 s6, 1, 0
s_sub_u32 s96, s96, s6
s_lshr_b32 s6, s4, 3
s_lshl_b32 s7, s3, 2
s_add_u32 s68, s6, s7
s_and_b32 s69, s4, 7
v_mul_u32_u24 v2, 26, v1
v_lshrrev_b32 v2, 8, v2
v_mul_u32_u24 v3, 10, v2
v_sub_u32 v3, v1, v3
s_lshl_b32 s6, s68, 6
s_lshl_b32 s7, s5, 4
s_add_u32 s6, s6, s7
s_mul_i32 s6, s6, 1280
s_mul_i32 s7, s69, 160
s_add_u32 s6, s6, s7
v_mul_u32_u24 v4, 5120, v2
v_lshl_add_u32 v4, v3, 4, v4
v_add_u32 v244, s6, v4
v_subrev_u32 v245, 3840, v244
s_mul_i32 s92, s69, 640
s_mul_i32 s7, s5, 2560
s_add_u32 s7, s7, 142592
s_mov_b32 m0, s7
v_lshl_add_u32 v247, v3, 6, s7
s_lshl_b32 s7, s5, 5
s_sub_u32 s7, 131192, s7
v_mul_u32_u24 v4, 1152, v3
v_lshlrev_b32 v2, 3, v2
v_sub_u32 v4, v4, v2
v_add_u32 v202, s7, v4
v_lshrrev_b32 v2, 3, v1
s_mul_i32 s6, s5, 20
v_add_u32 v2, s6, v2
v_and_b32 v3, 7, v1
v_lshlrev_b32 v3, 4, v3
v_mul_u32_u24 v4, 144, v2
v_add_u32 v4, v4, v3
v_add_u32 v203, 131072, v4
v_lshl_add_u32 v172, v2, 12, v3
s_mul_i32 s6, s69, 327680
s_lshl_b32 s7, s68, 7
s_sub_u32 s6, s6, s7
s_add_u32 s70, s6, 1052544
s_add_u32 s71, s70, 32768
s_add_u32 s72, s70, 65536
s_lshl_b32 s79, s78, 8
s_mul_i32 s80, s77, 163840
s_lshl_b32 s81, s5, 12
v_lshrrev_b32 v2, 4, v1
v_and_b32 v3, 15, v1
v_lshlrev_b32 v4, 2, v2
v_xor_b32 v4, v3, v4
s_lshl_b32 s6, s5, 4
v_add_u32 v5, s6, v2
v_mul_u32_u24 v5, 3456, v5
v_lshl_add_u32 v208, v4, 4, v5
s_cmp_eq_u32 s78, 13
s_cselect_b32 s7, 8, 16
v_cmp_le_u32 vcc, s7, v4
v_mov_b32 v6, 2147418112
v_cndmask_b32 v208, v208, v6, vcc
v_add_u32 v209, 12800, v208
v_add_u32 v210, 25600, v208
v_add_u32 v211, 38400, v208
v_lshrrev_b32 v4, 3, v1
v_and_b32 v5, 7, v1
s_lshl_b32 s6, s5, 5
v_add_u32 v4, s6, v4
v_mul_u32_u24 v4, 1280, v4
v_add_u32 v6, 0, v2
v_xor_b32 v6, v5, v6
v_lshl_add_u32 v6, v6, 4, v4
v_add_u32 v212, 0, v6
v_add_u32 v6, 4, v2
v_xor_b32 v6, v5, v6
v_lshl_add_u32 v6, v6, 4, v4
v_add_u32 v213, 9216, v6
v_add_u32 v6, 0, v2
v_xor_b32 v6, v5, v6
v_lshl_add_u32 v6, v6, 4, v4
v_add_u32 v214, 18432, v6
v_add_u32 v6, 4, v2
v_xor_b32 v6, v5, v6
v_lshl_add_u32 v6, v6, 4, v4
v_add_u32 v215, 27648, v6
s_lshl_b32 s6, s4, 2
s_add_u32 s6, s6, s5
s_lshl_b32 s7, s6, 3
v_and_b32 v2, 7, v1
v_add_u32 v2, s7, v2
v_lshrrev_b32 v3, 3, v1
v_mul_u32_u24 v4, 4682, v2
v_lshrrev_b32 v4, 16, v4
v_mul_u32_u24 v5, 14, v4
v_sub_u32 v5, v2, v5
v_lshl_add_u32 v4, v3, 6, v4
v_mul_u32_u24 v4, 3456, v4
v_lshl_add_u32 v4, v5, 7, v4
s_lshr_b32 s7, s3, 2
s_mul_i32 s73, s7, 1792
v_add_u32 v4, s73, v4
s_sub_u32 s7, 13, s7
v_mov_b32 v6, 2147418112
v_cmp_lt_u32 vcc, s7, v5
v_cndmask_b32 v232, v4, v6, vcc
v_mul_u32_u24 v2, 52, v1
v_lshrrev_b32 v2, 8, v2
v_mul_u32_u24 v3, 5, v2
v_sub_u32 v3, v1, v3
s_mul_i32 s7, s6, 5
v_add_u32 v3, s7, v3
v_cmp_gt_u32 vcc, 512, v3
s_and_b32 s7, s3, 3
s_lshl_b32 s7, s7, 9
v_add_u32 v3, s7, v3
v_mul_u32_u24 v3, 1280, v3
v_lshl_add_u32 v3, v2, 7, v3
v_cndmask_b32 v233, v6, v3, vcc
s_lshl_b32 s6, s68, 6
s_lshl_b32 s7, s5, 4
s_add_u32 s6, s6, s7
s_mul_i32 s6, s6, 1280
s_mul_i32 s7, s69, 160
s_and_b32 s7, s7, 0xffffff80
s_add_u32 s6, s6, s7
v_lshrrev_b32 v2, 1, v1
v_mul_u32_u24 v2, 1280, v2
v_and_b32 v3, 1, v1
v_lshl_add_u32 v2, v3, 7, v2
v_add_u32 v129, s6, v2
v_subrev_u32 v128, 3840, v129
s_mul_i32 s7, s69, 640
v_lshlrev_b32 v2, 7, v1
v_add_u32 v130, s7, v2
s_waitcnt lgkmcnt(0)
s_mov_b32 s24, s66
s_and_b32 s25, s67, 0xffff
s_mov_b32 s26, 17825792
s_mov_b32 s27, 0x20000
s_lshl_b32 s6, s88, 1
s_and_b32 s6, s6, 0xfffffffc
s_load_dwordx2 s[0:1], s[50:51], s6
s_cmp_lg_u32 s5, 0
s_cbranch_scc1 L_clr_1
v_lshl_add_u32 v2, v1, 2, v252
v_mov_b32 v3, 0
s_mov_b64 exec, 0xff
buffer_store_dword v3, v2, s[24:27], 0 offen sc1
s_mov_b64 exec, -1
L_clr_1:
s_mov_b32 s12, s42
s_and_b32 s13, s43, 0xffff
s_mov_b32 s14, 2621440
s_mov_b32 s15, 0x20000
s_mov_b32 s16, s44
s_and_b32 s17, s45, 0xffff
s_mov_b32 s18, 2621440
s_mov_b32 s19, 0x20000
s_mov_b32 s32, s46
s_and_b32 s33, s47, 0xffff
s_mov_b32 s34, 5120
s_mov_b32 s35, 0x20000
s_mov_b32 exec_hi, 0xff
buffer_load_dwordx4 v[8:11], v245, s[12:15], 0 offen offset:0
buffer_load_dwordx4 v[12:15], v245, s[12:15], 0 offen offset:1280
buffer_load_dwordx4 v[16:19], v245, s[12:15], 0 offen offset:2560
buffer_load_dwordx4 v[20:23], v244, s[12:15], 0 offen offset:0
buffer_load_dwordx4 v[24:27], v244, s[12:15], 0 offen offset:1280
buffer_load_dwordx4 v[28:31], v244, s[12:15], 0 offen offset:2560
buffer_load_dwordx4 v[32:35], v244, s[12:15], 0 offen offset:3840
buffer_load_dwordx4 v248, s[32:35], s92 offen lds
buffer_load_dwordx4 v[174:177], v244, s[16:19], 0 offen offset:0
buffer_load_dwordx4 v[178:181], v244, s[16:19], 0 offen offset:1280
buffer_load_dwordx4 v[182:185], v244, s[16:19], 0 offen offset:2560
buffer_load_dwordx4 v[186:189], v244, s[16:19], 0 offen offset:3840
s_mov_b64 exec, -1
s_mov_b32 s20, s54
s_and_b32 s21, s55, 0xffff
s_mov_b32 s22, 2211840
s_mov_b32 s23, 0x20000
s_mov_b32 s8, s40
s_and_b32 s9, s41, 0xffff
s_mov_b32 s10, 2621440
s_mov_b32 s11, 0x20000
s_mov_b32 s28, s62
s_and_b32 s29, s63, 0xffff
s_mov_b32 s30, 2621440
s_mov_b32 s31, 0x20000
s_mov_b32 s52, s64
s_and_b32 s53, s65, 0xffff
s_mov_b32 s54, 256
s_mov_b32 s55, 0x20000
s_mov_b32 s42, 0
s_mov_b32 s36, s58
s_and_b32 s37, s59, 0xffff
s_mov_b32 s38, 2211840
s_mov_b32 s39, 0x20000
s_lshr_b32 s6, s2, 2
s_lshl_b32 s6, s6, 5
s_lshl_b32 s7, s5, 3
s_add_u32 s6, s6, s7
s_mul_i32 s6, s6, 1280
s_and_b32 s7, s2, 3
s_mul_i32 s7, s7, 320
s_add_u32 s6, s6, s7
s_cmp_lt_u32 s2, 216
s_cselect_b32 s6, s6, 2147418112
v_add_u32 v2, 0, v1
v_mul_u32_u24 v3, 205, v2
v_lshrrev_b32 v3, 12, v3
v_mul_u32_u24 v4, 20, v3
v_sub_u32 v2, v2, v4
v_mul_u32_u24 v3, 1280, v3
v_lshl_add_u32 v2, v2, 4, v3
v_add_u32 v2, s6, v2
v_subrev_u32 v204, 0, v2
v_add_u32 v2, 64, v1
v_mul_u32_u24 v3, 205, v2
v_lshrrev_b32 v3, 12, v3
v_mul_u32_u24 v4, 20, v3
v_sub_u32 v2, v2, v4
v_mul_u32_u24 v3, 1280, v3
v_lshl_add_u32 v2, v2, 4, v3
v_add_u32 v2, s6, v2
v_subrev_u32 v205, 1024, v2
v_add_u32 v2, 128, v1
v_mul_u32_u24 v3, 205, v2
v_lshrrev_b32 v3, 12, v3
v_mul_u32_u24 v4, 20, v3
v_sub_u32 v2, v2, v4
v_mul_u32_u24 v3, 1280, v3
v_lshl_add_u32 v2, v2, 4, v3
v_add_u32 v2, s6, v2
v_subrev_u32 v206, 2048, v2
s_mul_i32 s6, s5, 2560
s_add_u32 s74, s6, 142592
v_lshrrev_b32 v2, 4, v1
v_bfe_u32 v3, v1, 2, 2
v_lshrrev_b32 v4, 1, v2
v_lshlrev_b32 v4, 4, v4
v_and_b32 v2, 1, v2
v_lshl_add_u32 v2, v2, 2, v3
v_add_u32 v2, v2, v4
v_mul_u32_u24 v2, 320, v2
v_and_b32 v3, 3, v1
v_mul_u32_u24 v3, 40, v3
v_add_u32 v2, v2, v3
v_add_u32 v5, 142592, v2
s_and_b32 s6, s2, 3
s_lshl_b32 s6, s6, 1
s_mul_i32 s6, s6, 54
s_lshr_b32 s7, s2, 2
s_add_u32 s6, s6, s7
s_mul_i32 s84, s6, 5120
s_add_u32 s84, s84, 7340032
v_mov_b32 v207, 2147418112
s_cmp_lt_u32 s2, 216
s_cselect_b64 vcc, -1, 0
v_cndmask_b32 v207, v207, v248, vcc
s_add_u32 s6, s5, 0
s_cmp_ge_u32 s6, 5
s_cselect_b32 s7, 5, 0
s_cselect_b32 s43, 276480, 0
s_cselect_b32 s75, 160, 0
s_sub_u32 s6, s6, s7
s_lshl_b32 s7, s6, 3
s_add_u32 s75, s75, s7
v_add_u32 v200, s75, v5
s_lshl_b32 s6, s6, 10
s_add_u32 s6, s6, s43
s_add_u32 s75, s6, s84
s_add_u32 s6, s5, 4
s_cmp_ge_u32 s6, 5
s_cselect_b32 s7, 5, 0
s_cselect_b32 s43, 276480, 0
s_cselect_b32 s76, 160, 0
s_sub_u32 s6, s6, s7
s_lshl_b32 s7, s6, 3
s_add_u32 s76, s76, s7
v_add_u32 v201, s76, v5
s_lshl_b32 s6, s6, 10
s_add_u32 s6, s6, s43
s_add_u32 s76, s6, s84
s_add_u32 s6, s5, 8
s_cmp_ge_u32 s6, 5
s_cselect_b32 s7, 5, 0
s_cselect_b32 s43, 276480, 0
s_cselect_b32 s93, 160, 0
s_sub_u32 s6, s6, s7
s_lshl_b32 s7, s6, 3
s_add_u32 s93, s93, s7
v_add_u32 v246, s93, v5
s_lshl_b32 s6, s6, 10
s_add_u32 s6, s6, s43
s_add_u32 s93, s6, s84
s_cmp_ge_u32 s5, 2
s_cselect_b64 vcc, -1, 0
v_mov_b32 v3, 2147418112
v_cndmask_b32 v173, v207, v3, vcc
s_mov_b32 exec_lo, 0xffffff
s_mov_b32 exec_hi, 0x0
buffer_load_dword v234, v232, s[20:23], 0 offen
s_mov_b64 exec, -1
s_mov_b32 exec_lo, 0x7fff
s_mov_b32 exec_hi, 0x0
buffer_load_dword v234, v233, s[8:11], 0 offen
s_mov_b64 exec, -1
v_lshrrev_b32 v2, 4, v1
v_bfe_u32 v4, v1, 2, 2
v_and_b32 v5, 3, v1
v_lshrrev_b32 v6, 5, v1
v_lshl_add_u32 v6, v6, 3, v4
v_lshlrev_b32 v6, 8, v6
s_lshl_b32 s6, s82, 1
v_xor_b32 v4, s6, v4
v_lshlrev_b32 v4, 2, v4
v_and_b32 v3, 1, v2
v_lshl_or_b32 v4, v3, 1, v4
v_lshrrev_b32 v3, 1, v5
v_or_b32 v4, v4, v3
v_lshl_add_u32 v6, v4, 4, v6
v_and_b32 v5, 1, v5
v_lshl_add_u32 v216, v5, 3, v6
v_xor_b32 v217, 64, v216
v_add_u32 v218, 0x10000, v216
v_add_u32 v219, 0x10000, v217
v_and_b32 v4, 31, v1
v_bfe_u32 v5, v1, 1, 3
v_lshrrev_b32 v6, 5, v1
v_xor_b32 v5, v5, v6
s_lshl_b32 s6, s83, 6
v_add_u32 v4, s6, v4
v_lshlrev_b32 v4, 7, v4
v_lshl_add_u32 v220, v5, 4, v4
v_xor_b32 v221, 32, v220
v_xor_b32 v222, 64, v220
v_xor_b32 v223, 96, v220
v_add_u32 v224, 0x10000, v220
v_add_u32 v225, 0x10000, v221
v_add_u32 v226, 0x10000, v222
v_add_u32 v227, 0x10000, v223
v_and_b32 v2, 15, v1
v_min_u32 v2, 13, v2
v_add_u32 v2, s96, v2
v_min_u32 v2, 53, v2
v_lshlrev_b32 v2, 2, v2
s_lshr_b32 s43, s95, 1
v_add_u32 v2, s43, v2
v_lshlrev_b32 v2, 7, v2
v_add_u32 v228, 12, v2
s_lshl_b32 s6, s77, 1
v_and_b32 v4, 1, v1
v_add_u32 v4, s6, v4
v_and_b32 v5, 3, v4
v_add_u32 v5, 28, v5
s_lshr_b32 s6, s77, 2
s_and_b32 s7, s77, 2
s_lshl_b32 s7, s7, 1
s_add_u32 s6, s6, s7
v_mov_b32 v4, s6
v_lshl_add_u32 v4, v5, 3, v4
v_lshlrev_b32 v4, 7, v4
v_add_u32 v231, 4, v4
v_and_b32 v2, 31, v1
v_and_b32 v3, 7, v2
v_lshrrev_b32 v2, 3, v2
v_lshlrev_b32 v2, 3, v2
v_add_u32 v2, s3, v2
v_lshl_add_u32 v2, v2, 3, v3
v_lshlrev_b32 v229, 7, v2
v_cmp_gt_u32 vcc, 14, v1
v_cndmask_b32 v2, 0, v1, vcc
v_cmp_lt_u32 vcc, 6, v2
v_cndmask_b32 v3, 0, 1, vcc
v_mul_u32_u24 v4, 7, v3
v_sub_u32 v2, v2, v4
s_lshr_b32 s6, s94, 1
s_and_b32 s7, s6, 3
s_lshr_b32 s6, s6, 2
v_lshlrev_b32 v3, 2, v3
v_lshlrev_b32 v2, 2, v2
v_add_u32 v2, s7, v2
v_add_u32 v3, s6, v3
v_lshl_add_u32 v2, v2, 3, v3
v_lshlrev_b32 v2, 7, v2
v_add_u32 v249, 16, v2
v_and_b32 v2, 31, v1
v_lshlrev_b32 v2, 3, v2
v_add_u32 v2, s95, v2
v_lshlrev_b32 v2, 7, v2
v_add_u32 v250, 20, v2
v_mov_b32 v2, 2147418112
s_cmp_lg_u32 s5, 0
s_cselect_b64 vcc, -1, 0
v_cndmask_b32 v231, v231, v2, vcc
v_cndmask_b32 v230, v230, v2, vcc
v_and_b32 v2, 15, v1
v_bfe_u32 v3, v1, 4, 1
v_lshlrev_b32 v3, 2, v3
v_cmp_eq_u32 vcc, v2, v3
v_mov_b32 v2, 0x3f803f80
v_cndmask_b32 v160, 0, v2, vcc
v_mov_b32 v161, v160
v_mov_b32 v162, v160
v_mov_b32 v163, v160
s_add_u32 m0, s81, 0
s_nop 0
buffer_load_dwordx4 v208, s[20:23], s79 offen offset:0 lds
buffer_load_dwordx4 v209, s[20:23], s79 offen offset:1024 lds
buffer_load_dwordx4 v210, s[20:23], s79 offen offset:2048 lds
buffer_load_dwordx4 v211, s[20:23], s79 offen offset:3072 lds
s_add_u32 m0, s81, 16384
s_nop 0
buffer_load_dwordx4 v212, s[8:11], s80 offen offset:0 lds
buffer_load_dwordx4 v213, s[8:11], s80 offen offset:1024 lds
buffer_load_dwordx4 v214, s[8:11], s80 offen offset:2048 lds
buffer_load_dwordx4 v215, s[8:11], s80 offen offset:3072 lds
s_waitcnt vmcnt(10)
ds_read_b128 v[36:39], v247 offset:0
ds_read_b128 v[40:43], v247 offset:16
ds_read_b128 v[44:47], v247 offset:32
ds_read_b128 v[48:51], v247 offset:48
s_cmp_lg_u32 s5, 0
s_cbranch_scc1 L_arr_2
s_and_b32 s6, s2, 7
s_lshl_b32 s6, s6, 5
v_mov_b32 v2, s6
s_mov_b64 exec, 1
buffer_atomic_add v253, v2, s[52:55], 0 offen sc1
s_mov_b64 exec, -1
L_arr_2:
v_lshlrev_b32 v194, 16, v8
v_and_b32 v195, 0xffff0000, v8
v_lshlrev_b32 v196, 16, v12
v_and_b32 v197, 0xffff0000, v12
s_mov_b32 exec_lo, 0xff000000
s_mov_b32 exec_hi, 0xffffff
buffer_load_dword v234, v232, s[20:23], 0 offen
s_mov_b64 exec, -1
s_mov_b32 exec_lo, 0xffff8000
s_mov_b32 exec_hi, 0x7
buffer_load_dword v234, v233, s[8:11], 0 offen
s_mov_b64 exec, -1
v_lshlrev_b32 v198, 16, v16
v_and_b32 v199, 0xffff0000, v16
v_lshlrev_b32 v236, 16, v20
v_and_b32 v237, 0xffff0000, v20
v_lshlrev_b32 v238, 16, v24
v_and_b32 v239, 0xffff0000, v24
v_lshlrev_b32 v240, 16, v28
v_and_b32 v241, 0xffff0000, v28
v_lshlrev_b32 v242, 16, v32
v_and_b32 v243, 0xffff0000, v32
s_waitcnt lgkmcnt(0)
v_lshlrev_b32 v52, 16, v36
v_lshlrev_b32 v53, 16, v38
v_and_b32 v54, 0xffff0000, v36
v_and_b32 v55, 0xffff0000, v38
v_lshlrev_b32 v56, 16, v37
v_lshlrev_b32 v57, 16, v39
v_and_b32 v58, 0xffff0000, v37
v_and_b32 v59, 0xffff0000, v39
v_pk_mul_f32 v[60:61], v[236:237], v[52:53]
v_pk_mul_f32 v[62:63], v[238:239], v[52:53]
v_pk_mul_f32 v[190:191], v[240:241], v[52:53]
v_pk_mul_f32 v[192:193], v[242:243], v[52:53]
v_pk_fma_f32 v[60:61], v[198:199], v[54:55], v[60:61]
v_pk_fma_f32 v[62:63], v[236:237], v[54:55], v[62:63]
v_pk_fma_f32 v[190:191], v[238:239], v[54:55], v[190:191]
v_pk_fma_f32 v[192:193], v[240:241], v[54:55], v[192:193]
v_pk_fma_f32 v[60:61], v[196:197], v[56:57], v[60:61]
v_pk_fma_f32 v[62:63], v[198:199], v[56:57], v[62:63]
v_pk_fma_f32 v[190:191], v[236:237], v[56:57], v[190:191]
v_pk_fma_f32 v[192:193], v[238:239], v[56:57], v[192:193]
v_pk_fma_f32 v[60:61], v[194:195], v[58:59], v[60:61]
v_pk_fma_f32 v[62:63], v[196:197], v[58:59], v[62:63]
v_pk_fma_f32 v[190:191], v[198:199], v[58:59], v[190:191]
v_pk_fma_f32 v[192:193], v[236:237], v[58:59], v[192:193]
v_lshlrev_b32 v194, 16, v174
v_and_b32 v195, 0xffff0000, v174
v_lshlrev_b32 v196, 16, v178
v_and_b32 v197, 0xffff0000, v178
v_lshlrev_b32 v198, 16, v182
v_and_b32 v199, 0xffff0000, v182
v_lshlrev_b32 v236, 16, v186
v_and_b32 v237, 0xffff0000, v186
v_pk_mul_f32 v[60:61], v[60:61], v[194:195]
v_pk_mul_f32 v[62:63], v[62:63], v[196:197]
v_pk_mul_f32 v[190:191], v[190:191], v[198:199]
v_pk_mul_f32 v[192:193], v[192:193], v[236:237]
s_mov_b32 exec_hi, 0xff
v_cvt_pk_bf16_f32 v238, v192, v190
v_cvt_pk_bf16_f32 v239, v62, v60
ds_write_b64 v202, v[238:239] offset:0
v_cvt_pk_bf16_f32 v240, v193, v191
v_cvt_pk_bf16_f32 v241, v63, v61
ds_write_b64 v202, v[240:241] offset:144
s_mov_b64 exec, -1
v_lshlrev_b32 v194, 16, v9
v_and_b32 v195, 0xffff0000, v9
v_lshlrev_b32 v196, 16, v13
v_and_b32 v197, 0xffff0000, v13
v_lshlrev_b32 v198, 16, v17
v_and_b32 v199, 0xffff0000, v17
v_lshlrev_b32 v236, 16, v21
v_and_b32 v237, 0xffff0000, v21
v_lshlrev_b32 v238, 16, v25
v_and_b32 v239, 0xffff0000, v25
v_lshlrev_b32 v240, 16, v29
v_and_b32 v241, 0xffff0000, v29
v_lshlrev_b32 v242, 16, v33
v_and_b32 v243, 0xffff0000, v33
v_lshlrev_b32 v52, 16, v40
v_lshlrev_b32 v53, 16, v42
v_and_b32 v54, 0xffff0000, v40
v_and_b32 v55, 0xffff0000, v42
v_lshlrev_b32 v56, 16, v41
v_lshlrev_b32 v57, 16, v43
v_and_b32 v58, 0xffff0000, v41
v_and_b32 v59, 0xffff0000, v43
v_pk_mul_f32 v[60:61], v[236:237], v[52:53]
v_pk_mul_f32 v[62:63], v[238:239], v[52:53]
v_pk_mul_f32 v[190:191], v[240:241], v[52:53]
v_pk_mul_f32 v[192:193], v[242:243], v[52:53]
v_pk_fma_f32 v[60:61], v[198:199], v[54:55], v[60:61]
v_pk_fma_f32 v[62:63], v[236:237], v[54:55], v[62:63]
v_pk_fma_f32 v[190:191], v[238:239], v[54:55], v[190:191]
v_pk_fma_f32 v[192:193], v[240:241], v[54:55], v[192:193]
v_pk_fma_f32 v[60:61], v[196:197], v[56:57], v[60:61]
v_pk_fma_f32 v[62:63], v[198:199], v[56:57], v[62:63]
v_pk_fma_f32 v[190:191], v[236:237], v[56:57], v[190:191]
v_pk_fma_f32 v[192:193], v[238:239], v[56:57], v[192:193]
v_pk_fma_f32 v[60:61], v[194:195], v[58:59], v[60:61]
v_pk_fma_f32 v[62:63], v[196:197], v[58:59], v[62:63]
v_pk_fma_f32 v[190:191], v[198:199], v[58:59], v[190:191]
v_pk_fma_f32 v[192:193], v[236:237], v[58:59], v[192:193]
v_lshlrev_b32 v194, 16, v175
v_and_b32 v195, 0xffff0000, v175
v_lshlrev_b32 v196, 16, v179
v_and_b32 v197, 0xffff0000, v179
v_lshlrev_b32 v198, 16, v183
v_and_b32 v199, 0xffff0000, v183
v_lshlrev_b32 v236, 16, v187
v_and_b32 v237, 0xffff0000, v187
v_pk_mul_f32 v[60:61], v[60:61], v[194:195]
v_pk_mul_f32 v[62:63], v[62:63], v[196:197]
v_pk_mul_f32 v[190:191], v[190:191], v[198:199]
v_pk_mul_f32 v[192:193], v[192:193], v[236:237]
s_mov_b32 exec_hi, 0xff
v_cvt_pk_bf16_f32 v238, v192, v190
v_cvt_pk_bf16_f32 v239, v62, v60
ds_write_b64 v202, v[238:239] offset:288
v_cvt_pk_bf16_f32 v240, v193, v191
v_cvt_pk_bf16_f32 v241, v63, v61
ds_write_b64 v202, v[240:241] offset:432
s_mov_b64 exec, -1
v_lshlrev_b32 v194, 16, v10
v_and_b32 v195, 0xffff0000, v10
v_lshlrev_b32 v196, 16, v14
v_and_b32 v197, 0xffff0000, v14
v_lshlrev_b32 v198, 16, v18
v_and_b32 v199, 0xffff0000, v18
v_lshlrev_b32 v236, 16, v22
v_and_b32 v237, 0xffff0000, v22
v_lshlrev_b32 v238, 16, v26
v_and_b32 v239, 0xffff0000, v26
v_lshlrev_b32 v240, 16, v30
v_and_b32 v241, 0xffff0000, v30
v_lshlrev_b32 v242, 16, v34
v_and_b32 v243, 0xffff0000, v34
v_lshlrev_b32 v52, 16, v44
v_lshlrev_b32 v53, 16, v46
v_and_b32 v54, 0xffff0000, v44
v_and_b32 v55, 0xffff0000, v46
v_lshlrev_b32 v56, 16, v45
v_lshlrev_b32 v57, 16, v47
v_and_b32 v58, 0xffff0000, v45
v_and_b32 v59, 0xffff0000, v47
v_pk_mul_f32 v[60:61], v[236:237], v[52:53]
v_pk_mul_f32 v[62:63], v[238:239], v[52:53]
v_pk_mul_f32 v[190:191], v[240:241], v[52:53]
v_pk_mul_f32 v[192:193], v[242:243], v[52:53]
v_pk_fma_f32 v[60:61], v[198:199], v[54:55], v[60:61]
v_pk_fma_f32 v[62:63], v[236:237], v[54:55], v[62:63]
v_pk_fma_f32 v[190:191], v[238:239], v[54:55], v[190:191]
v_pk_fma_f32 v[192:193], v[240:241], v[54:55], v[192:193]
v_pk_fma_f32 v[60:61], v[196:197], v[56:57], v[60:61]
v_pk_fma_f32 v[62:63], v[198:199], v[56:57], v[62:63]
v_pk_fma_f32 v[190:191], v[236:237], v[56:57], v[190:191]
v_pk_fma_f32 v[192:193], v[238:239], v[56:57], v[192:193]
v_pk_fma_f32 v[60:61], v[194:195], v[58:59], v[60:61]
v_pk_fma_f32 v[62:63], v[196:197], v[58:59], v[62:63]
v_pk_fma_f32 v[190:191], v[198:199], v[58:59], v[190:191]
v_pk_fma_f32 v[192:193], v[236:237], v[58:59], v[192:193]
v_lshlrev_b32 v194, 16, v176
v_and_b32 v195, 0xffff0000, v176
v_lshlrev_b32 v196, 16, v180
v_and_b32 v197, 0xffff0000, v180
v_lshlrev_b32 v198, 16, v184
v_and_b32 v199, 0xffff0000, v184
v_lshlrev_b32 v236, 16, v188
v_and_b32 v237, 0xffff0000, v188
v_pk_mul_f32 v[60:61], v[60:61], v[194:195]
v_pk_mul_f32 v[62:63], v[62:63], v[196:197]
v_pk_mul_f32 v[190:191], v[190:191], v[198:199]
v_pk_mul_f32 v[192:193], v[192:193], v[236:237]
s_mov_b32 exec_hi, 0xff
v_cvt_pk_bf16_f32 v238, v192, v190
v_cvt_pk_bf16_f32 v239, v62, v60
ds_write_b64 v202, v[238:239] offset:576
v_cvt_pk_bf16_f32 v240, v193, v191
v_cvt_pk_bf16_f32 v241, v63, v61
ds_write_b64 v202, v[240:241] offset:720
s_mov_b64 exec, -1
v_lshlrev_b32 v194, 16, v11
v_and_b32 v195, 0xffff0000, v11
v_lshlrev_b32 v196, 16, v15
v_and_b32 v197, 0xffff0000, v15
v_lshlrev_b32 v198, 16, v19
v_and_b32 v199, 0xffff0000, v19
v_lshlrev_b32 v236, 16, v23
v_and_b32 v237, 0xffff0000, v23
v_lshlrev_b32 v238, 16, v27
v_and_b32 v239, 0xffff0000, v27
v_lshlrev_b32 v240, 16, v31
v_and_b32 v241, 0xffff0000, v31
v_lshlrev_b32 v242, 16, v35
v_and_b32 v243, 0xffff0000, v35
v_lshlrev_b32 v52, 16, v48
v_lshlrev_b32 v53, 16, v50
v_and_b32 v54, 0xffff0000, v48
v_and_b32 v55, 0xffff0000, v50
v_lshlrev_b32 v56, 16, v49
v_lshlrev_b32 v57, 16, v51
v_and_b32 v58, 0xffff0000, v49
v_and_b32 v59, 0xffff0000, v51
v_pk_mul_f32 v[60:61], v[236:237], v[52:53]
v_pk_mul_f32 v[62:63], v[238:239], v[52:53]
v_pk_mul_f32 v[190:191], v[240:241], v[52:53]
v_pk_mul_f32 v[192:193], v[242:243], v[52:53]
v_pk_fma_f32 v[60:61], v[198:199], v[54:55], v[60:61]
v_pk_fma_f32 v[62:63], v[236:237], v[54:55], v[62:63]
v_pk_fma_f32 v[190:191], v[238:239], v[54:55], v[190:191]
v_pk_fma_f32 v[192:193], v[240:241], v[54:55], v[192:193]
v_pk_fma_f32 v[60:61], v[196:197], v[56:57], v[60:61]
v_pk_fma_f32 v[62:63], v[198:199], v[56:57], v[62:63]
v_pk_fma_f32 v[190:191], v[236:237], v[56:57], v[190:191]
v_pk_fma_f32 v[192:193], v[238:239], v[56:57], v[192:193]
v_pk_fma_f32 v[60:61], v[194:195], v[58:59], v[60:61]
v_pk_fma_f32 v[62:63], v[196:197], v[58:59], v[62:63]
v_pk_fma_f32 v[190:191], v[198:199], v[58:59], v[190:191]
v_pk_fma_f32 v[192:193], v[236:237], v[58:59], v[192:193]
v_lshlrev_b32 v194, 16, v177
v_and_b32 v195, 0xffff0000, v177
v_lshlrev_b32 v196, 16, v181
v_and_b32 v197, 0xffff0000, v181
v_lshlrev_b32 v198, 16, v185
v_and_b32 v199, 0xffff0000, v185
v_lshlrev_b32 v236, 16, v189
v_and_b32 v237, 0xffff0000, v189
v_pk_mul_f32 v[60:61], v[60:61], v[194:195]
v_pk_mul_f32 v[62:63], v[62:63], v[196:197]
v_pk_mul_f32 v[190:191], v[190:191], v[198:199]
v_pk_mul_f32 v[192:193], v[192:193], v[236:237]
s_mov_b32 exec_hi, 0xff
v_cvt_pk_bf16_f32 v238, v192, v190
v_cvt_pk_bf16_f32 v239, v62, v60
ds_write_b64 v202, v[238:239] offset:864
v_cvt_pk_bf16_f32 v240, v193, v191
v_cvt_pk_bf16_f32 v241, v63, v61
ds_write_b64 v202, v[240:241] offset:1008
s_mov_b64 exec, -1
s_add_u32 m0, s81, 32768
s_add_u32 s79, s79, 221184
buffer_load_dwordx4 v208, s[20:23], s79 offen offset:0 lds
buffer_load_dwordx4 v209, s[20:23], s79 offen offset:1024 lds
buffer_load_dwordx4 v210, s[20:23], s79 offen offset:2048 lds
buffer_load_dwordx4 v211, s[20:23], s79 offen offset:3072 lds
s_add_u32 m0, s81, 49152
s_add_u32 s80, s80, 128
buffer_load_dwordx4 v212, s[8:11], s80 offen offset:0 lds
buffer_load_dwordx4 v213, s[8:11], s80 offen offset:1024 lds
buffer_load_dwordx4 v214, s[8:11], s80 offen offset:2048 lds
buffer_load_dwordx4 v215, s[8:11], s80 offen offset:3072 lds
s_waitcnt vmcnt(10)
s_waitcnt lgkmcnt(0)
s_barrier
ds_read_b64_tr_b16 v[128:129], v216 offset:0
ds_read_b64_tr_b16 v[130:131], v216 offset:1024
ds_read_b128 v[136:139], v220 offset:16384
ds_read_b128 v[140:143], v220 offset:20480
ds_read_b64_tr_b16 v[132:133], v217 offset:0
ds_read_b64_tr_b16 v[134:135], v217 offset:1024
ds_read_b128 v[8:11], v203 offset:0
ds_read_b128 v[12:15], v203 offset:1152
ds_read_b128 v[16:19], v203 offset:2304
s_waitcnt lgkmcnt(6)
v_mfma_f32_32x32x16_bf16 v[64:79], v[128:131], v[136:139], 0
ds_read_b64_tr_b16 v[144:145], v216 offset:4096
ds_read_b64_tr_b16 v[146:147], v216 offset:5120
s_add_u32 m0, s81, 65536
s_add_u32 s79, s79, 221184
buffer_load_dwordx4 v208, s[20:23], s79 offen offset:0 lds
s_waitcnt lgkmcnt(7)
v_mfma_f32_32x32x16_bf16 v[80:95], v[128:131], v[140:143], 0
ds_read_b128 v[152:155], v221 offset:16384
ds_read_b128 v[156:159], v221 offset:20480
buffer_load_dwordx4 v209, s[20:23], s79 offen offset:1024 lds
v_mfma_f32_16x16x32_bf16 v[164:167], v[160:163], v[128:131], 0
s_waitcnt lgkmcnt(7)
v_mfma_f32_32x32x16_bf16 v[96:111], v[132:135], v[136:139], 0
ds_read_b64_tr_b16 v[148:149], v217 offset:4096
ds_read_b64_tr_b16 v[150:151], v217 offset:5120
buffer_load_dwordx4 v210, s[20:23], s79 offen offset:2048 lds
v_mfma_f32_32x32x16_bf16 v[112:127], v[132:135], v[140:143], 0
buffer_load_dwordx4 v211, s[20:23], s79 offen offset:3072 lds
v_mfma_f32_16x16x32_bf16 v[168:171], v[160:163], v[132:135], 0
s_waitcnt lgkmcnt(3)
v_mfma_f32_32x32x16_bf16 v[64:79], v[144:147], v[152:155], v[64:79]
ds_read_b64_tr_b16 v[128:129], v216 offset:8192
ds_read_b64_tr_b16 v[130:131], v216 offset:9216
s_add_u32 m0, s81, 81920
s_add_u32 s80, s80, 128
buffer_load_dwordx4 v212, s[8:11], s80 offen offset:0 lds
s_waitcnt lgkmcnt(4)
v_mfma_f32_32x32x16_bf16 v[80:95], v[144:147], v[156:159], v[80:95]
ds_read_b128 v[136:139], v222 offset:16384
ds_read_b128 v[140:143], v222 offset:20480
buffer_load_dwordx4 v213, s[8:11], s80 offen offset:1024 lds
v_mfma_f32_16x16x32_bf16 v[164:167], v[160:163], v[144:147], v[164:167]
s_waitcnt lgkmcnt(4)
v_mfma_f32_32x32x16_bf16 v[96:111], v[148:151], v[152:155], v[96:111]
ds_read_b64_tr_b16 v[132:133], v217 offset:8192
ds_read_b64_tr_b16 v[134:135], v217 offset:9216
buffer_load_dwordx4 v214, s[8:11], s80 offen offset:2048 lds
v_mfma_f32_32x32x16_bf16 v[112:127], v[148:151], v[156:159], v[112:127]
buffer_load_dwordx4 v215, s[8:11], s80 offen offset:3072 lds
v_mfma_f32_16x16x32_bf16 v[168:171], v[160:163], v[148:151], v[168:171]
s_waitcnt lgkmcnt(3)
v_mfma_f32_32x32x16_bf16 v[64:79], v[128:131], v[136:139], v[64:79]
ds_read_b64_tr_b16 v[144:145], v216 offset:12288
ds_read_b64_tr_b16 v[146:147], v216 offset:13312
s_waitcnt vmcnt(8)
s_cmp_eq_u32 s82, 0
s_cbranch_scc0 L_nb_3
s_barrier
L_nb_3:
s_waitcnt lgkmcnt(4)
v_mfma_f32_32x32x16_bf16 v[80:95], v[128:131], v[140:143], v[80:95]
ds_read_b128 v[152:155], v223 offset:16384
ds_read_b128 v[156:159], v223 offset:20480
s_cmp_eq_u32 s82, 1
s_cbranch_scc0 L_nb_4
s_barrier
L_nb_4:
v_mfma_f32_16x16x32_bf16 v[164:167], v[160:163], v[128:131], v[164:167]
s_waitcnt lgkmcnt(4)
v_mfma_f32_32x32x16_bf16 v[96:111], v[132:135], v[136:139], v[96:111]
ds_read_b64_tr_b16 v[148:149], v217 offset:12288
ds_read_b64_tr_b16 v[150:151], v217 offset:13312
s_add_u32 m0, s81, 98304
s_add_u32 s79, s79, 221184
buffer_load_dwordx4 v208, s[20:23], s79 offen offset:0 lds
v_mfma_f32_32x32x16_bf16 v[112:127], v[132:135], v[140:143], v[112:127]
buffer_store_dwordx4 v[8:11], v172, s[24:27], s70 offen sc1
v_mfma_f32_16x16x32_bf16 v[168:171], v[160:163], v[132:135], v[168:171]
s_waitcnt lgkmcnt(3)
v_mfma_f32_32x32x16_bf16 v[64:79], v[144:147], v[152:155], v[64:79]
ds_read_b64_tr_b16 v[128:129], v216 offset:32768
ds_read_b64_tr_b16 v[130:131], v216 offset:33792
buffer_load_dwordx4 v209, s[20:23], s79 offen offset:1024 lds
s_waitcnt lgkmcnt(4)
v_mfma_f32_32x32x16_bf16 v[80:95], v[144:147], v[156:159], v[80:95]
ds_read_b128 v[136:139], v220 offset:49152
ds_read_b128 v[140:143], v220 offset:53248
v_mfma_f32_16x16x32_bf16 v[164:167], v[160:163], v[144:147], v[164:167]
s_waitcnt lgkmcnt(4)
v_mfma_f32_32x32x16_bf16 v[96:111], v[148:151], v[152:155], v[96:111]
ds_read_b64_tr_b16 v[132:133], v217 offset:32768
ds_read_b64_tr_b16 v[134:135], v217 offset:33792
buffer_load_dwordx4 v210, s[20:23], s79 offen offset:2048 lds
v_mfma_f32_32x32x16_bf16 v[112:127], v[148:151], v[156:159], v[112:127]
v_mfma_f32_16x16x32_bf16 v[168:171], v[160:163], v[148:151], v[168:171]
s_waitcnt lgkmcnt(3)
v_mfma_f32_32x32x16_bf16 v[64:79], v[128:131], v[136:139], v[64:79]
ds_read_b64_tr_b16 v[144:145], v216 offset:36864
ds_read_b64_tr_b16 v[146:147], v216 offset:37888
buffer_load_dwordx4 v211, s[20:23], s79 offen offset:3072 lds
s_waitcnt lgkmcnt(4)
v_mfma_f32_32x32x16_bf16 v[80:95], v[128:131], v[140:143], v[80:95]
ds_read_b128 v[152:155], v221 offset:49152
ds_read_b128 v[156:159], v221 offset:53248
v_mfma_f32_16x16x32_bf16 v[164:167], v[160:163], v[128:131], v[164:167]
s_waitcnt lgkmcnt(4)
v_mfma_f32_32x32x16_bf16 v[96:111], v[132:135], v[136:139], v[96:111]
ds_read_b64_tr_b16 v[148:149], v217 offset:36864
ds_read_b64_tr_b16 v[150:151], v217 offset:37888
s_add_u32 m0, s81, 114688
s_add_u32 s80, s80, 128
buffer_load_dwordx4 v212, s[8:11], s80 offen offset:0 lds
v_mfma_f32_32x32x16_bf16 v[112:127], v[132:135], v[140:143], v[112:127]
buffer_store_dwordx4 v[12:15], v172, s[24:27], s71 offen sc1
v_mfma_f32_16x16x32_bf16 v[168:171], v[160:163], v[132:135], v[168:171]
s_waitcnt lgkmcnt(3)
v_mfma_f32_32x32x16_bf16 v[64:79], v[144:147], v[152:155], v[64:79]
ds_read_b64_tr_b16 v[128:129], v216 offset:40960
ds_read_b64_tr_b16 v[130:131], v216 offset:41984
buffer_load_dwordx4 v213, s[8:11], s80 offen offset:1024 lds
s_waitcnt lgkmcnt(4)
v_mfma_f32_32x32x16_bf16 v[80:95], v[144:147], v[156:159], v[80:95]
ds_read_b128 v[136:139], v222 offset:49152
ds_read_b128 v[140:143], v222 offset:53248
v_mfma_f32_16x16x32_bf16 v[164:167], v[160:163], v[144:147], v[164:167]
s_waitcnt lgkmcnt(4)
v_mfma_f32_32x32x16_bf16 v[96:111], v[148:151], v[152:155], v[96:111]
ds_read_b64_tr_b16 v[132:133], v217 offset:40960
ds_read_b64_tr_b16 v[134:135], v217 offset:41984
buffer_load_dwordx4 v214, s[8:11], s80 offen offset:2048 lds
v_mfma_f32_32x32x16_bf16 v[112:127], v[148:151], v[156:159], v[112:127]
v_mfma_f32_16x16x32_bf16 v[168:171], v[160:163], v[148:151], v[168:171]
s_waitcnt lgkmcnt(3)
v_mfma_f32_32x32x16_bf16 v[64:79], v[128:131], v[136:139], v[64:79]
ds_read_b64_tr_b16 v[144:145], v216 offset:45056
ds_read_b64_tr_b16 v[146:147], v216 offset:46080
s_waitcnt vmcnt(9)
s_cmp_eq_u32 s82, 0
s_cbranch_scc0 L_nb_5
s_barrier
L_nb_5:
buffer_load_dwordx4 v215, s[8:11], s80 offen offset:3072 lds
s_waitcnt lgkmcnt(4)
v_mfma_f32_32x32x16_bf16 v[80:95], v[128:131], v[140:143], v[80:95]
ds_read_b128 v[152:155], v223 offset:49152
ds_read_b128 v[156:159], v223 offset:53248
s_cmp_eq_u32 s82, 1
s_cbranch_scc0 L_nb_6
s_barrier
L_nb_6:
v_mfma_f32_16x16x32_bf16 v[164:167], v[160:163], v[128:131], v[164:167]
s_waitcnt lgkmcnt(4)
v_mfma_f32_32x32x16_bf16 v[96:111], v[132:135], v[136:139], v[96:111]
ds_read_b64_tr_b16 v[148:149], v217 offset:45056
ds_read_b64_tr_b16 v[150:151], v217 offset:46080
s_add_u32 m0, s81, 0
s_add_u32 s79, s79, 221184
buffer_load_dwordx4 v208, s[20:23], s79 offen offset:0 lds
v_mfma_f32_32x32x16_bf16 v[112:127], v[132:135], v[140:143], v[112:127]
s_mov_b32 exec_hi, 0
buffer_store_dwordx4 v[16:19], v172, s[24:27], s72 offen sc1
s_mov_b64 exec, -1
v_mfma_f32_16x16x32_bf16 v[168:171], v[160:163], v[132:135], v[168:171]
s_waitcnt lgkmcnt(3)
v_mfma_f32_32x32x16_bf16 v[64:79], v[144:147], v[152:155], v[64:79]
ds_read_b64_tr_b16 v[128:129], v218 offset:0
ds_read_b64_tr_b16 v[130:131], v218 offset:1024
buffer_load_dwordx4 v209, s[20:23], s79 offen offset:1024 lds
s_waitcnt lgkmcnt(4)
v_mfma_f32_32x32x16_bf16 v[80:95], v[144:147], v[156:159], v[80:95]
ds_read_b128 v[136:139], v224 offset:16384
ds_read_b128 v[140:143], v224 offset:20480
v_mfma_f32_16x16x32_bf16 v[164:167], v[160:163], v[144:147], v[164:167]
s_waitcnt lgkmcnt(4)
v_mfma_f32_32x32x16_bf16 v[96:111], v[148:151], v[152:155], v[96:111]
ds_read_b64_tr_b16 v[132:133], v219 offset:0
ds_read_b64_tr_b16 v[134:135], v219 offset:1024
buffer_load_dwordx4 v210, s[20:23], s79 offen offset:2048 lds
v_mfma_f32_32x32x16_bf16 v[112:127], v[148:151], v[156:159], v[112:127]
v_mfma_f32_16x16x32_bf16 v[168:171], v[160:163], v[148:151], v[168:171]
s_waitcnt lgkmcnt(3)
v_mfma_f32_32x32x16_bf16 v[64:79], v[128:131], v[136:139], v[64:79]
ds_read_b64_tr_b16 v[144:145], v218 offset:4096
ds_read_b64_tr_b16 v[146:147], v218 offset:5120
buffer_load_dwordx4 v211, s[20:23], s79 offen offset:3072 lds
s_waitcnt lgkmcnt(4)
v_mfma_f32_32x32x16_bf16 v[80:95], v[128:131], v[140:143], v[80:95]
ds_read_b128 v[152:155], v225 offset:16384
ds_read_b128 v[156:159], v225 offset:20480
v_mfma_f32_16x16x32_bf16 v[164:167], v[160:163], v[128:131], v[164:167]
s_waitcnt lgkmcnt(4)
v_mfma_f32_32x32x16_bf16 v[96:111], v[132:135], v[136:139], v[96:111]
ds_read_b64_tr_b16 v[148:149], v219 offset:4096
ds_read_b64_tr_b16 v[150:151], v219 offset:5120
s_add_u32 m0, s81, 16384
s_add_u32 s80, s80, 128
buffer_load_dwordx4 v212, s[8:11], s80 offen offset:0 lds
v_mfma_f32_32x32x16_bf16 v[112:127], v[132:135], v[140:143], v[112:127]
v_mfma_f32_16x16x32_bf16 v[168:171], v[160:163], v[132:135], v[168:171]
s_waitcnt lgkmcnt(3)
v_mfma_f32_32x32x16_bf16 v[64:79], v[144:147], v[152:155], v[64:79]
ds_read_b64_tr_b16 v[128:129], v218 offset:8192
ds_read_b64_tr_b16 v[130:131], v218 offset:9216
buffer_load_dwordx4 v213, s[8:11], s80 offen offset:1024 lds
s_waitcnt lgkmcnt(4)
v_mfma_f32_32x32x16_bf16 v[80:95], v[144:147], v[156:159], v[80:95]
ds_read_b128 v[136:139], v226 offset:16384
ds_read_b128 v[140:143], v226 offset:20480
v_mfma_f32_16x16x32_bf16 v[164:167], v[160:163], v[144:147], v[164:167]
s_waitcnt lgkmcnt(4)
v_mfma_f32_32x32x16_bf16 v[96:111], v[148:151], v[152:155], v[96:111]
ds_read_b64_tr_b16 v[132:133], v219 offset:8192
ds_read_b64_tr_b16 v[134:135], v219 offset:9216
buffer_load_dwordx4 v214, s[8:11], s80 offen offset:2048 lds
v_mfma_f32_32x32x16_bf16 v[112:127], v[148:151], v[156:159], v[112:127]
buffer_load_dword v254, v230, s[52:55], 0 offen sc1
v_mfma_f32_16x16x32_bf16 v[168:171], v[160:163], v[148:151], v[168:171]
s_waitcnt lgkmcnt(3)
v_mfma_f32_32x32x16_bf16 v[64:79], v[128:131], v[136:139], v[64:79]
ds_read_b64_tr_b16 v[144:145], v218 offset:12288
ds_read_b64_tr_b16 v[146:147], v218 offset:13312
s_waitcnt vmcnt(9)
s_cmp_eq_u32 s82, 0
s_cbranch_scc0 L_nb_7
s_barrier
L_nb_7:
buffer_load_dwordx4 v215, s[8:11], s80 offen offset:3072 lds
s_waitcnt lgkmcnt(4)
v_mfma_f32_32x32x16_bf16 v[80:95], v[128:131], v[140:143], v[80:95]
ds_read_b128 v[152:155], v227 offset:16384
ds_read_b128 v[156:159], v227 offset:20480
s_cmp_eq_u32 s82, 1
s_cbranch_scc0 L_nb_8
s_barrier
L_nb_8:
v_mfma_f32_16x16x32_bf16 v[164:167], v[160:163], v[128:131], v[164:167]
s_waitcnt lgkmcnt(4)
v_mfma_f32_32x32x16_bf16 v[96:111], v[132:135], v[136:139], v[96:111]
ds_read_b64_tr_b16 v[148:149], v219 offset:12288
ds_read_b64_tr_b16 v[150:151], v219 offset:13312
s_add_u32 m0, s81, 32768
s_add_u32 s79, s79, 221184
buffer_load_dwordx4 v208, s[20:23], s79 offen offset:0 lds
v_mfma_f32_32x32x16_bf16 v[112:127], v[132:135], v[140:143], v[112:127]
v_mfma_f32_16x16x32_bf16 v[168:171], v[160:163], v[132:135], v[168:171]
s_waitcnt lgkmcnt(3)
v_mfma_f32_32x32x16_bf16 v[64:79], v[144:147], v[152:155], v[64:79]
ds_read_b64_tr_b16 v[128:129], v218 offset:32768
ds_read_b64_tr_b16 v[130:131], v218 offset:33792
buffer_load_dwordx4 v209, s[20:23], s79 offen offset:1024 lds
s_waitcnt lgkmcnt(4)
v_mfma_f32_32x32x16_bf16 v[80:95], v[144:147], v[156:159], v[80:95]
ds_read_b128 v[136:139], v224 offset:49152
ds_read_b128 v[140:143], v224 offset:53248
v_mfma_f32_16x16x32_bf16 v[164:167], v[160:163], v[144:147], v[164:167]
s_waitcnt lgkmcnt(4)
v_mfma_f32_32x32x16_bf16 v[96:111], v[148:151], v[152:155], v[96:111]
ds_read_b64_tr_b16 v[132:133], v219 offset:32768
ds_read_b64_tr_b16 v[134:135], v219 offset:33792
buffer_load_dwordx4 v210, s[20:23], s79 offen offset:2048 lds
v_mfma_f32_32x32x16_bf16 v[112:127], v[148:151], v[156:159], v[112:127]
v_mfma_f32_16x16x32_bf16 v[168:171], v[160:163], v[148:151], v[168:171]
s_waitcnt lgkmcnt(3)
v_mfma_f32_32x32x16_bf16 v[64:79], v[128:131], v[136:139], v[64:79]
ds_read_b64_tr_b16 v[144:145], v218 offset:36864
ds_read_b64_tr_b16 v[146:147], v218 offset:37888
buffer_load_dwordx4 v211, s[20:23], s79 offen offset:3072 lds
s_waitcnt lgkmcnt(4)
v_mfma_f32_32x32x16_bf16 v[80:95], v[128:131], v[140:143], v[80:95]
ds_read_b128 v[152:155], v225 offset:49152
ds_read_b128 v[156:159], v225 offset:53248
s_mov_b32 m0, s74
s_nop 0
buffer_load_dwordx4 v204, s[36:39], 0 offen lds
s_mov_b32 m0, s74
s_nop 0
buffer_load_dwordx4 v205, s[36:39], 0 offen offset:1024 lds
s_mov_b32 m0, s74
s_mov_b32 exec_hi, 0
buffer_load_dwordx4 v206, s[36:39], 0 offen offset:2048 lds
s_mov_b64 exec, -1
v_mfma_f32_16x16x32_bf16 v[164:167], v[160:163], v[128:131], v[164:167]
s_waitcnt lgkmcnt(4)
v_mfma_f32_32x32x16_bf16 v[96:111], v[132:135], v[136:139], v[96:111]
ds_read_b64_tr_b16 v[148:149], v219 offset:36864
ds_read_b64_tr_b16 v[150:151], v219 offset:37888
s_add_u32 m0, s81, 49152
s_add_u32 s80, s80, 128
buffer_load_dwordx4 v212, s[8:11], s80 offen offset:0 lds
v_mfma_f32_32x32x16_bf16 v[112:127], v[132:135], v[140:143], v[112:127]
v_mfma_f32_16x16x32_bf16 v[168:171], v[160:163], v[132:135], v[168:171]
s_waitcnt lgkmcnt(3)
v_mfma_f32_32x32x16_bf16 v[64:79], v[144:147], v[152:155], v[64:79]
ds_read_b64_tr_b16 v[128:129], v218 offset:40960
ds_read_b64_tr_b16 v[130:131], v218 offset:41984
buffer_load_dwordx4 v213, s[8:11], s80 offen offset:1024 lds
s_waitcnt lgkmcnt(4)
v_mfma_f32_32x32x16_bf16 v[80:95], v[144:147], v[156:159], v[80:95]
ds_read_b128 v[136:139], v226 offset:49152
ds_read_b128 v[140:143], v226 offset:53248
v_mfma_f32_16x16x32_bf16 v[164:167], v[160:163], v[144:147], v[164:167]
s_waitcnt lgkmcnt(4)
v_mfma_f32_32x32x16_bf16 v[96:111], v[148:151], v[152:155], v[96:111]
ds_read_b64_tr_b16 v[132:133], v219 offset:40960
ds_read_b64_tr_b16 v[134:135], v219 offset:41984
buffer_load_dwordx4 v214, s[8:11], s80 offen offset:2048 lds
v_mfma_f32_32x32x16_bf16 v[112:127], v[148:151], v[156:159], v[112:127]
v_mfma_f32_16x16x32_bf16 v[168:171], v[160:163], v[148:151], v[168:171]
s_waitcnt lgkmcnt(3)
v_mfma_f32_32x32x16_bf16 v[64:79], v[128:131], v[136:139], v[64:79]
ds_read_b64_tr_b16 v[144:145], v218 offset:45056
ds_read_b64_tr_b16 v[146:147], v218 offset:46080
s_waitcnt vmcnt(10)
s_cmp_eq_u32 s82, 0
s_cbranch_scc0 L_nb_9
s_barrier
L_nb_9:
buffer_load_dwordx4 v215, s[8:11], s80 offen offset:3072 lds
s_waitcnt lgkmcnt(4)
v_mfma_f32_32x32x16_bf16 v[80:95], v[128:131], v[140:143], v[80:95]
ds_read_b128 v[152:155], v227 offset:49152
ds_read_b128 v[156:159], v227 offset:53248
s_cmp_eq_u32 s82, 1
s_cbranch_scc0 L_nb_10
s_barrier
L_nb_10:
s_mov_b32 exec_lo, 0x0
s_mov_b32 exec_hi, 0xff000000
buffer_load_dword v234, v232, s[20:23], 0 offen
s_mov_b64 exec, -1
s_mov_b32 s6, 1769472
s_mov_b32 exec_lo, 0xffff
s_mov_b32 exec_hi, 0x0
buffer_load_dword v234, v232, s[20:23], s6 offen
s_mov_b64 exec, -1
s_mov_b32 exec_lo, 0x0
s_mov_b32 exec_hi, 0x3fff8
buffer_load_dword v234, v233, s[8:11], 0 offen
s_mov_b64 exec, -1
v_mfma_f32_16x16x32_bf16 v[164:167], v[160:163], v[128:131], v[164:167]
s_waitcnt lgkmcnt(4)
v_mfma_f32_32x32x16_bf16 v[96:111], v[132:135], v[136:139], v[96:111]
ds_read_b64_tr_b16 v[148:149], v219 offset:45056
ds_read_b64_tr_b16 v[150:151], v219 offset:46080
s_add_u32 m0, s81, 65536
s_add_u32 s79, s79, 221184
buffer_load_dwordx4 v208, s[20:23], s79 offen offset:0 lds
v_mfma_f32_32x32x16_bf16 v[112:127], v[132:135], v[140:143], v[112:127]
v_mfma_f32_16x16x32_bf16 v[168:171], v[160:163], v[132:135], v[168:171]
s_waitcnt lgkmcnt(3)
v_mfma_f32_32x32x16_bf16 v[64:79], v[144:147], v[152:155], v[64:79]
ds_read_b64_tr_b16 v[128:129], v216 offset:0
ds_read_b64_tr_b16 v[130:131], v216 offset:1024
buffer_load_dwordx4 v209, s[20:23], s79 offen offset:1024 lds
s_waitcnt lgkmcnt(4)
v_mfma_f32_32x32x16_bf16 v[80:95], v[144:147], v[156:159], v[80:95]
ds_read_b128 v[136:139], v220 offset:16384
ds_read_b128 v[140:143], v220 offset:20480
v_mfma_f32_16x16x32_bf16 v[164:167], v[160:163], v[144:147], v[164:167]
s_waitcnt lgkmcnt(4)
v_mfma_f32_32x32x16_bf16 v[96:111], v[148:151], v[152:155], v[96:111]
ds_read_b64_tr_b16 v[132:133], v217 offset:0
ds_read_b64_tr_b16 v[134:135], v217 offset:1024
buffer_load_dwordx4 v210, s[20:23], s79 offen offset:2048 lds
v_mfma_f32_32x32x16_bf16 v[112:127], v[148:151], v[156:159], v[112:127]
v_mfma_f32_16x16x32_bf16 v[168:171], v[160:163], v[148:151], v[168:171]
s_waitcnt lgkmcnt(3)
v_mfma_f32_32x32x16_bf16 v[64:79], v[128:131], v[136:139], v[64:79]
ds_read_b64_tr_b16 v[144:145], v216 offset:4096
ds_read_b64_tr_b16 v[146:147], v216 offset:5120
buffer_load_dwordx4 v211, s[20:23], s79 offen offset:3072 lds
s_waitcnt lgkmcnt(4)
v_mfma_f32_32x32x16_bf16 v[80:95], v[128:131], v[140:143], v[80:95]
ds_read_b128 v[152:155], v221 offset:16384
ds_read_b128 v[156:159], v221 offset:20480
v_mfma_f32_16x16x32_bf16 v[164:167], v[160:163], v[128:131], v[164:167]
s_waitcnt lgkmcnt(4)
v_mfma_f32_32x32x16_bf16 v[96:111], v[132:135], v[136:139], v[96:111]
ds_read_b64_tr_b16 v[148:149], v217 offset:4096
ds_read_b64_tr_b16 v[150:151], v217 offset:5120
s_add_u32 m0, s81, 81920
s_add_u32 s80, s80, 128
buffer_load_dwordx4 v212, s[8:11], s80 offen offset:0 lds
v_mfma_f32_32x32x16_bf16 v[112:127], v[132:135], v[140:143], v[112:127]
v_mfma_f32_16x16x32_bf16 v[168:171], v[160:163], v[132:135], v[168:171]
s_waitcnt lgkmcnt(3)
v_mfma_f32_32x32x16_bf16 v[64:79], v[144:147], v[152:155], v[64:79]
ds_read_b64_tr_b16 v[128:129], v216 offset:8192
ds_read_b64_tr_b16 v[130:131], v216 offset:9216
buffer_load_dwordx4 v213, s[8:11], s80 offen offset:1024 lds
s_waitcnt lgkmcnt(4)
v_mfma_f32_32x32x16_bf16 v[80:95], v[144:147], v[156:159], v[80:95]
ds_read_b128 v[136:139], v222 offset:16384
ds_read_b128 v[140:143], v222 offset:20480
v_mfma_f32_16x16x32_bf16 v[164:167], v[160:163], v[144:147], v[164:167]
s_waitcnt lgkmcnt(4)
v_mfma_f32_32x32x16_bf16 v[96:111], v[148:151], v[152:155], v[96:111]
ds_read_b64_tr_b16 v[132:133], v217 offset:8192
ds_read_b64_tr_b16 v[134:135], v217 offset:9216
buffer_load_dwordx4 v214, s[8:11], s80 offen offset:2048 lds
v_mfma_f32_32x32x16_bf16 v[112:127], v[148:151], v[156:159], v[112:127]
v_mfma_f32_16x16x32_bf16 v[168:171], v[160:163], v[148:151], v[168:171]
s_waitcnt lgkmcnt(3)
v_mfma_f32_32x32x16_bf16 v[64:79], v[128:131], v[136:139], v[64:79]
ds_read_b64_tr_b16 v[144:145], v216 offset:12288
ds_read_b64_tr_b16 v[146:147], v216 offset:13312
s_waitcnt vmcnt(10)
s_cmp_lg_u32 s5, 0
s_cbranch_scc1 L_back_12
v_cmp_gt_u32 vcc, 32, v254
s_cbranch_vccnz L_slow_11
L_back_12:
s_cmp_eq_u32 s82, 0
s_cbranch_scc0 L_nb_13
s_barrier
L_nb_13:
buffer_load_dwordx4 v215, s[8:11], s80 offen offset:3072 lds
s_waitcnt lgkmcnt(4)
v_mfma_f32_32x32x16_bf16 v[80:95], v[128:131], v[140:143], v[80:95]
ds_read_b128 v[152:155], v223 offset:16384
ds_read_b128 v[156:159], v223 offset:20480
s_cmp_eq_u32 s82, 1
s_cbranch_scc0 L_nb_14
s_barrier
L_nb_14:
s_cmp_lg_u32 s5, 0
s_cbranch_scc1 L_fl_15
s_mov_b64 exec, 1
buffer_store_dword v253, v252, s[24:27], 0 offen offset:0 sc1
s_mov_b64 exec, -1
L_fl_15:
v_mfma_f32_16x16x32_bf16 v[164:167], v[160:163], v[128:131], v[164:167]
s_waitcnt lgkmcnt(4)
v_mfma_f32_32x32x16_bf16 v[96:111], v[132:135], v[136:139], v[96:111]
ds_read_b64_tr_b16 v[148:149], v217 offset:12288
ds_read_b64_tr_b16 v[150:151], v217 offset:13312
s_add_u32 m0, s81, 98304
s_add_u32 s79, s79, 221184
buffer_load_dwordx4 v208, s[20:23], s79 offen offset:0 lds
v_mfma_f32_32x32x16_bf16 v[112:127], v[132:135], v[140:143], v[112:127]
v_mfma_f32_16x16x32_bf16 v[168:171], v[160:163], v[132:135], v[168:171]
s_waitcnt lgkmcnt(3)
v_mfma_f32_32x32x16_bf16 v[64:79], v[144:147], v[152:155], v[64:79]
ds_read_b64_tr_b16 v[128:129], v216 offset:32768
ds_read_b64_tr_b16 v[130:131], v216 offset:33792
buffer_load_dwordx4 v209, s[20:23], s79 offen offset:1024 lds
ds_read_b64_tr_b16 v[174:175], v200
ds_read_b64_tr_b16 v[176:177], v200 offset:2560
s_lshl_b32 s6, s89, 2
s_add_u32 s6, s6, s5
s_lshl_b32 s7, s6, 1
s_waitcnt lgkmcnt(6)
v_mfma_f32_32x32x16_bf16 v[80:95], v[144:147], v[156:159], v[80:95]
ds_read_b128 v[136:139], v220 offset:49152
ds_read_b128 v[140:143], v220 offset:53248
ds_read_b64_tr_b16 v[178:179], v201
ds_read_b64_tr_b16 v[180:181], v201 offset:2560
s_lshr_b32 s85, 6436, s7
s_and_b32 s85, s85, 3
s_lshr_b32 s86, 55, s6
v_mfma_f32_16x16x32_bf16 v[164:167], v[160:163], v[144:147], v[164:167]
s_waitcnt lgkmcnt(8)
v_mfma_f32_32x32x16_bf16 v[96:111], v[148:151], v[152:155], v[96:111]
ds_read_b64_tr_b16 v[132:133], v217 offset:32768
ds_read_b64_tr_b16 v[134:135], v217 offset:33792
buffer_load_dwordx4 v210, s[20:23], s79 offen offset:2048 lds
ds_read_b64_tr_b16 v[182:183], v246
ds_read_b64_tr_b16 v[184:185], v246 offset:2560
s_and_b32 s86, s86, 1
s_lshr_b32 s87, 61311, s7
s_and_b32 s87, s87, 3
v_mfma_f32_32x32x16_bf16 v[112:127], v[148:151], v[156:159], v[112:127]
v_and_b32 v2, 3, v1
v_mul_u32_u24 v2, 4416, v2
v_bfe_u32 v3, v1, 2, 2
v_mfma_f32_16x16x32_bf16 v[168:171], v[160:163], v[148:151], v[168:171]
s_waitcnt lgkmcnt(7)
v_mfma_f32_32x32x16_bf16 v[64:79], v[128:131], v[136:139], v[64:79]
ds_read_b64_tr_b16 v[144:145], v216 offset:36864
ds_read_b64_tr_b16 v[146:147], v216 offset:37888
buffer_load_dwordx4 v211, s[20:23], s79 offen offset:3072 lds
v_lshrrev_b32 v18, 4, v1
v_add_u32 v3, v3, v18
v_lshl_add_u32 v16, v3, 4, v2
s_waitcnt lgkmcnt(8)
v_mfma_f32_32x32x16_bf16 v[80:95], v[128:131], v[140:143], v[80:95]
ds_read_b128 v[152:155], v221 offset:49152
ds_read_b128 v[156:159], v221 offset:53248
v_and_b32 v2, 1, v1
v_mul_u32_u24 v2, 6784, v2
v_bfe_u32 v3, v1, 1, 3
v_mfma_f32_16x16x32_bf16 v[164:167], v[160:163], v[128:131], v[164:167]
s_waitcnt lgkmcnt(6)
v_mfma_f32_32x32x16_bf16 v[96:111], v[132:135], v[136:139], v[96:111]
ds_read_b64_tr_b16 v[148:149], v217 offset:36864
ds_read_b64_tr_b16 v[150:151], v217 offset:37888
s_add_u32 m0, s81, 114688
s_add_u32 s80, s80, 128
buffer_load_dwordx4 v212, s[8:11], s80 offen offset:0 lds
s_lshl_b32 s6, s86, 3
s_sub_u32 s6, 15, s6
v_sub_u32 v5, s6, v3
v_mfma_f32_32x32x16_bf16 v[112:127], v[132:135], v[140:143], v[112:127]
v_mul_u32_u24 v5, 288, v5
v_add_u32 v2, v2, v5
v_lshl_add_u32 v17, v18, 4, v2
v_mfma_f32_16x16x32_bf16 v[168:171], v[160:163], v[132:135], v[168:171]
s_waitcnt lgkmcnt(3)
v_mfma_f32_32x32x16_bf16 v[64:79], v[144:147], v[152:155], v[64:79]
ds_read_b64_tr_b16 v[128:129], v216 offset:40960
ds_read_b64_tr_b16 v[130:131], v216 offset:41984
buffer_load_dwordx4 v213, s[8:11], s80 offen offset:1024 lds
s_lshl_b32 s6, s86, 3
v_add_u32 v3, s6, v3
v_lshlrev_b32 v3, 8, v3
s_waitcnt lgkmcnt(4)
v_mfma_f32_32x32x16_bf16 v[80:95], v[144:147], v[156:159], v[80:95]
ds_read_b128 v[136:139], v222 offset:49152
ds_read_b128 v[140:143], v222 offset:53248
v_and_b32 v2, 1, v1
v_lshl_or_b32 v2, v18, 1, v2
v_lshl_or_b32 v11, v2, 4, v3
v_mfma_f32_16x16x32_bf16 v[164:167], v[160:163], v[144:147], v[164:167]
s_waitcnt lgkmcnt(4)
v_mfma_f32_32x32x16_bf16 v[96:111], v[148:151], v[152:155], v[96:111]
ds_read_b64_tr_b16 v[132:133], v217 offset:40960
ds_read_b64_tr_b16 v[134:135], v217 offset:41984
buffer_load_dwordx4 v214, s[8:11], s80 offen offset:2048 lds
s_mul_i32 s6, s85, 31232
s_add_u32 s6, s6, 65536
v_add_u32 v8, s6, v16
v_mfma_f32_32x32x16_bf16 v[112:127], v[148:151], v[156:159], v[112:127]
buffer_load_dword v254, v231, s[24:27], 0 offen sc1
s_add_u32 s6, s6, 17664
v_add_u32 v9, s6, v17
v_lshlrev_b32 v10, 5, v18
v_mfma_f32_16x16x32_bf16 v[168:171], v[160:163], v[148:151], v[168:171]
s_waitcnt lgkmcnt(3)
v_mfma_f32_32x32x16_bf16 v[64:79], v[128:131], v[136:139], v[64:79]
ds_read_b64_tr_b16 v[144:145], v216 offset:45056
ds_read_b64_tr_b16 v[146:147], v216 offset:46080
s_waitcnt vmcnt(8)
s_cmp_eq_u32 s82, 0
s_cbranch_scc0 L_nb_16
s_barrier
L_nb_16:
buffer_load_dwordx4 v215, s[8:11], s80 offen offset:3072 lds
s_waitcnt lgkmcnt(4)
v_mfma_f32_32x32x16_bf16 v[80:95], v[128:131], v[140:143], v[80:95]
ds_read_b128 v[152:155], v223 offset:49152
ds_read_b128 v[156:159], v223 offset:53248
s_cmp_eq_u32 s82, 1
s_cbranch_scc0 L_nb_17
s_barrier
L_nb_17:
buffer_store_dwordx4 v[174:177], v207, s[24:27], s75 offen sc1
v_mfma_f32_16x16x32_bf16 v[164:167], v[160:163], v[128:131], v[164:167]
s_waitcnt lgkmcnt(4)
v_mfma_f32_32x32x16_bf16 v[96:111], v[132:135], v[136:139], v[96:111]
ds_read_b64_tr_b16 v[148:149], v217 offset:45056
ds_read_b64_tr_b16 v[150:151], v217 offset:46080
s_add_u32 m0, s81, 0
s_add_u32 s79, s79, 221184
buffer_load_dwordx4 v208, s[20:23], s79 offen offset:0 lds
buffer_store_dwordx4 v[178:181], v207, s[24:27], s76 offen sc1
v_mfma_f32_32x32x16_bf16 v[112:127], v[132:135], v[140:143], v[112:127]
v_mfma_f32_16x16x32_bf16 v[168:171], v[160:163], v[132:135], v[168:171]
s_waitcnt lgkmcnt(3)
v_mfma_f32_32x32x16_bf16 v[64:79], v[144:147], v[152:155], v[64:79]
ds_read_b64_tr_b16 v[128:129], v218 offset:0
ds_read_b64_tr_b16 v[130:131], v218 offset:1024
buffer_load_dwordx4 v209, s[20:23], s79 offen offset:1024 lds
v_sub_u32 v10, v9, v10
v_add_u32 v10, 0, v10
s_add_u32 s91, s88, s85
s_waitcnt lgkmcnt(4)
v_mfma_f32_32x32x16_bf16 v[80:95], v[144:147], v[156:159], v[80:95]
ds_read_b128 v[136:139], v224 offset:16384
ds_read_b128 v[140:143], v224 offset:20480
s_and_b32 s46, s88, 0xfffffffe
s_sub_u32 s46, s91, s46
s_cmp_ge_u32 s46, 2
s_cselect_b32 s47, s1, s0
v_mfma_f32_16x16x32_bf16 v[164:167], v[160:163], v[144:147], v[164:167]
s_waitcnt lgkmcnt(4)
v_mfma_f32_32x32x16_bf16 v[96:111], v[148:151], v[152:155], v[96:111]
ds_read_b64_tr_b16 v[132:133], v219 offset:0
ds_read_b64_tr_b16 v[134:135], v219 offset:1024
buffer_load_dwordx4 v210, s[20:23], s79 offen offset:2048 lds
s_and_b32 s46, s46, 1
s_lshl_b32 s46, s46, 4
s_lshr_b32 s47, s47, s46
v_mfma_f32_32x32x16_bf16 v[112:127], v[148:151], v[156:159], v[112:127]
s_and_b32 s47, s47, 0xffff
v_mov_b32 v61, s47
v_and_b32 v19, 15, v1
v_mfma_f32_16x16x32_bf16 v[168:171], v[160:163], v[148:151], v[168:171]
s_waitcnt lgkmcnt(3)
v_mfma_f32_32x32x16_bf16 v[64:79], v[128:131], v[136:139], v[64:79]
ds_read_b64_tr_b16 v[144:145], v218 offset:4096
ds_read_b64_tr_b16 v[146:147], v218 offset:5120
buffer_load_dwordx4 v211, s[20:23], s79 offen offset:3072 lds
v_lshl_add_u32 v19, v18, 2, v19
v_sub_u32 v19, 15, v19
v_cmp_eq_u32 vcc, 0, v19
v_cndmask_b32 v192, 0, v61, vcc
s_waitcnt lgkmcnt(4)
v_mfma_f32_32x32x16_bf16 v[80:95], v[128:131], v[140:143], v[80:95]
ds_read_b128 v[152:155], v225 offset:16384
ds_read_b128 v[156:159], v225 offset:20480
v_cmp_eq_u32 vcc, 1, v19
v_cndmask_b32 v193, 0, v61, vcc
v_cmp_eq_u32 vcc, 2, v19
v_cndmask_b32 v194, 0, v61, vcc
v_mfma_f32_16x16x32_bf16 v[164:167], v[160:163], v[128:131], v[164:167]
s_waitcnt lgkmcnt(4)
v_mfma_f32_32x32x16_bf16 v[96:111], v[132:135], v[136:139], v[96:111]
ds_read_b64_tr_b16 v[148:149], v219 offset:4096
ds_read_b64_tr_b16 v[150:151], v219 offset:5120
s_add_u32 m0, s81, 16384
s_add_u32 s80, s80, 128
buffer_load_dwordx4 v212, s[8:11], s80 offen offset:0 lds
v_cmp_eq_u32 vcc, 3, v19
v_cndmask_b32 v195, 0, v61, vcc
s_lshl_b32 s92, s91, 12
v_mfma_f32_32x32x16_bf16 v[112:127], v[132:135], v[140:143], v[112:127]
s_add_u32 s92, s92, 4194304
v_mfma_f32_16x16x32_bf16 v[168:171], v[160:163], v[132:135], v[168:171]
s_waitcnt lgkmcnt(3)
v_mfma_f32_32x32x16_bf16 v[64:79], v[144:147], v[152:155], v[64:79]
ds_read_b64_tr_b16 v[128:129], v218 offset:8192
ds_read_b64_tr_b16 v[130:131], v218 offset:9216
buffer_load_dwordx4 v213, s[8:11], s80 offen offset:1024 lds
s_waitcnt lgkmcnt(4)
v_mfma_f32_32x32x16_bf16 v[80:95], v[144:147], v[156:159], v[80:95]
ds_read_b128 v[136:139], v226 offset:16384
ds_read_b128 v[140:143], v226 offset:20480
v_mfma_f32_16x16x32_bf16 v[164:167], v[160:163], v[144:147], v[164:167]
s_waitcnt lgkmcnt(4)
v_mfma_f32_32x32x16_bf16 v[96:111], v[148:151], v[152:155], v[96:111]
ds_read_b64_tr_b16 v[132:133], v219 offset:8192
ds_read_b64_tr_b16 v[134:135], v219 offset:9216
buffer_load_dwordx4 v214, s[8:11], s80 offen offset:2048 lds
v_mfma_f32_32x32x16_bf16 v[112:127], v[148:151], v[156:159], v[112:127]
v_mfma_f32_16x16x32_bf16 v[168:171], v[160:163], v[148:151], v[168:171]
s_waitcnt lgkmcnt(3)
v_mfma_f32_32x32x16_bf16 v[64:79], v[128:131], v[136:139], v[64:79]
ds_read_b64_tr_b16 v[144:145], v218 offset:12288
ds_read_b64_tr_b16 v[146:147], v218 offset:13312
s_waitcnt vmcnt(9)
s_cmp_eq_u32 s82, 0
s_cbranch_scc0 L_nb_18
s_barrier
L_nb_18:
buffer_load_dwordx4 v215, s[8:11], s80 offen offset:3072 lds
s_waitcnt lgkmcnt(4)
v_mfma_f32_32x32x16_bf16 v[80:95], v[128:131], v[140:143], v[80:95]
ds_read_b128 v[152:155], v227 offset:16384
ds_read_b128 v[156:159], v227 offset:20480
s_cmp_eq_u32 s82, 1
s_cbranch_scc0 L_nb_19
s_barrier
L_nb_19:
buffer_store_dwordx4 v[182:185], v173, s[24:27], s93 offen sc1
v_mfma_f32_16x16x32_bf16 v[164:167], v[160:163], v[128:131], v[164:167]
s_waitcnt lgkmcnt(4)
v_mfma_f32_32x32x16_bf16 v[96:111], v[132:135], v[136:139], v[96:111]
ds_read_b64_tr_b16 v[148:149], v219 offset:12288
ds_read_b64_tr_b16 v[150:151], v219 offset:13312
s_add_u32 m0, s81, 32768
s_add_u32 s79, s79, 221184
buffer_load_dwordx4 v208, s[20:23], s79 offen offset:0 lds
v_mfma_f32_32x32x16_bf16 v[112:127], v[132:135], v[140:143], v[112:127]
v_mfma_f32_16x16x32_bf16 v[168:171], v[160:163], v[132:135], v[168:171]
s_waitcnt lgkmcnt(3)
v_mfma_f32_32x32x16_bf16 v[64:79], v[144:147], v[152:155], v[64:79]
ds_read_b64_tr_b16 v[128:129], v218 offset:32768
ds_read_b64_tr_b16 v[130:131], v218 offset:33792
buffer_load_dwordx4 v209, s[20:23], s79 offen offset:1024 lds
s_waitcnt lgkmcnt(4)
v_mfma_f32_32x32x16_bf16 v[80:95], v[144:147], v[156:159], v[80:95]
ds_read_b128 v[136:139], v224 offset:49152
ds_read_b128 v[140:143], v224 offset:53248
v_mfma_f32_16x16x32_bf16 v[164:167], v[160:163], v[144:147], v[164:167]
s_waitcnt lgkmcnt(4)
v_mfma_f32_32x32x16_bf16 v[96:111], v[148:151], v[152:155], v[96:111]
ds_read_b64_tr_b16 v[132:133], v219 offset:32768
ds_read_b64_tr_b16 v[134:135], v219 offset:33792
buffer_load_dwordx4 v210, s[20:23], s79 offen offset:2048 lds
v_mfma_f32_32x32x16_bf16 v[112:127], v[148:151], v[156:159], v[112:127]
v_mfma_f32_16x16x32_bf16 v[168:171], v[160:163], v[148:151], v[168:171]
s_waitcnt lgkmcnt(3)
v_mfma_f32_32x32x16_bf16 v[64:79], v[128:131], v[136:139], v[64:79]
ds_read_b64_tr_b16 v[144:145], v218 offset:36864
ds_read_b64_tr_b16 v[146:147], v218 offset:37888
buffer_load_dwordx4 v211, s[20:23], s79 offen offset:3072 lds
s_waitcnt lgkmcnt(4)
v_mfma_f32_32x32x16_bf16 v[80:95], v[128:131], v[140:143], v[80:95]
ds_read_b128 v[152:155], v225 offset:49152
ds_read_b128 v[156:159], v225 offset:53248
v_mfma_f32_16x16x32_bf16 v[164:167], v[160:163], v[128:131], v[164:167]
s_waitcnt lgkmcnt(4)
v_mfma_f32_32x32x16_bf16 v[96:111], v[132:135], v[136:139], v[96:111]
ds_read_b64_tr_b16 v[148:149], v219 offset:36864
ds_read_b64_tr_b16 v[150:151], v219 offset:37888
s_add_u32 m0, s81, 49152
s_add_u32 s80, s80, 128
buffer_load_dwordx4 v212, s[8:11], s80 offen offset:0 lds
v_mfma_f32_32x32x16_bf16 v[112:127], v[132:135], v[140:143], v[112:127]
v_mfma_f32_16x16x32_bf16 v[168:171], v[160:163], v[132:135], v[168:171]
s_waitcnt lgkmcnt(3)
v_mfma_f32_32x32x16_bf16 v[64:79], v[144:147], v[152:155], v[64:79]
ds_read_b64_tr_b16 v[128:129], v218 offset:40960
ds_read_b64_tr_b16 v[130:131], v218 offset:41984
buffer_load_dwordx4 v213, s[8:11], s80 offen offset:1024 lds
s_waitcnt lgkmcnt(4)
v_mfma_f32_32x32x16_bf16 v[80:95], v[144:147], v[156:159], v[80:95]
ds_read_b128 v[136:139], v226 offset:49152
ds_read_b128 v[140:143], v226 offset:53248
v_mfma_f32_16x16x32_bf16 v[164:167], v[160:163], v[144:147], v[164:167]
s_waitcnt lgkmcnt(4)
v_mfma_f32_32x32x16_bf16 v[96:111], v[148:151], v[152:155], v[96:111]
ds_read_b64_tr_b16 v[132:133], v219 offset:40960
ds_read_b64_tr_b16 v[134:135], v219 offset:41984
buffer_load_dwordx4 v214, s[8:11], s80 offen offset:2048 lds
v_mfma_f32_32x32x16_bf16 v[112:127], v[148:151], v[156:159], v[112:127]
v_mfma_f32_16x16x32_bf16 v[168:171], v[160:163], v[148:151], v[168:171]
s_waitcnt lgkmcnt(3)
v_mfma_f32_32x32x16_bf16 v[64:79], v[128:131], v[136:139], v[64:79]
ds_read_b64_tr_b16 v[144:145], v218 offset:45056
ds_read_b64_tr_b16 v[146:147], v218 offset:46080
s_waitcnt vmcnt(8)
s_cmp_lg_u32 s5, 0
s_cbranch_scc1 L_back_21
v_cmp_eq_u32 vcc, 0, v254
s_cbranch_vccnz L_slow_20
L_back_21:
s_cmp_eq_u32 s82, 0
s_cbranch_scc0 L_nb_22
s_barrier
L_nb_22:
buffer_load_dwordx4 v215, s[8:11], s80 offen offset:3072 lds
s_waitcnt lgkmcnt(4)
v_mfma_f32_32x32x16_bf16 v[80:95], v[128:131], v[140:143], v[80:95]
ds_read_b128 v[152:155], v227 offset:49152
ds_read_b128 v[156:159], v227 offset:53248
s_cmp_eq_u32 s82, 1
s_cbranch_scc0 L_nb_23
s_barrier
L_nb_23:
s_mov_b32 s36, s56
s_and_b32 s37, s57, 0xffff
s_mov_b32 s38, 3456
s_mov_b32 s39, 0x20000
v_and_b32 v2, 31, v1
s_lshl_b32 s6, s78, 7
s_lshl_b32 s7, s82, 6
s_add_u32 s6, s6, s7
v_add_u32 v3, s6, v2
v_lshlrev_b32 v3, 1, v3
s_cmp_ge_u32 s6, 1728
s_cselect_b32 s101, 0, 32
s_lshl_b32 s6, s77, 7
s_lshl_b32 s7, s83, 6
s_add_u32 s6, s6, s7
v_add_u32 v4, s6, v2
v_lshlrev_b32 v4, 4, v4
v_mov_b32 v5, 2147418112
v_cmp_gt_u32 vcc, 32, v1
v_cndmask_b32 v3, v5, v3, vcc
v_cndmask_b32 v5, v5, v4, vcc
s_mov_b32 s7, 65536
s_mov_b32 s84, 98304
buffer_load_ushort v28, v3, s[36:39], 0 offen
buffer_load_ushort v32, v3, s[36:39], 0 offen offset:64
buffer_load_dwordx4 v[36:39], v5, s[24:27], s7 offen
buffer_load_dwordx4 v[40:43], v5, s[24:27], s7 offen offset:512
buffer_load_dwordx4 v[44:47], v4, s[24:27], s84 offen
buffer_load_dwordx4 v[48:51], v4, s[24:27], s84 offen offset:512
v_mfma_f32_16x16x32_bf16 v[164:167], v[160:163], v[128:131], v[164:167]
s_waitcnt lgkmcnt(4)
v_mfma_f32_32x32x16_bf16 v[96:111], v[132:135], v[136:139], v[96:111]
ds_read_b64_tr_b16 v[148:149], v219 offset:45056
ds_read_b64_tr_b16 v[150:151], v219 offset:46080
s_mov_b32 s32, s48
s_and_b32 s33, s49, 0xffff
s_mov_b32 s34, 2621440
s_mov_b32 s35, 0x20000
s_lshl_b32 s6, s88, 5
s_mul_i32 s7, s5, 24
s_add_u32 s6, s6, s7
v_add_u32 v2, s6, v1
v_lshlrev_b32 v235, 7, v2
s_mov_b32 exec_lo, 0xffffff
s_mov_b32 exec_hi, 0x0
buffer_load_dword v234, v235, s[32:35], 0 offen
s_mov_b64 exec, -1
v_mfma_f32_32x32x16_bf16 v[112:127], v[132:135], v[140:143], v[112:127]
v_mfma_f32_16x16x32_bf16 v[168:171], v[160:163], v[132:135], v[168:171]
s_waitcnt lgkmcnt(3)
v_mfma_f32_32x32x16_bf16 v[64:79], v[144:147], v[152:155], v[64:79]
ds_read_b64_tr_b16 v[128:129], v216 offset:0
ds_read_b64_tr_b16 v[130:131], v216 offset:1024
s_lshl_b32 s6, s5, 2
v_lshlrev_b32 v202, 2, v1
v_add_u32 v202, s6, v202
v_subrev_u32 v202, 252, v202
v_add_u32 v203, s6, v248
s_waitcnt lgkmcnt(4)
v_mfma_f32_32x32x16_bf16 v[80:95], v[144:147], v[156:159], v[80:95]
ds_read_b128 v[136:139], v220 offset:16384
ds_read_b128 v[140:143], v220 offset:20480
v_add_u32 v203, 4, v203
s_mul_i32 s90, s5, 4416
s_lshr_b32 s6, s4, 3
s_mul_i32 s6, s6, 14
s_and_b32 s7, s4, 7
v_mfma_f32_16x16x32_bf16 v[164:167], v[160:163], v[144:147], v[164:167]
s_waitcnt lgkmcnt(4)
v_mfma_f32_32x32x16_bf16 v[96:111], v[148:151], v[152:155], v[96:111]
ds_read_b64_tr_b16 v[132:133], v217 offset:0
ds_read_b64_tr_b16 v[134:135], v217 offset:1024
s_mul_i32 s7, s7, 7
s_add_u32 s6, s6, s7
s_lshr_b32 s6, s6, 2
s_cmp_ge_u32 s5, 2
s_cselect_b32 s43, 13, 14
v_mfma_f32_32x32x16_bf16 v[112:127], v[148:151], v[156:159], v[112:127]
s_cmp_ge_u32 s6, s43
s_cselect_b32 s7, s43, 0
s_sub_u32 s93, s6, s7
s_mov_b32 s93, 0
s_mul_i32 s6, s95, 54
v_mfma_f32_16x16x32_bf16 v[168:171], v[160:163], v[148:151], v[168:171]
s_waitcnt lgkmcnt(3)
v_mfma_f32_32x32x16_bf16 v[64:79], v[128:131], v[136:139], v[64:79]
ds_read_b64_tr_b16 v[144:145], v216 offset:4096
ds_read_b64_tr_b16 v[146:147], v216 offset:5120
s_add_u32 s6, s6, s96
s_mul_i32 s79, s6, 5120
s_add_u32 s79, s79, 7340032
s_mul_i32 s7, s43, 5120
s_add_u32 s80, s79, s7
s_waitcnt lgkmcnt(4)
v_mfma_f32_32x32x16_bf16 v[80:95], v[128:131], v[140:143], v[80:95]
ds_read_b128 v[152:155], v221 offset:16384
ds_read_b128 v[156:159], v221 offset:20480
s_mul_i32 s7, s93, 5120
s_add_u32 s97, s79, s7
s_add_u32 s98, s97, 4096
v_and_b32 v2, 15, v1
v_lshrrev_b32 v3, 3, v2
v_mfma_f32_16x16x32_bf16 v[164:167], v[160:163], v[128:131], v[164:167]
s_waitcnt lgkmcnt(4)
v_mfma_f32_32x32x16_bf16 v[96:111], v[132:135], v[136:139], v[96:111]
ds_read_b64_tr_b16 v[148:149], v217 offset:4096
ds_read_b64_tr_b16 v[150:151], v217 offset:5120
v_lshlrev_b32 v3, 3, v3
v_and_b32 v4, 1, v2
v_lshl_or_b32 v3, v4, 2, v3
v_bfe_u32 v4, v2, 1, 2
v_or_b32 v3, v3, v4
v_mfma_f32_32x32x16_bf16 v[112:127], v[132:135], v[140:143], v[112:127]
v_lshlrev_b32 v3, 4, v3
v_bfe_u32 v4, v1, 4, 1
v_lshl_or_b32 v3, v4, 10, v3
v_lshrrev_b32 v4, 5, v1
v_lshl_or_b32 v3, v4, 8, v3
v_mfma_f32_16x16x32_bf16 v[168:171], v[160:163], v[132:135], v[168:171]
s_waitcnt lgkmcnt(3)
v_mfma_f32_32x32x16_bf16 v[64:79], v[144:147], v[152:155], v[64:79]
ds_read_b64_tr_b16 v[128:129], v216 offset:8192
ds_read_b64_tr_b16 v[130:131], v216 offset:9216
v_mov_b32 v4, 2147418112
s_cmp_eq_u32 s101, 0
s_cselect_b64 vcc, -1, 0
v_cndmask_b32 v60, v3, v4, vcc
s_lshl_b32 s6, s77, 1
s_waitcnt lgkmcnt(4)
v_mfma_f32_32x32x16_bf16 v[80:95], v[144:147], v[156:159], v[80:95]
ds_read_b128 v[136:139], v222 offset:16384
ds_read_b128 v[140:143], v222 offset:20480
s_add_u32 s6, s6, s83
s_mul_i32 s6, s6, 54
s_lshl_b32 s7, s78, 2
s_add_u32 s6, s6, s7
s_lshl_b32 s7, s82, 1
v_mfma_f32_16x16x32_bf16 v[164:167], v[160:163], v[144:147], v[164:167]
s_waitcnt lgkmcnt(4)
v_mfma_f32_32x32x16_bf16 v[96:111], v[148:151], v[152:155], v[96:111]
ds_read_b64_tr_b16 v[132:133], v217 offset:8192
ds_read_b64_tr_b16 v[134:135], v217 offset:9216
s_add_u32 s6, s6, s7
s_lshl_b32 s6, s6, 12
s_add_u32 s100, s6, 10485760
s_add_u32 s101, s100, 4096
v_mfma_f32_32x32x16_bf16 v[112:127], v[148:151], v[156:159], v[112:127]
v_mfma_f32_16x16x32_bf16 v[168:171], v[160:163], v[148:151], v[168:171]
s_waitcnt lgkmcnt(3)
v_mfma_f32_32x32x16_bf16 v[64:79], v[128:131], v[136:139], v[64:79]
ds_read_b64_tr_b16 v[144:145], v216 offset:12288
ds_read_b64_tr_b16 v[146:147], v216 offset:13312
s_waitcnt vmcnt(7)
s_cmp_eq_u32 s82, 0
s_cbranch_scc0 L_nb_24
s_barrier
L_nb_24:
s_waitcnt lgkmcnt(4)
v_mfma_f32_32x32x16_bf16 v[80:95], v[128:131], v[140:143], v[80:95]
ds_read_b128 v[152:155], v223 offset:16384
ds_read_b128 v[156:159], v223 offset:20480
s_cmp_eq_u32 s82, 1
s_cbranch_scc0 L_nb_25
s_barrier
L_nb_25:
s_cmp_lg_u32 s5, 0
s_cbranch_scc1 L_fl_26
s_mov_b64 exec, 1
buffer_store_dword v253, v252, s[24:27], 0 offen offset:12 sc1
s_mov_b64 exec, -1
L_fl_26:
v_mfma_f32_16x16x32_bf16 v[164:167], v[160:163], v[128:131], v[164:167]
s_waitcnt lgkmcnt(4)
v_mfma_f32_32x32x16_bf16 v[96:111], v[132:135], v[136:139], v[96:111]
ds_read_b64_tr_b16 v[148:149], v217 offset:12288
ds_read_b64_tr_b16 v[150:151], v217 offset:13312
s_add_u32 s6, s88, 0
s_lshl_b32 s6, s6, 12
s_add_u32 s32, s48, s6
s_addc_u32 s33, s49, 0
s_and_b32 s33, s33, 0xffff
s_mov_b32 s34, 4096
s_mov_b32 s35, 0x20000
s_add_u32 m0, s90, 65536
s_nop 0
buffer_load_dword v202, s[32:35], 0 offen lds
s_add_u32 m0, s90, 65792
s_nop 0
v_mfma_f32_32x32x16_bf16 v[112:127], v[132:135], v[140:143], v[112:127]
buffer_load_dwordx4 v203, s[32:35], 0 offen offset:0 lds
v_mfma_f32_16x16x32_bf16 v[168:171], v[160:163], v[132:135], v[168:171]
s_waitcnt lgkmcnt(3)
v_mfma_f32_32x32x16_bf16 v[64:79], v[144:147], v[152:155], v[64:79]
ds_read_b64_tr_b16 v[128:129], v216 offset:32768
ds_read_b64_tr_b16 v[130:131], v216 offset:33792
v_lshlrev_b32 v5, 4, v0
v_add_u32 v5, 87808, v5
v_add_u32 v7, 62464, v5
v_mov_b32 v12, 0
buffer_load_dwordx4 v203, s[32:35], 0 offen offset:1024 lds
s_waitcnt lgkmcnt(4)
v_mfma_f32_32x32x16_bf16 v[80:95], v[144:147], v[156:159], v[80:95]
ds_read_b128 v[136:139], v220 offset:49152
ds_read_b128 v[140:143], v220 offset:53248
v_mov_b32 v13, 0
v_mov_b32 v14, 0
v_mov_b32 v15, 0
buffer_load_dwordx4 v203, s[32:35], 0 offen offset:2048 lds
v_mfma_f32_16x16x32_bf16 v[164:167], v[160:163], v[144:147], v[164:167]
s_waitcnt lgkmcnt(4)
v_mfma_f32_32x32x16_bf16 v[96:111], v[148:151], v[152:155], v[96:111]
ds_read_b64_tr_b16 v[132:133], v217 offset:32768
ds_read_b64_tr_b16 v[134:135], v217 offset:33792
v_cmp_gt_u32 vcc, 126, v0
s_and_saveexec_b64 s[6:7], vcc
ds_write_b128 v5, v[12:15] offset:0
ds_write_b128 v5, v[12:15] offset:6784
ds_write_b128 v5, v[12:15] offset:31232
ds_write_b128 v5, v[12:15] offset:38016
ds_write_b128 v7, v[12:15] offset:0
ds_write_b128 v7, v[12:15] offset:6784
s_mov_b64 exec, s[6:7]
v_mfma_f32_32x32x16_bf16 v[112:127], v[148:151], v[156:159], v[112:127]
buffer_load_dwordx4 v203, s[32:35], 0 offen offset:3072 lds
v_mfma_f32_16x16x32_bf16 v[168:171], v[160:163], v[148:151], v[168:171]
s_waitcnt lgkmcnt(9)
v_mfma_f32_32x32x16_bf16 v[64:79], v[128:131], v[136:139], v[64:79]
ds_read_b64_tr_b16 v[144:145], v216 offset:36864
ds_read_b64_tr_b16 v[146:147], v216 offset:37888
s_add_u32 s6, s88, 1
s_lshl_b32 s6, s6, 12
s_add_u32 s32, s48, s6
s_addc_u32 s33, s49, 0
s_and_b32 s33, s33, 0xffff
s_mov_b32 s34, 4096
s_mov_b32 s35, 0x20000
s_add_u32 m0, s90, 96768
s_nop 0
buffer_load_dword v202, s[32:35], 0 offen lds
s_add_u32 m0, s90, 97024
s_nop 0
s_waitcnt lgkmcnt(10)
v_mfma_f32_32x32x16_bf16 v[80:95], v[128:131], v[140:143], v[80:95]
ds_read_b128 v[152:155], v221 offset:49152
ds_read_b128 v[156:159], v221 offset:53248
buffer_load_dwordx4 v203, s[32:35], 0 offen offset:0 lds
v_mfma_f32_16x16x32_bf16 v[164:167], v[160:163], v[128:131], v[164:167]
s_waitcnt lgkmcnt(10)
v_mfma_f32_32x32x16_bf16 v[96:111], v[132:135], v[136:139], v[96:111]
ds_read_b64_tr_b16 v[148:149], v217 offset:36864
ds_read_b64_tr_b16 v[150:151], v217 offset:37888
buffer_load_dwordx4 v203, s[32:35], 0 offen offset:1024 lds
v_mfma_f32_32x32x16_bf16 v[112:127], v[132:135], v[140:143], v[112:127]
buffer_load_dwordx4 v203, s[32:35], 0 offen offset:2048 lds
v_mfma_f32_16x16x32_bf16 v[168:171], v[160:163], v[132:135], v[168:171]
s_waitcnt lgkmcnt(3)
v_mfma_f32_32x32x16_bf16 v[64:79], v[144:147], v[152:155], v[64:79]
ds_read_b64_tr_b16 v[128:129], v216 offset:40960
ds_read_b64_tr_b16 v[130:131], v216 offset:41984
buffer_load_dwordx4 v203, s[32:35], 0 offen offset:3072 lds
s_waitcnt lgkmcnt(4)
v_mfma_f32_32x32x16_bf16 v[80:95], v[144:147], v[156:159], v[80:95]
ds_read_b128 v[136:139], v222 offset:49152
ds_read_b128 v[140:143], v222 offset:53248
s_add_u32 s6, s88, 2
s_lshl_b32 s6, s6, 12
s_add_u32 s32, s48, s6
s_addc_u32 s33, s49, 0
s_and_b32 s33, s33, 0xffff
s_mov_b32 s34, 4096
s_mov_b32 s35, 0x20000
s_add_u32 m0, s90, 128000
s_nop 0
buffer_load_dword v202, s[32:35], 0 offen lds
s_add_u32 m0, s90, 128256
s_nop 0
v_mfma_f32_16x16x32_bf16 v[164:167], v[160:163], v[144:147], v[164:167]
s_waitcnt lgkmcnt(4)
v_mfma_f32_32x32x16_bf16 v[96:111], v[148:151], v[152:155], v[96:111]
ds_read_b64_tr_b16 v[132:133], v217 offset:40960
ds_read_b64_tr_b16 v[134:135], v217 offset:41984
buffer_load_dwordx4 v203, s[32:35], 0 offen offset:0 lds
v_mfma_f32_32x32x16_bf16 v[112:127], v[148:151], v[156:159], v[112:127]
buffer_load_dwordx4 v203, s[32:35], 0 offen offset:1024 lds
v_mfma_f32_16x16x32_bf16 v[168:171], v[160:163], v[148:151], v[168:171]
s_waitcnt lgkmcnt(3)
v_mfma_f32_32x32x16_bf16 v[64:79], v[128:131], v[136:139], v[64:79]
ds_read_b64_tr_b16 v[144:145], v216 offset:45056
ds_read_b64_tr_b16 v[146:147], v216 offset:46080
buffer_load_dwordx4 v203, s[32:35], 0 offen offset:2048 lds
s_waitcnt lgkmcnt(4)
v_mfma_f32_32x32x16_bf16 v[80:95], v[128:131], v[140:143], v[80:95]
ds_read_b128 v[152:155], v223 offset:49152
ds_read_b128 v[156:159], v223 offset:53248
buffer_load_dwordx4 v203, s[32:35], 0 offen offset:3072 lds
v_mfma_f32_16x16x32_bf16 v[164:167], v[160:163], v[128:131], v[164:167]
s_waitcnt lgkmcnt(4)
v_mfma_f32_32x32x16_bf16 v[96:111], v[132:135], v[136:139], v[96:111]
ds_read_b64_tr_b16 v[148:149], v217 offset:45056
ds_read_b64_tr_b16 v[150:151], v217 offset:46080
v_mfma_f32_32x32x16_bf16 v[112:127], v[132:135], v[140:143], v[112:127]
v_mfma_f32_16x16x32_bf16 v[168:171], v[160:163], v[132:135], v[168:171]
s_waitcnt lgkmcnt(3)
v_mfma_f32_32x32x16_bf16 v[64:79], v[144:147], v[152:155], v[64:79]
s_waitcnt lgkmcnt(2)
v_mfma_f32_32x32x16_bf16 v[80:95], v[144:147], v[156:159], v[80:95]
v_mfma_f32_16x16x32_bf16 v[164:167], v[160:163], v[144:147], v[164:167]
s_waitcnt lgkmcnt(0)
v_mfma_f32_32x32x16_bf16 v[96:111], v[148:151], v[152:155], v[96:111]
v_mfma_f32_32x32x16_bf16 v[112:127], v[148:151], v[156:159], v[112:127]
v_mfma_f32_16x16x32_bf16 v[168:171], v[160:163], v[148:151], v[168:171]
s_waitcnt vmcnt(16)
s_nop 7
v_lshl_or_b32 v28, v28, 16, v28
v_cvt_pk_bf16_f32 v29, v164, v164
v_lshlrev_b32 v2, 16, v29
v_sub_f32 v2, v164, v2
v_cvt_pk_bf16_f32 v30, v2, v2
v_mov_b32 v31, 0
v_lshl_or_b32 v32, v32, 16, v32
v_cvt_pk_bf16_f32 v33, v168, v168
v_lshlrev_b32 v2, 16, v33
v_sub_f32 v2, v168, v2
v_cvt_pk_bf16_f32 v34, v2, v2
v_mov_b32 v35, 0
s_nop 1
v_mfma_f32_32x32x16_bf16 v[64:79], v[28:31], v[36:39], v[64:79]
v_mfma_f32_32x32x16_bf16 v[80:95], v[28:31], v[40:43], v[80:95]
v_mfma_f32_32x32x16_bf16 v[96:111], v[32:35], v[36:39], v[96:111]
v_mfma_f32_32x32x16_bf16 v[112:127], v[32:35], v[40:43], v[112:127]
v_mul_f32 v52, -2.302208198144325, v45
v_mul_f32 v2, v45, v45
v_mul_f32 v2, v2, v45
v_mul_f32 v53, -0.1029432395800235, v2
v_mov_b32 v54, v46
v_mov_b32 v55, v46
v_mul_f32 v56, -2.302208198144325, v49
v_mul_f32 v2, v49, v49
v_mul_f32 v2, v2, v49
v_mul_f32 v57, -0.1029432395800235, v2
v_mov_b32 v58, v50
v_mov_b32 v59, v50
buffer_load_dword v251, v229, s[24:27], 0 offen sc1
v_pk_mul_f32 v[160:161], v[64:65], v[64:65]
v_pk_mul_f32 v[162:163], v[66:67], v[66:67]
v_pk_mul_f32 v[164:165], v[68:69], v[68:69]
v_pk_mul_f32 v[166:167], v[70:71], v[70:71]
v_pk_fma_f32 v[160:161], v[160:161], v[52:53], v[52:53] op_sel:[0,1,0] op_sel_hi:[1,1,0]
v_pk_fma_f32 v[162:163], v[162:163], v[52:53], v[52:53] op_sel:[0,1,0] op_sel_hi:[1,1,0]
v_pk_fma_f32 v[164:165], v[164:165], v[52:53], v[52:53] op_sel:[0,1,0] op_sel_hi:[1,1,0]
v_pk_fma_f32 v[166:167], v[166:167], v[52:53], v[52:53] op_sel:[0,1,0] op_sel_hi:[1,1,0]
v_pk_mul_f32 v[160:161], v[160:161], v[64:65]
v_pk_mul_f32 v[162:163], v[162:163], v[66:67]
v_pk_mul_f32 v[164:165], v[164:165], v[68:69]
v_pk_mul_f32 v[166:167], v[166:167], v[70:71]
v_exp_f32 v160, v160
v_exp_f32 v161, v161
v_exp_f32 v162, v162
v_exp_f32 v163, v163
v_exp_f32 v164, v164
v_exp_f32 v165, v165
v_exp_f32 v166, v166
v_exp_f32 v167, v167
v_pk_fma_f32 v[160:161], v[160:161], v[54:55], v[54:55]
v_pk_fma_f32 v[162:163], v[162:163], v[54:55], v[54:55]
v_pk_fma_f32 v[164:165], v[164:165], v[54:55], v[54:55]
v_pk_fma_f32 v[166:167], v[166:167], v[54:55], v[54:55]
v_rcp_f32 v160, v160
v_rcp_f32 v161, v161
v_rcp_f32 v162, v162
v_rcp_f32 v163, v163
v_rcp_f32 v164, v164
v_rcp_f32 v165, v165
v_rcp_f32 v166, v166
v_rcp_f32 v167, v167
v_pk_mul_f32 v[160:161], v[160:161], v[64:65]
v_pk_mul_f32 v[162:163], v[162:163], v[66:67]
v_pk_mul_f32 v[164:165], v[164:165], v[68:69]
v_pk_mul_f32 v[166:167], v[166:167], v[70:71]
v_cvt_pk_bf16_f32 v64, v160, v161
v_cvt_pk_bf16_f32 v65, v162, v163
v_cvt_pk_bf16_f32 v66, v164, v165
v_cvt_pk_bf16_f32 v67, v166, v167
buffer_store_dwordx4 v[64:67], v60, s[24:27], s100 offen offset:0 sc1
buffer_load_dword v254, v228, s[24:27], 0 offen sc1
v_pk_mul_f32 v[160:161], v[72:73], v[72:73]
v_pk_mul_f32 v[162:163], v[74:75], v[74:75]
v_pk_mul_f32 v[164:165], v[76:77], v[76:77]
v_pk_mul_f32 v[166:167], v[78:79], v[78:79]
v_pk_fma_f32 v[160:161], v[160:161], v[52:53], v[52:53] op_sel:[0,1,0] op_sel_hi:[1,1,0]
v_pk_fma_f32 v[162:163], v[162:163], v[52:53], v[52:53] op_sel:[0,1,0] op_sel_hi:[1,1,0]
v_pk_fma_f32 v[164:165], v[164:165], v[52:53], v[52:53] op_sel:[0,1,0] op_sel_hi:[1,1,0]
v_pk_fma_f32 v[166:167], v[166:167], v[52:53], v[52:53] op_sel:[0,1,0] op_sel_hi:[1,1,0]
v_pk_mul_f32 v[160:161], v[160:161], v[72:73]
v_pk_mul_f32 v[162:163], v[162:163], v[74:75]
v_pk_mul_f32 v[164:165], v[164:165], v[76:77]
v_pk_mul_f32 v[166:167], v[166:167], v[78:79]
v_exp_f32 v160, v160
v_exp_f32 v161, v161
v_exp_f32 v162, v162
v_exp_f32 v163, v163
v_exp_f32 v164, v164
v_exp_f32 v165, v165
v_exp_f32 v166, v166
v_exp_f32 v167, v167
v_pk_fma_f32 v[160:161], v[160:161], v[54:55], v[54:55]
v_pk_fma_f32 v[162:163], v[162:163], v[54:55], v[54:55]
v_pk_fma_f32 v[164:165], v[164:165], v[54:55], v[54:55]
v_pk_fma_f32 v[166:167], v[166:167], v[54:55], v[54:55]
v_rcp_f32 v160, v160
v_rcp_f32 v161, v161
v_rcp_f32 v162, v162
v_rcp_f32 v163, v163
v_rcp_f32 v164, v164
v_rcp_f32 v165, v165
v_rcp_f32 v166, v166
v_rcp_f32 v167, v167
v_pk_mul_f32 v[160:161], v[160:161], v[72:73]
v_pk_mul_f32 v[162:163], v[162:163], v[74:75]
v_pk_mul_f32 v[164:165], v[164:165], v[76:77]
v_pk_mul_f32 v[166:167], v[166:167], v[78:79]
v_cvt_pk_bf16_f32 v72, v160, v161
v_cvt_pk_bf16_f32 v73, v162, v163
v_cvt_pk_bf16_f32 v74, v164, v165
v_cvt_pk_bf16_f32 v75, v166, v167
buffer_store_dwordx4 v[72:75], v60, s[24:27], s100 offen offset:512 sc1
v_pk_mul_f32 v[160:161], v[80:81], v[80:81]
v_pk_mul_f32 v[162:163], v[82:83], v[82:83]
v_pk_mul_f32 v[164:165], v[84:85], v[84:85]
v_pk_mul_f32 v[166:167], v[86:87], v[86:87]
v_pk_fma_f32 v[160:161], v[160:161], v[56:57], v[56:57] op_sel:[0,1,0] op_sel_hi:[1,1,0]
v_pk_fma_f32 v[162:163], v[162:163], v[56:57], v[56:57] op_sel:[0,1,0] op_sel_hi:[1,1,0]
v_pk_fma_f32 v[164:165], v[164:165], v[56:57], v[56:57] op_sel:[0,1,0] op_sel_hi:[1,1,0]
v_pk_fma_f32 v[166:167], v[166:167], v[56:57], v[56:57] op_sel:[0,1,0] op_sel_hi:[1,1,0]
v_pk_mul_f32 v[160:161], v[160:161], v[80:81]
v_pk_mul_f32 v[162:163], v[162:163], v[82:83]
v_pk_mul_f32 v[164:165], v[164:165], v[84:85]
v_pk_mul_f32 v[166:167], v[166:167], v[86:87]
v_exp_f32 v160, v160
v_exp_f32 v161, v161
v_exp_f32 v162, v162
v_exp_f32 v163, v163
v_exp_f32 v164, v164
v_exp_f32 v165, v165
v_exp_f32 v166, v166
v_exp_f32 v167, v167
v_pk_fma_f32 v[160:161], v[160:161], v[58:59], v[58:59]
v_pk_fma_f32 v[162:163], v[162:163], v[58:59], v[58:59]
v_pk_fma_f32 v[164:165], v[164:165], v[58:59], v[58:59]
v_pk_fma_f32 v[166:167], v[166:167], v[58:59], v[58:59]
v_rcp_f32 v160, v160
v_rcp_f32 v161, v161
v_rcp_f32 v162, v162
v_rcp_f32 v163, v163
v_rcp_f32 v164, v164
v_rcp_f32 v165, v165
v_rcp_f32 v166, v166
v_rcp_f32 v167, v167
v_pk_mul_f32 v[160:161], v[160:161], v[80:81]
v_pk_mul_f32 v[162:163], v[162:163], v[82:83]
v_pk_mul_f32 v[164:165], v[164:165], v[84:85]
v_pk_mul_f32 v[166:167], v[166:167], v[86:87]
v_cvt_pk_bf16_f32 v80, v160, v161
v_cvt_pk_bf16_f32 v81, v162, v163
v_cvt_pk_bf16_f32 v82, v164, v165
v_cvt_pk_bf16_f32 v83, v166, v167
buffer_store_dwordx4 v[80:83], v60, s[24:27], s100 offen offset:2048 sc1
s_waitcnt vmcnt(4)
v_cmp_eq_u32 vcc, 0, v251
s_cbranch_vccnz L_slow_27
L_back_28:
v_lshlrev_b32 v4, 4, v0
s_add_u32 s6, s88, 0
s_lshl_b32 s6, s6, 12
s_add_u32 s6, s6, 1048576
s_add_u32 s36, s66, s6
s_addc_u32 s37, s67, 0
s_and_b32 s37, s37, 0xffff
s_mov_b32 s38, 4096
s_mov_b32 s39, 0x20000
buffer_load_dwordx4 v[32:35], v4, s[36:39], 0 offen
buffer_load_dword v36, v4, s[36:39], 0 offen offset:16
s_add_u32 s6, s88, 1
s_lshl_b32 s6, s6, 12
s_add_u32 s6, s6, 1048576
s_add_u32 s36, s66, s6
s_addc_u32 s37, s67, 0
s_and_b32 s37, s37, 0xffff
s_mov_b32 s38, 4096
s_mov_b32 s39, 0x20000
buffer_load_dwordx4 v[38:41], v4, s[36:39], 0 offen
buffer_load_dword v42, v4, s[36:39], 0 offen offset:16
s_add_u32 s6, s88, 2
s_lshl_b32 s6, s6, 12
s_add_u32 s6, s6, 1048576
s_add_u32 s36, s66, s6
s_addc_u32 s37, s67, 0
s_and_b32 s37, s37, 0xffff
s_mov_b32 s38, 4096
s_mov_b32 s39, 0x20000
buffer_load_dwordx4 v[44:47], v4, s[36:39], 0 offen
buffer_load_dword v48, v4, s[36:39], 0 offen offset:16
v_pk_mul_f32 v[160:161], v[88:89], v[88:89]
v_pk_mul_f32 v[162:163], v[90:91], v[90:91]
v_pk_mul_f32 v[164:165], v[92:93], v[92:93]
v_pk_mul_f32 v[166:167], v[94:95], v[94:95]
v_pk_fma_f32 v[160:161], v[160:161], v[56:57], v[56:57] op_sel:[0,1,0] op_sel_hi:[1,1,0]
v_pk_fma_f32 v[162:163], v[162:163], v[56:57], v[56:57] op_sel:[0,1,0] op_sel_hi:[1,1,0]
v_pk_fma_f32 v[164:165], v[164:165], v[56:57], v[56:57] op_sel:[0,1,0] op_sel_hi:[1,1,0]
v_pk_fma_f32 v[166:167], v[166:167], v[56:57], v[56:57] op_sel:[0,1,0] op_sel_hi:[1,1,0]
v_pk_mul_f32 v[160:161], v[160:161], v[88:89]
v_pk_mul_f32 v[162:163], v[162:163], v[90:91]
v_pk_mul_f32 v[164:165], v[164:165], v[92:93]
v_pk_mul_f32 v[166:167], v[166:167], v[94:95]
v_exp_f32 v160, v160
v_exp_f32 v161, v161
v_exp_f32 v162, v162
v_exp_f32 v163, v163
v_exp_f32 v164, v164
v_exp_f32 v165, v165
v_exp_f32 v166, v166
v_exp_f32 v167, v167
v_pk_fma_f32 v[160:161], v[160:161], v[58:59], v[58:59]
v_pk_fma_f32 v[162:163], v[162:163], v[58:59], v[58:59]
v_pk_fma_f32 v[164:165], v[164:165], v[58:59], v[58:59]
v_pk_fma_f32 v[166:167], v[166:167], v[58:59], v[58:59]
v_rcp_f32 v160, v160
v_rcp_f32 v161, v161
v_rcp_f32 v162, v162
v_rcp_f32 v163, v163
v_rcp_f32 v164, v164
v_rcp_f32 v165, v165
v_rcp_f32 v166, v166
v_rcp_f32 v167, v167
v_pk_mul_f32 v[160:161], v[160:161], v[88:89]
v_pk_mul_f32 v[162:163], v[162:163], v[90:91]
v_pk_mul_f32 v[164:165], v[164:165], v[92:93]
v_pk_mul_f32 v[166:167], v[166:167], v[94:95]
v_cvt_pk_bf16_f32 v88, v160, v161
v_cvt_pk_bf16_f32 v89, v162, v163
v_cvt_pk_bf16_f32 v90, v164, v165
v_cvt_pk_bf16_f32 v91, v166, v167
buffer_store_dwordx4 v[88:91], v60, s[24:27], s100 offen offset:2560 sc1
s_waitcnt vmcnt(9)
v_cmp_eq_u32 vcc, 0, v254
s_cbranch_vccnz L_slow_29
L_back_30:
v_pk_mul_f32 v[160:161], v[96:97], v[96:97]
v_pk_mul_f32 v[162:163], v[98:99], v[98:99]
v_pk_mul_f32 v[164:165], v[100:101], v[100:101]
v_pk_mul_f32 v[166:167], v[102:103], v[102:103]
buffer_load_dwordx4 a[0:3], v248, s[24:27], s97 offen offset:0
v_pk_fma_f32 v[160:161], v[160:161], v[52:53], v[52:53] op_sel:[0,1,0] op_sel_hi:[1,1,0]
v_pk_fma_f32 v[162:163], v[162:163], v[52:53], v[52:53] op_sel:[0,1,0] op_sel_hi:[1,1,0]
v_pk_fma_f32 v[164:165], v[164:165], v[52:53], v[52:53] op_sel:[0,1,0] op_sel_hi:[1,1,0]
v_pk_fma_f32 v[166:167], v[166:167], v[52:53], v[52:53] op_sel:[0,1,0] op_sel_hi:[1,1,0]
v_pk_mul_f32 v[160:161], v[160:161], v[96:97]
v_pk_mul_f32 v[162:163], v[162:163], v[98:99]
v_pk_mul_f32 v[164:165], v[164:165], v[100:101]
v_pk_mul_f32 v[166:167], v[166:167], v[102:103]
buffer_load_dwordx4 a[4:7], v248, s[24:27], s97 offen offset:1024
v_exp_f32 v160, v160
v_exp_f32 v161, v161
v_exp_f32 v162, v162
v_exp_f32 v163, v163
v_exp_f32 v164, v164
v_exp_f32 v165, v165
v_exp_f32 v166, v166
v_exp_f32 v167, v167
buffer_load_dwordx4 a[8:11], v248, s[24:27], s97 offen offset:2048
v_pk_fma_f32 v[160:161], v[160:161], v[54:55], v[54:55]
v_pk_fma_f32 v[162:163], v[162:163], v[54:55], v[54:55]
v_pk_fma_f32 v[164:165], v[164:165], v[54:55], v[54:55]
v_pk_fma_f32 v[166:167], v[166:167], v[54:55], v[54:55]
v_rcp_f32 v160, v160
v_rcp_f32 v161, v161
v_rcp_f32 v162, v162
v_rcp_f32 v163, v163
buffer_load_dwordx4 a[12:15], v248, s[24:27], s97 offen offset:3072
v_rcp_f32 v164, v164
v_rcp_f32 v165, v165
v_rcp_f32 v166, v166
v_rcp_f32 v167, v167
v_pk_mul_f32 v[160:161], v[160:161], v[96:97]
v_pk_mul_f32 v[162:163], v[162:163], v[98:99]
v_pk_mul_f32 v[164:165], v[164:165], v[100:101]
v_pk_mul_f32 v[166:167], v[166:167], v[102:103]
buffer_load_dwordx4 a[16:19], v248, s[24:27], s98 offen
s_add_u32 s97, s97, 5120
s_cmp_eq_u32 s97, s80
s_cselect_b32 s97, s79, s97
s_add_u32 s98, s97, 4096
v_cvt_pk_bf16_f32 v96, v160, v161
v_cvt_pk_bf16_f32 v97, v162, v163
v_cvt_pk_bf16_f32 v98, v164, v165
v_cvt_pk_bf16_f32 v99, v166, v167
buffer_store_dwordx4 v[96:99], v60, s[24:27], s101 offen offset:0 sc1
v_pk_mul_f32 v[160:161], v[104:105], v[104:105]
v_pk_mul_f32 v[162:163], v[106:107], v[106:107]
v_pk_mul_f32 v[164:165], v[108:109], v[108:109]
v_pk_mul_f32 v[166:167], v[110:111], v[110:111]
buffer_load_dwordx4 a[20:23], v248, s[24:27], s97 offen offset:0
v_pk_fma_f32 v[160:161], v[160:161], v[52:53], v[52:53] op_sel:[0,1,0] op_sel_hi:[1,1,0]
v_pk_fma_f32 v[162:163], v[162:163], v[52:53], v[52:53] op_sel:[0,1,0] op_sel_hi:[1,1,0]
v_pk_fma_f32 v[164:165], v[164:165], v[52:53], v[52:53] op_sel:[0,1,0] op_sel_hi:[1,1,0]
v_pk_fma_f32 v[166:167], v[166:167], v[52:53], v[52:53] op_sel:[0,1,0] op_sel_hi:[1,1,0]
v_pk_mul_f32 v[160:161], v[160:161], v[104:105]
v_pk_mul_f32 v[162:163], v[162:163], v[106:107]
v_pk_mul_f32 v[164:165], v[164:165], v[108:109]
v_pk_mul_f32 v[166:167], v[166:167], v[110:111]
buffer_load_dwordx4 a[24:27], v248, s[24:27], s97 offen offset:1024
v_exp_f32 v160, v160
v_exp_f32 v161, v161
v_exp_f32 v162, v162
v_exp_f32 v163, v163
v_exp_f32 v164, v164
v_exp_f32 v165, v165
v_exp_f32 v166, v166
v_exp_f32 v167, v167
buffer_load_dwordx4 a[28:31], v248, s[24:27], s97 offen offset:2048
v_pk_fma_f32 v[160:161], v[160:161], v[54:55], v[54:55]
v_pk_fma_f32 v[162:163], v[162:163], v[54:55], v[54:55]
v_pk_fma_f32 v[164:165], v[164:165], v[54:55], v[54:55]
v_pk_fma_f32 v[166:167], v[166:167], v[54:55], v[54:55]
v_rcp_f32 v160, v160
v_rcp_f32 v161, v161
v_rcp_f32 v162, v162
v_rcp_f32 v163, v163
buffer_load_dwordx4 a[32:35], v248, s[24:27], s97 offen offset:3072
v_rcp_f32 v164, v164
v_rcp_f32 v165, v165
v_rcp_f32 v166, v166
v_rcp_f32 v167, v167
v_pk_mul_f32 v[160:161], v[160:161], v[104:105]
v_pk_mul_f32 v[162:163], v[162:163], v[106:107]
v_pk_mul_f32 v[164:165], v[164:165], v[108:109]
v_pk_mul_f32 v[166:167], v[166:167], v[110:111]
buffer_load_dwordx4 a[36:39], v248, s[24:27], s98 offen
s_add_u32 s97, s97, 5120
s_cmp_eq_u32 s97, s80
s_cselect_b32 s97, s79, s97
s_add_u32 s98, s97, 4096
v_cvt_pk_bf16_f32 v104, v160, v161
v_cvt_pk_bf16_f32 v105, v162, v163
v_cvt_pk_bf16_f32 v106, v164, v165
v_cvt_pk_bf16_f32 v107, v166, v167
buffer_store_dwordx4 v[104:107], v60, s[24:27], s101 offen offset:512 sc1
v_pk_mul_f32 v[160:161], v[112:113], v[112:113]
v_pk_mul_f32 v[162:163], v[114:115], v[114:115]
v_lshrrev_b32 v4, 4, v0
v_mul_u32_u24 v4, 288, v4
v_and_b32 v5, 15, v0
v_lshl_add_u32 v4, v5, 4, v4
v_add_u32 v4, 83200, v4
v_add_u32 v6, 62464, v4
s_waitcnt vmcnt(13)
v_pk_mul_f32 v[164:165], v[116:117], v[116:117]
v_pk_mul_f32 v[166:167], v[118:119], v[118:119]
v_pk_fma_f32 v[160:161], v[160:161], v[56:57], v[56:57] op_sel:[0,1,0] op_sel_hi:[1,1,0]
v_pk_fma_f32 v[162:163], v[162:163], v[56:57], v[56:57] op_sel:[0,1,0] op_sel_hi:[1,1,0]
buffer_load_dwordx4 a[40:43], v248, s[24:27], s97 offen offset:0
v_pk_fma_f32 v[164:165], v[164:165], v[56:57], v[56:57] op_sel:[0,1,0] op_sel_hi:[1,1,0]
v_pk_fma_f32 v[166:167], v[166:167], v[56:57], v[56:57] op_sel:[0,1,0] op_sel_hi:[1,1,0]
v_pk_mul_f32 v[160:161], v[160:161], v[112:113]
v_pk_mul_f32 v[162:163], v[162:163], v[114:115]
ds_write_b128 v4, v[32:35] offset:6784
v_pk_mul_f32 v[164:165], v[164:165], v[116:117]
v_pk_mul_f32 v[166:167], v[166:167], v[118:119]
v_exp_f32 v160, v160
v_exp_f32 v161, v161
buffer_load_dwordx4 a[44:47], v248, s[24:27], s97 offen offset:1024
v_exp_f32 v162, v162
v_exp_f32 v163, v163
v_exp_f32 v164, v164
v_exp_f32 v165, v165
v_alignbit_b32 v12, v33, v32, 16
v_alignbit_b32 v13, v34, v33, 16
v_alignbit_b32 v14, v35, v34, 16
v_alignbit_b32 v15, v36, v35, 16
v_exp_f32 v166, v166
v_exp_f32 v167, v167
v_pk_fma_f32 v[160:161], v[160:161], v[58:59], v[58:59]
v_pk_fma_f32 v[162:163], v[162:163], v[58:59], v[58:59]
buffer_load_dwordx4 a[48:51], v248, s[24:27], s97 offen offset:2048
v_pk_fma_f32 v[164:165], v[164:165], v[58:59], v[58:59]
v_pk_fma_f32 v[166:167], v[166:167], v[58:59], v[58:59]
v_rcp_f32 v160, v160
v_rcp_f32 v161, v161
ds_write_b128 v4, v[12:15] offset:0
v_rcp_f32 v162, v162
v_rcp_f32 v163, v163
v_rcp_f32 v164, v164
v_rcp_f32 v165, v165
buffer_load_dwordx4 a[52:55], v248, s[24:27], s97 offen offset:3072
v_rcp_f32 v166, v166
v_rcp_f32 v167, v167
v_pk_mul_f32 v[160:161], v[160:161], v[112:113]
v_pk_mul_f32 v[162:163], v[162:163], v[114:115]
ds_write_b128 v4, v[38:41] offset:38016
v_pk_mul_f32 v[164:165], v[164:165], v[116:117]
v_pk_mul_f32 v[166:167], v[166:167], v[118:119]
v_cvt_pk_bf16_f32 v112, v160, v161
v_cvt_pk_bf16_f32 v113, v162, v163
buffer_load_dwordx4 a[56:59], v248, s[24:27], s98 offen
s_add_u32 s97, s97, 5120
s_cmp_eq_u32 s97, s80
s_cselect_b32 s97, s79, s97
s_add_u32 s98, s97, 4096
v_cvt_pk_bf16_f32 v114, v164, v165
v_cvt_pk_bf16_f32 v115, v166, v167
buffer_store_dwordx4 v[112:115], v60, s[24:27], s101 offen offset:2048 sc1
v_pk_mul_f32 v[160:161], v[120:121], v[120:121]
v_pk_mul_f32 v[162:163], v[122:123], v[122:123]
v_alignbit_b32 v12, v39, v38, 16
v_alignbit_b32 v13, v40, v39, 16
v_alignbit_b32 v14, v41, v40, 16
v_alignbit_b32 v15, v42, v41, 16
v_pk_mul_f32 v[164:165], v[124:125], v[124:125]
v_pk_mul_f32 v[166:167], v[126:127], v[126:127]
v_pk_fma_f32 v[160:161], v[160:161], v[56:57], v[56:57] op_sel:[0,1,0] op_sel_hi:[1,1,0]
v_pk_fma_f32 v[162:163], v[162:163], v[56:57], v[56:57] op_sel:[0,1,0] op_sel_hi:[1,1,0]
buffer_load_dwordx4 a[60:63], v248, s[24:27], s97 offen offset:0
v_pk_fma_f32 v[164:165], v[164:165], v[56:57], v[56:57] op_sel:[0,1,0] op_sel_hi:[1,1,0]
v_pk_fma_f32 v[166:167], v[166:167], v[56:57], v[56:57] op_sel:[0,1,0] op_sel_hi:[1,1,0]
v_pk_mul_f32 v[160:161], v[160:161], v[120:121]
v_pk_mul_f32 v[162:163], v[162:163], v[122:123]
ds_write_b128 v4, v[12:15] offset:31232
v_pk_mul_f32 v[164:165], v[164:165], v[124:125]
v_pk_mul_f32 v[166:167], v[166:167], v[126:127]
v_exp_f32 v160, v160
v_exp_f32 v161, v161
buffer_load_dwordx4 a[64:67], v248, s[24:27], s97 offen offset:1024
v_exp_f32 v162, v162
v_exp_f32 v163, v163
v_exp_f32 v164, v164
v_exp_f32 v165, v165
ds_write_b128 v6, v[44:47] offset:6784
v_exp_f32 v166, v166
v_exp_f32 v167, v167
v_pk_fma_f32 v[160:161], v[160:161], v[58:59], v[58:59]
v_pk_fma_f32 v[162:163], v[162:163], v[58:59], v[58:59]
buffer_load_dwordx4 a[68:71], v248, s[24:27], s97 offen offset:2048
v_pk_fma_f32 v[164:165], v[164:165], v[58:59], v[58:59]
v_pk_fma_f32 v[166:167], v[166:167], v[58:59], v[58:59]
v_rcp_f32 v160, v160
v_rcp_f32 v161, v161
v_alignbit_b32 v12, v45, v44, 16
v_alignbit_b32 v13, v46, v45, 16
v_alignbit_b32 v14, v47, v46, 16
v_alignbit_b32 v15, v48, v47, 16
v_rcp_f32 v162, v162
v_rcp_f32 v163, v163
v_rcp_f32 v164, v164
v_rcp_f32 v165, v165
buffer_load_dwordx4 a[72:75], v248, s[24:27], s97 offen offset:3072
v_rcp_f32 v166, v166
v_rcp_f32 v167, v167
v_pk_mul_f32 v[160:161], v[160:161], v[120:121]
v_pk_mul_f32 v[162:163], v[162:163], v[122:123]
ds_write_b128 v6, v[12:15] offset:0
v_pk_mul_f32 v[164:165], v[164:165], v[124:125]
v_pk_mul_f32 v[166:167], v[166:167], v[126:127]
v_cvt_pk_bf16_f32 v120, v160, v161
v_cvt_pk_bf16_f32 v121, v162, v163
buffer_load_dwordx4 a[76:79], v248, s[24:27], s98 offen
s_add_u32 s97, s97, 5120
s_cmp_eq_u32 s97, s80
s_cselect_b32 s97, s79, s97
s_add_u32 s98, s97, 4096
v_cvt_pk_bf16_f32 v122, v164, v165
v_cvt_pk_bf16_f32 v123, v166, v167
buffer_store_dwordx4 v[120:123], v60, s[24:27], s101 offen offset:2560 sc1
L_conv:
s_waitcnt lgkmcnt(0)
s_barrier
v_mov_b32 v2, 61440
v_mov_b32 v3, 0
ds_write_b32 v2, v3
ds_read_b128 v[140:143], v8 offset:192
ds_read_b128 v[160:163], v9 offset:0
ds_read_b128 v[144:147], v8 offset:256
ds_read_b128 v[164:167], v9 offset:64
ds_read_b128 v[148:151], v8 offset:320
ds_read_b128 v[168:171], v9 offset:128
ds_read_b128 v[152:155], v8 offset:384
ds_read_b128 v[156:159], v8 offset:448
s_waitcnt lgkmcnt(6)
v_mfma_f32_16x16x32_bf16 v[188:191], v[192:195], v[160:163], 0
ds_read_b128 v[128:131], v8 offset:512
v_mfma_f32_16x16x32_bf16 v[188:191], v[140:143], v[160:163], v[188:191]
ds_read_b128 v[172:175], v9 offset:192
s_waitcnt lgkmcnt(6)
v_mfma_f32_16x16x32_bf16 v[184:187], v[192:195], v[164:167], 0
ds_read_b128 v[132:135], v8 offset:576
v_mfma_f32_16x16x32_bf16 v[188:191], v[144:147], v[164:167], v[188:191]
ds_read_b128 v[160:163], v9 offset:288
v_mfma_f32_16x16x32_bf16 v[184:187], v[140:143], v[164:167], v[184:187]
buffer_load_dwordx4 a[80:83], v248, s[24:27], s97 offen offset:0
s_waitcnt lgkmcnt(6)
v_mfma_f32_16x16x32_bf16 v[180:183], v[192:195], v[168:171], 0
ds_read_b128 v[136:139], v8 offset:640
v_mfma_f32_16x16x32_bf16 v[184:187], v[144:147], v[168:171], v[184:187]
ds_read_b128 v[164:167], v9 offset:352
v_mfma_f32_16x16x32_bf16 v[188:191], v[148:151], v[168:171], v[188:191]
buffer_load_dwordx4 a[84:87], v248, s[24:27], s97 offen offset:1024
v_mfma_f32_16x16x32_bf16 v[180:183], v[140:143], v[168:171], v[180:183]
s_waitcnt lgkmcnt(4)
v_mfma_f32_16x16x32_bf16 v[176:179], v[192:195], v[172:175], 0
v_mfma_f32_16x16x32_bf16 v[180:183], v[144:147], v[172:175], v[180:183]
v_mfma_f32_16x16x32_bf16 v[176:179], v[140:143], v[172:175], v[176:179]
ds_read_b128 v[140:143], v8 offset:704
buffer_load_dwordx4 a[88:91], v248, s[24:27], s97 offen offset:2048
v_mfma_f32_16x16x32_bf16 v[184:187], v[148:151], v[172:175], v[184:187]
ds_read_b128 v[168:171], v9 offset:416
v_mfma_f32_16x16x32_bf16 v[188:191], v[152:155], v[172:175], v[188:191]
s_waitcnt lgkmcnt(4)
v_mfma_f32_16x16x32_bf16 v[176:179], v[144:147], v[160:163], v[176:179]
ds_read_b128 v[144:147], v8 offset:768
v_mfma_f32_16x16x32_bf16 v[180:183], v[148:151], v[160:163], v[180:183]
ds_read_b128 v[172:175], v9 offset:480
v_mfma_f32_16x16x32_bf16 v[184:187], v[152:155], v[160:163], v[184:187]
buffer_load_dwordx4 a[92:95], v248, s[24:27], s97 offen offset:3072
v_mfma_f32_16x16x32_bf16 v[188:191], v[156:159], v[160:163], v[188:191]
s_waitcnt lgkmcnt(4)
v_mfma_f32_16x16x32_bf16 v[176:179], v[148:151], v[164:167], v[176:179]
ds_read_b128 v[148:151], v8 offset:832
v_mfma_f32_16x16x32_bf16 v[180:183], v[152:155], v[164:167], v[180:183]
ds_read_b128 v[160:163], v9 offset:576
v_mfma_f32_16x16x32_bf16 v[184:187], v[156:159], v[164:167], v[184:187]
buffer_load_dwordx4 a[96:99], v248, s[24:27], s98 offen
v_mfma_f32_16x16x32_bf16 v[188:191], v[128:131], v[164:167], v[188:191]
s_add_u32 s97, s97, 5120
s_cmp_eq_u32 s97, s80
s_cselect_b32 s97, s79, s97
s_add_u32 s98, s97, 4096
s_waitcnt lgkmcnt(4)
v_mfma_f32_16x16x32_bf16 v[176:179], v[152:155], v[168:171], v[176:179]
ds_read_b128 v[152:155], v8 offset:896
v_mfma_f32_16x16x32_bf16 v[180:183], v[156:159], v[168:171], v[180:183]
ds_read_b128 v[164:167], v9 offset:640
v_mfma_f32_16x16x32_bf16 v[184:187], v[128:131], v[168:171], v[184:187]
v_mfma_f32_16x16x32_bf16 v[188:191], v[132:135], v[168:171], v[188:191]
s_waitcnt lgkmcnt(4)
v_mfma_f32_16x16x32_bf16 v[176:179], v[156:159], v[172:175], v[176:179]
ds_read_b128 v[156:159], v8 offset:960
v_mfma_f32_16x16x32_bf16 v[180:183], v[128:131], v[172:175], v[180:183]
ds_read_b128 v[168:171], v9 offset:704
v_mfma_f32_16x16x32_bf16 v[184:187], v[132:135], v[172:175], v[184:187]
buffer_load_dwordx4 a[100:103], v248, s[24:27], s97 offen offset:0
v_mfma_f32_16x16x32_bf16 v[188:191], v[136:139], v[172:175], v[188:191]
s_waitcnt lgkmcnt(4)
v_mfma_f32_16x16x32_bf16 v[176:179], v[128:131], v[160:163], v[176:179]
ds_read_b128 v[128:131], v8 offset:1024
v_mfma_f32_16x16x32_bf16 v[180:183], v[132:135], v[160:163], v[180:183]
ds_read_b128 v[172:175], v9 offset:768
v_mfma_f32_16x16x32_bf16 v[184:187], v[136:139], v[160:163], v[184:187]
buffer_load_dwordx4 a[104:107], v248, s[24:27], s97 offen offset:1024
v_mfma_f32_16x16x32_bf16 v[188:191], v[140:143], v[160:163], v[188:191]
s_waitcnt lgkmcnt(4)
v_mfma_f32_16x16x32_bf16 v[176:179], v[132:135], v[164:167], v[176:179]
ds_read_b128 v[132:135], v8 offset:1088
v_mfma_f32_16x16x32_bf16 v[180:183], v[136:139], v[164:167], v[180:183]
ds_read_b128 v[160:163], v9 offset:864
v_mfma_f32_16x16x32_bf16 v[184:187], v[140:143], v[164:167], v[184:187]
buffer_load_dwordx4 a[108:111], v248, s[24:27], s97 offen offset:2048
v_mfma_f32_16x16x32_bf16 v[188:191], v[144:147], v[164:167], v[188:191]
s_waitcnt lgkmcnt(4)
v_mfma_f32_16x16x32_bf16 v[176:179], v[136:139], v[168:171], v[176:179]
ds_read_b128 v[136:139], v8 offset:1152
v_mfma_f32_16x16x32_bf16 v[180:183], v[140:143], v[168:171], v[180:183]
ds_read_b128 v[164:167], v9 offset:928
v_mfma_f32_16x16x32_bf16 v[184:187], v[144:147], v[168:171], v[184:187]
buffer_load_dwordx4 a[112:115], v248, s[24:27], s97 offen offset:3072
v_mfma_f32_16x16x32_bf16 v[188:191], v[148:151], v[168:171], v[188:191]
s_waitcnt lgkmcnt(4)
v_mfma_f32_16x16x32_bf16 v[176:179], v[140:143], v[172:175], v[176:179]
ds_read_b128 v[140:143], v8 offset:1216
v_mfma_f32_16x16x32_bf16 v[180:183], v[144:147], v[172:175], v[180:183]
ds_read_b128 v[168:171], v9 offset:992
v_mfma_f32_16x16x32_bf16 v[184:187], v[148:151], v[172:175], v[184:187]
buffer_load_dwordx4 a[116:119], v248, s[24:27], s98 offen
v_mfma_f32_16x16x32_bf16 v[188:191], v[152:155], v[172:175], v[188:191]
s_add_u32 s97, s97, 5120
s_cmp_eq_u32 s97, s80
s_cselect_b32 s97, s79, s97
s_add_u32 s98, s97, 4096
s_waitcnt lgkmcnt(4)
v_mfma_f32_16x16x32_bf16 v[176:179], v[144:147], v[160:163], v[176:179]
ds_read_b128 v[144:147], v8 offset:1280
v_mfma_f32_16x16x32_bf16 v[180:183], v[148:151], v[160:163], v[180:183]
ds_read_b128 v[172:175], v9 offset:1056
v_mfma_f32_16x16x32_bf16 v[184:187], v[152:155], v[160:163], v[184:187]
v_mfma_f32_16x16x32_bf16 v[188:191], v[156:159], v[160:163], v[188:191]
s_waitcnt lgkmcnt(4)
v_mfma_f32_16x16x32_bf16 v[176:179], v[148:151], v[164:167], v[176:179]
ds_read_b128 v[148:151], v8 offset:1344
v_mfma_f32_16x16x32_bf16 v[180:183], v[152:155], v[164:167], v[180:183]
ds_read_b128 v[160:163], v9 offset:1152
v_mfma_f32_16x16x32_bf16 v[184:187], v[156:159], v[164:167], v[184:187]
buffer_load_dwordx4 a[120:123], v248, s[24:27], s97 offen offset:0
v_mfma_f32_16x16x32_bf16 v[188:191], v[128:131], v[164:167], v[188:191]
s_waitcnt vmcnt(11)
s_barrier
s_cmp_lg_u32 s5, 0
s_cbranch_scc1 L_fl_33
s_mov_b64 exec, 1
buffer_store_dword v253, v252, s[24:27], 0 offen offset:16 sc1
s_mov_b64 exec, -1
L_fl_33:
s_waitcnt lgkmcnt(4)
v_mfma_f32_16x16x32_bf16 v[176:179], v[152:155], v[168:171], v[176:179]
ds_read_b128 v[152:155], v8 offset:1408
v_mfma_f32_16x16x32_bf16 v[180:183], v[156:159], v[168:171], v[180:183]
ds_read_b128 v[164:167], v9 offset:1216
v_mfma_f32_16x16x32_bf16 v[184:187], v[128:131], v[168:171], v[184:187]
buffer_load_dwordx4 a[124:127], v248, s[24:27], s97 offen offset:1024
v_mfma_f32_16x16x32_bf16 v[188:191], v[132:135], v[168:171], v[188:191]
s_waitcnt lgkmcnt(4)
v_mfma_f32_16x16x32_bf16 v[176:179], v[156:159], v[172:175], v[176:179]
ds_read_b128 v[156:159], v8 offset:1472
v_mfma_f32_16x16x32_bf16 v[180:183], v[128:131], v[172:175], v[180:183]
ds_read_b128 v[168:171], v9 offset:1280
v_mfma_f32_16x16x32_bf16 v[184:187], v[132:135], v[172:175], v[184:187]
buffer_load_dwordx4 a[128:131], v248, s[24:27], s97 offen offset:2048
v_mfma_f32_16x16x32_bf16 v[188:191], v[136:139], v[172:175], v[188:191]
s_waitcnt lgkmcnt(4)
v_mfma_f32_16x16x32_bf16 v[176:179], v[128:131], v[160:163], v[176:179]
ds_read_b128 v[128:131], v8 offset:1536
v_mfma_f32_16x16x32_bf16 v[180:183], v[132:135], v[160:163], v[180:183]
ds_read_b128 v[172:175], v9 offset:1344
v_mfma_f32_16x16x32_bf16 v[184:187], v[136:139], v[160:163], v[184:187]
buffer_load_dwordx4 a[132:135], v248, s[24:27], s97 offen offset:3072
v_mfma_f32_16x16x32_bf16 v[188:191], v[140:143], v[160:163], v[188:191]
s_waitcnt lgkmcnt(4)
v_mfma_f32_16x16x32_bf16 v[176:179], v[132:135], v[164:167], v[176:179]
ds_read_b128 v[132:135], v8 offset:1600
v_mfma_f32_16x16x32_bf16 v[180:183], v[136:139], v[164:167], v[180:183]
ds_read_b128 v[160:163], v9 offset:1440
v_mfma_f32_16x16x32_bf16 v[184:187], v[140:143], v[164:167], v[184:187]
buffer_load_dwordx4 a[136:139], v248, s[24:27], s98 offen
v_mfma_f32_16x16x32_bf16 v[188:191], v[144:147], v[164:167], v[188:191]
s_add_u32 s97, s97, 5120
s_cmp_eq_u32 s97, s80
s_cselect_b32 s97, s79, s97
s_add_u32 s98, s97, 4096
s_waitcnt lgkmcnt(4)
v_mfma_f32_16x16x32_bf16 v[176:179], v[136:139], v[168:171], v[176:179]
ds_read_b128 v[136:139], v8 offset:1664
v_mfma_f32_16x16x32_bf16 v[180:183], v[140:143], v[168:171], v[180:183]
ds_read_b128 v[164:167], v9 offset:1504
v_mfma_f32_16x16x32_bf16 v[184:187], v[144:147], v[168:171], v[184:187]
v_mfma_f32_16x16x32_bf16 v[188:191], v[148:151], v[168:171], v[188:191]
s_waitcnt lgkmcnt(4)
v_mfma_f32_16x16x32_bf16 v[176:179], v[140:143], v[172:175], v[176:179]
ds_read_b128 v[140:143], v8 offset:1728
v_mfma_f32_16x16x32_bf16 v[180:183], v[144:147], v[172:175], v[180:183]
ds_read_b128 v[168:171], v9 offset:1568
v_mfma_f32_16x16x32_bf16 v[184:187], v[148:151], v[172:175], v[184:187]
buffer_load_dwordx4 a[140:143], v248, s[24:27], s97 offen offset:0
v_mfma_f32_16x16x32_bf16 v[188:191], v[152:155], v[172:175], v[188:191]
s_waitcnt lgkmcnt(4)
v_mfma_f32_16x16x32_bf16 v[176:179], v[144:147], v[160:163], v[176:179]
ds_read_b128 v[144:147], v8 offset:1792
v_mfma_f32_16x16x32_bf16 v[180:183], v[148:151], v[160:163], v[180:183]
ds_read_b128 v[172:175], v9 offset:1632
v_mfma_f32_16x16x32_bf16 v[184:187], v[152:155], v[160:163], v[184:187]
buffer_load_dwordx4 a[144:147], v248, s[24:27], s97 offen offset:1024
v_mfma_f32_16x16x32_bf16 v[188:191], v[156:159], v[160:163], v[188:191]
s_mov_b32 s32, s60
s_and_b32 s33, s61, 0xffff
s_mov_b32 s34, 1280
s_mov_b32 s35, 0x20000
v_lshrrev_b32 v19, 4, v1
v_mul_u32_u24 v19, 40, v19
s_mul_i32 s6, s95, 160
v_add_u32 v19, s6, v19
buffer_load_dwordx4 a[240:243], v19, s[32:35], 0 offen
buffer_load_dwordx4 a[244:247], v19, s[32:35], 0 offen offset:16
buffer_load_dwordx2 a[248:249], v19, s[32:35], 0 offen offset:32
s_waitcnt lgkmcnt(4)
v_mfma_f32_16x16x32_bf16 v[176:179], v[148:151], v[164:167], v[176:179]
ds_read_b128 v[148:151], v8 offset:1856
v_mfma_f32_16x16x32_bf16 v[180:183], v[152:155], v[164:167], v[180:183]
ds_read_b128 v[160:163], v9 offset:1728
v_mfma_f32_16x16x32_bf16 v[184:187], v[156:159], v[164:167], v[184:187]
buffer_load_dwordx4 a[148:151], v248, s[24:27], s97 offen offset:2048
v_mfma_f32_16x16x32_bf16 v[188:191], v[128:131], v[164:167], v[188:191]
s_waitcnt lgkmcnt(4)
v_mfma_f32_16x16x32_bf16 v[176:179], v[152:155], v[168:171], v[176:179]
ds_read_b128 v[152:155], v8 offset:1920
v_mfma_f32_16x16x32_bf16 v[180:183], v[156:159], v[168:171], v[180:183]
ds_read_b128 v[164:167], v9 offset:1792
v_mfma_f32_16x16x32_bf16 v[184:187], v[128:131], v[168:171], v[184:187]
buffer_load_dwordx4 a[152:155], v248, s[24:27], s97 offen offset:3072
v_mfma_f32_16x16x32_bf16 v[188:191], v[132:135], v[168:171], v[188:191]
s_waitcnt lgkmcnt(4)
v_mfma_f32_16x16x32_bf16 v[176:179], v[156:159], v[172:175], v[176:179]
ds_read_b128 v[156:159], v8 offset:1984
v_mfma_f32_16x16x32_bf16 v[180:183], v[128:131], v[172:175], v[180:183]
ds_read_b128 v[168:171], v9 offset:1856
v_mfma_f32_16x16x32_bf16 v[184:187], v[132:135], v[172:175], v[184:187]
buffer_load_dwordx4 a[156:159], v248, s[24:27], s98 offen
v_mfma_f32_16x16x32_bf16 v[188:191], v[136:139], v[172:175], v[188:191]
s_add_u32 s97, s97, 5120
s_cmp_eq_u32 s97, s80
s_cselect_b32 s97, s79, s97
s_add_u32 s98, s97, 4096
s_waitcnt lgkmcnt(4)
v_mfma_f32_16x16x32_bf16 v[176:179], v[128:131], v[160:163], v[176:179]
ds_read_b128 v[128:131], v8 offset:2048
v_mfma_f32_16x16x32_bf16 v[180:183], v[132:135], v[160:163], v[180:183]
ds_read_b128 v[172:175], v9 offset:1920
v_mfma_f32_16x16x32_bf16 v[184:187], v[136:139], v[160:163], v[184:187]
v_mfma_f32_16x16x32_bf16 v[188:191], v[140:143], v[160:163], v[188:191]
s_waitcnt lgkmcnt(4)
v_mfma_f32_16x16x32_bf16 v[176:179], v[132:135], v[164:167], v[176:179]
ds_read_b128 v[132:135], v8 offset:2112
v_mfma_f32_16x16x32_bf16 v[180:183], v[136:139], v[164:167], v[180:183]
ds_read_b128 v[160:163], v9 offset:2016
v_mfma_f32_16x16x32_bf16 v[184:187], v[140:143], v[164:167], v[184:187]
buffer_load_dwordx4 a[160:163], v248, s[24:27], s97 offen offset:0
v_mfma_f32_16x16x32_bf16 v[188:191], v[144:147], v[164:167], v[188:191]
s_waitcnt lgkmcnt(4)
v_mfma_f32_16x16x32_bf16 v[176:179], v[136:139], v[168:171], v[176:179]
ds_read_b128 v[136:139], v8 offset:2176
v_mfma_f32_16x16x32_bf16 v[180:183], v[140:143], v[168:171], v[180:183]
ds_read_b128 v[164:167], v9 offset:2080
v_mfma_f32_16x16x32_bf16 v[184:187], v[144:147], v[168:171], v[184:187]
buffer_load_dwordx4 a[164:167], v248, s[24:27], s97 offen offset:1024
v_mfma_f32_16x16x32_bf16 v[188:191], v[148:151], v[168:171], v[188:191]
s_cmp_lg_u32 s86, 0
s_cbranch_scc1 L_stay_35
s_cmp_eq_u32 s87, 3
s_cselect_b32 s85, s85, s87
s_mul_i32 s84, s85, 31232
s_add_u32 s84, s84, 63488
v_add_u32 v8, s84, v16
s_waitcnt lgkmcnt(4)
v_mfma_f32_16x16x32_bf16 v[176:179], v[140:143], v[172:175], v[176:179]
ds_read_b128 v[140:143], v8 offset:2240
v_mfma_f32_16x16x32_bf16 v[180:183], v[144:147], v[172:175], v[180:183]
ds_read_b128 v[168:171], v9 offset:2144
s_add_u32 s84, s84, 17408
s_add_u32 s91, s88, s85
v_mfma_f32_16x16x32_bf16 v[184:187], v[148:151], v[172:175], v[184:187]
buffer_load_dwordx4 a[168:171], v248, s[24:27], s97 offen offset:2048
v_mfma_f32_16x16x32_bf16 v[188:191], v[152:155], v[172:175], v[188:191]
s_waitcnt lgkmcnt(4)
v_mfma_f32_16x16x32_bf16 v[176:179], v[144:147], v[160:163], v[176:179]
ds_read_b128 v[144:147], v8 offset:2304
s_and_b32 s89, s88, 0xfffffffe
s_sub_u32 s89, s91, s89
s_cmp_ge_u32 s89, 2
s_cselect_b32 s90, s1, s0
v_mfma_f32_16x16x32_bf16 v[180:183], v[148:151], v[160:163], v[180:183]
ds_read_b128 v[172:175], v9 offset:2208
s_and_b32 s89, s89, 1
s_lshl_b32 s89, s89, 4
s_lshr_b32 s90, s90, s89
s_and_b32 s90, s90, 0xffff
v_mfma_f32_16x16x32_bf16 v[184:187], v[152:155], v[160:163], v[184:187]
buffer_load_dwordx4 a[172:175], v248, s[24:27], s97 offen offset:3072
v_mfma_f32_16x16x32_bf16 v[188:191], v[156:159], v[160:163], v[188:191]
v_add_u32 v9, s84, v17
s_waitcnt lgkmcnt(4)
v_mfma_f32_16x16x32_bf16 v[176:179], v[148:151], v[164:167], v[176:179]
ds_read_b128 v[148:151], v8 offset:2368
v_mov_b32 v3, s90
v_and_b32 v2, 15, v1
v_mfma_f32_16x16x32_bf16 v[180:183], v[152:155], v[164:167], v[180:183]
ds_read_b128 v[160:163], v9 offset:2304
v_lshl_add_u32 v2, v18, 2, v2
v_sub_u32 v2, 15, v2
v_mfma_f32_16x16x32_bf16 v[184:187], v[156:159], v[164:167], v[184:187]
buffer_load_dwordx4 a[176:179], v248, s[24:27], s98 offen
v_mfma_f32_16x16x32_bf16 v[188:191], v[128:131], v[164:167], v[188:191]
s_add_u32 s97, s97, 5120
s_cmp_eq_u32 s97, s80
s_cselect_b32 s97, s79, s97
s_add_u32 s98, s97, 4096
s_waitcnt lgkmcnt(4)
v_mfma_f32_16x16x32_bf16 v[176:179], v[152:155], v[168:171], v[176:179]
ds_read_b128 v[152:155], v8 offset:2432
v_cmp_eq_u32 vcc, 0, v2
v_cndmask_b32 v192, 0, v3, vcc
v_mfma_f32_16x16x32_bf16 v[180:183], v[156:159], v[168:171], v[180:183]
ds_read_b128 v[164:167], v9 offset:2368
v_cmp_eq_u32 vcc, 1, v2
v_cndmask_b32 v193, 0, v3, vcc
v_mfma_f32_16x16x32_bf16 v[184:187], v[128:131], v[168:171], v[184:187]
v_cmp_eq_u32 vcc, 2, v2
v_cndmask_b32 v194, 0, v3, vcc
v_mfma_f32_16x16x32_bf16 v[188:191], v[132:135], v[168:171], v[188:191]
v_cmp_eq_u32 vcc, 3, v2
v_cndmask_b32 v195, 0, v3, vcc
s_waitcnt lgkmcnt(4)
v_mfma_f32_16x16x32_bf16 v[188:191], v[136:139], v[172:175], v[188:191]
v_mfma_f32_16x16x32_bf16 v[184:187], v[132:135], v[172:175], v[184:187]
ds_read_b128 v[168:171], v9 offset:2432
v_mfma_f32_16x16x32_bf16 v[180:183], v[128:131], v[172:175], v[180:183]
v_mfma_f32_16x16x32_bf16 v[176:179], v[156:159], v[172:175], v[176:179]
ds_read_b128 v[156:159], v8 offset:2496
v_cvt_pk_bf16_f32 v26, v188, v189
v_cvt_pk_bf16_f32 v27, v190, v191
s_waitcnt lgkmcnt(4)
v_mfma_f32_16x16x32_bf16 v[188:191], v[192:195], v[160:163], 0
ds_read_b128 v[128:131], v8 offset:2560
v_cvt_pk_bf16_f32 v24, v184, v185
v_cvt_pk_bf16_f32 v25, v186, v187
v_mfma_f32_16x16x32_bf16 v[188:191], v[140:143], v[160:163], v[188:191]
ds_read_b128 v[172:175], v9 offset:2496
buffer_store_dwordx4 v[24:27], v11, s[24:27], s92 offen offset:128 sc1
buffer_load_dwordx4 a[180:183], v248, s[24:27], s97 offen offset:0
buffer_load_dwordx4 a[184:187], v248, s[24:27], s97 offen offset:1024
s_waitcnt lgkmcnt(4)
v_mfma_f32_16x16x32_bf16 v[184:187], v[192:195], v[164:167], 0
ds_read_b128 v[132:135], v8 offset:2624
v_cvt_pk_bf16_f32 v22, v180, v181
v_cvt_pk_bf16_f32 v23, v182, v183
v_mfma_f32_16x16x32_bf16 v[188:191], v[144:147], v[164:167], v[188:191]
ds_read_b128 v[160:163], v9 offset:2592
v_cvt_pk_bf16_f32 v20, v176, v177
v_cvt_pk_bf16_f32 v21, v178, v179
v_mfma_f32_16x16x32_bf16 v[184:187], v[140:143], v[164:167], v[184:187]
buffer_store_dwordx4 v[20:23], v11, s[24:27], s92 offen offset:0 sc1
buffer_load_dwordx4 a[188:191], v248, s[24:27], s97 offen offset:2048
s_waitcnt lgkmcnt(5)
v_mfma_f32_16x16x32_bf16 v[180:183], v[192:195], v[168:171], 0
ds_read_b128 v[136:139], v8 offset:2688
v_mfma_f32_16x16x32_bf16 v[184:187], v[144:147], v[168:171], v[184:187]
ds_read_b128 v[164:167], v9 offset:2656
s_lshl_b32 s92, s91, 12
s_add_u32 s92, s92, 4194304
s_cmp_eq_u32 s87, 3
s_cselect_b64 vcc, -1, 0
v_mfma_f32_16x16x32_bf16 v[188:191], v[148:151], v[168:171], v[188:191]
v_mov_b32 v2, 2147418112
v_cndmask_b32 v11, v11, v2, vcc
buffer_load_dwordx4 a[192:195], v248, s[24:27], s97 offen offset:3072
v_mfma_f32_16x16x32_bf16 v[180:183], v[140:143], v[168:171], v[180:183]
s_waitcnt lgkmcnt(4)
v_mfma_f32_16x16x32_bf16 v[176:179], v[192:195], v[172:175], 0
v_mfma_f32_16x16x32_bf16 v[180:183], v[144:147], v[172:175], v[180:183]
v_mfma_f32_16x16x32_bf16 v[176:179], v[140:143], v[172:175], v[176:179]
ds_read_b128 v[140:143], v8 offset:2752
buffer_load_dwordx4 a[196:199], v248, s[24:27], s98 offen
v_mfma_f32_16x16x32_bf16 v[184:187], v[148:151], v[172:175], v[184:187]
ds_read_b128 v[168:171], v9 offset:2720
s_add_u32 s97, s97, 5120
s_cmp_eq_u32 s97, s80
s_cselect_b32 s97, s79, s97
s_add_u32 s98, s97, 4096
v_mfma_f32_16x16x32_bf16 v[188:191], v[152:155], v[172:175], v[188:191]
s_branch L_join_36
L_stay_35:
s_waitcnt lgkmcnt(4)
v_mfma_f32_16x16x32_bf16 v[176:179], v[140:143], v[172:175], v[176:179]
ds_read_b128 v[140:143], v8 offset:2240
v_mfma_f32_16x16x32_bf16 v[180:183], v[144:147], v[172:175], v[180:183]
ds_read_b128 v[168:171], v9 offset:2144
v_mfma_f32_16x16x32_bf16 v[184:187], v[148:151], v[172:175], v[184:187]
buffer_load_dwordx4 a[168:171], v248, s[24:27], s97 offen offset:2048
v_mfma_f32_16x16x32_bf16 v[188:191], v[152:155], v[172:175], v[188:191]
s_waitcnt lgkmcnt(4)
v_mfma_f32_16x16x32_bf16 v[176:179], v[144:147], v[160:163], v[176:179]
ds_read_b128 v[144:147], v8 offset:2304
v_mfma_f32_16x16x32_bf16 v[180:183], v[148:151], v[160:163], v[180:183]
ds_read_b128 v[172:175], v9 offset:2208
v_mfma_f32_16x16x32_bf16 v[184:187], v[152:155], v[160:163], v[184:187]
buffer_load_dwordx4 a[172:175], v248, s[24:27], s97 offen offset:3072
v_mfma_f32_16x16x32_bf16 v[188:191], v[156:159], v[160:163], v[188:191]
s_waitcnt lgkmcnt(4)
v_mfma_f32_16x16x32_bf16 v[176:179], v[148:151], v[164:167], v[176:179]
ds_read_b128 v[148:151], v8 offset:2368
v_mfma_f32_16x16x32_bf16 v[180:183], v[152:155], v[164:167], v[180:183]
ds_read_b128 v[160:163], v9 offset:2304
v_mfma_f32_16x16x32_bf16 v[184:187], v[156:159], v[164:167], v[184:187]
buffer_load_dwordx4 a[176:179], v248, s[24:27], s98 offen
v_mfma_f32_16x16x32_bf16 v[188:191], v[128:131], v[164:167], v[188:191]
s_add_u32 s97, s97, 5120
s_cmp_eq_u32 s97, s80
s_cselect_b32 s97, s79, s97
s_add_u32 s98, s97, 4096
s_waitcnt lgkmcnt(4)
v_mfma_f32_16x16x32_bf16 v[176:179], v[152:155], v[168:171], v[176:179]
ds_read_b128 v[152:155], v8 offset:2432
v_mfma_f32_16x16x32_bf16 v[180:183], v[156:159], v[168:171], v[180:183]
ds_read_b128 v[164:167], v9 offset:2368
v_mfma_f32_16x16x32_bf16 v[184:187], v[128:131], v[168:171], v[184:187]
v_mfma_f32_16x16x32_bf16 v[188:191], v[132:135], v[168:171], v[188:191]
s_waitcnt lgkmcnt(4)
v_mfma_f32_16x16x32_bf16 v[176:179], v[156:159], v[172:175], v[176:179]
ds_read_b128 v[156:159], v8 offset:2496
v_mfma_f32_16x16x32_bf16 v[180:183], v[128:131], v[172:175], v[180:183]
ds_read_b128 v[168:171], v9 offset:2432
v_mfma_f32_16x16x32_bf16 v[184:187], v[132:135], v[172:175], v[184:187]
v_mfma_f32_16x16x32_bf16 v[188:191], v[136:139], v[172:175], v[188:191]
s_waitcnt lgkmcnt(4)
v_mfma_f32_16x16x32_bf16 v[176:179], v[128:131], v[160:163], v[176:179]
ds_read_b128 v[128:131], v8 offset:2560
v_mfma_f32_16x16x32_bf16 v[180:183], v[132:135], v[160:163], v[180:183]
ds_read_b128 v[172:175], v9 offset:2496
v_mfma_f32_16x16x32_bf16 v[184:187], v[136:139], v[160:163], v[184:187]
buffer_load_dwordx4 a[180:183], v248, s[24:27], s97 offen offset:0
v_mfma_f32_16x16x32_bf16 v[188:191], v[140:143], v[160:163], v[188:191]
buffer_load_dwordx4 a[184:187], v248, s[24:27], s97 offen offset:1024
s_waitcnt lgkmcnt(4)
v_mfma_f32_16x16x32_bf16 v[176:179], v[132:135], v[164:167], v[176:179]
ds_read_b128 v[132:135], v8 offset:2624
v_mfma_f32_16x16x32_bf16 v[180:183], v[136:139], v[164:167], v[180:183]
ds_read_b128 v[160:163], v9 offset:2592
v_mfma_f32_16x16x32_bf16 v[184:187], v[140:143], v[164:167], v[184:187]
buffer_load_dwordx4 a[188:191], v248, s[24:27], s97 offen offset:2048
v_mfma_f32_16x16x32_bf16 v[188:191], v[144:147], v[164:167], v[188:191]
s_waitcnt lgkmcnt(4)
v_mfma_f32_16x16x32_bf16 v[176:179], v[136:139], v[168:171], v[176:179]
ds_read_b128 v[136:139], v8 offset:2688
v_mfma_f32_16x16x32_bf16 v[180:183], v[140:143], v[168:171], v[180:183]
ds_read_b128 v[164:167], v9 offset:2656
v_mfma_f32_16x16x32_bf16 v[184:187], v[144:147], v[168:171], v[184:187]
buffer_load_dwordx4 a[192:195], v248, s[24:27], s97 offen offset:3072
v_mfma_f32_16x16x32_bf16 v[188:191], v[148:151], v[168:171], v[188:191]
s_waitcnt lgkmcnt(4)
v_mfma_f32_16x16x32_bf16 v[176:179], v[140:143], v[172:175], v[176:179]
ds_read_b128 v[140:143], v8 offset:2752
v_mfma_f32_16x16x32_bf16 v[180:183], v[144:147], v[172:175], v[180:183]
ds_read_b128 v[168:171], v9 offset:2720
v_mfma_f32_16x16x32_bf16 v[184:187], v[148:151], v[172:175], v[184:187]
buffer_load_dwordx4 a[196:199], v248, s[24:27], s98 offen
v_mfma_f32_16x16x32_bf16 v[188:191], v[152:155], v[172:175], v[188:191]
s_add_u32 s97, s97, 5120
s_cmp_eq_u32 s97, s80
s_cselect_b32 s97, s79, s97
s_add_u32 s98, s97, 4096
L_join_36:
s_waitcnt lgkmcnt(4)
v_mfma_f32_16x16x32_bf16 v[176:179], v[144:147], v[160:163], v[176:179]
ds_read_b128 v[144:147], v8 offset:2816
v_mfma_f32_16x16x32_bf16 v[180:183], v[148:151], v[160:163], v[180:183]
ds_read_b128 v[172:175], v9 offset:2784
v_mfma_f32_16x16x32_bf16 v[184:187], v[152:155], v[160:163], v[184:187]
buffer_load_dwordx4 a[200:203], v248, s[24:27], s97 offen offset:0
v_mfma_f32_16x16x32_bf16 v[188:191], v[156:159], v[160:163], v[188:191]
s_waitcnt lgkmcnt(4)
v_mfma_f32_16x16x32_bf16 v[176:179], v[148:151], v[164:167], v[176:179]
ds_read_b128 v[148:151], v8 offset:2880
v_mfma_f32_16x16x32_bf16 v[180:183], v[152:155], v[164:167], v[180:183]
ds_read_b128 v[160:163], v9 offset:2880
v_mfma_f32_16x16x32_bf16 v[184:187], v[156:159], v[164:167], v[184:187]
buffer_load_dwordx4 a[204:207], v248, s[24:27], s97 offen offset:1024
v_mfma_f32_16x16x32_bf16 v[188:191], v[128:131], v[164:167], v[188:191]
s_waitcnt lgkmcnt(4)
v_mfma_f32_16x16x32_bf16 v[176:179], v[152:155], v[168:171], v[176:179]
ds_read_b128 v[152:155], v8 offset:2944
v_mfma_f32_16x16x32_bf16 v[180:183], v[156:159], v[168:171], v[180:183]
ds_read_b128 v[164:167], v9 offset:2944
v_mfma_f32_16x16x32_bf16 v[184:187], v[128:131], v[168:171], v[184:187]
buffer_load_dwordx4 a[208:211], v248, s[24:27], s97 offen offset:2048
v_mfma_f32_16x16x32_bf16 v[188:191], v[132:135], v[168:171], v[188:191]
s_waitcnt lgkmcnt(4)
v_mfma_f32_16x16x32_bf16 v[176:179], v[156:159], v[172:175], v[176:179]
ds_read_b128 v[156:159], v8 offset:3008
v_mfma_f32_16x16x32_bf16 v[180:183], v[128:131], v[172:175], v[180:183]
ds_read_b128 v[168:171], v9 offset:3008
v_mfma_f32_16x16x32_bf16 v[184:187], v[132:135], v[172:175], v[184:187]
buffer_load_dwordx4 a[212:215], v248, s[24:27], s97 offen offset:3072
v_mfma_f32_16x16x32_bf16 v[188:191], v[136:139], v[172:175], v[188:191]
buffer_load_dwordx4 a[216:219], v248, s[24:27], s98 offen
s_add_u32 s97, s97, 5120
s_cmp_eq_u32 s97, s80
s_cselect_b32 s97, s79, s97
s_add_u32 s98, s97, 4096
s_waitcnt lgkmcnt(4)
v_mfma_f32_16x16x32_bf16 v[176:179], v[128:131], v[160:163], v[176:179]
ds_read_b128 v[128:131], v8 offset:3072
v_mfma_f32_16x16x32_bf16 v[180:183], v[132:135], v[160:163], v[180:183]
ds_read_b128 v[172:175], v9 offset:3072
v_mfma_f32_16x16x32_bf16 v[184:187], v[136:139], v[160:163], v[184:187]
buffer_load_dwordx4 a[220:223], v248, s[24:27], s97 offen offset:0
v_mfma_f32_16x16x32_bf16 v[188:191], v[140:143], v[160:163], v[188:191]
s_waitcnt lgkmcnt(4)
v_mfma_f32_16x16x32_bf16 v[176:179], v[132:135], v[164:167], v[176:179]
ds_read_b128 v[132:135], v8 offset:3136
v_mfma_f32_16x16x32_bf16 v[180:183], v[136:139], v[164:167], v[180:183]
ds_read_b128 v[160:163], v9 offset:3168
v_mfma_f32_16x16x32_bf16 v[184:187], v[140:143], v[164:167], v[184:187]
buffer_load_dwordx4 a[224:227], v248, s[24:27], s97 offen offset:1024
v_mfma_f32_16x16x32_bf16 v[188:191], v[144:147], v[164:167], v[188:191]
s_waitcnt lgkmcnt(4)
v_mfma_f32_16x16x32_bf16 v[176:179], v[136:139], v[168:171], v[176:179]
ds_read_b128 v[136:139], v8 offset:3200
v_mfma_f32_16x16x32_bf16 v[180:183], v[140:143], v[168:171], v[180:183]
ds_read_b128 v[164:167], v9 offset:3232
v_mfma_f32_16x16x32_bf16 v[184:187], v[144:147], v[168:171], v[184:187]
buffer_load_dwordx4 a[228:231], v248, s[24:27], s97 offen offset:2048
v_mfma_f32_16x16x32_bf16 v[188:191], v[148:151], v[168:171], v[188:191]
s_waitcnt lgkmcnt(4)
v_mfma_f32_16x16x32_bf16 v[176:179], v[140:143], v[172:175], v[176:179]
ds_read_b128 v[140:143], v8 offset:3264
v_mfma_f32_16x16x32_bf16 v[180:183], v[144:147], v[172:175], v[180:183]
ds_read_b128 v[168:171], v9 offset:3296
v_mfma_f32_16x16x32_bf16 v[184:187], v[148:151], v[172:175], v[184:187]
buffer_load_dwordx4 a[232:235], v248, s[24:27], s97 offen offset:3072
v_mfma_f32_16x16x32_bf16 v[188:191], v[152:155], v[172:175], v[188:191]
buffer_load_dword v254, v249, s[24:27], 0 offen sc1
s_waitcnt lgkmcnt(4)
v_mfma_f32_16x16x32_bf16 v[176:179], v[144:147], v[160:163], v[176:179]
ds_read_b128 v[144:147], v8 offset:3328
v_mfma_f32_16x16x32_bf16 v[180:183], v[148:151], v[160:163], v[180:183]
ds_read_b128 v[172:175], v9 offset:3360
v_mfma_f32_16x16x32_bf16 v[184:187], v[152:155], v[160:163], v[184:187]
buffer_load_dwordx4 a[236:239], v248, s[24:27], s98 offen
v_mfma_f32_16x16x32_bf16 v[188:191], v[156:159], v[160:163], v[188:191]
s_add_u32 s97, s97, 5120
s_cmp_eq_u32 s97, s80
s_cselect_b32 s97, s79, s97
s_add_u32 s98, s97, 4096
s_waitcnt lgkmcnt(4)
v_mfma_f32_16x16x32_bf16 v[176:179], v[148:151], v[164:167], v[176:179]
ds_read_b128 v[148:151], v8 offset:3392
v_mfma_f32_16x16x32_bf16 v[180:183], v[152:155], v[164:167], v[180:183]
ds_read_b128 v[160:163], v9 offset:3456
v_mfma_f32_16x16x32_bf16 v[184:187], v[156:159], v[164:167], v[184:187]
buffer_load_dwordx4 v[208:211], v248, s[24:27], s97 offen offset:0
v_mfma_f32_16x16x32_bf16 v[188:191], v[128:131], v[164:167], v[188:191]
s_waitcnt lgkmcnt(4)
v_mfma_f32_16x16x32_bf16 v[176:179], v[152:155], v[168:171], v[176:179]
ds_read_b128 v[152:155], v8 offset:3456
v_mfma_f32_16x16x32_bf16 v[180:183], v[156:159], v[168:171], v[180:183]
ds_read_b128 v[164:167], v9 offset:3520
v_mfma_f32_16x16x32_bf16 v[184:187], v[128:131], v[168:171], v[184:187]
buffer_load_dwordx4 v[212:215], v248, s[24:27], s97 offen offset:1024
v_mfma_f32_16x16x32_bf16 v[188:191], v[132:135], v[168:171], v[188:191]
buffer_load_dwordx4 v[216:219], v248, s[24:27], s97 offen offset:2048
s_waitcnt lgkmcnt(4)
v_mfma_f32_16x16x32_bf16 v[176:179], v[156:159], v[172:175], v[176:179]
ds_read_b128 v[156:159], v8 offset:3520
v_mfma_f32_16x16x32_bf16 v[180:183], v[128:131], v[172:175], v[180:183]
ds_read_b128 v[168:171], v9 offset:3584
v_mfma_f32_16x16x32_bf16 v[184:187], v[132:135], v[172:175], v[184:187]
buffer_load_dwordx4 v[220:223], v248, s[24:27], s97 offen offset:3072
v_mfma_f32_16x16x32_bf16 v[188:191], v[136:139], v[172:175], v[188:191]
s_waitcnt lgkmcnt(4)
v_mfma_f32_16x16x32_bf16 v[176:179], v[128:131], v[160:163], v[176:179]
ds_read_b128 v[128:131], v8 offset:3584
v_mfma_f32_16x16x32_bf16 v[180:183], v[132:135], v[160:163], v[180:183]
ds_read_b128 v[172:175], v9 offset:3648
v_mfma_f32_16x16x32_bf16 v[184:187], v[136:139], v[160:163], v[184:187]
buffer_load_dwordx4 v[224:227], v248, s[24:27], s98 offen
v_mfma_f32_16x16x32_bf16 v[188:191], v[140:143], v[160:163], v[188:191]
s_add_u32 s97, s97, 5120
s_cmp_eq_u32 s97, s80
s_cselect_b32 s97, s79, s97
s_add_u32 s98, s97, 4096
s_waitcnt lgkmcnt(4)
v_mfma_f32_16x16x32_bf16 v[176:179], v[132:135], v[164:167], v[176:179]
ds_read_b128 v[132:135], v8 offset:3648
v_mfma_f32_16x16x32_bf16 v[180:183], v[136:139], v[164:167], v[180:183]
ds_read_b128 v[160:163], v9 offset:3744
v_mfma_f32_16x16x32_bf16 v[184:187], v[140:143], v[164:167], v[184:187]
buffer_load_dwordx4 v[228:231], v248, s[24:27], s97 offen offset:0
v_mfma_f32_16x16x32_bf16 v[188:191], v[144:147], v[164:167], v[188:191]
s_waitcnt lgkmcnt(4)
v_mfma_f32_16x16x32_bf16 v[176:179], v[136:139], v[168:171], v[176:179]
ds_read_b128 v[136:139], v8 offset:3712
v_mfma_f32_16x16x32_bf16 v[180:183], v[140:143], v[168:171], v[180:183]
ds_read_b128 v[164:167], v9 offset:3808
v_mfma_f32_16x16x32_bf16 v[184:187], v[144:147], v[168:171], v[184:187]
buffer_load_dwordx4 v[232:235], v248, s[24:27], s97 offen offset:1024
v_mfma_f32_16x16x32_bf16 v[188:191], v[148:151], v[168:171], v[188:191]
s_waitcnt lgkmcnt(4)
v_mfma_f32_16x16x32_bf16 v[176:179], v[140:143], v[172:175], v[176:179]
ds_read_b128 v[140:143], v8 offset:3776
v_mfma_f32_16x16x32_bf16 v[180:183], v[144:147], v[172:175], v[180:183]
ds_read_b128 v[168:171], v9 offset:3872
v_mfma_f32_16x16x32_bf16 v[184:187], v[148:151], v[172:175], v[184:187]
buffer_load_dwordx4 v[236:239], v248, s[24:27], s97 offen offset:2048
v_mfma_f32_16x16x32_bf16 v[188:191], v[152:155], v[172:175], v[188:191]
s_waitcnt lgkmcnt(4)
v_mfma_f32_16x16x32_bf16 v[176:179], v[144:147], v[160:163], v[176:179]
ds_read_b128 v[144:147], v8 offset:3840
v_mfma_f32_16x16x32_bf16 v[180:183], v[148:151], v[160:163], v[180:183]
ds_read_b128 v[172:175], v9 offset:3936
v_mfma_f32_16x16x32_bf16 v[184:187], v[152:155], v[160:163], v[184:187]
buffer_load_dwordx4 v[240:243], v248, s[24:27], s97 offen offset:3072
v_mfma_f32_16x16x32_bf16 v[188:191], v[156:159], v[160:163], v[188:191]
s_waitcnt lgkmcnt(4)
v_mfma_f32_16x16x32_bf16 v[176:179], v[148:151], v[164:167], v[176:179]
ds_read_b128 v[148:151], v8 offset:3904
v_mfma_f32_16x16x32_bf16 v[180:183], v[152:155], v[164:167], v[180:183]
ds_read_b128 v[160:163], v9 offset:4032
v_mfma_f32_16x16x32_bf16 v[184:187], v[156:159], v[164:167], v[184:187]
buffer_load_dwordx4 v[244:247], v248, s[24:27], s98 offen
v_mfma_f32_16x16x32_bf16 v[188:191], v[128:131], v[164:167], v[188:191]
s_add_u32 s97, s97, 5120
s_cmp_eq_u32 s97, s80
s_cselect_b32 s97, s79, s97
s_add_u32 s98, s97, 4096
s_waitcnt vmcnt(11)
v_cmp_eq_u32 vcc, 0, v254
s_cbranch_vccnz L_slow_37
L_back_38:
s_mul_i32 s6, s94, 54
s_add_u32 s6, s6, s96
s_lshl_b32 s81, s6, 12
s_add_u32 s81, s81, 10485760
s_cmp_ge_u32 s5, 2
s_cselect_b32 s7, 13, 14
s_lshl_b32 s7, s7, 12
s_add_u32 s82, s81, s7
s_lshl_b32 s7, s93, 12
s_add_u32 s99, s81, s7
s_add_u32 s6, s5, 0
s_and_b32 s6, s6, 3
s_lshl_b32 s6, s6, 10
v_add_u32 v56, s6, v248
s_add_u32 s6, s5, 1
s_and_b32 s6, s6, 3
s_lshl_b32 s6, s6, 10
v_add_u32 v57, s6, v248
s_add_u32 s6, s5, 2
s_and_b32 s6, s6, 3
s_lshl_b32 s6, s6, 10
v_add_u32 v58, s6, v248
s_add_u32 s6, s5, 3
s_and_b32 s6, s6, 3
s_lshl_b32 s6, s6, 10
v_add_u32 v59, s6, v248
s_waitcnt lgkmcnt(4)
v_mfma_f32_16x16x32_bf16 v[176:179], v[152:155], v[168:171], v[176:179]
ds_read_b128 v[152:155], v8 offset:3968
v_mfma_f32_16x16x32_bf16 v[180:183], v[156:159], v[168:171], v[180:183]
ds_read_b128 v[164:167], v9 offset:4096
v_mfma_f32_16x16x32_bf16 v[184:187], v[128:131], v[168:171], v[184:187]
v_mfma_f32_16x16x32_bf16 v[188:191], v[132:135], v[168:171], v[188:191]
s_waitcnt lgkmcnt(4)
v_mfma_f32_16x16x32_bf16 v[176:179], v[156:159], v[172:175], v[176:179]
ds_read_b128 v[156:159], v8 offset:4032
v_mfma_f32_16x16x32_bf16 v[180:183], v[128:131], v[172:175], v[180:183]
ds_read_b128 v[168:171], v9 offset:4160
v_mfma_f32_16x16x32_bf16 v[184:187], v[132:135], v[172:175], v[184:187]
buffer_load_dwordx4 v[64:67], v57, s[24:27], s99 offen
s_add_u32 s99, s99, 4096
v_mfma_f32_16x16x32_bf16 v[188:191], v[136:139], v[172:175], v[188:191]
buffer_load_dwordx4 v[68:71], v57, s[24:27], s99 offen
s_add_u32 s99, s99, 4096
s_waitcnt lgkmcnt(4)
v_mfma_f32_16x16x32_bf16 v[176:179], v[128:131], v[160:163], v[176:179]
ds_read_b128 v[128:131], v8 offset:4096
v_mfma_f32_16x16x32_bf16 v[180:183], v[132:135], v[160:163], v[180:183]
ds_read_b128 v[172:175], v9 offset:4224
v_mfma_f32_16x16x32_bf16 v[184:187], v[136:139], v[160:163], v[184:187]
buffer_load_dwordx4 v[72:75], v57, s[24:27], s99 offen
s_add_u32 s99, s99, 4096
v_mfma_f32_16x16x32_bf16 v[188:191], v[140:143], v[160:163], v[188:191]
s_waitcnt lgkmcnt(4)
v_mfma_f32_16x16x32_bf16 v[176:179], v[132:135], v[164:167], v[176:179]
ds_read_b128 v[132:135], v8 offset:4160
v_mfma_f32_16x16x32_bf16 v[180:183], v[136:139], v[164:167], v[180:183]
ds_read_b128 v[160:163], v9 offset:4320
v_mfma_f32_16x16x32_bf16 v[184:187], v[140:143], v[164:167], v[184:187]
buffer_load_dwordx4 v[76:79], v57, s[24:27], s99 offen
s_add_u32 s99, s99, 4096
v_mfma_f32_16x16x32_bf16 v[188:191], v[144:147], v[164:167], v[188:191]
s_waitcnt lgkmcnt(4)
v_mfma_f32_16x16x32_bf16 v[176:179], v[136:139], v[168:171], v[176:179]
ds_read_b128 v[136:139], v8 offset:4224
v_mfma_f32_16x16x32_bf16 v[180:183], v[140:143], v[168:171], v[180:183]
ds_read_b128 v[164:167], v9 offset:4384
v_mfma_f32_16x16x32_bf16 v[184:187], v[144:147], v[168:171], v[184:187]
buffer_load_dwordx4 v[80:83], v57, s[24:27], s99 offen
s_add_u32 s99, s99, 4096
v_mfma_f32_16x16x32_bf16 v[188:191], v[148:151], v[168:171], v[188:191]
buffer_load_dwordx4 v[84:87], v57, s[24:27], s99 offen
s_add_u32 s99, s99, 4096
s_waitcnt lgkmcnt(4)
v_mfma_f32_16x16x32_bf16 v[176:179], v[140:143], v[172:175], v[176:179]
v_mfma_f32_16x16x32_bf16 v[180:183], v[144:147], v[172:175], v[180:183]
ds_read_b128 v[168:171], v9 offset:4448
v_mfma_f32_16x16x32_bf16 v[184:187], v[148:151], v[172:175], v[184:187]
buffer_load_dwordx4 v[88:91], v57, s[24:27], s99 offen
s_add_u32 s99, s99, 4096
v_mfma_f32_16x16x32_bf16 v[188:191], v[152:155], v[172:175], v[188:191]
s_waitcnt lgkmcnt(3)
v_mfma_f32_16x16x32_bf16 v[176:179], v[144:147], v[160:163], v[176:179]
v_mfma_f32_16x16x32_bf16 v[180:183], v[148:151], v[160:163], v[180:183]
ds_read_b128 v[172:175], v9 offset:4512
v_mfma_f32_16x16x32_bf16 v[184:187], v[152:155], v[160:163], v[184:187]
buffer_load_dwordx4 v[92:95], v57, s[24:27], s99 offen
s_add_u32 s99, s99, 4096
v_mfma_f32_16x16x32_bf16 v[188:191], v[156:159], v[160:163], v[188:191]
s_waitcnt lgkmcnt(2)
v_mfma_f32_16x16x32_bf16 v[176:179], v[148:151], v[164:167], v[176:179]
v_mfma_f32_16x16x32_bf16 v[180:183], v[152:155], v[164:167], v[180:183]
v_mfma_f32_16x16x32_bf16 v[184:187], v[156:159], v[164:167], v[184:187]
buffer_load_dwordx4 v[96:99], v57, s[24:27], s99 offen
s_add_u32 s99, s99, 4096
v_mfma_f32_16x16x32_bf16 v[188:191], v[128:131], v[164:167], v[188:191]
buffer_load_dwordx4 v[100:103], v57, s[24:27], s99 offen
s_add_u32 s99, s99, 4096
s_waitcnt lgkmcnt(1)
v_mfma_f32_16x16x32_bf16 v[176:179], v[152:155], v[168:171], v[176:179]
v_mfma_f32_16x16x32_bf16 v[180:183], v[156:159], v[168:171], v[180:183]
v_mfma_f32_16x16x32_bf16 v[184:187], v[128:131], v[168:171], v[184:187]
buffer_load_dwordx4 v[104:107], v57, s[24:27], s99 offen
s_add_u32 s99, s99, 4096
v_mfma_f32_16x16x32_bf16 v[188:191], v[132:135], v[168:171], v[188:191]
s_waitcnt lgkmcnt(0)
v_mfma_f32_16x16x32_bf16 v[176:179], v[156:159], v[172:175], v[176:179]
v_mfma_f32_16x16x32_bf16 v[180:183], v[128:131], v[172:175], v[180:183]
v_mfma_f32_16x16x32_bf16 v[184:187], v[132:135], v[172:175], v[184:187]
buffer_load_dwordx4 v[108:111], v57, s[24:27], s99 offen
s_add_u32 s99, s99, 4096
v_mfma_f32_16x16x32_bf16 v[188:191], v[136:139], v[172:175], v[188:191]
s_nop 3
v_cvt_pk_bf16_f32 v20, v176, v177
v_cvt_pk_bf16_f32 v21, v178, v179
v_cvt_pk_bf16_f32 v22, v180, v181
v_cvt_pk_bf16_f32 v23, v182, v183
buffer_store_dwordx4 v[20:23], v11, s[24:27], s92 offen offset:0 sc1
v_cvt_pk_bf16_f32 v24, v184, v185
v_cvt_pk_bf16_f32 v25, v186, v187
v_cvt_pk_bf16_f32 v26, v188, v189
v_cvt_pk_bf16_f32 v27, v190, v191
buffer_store_dwordx4 v[24:27], v11, s[24:27], s92 offen offset:128 sc1
L_gemm2:
s_waitcnt vmcnt(13)
v_mfma_f32_16x16x32_bf16 v[148:151], a[0:3], v[64:67], 0
buffer_load_dwordx4 v[112:115], v57, s[24:27], s99 offen
v_mfma_f32_16x16x32_bf16 v[152:155], a[4:7], v[64:67], 0
s_add_u32 s99, s99, 4096
v_and_b32 v50, 15, v1
v_mfma_f32_16x16x32_bf16 v[156:159], a[8:11], v[64:67], 0
v_lshrrev_b32 v51, 3, v50
v_lshlrev_b32 v51, 3, v51
v_mfma_f32_16x16x32_bf16 v[160:163], a[12:15], v[64:67], 0
v_and_b32 v52, 3, v50
v_mfma_f32_16x16x32_bf16 v[164:167], a[16:19], v[64:67], 0
v_lshl_or_b32 v51, v52, 1, v51
v_bfe_u32 v52, v50, 2, 1
s_waitcnt vmcnt(13)
v_mfma_f32_16x16x32_bf16 v[148:151], a[20:23], v[68:71], v[148:151]
buffer_load_dwordx4 v[116:119], v57, s[24:27], s99 offen
v_mfma_f32_16x16x32_bf16 v[152:155], a[24:27], v[68:71], v[152:155]
s_mov_b32 s99, s81
v_mfma_f32_16x16x32_bf16 v[156:159], a[28:31], v[68:71], v[156:159]
v_or_b32 v51, v51, v52
v_mul_u32_u24 v51, 176, v51
v_mfma_f32_16x16x32_bf16 v[160:163], a[32:35], v[68:71], v[160:163]
v_lshrrev_b32 v53, 4, v1
v_mfma_f32_16x16x32_bf16 v[164:167], a[36:39], v[68:71], v[164:167]
v_mul_u32_u24 v52, 40, v53
s_mul_i32 s86, s5, 2816
s_waitcnt vmcnt(13)
v_mfma_f32_16x16x32_bf16 v[148:151], a[40:43], v[72:75], v[148:151]
buffer_load_dwordx4 v[120:123], v58, s[24:27], s99 offen
v_mfma_f32_16x16x32_bf16 v[152:155], a[44:47], v[72:75], v[152:155]
s_add_u32 s99, s99, 4096
s_add_u32 s86, s86, 73728
v_mfma_f32_16x16x32_bf16 v[156:159], a[48:51], v[72:75], v[156:159]
v_add_u32 v51, v51, v52
v_mfma_f32_16x16x32_bf16 v[160:163], a[52:55], v[72:75], v[160:163]
s_and_b32 s87, s95, 1
v_mfma_f32_16x16x32_bf16 v[164:167], a[56:59], v[72:75], v[164:167]
s_lshl_b32 s87, s87, 1
v_subrev_u32 v52, s87, v50
s_waitcnt vmcnt(13)
v_mfma_f32_16x16x32_bf16 v[148:151], a[60:63], v[76:79], v[148:151]
buffer_load_dwordx4 v[124:127], v58, s[24:27], s99 offen
v_mfma_f32_16x16x32_bf16 v[152:155], a[64:67], v[76:79], v[152:155]
s_add_u32 s99, s99, 4096
v_lshlrev_b32 v52, 4, v52
v_mfma_f32_16x16x32_bf16 v[156:159], a[68:71], v[76:79], v[156:159]
v_add_u32 v50, s86, v51
v_mfma_f32_16x16x32_bf16 v[160:163], a[72:75], v[76:79], v[160:163]
v_mul_u32_u24 v51, 176, v53
v_add_u32 v51, v51, v52
v_mfma_f32_16x16x32_bf16 v[164:167], a[76:79], v[76:79], v[164:167]
v_add_u32 v51, s86, v51
s_waitcnt vmcnt(13)
v_mfma_f32_16x16x32_bf16 v[148:151], a[80:83], v[80:83], v[148:151]
buffer_load_dwordx4 v[64:67], v58, s[24:27], s99 offen
v_mfma_f32_16x16x32_bf16 v[152:155], a[84:87], v[80:83], v[152:155]
s_add_u32 s99, s99, 4096
s_lshl_b32 s86, s94, 6
v_mfma_f32_16x16x32_bf16 v[156:159], a[88:91], v[80:83], v[156:159]
s_lshl_b32 s85, s5, 4
v_mfma_f32_16x16x32_bf16 v[160:163], a[92:95], v[80:83], v[160:163]
s_add_u32 s86, s86, s85
v_add_u32 v53, s86, v53
v_mfma_f32_16x16x32_bf16 v[164:167], a[96:99], v[80:83], v[164:167]
v_mul_u32_u24 v53, 1280, v53
s_waitcnt vmcnt(13)
v_mfma_f32_16x16x32_bf16 v[148:151], a[100:103], v[84:87], v[148:151]
buffer_load_dwordx4 v[68:71], v58, s[24:27], s99 offen
v_mfma_f32_16x16x32_bf16 v[152:155], a[104:107], v[84:87], v[152:155]
s_add_u32 s99, s99, 4096
s_mul_i32 s86, s95, 160
v_mfma_f32_16x16x32_bf16 v[156:159], a[108:111], v[84:87], v[156:159]
v_add_u32 v52, s86, v52
v_mfma_f32_16x16x32_bf16 v[160:163], a[112:115], v[84:87], v[160:163]
v_add_u32 v52, v52, v53
v_add_u32 v53, 5120, v52
v_mfma_f32_16x16x32_bf16 v[164:167], a[116:119], v[84:87], v[164:167]
v_add_u32 v54, 10240, v52
s_waitcnt vmcnt(13)
v_mfma_f32_16x16x32_bf16 v[148:151], a[120:123], v[88:91], v[148:151]
buffer_load_dwordx4 v[72:75], v58, s[24:27], s99 offen
v_mfma_f32_16x16x32_bf16 v[152:155], a[124:127], v[88:91], v[152:155]
s_add_u32 s99, s99, 4096
v_add_u32 v55, 15360, v52
v_mfma_f32_16x16x32_bf16 v[156:159], a[128:131], v[88:91], v[156:159]
s_lshl_b32 s86, 0x03ff03ff, s87
s_mov_b32 s87, s86
v_mfma_f32_16x16x32_bf16 v[160:163], a[132:135], v[88:91], v[160:163]
s_mul_i32 s83, s5, 15360
v_mfma_f32_16x16x32_bf16 v[164:167], a[136:139], v[88:91], v[164:167]
s_add_u32 s83, s83, 10240
s_waitcnt vmcnt(13)
v_mfma_f32_16x16x32_bf16 v[148:151], a[140:143], v[92:95], v[148:151]
buffer_load_dwordx4 v[76:79], v58, s[24:27], s99 offen
v_mfma_f32_16x16x32_bf16 v[152:155], a[144:147], v[92:95], v[152:155]
s_add_u32 s99, s99, 4096
v_and_b32 v2, 15, v1
v_mfma_f32_16x16x32_bf16 v[156:159], a[148:151], v[92:95], v[156:159]
v_lshrrev_b32 v4, 3, v2
v_lshlrev_b32 v4, 3, v4
v_mfma_f32_16x16x32_bf16 v[160:163], a[152:155], v[92:95], v[160:163]
s_add_u32 m0, s83, 0
s_mov_b64 exec, s[86:87]
buffer_load_dwordx4 v52, s[8:11], 0 offen lds
s_mov_b64 exec, -1
v_mfma_f32_16x16x32_bf16 v[164:167], a[156:159], v[92:95], v[164:167]
v_and_b32 v5, 3, v2
v_lshl_or_b32 v4, v5, 1, v4
s_waitcnt vmcnt(14)
v_mfma_f32_16x16x32_bf16 v[148:151], a[160:163], v[96:99], v[148:151]
buffer_load_dwordx4 v[80:83], v58, s[24:27], s99 offen
v_mfma_f32_16x16x32_bf16 v[152:155], a[164:167], v[96:99], v[152:155]
s_add_u32 s99, s99, 4096
v_bfe_u32 v5, v2, 2, 1
v_mfma_f32_16x16x32_bf16 v[156:159], a[168:171], v[96:99], v[156:159]
v_or_b32 v4, v4, v5
s_lshl_b32 s6, s94, 6
v_mfma_f32_16x16x32_bf16 v[160:163], a[172:175], v[96:99], v[160:163]
s_add_u32 m0, s83, 1088
s_mov_b64 exec, s[86:87]
buffer_load_dwordx4 v53, s[8:11], 0 offen lds
s_mov_b64 exec, -1
v_mfma_f32_16x16x32_bf16 v[164:167], a[176:179], v[96:99], v[164:167]
s_lshl_b32 s7, s5, 4
s_add_u32 s6, s6, s7
s_waitcnt vmcnt(15)
v_mfma_f32_16x16x32_bf16 v[148:151], a[180:183], v[100:103], v[148:151]
buffer_load_dwordx4 v[84:87], v58, s[24:27], s99 offen
v_mfma_f32_16x16x32_bf16 v[152:155], a[184:187], v[100:103], v[152:155]
s_add_u32 s99, s99, 4096
v_add_u32 v5, s6, v4
v_mfma_f32_16x16x32_bf16 v[156:159], a[188:191], v[100:103], v[156:159]
v_lshlrev_b32 v5, 4, v5
v_lshrrev_b32 v3, 2, v4
v_mfma_f32_16x16x32_bf16 v[160:163], a[192:195], v[100:103], v[160:163]
s_add_u32 m0, s83, 2176
s_mov_b64 exec, s[86:87]
buffer_load_dwordx4 v54, s[8:11], 0 offen lds
s_mov_b64 exec, -1
v_mfma_f32_16x16x32_bf16 v[164:167], a[196:199], v[100:103], v[164:167]
v_mul_u32_u24 v3, 1088, v3
v_and_b32 v4, 3, v4
s_waitcnt vmcnt(16)
v_mfma_f32_16x16x32_bf16 v[148:151], a[200:203], v[104:107], v[148:151]
buffer_load_dwordx4 v[88:91], v58, s[24:27], s99 offen
v_mfma_f32_16x16x32_bf16 v[152:155], a[204:207], v[104:107], v[152:155]
s_add_u32 s99, s99, 4096
v_lshl_add_u32 v3, v4, 8, v3
v_mfma_f32_16x16x32_bf16 v[156:159], a[208:211], v[104:107], v[156:159]
v_lshrrev_b32 v4, 4, v1
v_mul_u32_u24 v4, 40, v4
v_mfma_f32_16x16x32_bf16 v[160:163], a[212:215], v[104:107], v[160:163]
s_add_u32 m0, s83, 3264
s_mov_b64 exec, s[86:87]
buffer_load_dwordx4 v55, s[8:11], 0 offen lds
s_mov_b64 exec, -1
v_mfma_f32_16x16x32_bf16 v[164:167], a[216:219], v[104:107], v[164:167]
v_add_u32 v3, v3, v4
s_and_b32 s6, s95, 1
s_lshl_b32 s6, s6, 5
s_add_u32 s6, s6, s83
v_add_u32 v7, s6, v3
s_waitcnt vmcnt(17)
v_mfma_f32_16x16x32_bf16 v[148:151], a[220:223], v[108:111], v[148:151]
buffer_load_dwordx4 v[92:95], v58, s[24:27], s99 offen
v_mfma_f32_16x16x32_bf16 v[152:155], a[224:227], v[108:111], v[152:155]
s_add_u32 s99, s99, 4096
v_mfma_f32_16x16x32_bf16 v[156:159], a[228:231], v[108:111], v[156:159]
v_mfma_f32_16x16x32_bf16 v[160:163], a[232:235], v[108:111], v[160:163]
s_mov_b32 s7, 98304
buffer_load_dwordx2 v[18:19], v5, s[24:27], s7 offen
v_mfma_f32_16x16x32_bf16 v[164:167], a[236:239], v[108:111], v[164:167]
s_waitcnt vmcnt(17)
v_mov_b32 v61, 61440
s_mov_b64 exec, 1
ds_add_rtn_u32 v61, v61, v253
s_mov_b64 exec, -1
s_waitcnt vmcnt(16)
v_mfma_f32_16x16x32_bf16 v[148:151], v[208:211], v[112:115], v[148:151]
buffer_load_dwordx4 v[96:99], v58, s[24:27], s99 offen
v_mfma_f32_16x16x32_bf16 v[152:155], v[212:215], v[112:115], v[152:155]
s_add_u32 s99, s99, 4096
v_accvgpr_read_b32 v2, a240
v_mfma_f32_16x16x32_bf16 v[156:159], v[216:219], v[112:115], v[156:159]
v_lshlrev_b32 v128, 16, v2
v_mfma_f32_16x16x32_bf16 v[160:163], v[220:223], v[112:115], v[160:163]
v_and_b32 v129, 0xffff0000, v2
v_accvgpr_read_b32 v3, a241
v_mfma_f32_16x16x32_bf16 v[164:167], v[224:227], v[112:115], v[164:167]
v_lshlrev_b32 v130, 16, v3
s_cmp_ge_u32 s5, 2
s_cbranch_scc1 L_umskip_39
s_waitcnt vmcnt(16)
v_mfma_f32_16x16x32_bf16 v[148:151], v[228:231], v[116:119], v[148:151]
v_mfma_f32_16x16x32_bf16 v[152:155], v[232:235], v[116:119], v[152:155]
v_mfma_f32_16x16x32_bf16 v[156:159], v[236:239], v[116:119], v[156:159]
v_mfma_f32_16x16x32_bf16 v[160:163], v[240:243], v[116:119], v[160:163]
v_mfma_f32_16x16x32_bf16 v[164:167], v[244:247], v[116:119], v[164:167]
L_umskip_39:
s_waitcnt lgkmcnt(0)
v_readfirstlane_b32 s6, v61
s_cmp_lg_u32 s6, 3
s_cbranch_scc1 L_yfl_40
s_mov_b64 exec, 1
buffer_store_dword v253, v252, s[24:27], 0 offen offset:20 sc1
s_mov_b64 exec, -1
L_yfl_40:
s_waitcnt vmcnt(15)
v_mfma_f32_16x16x32_bf16 v[168:171], a[0:3], v[120:123], 0
buffer_load_dwordx4 v[100:103], v58, s[24:27], s99 offen
v_mfma_f32_16x16x32_bf16 v[172:175], a[4:7], v[120:123], 0
s_add_u32 s99, s99, 4096
s_add_u32 s84, s5, 1
s_and_b32 s84, s84, 3
s_mul_i32 s84, s84, 15360
v_mfma_f32_16x16x32_bf16 v[176:179], a[8:11], v[120:123], 0
buffer_load_dwordx4 v[104:107], v58, s[24:27], s99 offen
s_add_u32 s84, s84, 0
v_lshl_add_u32 v60, v1, 4, s84
v_mfma_f32_16x16x32_bf16 v[180:183], a[12:15], v[120:123], 0
s_add_u32 s99, s99, 4096
v_mfma_f32_16x16x32_bf16 v[184:187], a[16:19], v[120:123], 0
v_and_b32 v131, 0xffff0000, v3
v_accvgpr_read_b32 v4, a242
s_waitcnt vmcnt(16)
v_mfma_f32_16x16x32_bf16 v[168:171], a[20:23], v[124:127], v[168:171]
buffer_load_dwordx4 v[108:111], v58, s[24:27], s99 offen
v_mfma_f32_16x16x32_bf16 v[172:175], a[24:27], v[124:127], v[172:175]
s_mov_b32 s99, s81
v_mfma_f32_16x16x32_bf16 v[176:179], a[28:31], v[124:127], v[176:179]
ds_write_b128 v60, v[148:151] offset:0
v_mfma_f32_16x16x32_bf16 v[180:183], a[32:35], v[124:127], v[180:183]
v_lshlrev_b32 v132, 16, v4
v_mfma_f32_16x16x32_bf16 v[184:187], a[36:39], v[124:127], v[184:187]
v_and_b32 v133, 0xffff0000, v4
v_accvgpr_read_b32 v5, a243
s_waitcnt vmcnt(16)
v_mfma_f32_16x16x32_bf16 v[168:171], a[40:43], v[64:67], v[168:171]
buffer_load_dwordx4 v[112:115], v59, s[24:27], s99 offen
v_mfma_f32_16x16x32_bf16 v[172:175], a[44:47], v[64:67], v[172:175]
s_add_u32 s99, s99, 4096
v_mfma_f32_16x16x32_bf16 v[176:179], a[48:51], v[64:67], v[176:179]
ds_write_b128 v60, v[152:155] offset:1024
v_mfma_f32_16x16x32_bf16 v[180:183], a[52:55], v[64:67], v[180:183]
v_lshlrev_b32 v134, 16, v5
v_and_b32 v135, 0xffff0000, v5
v_mfma_f32_16x16x32_bf16 v[184:187], a[56:59], v[64:67], v[184:187]
v_accvgpr_read_b32 v2, a244
s_waitcnt vmcnt(16)
v_mfma_f32_16x16x32_bf16 v[168:171], a[60:63], v[68:71], v[168:171]
buffer_load_dwordx4 v[116:119], v59, s[24:27], s99 offen
v_mfma_f32_16x16x32_bf16 v[172:175], a[64:67], v[68:71], v[172:175]
s_add_u32 s99, s99, 4096
v_mfma_f32_16x16x32_bf16 v[176:179], a[68:71], v[68:71], v[176:179]
v_lshlrev_b32 v136, 16, v2
v_and_b32 v137, 0xffff0000, v2
v_mfma_f32_16x16x32_bf16 v[180:183], a[72:75], v[68:71], v[180:183]
v_accvgpr_read_b32 v3, a245
v_mfma_f32_16x16x32_bf16 v[184:187], a[76:79], v[68:71], v[184:187]
ds_write_b128 v60, v[156:159] offset:2048
s_waitcnt vmcnt(16)
v_mfma_f32_16x16x32_bf16 v[168:171], a[80:83], v[72:75], v[168:171]
buffer_load_dwordx4 v[120:123], v59, s[24:27], s99 offen
v_mfma_f32_16x16x32_bf16 v[172:175], a[84:87], v[72:75], v[172:175]
s_add_u32 s99, s99, 4096
v_mfma_f32_16x16x32_bf16 v[176:179], a[88:91], v[72:75], v[176:179]
v_lshlrev_b32 v138, 16, v3
v_and_b32 v139, 0xffff0000, v3
v_mfma_f32_16x16x32_bf16 v[180:183], a[92:95], v[72:75], v[180:183]
v_accvgpr_read_b32 v4, a246
v_mfma_f32_16x16x32_bf16 v[184:187], a[96:99], v[72:75], v[184:187]
v_lshlrev_b32 v140, 16, v4
s_waitcnt vmcnt(16)
v_mfma_f32_16x16x32_bf16 v[168:171], a[100:103], v[76:79], v[168:171]
buffer_load_dwordx4 v[124:127], v59, s[24:27], s99 offen
v_mfma_f32_16x16x32_bf16 v[172:175], a[104:107], v[76:79], v[172:175]
s_add_u32 s99, s99, 4096
v_and_b32 v141, 0xffff0000, v4
v_mfma_f32_16x16x32_bf16 v[176:179], a[108:111], v[76:79], v[176:179]
ds_write_b128 v60, v[160:163] offset:3072
v_mfma_f32_16x16x32_bf16 v[180:183], a[112:115], v[76:79], v[180:183]
v_accvgpr_read_b32 v5, a247
v_mfma_f32_16x16x32_bf16 v[184:187], a[116:119], v[76:79], v[184:187]
v_lshlrev_b32 v142, 16, v5
s_waitcnt vmcnt(15)
v_mfma_f32_16x16x32_bf16 v[168:171], a[120:123], v[80:83], v[168:171]
buffer_load_dwordx4 v[64:67], v59, s[24:27], s99 offen
v_mfma_f32_16x16x32_bf16 v[172:175], a[124:127], v[80:83], v[172:175]
s_add_u32 s99, s99, 4096
v_and_b32 v143, 0xffff0000, v5
v_mfma_f32_16x16x32_bf16 v[176:179], a[128:131], v[80:83], v[176:179]
v_accvgpr_read_b32 v2, a248
v_mfma_f32_16x16x32_bf16 v[180:183], a[132:135], v[80:83], v[180:183]
ds_write_b128 v60, v[164:167] offset:4096
v_mfma_f32_16x16x32_bf16 v[184:187], a[136:139], v[80:83], v[184:187]
v_lshlrev_b32 v144, 16, v2
s_waitcnt vmcnt(14)
v_mfma_f32_16x16x32_bf16 v[168:171], a[140:143], v[84:87], v[168:171]
buffer_load_dwordx4 v[68:71], v59, s[24:27], s99 offen
v_mfma_f32_16x16x32_bf16 v[172:175], a[144:147], v[84:87], v[172:175]
s_add_u32 s99, s99, 4096
v_and_b32 v145, 0xffff0000, v2
v_mfma_f32_16x16x32_bf16 v[176:179], a[148:151], v[84:87], v[176:179]
v_accvgpr_read_b32 v3, a249
v_mfma_f32_16x16x32_bf16 v[180:183], a[152:155], v[84:87], v[180:183]
v_lshlrev_b32 v146, 16, v3
v_mfma_f32_16x16x32_bf16 v[184:187], a[156:159], v[84:87], v[184:187]
v_and_b32 v147, 0xffff0000, v3
s_waitcnt vmcnt(13)
v_mfma_f32_16x16x32_bf16 v[168:171], a[160:163], v[88:91], v[168:171]
buffer_load_dwordx4 v[72:75], v59, s[24:27], s99 offen
v_mfma_f32_16x16x32_bf16 v[172:175], a[164:167], v[88:91], v[172:175]
s_add_u32 s99, s99, 4096
s_mul_i32 s82, s5, 15360
v_mfma_f32_16x16x32_bf16 v[176:179], a[168:171], v[88:91], v[176:179]
s_add_u32 s82, s82, 0
v_mfma_f32_16x16x32_bf16 v[180:183], a[172:175], v[88:91], v[180:183]
v_lshl_add_u32 v62, v1, 4, s82
v_lshrrev_b32 v2, 4, v1
v_mfma_f32_16x16x32_bf16 v[184:187], a[176:179], v[88:91], v[184:187]
v_mul_u32_u24 v2, 20, v2
s_waitcnt vmcnt(12)
v_mfma_f32_16x16x32_bf16 v[168:171], a[180:183], v[92:95], v[168:171]
buffer_load_dwordx4 v[76:79], v59, s[24:27], s99 offen
v_mfma_f32_16x16x32_bf16 v[172:175], a[184:187], v[92:95], v[172:175]
s_add_u32 s99, s99, 4096
v_bfe_u32 v3, v1, 2, 2
v_mfma_f32_16x16x32_bf16 v[176:179], a[188:191], v[92:95], v[176:179]
v_add_u32 v2, v2, v3
v_mfma_f32_16x16x32_bf16 v[180:183], a[192:195], v[92:95], v[180:183]
v_lshlrev_b32 v2, 7, v2
v_mfma_f32_16x16x32_bf16 v[184:187], a[196:199], v[92:95], v[184:187]
v_and_b32 v3, 3, v1
s_waitcnt vmcnt(11)
v_mfma_f32_16x16x32_bf16 v[168:171], a[200:203], v[96:99], v[168:171]
buffer_load_dwordx4 v[80:83], v59, s[24:27], s99 offen
v_mfma_f32_16x16x32_bf16 v[172:175], a[204:207], v[96:99], v[172:175]
s_add_u32 s99, s99, 4096
v_lshl_add_u32 v2, v3, 4, v2
v_mfma_f32_16x16x32_bf16 v[176:179], a[208:211], v[96:99], v[176:179]
s_and_b32 s82, s5, 1
v_mfma_f32_16x16x32_bf16 v[180:183], a[212:215], v[96:99], v[180:183]
s_lshl_b32 s82, s82, 6
s_lshr_b32 s83, s5, 1
v_mfma_f32_16x16x32_bf16 v[184:187], a[216:219], v[96:99], v[184:187]
s_lshl_b32 s83, s83, 3
s_waitcnt vmcnt(11)
v_mfma_f32_16x16x32_bf16 v[168:171], a[220:223], v[100:103], v[168:171]
buffer_load_dwordx4 v[84:87], v59, s[24:27], s99 offen
v_mfma_f32_16x16x32_bf16 v[172:175], a[224:227], v[100:103], v[172:175]
s_add_u32 s99, s99, 4096
ds_read_b64 v[8:9], v7 offset:0
v_mfma_f32_16x16x32_bf16 v[176:179], a[228:231], v[100:103], v[176:179]
ds_read_b64 v[10:11], v7 offset:8
ds_read_b64 v[12:13], v7 offset:16
v_mfma_f32_16x16x32_bf16 v[180:183], a[232:235], v[100:103], v[180:183]
ds_read_b64 v[14:15], v7 offset:24
v_mfma_f32_16x16x32_bf16 v[184:187], a[236:239], v[100:103], v[184:187]
ds_read_b64 v[16:17], v7 offset:32
s_add_u32 s82, s82, s83
s_waitcnt vmcnt(11)
v_mfma_f32_16x16x32_bf16 v[168:171], v[208:211], v[104:107], v[168:171]
buffer_load_dwordx4 v[88:91], v59, s[24:27], s99 offen
v_mfma_f32_16x16x32_bf16 v[172:175], v[212:215], v[104:107], v[172:175]
s_add_u32 s99, s99, 4096
s_add_u32 s82, s82, 61440
v_mfma_f32_16x16x32_bf16 v[176:179], v[216:219], v[104:107], v[176:179]
v_add_u32 v63, s82, v2
v_mfma_f32_16x16x32_bf16 v[180:183], v[220:223], v[104:107], v[180:183]
v_mov_b32 v48, -1.4426950408889634
v_mfma_f32_16x16x32_bf16 v[184:187], v[224:227], v[104:107], v[184:187]
v_mov_b32 v49, 1.0
s_cmp_ge_u32 s5, 2
s_cbranch_scc1 L_umskip_41
s_waitcnt vmcnt(11)
v_mfma_f32_16x16x32_bf16 v[168:171], v[228:231], v[108:111], v[168:171]
v_mfma_f32_16x16x32_bf16 v[172:175], v[232:235], v[108:111], v[172:175]
v_mfma_f32_16x16x32_bf16 v[176:179], v[236:239], v[108:111], v[176:179]
v_mfma_f32_16x16x32_bf16 v[180:183], v[240:243], v[108:111], v[180:183]
v_mfma_f32_16x16x32_bf16 v[184:187], v[244:247], v[108:111], v[184:187]
L_umskip_41:
s_waitcnt lgkmcnt(0)
s_waitcnt vmcnt(10)
v_mfma_f32_16x16x32_bf16 v[188:191], a[0:3], v[112:115], 0
buffer_load_dwordx4 v[92:95], v59, s[24:27], s99 offen
v_mfma_f32_16x16x32_bf16 v[192:195], a[4:7], v[112:115], 0
s_add_u32 s99, s99, 4096
s_add_u32 s84, s5, 2
s_and_b32 s84, s84, 3
s_mul_i32 s84, s84, 15360
v_mfma_f32_16x16x32_bf16 v[196:199], a[8:11], v[112:115], 0
buffer_load_dwordx4 v[96:99], v59, s[24:27], s99 offen
s_add_u32 s84, s84, 5120
v_lshl_add_u32 v60, v1, 4, s84
v_mfma_f32_16x16x32_bf16 v[200:203], a[12:15], v[112:115], 0
s_add_u32 s99, s99, 4096
v_mul_f32 v6, v18, v19
v_mfma_f32_16x16x32_bf16 v[204:207], a[16:19], v[112:115], 0
v_mov_b32 v7, v19
v_sub_f32 v6, 0, v6
s_waitcnt vmcnt(11)
v_mfma_f32_16x16x32_bf16 v[188:191], a[20:23], v[116:119], v[188:191]
buffer_load_dwordx4 v[100:103], v59, s[24:27], s99 offen
v_mfma_f32_16x16x32_bf16 v[192:195], a[24:27], v[116:119], v[192:195]
s_mov_b32 s99, s81
v_lshlrev_b32 v40, 16, v8
v_mfma_f32_16x16x32_bf16 v[196:199], a[28:31], v[116:119], v[196:199]
ds_write_b128 v60, v[168:171] offset:0
v_mfma_f32_16x16x32_bf16 v[200:203], a[32:35], v[116:119], v[200:203]
v_and_b32 v41, 0xffff0000, v8
v_mfma_f32_16x16x32_bf16 v[204:207], a[36:39], v[116:119], v[204:207]
v_lshlrev_b32 v42, 16, v9
v_and_b32 v43, 0xffff0000, v9
s_waitcnt vmcnt(11)
v_mfma_f32_16x16x32_bf16 v[188:191], a[40:43], v[120:123], v[188:191]
buffer_load_dwordx4 v[104:107], v56, s[24:27], s99 offen
v_mfma_f32_16x16x32_bf16 v[192:195], a[44:47], v[120:123], v[192:195]
s_add_u32 s99, s99, 4096
v_mfma_f32_16x16x32_bf16 v[196:199], a[48:51], v[120:123], v[196:199]
ds_write_b128 v60, v[172:175] offset:1024
v_mfma_f32_16x16x32_bf16 v[200:203], a[52:55], v[120:123], v[200:203]
v_lshlrev_b32 v44, 16, v10
v_and_b32 v45, 0xffff0000, v10
v_mfma_f32_16x16x32_bf16 v[204:207], a[56:59], v[120:123], v[204:207]
v_lshlrev_b32 v46, 16, v11
s_waitcnt vmcnt(11)
v_mfma_f32_16x16x32_bf16 v[188:191], a[60:63], v[124:127], v[188:191]
buffer_load_dwordx4 v[108:111], v56, s[24:27], s99 offen
v_mfma_f32_16x16x32_bf16 v[192:195], a[64:67], v[124:127], v[192:195]
s_add_u32 s99, s99, 4096
v_and_b32 v47, 0xffff0000, v11
v_mfma_f32_16x16x32_bf16 v[196:199], a[68:71], v[124:127], v[196:199]
v_lshlrev_b32 v28, 16, v12
v_and_b32 v29, 0xffff0000, v12
v_mfma_f32_16x16x32_bf16 v[200:203], a[72:75], v[124:127], v[200:203]
v_lshlrev_b32 v30, 16, v13
v_mfma_f32_16x16x32_bf16 v[204:207], a[76:79], v[124:127], v[204:207]
ds_write_b128 v60, v[176:179] offset:2048
s_waitcnt vmcnt(11)
v_mfma_f32_16x16x32_bf16 v[188:191], a[80:83], v[64:67], v[188:191]
buffer_load_dwordx4 v[112:115], v56, s[24:27], s99 offen
v_mfma_f32_16x16x32_bf16 v[192:195], a[84:87], v[64:67], v[192:195]
s_add_u32 s99, s99, 4096
v_and_b32 v31, 0xffff0000, v13
v_mfma_f32_16x16x32_bf16 v[196:199], a[88:91], v[64:67], v[196:199]
v_lshlrev_b32 v32, 16, v14
v_and_b32 v33, 0xffff0000, v14
v_mfma_f32_16x16x32_bf16 v[200:203], a[92:95], v[64:67], v[200:203]
v_lshlrev_b32 v34, 16, v15
v_mfma_f32_16x16x32_bf16 v[204:207], a[96:99], v[64:67], v[204:207]
v_and_b32 v35, 0xffff0000, v15
v_lshlrev_b32 v36, 16, v16
s_waitcnt vmcnt(11)
v_mfma_f32_16x16x32_bf16 v[188:191], a[100:103], v[68:71], v[188:191]
buffer_load_dwordx4 v[116:119], v56, s[24:27], s99 offen
v_mfma_f32_16x16x32_bf16 v[192:195], a[104:107], v[68:71], v[192:195]
s_add_u32 s99, s99, 4096
v_mfma_f32_16x16x32_bf16 v[196:199], a[108:111], v[68:71], v[196:199]
ds_write_b128 v60, v[180:183] offset:3072
v_mfma_f32_16x16x32_bf16 v[200:203], a[112:115], v[68:71], v[200:203]
v_and_b32 v37, 0xffff0000, v16
v_lshlrev_b32 v38, 16, v17
v_mfma_f32_16x16x32_bf16 v[204:207], a[116:119], v[68:71], v[204:207]
v_and_b32 v39, 0xffff0000, v17
v_fma_f32 v20, v40, v7, v6
s_waitcnt vmcnt(11)
v_mfma_f32_16x16x32_bf16 v[188:191], a[120:123], v[72:75], v[188:191]
buffer_load_dwordx4 v[120:123], v56, s[24:27], s99 offen
v_mfma_f32_16x16x32_bf16 v[192:195], a[124:127], v[72:75], v[192:195]
s_add_u32 s99, s99, 4096
v_mfma_f32_16x16x32_bf16 v[196:199], a[128:131], v[72:75], v[196:199]
v_fma_f32 v21, v41, v7, v6
v_fma_f32 v22, v42, v7, v6
v_mfma_f32_16x16x32_bf16 v[200:203], a[132:135], v[72:75], v[200:203]
ds_write_b128 v60, v[184:187] offset:4096
v_mfma_f32_16x16x32_bf16 v[204:207], a[136:139], v[72:75], v[204:207]
v_fma_f32 v23, v43, v7, v6
s_cmp_lg_u32 s5, 0
s_cbranch_scc1 L_ypl_42
buffer_load_dword v254, v250, s[24:27], 0 offen sc1
L_ypl_42:
s_waitcnt vmcnt(11)
v_mfma_f32_16x16x32_bf16 v[188:191], a[140:143], v[76:79], v[188:191]
buffer_load_dwordx4 v[124:127], v56, s[24:27], s99 offen
v_mfma_f32_16x16x32_bf16 v[192:195], a[144:147], v[76:79], v[192:195]
s_add_u32 s99, s99, 4096
v_fma_f32 v24, v44, v7, v6
v_mfma_f32_16x16x32_bf16 v[196:199], a[148:151], v[76:79], v[196:199]
v_fma_f32 v25, v45, v7, v6
v_fma_f32 v26, v46, v7, v6
v_mfma_f32_16x16x32_bf16 v[200:203], a[152:155], v[76:79], v[200:203]
v_fma_f32 v27, v47, v7, v6
v_mfma_f32_16x16x32_bf16 v[204:207], a[156:159], v[76:79], v[204:207]
v_fma_f32 v28, v28, v7, v6
v_fma_f32 v29, v29, v7, v6
s_waitcnt vmcnt(11)
v_mfma_f32_16x16x32_bf16 v[188:191], a[160:163], v[80:83], v[188:191]
buffer_load_dwordx4 v[64:67], v56, s[24:27], s99 offen
v_mfma_f32_16x16x32_bf16 v[192:195], a[164:167], v[80:83], v[192:195]
s_add_u32 s99, s99, 4096
v_fma_f32 v30, v30, v7, v6
v_mfma_f32_16x16x32_bf16 v[196:199], a[168:171], v[80:83], v[196:199]
v_fma_f32 v31, v31, v7, v6
v_mfma_f32_16x16x32_bf16 v[200:203], a[172:175], v[80:83], v[200:203]
v_fma_f32 v32, v32, v7, v6
v_fma_f32 v33, v33, v7, v6
v_mfma_f32_16x16x32_bf16 v[204:207], a[176:179], v[80:83], v[204:207]
v_fma_f32 v34, v34, v7, v6
s_waitcnt vmcnt(11)
v_mfma_f32_16x16x32_bf16 v[188:191], a[180:183], v[84:87], v[188:191]
buffer_load_dwordx4 v[68:71], v56, s[24:27], s99 offen
v_mfma_f32_16x16x32_bf16 v[192:195], a[184:187], v[84:87], v[192:195]
s_add_u32 s99, s99, 4096
v_fma_f32 v35, v35, v7, v6
v_mfma_f32_16x16x32_bf16 v[196:199], a[188:191], v[84:87], v[196:199]
v_fma_f32 v36, v36, v7, v6
v_lshrrev_b32 v2, 3, v1
v_mfma_f32_16x16x32_bf16 v[200:203], a[192:195], v[84:87], v[200:203]
v_fma_f32 v37, v37, v7, v6
v_fma_f32 v38, v38, v7, v6
v_mfma_f32_16x16x32_bf16 v[204:207], a[196:199], v[84:87], v[204:207]
v_fma_f32 v39, v39, v7, v6
v_and_b32 v3, 7, v1
s_waitcnt vmcnt(11)
v_mfma_f32_16x16x32_bf16 v[188:191], a[200:203], v[88:91], v[188:191]
buffer_load_dwordx4 v[72:75], v56, s[24:27], s99 offen
v_mfma_f32_16x16x32_bf16 v[192:195], a[204:207], v[88:91], v[192:195]
s_add_u32 s99, s99, 4096
v_lshlrev_b32 v3, 4, v3
v_mfma_f32_16x16x32_bf16 v[196:199], a[208:211], v[88:91], v[196:199]
v_lshl_add_u32 v61, v2, 12, v3
v_mfma_f32_16x16x32_bf16 v[200:203], a[212:215], v[88:91], v[200:203]
s_mul_i32 s90, s95, 80
v_mfma_f32_16x16x32_bf16 v[204:207], a[216:219], v[88:91], v[204:207]
s_lshl_b32 s91, s5, 3
s_add_u32 s90, s90, s91
s_waitcnt vmcnt(11)
v_mfma_f32_16x16x32_bf16 v[188:191], a[220:223], v[92:95], v[188:191]
buffer_load_dwordx4 v[76:79], v56, s[24:27], s99 offen
v_mfma_f32_16x16x32_bf16 v[192:195], a[224:227], v[92:95], v[192:195]
s_add_u32 s99, s99, 4096
v_mfma_f32_16x16x32_bf16 v[196:199], a[228:231], v[92:95], v[196:199]
s_lshl_b32 s90, s90, 12
s_lshl_b32 s91, s94, 7
v_mfma_f32_16x16x32_bf16 v[200:203], a[232:235], v[92:95], v[200:203]
s_add_u32 s90, s90, s91
v_mfma_f32_16x16x32_bf16 v[204:207], a[236:239], v[92:95], v[204:207]
s_add_u32 s90, s90, 4194304
s_lshl_b32 s91, s5, 14
s_waitcnt vmcnt(11)
v_mfma_f32_16x16x32_bf16 v[188:191], v[208:211], v[96:99], v[188:191]
buffer_load_dwordx4 v[80:83], v56, s[24:27], s99 offen
v_mfma_f32_16x16x32_bf16 v[192:195], v[212:215], v[96:99], v[192:195]
s_add_u32 s99, s99, 4096
v_mfma_f32_16x16x32_bf16 v[196:199], v[216:219], v[96:99], v[196:199]
s_sub_u32 s88, s90, s91
s_add_u32 s88, s88, 262144
v_mfma_f32_16x16x32_bf16 v[200:203], v[220:223], v[96:99], v[200:203]
s_lshl_b32 s89, s5, 9
v_mfma_f32_16x16x32_bf16 v[204:207], v[224:227], v[96:99], v[204:207]
s_add_u32 s89, s89, 69632
s_cmp_ge_u32 s5, 2
s_cbranch_scc1 L_umskip_43
s_waitcnt vmcnt(11)
v_mfma_f32_16x16x32_bf16 v[188:191], v[228:231], v[100:103], v[188:191]
v_mfma_f32_16x16x32_bf16 v[192:195], v[232:235], v[100:103], v[192:195]
v_mfma_f32_16x16x32_bf16 v[196:199], v[236:239], v[100:103], v[196:199]
v_mfma_f32_16x16x32_bf16 v[200:203], v[240:243], v[100:103], v[200:203]
v_mfma_f32_16x16x32_bf16 v[204:207], v[244:247], v[100:103], v[204:207]
L_umskip_43:
s_waitcnt vmcnt(10)
v_mfma_f32_16x16x32_bf16 v[128:131], a[0:3], v[104:107], v[128:131]
buffer_load_dwordx4 v[84:87], v56, s[24:27], s99 offen
v_mfma_f32_16x16x32_bf16 v[132:135], a[4:7], v[104:107], v[132:135]
s_add_u32 s99, s99, 4096
s_add_u32 s84, s5, 3
s_and_b32 s84, s84, 3
s_mul_i32 s84, s84, 15360
v_mfma_f32_16x16x32_bf16 v[136:139], a[8:11], v[104:107], v[136:139]
buffer_load_dwordx4 v[88:91], v56, s[24:27], s99 offen
s_add_u32 s84, s84, 10240
v_lshl_add_u32 v60, v1, 4, s84
v_mfma_f32_16x16x32_bf16 v[140:143], a[12:15], v[104:107], v[140:143]
s_add_u32 s99, s99, 4096
s_lshl_b32 s91, s5, 10
v_mfma_f32_16x16x32_bf16 v[144:147], a[16:19], v[104:107], v[144:147]
s_add_u32 s91, s91, 61440
s_barrier
s_waitcnt vmcnt(11)
v_mfma_f32_16x16x32_bf16 v[128:131], a[20:23], v[108:111], v[128:131]
buffer_load_dwordx4 v[92:95], v56, s[24:27], s99 offen
v_mfma_f32_16x16x32_bf16 v[132:135], a[24:27], v[108:111], v[132:135]
s_mov_b32 s99, s81
v_mfma_f32_16x16x32_bf16 v[136:139], a[28:31], v[108:111], v[136:139]
ds_write_b128 v60, v[188:191] offset:0
v_mfma_f32_16x16x32_bf16 v[140:143], a[32:35], v[108:111], v[140:143]
v_mfma_f32_16x16x32_bf16 v[144:147], a[36:39], v[108:111], v[144:147]
ds_write_b128 v60, v[192:195] offset:1024
s_waitcnt vmcnt(11)
v_mfma_f32_16x16x32_bf16 v[128:131], a[40:43], v[112:115], v[128:131]
v_lshlrev_b32 v96, 16, v12
v_mfma_f32_16x16x32_bf16 v[132:135], a[44:47], v[112:115], v[132:135]
v_and_b32 v97, 0xffff0000, v12
v_mfma_f32_16x16x32_bf16 v[136:139], a[48:51], v[112:115], v[136:139]
v_lshlrev_b32 v98, 16, v13
v_mfma_f32_16x16x32_bf16 v[140:143], a[52:55], v[112:115], v[140:143]
ds_write_b128 v60, v[196:199] offset:2048
v_mfma_f32_16x16x32_bf16 v[144:147], a[56:59], v[112:115], v[144:147]
v_and_b32 v99, 0xffff0000, v13
s_waitcnt vmcnt(10)
v_mfma_f32_16x16x32_bf16 v[128:131], a[60:63], v[116:119], v[128:131]
v_lshlrev_b32 v100, 16, v14
v_mfma_f32_16x16x32_bf16 v[132:135], a[64:67], v[116:119], v[132:135]
v_and_b32 v101, 0xffff0000, v14
v_mfma_f32_16x16x32_bf16 v[136:139], a[68:71], v[116:119], v[136:139]
ds_write_b128 v60, v[200:203] offset:3072
v_mfma_f32_16x16x32_bf16 v[140:143], a[72:75], v[116:119], v[140:143]
v_lshlrev_b32 v102, 16, v15
v_mfma_f32_16x16x32_bf16 v[144:147], a[76:79], v[116:119], v[144:147]
v_and_b32 v103, 0xffff0000, v15
s_waitcnt vmcnt(9)
v_mfma_f32_16x16x32_bf16 v[128:131], a[80:83], v[120:123], v[128:131]
v_lshlrev_b32 v104, 16, v16
v_mfma_f32_16x16x32_bf16 v[132:135], a[84:87], v[120:123], v[132:135]
ds_write_b128 v60, v[204:207] offset:4096
v_mfma_f32_16x16x32_bf16 v[136:139], a[88:91], v[120:123], v[136:139]
v_and_b32 v105, 0xffff0000, v16
v_mfma_f32_16x16x32_bf16 v[140:143], a[92:95], v[120:123], v[140:143]
v_lshlrev_b32 v106, 16, v17
v_mfma_f32_16x16x32_bf16 v[144:147], a[96:99], v[120:123], v[144:147]
v_and_b32 v107, 0xffff0000, v17
s_cmp_lg_u32 s5, 0
s_cbranch_scc1 L_back_45
s_waitcnt vmcnt(9)
v_cmp_eq_u32 vcc, 0, v254
s_cbranch_vccnz L_slow_44
L_back_45:
s_waitcnt lgkmcnt(0)
s_barrier
s_mov_b32 m0, s91
s_add_u32 s91, s91, 4096
buffer_load_dwordx4 v61, s[24:27], s90 offen lds
s_add_u32 s90, s90, 131072
s_mov_b32 m0, s91
s_add_u32 s91, s91, 4096
buffer_load_dwordx4 v61, s[24:27], s90 offen lds
s_add_u32 s90, s90, 131072
s_mov_b32 m0, s89
s_mov_b32 exec_hi, 0
buffer_load_dwordx4 v61, s[24:27], s88 offen lds
s_mov_b32 exec_hi, -1
s_waitcnt vmcnt(11)
v_mfma_f32_16x16x32_bf16 v[128:131], a[100:103], v[124:127], v[128:131]
ds_read_b128 v[148:151], v62 offset:0
ds_read_b128 v[152:155], v62 offset:1024
v_mfma_f32_16x16x32_bf16 v[132:135], a[104:107], v[124:127], v[132:135]
ds_read_b128 v[156:159], v62 offset:2048
v_mfma_f32_16x16x32_bf16 v[136:139], a[108:111], v[124:127], v[136:139]
ds_read_b128 v[160:163], v62 offset:3072
ds_read_b128 v[164:167], v62 offset:4096
v_mfma_f32_16x16x32_bf16 v[140:143], a[112:115], v[124:127], v[140:143]
ds_read_b128 v[168:171], v62 offset:5120
v_mfma_f32_16x16x32_bf16 v[144:147], a[116:119], v[124:127], v[144:147]
ds_read_b128 v[172:175], v62 offset:6144
ds_read_b128 v[176:179], v62 offset:7168
s_waitcnt vmcnt(10)
v_mfma_f32_16x16x32_bf16 v[128:131], a[120:123], v[64:67], v[128:131]
ds_read_b128 v[180:183], v62 offset:8192
v_mfma_f32_16x16x32_bf16 v[132:135], a[124:127], v[64:67], v[132:135]
ds_read_b128 v[184:187], v62 offset:9216
ds_read_b128 v[188:191], v62 offset:10240
v_mfma_f32_16x16x32_bf16 v[136:139], a[128:131], v[64:67], v[136:139]
ds_read_b128 v[192:195], v62 offset:11264
v_mfma_f32_16x16x32_bf16 v[140:143], a[132:135], v[64:67], v[140:143]
ds_read_b128 v[196:199], v62 offset:12288
ds_read_b128 v[200:203], v62 offset:13312
v_mfma_f32_16x16x32_bf16 v[144:147], a[136:139], v[64:67], v[144:147]
ds_read_b128 v[204:207], v62 offset:14336
s_waitcnt vmcnt(9)
v_mfma_f32_16x16x32_bf16 v[128:131], a[140:143], v[68:71], v[128:131]
v_mfma_f32_16x16x32_bf16 v[132:135], a[144:147], v[68:71], v[132:135]
v_mfma_f32_16x16x32_bf16 v[136:139], a[148:151], v[68:71], v[136:139]
v_mfma_f32_16x16x32_bf16 v[140:143], a[152:155], v[68:71], v[140:143]
v_mfma_f32_16x16x32_bf16 v[144:147], a[156:159], v[68:71], v[144:147]
s_waitcnt lgkmcnt(5)
s_waitcnt vmcnt(8)
v_mfma_f32_16x16x32_bf16 v[128:131], a[160:163], v[72:75], v[128:131]
v_add_f32 v148, v148, v168
v_add_f32 v149, v149, v169
v_mfma_f32_16x16x32_bf16 v[132:135], a[164:167], v[72:75], v[132:135]
v_add_f32 v150, v150, v170
v_add_f32 v151, v151, v171
v_mfma_f32_16x16x32_bf16 v[136:139], a[168:171], v[72:75], v[136:139]
v_add_f32 v152, v152, v172
v_add_f32 v153, v153, v173
v_mfma_f32_16x16x32_bf16 v[140:143], a[172:175], v[72:75], v[140:143]
v_add_f32 v154, v154, v174
v_add_f32 v155, v155, v175
v_mfma_f32_16x16x32_bf16 v[144:147], a[176:179], v[72:75], v[144:147]
v_add_f32 v156, v156, v176
v_add_f32 v157, v157, v177
s_waitcnt vmcnt(7)
v_mfma_f32_16x16x32_bf16 v[128:131], a[180:183], v[76:79], v[128:131]
v_add_f32 v158, v158, v178
v_add_f32 v159, v159, v179
v_mfma_f32_16x16x32_bf16 v[132:135], a[184:187], v[76:79], v[132:135]
v_add_f32 v160, v160, v180
v_add_f32 v161, v161, v181
v_mfma_f32_16x16x32_bf16 v[136:139], a[188:191], v[76:79], v[136:139]
v_add_f32 v162, v162, v182
v_add_f32 v163, v163, v183
v_mfma_f32_16x16x32_bf16 v[140:143], a[192:195], v[76:79], v[140:143]
v_add_f32 v164, v164, v184
v_add_f32 v165, v165, v185
v_mfma_f32_16x16x32_bf16 v[144:147], a[196:199], v[76:79], v[144:147]
v_add_f32 v166, v166, v186
v_add_f32 v167, v167, v187
s_waitcnt lgkmcnt(0)
s_waitcnt vmcnt(6)
v_mfma_f32_16x16x32_bf16 v[128:131], a[200:203], v[80:83], v[128:131]
v_add_f32 v148, v148, v188
v_add_f32 v149, v149, v189
v_mfma_f32_16x16x32_bf16 v[132:135], a[204:207], v[80:83], v[132:135]
v_add_f32 v150, v150, v190
v_add_f32 v151, v151, v191
v_mfma_f32_16x16x32_bf16 v[136:139], a[208:211], v[80:83], v[136:139]
v_add_f32 v152, v152, v192
v_add_f32 v153, v153, v193
v_mfma_f32_16x16x32_bf16 v[140:143], a[212:215], v[80:83], v[140:143]
v_add_f32 v154, v154, v194
v_add_f32 v155, v155, v195
v_mfma_f32_16x16x32_bf16 v[144:147], a[216:219], v[80:83], v[144:147]
v_add_f32 v156, v156, v196
v_add_f32 v157, v157, v197
s_waitcnt vmcnt(5)
v_mfma_f32_16x16x32_bf16 v[128:131], a[220:223], v[84:87], v[128:131]
v_add_f32 v158, v158, v198
v_add_f32 v159, v159, v199
v_mfma_f32_16x16x32_bf16 v[132:135], a[224:227], v[84:87], v[132:135]
v_add_f32 v160, v160, v200
v_add_f32 v161, v161, v201
v_mfma_f32_16x16x32_bf16 v[136:139], a[228:231], v[84:87], v[136:139]
v_add_f32 v162, v162, v202
v_add_f32 v163, v163, v203
v_mfma_f32_16x16x32_bf16 v[140:143], a[232:235], v[84:87], v[140:143]
v_add_f32 v164, v164, v204
v_add_f32 v165, v165, v205
v_mfma_f32_16x16x32_bf16 v[144:147], a[236:239], v[84:87], v[144:147]
v_add_f32 v166, v166, v206
v_add_f32 v167, v167, v207
s_waitcnt vmcnt(4)
v_mfma_f32_16x16x32_bf16 v[128:131], v[208:211], v[88:91], v[128:131]
v_mfma_f32_16x16x32_bf16 v[132:135], v[212:215], v[88:91], v[132:135]
v_mfma_f32_16x16x32_bf16 v[136:139], v[216:219], v[88:91], v[136:139]
v_mfma_f32_16x16x32_bf16 v[140:143], v[220:223], v[88:91], v[140:143]
v_mfma_f32_16x16x32_bf16 v[144:147], v[224:227], v[88:91], v[144:147]
s_cmp_ge_u32 s5, 2
s_cbranch_scc1 L_umskip_46
s_waitcnt vmcnt(3)
v_mfma_f32_16x16x32_bf16 v[128:131], v[228:231], v[92:95], v[128:131]
v_mfma_f32_16x16x32_bf16 v[132:135], v[232:235], v[92:95], v[132:135]
v_mfma_f32_16x16x32_bf16 v[136:139], v[236:239], v[92:95], v[136:139]
v_mfma_f32_16x16x32_bf16 v[140:143], v[240:243], v[92:95], v[140:143]
v_mfma_f32_16x16x32_bf16 v[144:147], v[244:247], v[92:95], v[144:147]
L_umskip_46:
s_nop 7
v_pk_add_f32 v[128:129], v[128:129], v[148:149]
v_pk_add_f32 v[130:131], v[130:131], v[150:151]
v_pk_add_f32 v[132:133], v[132:133], v[152:153]
v_pk_add_f32 v[134:135], v[134:135], v[154:155]
v_pk_add_f32 v[136:137], v[136:137], v[156:157]
v_pk_add_f32 v[138:139], v[138:139], v[158:159]
v_pk_add_f32 v[140:141], v[140:141], v[160:161]
v_pk_add_f32 v[142:143], v[142:143], v[162:163]
v_pk_add_f32 v[144:145], v[144:145], v[164:165]
v_pk_add_f32 v[146:147], v[146:147], v[166:167]
v_pk_mul_f32 v[64:65], v[128:129], v[48:49] op_sel_hi:[1,0]
v_pk_mul_f32 v[66:67], v[130:131], v[48:49] op_sel_hi:[1,0]
v_pk_mul_f32 v[68:69], v[132:133], v[48:49] op_sel_hi:[1,0]
v_pk_mul_f32 v[70:71], v[134:135], v[48:49] op_sel_hi:[1,0]
v_pk_mul_f32 v[72:73], v[136:137], v[48:49] op_sel_hi:[1,0]
v_pk_mul_f32 v[74:75], v[138:139], v[48:49] op_sel_hi:[1,0]
v_pk_mul_f32 v[76:77], v[140:141], v[48:49] op_sel_hi:[1,0]
v_pk_mul_f32 v[78:79], v[142:143], v[48:49] op_sel_hi:[1,0]
v_pk_mul_f32 v[80:81], v[144:145], v[48:49] op_sel_hi:[1,0]
v_pk_mul_f32 v[82:83], v[146:147], v[48:49] op_sel_hi:[1,0]
v_exp_f32 v64, v64
v_exp_f32 v65, v65
v_exp_f32 v66, v66
v_exp_f32 v67, v67
v_exp_f32 v68, v68
v_exp_f32 v69, v69
v_exp_f32 v70, v70
v_exp_f32 v71, v71
v_exp_f32 v72, v72
v_exp_f32 v73, v73
v_exp_f32 v74, v74
v_exp_f32 v75, v75
v_exp_f32 v76, v76
v_exp_f32 v77, v77
v_exp_f32 v78, v78
v_exp_f32 v79, v79
v_exp_f32 v80, v80
v_exp_f32 v81, v81
v_exp_f32 v82, v82
v_exp_f32 v83, v83
s_waitcnt vmcnt(0) lgkmcnt(0)
s_barrier
ds_read_b64_tr_b16 v[188:189], v63 offset:0
ds_read_b64_tr_b16 v[190:191], v63 offset:512
ds_read_b64_tr_b16 v[192:193], v63 offset:1024
ds_read_b64_tr_b16 v[194:195], v63 offset:1536
ds_read_b64_tr_b16 v[196:197], v63 offset:2048
v_pk_add_f32 v[64:65], v[64:65], v[48:49] op_sel:[0,1] op_sel_hi:[1,1]
v_pk_add_f32 v[66:67], v[66:67], v[48:49] op_sel:[0,1] op_sel_hi:[1,1]
v_pk_add_f32 v[68:69], v[68:69], v[48:49] op_sel:[0,1] op_sel_hi:[1,1]
v_pk_add_f32 v[70:71], v[70:71], v[48:49] op_sel:[0,1] op_sel_hi:[1,1]
v_pk_add_f32 v[72:73], v[72:73], v[48:49] op_sel:[0,1] op_sel_hi:[1,1]
v_pk_add_f32 v[74:75], v[74:75], v[48:49] op_sel:[0,1] op_sel_hi:[1,1]
v_pk_add_f32 v[76:77], v[76:77], v[48:49] op_sel:[0,1] op_sel_hi:[1,1]
v_pk_add_f32 v[78:79], v[78:79], v[48:49] op_sel:[0,1] op_sel_hi:[1,1]
v_pk_add_f32 v[80:81], v[80:81], v[48:49] op_sel:[0,1] op_sel_hi:[1,1]
v_pk_add_f32 v[82:83], v[82:83], v[48:49] op_sel:[0,1] op_sel_hi:[1,1]
v_rcp_f32 v64, v64
v_rcp_f32 v65, v65
v_rcp_f32 v66, v66
v_rcp_f32 v67, v67
v_rcp_f32 v68, v68
v_rcp_f32 v69, v69
v_rcp_f32 v70, v70
v_rcp_f32 v71, v71
v_rcp_f32 v72, v72
v_rcp_f32 v73, v73
v_rcp_f32 v74, v74
v_rcp_f32 v75, v75
v_rcp_f32 v76, v76
v_rcp_f32 v77, v77
v_rcp_f32 v78, v78
v_rcp_f32 v79, v79
v_rcp_f32 v80, v80
v_rcp_f32 v81, v81
v_rcp_f32 v82, v82
v_rcp_f32 v83, v83
s_waitcnt lgkmcnt(0)
v_lshlrev_b32 v108, 16, v188
v_and_b32 v109, 0xffff0000, v188
v_lshlrev_b32 v110, 16, v189
v_and_b32 v111, 0xffff0000, v189
v_lshlrev_b32 v112, 16, v190
v_and_b32 v113, 0xffff0000, v190
v_lshlrev_b32 v114, 16, v191
v_and_b32 v115, 0xffff0000, v191
v_pk_mul_f32 v[64:65], v[64:65], v[128:129]
v_pk_mul_f32 v[66:67], v[66:67], v[130:131]
v_pk_mul_f32 v[68:69], v[68:69], v[132:133]
v_pk_mul_f32 v[70:71], v[70:71], v[134:135]
v_pk_mul_f32 v[108:109], v[108:109], v[20:21]
v_pk_mul_f32 v[110:111], v[110:111], v[22:23]
v_pk_mul_f32 v[112:113], v[112:113], v[24:25]
v_pk_mul_f32 v[114:115], v[114:115], v[26:27]
v_pk_fma_f32 v[108:109], v[108:109], v[64:65], v[40:41]
v_pk_fma_f32 v[110:111], v[110:111], v[66:67], v[42:43]
v_pk_fma_f32 v[112:113], v[112:113], v[68:69], v[44:45]
v_pk_fma_f32 v[114:115], v[114:115], v[70:71], v[46:47]
v_cvt_pk_bf16_f32 v188, v108, v109
v_cvt_pk_bf16_f32 v189, v110, v111
v_cvt_pk_bf16_f32 v190, v112, v113
v_cvt_pk_bf16_f32 v191, v114, v115
ds_write_b64 v50, v[188:189] offset:0
ds_write_b64 v50, v[190:191] offset:8
v_lshlrev_b32 v116, 16, v192
v_and_b32 v117, 0xffff0000, v192
v_lshlrev_b32 v118, 16, v193
v_and_b32 v119, 0xffff0000, v193
v_lshlrev_b32 v120, 16, v194
v_and_b32 v121, 0xffff0000, v194
v_lshlrev_b32 v122, 16, v195
v_and_b32 v123, 0xffff0000, v195
v_lshlrev_b32 v124, 16, v196
v_and_b32 v125, 0xffff0000, v196
v_lshlrev_b32 v126, 16, v197
v_and_b32 v127, 0xffff0000, v197
v_pk_mul_f32 v[72:73], v[72:73], v[136:137]
v_pk_mul_f32 v[74:75], v[74:75], v[138:139]
v_pk_mul_f32 v[76:77], v[76:77], v[140:141]
v_pk_mul_f32 v[78:79], v[78:79], v[142:143]
v_pk_mul_f32 v[80:81], v[80:81], v[144:145]
v_pk_mul_f32 v[82:83], v[82:83], v[146:147]
v_pk_mul_f32 v[116:117], v[116:117], v[28:29]
v_pk_mul_f32 v[118:119], v[118:119], v[30:31]
v_pk_mul_f32 v[120:121], v[120:121], v[32:33]
v_pk_mul_f32 v[122:123], v[122:123], v[34:35]
v_pk_mul_f32 v[124:125], v[124:125], v[36:37]
v_pk_mul_f32 v[126:127], v[126:127], v[38:39]
v_pk_fma_f32 v[116:117], v[116:117], v[72:73], v[96:97]
v_pk_fma_f32 v[118:119], v[118:119], v[74:75], v[98:99]
v_pk_fma_f32 v[120:121], v[120:121], v[76:77], v[100:101]
v_pk_fma_f32 v[122:123], v[122:123], v[78:79], v[102:103]
v_pk_fma_f32 v[124:125], v[124:125], v[80:81], v[104:105]
v_pk_fma_f32 v[126:127], v[126:127], v[82:83], v[106:107]
v_cvt_pk_bf16_f32 v192, v116, v117
v_cvt_pk_bf16_f32 v193, v118, v119
v_cvt_pk_bf16_f32 v194, v120, v121
v_cvt_pk_bf16_f32 v195, v122, v123
v_cvt_pk_bf16_f32 v196, v124, v125
v_cvt_pk_bf16_f32 v197, v126, v127
ds_write_b64 v50, v[192:193] offset:16
ds_write_b64 v50, v[194:195] offset:24
ds_write_b64 v50, v[196:197] offset:32
s_mov_b64 exec, s[86:87]
ds_read_b128 v[64:67], v51 offset:0
ds_read_b128 v[68:71], v51 offset:704
ds_read_b128 v[72:75], v51 offset:1408
ds_read_b128 v[76:79], v51 offset:2112
s_waitcnt lgkmcnt(3)
buffer_store_dwordx4 v[64:67], v52, s[28:31], 0 offen
s_waitcnt lgkmcnt(2)
buffer_store_dwordx4 v[68:71], v53, s[28:31], 0 offen
s_waitcnt lgkmcnt(1)
buffer_store_dwordx4 v[72:75], v54, s[28:31], 0 offen
s_waitcnt lgkmcnt(0)
buffer_store_dwordx4 v[76:79], v55, s[28:31], 0 offen
s_mov_b64 exec, -1
L_end:
s_endpgm
L_spare:
s_and_b32 s6, s3, 3
s_lshr_b32 s7, s3, 2
s_lshl_b32 s6, s6, 1
s_add_u32 s73, s6, s7
s_lshl_b32 s73, s73, 2
s_add_u32 s73, s73, s4
s_sub_u32 s73, s73, 28
s_and_b32 s6, s3, 3
s_lshl_b32 s6, s6, 2
s_and_b32 s7, s4, 3
s_add_u32 s77, s6, s7
s_lshr_b32 s6, s3, 2
s_mul_i32 s6, s6, 7
s_lshr_b32 s7, s4, 2
s_add_u32 s78, s6, s7
s_and_b32 s82, s5, 1
s_lshr_b32 s83, s5, 1
s_lshl_b32 s6, s3, 4
s_lshr_b32 s7, s4, 1
s_add_u32 s6, s6, s7
s_mul_i32 s6, s6, 5
s_and_b32 s89, s4, 1
s_lshl_b32 s7, s89, 1
s_add_u32 s88, s6, s7
s_and_b32 s6, s3, 3
s_lshl_b32 s6, s6, 3
s_and_b32 s7, s4, 7
s_add_u32 s94, s6, s7
s_lshr_b32 s6, s3, 2
s_xor_b32 s6, s6, 1
s_lshl_b32 s6, s6, 2
s_lshr_b32 s7, s4, 3
s_add_u32 s95, s6, s7
s_mul_i32 s96, s5, 14
s_cmp_eq_u32 s5, 3
s_cselect_b32 s6, 1, 0
s_sub_u32 s96, s96, s6
s_lshr_b32 s6, s4, 3
s_lshl_b32 s7, s3, 2
s_add_u32 s68, s6, s7
s_and_b32 s69, s4, 7
v_mul_u32_u24 v2, 26, v1
v_lshrrev_b32 v2, 8, v2
v_mul_u32_u24 v3, 10, v2
v_sub_u32 v3, v1, v3
s_lshl_b32 s6, s68, 6
s_lshl_b32 s7, s5, 4
s_add_u32 s6, s6, s7
s_mul_i32 s6, s6, 1280
s_mul_i32 s7, s69, 160
s_add_u32 s6, s6, s7
v_mul_u32_u24 v4, 5120, v2
v_lshl_add_u32 v4, v3, 4, v4
v_add_u32 v244, s6, v4
v_subrev_u32 v245, 3840, v244
s_mul_i32 s92, s69, 640
s_mul_i32 s7, s5, 2560
s_add_u32 s7, s7, 142592
s_mov_b32 m0, s7
v_lshl_add_u32 v247, v3, 6, s7
s_lshl_b32 s7, s5, 5
s_sub_u32 s7, 131192, s7
v_mul_u32_u24 v4, 1152, v3
v_lshlrev_b32 v2, 3, v2
v_sub_u32 v4, v4, v2
v_add_u32 v202, s7, v4
v_lshrrev_b32 v2, 3, v1
s_mul_i32 s6, s5, 20
v_add_u32 v2, s6, v2
v_and_b32 v3, 7, v1
v_lshlrev_b32 v3, 4, v3
v_mul_u32_u24 v4, 144, v2
v_add_u32 v4, v4, v3
v_add_u32 v203, 131072, v4
v_lshl_add_u32 v172, v2, 12, v3
s_mul_i32 s6, s69, 327680
s_lshl_b32 s7, s68, 7
s_sub_u32 s6, s6, s7
s_add_u32 s70, s6, 1052544
s_add_u32 s71, s70, 32768
s_add_u32 s72, s70, 65536
s_lshl_b32 s6, s73, 6
s_lshl_b32 s7, s5, 4
s_add_u32 s6, s6, s7
s_mul_i32 s75, s6, 1280
s_lshl_b32 s6, s73, 2
s_add_u32 s6, s6, s5
s_mul_i32 s76, s6, 20480
v_lshlrev_b32 v233, 7, v1
s_lshl_b32 s6, s73, 6
s_lshl_b32 s7, s5, 4
s_add_u32 s74, s6, s7
v_and_b32 v2, 15, v1
v_lshrrev_b32 v3, 4, v1
v_add_u32 v4, s74, v2
v_mul_u32_u24 v4, 1280, v4
v_lshl_add_u32 v211, v3, 4, v4
s_waitcnt lgkmcnt(0)
s_mov_b32 s24, s66
s_and_b32 s25, s67, 0xffff
s_mov_b32 s26, 17825792
s_mov_b32 s27, 0x20000
s_lshl_b32 s6, s88, 1
s_and_b32 s6, s6, 0xfffffffc
s_load_dwordx2 s[0:1], s[50:51], s6
s_cmp_lg_u32 s5, 0
s_cbranch_scc1 L_clr_47
v_lshl_add_u32 v2, v1, 2, v252
v_mov_b32 v3, 0
s_mov_b64 exec, 0xff
buffer_store_dword v3, v2, s[24:27], 0 offen sc1
s_mov_b64 exec, -1
L_clr_47:
s_mov_b32 s12, s42
s_and_b32 s13, s43, 0xffff
s_mov_b32 s14, 2621440
s_mov_b32 s15, 0x20000
s_mov_b32 s16, s44
s_and_b32 s17, s45, 0xffff
s_mov_b32 s18, 2621440
s_mov_b32 s19, 0x20000
s_mov_b32 s32, s46
s_and_b32 s33, s47, 0xffff
s_mov_b32 s34, 5120
s_mov_b32 s35, 0x20000
s_mov_b32 s8, s40
s_and_b32 s9, s41, 0xffff
s_mov_b32 s10, 2621440
s_mov_b32 s11, 0x20000
s_mov_b32 s28, s62
s_and_b32 s29, s63, 0xffff
s_mov_b32 s30, 2621440
s_mov_b32 s31, 0x20000
s_mov_b32 s52, s64
s_and_b32 s53, s65, 0xffff
s_mov_b32 s54, 256
s_mov_b32 s55, 0x20000
s_mov_b32 s42, 0
buffer_load_dwordx4 a[0:3], v211, s[8:11], 0 offen offset:0
buffer_load_dwordx4 a[4:7], v211, s[8:11], 0 offen offset:64
buffer_load_dwordx4 a[8:11], v211, s[8:11], 0 offen offset:128
buffer_load_dwordx4 a[12:15], v211, s[8:11], 0 offen offset:192
s_waitcnt vmcnt(4)
s_cmp_lg_u32 s5, 0
s_cbranch_scc1 L_arr_48
s_and_b32 s6, s2, 7
s_lshl_b32 s6, s6, 5
v_mov_b32 v2, s6
s_mov_b64 exec, 1
buffer_atomic_add v253, v2, s[52:55], 0 offen sc1
s_mov_b64 exec, -1
L_arr_48:
buffer_load_dwordx4 a[16:19], v211, s[8:11], 0 offen offset:256
buffer_load_dwordx4 a[20:23], v211, s[8:11], 0 offen offset:320
buffer_load_dwordx4 a[24:27], v211, s[8:11], 0 offen offset:384
buffer_load_dwordx4 a[28:31], v211, s[8:11], 0 offen offset:448
buffer_load_dwordx4 a[32:35], v211, s[8:11], 0 offen offset:512
buffer_load_dwordx4 a[36:39], v211, s[8:11], 0 offen offset:576
buffer_load_dwordx4 a[40:43], v211, s[8:11], 0 offen offset:640
buffer_load_dwordx4 a[44:47], v211, s[8:11], 0 offen offset:704
buffer_load_dwordx4 a[48:51], v211, s[8:11], 0 offen offset:768
buffer_load_dwordx4 a[52:55], v211, s[8:11], 0 offen offset:832
buffer_load_dwordx4 a[56:59], v211, s[8:11], 0 offen offset:896
buffer_load_dwordx4 a[60:63], v211, s[8:11], 0 offen offset:960
buffer_load_dwordx4 a[64:67], v211, s[8:11], 0 offen offset:1024
buffer_load_dwordx4 a[68:71], v211, s[8:11], 0 offen offset:1088
buffer_load_dwordx4 a[72:75], v211, s[8:11], 0 offen offset:1152
buffer_load_dwordx4 a[76:79], v211, s[8:11], 0 offen offset:1216
v_and_b32 v2, 15, v1
v_min_u32 v2, 13, v2
v_add_u32 v2, s96, v2
v_min_u32 v2, 53, v2
v_lshlrev_b32 v2, 2, v2
s_lshr_b32 s43, s95, 1
v_add_u32 v2, s43, v2
v_lshlrev_b32 v2, 7, v2
v_add_u32 v228, 12, v2
s_lshl_b32 s6, s77, 1
v_and_b32 v4, 1, v1
v_add_u32 v4, s6, v4
v_and_b32 v5, 3, v4
v_add_u32 v5, 28, v5
s_lshr_b32 s6, s77, 2
s_and_b32 s7, s77, 2
s_lshl_b32 s7, s7, 1
s_add_u32 s6, s6, s7
v_mov_b32 v4, s6
v_lshl_add_u32 v4, v5, 3, v4
v_lshlrev_b32 v4, 7, v4
v_add_u32 v231, 4, v4
v_and_b32 v2, 31, v1
v_and_b32 v3, 7, v2
v_lshrrev_b32 v2, 3, v2
v_lshlrev_b32 v2, 3, v2
v_add_u32 v2, s3, v2
v_lshl_add_u32 v2, v2, 3, v3
v_lshlrev_b32 v229, 7, v2
v_cmp_gt_u32 vcc, 14, v1
v_cndmask_b32 v2, 0, v1, vcc
v_cmp_lt_u32 vcc, 6, v2
v_cndmask_b32 v3, 0, 1, vcc
v_mul_u32_u24 v4, 7, v3
v_sub_u32 v2, v2, v4
s_lshr_b32 s6, s94, 1
s_and_b32 s7, s6, 3
s_lshr_b32 s6, s6, 2
v_lshlrev_b32 v3, 2, v3
v_lshlrev_b32 v2, 2, v2
v_add_u32 v2, s7, v2
v_add_u32 v3, s6, v3
v_lshl_add_u32 v2, v2, 3, v3
v_lshlrev_b32 v2, 7, v2
v_add_u32 v249, 16, v2
v_and_b32 v2, 31, v1
v_lshlrev_b32 v2, 3, v2
v_add_u32 v2, s95, v2
v_lshlrev_b32 v2, 7, v2
v_add_u32 v250, 20, v2
v_mov_b32 v2, 2147418112
s_cmp_lg_u32 s5, 0
s_cselect_b64 vcc, -1, 0
v_cndmask_b32 v231, v231, v2, vcc
v_cndmask_b32 v230, v230, v2, vcc
v_mov_b32 v214, 0x3f803f80
v_mov_b32 v215, 0x3f803f80
v_mov_b32 v216, 0x3f803f80
v_mov_b32 v217, 0x3f803f80
v_mov_b32 v218, 0
v_mov_b32 v219, 0
v_mov_b32 v220, 0
v_mov_b32 v221, 0
v_mov_b32 v222, 0
v_mov_b32 v223, 0
v_mov_b32 v224, 0
v_mov_b32 v225, 0
s_waitcnt vmcnt(19)
v_mfma_f32_16x16x32_bf16 v[218:221], a[0:3], a[0:3], v[218:221]
v_mfma_f32_16x16x32_bf16 v[222:225], a[0:3], v[214:217], v[222:225]
s_waitcnt vmcnt(18)
v_mfma_f32_16x16x32_bf16 v[218:221], a[4:7], a[4:7], v[218:221]
v_mfma_f32_16x16x32_bf16 v[222:225], a[4:7], v[214:217], v[222:225]
s_waitcnt vmcnt(17)
v_mfma_f32_16x16x32_bf16 v[218:221], a[8:11], a[8:11], v[218:221]
v_mfma_f32_16x16x32_bf16 v[222:225], a[8:11], v[214:217], v[222:225]
s_waitcnt vmcnt(16)
v_mfma_f32_16x16x32_bf16 v[218:221], a[12:15], a[12:15], v[218:221]
v_mfma_f32_16x16x32_bf16 v[222:225], a[12:15], v[214:217], v[222:225]
s_waitcnt vmcnt(15)
v_mfma_f32_16x16x32_bf16 v[218:221], a[16:19], a[16:19], v[218:221]
v_mfma_f32_16x16x32_bf16 v[222:225], a[16:19], v[214:217], v[222:225]
s_waitcnt vmcnt(14)
v_mfma_f32_16x16x32_bf16 v[218:221], a[20:23], a[20:23], v[218:221]
v_mfma_f32_16x16x32_bf16 v[222:225], a[20:23], v[214:217], v[222:225]
s_waitcnt vmcnt(13)
v_mfma_f32_16x16x32_bf16 v[218:221], a[24:27], a[24:27], v[218:221]
v_mfma_f32_16x16x32_bf16 v[222:225], a[24:27], v[214:217], v[222:225]
s_waitcnt vmcnt(12)
v_mfma_f32_16x16x32_bf16 v[218:221], a[28:31], a[28:31], v[218:221]
v_mfma_f32_16x16x32_bf16 v[222:225], a[28:31], v[214:217], v[222:225]
s_waitcnt vmcnt(11)
v_mfma_f32_16x16x32_bf16 v[218:221], a[32:35], a[32:35], v[218:221]
v_mfma_f32_16x16x32_bf16 v[222:225], a[32:35], v[214:217], v[222:225]
s_waitcnt vmcnt(10)
v_mfma_f32_16x16x32_bf16 v[218:221], a[36:39], a[36:39], v[218:221]
v_mfma_f32_16x16x32_bf16 v[222:225], a[36:39], v[214:217], v[222:225]
s_waitcnt vmcnt(9)
v_mfma_f32_16x16x32_bf16 v[218:221], a[40:43], a[40:43], v[218:221]
v_mfma_f32_16x16x32_bf16 v[222:225], a[40:43], v[214:217], v[222:225]
s_waitcnt vmcnt(8)
v_mfma_f32_16x16x32_bf16 v[218:221], a[44:47], a[44:47], v[218:221]
v_mfma_f32_16x16x32_bf16 v[222:225], a[44:47], v[214:217], v[222:225]
s_waitcnt vmcnt(7)
v_mfma_f32_16x16x32_bf16 v[218:221], a[48:51], a[48:51], v[218:221]
v_mfma_f32_16x16x32_bf16 v[222:225], a[48:51], v[214:217], v[222:225]
s_waitcnt vmcnt(6)
v_mfma_f32_16x16x32_bf16 v[218:221], a[52:55], a[52:55], v[218:221]
v_mfma_f32_16x16x32_bf16 v[222:225], a[52:55], v[214:217], v[222:225]
s_waitcnt vmcnt(5)
v_mfma_f32_16x16x32_bf16 v[218:221], a[56:59], a[56:59], v[218:221]
v_mfma_f32_16x16x32_bf16 v[222:225], a[56:59], v[214:217], v[222:225]
s_waitcnt vmcnt(4)
v_mfma_f32_16x16x32_bf16 v[218:221], a[60:63], a[60:63], v[218:221]
v_mfma_f32_16x16x32_bf16 v[222:225], a[60:63], v[214:217], v[222:225]
s_waitcnt vmcnt(3)
v_mfma_f32_16x16x32_bf16 v[218:221], a[64:67], a[64:67], v[218:221]
v_mfma_f32_16x16x32_bf16 v[222:225], a[64:67], v[214:217], v[222:225]
s_waitcnt vmcnt(2)
v_mfma_f32_16x16x32_bf16 v[218:221], a[68:71], a[68:71], v[218:221]
v_mfma_f32_16x16x32_bf16 v[222:225], a[68:71], v[214:217], v[222:225]
s_waitcnt vmcnt(1)
v_mfma_f32_16x16x32_bf16 v[218:221], a[72:75], a[72:75], v[218:221]
v_mfma_f32_16x16x32_bf16 v[222:225], a[72:75], v[214:217], v[222:225]
s_waitcnt vmcnt(0)
v_mfma_f32_16x16x32_bf16 v[218:221], a[76:79], a[76:79], v[218:221]
v_mfma_f32_16x16x32_bf16 v[222:225], a[76:79], v[214:217], v[222:225]
v_and_b32 v5, 1, v1
v_cmp_eq_u32 vcc, 1, v5
v_and_b32 v5, 2, v1
v_cmp_eq_u32 s[6:7], 2, v5
s_nop 7
v_cndmask_b32 v2, v218, v219, vcc
v_cndmask_b32 v3, v220, v221, vcc
v_cndmask_b32 v4, v222, v223, vcc
v_cndmask_b32 v5, v224, v225, vcc
v_cndmask_b32 v2, v2, v3, s[6:7]
v_cndmask_b32 v3, v4, v5, s[6:7]
v_mul_f32 v214, 0.0015625, v3
v_mul_f32 v2, 0.0015625, v2
v_fma_f32 v2, -v214, v214, v2
v_max_f32 v2, 0, v2
v_add_f32 v2, 0x3727c5ac, v2
v_sqrt_f32 v216, v2
s_nop 0
v_rcp_f32 v215, v216
v_mov_b32 v217, 0
v_sub_f32 v3, 0, v214
v_cvt_pk_bf16_f32 v4, v216, v3
v_lshlrev_b32 v5, 16, v4
v_and_b32 v6, 0xffff0000, v4
v_sub_f32 v5, v216, v5
v_sub_f32 v6, v3, v6
v_cvt_pk_bf16_f32 v5, v5, v6
s_mov_b32 s6, 0x05040100
s_mov_b32 s7, 0x07060302
v_perm_b32 v218, v5, v4, s6
v_perm_b32 v219, v5, v4, s7
v_mov_b32 v220, v219
v_mov_b32 v221, 0
v_lshrrev_b32 v3, 4, v1
v_and_b32 v5, 3, v1
v_lshl_add_u32 v5, v3, 2, v5
v_add_u32 v5, s74, v5
v_lshlrev_b32 v5, 4, v5
s_mov_b32 s6, 65536
s_mov_b32 s7, 98304
s_mov_b32 exec_lo, 0x00f0000f
s_mov_b32 exec_hi, 0xf0000f00
buffer_store_dwordx4 v[218:221], v5, s[24:27], s6 offen sc1
buffer_store_dwordx4 v[214:217], v5, s[24:27], s7 offen sc1
s_mov_b64 exec, -1
buffer_load_dword v254, v230, s[52:55], 0 offen sc1
s_mov_b32 exec_hi, 0xff
buffer_load_dwordx4 v[8:11], v245, s[12:15], 0 offen offset:0
buffer_load_dwordx4 v[12:15], v245, s[12:15], 0 offen offset:1280
buffer_load_dwordx4 v[16:19], v245, s[12:15], 0 offen offset:2560
buffer_load_dwordx4 v[20:23], v244, s[12:15], 0 offen offset:0
buffer_load_dwordx4 v[24:27], v244, s[12:15], 0 offen offset:1280
buffer_load_dwordx4 v[28:31], v244, s[12:15], 0 offen offset:2560
buffer_load_dwordx4 v[32:35], v244, s[12:15], 0 offen offset:3840
buffer_load_dwordx4 v248, s[32:35], s92 offen lds
buffer_load_dwordx4 v[174:177], v244, s[16:19], 0 offen offset:0
buffer_load_dwordx4 v[178:181], v244, s[16:19], 0 offen offset:1280
buffer_load_dwordx4 v[182:185], v244, s[16:19], 0 offen offset:2560
buffer_load_dwordx4 v[186:189], v244, s[16:19], 0 offen offset:3840
s_mov_b64 exec, -1
s_mov_b32 s36, s58
s_and_b32 s37, s59, 0xffff
s_mov_b32 s38, 2211840
s_mov_b32 s39, 0x20000
s_sub_u32 s6, s4, 28
s_lshl_b32 s6, s6, 2
s_add_u32 s6, s6, s5
s_mul_i32 s79, s6, 162
s_lshr_b32 s6, s3, 2
s_lshl_b32 s80, s6, 5
s_and_b32 s7, s3, 3
s_mul_i32 s7, s7, 320
s_and_b32 s81, s7, 0xffffff80
v_add_u32 v2, s79, v1
v_add_u32 v2, 0, v2
v_mul_u32_u24 v3, 2731, v2
v_lshrrev_b32 v3, 18, v3
v_mul_u32_u24 v4, 96, v3
v_sub_u32 v4, v2, v4
v_mul_u32_u24 v5, 86, v4
v_lshrrev_b32 v5, 8, v5
v_mul_u32_u24 v6, 3, v5
v_sub_u32 v6, v4, v6
v_lshlrev_b32 v3, 6, v3
v_add_u32 v3, v3, v5
v_add_u32 v3, s80, v3
v_mul_u32_u24 v3, 1280, v3
v_lshl_add_u32 v3, v6, 7, v3
v_add_u32 v128, s81, v3
v_add_u32 v2, s79, v1
v_add_u32 v2, 64, v2
v_mul_u32_u24 v3, 2731, v2
v_lshrrev_b32 v3, 18, v3
v_mul_u32_u24 v4, 96, v3
v_sub_u32 v4, v2, v4
v_mul_u32_u24 v5, 86, v4
v_lshrrev_b32 v5, 8, v5
v_mul_u32_u24 v6, 3, v5
v_sub_u32 v6, v4, v6
v_lshlrev_b32 v3, 6, v3
v_add_u32 v3, v3, v5
v_add_u32 v3, s80, v3
v_mul_u32_u24 v3, 1280, v3
v_lshl_add_u32 v3, v6, 7, v3
v_add_u32 v129, s81, v3
v_add_u32 v2, s79, v1
v_add_u32 v2, 128, v2
v_mul_u32_u24 v3, 2731, v2
v_lshrrev_b32 v3, 18, v3
v_mul_u32_u24 v4, 96, v3
v_sub_u32 v4, v2, v4
v_mul_u32_u24 v5, 86, v4
v_lshrrev_b32 v5, 8, v5
v_mul_u32_u24 v6, 3, v5
v_sub_u32 v6, v4, v6
v_lshlrev_b32 v3, 6, v3
v_add_u32 v3, v3, v5
v_add_u32 v3, s80, v3
v_mul_u32_u24 v3, 1280, v3
v_lshl_add_u32 v3, v6, 7, v3
v_add_u32 v130, s81, v3
buffer_load_dword v234, v128, s[36:39], 0 offen
buffer_load_dword v234, v129, s[36:39], 0 offen
s_mov_b32 exec_lo, 0xffffffff
s_mov_b32 exec_hi, 0x3
buffer_load_dword v234, v130, s[36:39], 0 offen
s_mov_b64 exec, -1
s_waitcnt vmcnt(16)
s_barrier
s_cmp_lg_u32 s5, 0
s_cbranch_scc1 L_fl_49
s_mov_b64 exec, 1
buffer_store_dword v253, v252, s[24:27], 0 offen offset:4 sc1
s_mov_b64 exec, -1
L_fl_49:
s_waitcnt vmcnt(15)
s_cmp_lg_u32 s5, 0
s_cbranch_scc1 L_back_51
v_cmp_gt_u32 vcc, 32, v254
s_cbranch_vccnz L_slow_50
L_back_51:
s_waitcnt vmcnt(3)
ds_read_b128 v[36:39], v247 offset:0
ds_read_b128 v[40:43], v247 offset:16
ds_read_b128 v[44:47], v247 offset:32
ds_read_b128 v[48:51], v247 offset:48
v_lshlrev_b32 v194, 16, v8
v_and_b32 v195, 0xffff0000, v8
v_lshlrev_b32 v196, 16, v12
v_and_b32 v197, 0xffff0000, v12
v_lshlrev_b32 v198, 16, v16
v_and_b32 v199, 0xffff0000, v16
v_lshlrev_b32 v236, 16, v20
v_and_b32 v237, 0xffff0000, v20
v_lshlrev_b32 v238, 16, v24
v_and_b32 v239, 0xffff0000, v24
v_lshlrev_b32 v240, 16, v28
v_and_b32 v241, 0xffff0000, v28
v_lshlrev_b32 v242, 16, v32
v_and_b32 v243, 0xffff0000, v32
s_waitcnt lgkmcnt(0)
v_lshlrev_b32 v52, 16, v36
v_lshlrev_b32 v53, 16, v38
v_and_b32 v54, 0xffff0000, v36
v_and_b32 v55, 0xffff0000, v38
v_lshlrev_b32 v56, 16, v37
v_lshlrev_b32 v57, 16, v39
v_and_b32 v58, 0xffff0000, v37
v_and_b32 v59, 0xffff0000, v39
v_pk_mul_f32 v[60:61], v[236:237], v[52:53]
v_pk_mul_f32 v[62:63], v[238:239], v[52:53]
v_pk_mul_f32 v[190:191], v[240:241], v[52:53]
v_pk_mul_f32 v[192:193], v[242:243], v[52:53]
v_pk_fma_f32 v[60:61], v[198:199], v[54:55], v[60:61]
v_pk_fma_f32 v[62:63], v[236:237], v[54:55], v[62:63]
v_pk_fma_f32 v[190:191], v[238:239], v[54:55], v[190:191]
v_pk_fma_f32 v[192:193], v[240:241], v[54:55], v[192:193]
v_pk_fma_f32 v[60:61], v[196:197], v[56:57], v[60:61]
v_pk_fma_f32 v[62:63], v[198:199], v[56:57], v[62:63]
v_pk_fma_f32 v[190:191], v[236:237], v[56:57], v[190:191]
v_pk_fma_f32 v[192:193], v[238:239], v[56:57], v[192:193]
v_pk_fma_f32 v[60:61], v[194:195], v[58:59], v[60:61]
v_pk_fma_f32 v[62:63], v[196:197], v[58:59], v[62:63]
v_pk_fma_f32 v[190:191], v[198:199], v[58:59], v[190:191]
v_pk_fma_f32 v[192:193], v[236:237], v[58:59], v[192:193]
v_lshlrev_b32 v194, 16, v174
v_and_b32 v195, 0xffff0000, v174
v_lshlrev_b32 v196, 16, v178
v_and_b32 v197, 0xffff0000, v178
v_lshlrev_b32 v198, 16, v182
v_and_b32 v199, 0xffff0000, v182
v_lshlrev_b32 v236, 16, v186
v_and_b32 v237, 0xffff0000, v186
v_pk_mul_f32 v[60:61], v[60:61], v[194:195]
v_pk_mul_f32 v[62:63], v[62:63], v[196:197]
v_pk_mul_f32 v[190:191], v[190:191], v[198:199]
v_pk_mul_f32 v[192:193], v[192:193], v[236:237]
s_mov_b32 exec_hi, 0xff
v_cvt_pk_bf16_f32 v238, v192, v190
v_cvt_pk_bf16_f32 v239, v62, v60
ds_write_b64 v202, v[238:239] offset:0
v_cvt_pk_bf16_f32 v240, v193, v191
v_cvt_pk_bf16_f32 v241, v63, v61
ds_write_b64 v202, v[240:241] offset:144
s_mov_b64 exec, -1
v_lshlrev_b32 v194, 16, v9
v_and_b32 v195, 0xffff0000, v9
v_lshlrev_b32 v196, 16, v13
v_and_b32 v197, 0xffff0000, v13
v_lshlrev_b32 v198, 16, v17
v_and_b32 v199, 0xffff0000, v17
v_lshlrev_b32 v236, 16, v21
v_and_b32 v237, 0xffff0000, v21
v_lshlrev_b32 v238, 16, v25
v_and_b32 v239, 0xffff0000, v25
v_lshlrev_b32 v240, 16, v29
v_and_b32 v241, 0xffff0000, v29
v_lshlrev_b32 v242, 16, v33
v_and_b32 v243, 0xffff0000, v33
v_lshlrev_b32 v52, 16, v40
v_lshlrev_b32 v53, 16, v42
v_and_b32 v54, 0xffff0000, v40
v_and_b32 v55, 0xffff0000, v42
v_lshlrev_b32 v56, 16, v41
v_lshlrev_b32 v57, 16, v43
v_and_b32 v58, 0xffff0000, v41
v_and_b32 v59, 0xffff0000, v43
v_pk_mul_f32 v[60:61], v[236:237], v[52:53]
v_pk_mul_f32 v[62:63], v[238:239], v[52:53]
v_pk_mul_f32 v[190:191], v[240:241], v[52:53]
v_pk_mul_f32 v[192:193], v[242:243], v[52:53]
v_pk_fma_f32 v[60:61], v[198:199], v[54:55], v[60:61]
v_pk_fma_f32 v[62:63], v[236:237], v[54:55], v[62:63]
v_pk_fma_f32 v[190:191], v[238:239], v[54:55], v[190:191]
v_pk_fma_f32 v[192:193], v[240:241], v[54:55], v[192:193]
v_pk_fma_f32 v[60:61], v[196:197], v[56:57], v[60:61]
v_pk_fma_f32 v[62:63], v[198:199], v[56:57], v[62:63]
v_pk_fma_f32 v[190:191], v[236:237], v[56:57], v[190:191]
v_pk_fma_f32 v[192:193], v[238:239], v[56:57], v[192:193]
v_pk_fma_f32 v[60:61], v[194:195], v[58:59], v[60:61]
v_pk_fma_f32 v[62:63], v[196:197], v[58:59], v[62:63]
v_pk_fma_f32 v[190:191], v[198:199], v[58:59], v[190:191]
v_pk_fma_f32 v[192:193], v[236:237], v[58:59], v[192:193]
v_lshlrev_b32 v194, 16, v175
v_and_b32 v195, 0xffff0000, v175
v_lshlrev_b32 v196, 16, v179
v_and_b32 v197, 0xffff0000, v179
v_lshlrev_b32 v198, 16, v183
v_and_b32 v199, 0xffff0000, v183
v_lshlrev_b32 v236, 16, v187
v_and_b32 v237, 0xffff0000, v187
v_pk_mul_f32 v[60:61], v[60:61], v[194:195]
v_pk_mul_f32 v[62:63], v[62:63], v[196:197]
v_pk_mul_f32 v[190:191], v[190:191], v[198:199]
v_pk_mul_f32 v[192:193], v[192:193], v[236:237]
s_mov_b32 exec_hi, 0xff
v_cvt_pk_bf16_f32 v238, v192, v190
v_cvt_pk_bf16_f32 v239, v62, v60
ds_write_b64 v202, v[238:239] offset:288
v_cvt_pk_bf16_f32 v240, v193, v191
v_cvt_pk_bf16_f32 v241, v63, v61
ds_write_b64 v202, v[240:241] offset:432
s_mov_b64 exec, -1
v_lshlrev_b32 v194, 16, v10
v_and_b32 v195, 0xffff0000, v10
v_lshlrev_b32 v196, 16, v14
v_and_b32 v197, 0xffff0000, v14
v_lshlrev_b32 v198, 16, v18
v_and_b32 v199, 0xffff0000, v18
v_lshlrev_b32 v236, 16, v22
v_and_b32 v237, 0xffff0000, v22
v_lshlrev_b32 v238, 16, v26
v_and_b32 v239, 0xffff0000, v26
v_lshlrev_b32 v240, 16, v30
v_and_b32 v241, 0xffff0000, v30
v_lshlrev_b32 v242, 16, v34
v_and_b32 v243, 0xffff0000, v34
v_lshlrev_b32 v52, 16, v44
v_lshlrev_b32 v53, 16, v46
v_and_b32 v54, 0xffff0000, v44
v_and_b32 v55, 0xffff0000, v46
v_lshlrev_b32 v56, 16, v45
v_lshlrev_b32 v57, 16, v47
v_and_b32 v58, 0xffff0000, v45
v_and_b32 v59, 0xffff0000, v47
v_pk_mul_f32 v[60:61], v[236:237], v[52:53]
v_pk_mul_f32 v[62:63], v[238:239], v[52:53]
v_pk_mul_f32 v[190:191], v[240:241], v[52:53]
v_pk_mul_f32 v[192:193], v[242:243], v[52:53]
v_pk_fma_f32 v[60:61], v[198:199], v[54:55], v[60:61]
v_pk_fma_f32 v[62:63], v[236:237], v[54:55], v[62:63]
v_pk_fma_f32 v[190:191], v[238:239], v[54:55], v[190:191]
v_pk_fma_f32 v[192:193], v[240:241], v[54:55], v[192:193]
v_pk_fma_f32 v[60:61], v[196:197], v[56:57], v[60:61]
v_pk_fma_f32 v[62:63], v[198:199], v[56:57], v[62:63]
v_pk_fma_f32 v[190:191], v[236:237], v[56:57], v[190:191]
v_pk_fma_f32 v[192:193], v[238:239], v[56:57], v[192:193]
v_pk_fma_f32 v[60:61], v[194:195], v[58:59], v[60:61]
v_pk_fma_f32 v[62:63], v[196:197], v[58:59], v[62:63]
v_pk_fma_f32 v[190:191], v[198:199], v[58:59], v[190:191]
v_pk_fma_f32 v[192:193], v[236:237], v[58:59], v[192:193]
v_lshlrev_b32 v194, 16, v176
v_and_b32 v195, 0xffff0000, v176
v_lshlrev_b32 v196, 16, v180
v_and_b32 v197, 0xffff0000, v180
v_lshlrev_b32 v198, 16, v184
v_and_b32 v199, 0xffff0000, v184
v_lshlrev_b32 v236, 16, v188
v_and_b32 v237, 0xffff0000, v188
v_pk_mul_f32 v[60:61], v[60:61], v[194:195]
v_pk_mul_f32 v[62:63], v[62:63], v[196:197]
v_pk_mul_f32 v[190:191], v[190:191], v[198:199]
v_pk_mul_f32 v[192:193], v[192:193], v[236:237]
s_mov_b32 exec_hi, 0xff
v_cvt_pk_bf16_f32 v238, v192, v190
v_cvt_pk_bf16_f32 v239, v62, v60
ds_write_b64 v202, v[238:239] offset:576
v_cvt_pk_bf16_f32 v240, v193, v191
v_cvt_pk_bf16_f32 v241, v63, v61
ds_write_b64 v202, v[240:241] offset:720
s_mov_b64 exec, -1
v_lshlrev_b32 v194, 16, v11
v_and_b32 v195, 0xffff0000, v11
v_lshlrev_b32 v196, 16, v15
v_and_b32 v197, 0xffff0000, v15
v_lshlrev_b32 v198, 16, v19
v_and_b32 v199, 0xffff0000, v19
v_lshlrev_b32 v236, 16, v23
v_and_b32 v237, 0xffff0000, v23
v_lshlrev_b32 v238, 16, v27
v_and_b32 v239, 0xffff0000, v27
v_lshlrev_b32 v240, 16, v31
v_and_b32 v241, 0xffff0000, v31
v_lshlrev_b32 v242, 16, v35
v_and_b32 v243, 0xffff0000, v35
v_lshlrev_b32 v52, 16, v48
v_lshlrev_b32 v53, 16, v50
v_and_b32 v54, 0xffff0000, v48
v_and_b32 v55, 0xffff0000, v50
v_lshlrev_b32 v56, 16, v49
v_lshlrev_b32 v57, 16, v51
v_and_b32 v58, 0xffff0000, v49
v_and_b32 v59, 0xffff0000, v51
v_pk_mul_f32 v[60:61], v[236:237], v[52:53]
v_pk_mul_f32 v[62:63], v[238:239], v[52:53]
v_pk_mul_f32 v[190:191], v[240:241], v[52:53]
v_pk_mul_f32 v[192:193], v[242:243], v[52:53]
v_pk_fma_f32 v[60:61], v[198:199], v[54:55], v[60:61]
v_pk_fma_f32 v[62:63], v[236:237], v[54:55], v[62:63]
v_pk_fma_f32 v[190:191], v[238:239], v[54:55], v[190:191]
v_pk_fma_f32 v[192:193], v[240:241], v[54:55], v[192:193]
v_pk_fma_f32 v[60:61], v[196:197], v[56:57], v[60:61]
v_pk_fma_f32 v[62:63], v[198:199], v[56:57], v[62:63]
v_pk_fma_f32 v[190:191], v[236:237], v[56:57], v[190:191]
v_pk_fma_f32 v[192:193], v[238:239], v[56:57], v[192:193]
v_pk_fma_f32 v[60:61], v[194:195], v[58:59], v[60:61]
v_pk_fma_f32 v[62:63], v[196:197], v[58:59], v[62:63]
v_pk_fma_f32 v[190:191], v[198:199], v[58:59], v[190:191]
v_pk_fma_f32 v[192:193], v[236:237], v[58:59], v[192:193]
v_lshlrev_b32 v194, 16, v177
v_and_b32 v195, 0xffff0000, v177
v_lshlrev_b32 v196, 16, v181
v_and_b32 v197, 0xffff0000, v181
v_lshlrev_b32 v198, 16, v185
v_and_b32 v199, 0xffff0000, v185
v_lshlrev_b32 v236, 16, v189
v_and_b32 v237, 0xffff0000, v189
v_pk_mul_f32 v[60:61], v[60:61], v[194:195]
v_pk_mul_f32 v[62:63], v[62:63], v[196:197]
v_pk_mul_f32 v[190:191], v[190:191], v[198:199]
v_pk_mul_f32 v[192:193], v[192:193], v[236:237]
s_mov_b32 exec_hi, 0xff
v_cvt_pk_bf16_f32 v238, v192, v190
v_cvt_pk_bf16_f32 v239, v62, v60
ds_write_b64 v202, v[238:239] offset:864
v_cvt_pk_bf16_f32 v240, v193, v191
v_cvt_pk_bf16_f32 v241, v63, v61
ds_write_b64 v202, v[240:241] offset:1008
s_mov_b64 exec, -1
s_waitcnt lgkmcnt(0)
s_barrier
ds_read_b128 v[8:11], v203 offset:0
ds_read_b128 v[12:15], v203 offset:1152
ds_read_b128 v[16:19], v203 offset:2304
s_waitcnt lgkmcnt(0)
buffer_store_dwordx4 v[8:11], v172, s[24:27], s70 offen sc1
buffer_store_dwordx4 v[12:15], v172, s[24:27], s71 offen sc1
s_mov_b32 exec_hi, 0
buffer_store_dwordx4 v[16:19], v172, s[24:27], s72 offen sc1
s_mov_b64 exec, -1
buffer_load_dword v254, v229, s[24:27], 0 offen sc1
s_waitcnt vmcnt(1)
s_barrier
s_cmp_lg_u32 s5, 0
s_cbranch_scc1 L_fl_52
s_mov_b64 exec, 1
buffer_store_dword v253, v252, s[24:27], 0 offen offset:0 sc1
s_mov_b64 exec, -1
L_fl_52:
s_waitcnt vmcnt(0)
v_cmp_eq_u32 vcc, 0, v254
s_cbranch_vccnz L_slow_53
L_back_54:
v_mov_b32 v60, 2147418112
s_mov_b32 s100, 0
s_mov_b32 s101, 0
s_lshl_b32 s6, s5, 2
v_lshlrev_b32 v202, 2, v1
v_add_u32 v202, s6, v202
v_subrev_u32 v202, 252, v202
v_add_u32 v203, s6, v248
v_add_u32 v203, 4, v203
s_mul_i32 s90, s5, 4416
s_add_u32 s6, s88, 0
s_lshl_b32 s6, s6, 12
s_add_u32 s32, s48, s6
s_addc_u32 s33, s49, 0
s_and_b32 s33, s33, 0xffff
s_mov_b32 s34, 4096
s_mov_b32 s35, 0x20000
s_add_u32 m0, s90, 65536
s_nop 0
buffer_load_dword v202, s[32:35], 0 offen lds
s_add_u32 m0, s90, 65792
s_nop 0
buffer_load_dwordx4 v203, s[32:35], 0 offen offset:0 lds
buffer_load_dwordx4 v203, s[32:35], 0 offen offset:1024 lds
buffer_load_dwordx4 v203, s[32:35], 0 offen offset:2048 lds
buffer_load_dwordx4 v203, s[32:35], 0 offen offset:3072 lds
s_add_u32 s6, s88, 1
s_lshl_b32 s6, s6, 12
s_add_u32 s32, s48, s6
s_addc_u32 s33, s49, 0
s_and_b32 s33, s33, 0xffff
s_mov_b32 s34, 4096
s_mov_b32 s35, 0x20000
s_add_u32 m0, s90, 96768
s_nop 0
buffer_load_dword v202, s[32:35], 0 offen lds
s_add_u32 m0, s90, 97024
s_nop 0
buffer_load_dwordx4 v203, s[32:35], 0 offen offset:0 lds
buffer_load_dwordx4 v203, s[32:35], 0 offen offset:1024 lds
buffer_load_dwordx4 v203, s[32:35], 0 offen offset:2048 lds
buffer_load_dwordx4 v203, s[32:35], 0 offen offset:3072 lds
s_add_u32 s6, s88, 2
s_lshl_b32 s6, s6, 12
s_add_u32 s32, s48, s6
s_addc_u32 s33, s49, 0
s_and_b32 s33, s33, 0xffff
s_mov_b32 s34, 4096
s_mov_b32 s35, 0x20000
s_add_u32 m0, s90, 128000
s_nop 0
buffer_load_dword v202, s[32:35], 0 offen lds
s_add_u32 m0, s90, 128256
s_nop 0
buffer_load_dwordx4 v203, s[32:35], 0 offen offset:0 lds
buffer_load_dwordx4 v203, s[32:35], 0 offen offset:1024 lds
buffer_load_dwordx4 v203, s[32:35], 0 offen offset:2048 lds
buffer_load_dwordx4 v203, s[32:35], 0 offen offset:3072 lds
v_lshlrev_b32 v4, 4, v0
s_add_u32 s6, s88, 0
s_lshl_b32 s6, s6, 12
s_add_u32 s6, s6, 1048576
s_add_u32 s36, s66, s6
s_addc_u32 s37, s67, 0
s_and_b32 s37, s37, 0xffff
s_mov_b32 s38, 4096
s_mov_b32 s39, 0x20000
buffer_load_dwordx4 v[32:35], v4, s[36:39], 0 offen
buffer_load_dword v36, v4, s[36:39], 0 offen offset:16
s_add_u32 s6, s88, 1
s_lshl_b32 s6, s6, 12
s_add_u32 s6, s6, 1048576
s_add_u32 s36, s66, s6
s_addc_u32 s37, s67, 0
s_and_b32 s37, s37, 0xffff
s_mov_b32 s38, 4096
s_mov_b32 s39, 0x20000
buffer_load_dwordx4 v[38:41], v4, s[36:39], 0 offen
buffer_load_dword v42, v4, s[36:39], 0 offen offset:16
s_add_u32 s6, s88, 2
s_lshl_b32 s6, s6, 12
s_add_u32 s6, s6, 1048576
s_add_u32 s36, s66, s6
s_addc_u32 s37, s67, 0
s_and_b32 s37, s37, 0xffff
s_mov_b32 s38, 4096
s_mov_b32 s39, 0x20000
buffer_load_dwordx4 v[44:47], v4, s[36:39], 0 offen
buffer_load_dword v48, v4, s[36:39], 0 offen offset:16
buffer_load_dword v254, v228, s[24:27], 0 offen sc1
v_lshlrev_b32 v5, 4, v0
v_add_u32 v5, 87808, v5
v_add_u32 v7, 62464, v5
v_mov_b32 v12, 0
v_mov_b32 v13, 0
v_mov_b32 v14, 0
v_mov_b32 v15, 0
v_cmp_gt_u32 vcc, 126, v0
s_and_saveexec_b64 s[6:7], vcc
ds_write_b128 v5, v[12:15] offset:0
ds_write_b128 v5, v[12:15] offset:6784
ds_write_b128 v5, v[12:15] offset:31232
ds_write_b128 v5, v[12:15] offset:38016
ds_write_b128 v7, v[12:15] offset:0
ds_write_b128 v7, v[12:15] offset:6784
s_mov_b64 exec, s[6:7]
v_lshrrev_b32 v4, 4, v0
v_mul_u32_u24 v4, 288, v4
v_and_b32 v5, 15, v0
v_lshl_add_u32 v4, v5, 4, v4
v_add_u32 v4, 83200, v4
v_add_u32 v6, 62464, v4
s_waitcnt vmcnt(1)
ds_write_b128 v4, v[32:35] offset:6784
v_alignbit_b32 v12, v33, v32, 16
v_alignbit_b32 v13, v34, v33, 16
v_alignbit_b32 v14, v35, v34, 16
v_alignbit_b32 v15, v36, v35, 16
ds_write_b128 v4, v[12:15] offset:0
ds_write_b128 v4, v[38:41] offset:38016
v_alignbit_b32 v12, v39, v38, 16
v_alignbit_b32 v13, v40, v39, 16
v_alignbit_b32 v14, v41, v40, 16
v_alignbit_b32 v15, v42, v41, 16
ds_write_b128 v4, v[12:15] offset:31232
ds_write_b128 v6, v[44:47] offset:6784
v_alignbit_b32 v12, v45, v44, 16
v_alignbit_b32 v13, v46, v45, 16
v_alignbit_b32 v14, v47, v46, 16
v_alignbit_b32 v15, v48, v47, 16
ds_write_b128 v6, v[12:15] offset:0
s_waitcnt vmcnt(0)
v_cmp_eq_u32 vcc, 0, v254
s_cbranch_vccnz L_slow_55
L_back_56:
s_lshr_b32 s6, s4, 3
s_mul_i32 s6, s6, 14
s_and_b32 s7, s4, 7
s_mul_i32 s7, s7, 7
s_add_u32 s6, s6, s7
s_lshr_b32 s6, s6, 2
s_cmp_ge_u32 s5, 2
s_cselect_b32 s43, 13, 14
s_cmp_ge_u32 s6, s43
s_cselect_b32 s7, s43, 0
s_sub_u32 s93, s6, s7
s_mov_b32 s93, 0
s_mul_i32 s6, s95, 54
s_add_u32 s6, s6, s96
s_mul_i32 s79, s6, 5120
s_add_u32 s79, s79, 7340032
s_mul_i32 s7, s43, 5120
s_add_u32 s80, s79, s7
s_mul_i32 s7, s93, 5120
s_add_u32 s97, s79, s7
s_add_u32 s98, s97, 4096
buffer_load_dwordx4 a[0:3], v248, s[24:27], s97 offen offset:0
buffer_load_dwordx4 a[4:7], v248, s[24:27], s97 offen offset:1024
buffer_load_dwordx4 a[8:11], v248, s[24:27], s97 offen offset:2048
buffer_load_dwordx4 a[12:15], v248, s[24:27], s97 offen offset:3072
buffer_load_dwordx4 a[16:19], v248, s[24:27], s98 offen
s_add_u32 s97, s97, 5120
s_cmp_eq_u32 s97, s80
s_cselect_b32 s97, s79, s97
s_add_u32 s98, s97, 4096
buffer_load_dwordx4 a[20:23], v248, s[24:27], s97 offen offset:0
buffer_load_dwordx4 a[24:27], v248, s[24:27], s97 offen offset:1024
buffer_load_dwordx4 a[28:31], v248, s[24:27], s97 offen offset:2048
buffer_load_dwordx4 a[32:35], v248, s[24:27], s97 offen offset:3072
buffer_load_dwordx4 a[36:39], v248, s[24:27], s98 offen
s_add_u32 s97, s97, 5120
s_cmp_eq_u32 s97, s80
s_cselect_b32 s97, s79, s97
s_add_u32 s98, s97, 4096
buffer_load_dwordx4 a[40:43], v248, s[24:27], s97 offen offset:0
buffer_load_dwordx4 a[44:47], v248, s[24:27], s97 offen offset:1024
buffer_load_dwordx4 a[48:51], v248, s[24:27], s97 offen offset:2048
buffer_load_dwordx4 a[52:55], v248, s[24:27], s97 offen offset:3072
buffer_load_dwordx4 a[56:59], v248, s[24:27], s98 offen
s_add_u32 s97, s97, 5120
s_cmp_eq_u32 s97, s80
s_cselect_b32 s97, s79, s97
s_add_u32 s98, s97, 4096
buffer_load_dwordx4 a[60:63], v248, s[24:27], s97 offen offset:0
buffer_load_dwordx4 a[64:67], v248, s[24:27], s97 offen offset:1024
buffer_load_dwordx4 a[68:71], v248, s[24:27], s97 offen offset:2048
buffer_load_dwordx4 a[72:75], v248, s[24:27], s97 offen offset:3072
buffer_load_dwordx4 a[76:79], v248, s[24:27], s98 offen
s_add_u32 s97, s97, 5120
s_cmp_eq_u32 s97, s80
s_cselect_b32 s97, s79, s97
s_add_u32 s98, s97, 4096
s_lshl_b32 s6, s89, 2
s_add_u32 s6, s6, s5
s_lshl_b32 s7, s6, 1
s_lshr_b32 s85, 6436, s7
s_and_b32 s85, s85, 3
s_lshr_b32 s86, 55, s6
s_and_b32 s86, s86, 1
s_lshr_b32 s87, 61311, s7
s_and_b32 s87, s87, 3
v_and_b32 v2, 3, v1
v_mul_u32_u24 v2, 4416, v2
v_bfe_u32 v3, v1, 2, 2
v_lshrrev_b32 v18, 4, v1
v_add_u32 v3, v3, v18
v_lshl_add_u32 v16, v3, 4, v2
v_and_b32 v2, 1, v1
v_mul_u32_u24 v2, 6784, v2
v_bfe_u32 v3, v1, 1, 3
s_lshl_b32 s6, s86, 3
s_sub_u32 s6, 15, s6
v_sub_u32 v5, s6, v3
v_mul_u32_u24 v5, 288, v5
v_add_u32 v2, v2, v5
v_lshl_add_u32 v17, v18, 4, v2
s_lshl_b32 s6, s86, 3
v_add_u32 v3, s6, v3
v_lshlrev_b32 v3, 8, v3
v_and_b32 v2, 1, v1
v_lshl_or_b32 v2, v18, 1, v2
v_lshl_or_b32 v11, v2, 4, v3
s_mul_i32 s6, s85, 31232
s_add_u32 s6, s6, 65536
v_add_u32 v8, s6, v16
s_add_u32 s6, s6, 17664
v_add_u32 v9, s6, v17
v_lshlrev_b32 v10, 5, v18
v_sub_u32 v10, v9, v10
v_add_u32 v10, 0, v10
s_add_u32 s91, s88, s85
s_and_b32 s46, s88, 0xfffffffe
s_sub_u32 s46, s91, s46
s_cmp_ge_u32 s46, 2
s_cselect_b32 s47, s1, s0
s_and_b32 s46, s46, 1
s_lshl_b32 s46, s46, 4
s_lshr_b32 s47, s47, s46
s_and_b32 s47, s47, 0xffff
v_mov_b32 v61, s47
v_and_b32 v19, 15, v1
v_lshl_add_u32 v19, v18, 2, v19
v_sub_u32 v19, 15, v19
v_cmp_eq_u32 vcc, 0, v19
v_cndmask_b32 v192, 0, v61, vcc
v_cmp_eq_u32 vcc, 1, v19
v_cndmask_b32 v193, 0, v61, vcc
v_cmp_eq_u32 vcc, 2, v19
v_cndmask_b32 v194, 0, v61, vcc
v_cmp_eq_u32 vcc, 3, v19
v_cndmask_b32 v195, 0, v61, vcc
s_lshl_b32 s92, s91, 12
s_add_u32 s92, s92, 4194304
s_branch L_conv
L_slow_11:
s_add_u32 s42, s42, 1
s_cmp_gt_u32 s42, 200000
s_cbranch_scc1 L_back_12
buffer_load_dword v254, v230, s[52:55], 0 offen sc1
s_waitcnt vmcnt(0)
v_cmp_gt_u32 vcc, 32, v254
s_cbranch_vccnz L_slow_11
s_branch L_back_12
L_slow_20:
s_add_u32 s42, s42, 1
s_cmp_gt_u32 s42, 200000
s_cbranch_scc1 L_back_21
buffer_load_dword v254, v231, s[24:27], 0 offen sc1
s_waitcnt vmcnt(0)
v_cmp_eq_u32 vcc, 0, v254
s_cbranch_vccnz L_slow_20
s_branch L_back_21
L_slow_27:
s_add_u32 s42, s42, 1
s_cmp_gt_u32 s42, 200000
s_cbranch_scc1 L_back_28
buffer_load_dword v251, v229, s[24:27], 0 offen sc1
s_waitcnt vmcnt(0)
v_cmp_eq_u32 vcc, 0, v251
s_cbranch_vccnz L_slow_27
s_branch L_back_28
L_slow_29:
s_add_u32 s42, s42, 1
s_cmp_gt_u32 s42, 200000
s_cbranch_scc1 L_back_30
buffer_load_dword v254, v228, s[24:27], 0 offen sc1
s_waitcnt vmcnt(0)
v_cmp_eq_u32 vcc, 0, v254
s_cbranch_vccnz L_slow_29
s_branch L_back_30
L_slow_37:
s_add_u32 s42, s42, 1
s_cmp_gt_u32 s42, 200000
s_cbranch_scc1 L_back_38
buffer_load_dword v254, v249, s[24:27], 0 offen sc1
s_waitcnt vmcnt(0)
v_cmp_eq_u32 vcc, 0, v254
s_cbranch_vccnz L_slow_37
s_branch L_back_38
L_slow_44:
s_add_u32 s42, s42, 1
s_cmp_gt_u32 s42, 200000
s_cbranch_scc1 L_back_45
buffer_load_dword v254, v250, s[24:27], 0 offen sc1
s_waitcnt vmcnt(0)
v_cmp_eq_u32 vcc, 0, v254
s_cbranch_vccnz L_slow_44
s_branch L_back_45
L_slow_50:
s_add_u32 s42, s42, 1
s_cmp_gt_u32 s42, 200000
s_cbranch_scc1 L_back_51
buffer_load_dword v254, v230, s[52:55], 0 offen sc1
s_waitcnt vmcnt(0)
v_cmp_gt_u32 vcc, 32, v254
s_cbranch_vccnz L_slow_50
s_branch L_back_51
L_slow_53:
s_add_u32 s42, s42, 1
s_cmp_gt_u32 s42, 200000
s_cbranch_scc1 L_back_54
buffer_load_dword v254, v229, s[24:27], 0 offen sc1
s_waitcnt vmcnt(0)
v_cmp_eq_u32 vcc, 0, v254
s_cbranch_vccnz L_slow_53
s_branch L_back_54
L_slow_55:
s_add_u32 s42, s42, 1
s_cmp_gt_u32 s42, 200000
s_cbranch_scc1 L_back_56
buffer_load_dword v254, v228, s[24:27], 0 offen sc1
s_waitcnt vmcnt(0)
v_cmp_eq_u32 vcc, 0, v254
s_cbranch_vccnz L_slow_55
s_branch L_back_56
L_code_end:
.section .rodata,"a"
.p2align 6
.amdhsa_kernel recurrent_scan__ssm_conv_h3__dense_activation_gelu__prompt_kernel
  .amdhsa_next_free_vgpr 512
  .amdhsa_next_free_sgpr 102
  .amdhsa_accum_offset 256
  .amdhsa_group_segment_fixed_size 0
  .amdhsa_kernarg_size 112
  .amdhsa_user_sgpr_count 2
  .amdhsa_user_sgpr_kernarg_segment_ptr 1
  .amdhsa_system_sgpr_workgroup_id_x 1
.end_amdhsa_kernel
```

```asm
; @launch grid=(256,1,1) block=(256,1,1) lds=163840
.amdgcn_target "amdgcn-amd-amdhsa--gfx950"
.text
.globl recurrent_scan__ssm_conv_h3__dense_activation_gelu__prompt_kernel
.p2align 8
.type recurrent_scan__ssm_conv_h3__dense_activation_gelu__prompt_kernel,@function
recurrent_scan__ssm_conv_h3__dense_activation_gelu__prompt_kernel:
s_cmp_ge_u32 s2, 256
s_cbranch_scc1 L_end
s_load_dwordx16 s[40:55], s[0:1], 0
s_load_dwordx8 s[56:63], s[0:1], 64
s_load_dwordx4 s[64:67], s[0:1], 96
s_and_b32 s3, s2, 7
s_lshr_b32 s4, s2, 3
v_lshrrev_b32 v1, 6, v0
v_and_b32 v0, 0xff, v0
v_mov_b32 v253, 1
v_readfirstlane_b32 s5, v1
v_and_b32 v1, 63, v0
s_lshl_b32 s6, s2, 7
v_mov_b32 v252, s6
v_lshlrev_b32 v248, 4, v1
v_and_b32 v230, 7, v1
v_lshlrev_b32 v230, 5, v230
v_mov_b32 v255, 0
s_cmp_ge_u32 s4, 28
s_cbranch_scc1 L_spare
s_and_b32 s6, s3, 3
s_lshl_b32 s6, s6, 2
s_and_b32 s7, s4, 3
s_add_u32 s77, s6, s7
s_lshr_b32 s6, s3, 2
s_mul_i32 s6, s6, 7
s_lshr_b32 s7, s4, 2
s_add_u32 s78, s6, s7
s_and_b32 s82, s5, 1
s_lshr_b32 s83, s5, 1
s_lshl_b32 s6, s3, 4
s_lshr_b32 s7, s4, 1
s_add_u32 s6, s6, s7
s_mul_i32 s6, s6, 5
s_and_b32 s89, s4, 1
s_lshl_b32 s7, s89, 1
s_add_u32 s88, s6, s7
s_and_b32 s6, s3, 3
s_lshl_b32 s6, s6, 3
s_and_b32 s7, s4, 7
s_add_u32 s94, s6, s7
s_lshr_b32 s6, s3, 2
s_xor_b32 s6, s6, 1
s_lshl_b32 s6, s6, 2
s_lshr_b32 s7, s4, 3
s_add_u32 s95, s6, s7
s_mul_i32 s96, s5, 14
s_cmp_eq_u32 s5, 3
s_cselect_b32 s6, 1, 0
s_sub_u32 s96, s96, s6
s_lshr_b32 s6, s4, 3
s_lshl_b32 s7, s3, 2
s_add_u32 s68, s6, s7
s_and_b32 s69, s4, 7
v_mul_u32_u24 v2, 26, v1
v_lshrrev_b32 v2, 8, v2
v_mul_u32_u24 v3, 10, v2
v_sub_u32 v3, v1, v3
s_lshl_b32 s6, s68, 6
s_lshl_b32 s7, s5, 4
s_add_u32 s6, s6, s7
s_mul_i32 s6, s6, 1280
s_mul_i32 s7, s69, 160
s_add_u32 s6, s6, s7
v_mul_u32_u24 v4, 5120, v2
v_lshl_add_u32 v4, v3, 4, v4
v_add_u32 v244, s6, v4
v_subrev_u32 v245, 3840, v244
s_mul_i32 s92, s69, 640
s_mul_i32 s7, s5, 2560
s_add_u32 s7, s7, 142592
s_mov_b32 m0, s7
v_lshl_add_u32 v247, v3, 6, s7
s_lshl_b32 s7, s5, 5
s_sub_u32 s7, 131192, s7
v_mul_u32_u24 v4, 1152, v3
v_lshlrev_b32 v2, 3, v2
v_sub_u32 v4, v4, v2
v_add_u32 v202, s7, v4
v_lshrrev_b32 v2, 3, v1
s_mul_i32 s6, s5, 20
v_add_u32 v2, s6, v2
v_and_b32 v3, 7, v1
v_lshlrev_b32 v3, 4, v3
v_mul_u32_u24 v4, 144, v2
v_add_u32 v4, v4, v3
v_add_u32 v203, 131072, v4
v_lshl_add_u32 v172, v2, 12, v3
s_mul_i32 s6, s69, 327680
s_lshl_b32 s7, s68, 7
s_sub_u32 s6, s6, s7
s_add_u32 s70, s6, 1052544
s_add_u32 s71, s70, 32768
s_add_u32 s72, s70, 65536
s_lshl_b32 s79, s78, 8
s_mul_i32 s80, s77, 163840
s_lshl_b32 s81, s5, 12
v_lshrrev_b32 v2, 4, v1
v_and_b32 v3, 15, v1
v_lshlrev_b32 v4, 2, v2
v_xor_b32 v4, v3, v4
s_lshl_b32 s6, s5, 4
v_add_u32 v5, s6, v2
v_mul_u32_u24 v5, 3456, v5
v_lshl_add_u32 v208, v4, 4, v5
s_cmp_eq_u32 s78, 13
s_cselect_b32 s7, 8, 16
v_cmp_le_u32 vcc, s7, v4
v_mov_b32 v6, 2147418112
v_cndmask_b32 v208, v208, v6, vcc
v_add_u32 v209, 12800, v208
v_add_u32 v210, 25600, v208
v_add_u32 v211, 38400, v208
v_lshrrev_b32 v4, 3, v1
v_and_b32 v5, 7, v1
s_lshl_b32 s6, s5, 5
v_add_u32 v4, s6, v4
v_mul_u32_u24 v4, 1280, v4
v_add_u32 v6, 0, v2
v_xor_b32 v6, v5, v6
v_lshl_add_u32 v6, v6, 4, v4
v_add_u32 v212, 0, v6
v_add_u32 v6, 4, v2
v_xor_b32 v6, v5, v6
v_lshl_add_u32 v6, v6, 4, v4
v_add_u32 v213, 9216, v6
v_add_u32 v6, 0, v2
v_xor_b32 v6, v5, v6
v_lshl_add_u32 v6, v6, 4, v4
v_add_u32 v214, 18432, v6
v_add_u32 v6, 4, v2
v_xor_b32 v6, v5, v6
v_lshl_add_u32 v6, v6, 4, v4
v_add_u32 v215, 27648, v6
s_lshl_b32 s6, s4, 2
s_add_u32 s6, s6, s5
s_lshl_b32 s7, s6, 3
v_and_b32 v2, 7, v1
v_add_u32 v2, s7, v2
v_lshrrev_b32 v3, 3, v1
v_mul_u32_u24 v4, 4682, v2
v_lshrrev_b32 v4, 16, v4
v_mul_u32_u24 v5, 14, v4
v_sub_u32 v5, v2, v5
v_lshl_add_u32 v4, v3, 6, v4
v_mul_u32_u24 v4, 3456, v4
v_lshl_add_u32 v4, v5, 7, v4
s_lshr_b32 s7, s3, 2
s_mul_i32 s73, s7, 1792
v_add_u32 v4, s73, v4
s_sub_u32 s7, 13, s7
v_mov_b32 v6, 2147418112
v_cmp_lt_u32 vcc, s7, v5
v_cndmask_b32 v232, v4, v6, vcc
v_mul_u32_u24 v2, 52, v1
v_lshrrev_b32 v2, 8, v2
v_mul_u32_u24 v3, 5, v2
v_sub_u32 v3, v1, v3
s_mul_i32 s7, s6, 5
v_add_u32 v3, s7, v3
v_cmp_gt_u32 vcc, 512, v3
s_and_b32 s7, s3, 3
s_lshl_b32 s7, s7, 9
v_add_u32 v3, s7, v3
v_mul_u32_u24 v3, 1280, v3
v_lshl_add_u32 v3, v2, 7, v3
v_cndmask_b32 v233, v6, v3, vcc
s_lshl_b32 s6, s68, 6
s_lshl_b32 s7, s5, 4
s_add_u32 s6, s6, s7
s_mul_i32 s6, s6, 1280
s_mul_i32 s7, s69, 160
s_and_b32 s7, s7, 0xffffff80
s_add_u32 s6, s6, s7
v_lshrrev_b32 v2, 1, v1
v_mul_u32_u24 v2, 1280, v2
v_and_b32 v3, 1, v1
v_lshl_add_u32 v2, v3, 7, v2
v_add_u32 v129, s6, v2
v_subrev_u32 v128, 3840, v129
s_mul_i32 s7, s69, 640
v_lshlrev_b32 v2, 7, v1
v_add_u32 v130, s7, v2
s_waitcnt lgkmcnt(0)
s_mov_b32 s24, s66
s_and_b32 s25, s67, 0xffff
s_mov_b32 s26, 17825792
s_mov_b32 s27, 0x20000
s_lshl_b32 s6, s88, 1
s_and_b32 s6, s6, 0xfffffffc
s_load_dwordx2 s[0:1], s[50:51], s6
s_cmp_lg_u32 s5, 0
s_cbranch_scc1 L_clr_1
v_lshl_add_u32 v2, v1, 2, v252
v_mov_b32 v3, 0
s_mov_b64 exec, 0xff
buffer_store_dword v3, v2, s[24:27], 0 offen sc1
s_mov_b64 exec, -1
L_clr_1:
s_mov_b32 s12, s42
s_and_b32 s13, s43, 0xffff
s_mov_b32 s14, 2621440
s_mov_b32 s15, 0x20000
s_mov_b32 s16, s44
s_and_b32 s17, s45, 0xffff
s_mov_b32 s18, 2621440
s_mov_b32 s19, 0x20000
s_mov_b32 s32, s46
s_and_b32 s33, s47, 0xffff
s_mov_b32 s34, 5120
s_mov_b32 s35, 0x20000
s_mov_b32 exec_hi, 0xff
buffer_load_dwordx4 v[8:11], v245, s[12:15], 0 offen offset:0
buffer_load_dwordx4 v[12:15], v245, s[12:15], 0 offen offset:1280
buffer_load_dwordx4 v[16:19], v245, s[12:15], 0 offen offset:2560
buffer_load_dwordx4 v[20:23], v244, s[12:15], 0 offen offset:0
buffer_load_dwordx4 v[24:27], v244, s[12:15], 0 offen offset:1280
buffer_load_dwordx4 v[28:31], v244, s[12:15], 0 offen offset:2560
buffer_load_dwordx4 v[32:35], v244, s[12:15], 0 offen offset:3840
buffer_load_dwordx4 v248, s[32:35], s92 offen lds
buffer_load_dwordx4 v[174:177], v244, s[16:19], 0 offen offset:0
buffer_load_dwordx4 v[178:181], v244, s[16:19], 0 offen offset:1280
buffer_load_dwordx4 v[182:185], v244, s[16:19], 0 offen offset:2560
buffer_load_dwordx4 v[186:189], v244, s[16:19], 0 offen offset:3840
s_mov_b64 exec, -1
s_mov_b32 s20, s54
s_and_b32 s21, s55, 0xffff
s_mov_b32 s22, 2211840
s_mov_b32 s23, 0x20000
s_mov_b32 s8, s40
s_and_b32 s9, s41, 0xffff
s_mov_b32 s10, 2621440
s_mov_b32 s11, 0x20000
s_mov_b32 s28, s62
s_and_b32 s29, s63, 0xffff
s_mov_b32 s30, 2621440
s_mov_b32 s31, 0x20000
s_mov_b32 s52, s64
s_and_b32 s53, s65, 0xffff
s_mov_b32 s54, 256
s_mov_b32 s55, 0x20000
s_mov_b32 s42, 0
s_mov_b32 s36, s58
s_and_b32 s37, s59, 0xffff
s_mov_b32 s38, 2211840
s_mov_b32 s39, 0x20000
s_lshr_b32 s6, s2, 2
s_lshl_b32 s6, s6, 5
s_lshl_b32 s7, s5, 3
s_add_u32 s6, s6, s7
s_mul_i32 s6, s6, 1280
s_and_b32 s7, s2, 3
s_mul_i32 s7, s7, 320
s_add_u32 s6, s6, s7
s_cmp_lt_u32 s2, 216
s_cselect_b32 s6, s6, 2147418112
v_add_u32 v2, 0, v1
v_mul_u32_u24 v3, 205, v2
v_lshrrev_b32 v3, 12, v3
v_mul_u32_u24 v4, 20, v3
v_sub_u32 v2, v2, v4
v_mul_u32_u24 v3, 1280, v3
v_lshl_add_u32 v2, v2, 4, v3
v_add_u32 v2, s6, v2
v_subrev_u32 v204, 0, v2
v_add_u32 v2, 64, v1
v_mul_u32_u24 v3, 205, v2
v_lshrrev_b32 v3, 12, v3
v_mul_u32_u24 v4, 20, v3
v_sub_u32 v2, v2, v4
v_mul_u32_u24 v3, 1280, v3
v_lshl_add_u32 v2, v2, 4, v3
v_add_u32 v2, s6, v2
v_subrev_u32 v205, 1024, v2
v_add_u32 v2, 128, v1
v_mul_u32_u24 v3, 205, v2
v_lshrrev_b32 v3, 12, v3
v_mul_u32_u24 v4, 20, v3
v_sub_u32 v2, v2, v4
v_mul_u32_u24 v3, 1280, v3
v_lshl_add_u32 v2, v2, 4, v3
v_add_u32 v2, s6, v2
v_subrev_u32 v206, 2048, v2
s_mul_i32 s6, s5, 2560
s_add_u32 s74, s6, 142592
v_lshrrev_b32 v2, 4, v1
v_bfe_u32 v3, v1, 2, 2
v_lshrrev_b32 v4, 1, v2
v_lshlrev_b32 v4, 4, v4
v_and_b32 v2, 1, v2
v_lshl_add_u32 v2, v2, 2, v3
v_add_u32 v2, v2, v4
v_mul_u32_u24 v2, 320, v2
v_and_b32 v3, 3, v1
v_mul_u32_u24 v3, 40, v3
v_add_u32 v2, v2, v3
v_add_u32 v5, 142592, v2
s_and_b32 s6, s2, 3
s_lshl_b32 s6, s6, 1
s_mul_i32 s6, s6, 54
s_lshr_b32 s7, s2, 2
s_add_u32 s6, s6, s7
s_mul_i32 s84, s6, 5120
s_add_u32 s84, s84, 7340032
v_mov_b32 v207, 2147418112
s_cmp_lt_u32 s2, 216
s_cselect_b64 vcc, -1, 0
v_cndmask_b32 v207, v207, v248, vcc
s_add_u32 s6, s5, 0
s_cmp_ge_u32 s6, 5
s_cselect_b32 s7, 5, 0
s_cselect_b32 s43, 276480, 0
s_cselect_b32 s75, 160, 0
s_sub_u32 s6, s6, s7
s_lshl_b32 s7, s6, 3
s_add_u32 s75, s75, s7
v_add_u32 v200, s75, v5
s_lshl_b32 s6, s6, 10
s_add_u32 s6, s6, s43
s_add_u32 s75, s6, s84
s_add_u32 s6, s5, 4
s_cmp_ge_u32 s6, 5
s_cselect_b32 s7, 5, 0
s_cselect_b32 s43, 276480, 0
s_cselect_b32 s76, 160, 0
s_sub_u32 s6, s6, s7
s_lshl_b32 s7, s6, 3
s_add_u32 s76, s76, s7
v_add_u32 v201, s76, v5
s_lshl_b32 s6, s6, 10
s_add_u32 s6, s6, s43
s_add_u32 s76, s6, s84
s_add_u32 s6, s5, 8
s_cmp_ge_u32 s6, 5
s_cselect_b32 s7, 5, 0
s_cselect_b32 s43, 276480, 0
s_cselect_b32 s93, 160, 0
s_sub_u32 s6, s6, s7
s_lshl_b32 s7, s6, 3
s_add_u32 s93, s93, s7
v_add_u32 v246, s93, v5
s_lshl_b32 s6, s6, 10
s_add_u32 s6, s6, s43
s_add_u32 s93, s6, s84
s_cmp_ge_u32 s5, 2
s_cselect_b64 vcc, -1, 0
v_mov_b32 v3, 2147418112
v_cndmask_b32 v173, v207, v3, vcc
s_mov_b32 exec_lo, 0xffffff
s_mov_b32 exec_hi, 0x0
buffer_load_dword v234, v232, s[20:23], 0 offen
s_mov_b64 exec, -1
s_mov_b32 exec_lo, 0x7fff
s_mov_b32 exec_hi, 0x0
buffer_load_dword v234, v233, s[8:11], 0 offen
s_mov_b64 exec, -1
v_lshrrev_b32 v2, 4, v1
v_bfe_u32 v4, v1, 2, 2
v_and_b32 v5, 3, v1
v_lshrrev_b32 v6, 5, v1
v_lshl_add_u32 v6, v6, 3, v4
v_lshlrev_b32 v6, 8, v6
s_lshl_b32 s6, s82, 1
v_xor_b32 v4, s6, v4
v_lshlrev_b32 v4, 2, v4
v_and_b32 v3, 1, v2
v_lshl_or_b32 v4, v3, 1, v4
v_lshrrev_b32 v3, 1, v5
v_or_b32 v4, v4, v3
v_lshl_add_u32 v6, v4, 4, v6
v_and_b32 v5, 1, v5
v_lshl_add_u32 v216, v5, 3, v6
v_xor_b32 v217, 64, v216
v_add_u32 v218, 0x10000, v216
v_add_u32 v219, 0x10000, v217
v_and_b32 v4, 31, v1
v_bfe_u32 v5, v1, 1, 3
v_lshrrev_b32 v6, 5, v1
v_xor_b32 v5, v5, v6
s_lshl_b32 s6, s83, 6
v_add_u32 v4, s6, v4
v_lshlrev_b32 v4, 7, v4
v_lshl_add_u32 v220, v5, 4, v4
v_xor_b32 v221, 32, v220
v_xor_b32 v222, 64, v220
v_xor_b32 v223, 96, v220
v_add_u32 v224, 0x10000, v220
v_add_u32 v225, 0x10000, v221
v_add_u32 v226, 0x10000, v222
v_add_u32 v227, 0x10000, v223
v_and_b32 v2, 15, v1
v_min_u32 v2, 13, v2
v_add_u32 v2, s96, v2
v_min_u32 v2, 53, v2
v_lshlrev_b32 v2, 2, v2
s_lshr_b32 s43, s95, 1
v_add_u32 v2, s43, v2
v_lshlrev_b32 v2, 7, v2
v_add_u32 v228, 12, v2
s_lshl_b32 s6, s77, 1
v_and_b32 v4, 1, v1
v_add_u32 v4, s6, v4
v_and_b32 v5, 3, v4
v_add_u32 v5, 28, v5
s_lshr_b32 s6, s77, 2
s_and_b32 s7, s77, 2
s_lshl_b32 s7, s7, 1
s_add_u32 s6, s6, s7
v_mov_b32 v4, s6
v_lshl_add_u32 v4, v5, 3, v4
v_lshlrev_b32 v4, 7, v4
v_add_u32 v231, 4, v4
v_and_b32 v2, 31, v1
v_and_b32 v3, 7, v2
v_lshrrev_b32 v2, 3, v2
v_lshlrev_b32 v2, 3, v2
v_add_u32 v2, s3, v2
v_lshl_add_u32 v2, v2, 3, v3
v_lshlrev_b32 v229, 7, v2
v_cmp_gt_u32 vcc, 14, v1
v_cndmask_b32 v2, 0, v1, vcc
v_cmp_lt_u32 vcc, 6, v2
v_cndmask_b32 v3, 0, 1, vcc
v_mul_u32_u24 v4, 7, v3
v_sub_u32 v2, v2, v4
s_lshr_b32 s6, s94, 1
s_and_b32 s7, s6, 3
s_lshr_b32 s6, s6, 2
v_lshlrev_b32 v3, 2, v3
v_lshlrev_b32 v2, 2, v2
v_add_u32 v2, s7, v2
v_add_u32 v3, s6, v3
v_lshl_add_u32 v2, v2, 3, v3
v_lshlrev_b32 v2, 7, v2
v_add_u32 v249, 16, v2
v_and_b32 v2, 31, v1
v_lshlrev_b32 v2, 3, v2
v_add_u32 v2, s95, v2
v_lshlrev_b32 v2, 7, v2
v_add_u32 v250, 20, v2
v_mov_b32 v2, 2147418112
s_cmp_lg_u32 s5, 0
s_cselect_b64 vcc, -1, 0
v_cndmask_b32 v231, v231, v2, vcc
v_cndmask_b32 v230, v230, v2, vcc
v_and_b32 v2, 15, v1
v_bfe_u32 v3, v1, 4, 1
v_lshlrev_b32 v3, 2, v3
v_cmp_eq_u32 vcc, v2, v3
v_mov_b32 v2, 0x3f803f80
v_cndmask_b32 v160, 0, v2, vcc
v_mov_b32 v161, v160
v_mov_b32 v162, v160
v_mov_b32 v163, v160
s_add_u32 m0, s81, 0
s_nop 0
buffer_load_dwordx4 v208, s[20:23], s79 offen offset:0 lds
buffer_load_dwordx4 v209, s[20:23], s79 offen offset:1024 lds
buffer_load_dwordx4 v210, s[20:23], s79 offen offset:2048 lds
buffer_load_dwordx4 v211, s[20:23], s79 offen offset:3072 lds
s_add_u32 m0, s81, 16384
s_nop 0
buffer_load_dwordx4 v212, s[8:11], s80 offen offset:0 lds
buffer_load_dwordx4 v213, s[8:11], s80 offen offset:1024 lds
buffer_load_dwordx4 v214, s[8:11], s80 offen offset:2048 lds
buffer_load_dwordx4 v215, s[8:11], s80 offen offset:3072 lds
s_waitcnt vmcnt(10)
ds_read_b128 v[36:39], v247 offset:0
ds_read_b128 v[40:43], v247 offset:16
ds_read_b128 v[44:47], v247 offset:32
ds_read_b128 v[48:51], v247 offset:48
s_cmp_lg_u32 s5, 0
s_cbranch_scc1 L_arr_2
s_and_b32 s6, s2, 7
s_lshl_b32 s6, s6, 5
v_mov_b32 v2, s6
s_mov_b64 exec, 1
buffer_atomic_add v253, v2, s[52:55], 0 offen sc1
s_mov_b64 exec, -1
L_arr_2:
v_lshlrev_b32 v194, 16, v8
v_and_b32 v195, 0xffff0000, v8
v_lshlrev_b32 v196, 16, v12
v_and_b32 v197, 0xffff0000, v12
s_mov_b32 exec_lo, 0xff000000
s_mov_b32 exec_hi, 0xffffff
buffer_load_dword v234, v232, s[20:23], 0 offen
s_mov_b64 exec, -1
s_mov_b32 exec_lo, 0xffff8000
s_mov_b32 exec_hi, 0x7
buffer_load_dword v234, v233, s[8:11], 0 offen
s_mov_b64 exec, -1
v_lshlrev_b32 v198, 16, v16
v_and_b32 v199, 0xffff0000, v16
v_lshlrev_b32 v236, 16, v20
v_and_b32 v237, 0xffff0000, v20
v_lshlrev_b32 v238, 16, v24
v_and_b32 v239, 0xffff0000, v24
v_lshlrev_b32 v240, 16, v28
v_and_b32 v241, 0xffff0000, v28
v_lshlrev_b32 v242, 16, v32
v_and_b32 v243, 0xffff0000, v32
s_waitcnt lgkmcnt(0)
v_lshlrev_b32 v52, 16, v36
v_lshlrev_b32 v53, 16, v38
v_and_b32 v54, 0xffff0000, v36
v_and_b32 v55, 0xffff0000, v38
v_lshlrev_b32 v56, 16, v37
v_lshlrev_b32 v57, 16, v39
v_and_b32 v58, 0xffff0000, v37
v_and_b32 v59, 0xffff0000, v39
v_pk_mul_f32 v[60:61], v[236:237], v[52:53]
v_pk_mul_f32 v[62:63], v[238:239], v[52:53]
v_pk_mul_f32 v[190:191], v[240:241], v[52:53]
v_pk_mul_f32 v[192:193], v[242:243], v[52:53]
v_pk_fma_f32 v[60:61], v[198:199], v[54:55], v[60:61]
v_pk_fma_f32 v[62:63], v[236:237], v[54:55], v[62:63]
v_pk_fma_f32 v[190:191], v[238:239], v[54:55], v[190:191]
v_pk_fma_f32 v[192:193], v[240:241], v[54:55], v[192:193]
v_pk_fma_f32 v[60:61], v[196:197], v[56:57], v[60:61]
v_pk_fma_f32 v[62:63], v[198:199], v[56:57], v[62:63]
v_pk_fma_f32 v[190:191], v[236:237], v[56:57], v[190:191]
v_pk_fma_f32 v[192:193], v[238:239], v[56:57], v[192:193]
v_pk_fma_f32 v[60:61], v[194:195], v[58:59], v[60:61]
v_pk_fma_f32 v[62:63], v[196:197], v[58:59], v[62:63]
v_pk_fma_f32 v[190:191], v[198:199], v[58:59], v[190:191]
v_pk_fma_f32 v[192:193], v[236:237], v[58:59], v[192:193]
v_lshlrev_b32 v194, 16, v174
v_and_b32 v195, 0xffff0000, v174
v_lshlrev_b32 v196, 16, v178
v_and_b32 v197, 0xffff0000, v178
v_lshlrev_b32 v198, 16, v182
v_and_b32 v199, 0xffff0000, v182
v_lshlrev_b32 v236, 16, v186
v_and_b32 v237, 0xffff0000, v186
v_pk_mul_f32 v[60:61], v[60:61], v[194:195]
v_pk_mul_f32 v[62:63], v[62:63], v[196:197]
v_pk_mul_f32 v[190:191], v[190:191], v[198:199]
v_pk_mul_f32 v[192:193], v[192:193], v[236:237]
s_mov_b32 exec_hi, 0xff
v_cvt_pk_bf16_f32 v238, v192, v190
v_cvt_pk_bf16_f32 v239, v62, v60
ds_write_b64 v202, v[238:239] offset:0
v_cvt_pk_bf16_f32 v240, v193, v191
v_cvt_pk_bf16_f32 v241, v63, v61
ds_write_b64 v202, v[240:241] offset:144
s_mov_b64 exec, -1
v_lshlrev_b32 v194, 16, v9
v_and_b32 v195, 0xffff0000, v9
v_lshlrev_b32 v196, 16, v13
v_and_b32 v197, 0xffff0000, v13
v_lshlrev_b32 v198, 16, v17
v_and_b32 v199, 0xffff0000, v17
v_lshlrev_b32 v236, 16, v21
v_and_b32 v237, 0xffff0000, v21
v_lshlrev_b32 v238, 16, v25
v_and_b32 v239, 0xffff0000, v25
v_lshlrev_b32 v240, 16, v29
v_and_b32 v241, 0xffff0000, v29
v_lshlrev_b32 v242, 16, v33
v_and_b32 v243, 0xffff0000, v33
v_lshlrev_b32 v52, 16, v40
v_lshlrev_b32 v53, 16, v42
v_and_b32 v54, 0xffff0000, v40
v_and_b32 v55, 0xffff0000, v42
v_lshlrev_b32 v56, 16, v41
v_lshlrev_b32 v57, 16, v43
v_and_b32 v58, 0xffff0000, v41
v_and_b32 v59, 0xffff0000, v43
v_pk_mul_f32 v[60:61], v[236:237], v[52:53]
v_pk_mul_f32 v[62:63], v[238:239], v[52:53]
v_pk_mul_f32 v[190:191], v[240:241], v[52:53]
v_pk_mul_f32 v[192:193], v[242:243], v[52:53]
v_pk_fma_f32 v[60:61], v[198:199], v[54:55], v[60:61]
v_pk_fma_f32 v[62:63], v[236:237], v[54:55], v[62:63]
v_pk_fma_f32 v[190:191], v[238:239], v[54:55], v[190:191]
v_pk_fma_f32 v[192:193], v[240:241], v[54:55], v[192:193]
v_pk_fma_f32 v[60:61], v[196:197], v[56:57], v[60:61]
v_pk_fma_f32 v[62:63], v[198:199], v[56:57], v[62:63]
v_pk_fma_f32 v[190:191], v[236:237], v[56:57], v[190:191]
v_pk_fma_f32 v[192:193], v[238:239], v[56:57], v[192:193]
v_pk_fma_f32 v[60:61], v[194:195], v[58:59], v[60:61]
v_pk_fma_f32 v[62:63], v[196:197], v[58:59], v[62:63]
v_pk_fma_f32 v[190:191], v[198:199], v[58:59], v[190:191]
v_pk_fma_f32 v[192:193], v[236:237], v[58:59], v[192:193]
v_lshlrev_b32 v194, 16, v175
v_and_b32 v195, 0xffff0000, v175
v_lshlrev_b32 v196, 16, v179
v_and_b32 v197, 0xffff0000, v179
v_lshlrev_b32 v198, 16, v183
v_and_b32 v199, 0xffff0000, v183
v_lshlrev_b32 v236, 16, v187
v_and_b32 v237, 0xffff0000, v187
v_pk_mul_f32 v[60:61], v[60:61], v[194:195]
v_pk_mul_f32 v[62:63], v[62:63], v[196:197]
v_pk_mul_f32 v[190:191], v[190:191], v[198:199]
v_pk_mul_f32 v[192:193], v[192:193], v[236:237]
s_mov_b32 exec_hi, 0xff
v_cvt_pk_bf16_f32 v238, v192, v190
v_cvt_pk_bf16_f32 v239, v62, v60
ds_write_b64 v202, v[238:239] offset:288
v_cvt_pk_bf16_f32 v240, v193, v191
v_cvt_pk_bf16_f32 v241, v63, v61
ds_write_b64 v202, v[240:241] offset:432
s_mov_b64 exec, -1
v_lshlrev_b32 v194, 16, v10
v_and_b32 v195, 0xffff0000, v10
v_lshlrev_b32 v196, 16, v14
v_and_b32 v197, 0xffff0000, v14
v_lshlrev_b32 v198, 16, v18
v_and_b32 v199, 0xffff0000, v18
v_lshlrev_b32 v236, 16, v22
v_and_b32 v237, 0xffff0000, v22
v_lshlrev_b32 v238, 16, v26
v_and_b32 v239, 0xffff0000, v26
v_lshlrev_b32 v240, 16, v30
v_and_b32 v241, 0xffff0000, v30
v_lshlrev_b32 v242, 16, v34
v_and_b32 v243, 0xffff0000, v34
v_lshlrev_b32 v52, 16, v44
v_lshlrev_b32 v53, 16, v46
v_and_b32 v54, 0xffff0000, v44
v_and_b32 v55, 0xffff0000, v46
v_lshlrev_b32 v56, 16, v45
v_lshlrev_b32 v57, 16, v47
v_and_b32 v58, 0xffff0000, v45
v_and_b32 v59, 0xffff0000, v47
v_pk_mul_f32 v[60:61], v[236:237], v[52:53]
v_pk_mul_f32 v[62:63], v[238:239], v[52:53]
v_pk_mul_f32 v[190:191], v[240:241], v[52:53]
v_pk_mul_f32 v[192:193], v[242:243], v[52:53]
v_pk_fma_f32 v[60:61], v[198:199], v[54:55], v[60:61]
v_pk_fma_f32 v[62:63], v[236:237], v[54:55], v[62:63]
v_pk_fma_f32 v[190:191], v[238:239], v[54:55], v[190:191]
v_pk_fma_f32 v[192:193], v[240:241], v[54:55], v[192:193]
v_pk_fma_f32 v[60:61], v[196:197], v[56:57], v[60:61]
v_pk_fma_f32 v[62:63], v[198:199], v[56:57], v[62:63]
v_pk_fma_f32 v[190:191], v[236:237], v[56:57], v[190:191]
v_pk_fma_f32 v[192:193], v[238:239], v[56:57], v[192:193]
v_pk_fma_f32 v[60:61], v[194:195], v[58:59], v[60:61]
v_pk_fma_f32 v[62:63], v[196:197], v[58:59], v[62:63]
v_pk_fma_f32 v[190:191], v[198:199], v[58:59], v[190:191]
v_pk_fma_f32 v[192:193], v[236:237], v[58:59], v[192:193]
v_lshlrev_b32 v194, 16, v176
v_and_b32 v195, 0xffff0000, v176
v_lshlrev_b32 v196, 16, v180
v_and_b32 v197, 0xffff0000, v180
v_lshlrev_b32 v198, 16, v184
v_and_b32 v199, 0xffff0000, v184
v_lshlrev_b32 v236, 16, v188
v_and_b32 v237, 0xffff0000, v188
v_pk_mul_f32 v[60:61], v[60:61], v[194:195]
v_pk_mul_f32 v[62:63], v[62:63], v[196:197]
v_pk_mul_f32 v[190:191], v[190:191], v[198:199]
v_pk_mul_f32 v[192:193], v[192:193], v[236:237]
s_mov_b32 exec_hi, 0xff
v_cvt_pk_bf16_f32 v238, v192, v190
v_cvt_pk_bf16_f32 v239, v62, v60
ds_write_b64 v202, v[238:239] offset:576
v_cvt_pk_bf16_f32 v240, v193, v191
v_cvt_pk_bf16_f32 v241, v63, v61
ds_write_b64 v202, v[240:241] offset:720
s_mov_b64 exec, -1
v_lshlrev_b32 v194, 16, v11
v_and_b32 v195, 0xffff0000, v11
v_lshlrev_b32 v196, 16, v15
v_and_b32 v197, 0xffff0000, v15
v_lshlrev_b32 v198, 16, v19
v_and_b32 v199, 0xffff0000, v19
v_lshlrev_b32 v236, 16, v23
v_and_b32 v237, 0xffff0000, v23
v_lshlrev_b32 v238, 16, v27
v_and_b32 v239, 0xffff0000, v27
v_lshlrev_b32 v240, 16, v31
v_and_b32 v241, 0xffff0000, v31
v_lshlrev_b32 v242, 16, v35
v_and_b32 v243, 0xffff0000, v35
v_lshlrev_b32 v52, 16, v48
v_lshlrev_b32 v53, 16, v50
v_and_b32 v54, 0xffff0000, v48
v_and_b32 v55, 0xffff0000, v50
v_lshlrev_b32 v56, 16, v49
v_lshlrev_b32 v57, 16, v51
v_and_b32 v58, 0xffff0000, v49
v_and_b32 v59, 0xffff0000, v51
v_pk_mul_f32 v[60:61], v[236:237], v[52:53]
v_pk_mul_f32 v[62:63], v[238:239], v[52:53]
v_pk_mul_f32 v[190:191], v[240:241], v[52:53]
v_pk_mul_f32 v[192:193], v[242:243], v[52:53]
v_pk_fma_f32 v[60:61], v[198:199], v[54:55], v[60:61]
v_pk_fma_f32 v[62:63], v[236:237], v[54:55], v[62:63]
v_pk_fma_f32 v[190:191], v[238:239], v[54:55], v[190:191]
v_pk_fma_f32 v[192:193], v[240:241], v[54:55], v[192:193]
v_pk_fma_f32 v[60:61], v[196:197], v[56:57], v[60:61]
v_pk_fma_f32 v[62:63], v[198:199], v[56:57], v[62:63]
v_pk_fma_f32 v[190:191], v[236:237], v[56:57], v[190:191]
v_pk_fma_f32 v[192:193], v[238:239], v[56:57], v[192:193]
v_pk_fma_f32 v[60:61], v[194:195], v[58:59], v[60:61]
v_pk_fma_f32 v[62:63], v[196:197], v[58:59], v[62:63]
v_pk_fma_f32 v[190:191], v[198:199], v[58:59], v[190:191]
v_pk_fma_f32 v[192:193], v[236:237], v[58:59], v[192:193]
v_lshlrev_b32 v194, 16, v177
v_and_b32 v195, 0xffff0000, v177
v_lshlrev_b32 v196, 16, v181
v_and_b32 v197, 0xffff0000, v181
v_lshlrev_b32 v198, 16, v185
v_and_b32 v199, 0xffff0000, v185
v_lshlrev_b32 v236, 16, v189
v_and_b32 v237, 0xffff0000, v189
v_pk_mul_f32 v[60:61], v[60:61], v[194:195]
v_pk_mul_f32 v[62:63], v[62:63], v[196:197]
v_pk_mul_f32 v[190:191], v[190:191], v[198:199]
v_pk_mul_f32 v[192:193], v[192:193], v[236:237]
s_mov_b32 exec_hi, 0xff
v_cvt_pk_bf16_f32 v238, v192, v190
v_cvt_pk_bf16_f32 v239, v62, v60
ds_write_b64 v202, v[238:239] offset:864
v_cvt_pk_bf16_f32 v240, v193, v191
v_cvt_pk_bf16_f32 v241, v63, v61
ds_write_b64 v202, v[240:241] offset:1008
s_mov_b64 exec, -1
s_add_u32 m0, s81, 32768
s_add_u32 s79, s79, 221184
buffer_load_dwordx4 v208, s[20:23], s79 offen offset:0 lds
buffer_load_dwordx4 v209, s[20:23], s79 offen offset:1024 lds
buffer_load_dwordx4 v210, s[20:23], s79 offen offset:2048 lds
buffer_load_dwordx4 v211, s[20:23], s79 offen offset:3072 lds
s_add_u32 m0, s81, 49152
s_add_u32 s80, s80, 128
buffer_load_dwordx4 v212, s[8:11], s80 offen offset:0 lds
buffer_load_dwordx4 v213, s[8:11], s80 offen offset:1024 lds
buffer_load_dwordx4 v214, s[8:11], s80 offen offset:2048 lds
buffer_load_dwordx4 v215, s[8:11], s80 offen offset:3072 lds
s_waitcnt vmcnt(10)
s_waitcnt lgkmcnt(0)
s_barrier
ds_read_b64_tr_b16 v[128:129], v216 offset:0
ds_read_b64_tr_b16 v[130:131], v216 offset:1024
ds_read_b128 v[136:139], v220 offset:16384
ds_read_b128 v[140:143], v220 offset:20480
ds_read_b64_tr_b16 v[132:133], v217 offset:0
ds_read_b64_tr_b16 v[134:135], v217 offset:1024
ds_read_b128 v[8:11], v203 offset:0
ds_read_b128 v[12:15], v203 offset:1152
ds_read_b128 v[16:19], v203 offset:2304
s_waitcnt lgkmcnt(6)
v_mfma_f32_32x32x16_bf16 v[64:79], v[128:131], v[136:139], 0
ds_read_b64_tr_b16 v[144:145], v216 offset:4096
ds_read_b64_tr_b16 v[146:147], v216 offset:5120
s_add_u32 m0, s81, 65536
s_add_u32 s79, s79, 221184
buffer_load_dwordx4 v208, s[20:23], s79 offen offset:0 lds
s_waitcnt lgkmcnt(7)
v_mfma_f32_32x32x16_bf16 v[80:95], v[128:131], v[140:143], 0
ds_read_b128 v[152:155], v221 offset:16384
ds_read_b128 v[156:159], v221 offset:20480
buffer_load_dwordx4 v209, s[20:23], s79 offen offset:1024 lds
v_mfma_f32_16x16x32_bf16 v[164:167], v[160:163], v[128:131], 0
s_waitcnt lgkmcnt(7)
v_mfma_f32_32x32x16_bf16 v[96:111], v[132:135], v[136:139], 0
ds_read_b64_tr_b16 v[148:149], v217 offset:4096
ds_read_b64_tr_b16 v[150:151], v217 offset:5120
buffer_load_dwordx4 v210, s[20:23], s79 offen offset:2048 lds
v_mfma_f32_32x32x16_bf16 v[112:127], v[132:135], v[140:143], 0
buffer_load_dwordx4 v211, s[20:23], s79 offen offset:3072 lds
v_mfma_f32_16x16x32_bf16 v[168:171], v[160:163], v[132:135], 0
s_waitcnt lgkmcnt(3)
v_mfma_f32_32x32x16_bf16 v[64:79], v[144:147], v[152:155], v[64:79]
ds_read_b64_tr_b16 v[128:129], v216 offset:8192
ds_read_b64_tr_b16 v[130:131], v216 offset:9216
s_add_u32 m0, s81, 81920
s_add_u32 s80, s80, 128
buffer_load_dwordx4 v212, s[8:11], s80 offen offset:0 lds
s_waitcnt lgkmcnt(4)
v_mfma_f32_32x32x16_bf16 v[80:95], v[144:147], v[156:159], v[80:95]
ds_read_b128 v[136:139], v222 offset:16384
ds_read_b128 v[140:143], v222 offset:20480
buffer_load_dwordx4 v213, s[8:11], s80 offen offset:1024 lds
v_mfma_f32_16x16x32_bf16 v[164:167], v[160:163], v[144:147], v[164:167]
s_waitcnt lgkmcnt(4)
v_mfma_f32_32x32x16_bf16 v[96:111], v[148:151], v[152:155], v[96:111]
ds_read_b64_tr_b16 v[132:133], v217 offset:8192
ds_read_b64_tr_b16 v[134:135], v217 offset:9216
buffer_load_dwordx4 v214, s[8:11], s80 offen offset:2048 lds
v_mfma_f32_32x32x16_bf16 v[112:127], v[148:151], v[156:159], v[112:127]
buffer_load_dwordx4 v215, s[8:11], s80 offen offset:3072 lds
v_mfma_f32_16x16x32_bf16 v[168:171], v[160:163], v[148:151], v[168:171]
s_waitcnt lgkmcnt(3)
v_mfma_f32_32x32x16_bf16 v[64:79], v[128:131], v[136:139], v[64:79]
ds_read_b64_tr_b16 v[144:145], v216 offset:12288
ds_read_b64_tr_b16 v[146:147], v216 offset:13312
s_waitcnt vmcnt(8)
s_cmp_eq_u32 s82, 0
s_cbranch_scc0 L_nb_3
s_barrier
L_nb_3:
s_waitcnt lgkmcnt(4)
v_mfma_f32_32x32x16_bf16 v[80:95], v[128:131], v[140:143], v[80:95]
ds_read_b128 v[152:155], v223 offset:16384
ds_read_b128 v[156:159], v223 offset:20480
s_cmp_eq_u32 s82, 1
s_cbranch_scc0 L_nb_4
s_barrier
L_nb_4:
v_mfma_f32_16x16x32_bf16 v[164:167], v[160:163], v[128:131], v[164:167]
s_waitcnt lgkmcnt(4)
v_mfma_f32_32x32x16_bf16 v[96:111], v[132:135], v[136:139], v[96:111]
ds_read_b64_tr_b16 v[148:149], v217 offset:12288
ds_read_b64_tr_b16 v[150:151], v217 offset:13312
s_add_u32 m0, s81, 98304
s_add_u32 s79, s79, 221184
buffer_load_dwordx4 v208, s[20:23], s79 offen offset:0 lds
v_mfma_f32_32x32x16_bf16 v[112:127], v[132:135], v[140:143], v[112:127]
buffer_store_dwordx4 v[8:11], v172, s[24:27], s70 offen sc1
v_mfma_f32_16x16x32_bf16 v[168:171], v[160:163], v[132:135], v[168:171]
s_waitcnt lgkmcnt(3)
v_mfma_f32_32x32x16_bf16 v[64:79], v[144:147], v[152:155], v[64:79]
ds_read_b64_tr_b16 v[128:129], v216 offset:32768
ds_read_b64_tr_b16 v[130:131], v216 offset:33792
buffer_load_dwordx4 v209, s[20:23], s79 offen offset:1024 lds
s_waitcnt lgkmcnt(4)
v_mfma_f32_32x32x16_bf16 v[80:95], v[144:147], v[156:159], v[80:95]
ds_read_b128 v[136:139], v220 offset:49152
ds_read_b128 v[140:143], v220 offset:53248
v_mfma_f32_16x16x32_bf16 v[164:167], v[160:163], v[144:147], v[164:167]
s_waitcnt lgkmcnt(4)
v_mfma_f32_32x32x16_bf16 v[96:111], v[148:151], v[152:155], v[96:111]
ds_read_b64_tr_b16 v[132:133], v217 offset:32768
ds_read_b64_tr_b16 v[134:135], v217 offset:33792
buffer_load_dwordx4 v210, s[20:23], s79 offen offset:2048 lds
v_mfma_f32_32x32x16_bf16 v[112:127], v[148:151], v[156:159], v[112:127]
v_mfma_f32_16x16x32_bf16 v[168:171], v[160:163], v[148:151], v[168:171]
s_waitcnt lgkmcnt(3)
v_mfma_f32_32x32x16_bf16 v[64:79], v[128:131], v[136:139], v[64:79]
ds_read_b64_tr_b16 v[144:145], v216 offset:36864
ds_read_b64_tr_b16 v[146:147], v216 offset:37888
buffer_load_dwordx4 v211, s[20:23], s79 offen offset:3072 lds
s_waitcnt lgkmcnt(4)
v_mfma_f32_32x32x16_bf16 v[80:95], v[128:131], v[140:143], v[80:95]
ds_read_b128 v[152:155], v221 offset:49152
ds_read_b128 v[156:159], v221 offset:53248
v_mfma_f32_16x16x32_bf16 v[164:167], v[160:163], v[128:131], v[164:167]
s_waitcnt lgkmcnt(4)
v_mfma_f32_32x32x16_bf16 v[96:111], v[132:135], v[136:139], v[96:111]
ds_read_b64_tr_b16 v[148:149], v217 offset:36864
ds_read_b64_tr_b16 v[150:151], v217 offset:37888
s_add_u32 m0, s81, 114688
s_add_u32 s80, s80, 128
buffer_load_dwordx4 v212, s[8:11], s80 offen offset:0 lds
v_mfma_f32_32x32x16_bf16 v[112:127], v[132:135], v[140:143], v[112:127]
buffer_store_dwordx4 v[12:15], v172, s[24:27], s71 offen sc1
v_mfma_f32_16x16x32_bf16 v[168:171], v[160:163], v[132:135], v[168:171]
s_waitcnt lgkmcnt(3)
v_mfma_f32_32x32x16_bf16 v[64:79], v[144:147], v[152:155], v[64:79]
ds_read_b64_tr_b16 v[128:129], v216 offset:40960
ds_read_b64_tr_b16 v[130:131], v216 offset:41984
buffer_load_dwordx4 v213, s[8:11], s80 offen offset:1024 lds
s_waitcnt lgkmcnt(4)
v_mfma_f32_32x32x16_bf16 v[80:95], v[144:147], v[156:159], v[80:95]
ds_read_b128 v[136:139], v222 offset:49152
ds_read_b128 v[140:143], v222 offset:53248
v_mfma_f32_16x16x32_bf16 v[164:167], v[160:163], v[144:147], v[164:167]
s_waitcnt lgkmcnt(4)
v_mfma_f32_32x32x16_bf16 v[96:111], v[148:151], v[152:155], v[96:111]
ds_read_b64_tr_b16 v[132:133], v217 offset:40960
ds_read_b64_tr_b16 v[134:135], v217 offset:41984
buffer_load_dwordx4 v214, s[8:11], s80 offen offset:2048 lds
v_mfma_f32_32x32x16_bf16 v[112:127], v[148:151], v[156:159], v[112:127]
v_mfma_f32_16x16x32_bf16 v[168:171], v[160:163], v[148:151], v[168:171]
s_waitcnt lgkmcnt(3)
v_mfma_f32_32x32x16_bf16 v[64:79], v[128:131], v[136:139], v[64:79]
ds_read_b64_tr_b16 v[144:145], v216 offset:45056
ds_read_b64_tr_b16 v[146:147], v216 offset:46080
s_waitcnt vmcnt(9)
s_cmp_eq_u32 s82, 0
s_cbranch_scc0 L_nb_5
s_barrier
L_nb_5:
buffer_load_dwordx4 v215, s[8:11], s80 offen offset:3072 lds
s_waitcnt lgkmcnt(4)
v_mfma_f32_32x32x16_bf16 v[80:95], v[128:131], v[140:143], v[80:95]
ds_read_b128 v[152:155], v223 offset:49152
ds_read_b128 v[156:159], v223 offset:53248
s_cmp_eq_u32 s82, 1
s_cbranch_scc0 L_nb_6
s_barrier
L_nb_6:
v_mfma_f32_16x16x32_bf16 v[164:167], v[160:163], v[128:131], v[164:167]
s_waitcnt lgkmcnt(4)
v_mfma_f32_32x32x16_bf16 v[96:111], v[132:135], v[136:139], v[96:111]
ds_read_b64_tr_b16 v[148:149], v217 offset:45056
ds_read_b64_tr_b16 v[150:151], v217 offset:46080
s_add_u32 m0, s81, 0
s_add_u32 s79, s79, 221184
buffer_load_dwordx4 v208, s[20:23], s79 offen offset:0 lds
v_mfma_f32_32x32x16_bf16 v[112:127], v[132:135], v[140:143], v[112:127]
s_mov_b32 exec_hi, 0
buffer_store_dwordx4 v[16:19], v172, s[24:27], s72 offen sc1
s_mov_b64 exec, -1
v_mfma_f32_16x16x32_bf16 v[168:171], v[160:163], v[132:135], v[168:171]
s_waitcnt lgkmcnt(3)
v_mfma_f32_32x32x16_bf16 v[64:79], v[144:147], v[152:155], v[64:79]
ds_read_b64_tr_b16 v[128:129], v218 offset:0
ds_read_b64_tr_b16 v[130:131], v218 offset:1024
buffer_load_dwordx4 v209, s[20:23], s79 offen offset:1024 lds
s_waitcnt lgkmcnt(4)
v_mfma_f32_32x32x16_bf16 v[80:95], v[144:147], v[156:159], v[80:95]
ds_read_b128 v[136:139], v224 offset:16384
ds_read_b128 v[140:143], v224 offset:20480
v_mfma_f32_16x16x32_bf16 v[164:167], v[160:163], v[144:147], v[164:167]
s_waitcnt lgkmcnt(4)
v_mfma_f32_32x32x16_bf16 v[96:111], v[148:151], v[152:155], v[96:111]
ds_read_b64_tr_b16 v[132:133], v219 offset:0
ds_read_b64_tr_b16 v[134:135], v219 offset:1024
buffer_load_dwordx4 v210, s[20:23], s79 offen offset:2048 lds
v_mfma_f32_32x32x16_bf16 v[112:127], v[148:151], v[156:159], v[112:127]
v_mfma_f32_16x16x32_bf16 v[168:171], v[160:163], v[148:151], v[168:171]
s_waitcnt lgkmcnt(3)
v_mfma_f32_32x32x16_bf16 v[64:79], v[128:131], v[136:139], v[64:79]
ds_read_b64_tr_b16 v[144:145], v218 offset:4096
ds_read_b64_tr_b16 v[146:147], v218 offset:5120
buffer_load_dwordx4 v211, s[20:23], s79 offen offset:3072 lds
s_waitcnt lgkmcnt(4)
v_mfma_f32_32x32x16_bf16 v[80:95], v[128:131], v[140:143], v[80:95]
ds_read_b128 v[152:155], v225 offset:16384
ds_read_b128 v[156:159], v225 offset:20480
v_mfma_f32_16x16x32_bf16 v[164:167], v[160:163], v[128:131], v[164:167]
s_waitcnt lgkmcnt(4)
v_mfma_f32_32x32x16_bf16 v[96:111], v[132:135], v[136:139], v[96:111]
ds_read_b64_tr_b16 v[148:149], v219 offset:4096
ds_read_b64_tr_b16 v[150:151], v219 offset:5120
s_add_u32 m0, s81, 16384
s_add_u32 s80, s80, 128
buffer_load_dwordx4 v212, s[8:11], s80 offen offset:0 lds
v_mfma_f32_32x32x16_bf16 v[112:127], v[132:135], v[140:143], v[112:127]
v_mfma_f32_16x16x32_bf16 v[168:171], v[160:163], v[132:135], v[168:171]
s_waitcnt lgkmcnt(3)
v_mfma_f32_32x32x16_bf16 v[64:79], v[144:147], v[152:155], v[64:79]
ds_read_b64_tr_b16 v[128:129], v218 offset:8192
ds_read_b64_tr_b16 v[130:131], v218 offset:9216
buffer_load_dwordx4 v213, s[8:11], s80 offen offset:1024 lds
s_waitcnt lgkmcnt(4)
v_mfma_f32_32x32x16_bf16 v[80:95], v[144:147], v[156:159], v[80:95]
ds_read_b128 v[136:139], v226 offset:16384
ds_read_b128 v[140:143], v226 offset:20480
v_mfma_f32_16x16x32_bf16 v[164:167], v[160:163], v[144:147], v[164:167]
s_waitcnt lgkmcnt(4)
v_mfma_f32_32x32x16_bf16 v[96:111], v[148:151], v[152:155], v[96:111]
ds_read_b64_tr_b16 v[132:133], v219 offset:8192
ds_read_b64_tr_b16 v[134:135], v219 offset:9216
buffer_load_dwordx4 v214, s[8:11], s80 offen offset:2048 lds
v_mfma_f32_32x32x16_bf16 v[112:127], v[148:151], v[156:159], v[112:127]
buffer_load_dword v254, v230, s[52:55], 0 offen sc1
v_mfma_f32_16x16x32_bf16 v[168:171], v[160:163], v[148:151], v[168:171]
s_waitcnt lgkmcnt(3)
v_mfma_f32_32x32x16_bf16 v[64:79], v[128:131], v[136:139], v[64:79]
ds_read_b64_tr_b16 v[144:145], v218 offset:12288
ds_read_b64_tr_b16 v[146:147], v218 offset:13312
s_waitcnt vmcnt(9)
s_cmp_eq_u32 s82, 0
s_cbranch_scc0 L_nb_7
s_barrier
L_nb_7:
buffer_load_dwordx4 v215, s[8:11], s80 offen offset:3072 lds
s_waitcnt lgkmcnt(4)
v_mfma_f32_32x32x16_bf16 v[80:95], v[128:131], v[140:143], v[80:95]
ds_read_b128 v[152:155], v227 offset:16384
ds_read_b128 v[156:159], v227 offset:20480
s_cmp_eq_u32 s82, 1
s_cbranch_scc0 L_nb_8
s_barrier
L_nb_8:
v_mfma_f32_16x16x32_bf16 v[164:167], v[160:163], v[128:131], v[164:167]
s_waitcnt lgkmcnt(4)
v_mfma_f32_32x32x16_bf16 v[96:111], v[132:135], v[136:139], v[96:111]
ds_read_b64_tr_b16 v[148:149], v219 offset:12288
ds_read_b64_tr_b16 v[150:151], v219 offset:13312
s_add_u32 m0, s81, 32768
s_add_u32 s79, s79, 221184
buffer_load_dwordx4 v208, s[20:23], s79 offen offset:0 lds
v_mfma_f32_32x32x16_bf16 v[112:127], v[132:135], v[140:143], v[112:127]
v_mfma_f32_16x16x32_bf16 v[168:171], v[160:163], v[132:135], v[168:171]
s_waitcnt lgkmcnt(3)
v_mfma_f32_32x32x16_bf16 v[64:79], v[144:147], v[152:155], v[64:79]
ds_read_b64_tr_b16 v[128:129], v218 offset:32768
ds_read_b64_tr_b16 v[130:131], v218 offset:33792
buffer_load_dwordx4 v209, s[20:23], s79 offen offset:1024 lds
s_waitcnt lgkmcnt(4)
v_mfma_f32_32x32x16_bf16 v[80:95], v[144:147], v[156:159], v[80:95]
ds_read_b128 v[136:139], v224 offset:49152
ds_read_b128 v[140:143], v224 offset:53248
v_mfma_f32_16x16x32_bf16 v[164:167], v[160:163], v[144:147], v[164:167]
s_waitcnt lgkmcnt(4)
v_mfma_f32_32x32x16_bf16 v[96:111], v[148:151], v[152:155], v[96:111]
ds_read_b64_tr_b16 v[132:133], v219 offset:32768
ds_read_b64_tr_b16 v[134:135], v219 offset:33792
buffer_load_dwordx4 v210, s[20:23], s79 offen offset:2048 lds
v_mfma_f32_32x32x16_bf16 v[112:127], v[148:151], v[156:159], v[112:127]
v_mfma_f32_16x16x32_bf16 v[168:171], v[160:163], v[148:151], v[168:171]
s_waitcnt lgkmcnt(3)
v_mfma_f32_32x32x16_bf16 v[64:79], v[128:131], v[136:139], v[64:79]
ds_read_b64_tr_b16 v[144:145], v218 offset:36864
ds_read_b64_tr_b16 v[146:147], v218 offset:37888
buffer_load_dwordx4 v211, s[20:23], s79 offen offset:3072 lds
s_waitcnt lgkmcnt(4)
v_mfma_f32_32x32x16_bf16 v[80:95], v[128:131], v[140:143], v[80:95]
ds_read_b128 v[152:155], v225 offset:49152
ds_read_b128 v[156:159], v225 offset:53248
s_mov_b32 m0, s74
s_nop 0
buffer_load_dwordx4 v204, s[36:39], 0 offen lds
s_mov_b32 m0, s74
s_nop 0
buffer_load_dwordx4 v205, s[36:39], 0 offen offset:1024 lds
s_mov_b32 m0, s74
s_mov_b32 exec_hi, 0
buffer_load_dwordx4 v206, s[36:39], 0 offen offset:2048 lds
s_mov_b64 exec, -1
v_mfma_f32_16x16x32_bf16 v[164:167], v[160:163], v[128:131], v[164:167]
s_waitcnt lgkmcnt(4)
v_mfma_f32_32x32x16_bf16 v[96:111], v[132:135], v[136:139], v[96:111]
ds_read_b64_tr_b16 v[148:149], v219 offset:36864
ds_read_b64_tr_b16 v[150:151], v219 offset:37888
s_add_u32 m0, s81, 49152
s_add_u32 s80, s80, 128
buffer_load_dwordx4 v212, s[8:11], s80 offen offset:0 lds
v_mfma_f32_32x32x16_bf16 v[112:127], v[132:135], v[140:143], v[112:127]
v_mfma_f32_16x16x32_bf16 v[168:171], v[160:163], v[132:135], v[168:171]
s_waitcnt lgkmcnt(3)
v_mfma_f32_32x32x16_bf16 v[64:79], v[144:147], v[152:155], v[64:79]
ds_read_b64_tr_b16 v[128:129], v218 offset:40960
ds_read_b64_tr_b16 v[130:131], v218 offset:41984
buffer_load_dwordx4 v213, s[8:11], s80 offen offset:1024 lds
s_waitcnt lgkmcnt(4)
v_mfma_f32_32x32x16_bf16 v[80:95], v[144:147], v[156:159], v[80:95]
ds_read_b128 v[136:139], v226 offset:49152
ds_read_b128 v[140:143], v226 offset:53248
v_mfma_f32_16x16x32_bf16 v[164:167], v[160:163], v[144:147], v[164:167]
s_waitcnt lgkmcnt(4)
v_mfma_f32_32x32x16_bf16 v[96:111], v[148:151], v[152:155], v[96:111]
ds_read_b64_tr_b16 v[132:133], v219 offset:40960
ds_read_b64_tr_b16 v[134:135], v219 offset:41984
buffer_load_dwordx4 v214, s[8:11], s80 offen offset:2048 lds
v_mfma_f32_32x32x16_bf16 v[112:127], v[148:151], v[156:159], v[112:127]
v_mfma_f32_16x16x32_bf16 v[168:171], v[160:163], v[148:151], v[168:171]
s_waitcnt lgkmcnt(3)
v_mfma_f32_32x32x16_bf16 v[64:79], v[128:131], v[136:139], v[64:79]
ds_read_b64_tr_b16 v[144:145], v218 offset:45056
ds_read_b64_tr_b16 v[146:147], v218 offset:46080
s_waitcnt vmcnt(10)
s_cmp_eq_u32 s82, 0
s_cbranch_scc0 L_nb_9
s_barrier
L_nb_9:
buffer_load_dwordx4 v215, s[8:11], s80 offen offset:3072 lds
s_waitcnt lgkmcnt(4)
v_mfma_f32_32x32x16_bf16 v[80:95], v[128:131], v[140:143], v[80:95]
ds_read_b128 v[152:155], v227 offset:49152
ds_read_b128 v[156:159], v227 offset:53248
s_cmp_eq_u32 s82, 1
s_cbranch_scc0 L_nb_10
s_barrier
L_nb_10:
s_mov_b32 exec_lo, 0x0
s_mov_b32 exec_hi, 0xff000000
buffer_load_dword v234, v232, s[20:23], 0 offen
s_mov_b64 exec, -1
s_mov_b32 s6, 1769472
s_mov_b32 exec_lo, 0xffff
s_mov_b32 exec_hi, 0x0
buffer_load_dword v234, v232, s[20:23], s6 offen
s_mov_b64 exec, -1
s_mov_b32 exec_lo, 0x0
s_mov_b32 exec_hi, 0x3fff8
buffer_load_dword v234, v233, s[8:11], 0 offen
s_mov_b64 exec, -1
v_mfma_f32_16x16x32_bf16 v[164:167], v[160:163], v[128:131], v[164:167]
s_waitcnt lgkmcnt(4)
v_mfma_f32_32x32x16_bf16 v[96:111], v[132:135], v[136:139], v[96:111]
ds_read_b64_tr_b16 v[148:149], v219 offset:45056
ds_read_b64_tr_b16 v[150:151], v219 offset:46080
s_add_u32 m0, s81, 65536
s_add_u32 s79, s79, 221184
buffer_load_dwordx4 v208, s[20:23], s79 offen offset:0 lds
v_mfma_f32_32x32x16_bf16 v[112:127], v[132:135], v[140:143], v[112:127]
v_mfma_f32_16x16x32_bf16 v[168:171], v[160:163], v[132:135], v[168:171]
s_waitcnt lgkmcnt(3)
v_mfma_f32_32x32x16_bf16 v[64:79], v[144:147], v[152:155], v[64:79]
ds_read_b64_tr_b16 v[128:129], v216 offset:0
ds_read_b64_tr_b16 v[130:131], v216 offset:1024
buffer_load_dwordx4 v209, s[20:23], s79 offen offset:1024 lds
s_waitcnt lgkmcnt(4)
v_mfma_f32_32x32x16_bf16 v[80:95], v[144:147], v[156:159], v[80:95]
ds_read_b128 v[136:139], v220 offset:16384
ds_read_b128 v[140:143], v220 offset:20480
v_mfma_f32_16x16x32_bf16 v[164:167], v[160:163], v[144:147], v[164:167]
s_waitcnt lgkmcnt(4)
v_mfma_f32_32x32x16_bf16 v[96:111], v[148:151], v[152:155], v[96:111]
ds_read_b64_tr_b16 v[132:133], v217 offset:0
ds_read_b64_tr_b16 v[134:135], v217 offset:1024
buffer_load_dwordx4 v210, s[20:23], s79 offen offset:2048 lds
v_mfma_f32_32x32x16_bf16 v[112:127], v[148:151], v[156:159], v[112:127]
v_mfma_f32_16x16x32_bf16 v[168:171], v[160:163], v[148:151], v[168:171]
s_waitcnt lgkmcnt(3)
v_mfma_f32_32x32x16_bf16 v[64:79], v[128:131], v[136:139], v[64:79]
ds_read_b64_tr_b16 v[144:145], v216 offset:4096
ds_read_b64_tr_b16 v[146:147], v216 offset:5120
buffer_load_dwordx4 v211, s[20:23], s79 offen offset:3072 lds
s_waitcnt lgkmcnt(4)
v_mfma_f32_32x32x16_bf16 v[80:95], v[128:131], v[140:143], v[80:95]
ds_read_b128 v[152:155], v221 offset:16384
ds_read_b128 v[156:159], v221 offset:20480
v_mfma_f32_16x16x32_bf16 v[164:167], v[160:163], v[128:131], v[164:167]
s_waitcnt lgkmcnt(4)
v_mfma_f32_32x32x16_bf16 v[96:111], v[132:135], v[136:139], v[96:111]
ds_read_b64_tr_b16 v[148:149], v217 offset:4096
ds_read_b64_tr_b16 v[150:151], v217 offset:5120
s_add_u32 m0, s81, 81920
s_add_u32 s80, s80, 128
buffer_load_dwordx4 v212, s[8:11], s80 offen offset:0 lds
v_mfma_f32_32x32x16_bf16 v[112:127], v[132:135], v[140:143], v[112:127]
v_mfma_f32_16x16x32_bf16 v[168:171], v[160:163], v[132:135], v[168:171]
s_waitcnt lgkmcnt(3)
v_mfma_f32_32x32x16_bf16 v[64:79], v[144:147], v[152:155], v[64:79]
ds_read_b64_tr_b16 v[128:129], v216 offset:8192
ds_read_b64_tr_b16 v[130:131], v216 offset:9216
buffer_load_dwordx4 v213, s[8:11], s80 offen offset:1024 lds
s_waitcnt lgkmcnt(4)
v_mfma_f32_32x32x16_bf16 v[80:95], v[144:147], v[156:159], v[80:95]
ds_read_b128 v[136:139], v222 offset:16384
ds_read_b128 v[140:143], v222 offset:20480
v_mfma_f32_16x16x32_bf16 v[164:167], v[160:163], v[144:147], v[164:167]
s_waitcnt lgkmcnt(4)
v_mfma_f32_32x32x16_bf16 v[96:111], v[148:151], v[152:155], v[96:111]
ds_read_b64_tr_b16 v[132:133], v217 offset:8192
ds_read_b64_tr_b16 v[134:135], v217 offset:9216
buffer_load_dwordx4 v214, s[8:11], s80 offen offset:2048 lds
v_mfma_f32_32x32x16_bf16 v[112:127], v[148:151], v[156:159], v[112:127]
v_mfma_f32_16x16x32_bf16 v[168:171], v[160:163], v[148:151], v[168:171]
s_waitcnt lgkmcnt(3)
v_mfma_f32_32x32x16_bf16 v[64:79], v[128:131], v[136:139], v[64:79]
ds_read_b64_tr_b16 v[144:145], v216 offset:12288
ds_read_b64_tr_b16 v[146:147], v216 offset:13312
s_waitcnt vmcnt(10)
s_cmp_lg_u32 s5, 0
s_cbranch_scc1 L_back_12
v_cmp_gt_u32 vcc, 32, v254
s_cbranch_vccnz L_slow_11
L_back_12:
s_cmp_eq_u32 s82, 0
s_cbranch_scc0 L_nb_13
s_barrier
L_nb_13:
buffer_load_dwordx4 v215, s[8:11], s80 offen offset:3072 lds
s_waitcnt lgkmcnt(4)
v_mfma_f32_32x32x16_bf16 v[80:95], v[128:131], v[140:143], v[80:95]
ds_read_b128 v[152:155], v223 offset:16384
ds_read_b128 v[156:159], v223 offset:20480
s_cmp_eq_u32 s82, 1
s_cbranch_scc0 L_nb_14
s_barrier
L_nb_14:
s_cmp_lg_u32 s5, 0
s_cbranch_scc1 L_fl_15
s_mov_b64 exec, 1
buffer_store_dword v253, v252, s[24:27], 0 offen offset:0 sc1
s_mov_b64 exec, -1
L_fl_15:
v_mfma_f32_16x16x32_bf16 v[164:167], v[160:163], v[128:131], v[164:167]
s_waitcnt lgkmcnt(4)
v_mfma_f32_32x32x16_bf16 v[96:111], v[132:135], v[136:139], v[96:111]
ds_read_b64_tr_b16 v[148:149], v217 offset:12288
ds_read_b64_tr_b16 v[150:151], v217 offset:13312
s_add_u32 m0, s81, 98304
s_add_u32 s79, s79, 221184
buffer_load_dwordx4 v208, s[20:23], s79 offen offset:0 lds
v_mfma_f32_32x32x16_bf16 v[112:127], v[132:135], v[140:143], v[112:127]
v_mfma_f32_16x16x32_bf16 v[168:171], v[160:163], v[132:135], v[168:171]
s_waitcnt lgkmcnt(3)
v_mfma_f32_32x32x16_bf16 v[64:79], v[144:147], v[152:155], v[64:79]
ds_read_b64_tr_b16 v[128:129], v216 offset:32768
ds_read_b64_tr_b16 v[130:131], v216 offset:33792
buffer_load_dwordx4 v209, s[20:23], s79 offen offset:1024 lds
ds_read_b64_tr_b16 v[174:175], v200
ds_read_b64_tr_b16 v[176:177], v200 offset:2560
s_lshl_b32 s6, s89, 2
s_add_u32 s6, s6, s5
s_lshl_b32 s7, s6, 1
s_waitcnt lgkmcnt(6)
v_mfma_f32_32x32x16_bf16 v[80:95], v[144:147], v[156:159], v[80:95]
ds_read_b128 v[136:139], v220 offset:49152
ds_read_b128 v[140:143], v220 offset:53248
ds_read_b64_tr_b16 v[178:179], v201
ds_read_b64_tr_b16 v[180:181], v201 offset:2560
s_lshr_b32 s85, 6436, s7
s_and_b32 s85, s85, 3
s_lshr_b32 s86, 55, s6
v_mfma_f32_16x16x32_bf16 v[164:167], v[160:163], v[144:147], v[164:167]
s_waitcnt lgkmcnt(8)
v_mfma_f32_32x32x16_bf16 v[96:111], v[148:151], v[152:155], v[96:111]
ds_read_b64_tr_b16 v[132:133], v217 offset:32768
ds_read_b64_tr_b16 v[134:135], v217 offset:33792
buffer_load_dwordx4 v210, s[20:23], s79 offen offset:2048 lds
ds_read_b64_tr_b16 v[182:183], v246
ds_read_b64_tr_b16 v[184:185], v246 offset:2560
s_and_b32 s86, s86, 1
s_lshr_b32 s87, 61311, s7
s_and_b32 s87, s87, 3
v_mfma_f32_32x32x16_bf16 v[112:127], v[148:151], v[156:159], v[112:127]
v_and_b32 v2, 3, v1
v_mul_u32_u24 v2, 4416, v2
v_bfe_u32 v3, v1, 2, 2
v_mfma_f32_16x16x32_bf16 v[168:171], v[160:163], v[148:151], v[168:171]
s_waitcnt lgkmcnt(7)
v_mfma_f32_32x32x16_bf16 v[64:79], v[128:131], v[136:139], v[64:79]
ds_read_b64_tr_b16 v[144:145], v216 offset:36864
ds_read_b64_tr_b16 v[146:147], v216 offset:37888
buffer_load_dwordx4 v211, s[20:23], s79 offen offset:3072 lds
v_lshrrev_b32 v18, 4, v1
v_add_u32 v3, v3, v18
v_lshl_add_u32 v16, v3, 4, v2
s_waitcnt lgkmcnt(8)
v_mfma_f32_32x32x16_bf16 v[80:95], v[128:131], v[140:143], v[80:95]
ds_read_b128 v[152:155], v221 offset:49152
ds_read_b128 v[156:159], v221 offset:53248
v_and_b32 v2, 1, v1
v_mul_u32_u24 v2, 6784, v2
v_bfe_u32 v3, v1, 1, 3
v_mfma_f32_16x16x32_bf16 v[164:167], v[160:163], v[128:131], v[164:167]
s_waitcnt lgkmcnt(6)
v_mfma_f32_32x32x16_bf16 v[96:111], v[132:135], v[136:139], v[96:111]
ds_read_b64_tr_b16 v[148:149], v217 offset:36864
ds_read_b64_tr_b16 v[150:151], v217 offset:37888
s_add_u32 m0, s81, 114688
s_add_u32 s80, s80, 128
buffer_load_dwordx4 v212, s[8:11], s80 offen offset:0 lds
s_lshl_b32 s6, s86, 3
s_sub_u32 s6, 15, s6
v_sub_u32 v5, s6, v3
v_mfma_f32_32x32x16_bf16 v[112:127], v[132:135], v[140:143], v[112:127]
v_mul_u32_u24 v5, 288, v5
v_add_u32 v2, v2, v5
v_lshl_add_u32 v17, v18, 4, v2
v_mfma_f32_16x16x32_bf16 v[168:171], v[160:163], v[132:135], v[168:171]
s_waitcnt lgkmcnt(3)
v_mfma_f32_32x32x16_bf16 v[64:79], v[144:147], v[152:155], v[64:79]
ds_read_b64_tr_b16 v[128:129], v216 offset:40960
ds_read_b64_tr_b16 v[130:131], v216 offset:41984
buffer_load_dwordx4 v213, s[8:11], s80 offen offset:1024 lds
s_lshl_b32 s6, s86, 3
v_add_u32 v3, s6, v3
v_lshlrev_b32 v3, 8, v3
s_waitcnt lgkmcnt(4)
v_mfma_f32_32x32x16_bf16 v[80:95], v[144:147], v[156:159], v[80:95]
ds_read_b128 v[136:139], v222 offset:49152
ds_read_b128 v[140:143], v222 offset:53248
v_and_b32 v2, 1, v1
v_lshl_or_b32 v2, v18, 1, v2
v_lshl_or_b32 v11, v2, 4, v3
v_mfma_f32_16x16x32_bf16 v[164:167], v[160:163], v[144:147], v[164:167]
s_waitcnt lgkmcnt(4)
v_mfma_f32_32x32x16_bf16 v[96:111], v[148:151], v[152:155], v[96:111]
ds_read_b64_tr_b16 v[132:133], v217 offset:40960
ds_read_b64_tr_b16 v[134:135], v217 offset:41984
buffer_load_dwordx4 v214, s[8:11], s80 offen offset:2048 lds
s_mul_i32 s6, s85, 31232
s_add_u32 s6, s6, 65536
v_add_u32 v8, s6, v16
v_mfma_f32_32x32x16_bf16 v[112:127], v[148:151], v[156:159], v[112:127]
buffer_load_dword v254, v231, s[24:27], 0 offen sc1
s_add_u32 s6, s6, 17664
v_add_u32 v9, s6, v17
v_lshlrev_b32 v10, 5, v18
v_mfma_f32_16x16x32_bf16 v[168:171], v[160:163], v[148:151], v[168:171]
s_waitcnt lgkmcnt(3)
v_mfma_f32_32x32x16_bf16 v[64:79], v[128:131], v[136:139], v[64:79]
ds_read_b64_tr_b16 v[144:145], v216 offset:45056
ds_read_b64_tr_b16 v[146:147], v216 offset:46080
s_waitcnt vmcnt(8)
s_cmp_eq_u32 s82, 0
s_cbranch_scc0 L_nb_16
s_barrier
L_nb_16:
buffer_load_dwordx4 v215, s[8:11], s80 offen offset:3072 lds
s_waitcnt lgkmcnt(4)
v_mfma_f32_32x32x16_bf16 v[80:95], v[128:131], v[140:143], v[80:95]
ds_read_b128 v[152:155], v223 offset:49152
ds_read_b128 v[156:159], v223 offset:53248
s_cmp_eq_u32 s82, 1
s_cbranch_scc0 L_nb_17
s_barrier
L_nb_17:
buffer_store_dwordx4 v[174:177], v207, s[24:27], s75 offen sc1
v_mfma_f32_16x16x32_bf16 v[164:167], v[160:163], v[128:131], v[164:167]
s_waitcnt lgkmcnt(4)
v_mfma_f32_32x32x16_bf16 v[96:111], v[132:135], v[136:139], v[96:111]
ds_read_b64_tr_b16 v[148:149], v217 offset:45056
ds_read_b64_tr_b16 v[150:151], v217 offset:46080
s_add_u32 m0, s81, 0
s_add_u32 s79, s79, 221184
buffer_load_dwordx4 v208, s[20:23], s79 offen offset:0 lds
buffer_store_dwordx4 v[178:181], v207, s[24:27], s76 offen sc1
v_mfma_f32_32x32x16_bf16 v[112:127], v[132:135], v[140:143], v[112:127]
v_mfma_f32_16x16x32_bf16 v[168:171], v[160:163], v[132:135], v[168:171]
s_waitcnt lgkmcnt(3)
v_mfma_f32_32x32x16_bf16 v[64:79], v[144:147], v[152:155], v[64:79]
ds_read_b64_tr_b16 v[128:129], v218 offset:0
ds_read_b64_tr_b16 v[130:131], v218 offset:1024
buffer_load_dwordx4 v209, s[20:23], s79 offen offset:1024 lds
v_sub_u32 v10, v9, v10
v_add_u32 v10, 0, v10
s_add_u32 s91, s88, s85
s_waitcnt lgkmcnt(4)
v_mfma_f32_32x32x16_bf16 v[80:95], v[144:147], v[156:159], v[80:95]
ds_read_b128 v[136:139], v224 offset:16384
ds_read_b128 v[140:143], v224 offset:20480
s_and_b32 s46, s88, 0xfffffffe
s_sub_u32 s46, s91, s46
s_cmp_ge_u32 s46, 2
s_cselect_b32 s47, s1, s0
v_mfma_f32_16x16x32_bf16 v[164:167], v[160:163], v[144:147], v[164:167]
s_waitcnt lgkmcnt(4)
v_mfma_f32_32x32x16_bf16 v[96:111], v[148:151], v[152:155], v[96:111]
ds_read_b64_tr_b16 v[132:133], v219 offset:0
ds_read_b64_tr_b16 v[134:135], v219 offset:1024
buffer_load_dwordx4 v210, s[20:23], s79 offen offset:2048 lds
s_and_b32 s46, s46, 1
s_lshl_b32 s46, s46, 4
s_lshr_b32 s47, s47, s46
v_mfma_f32_32x32x16_bf16 v[112:127], v[148:151], v[156:159], v[112:127]
s_and_b32 s47, s47, 0xffff
v_mov_b32 v61, s47
v_and_b32 v19, 15, v1
v_mfma_f32_16x16x32_bf16 v[168:171], v[160:163], v[148:151], v[168:171]
s_waitcnt lgkmcnt(3)
v_mfma_f32_32x32x16_bf16 v[64:79], v[128:131], v[136:139], v[64:79]
ds_read_b64_tr_b16 v[144:145], v218 offset:4096
ds_read_b64_tr_b16 v[146:147], v218 offset:5120
buffer_load_dwordx4 v211, s[20:23], s79 offen offset:3072 lds
v_lshl_add_u32 v19, v18, 2, v19
v_sub_u32 v19, 15, v19
v_cmp_eq_u32 vcc, 0, v19
v_cndmask_b32 v192, 0, v61, vcc
s_waitcnt lgkmcnt(4)
v_mfma_f32_32x32x16_bf16 v[80:95], v[128:131], v[140:143], v[80:95]
ds_read_b128 v[152:155], v225 offset:16384
ds_read_b128 v[156:159], v225 offset:20480
v_cmp_eq_u32 vcc, 1, v19
v_cndmask_b32 v193, 0, v61, vcc
v_cmp_eq_u32 vcc, 2, v19
v_cndmask_b32 v194, 0, v61, vcc
v_mfma_f32_16x16x32_bf16 v[164:167], v[160:163], v[128:131], v[164:167]
s_waitcnt lgkmcnt(4)
v_mfma_f32_32x32x16_bf16 v[96:111], v[132:135], v[136:139], v[96:111]
ds_read_b64_tr_b16 v[148:149], v219 offset:4096
ds_read_b64_tr_b16 v[150:151], v219 offset:5120
s_add_u32 m0, s81, 16384
s_add_u32 s80, s80, 128
buffer_load_dwordx4 v212, s[8:11], s80 offen offset:0 lds
v_cmp_eq_u32 vcc, 3, v19
v_cndmask_b32 v195, 0, v61, vcc
s_lshl_b32 s92, s91, 12
v_mfma_f32_32x32x16_bf16 v[112:127], v[132:135], v[140:143], v[112:127]
s_add_u32 s92, s92, 4194304
v_mfma_f32_16x16x32_bf16 v[168:171], v[160:163], v[132:135], v[168:171]
s_waitcnt lgkmcnt(3)
v_mfma_f32_32x32x16_bf16 v[64:79], v[144:147], v[152:155], v[64:79]
ds_read_b64_tr_b16 v[128:129], v218 offset:8192
ds_read_b64_tr_b16 v[130:131], v218 offset:9216
buffer_load_dwordx4 v213, s[8:11], s80 offen offset:1024 lds
s_waitcnt lgkmcnt(4)
v_mfma_f32_32x32x16_bf16 v[80:95], v[144:147], v[156:159], v[80:95]
ds_read_b128 v[136:139], v226 offset:16384
ds_read_b128 v[140:143], v226 offset:20480
v_mfma_f32_16x16x32_bf16 v[164:167], v[160:163], v[144:147], v[164:167]
s_waitcnt lgkmcnt(4)
v_mfma_f32_32x32x16_bf16 v[96:111], v[148:151], v[152:155], v[96:111]
ds_read_b64_tr_b16 v[132:133], v219 offset:8192
ds_read_b64_tr_b16 v[134:135], v219 offset:9216
buffer_load_dwordx4 v214, s[8:11], s80 offen offset:2048 lds
v_mfma_f32_32x32x16_bf16 v[112:127], v[148:151], v[156:159], v[112:127]
v_mfma_f32_16x16x32_bf16 v[168:171], v[160:163], v[148:151], v[168:171]
s_waitcnt lgkmcnt(3)
v_mfma_f32_32x32x16_bf16 v[64:79], v[128:131], v[136:139], v[64:79]
ds_read_b64_tr_b16 v[144:145], v218 offset:12288
ds_read_b64_tr_b16 v[146:147], v218 offset:13312
s_waitcnt vmcnt(9)
s_cmp_eq_u32 s82, 0
s_cbranch_scc0 L_nb_18
s_barrier
L_nb_18:
buffer_load_dwordx4 v215, s[8:11], s80 offen offset:3072 lds
s_waitcnt lgkmcnt(4)
v_mfma_f32_32x32x16_bf16 v[80:95], v[128:131], v[140:143], v[80:95]
ds_read_b128 v[152:155], v227 offset:16384
ds_read_b128 v[156:159], v227 offset:20480
s_cmp_eq_u32 s82, 1
s_cbranch_scc0 L_nb_19
s_barrier
L_nb_19:
buffer_store_dwordx4 v[182:185], v173, s[24:27], s93 offen sc1
v_mfma_f32_16x16x32_bf16 v[164:167], v[160:163], v[128:131], v[164:167]
s_waitcnt lgkmcnt(4)
v_mfma_f32_32x32x16_bf16 v[96:111], v[132:135], v[136:139], v[96:111]
ds_read_b64_tr_b16 v[148:149], v219 offset:12288
ds_read_b64_tr_b16 v[150:151], v219 offset:13312
s_add_u32 m0, s81, 32768
s_add_u32 s79, s79, 221184
buffer_load_dwordx4 v208, s[20:23], s79 offen offset:0 lds
v_mfma_f32_32x32x16_bf16 v[112:127], v[132:135], v[140:143], v[112:127]
v_mfma_f32_16x16x32_bf16 v[168:171], v[160:163], v[132:135], v[168:171]
s_waitcnt lgkmcnt(3)
v_mfma_f32_32x32x16_bf16 v[64:79], v[144:147], v[152:155], v[64:79]
ds_read_b64_tr_b16 v[128:129], v218 offset:32768
ds_read_b64_tr_b16 v[130:131], v218 offset:33792
buffer_load_dwordx4 v209, s[20:23], s79 offen offset:1024 lds
s_waitcnt lgkmcnt(4)
v_mfma_f32_32x32x16_bf16 v[80:95], v[144:147], v[156:159], v[80:95]
ds_read_b128 v[136:139], v224 offset:49152
ds_read_b128 v[140:143], v224 offset:53248
v_mfma_f32_16x16x32_bf16 v[164:167], v[160:163], v[144:147], v[164:167]
s_waitcnt lgkmcnt(4)
v_mfma_f32_32x32x16_bf16 v[96:111], v[148:151], v[152:155], v[96:111]
ds_read_b64_tr_b16 v[132:133], v219 offset:32768
ds_read_b64_tr_b16 v[134:135], v219 offset:33792
buffer_load_dwordx4 v210, s[20:23], s79 offen offset:2048 lds
v_mfma_f32_32x32x16_bf16 v[112:127], v[148:151], v[156:159], v[112:127]
v_mfma_f32_16x16x32_bf16 v[168:171], v[160:163], v[148:151], v[168:171]
s_waitcnt lgkmcnt(3)
v_mfma_f32_32x32x16_bf16 v[64:79], v[128:131], v[136:139], v[64:79]
ds_read_b64_tr_b16 v[144:145], v218 offset:36864
ds_read_b64_tr_b16 v[146:147], v218 offset:37888
buffer_load_dwordx4 v211, s[20:23], s79 offen offset:3072 lds
s_waitcnt lgkmcnt(4)
v_mfma_f32_32x32x16_bf16 v[80:95], v[128:131], v[140:143], v[80:95]
ds_read_b128 v[152:155], v225 offset:49152
ds_read_b128 v[156:159], v225 offset:53248
v_mfma_f32_16x16x32_bf16 v[164:167], v[160:163], v[128:131], v[164:167]
s_waitcnt lgkmcnt(4)
v_mfma_f32_32x32x16_bf16 v[96:111], v[132:135], v[136:139], v[96:111]
ds_read_b64_tr_b16 v[148:149], v219 offset:36864
ds_read_b64_tr_b16 v[150:151], v219 offset:37888
s_add_u32 m0, s81, 49152
s_add_u32 s80, s80, 128
buffer_load_dwordx4 v212, s[8:11], s80 offen offset:0 lds
v_mfma_f32_32x32x16_bf16 v[112:127], v[132:135], v[140:143], v[112:127]
v_mfma_f32_16x16x32_bf16 v[168:171], v[160:163], v[132:135], v[168:171]
s_waitcnt lgkmcnt(3)
v_mfma_f32_32x32x16_bf16 v[64:79], v[144:147], v[152:155], v[64:79]
ds_read_b64_tr_b16 v[128:129], v218 offset:40960
ds_read_b64_tr_b16 v[130:131], v218 offset:41984
buffer_load_dwordx4 v213, s[8:11], s80 offen offset:1024 lds
s_waitcnt lgkmcnt(4)
v_mfma_f32_32x32x16_bf16 v[80:95], v[144:147], v[156:159], v[80:95]
ds_read_b128 v[136:139], v226 offset:49152
ds_read_b128 v[140:143], v226 offset:53248
v_mfma_f32_16x16x32_bf16 v[164:167], v[160:163], v[144:147], v[164:167]
s_waitcnt lgkmcnt(4)
v_mfma_f32_32x32x16_bf16 v[96:111], v[148:151], v[152:155], v[96:111]
ds_read_b64_tr_b16 v[132:133], v219 offset:40960
ds_read_b64_tr_b16 v[134:135], v219 offset:41984
buffer_load_dwordx4 v214, s[8:11], s80 offen offset:2048 lds
v_mfma_f32_32x32x16_bf16 v[112:127], v[148:151], v[156:159], v[112:127]
v_mfma_f32_16x16x32_bf16 v[168:171], v[160:163], v[148:151], v[168:171]
s_waitcnt lgkmcnt(3)
v_mfma_f32_32x32x16_bf16 v[64:79], v[128:131], v[136:139], v[64:79]
ds_read_b64_tr_b16 v[144:145], v218 offset:45056
ds_read_b64_tr_b16 v[146:147], v218 offset:46080
s_waitcnt vmcnt(8)
s_cmp_lg_u32 s5, 0
s_cbranch_scc1 L_back_21
v_cmp_eq_u32 vcc, 0, v254
s_cbranch_vccnz L_slow_20
L_back_21:
s_cmp_eq_u32 s82, 0
s_cbranch_scc0 L_nb_22
s_barrier
L_nb_22:
buffer_load_dwordx4 v215, s[8:11], s80 offen offset:3072 lds
s_waitcnt lgkmcnt(4)
v_mfma_f32_32x32x16_bf16 v[80:95], v[128:131], v[140:143], v[80:95]
ds_read_b128 v[152:155], v227 offset:49152
ds_read_b128 v[156:159], v227 offset:53248
s_cmp_eq_u32 s82, 1
s_cbranch_scc0 L_nb_23
s_barrier
L_nb_23:
s_mov_b32 s36, s56
s_and_b32 s37, s57, 0xffff
s_mov_b32 s38, 3456
s_mov_b32 s39, 0x20000
v_and_b32 v2, 31, v1
s_lshl_b32 s6, s78, 7
s_lshl_b32 s7, s82, 6
s_add_u32 s6, s6, s7
v_add_u32 v3, s6, v2
v_lshlrev_b32 v3, 1, v3
s_cmp_ge_u32 s6, 1728
s_cselect_b32 s101, 0, 32
s_lshl_b32 s6, s77, 7
s_lshl_b32 s7, s83, 6
s_add_u32 s6, s6, s7
v_add_u32 v4, s6, v2
v_lshlrev_b32 v4, 4, v4
v_mov_b32 v5, 2147418112
v_cmp_gt_u32 vcc, 32, v1
v_cndmask_b32 v3, v5, v3, vcc
v_cndmask_b32 v5, v5, v4, vcc
s_mov_b32 s7, 65536
s_mov_b32 s84, 98304
buffer_load_ushort v28, v3, s[36:39], 0 offen
buffer_load_ushort v32, v3, s[36:39], 0 offen offset:64
buffer_load_dwordx4 v[36:39], v5, s[24:27], s7 offen
buffer_load_dwordx4 v[40:43], v5, s[24:27], s7 offen offset:512
buffer_load_dwordx4 v[44:47], v4, s[24:27], s84 offen
buffer_load_dwordx4 v[48:51], v4, s[24:27], s84 offen offset:512
v_mfma_f32_16x16x32_bf16 v[164:167], v[160:163], v[128:131], v[164:167]
s_waitcnt lgkmcnt(4)
v_mfma_f32_32x32x16_bf16 v[96:111], v[132:135], v[136:139], v[96:111]
ds_read_b64_tr_b16 v[148:149], v219 offset:45056
ds_read_b64_tr_b16 v[150:151], v219 offset:46080
s_mov_b32 s32, s48
s_and_b32 s33, s49, 0xffff
s_mov_b32 s34, 2621440
s_mov_b32 s35, 0x20000
s_lshl_b32 s6, s88, 5
s_mul_i32 s7, s5, 24
s_add_u32 s6, s6, s7
v_add_u32 v2, s6, v1
v_lshlrev_b32 v235, 7, v2
s_mov_b32 exec_lo, 0xffffff
s_mov_b32 exec_hi, 0x0
buffer_load_dword v234, v235, s[32:35], 0 offen
s_mov_b64 exec, -1
v_mfma_f32_32x32x16_bf16 v[112:127], v[132:135], v[140:143], v[112:127]
v_mfma_f32_16x16x32_bf16 v[168:171], v[160:163], v[132:135], v[168:171]
s_waitcnt lgkmcnt(3)
v_mfma_f32_32x32x16_bf16 v[64:79], v[144:147], v[152:155], v[64:79]
ds_read_b64_tr_b16 v[128:129], v216 offset:0
ds_read_b64_tr_b16 v[130:131], v216 offset:1024
s_lshl_b32 s6, s5, 2
v_lshlrev_b32 v202, 2, v1
v_add_u32 v202, s6, v202
v_subrev_u32 v202, 252, v202
v_add_u32 v203, s6, v248
s_waitcnt lgkmcnt(4)
v_mfma_f32_32x32x16_bf16 v[80:95], v[144:147], v[156:159], v[80:95]
ds_read_b128 v[136:139], v220 offset:16384
ds_read_b128 v[140:143], v220 offset:20480
v_add_u32 v203, 4, v203
s_mul_i32 s90, s5, 4416
s_lshr_b32 s6, s4, 3
s_mul_i32 s6, s6, 14
s_and_b32 s7, s4, 7
v_mfma_f32_16x16x32_bf16 v[164:167], v[160:163], v[144:147], v[164:167]
s_waitcnt lgkmcnt(4)
v_mfma_f32_32x32x16_bf16 v[96:111], v[148:151], v[152:155], v[96:111]
ds_read_b64_tr_b16 v[132:133], v217 offset:0
ds_read_b64_tr_b16 v[134:135], v217 offset:1024
s_mul_i32 s7, s7, 7
s_add_u32 s6, s6, s7
s_lshr_b32 s6, s6, 2
s_cmp_ge_u32 s5, 2
s_cselect_b32 s43, 13, 14
v_mfma_f32_32x32x16_bf16 v[112:127], v[148:151], v[156:159], v[112:127]
s_cmp_ge_u32 s6, s43
s_cselect_b32 s7, s43, 0
s_sub_u32 s93, s6, s7
s_mov_b32 s93, 0
s_mul_i32 s6, s95, 54
v_mfma_f32_16x16x32_bf16 v[168:171], v[160:163], v[148:151], v[168:171]
s_waitcnt lgkmcnt(3)
v_mfma_f32_32x32x16_bf16 v[64:79], v[128:131], v[136:139], v[64:79]
ds_read_b64_tr_b16 v[144:145], v216 offset:4096
ds_read_b64_tr_b16 v[146:147], v216 offset:5120
s_add_u32 s6, s6, s96
s_mul_i32 s79, s6, 5120
s_add_u32 s79, s79, 7340032
s_mul_i32 s7, s43, 5120
s_add_u32 s80, s79, s7
s_waitcnt lgkmcnt(4)
v_mfma_f32_32x32x16_bf16 v[80:95], v[128:131], v[140:143], v[80:95]
ds_read_b128 v[152:155], v221 offset:16384
ds_read_b128 v[156:159], v221 offset:20480
s_mul_i32 s7, s93, 5120
s_add_u32 s97, s79, s7
s_add_u32 s98, s97, 4096
s_cmp_eq_u32 s5, 2
s_cselect_b32 s7, 4294890496, 0
v_mfma_f32_16x16x32_bf16 v[164:167], v[160:163], v[128:131], v[164:167]
s_waitcnt lgkmcnt(4)
v_mfma_f32_32x32x16_bf16 v[96:111], v[132:135], v[136:139], v[96:111]
ds_read_b64_tr_b16 v[148:149], v217 offset:4096
ds_read_b64_tr_b16 v[150:151], v217 offset:5120
s_cmp_eq_u32 s5, 3
s_cselect_b32 s7, 4294895616, s7
s_add_u32 s79, s79, s7
v_and_b32 v2, 15, v1
v_lshrrev_b32 v3, 3, v2
v_mfma_f32_32x32x16_bf16 v[112:127], v[132:135], v[140:143], v[112:127]
v_lshlrev_b32 v3, 3, v3
v_and_b32 v4, 1, v2
v_lshl_or_b32 v3, v4, 2, v3
v_bfe_u32 v4, v2, 1, 2
v_or_b32 v3, v3, v4
v_mfma_f32_16x16x32_bf16 v[168:171], v[160:163], v[132:135], v[168:171]
s_waitcnt lgkmcnt(3)
v_mfma_f32_32x32x16_bf16 v[64:79], v[144:147], v[152:155], v[64:79]
ds_read_b64_tr_b16 v[128:129], v216 offset:8192
ds_read_b64_tr_b16 v[130:131], v216 offset:9216
v_lshlrev_b32 v3, 4, v3
v_bfe_u32 v4, v1, 4, 1
v_lshl_or_b32 v3, v4, 10, v3
v_lshrrev_b32 v4, 5, v1
v_lshl_or_b32 v3, v4, 8, v3
s_waitcnt lgkmcnt(4)
v_mfma_f32_32x32x16_bf16 v[80:95], v[144:147], v[156:159], v[80:95]
ds_read_b128 v[136:139], v222 offset:16384
ds_read_b128 v[140:143], v222 offset:20480
v_mov_b32 v4, 2147418112
s_cmp_eq_u32 s101, 0
s_cselect_b64 vcc, -1, 0
v_cndmask_b32 v60, v3, v4, vcc
s_lshl_b32 s6, s77, 1
v_mfma_f32_16x16x32_bf16 v[164:167], v[160:163], v[144:147], v[164:167]
s_waitcnt lgkmcnt(4)
v_mfma_f32_32x32x16_bf16 v[96:111], v[148:151], v[152:155], v[96:111]
ds_read_b64_tr_b16 v[132:133], v217 offset:8192
ds_read_b64_tr_b16 v[134:135], v217 offset:9216
s_add_u32 s6, s6, s83
s_mul_i32 s6, s6, 54
s_lshl_b32 s7, s78, 2
s_add_u32 s6, s6, s7
s_lshl_b32 s7, s82, 1
v_mfma_f32_32x32x16_bf16 v[112:127], v[148:151], v[156:159], v[112:127]
s_add_u32 s6, s6, s7
s_lshl_b32 s6, s6, 12
s_add_u32 s100, s6, 10485760
s_add_u32 s101, s100, 4096
v_mfma_f32_16x16x32_bf16 v[168:171], v[160:163], v[148:151], v[168:171]
s_waitcnt lgkmcnt(3)
v_mfma_f32_32x32x16_bf16 v[64:79], v[128:131], v[136:139], v[64:79]
ds_read_b64_tr_b16 v[144:145], v216 offset:12288
ds_read_b64_tr_b16 v[146:147], v216 offset:13312
s_waitcnt vmcnt(7)
s_cmp_eq_u32 s82, 0
s_cbranch_scc0 L_nb_24
s_barrier
L_nb_24:
s_waitcnt lgkmcnt(4)
v_mfma_f32_32x32x16_bf16 v[80:95], v[128:131], v[140:143], v[80:95]
ds_read_b128 v[152:155], v223 offset:16384
ds_read_b128 v[156:159], v223 offset:20480
s_cmp_eq_u32 s82, 1
s_cbranch_scc0 L_nb_25
s_barrier
L_nb_25:
s_cmp_lg_u32 s5, 0
s_cbranch_scc1 L_fl_26
s_mov_b64 exec, 1
buffer_store_dword v253, v252, s[24:27], 0 offen offset:12 sc1
s_mov_b64 exec, -1
L_fl_26:
v_mfma_f32_16x16x32_bf16 v[164:167], v[160:163], v[128:131], v[164:167]
s_waitcnt lgkmcnt(4)
v_mfma_f32_32x32x16_bf16 v[96:111], v[132:135], v[136:139], v[96:111]
ds_read_b64_tr_b16 v[148:149], v217 offset:12288
ds_read_b64_tr_b16 v[150:151], v217 offset:13312
s_add_u32 s6, s88, 0
s_lshl_b32 s6, s6, 12
s_add_u32 s32, s48, s6
s_addc_u32 s33, s49, 0
s_and_b32 s33, s33, 0xffff
s_mov_b32 s34, 4096
s_mov_b32 s35, 0x20000
s_add_u32 m0, s90, 65536
s_nop 0
buffer_load_dword v202, s[32:35], 0 offen lds
s_add_u32 m0, s90, 65792
s_nop 0
v_mfma_f32_32x32x16_bf16 v[112:127], v[132:135], v[140:143], v[112:127]
buffer_load_dwordx4 v203, s[32:35], 0 offen offset:0 lds
v_mfma_f32_16x16x32_bf16 v[168:171], v[160:163], v[132:135], v[168:171]
s_waitcnt lgkmcnt(3)
v_mfma_f32_32x32x16_bf16 v[64:79], v[144:147], v[152:155], v[64:79]
ds_read_b64_tr_b16 v[128:129], v216 offset:32768
ds_read_b64_tr_b16 v[130:131], v216 offset:33792
v_lshlrev_b32 v5, 4, v0
v_add_u32 v5, 87808, v5
v_add_u32 v7, 62464, v5
v_mov_b32 v12, 0
buffer_load_dwordx4 v203, s[32:35], 0 offen offset:1024 lds
s_waitcnt lgkmcnt(4)
v_mfma_f32_32x32x16_bf16 v[80:95], v[144:147], v[156:159], v[80:95]
ds_read_b128 v[136:139], v220 offset:49152
ds_read_b128 v[140:143], v220 offset:53248
v_mov_b32 v13, 0
v_mov_b32 v14, 0
v_mov_b32 v15, 0
buffer_load_dwordx4 v203, s[32:35], 0 offen offset:2048 lds
v_mfma_f32_16x16x32_bf16 v[164:167], v[160:163], v[144:147], v[164:167]
s_waitcnt lgkmcnt(4)
v_mfma_f32_32x32x16_bf16 v[96:111], v[148:151], v[152:155], v[96:111]
ds_read_b64_tr_b16 v[132:133], v217 offset:32768
ds_read_b64_tr_b16 v[134:135], v217 offset:33792
v_cmp_gt_u32 vcc, 126, v0
s_and_saveexec_b64 s[6:7], vcc
ds_write_b128 v5, v[12:15] offset:0
ds_write_b128 v5, v[12:15] offset:6784
ds_write_b128 v5, v[12:15] offset:31232
ds_write_b128 v5, v[12:15] offset:38016
ds_write_b128 v7, v[12:15] offset:0
ds_write_b128 v7, v[12:15] offset:6784
s_mov_b64 exec, s[6:7]
v_mfma_f32_32x32x16_bf16 v[112:127], v[148:151], v[156:159], v[112:127]
buffer_load_dwordx4 v203, s[32:35], 0 offen offset:3072 lds
v_mfma_f32_16x16x32_bf16 v[168:171], v[160:163], v[148:151], v[168:171]
s_waitcnt lgkmcnt(9)
v_mfma_f32_32x32x16_bf16 v[64:79], v[128:131], v[136:139], v[64:79]
ds_read_b64_tr_b16 v[144:145], v216 offset:36864
ds_read_b64_tr_b16 v[146:147], v216 offset:37888
s_add_u32 s6, s88, 1
s_lshl_b32 s6, s6, 12
s_add_u32 s32, s48, s6
s_addc_u32 s33, s49, 0
s_and_b32 s33, s33, 0xffff
s_mov_b32 s34, 4096
s_mov_b32 s35, 0x20000
s_add_u32 m0, s90, 96768
s_nop 0
buffer_load_dword v202, s[32:35], 0 offen lds
s_add_u32 m0, s90, 97024
s_nop 0
s_waitcnt lgkmcnt(10)
v_mfma_f32_32x32x16_bf16 v[80:95], v[128:131], v[140:143], v[80:95]
ds_read_b128 v[152:155], v221 offset:49152
ds_read_b128 v[156:159], v221 offset:53248
buffer_load_dwordx4 v203, s[32:35], 0 offen offset:0 lds
v_mfma_f32_16x16x32_bf16 v[164:167], v[160:163], v[128:131], v[164:167]
s_waitcnt lgkmcnt(10)
v_mfma_f32_32x32x16_bf16 v[96:111], v[132:135], v[136:139], v[96:111]
ds_read_b64_tr_b16 v[148:149], v217 offset:36864
ds_read_b64_tr_b16 v[150:151], v217 offset:37888
buffer_load_dwordx4 v203, s[32:35], 0 offen offset:1024 lds
v_mfma_f32_32x32x16_bf16 v[112:127], v[132:135], v[140:143], v[112:127]
buffer_load_dwordx4 v203, s[32:35], 0 offen offset:2048 lds
v_mfma_f32_16x16x32_bf16 v[168:171], v[160:163], v[132:135], v[168:171]
s_waitcnt lgkmcnt(3)
v_mfma_f32_32x32x16_bf16 v[64:79], v[144:147], v[152:155], v[64:79]
ds_read_b64_tr_b16 v[128:129], v216 offset:40960
ds_read_b64_tr_b16 v[130:131], v216 offset:41984
buffer_load_dwordx4 v203, s[32:35], 0 offen offset:3072 lds
s_waitcnt lgkmcnt(4)
v_mfma_f32_32x32x16_bf16 v[80:95], v[144:147], v[156:159], v[80:95]
ds_read_b128 v[136:139], v222 offset:49152
ds_read_b128 v[140:143], v222 offset:53248
s_add_u32 s6, s88, 2
s_lshl_b32 s6, s6, 12
s_add_u32 s32, s48, s6
s_addc_u32 s33, s49, 0
s_and_b32 s33, s33, 0xffff
s_mov_b32 s34, 4096
s_mov_b32 s35, 0x20000
s_add_u32 m0, s90, 128000
s_nop 0
buffer_load_dword v202, s[32:35], 0 offen lds
s_add_u32 m0, s90, 128256
s_nop 0
v_mfma_f32_16x16x32_bf16 v[164:167], v[160:163], v[144:147], v[164:167]
s_waitcnt lgkmcnt(4)
v_mfma_f32_32x32x16_bf16 v[96:111], v[148:151], v[152:155], v[96:111]
ds_read_b64_tr_b16 v[132:133], v217 offset:40960
ds_read_b64_tr_b16 v[134:135], v217 offset:41984
buffer_load_dwordx4 v203, s[32:35], 0 offen offset:0 lds
v_mfma_f32_32x32x16_bf16 v[112:127], v[148:151], v[156:159], v[112:127]
buffer_load_dwordx4 v203, s[32:35], 0 offen offset:1024 lds
v_mfma_f32_16x16x32_bf16 v[168:171], v[160:163], v[148:151], v[168:171]
s_waitcnt lgkmcnt(3)
v_mfma_f32_32x32x16_bf16 v[64:79], v[128:131], v[136:139], v[64:79]
ds_read_b64_tr_b16 v[144:145], v216 offset:45056
ds_read_b64_tr_b16 v[146:147], v216 offset:46080
buffer_load_dwordx4 v203, s[32:35], 0 offen offset:2048 lds
s_waitcnt lgkmcnt(4)
v_mfma_f32_32x32x16_bf16 v[80:95], v[128:131], v[140:143], v[80:95]
ds_read_b128 v[152:155], v223 offset:49152
ds_read_b128 v[156:159], v223 offset:53248
buffer_load_dwordx4 v203, s[32:35], 0 offen offset:3072 lds
v_mfma_f32_16x16x32_bf16 v[164:167], v[160:163], v[128:131], v[164:167]
s_waitcnt lgkmcnt(4)
v_mfma_f32_32x32x16_bf16 v[96:111], v[132:135], v[136:139], v[96:111]
ds_read_b64_tr_b16 v[148:149], v217 offset:45056
ds_read_b64_tr_b16 v[150:151], v217 offset:46080
v_mfma_f32_32x32x16_bf16 v[112:127], v[132:135], v[140:143], v[112:127]
v_mfma_f32_16x16x32_bf16 v[168:171], v[160:163], v[132:135], v[168:171]
s_waitcnt lgkmcnt(3)
v_mfma_f32_32x32x16_bf16 v[64:79], v[144:147], v[152:155], v[64:79]
s_waitcnt lgkmcnt(2)
v_mfma_f32_32x32x16_bf16 v[80:95], v[144:147], v[156:159], v[80:95]
v_mfma_f32_16x16x32_bf16 v[164:167], v[160:163], v[144:147], v[164:167]
s_waitcnt lgkmcnt(0)
v_mfma_f32_32x32x16_bf16 v[96:111], v[148:151], v[152:155], v[96:111]
v_mfma_f32_32x32x16_bf16 v[112:127], v[148:151], v[156:159], v[112:127]
v_mfma_f32_16x16x32_bf16 v[168:171], v[160:163], v[148:151], v[168:171]
s_waitcnt vmcnt(16)
s_nop 7
v_lshl_or_b32 v28, v28, 16, v28
v_cvt_pk_bf16_f32 v29, v164, v164
v_lshlrev_b32 v2, 16, v29
v_sub_f32 v2, v164, v2
v_cvt_pk_bf16_f32 v30, v2, v2
v_mov_b32 v31, 0
v_lshl_or_b32 v32, v32, 16, v32
v_cvt_pk_bf16_f32 v33, v168, v168
v_lshlrev_b32 v2, 16, v33
v_sub_f32 v2, v168, v2
v_cvt_pk_bf16_f32 v34, v2, v2
v_mov_b32 v35, 0
s_nop 1
v_mfma_f32_32x32x16_bf16 v[64:79], v[28:31], v[36:39], v[64:79]
v_mfma_f32_32x32x16_bf16 v[80:95], v[28:31], v[40:43], v[80:95]
v_mfma_f32_32x32x16_bf16 v[96:111], v[32:35], v[36:39], v[96:111]
v_mfma_f32_32x32x16_bf16 v[112:127], v[32:35], v[40:43], v[112:127]
v_mul_f32 v52, -2.302208198144325, v45
v_mul_f32 v2, v45, v45
v_mul_f32 v2, v2, v45
v_mul_f32 v53, -0.1029432395800235, v2
v_mov_b32 v54, v46
v_mov_b32 v55, v46
v_mul_f32 v56, -2.302208198144325, v49
v_mul_f32 v2, v49, v49
v_mul_f32 v2, v2, v49
v_mul_f32 v57, -0.1029432395800235, v2
v_mov_b32 v58, v50
v_mov_b32 v59, v50
buffer_load_dword v251, v229, s[24:27], 0 offen sc1
buffer_load_dword v254, v228, s[24:27], 0 offen sc1
v_pk_mul_f32 v[160:161], v[64:65], v[64:65]
v_pk_mul_f32 v[162:163], v[66:67], v[66:67]
v_pk_mul_f32 v[164:165], v[68:69], v[68:69]
v_pk_mul_f32 v[166:167], v[70:71], v[70:71]
v_pk_fma_f32 v[160:161], v[160:161], v[52:53], v[52:53] op_sel:[0,1,0] op_sel_hi:[1,1,0]
v_pk_fma_f32 v[162:163], v[162:163], v[52:53], v[52:53] op_sel:[0,1,0] op_sel_hi:[1,1,0]
v_pk_fma_f32 v[164:165], v[164:165], v[52:53], v[52:53] op_sel:[0,1,0] op_sel_hi:[1,1,0]
v_pk_fma_f32 v[166:167], v[166:167], v[52:53], v[52:53] op_sel:[0,1,0] op_sel_hi:[1,1,0]
v_pk_mul_f32 v[160:161], v[160:161], v[64:65]
v_pk_mul_f32 v[162:163], v[162:163], v[66:67]
v_pk_mul_f32 v[164:165], v[164:165], v[68:69]
v_pk_mul_f32 v[166:167], v[166:167], v[70:71]
v_exp_f32 v160, v160
v_exp_f32 v161, v161
v_exp_f32 v162, v162
v_exp_f32 v163, v163
v_exp_f32 v164, v164
v_exp_f32 v165, v165
v_exp_f32 v166, v166
v_exp_f32 v167, v167
v_pk_fma_f32 v[160:161], v[160:161], v[54:55], v[54:55]
v_pk_fma_f32 v[162:163], v[162:163], v[54:55], v[54:55]
v_pk_fma_f32 v[164:165], v[164:165], v[54:55], v[54:55]
v_pk_fma_f32 v[166:167], v[166:167], v[54:55], v[54:55]
v_rcp_f32 v160, v160
v_rcp_f32 v161, v161
v_rcp_f32 v162, v162
v_rcp_f32 v163, v163
v_rcp_f32 v164, v164
v_rcp_f32 v165, v165
v_rcp_f32 v166, v166
v_rcp_f32 v167, v167
v_pk_mul_f32 v[160:161], v[160:161], v[64:65]
v_pk_mul_f32 v[162:163], v[162:163], v[66:67]
v_pk_mul_f32 v[164:165], v[164:165], v[68:69]
v_pk_mul_f32 v[166:167], v[166:167], v[70:71]
v_cvt_pk_bf16_f32 v64, v160, v161
v_cvt_pk_bf16_f32 v65, v162, v163
v_cvt_pk_bf16_f32 v66, v164, v165
v_cvt_pk_bf16_f32 v67, v166, v167
buffer_store_dwordx4 v[64:67], v60, s[24:27], s100 offen offset:0 sc1
v_pk_mul_f32 v[160:161], v[72:73], v[72:73]
v_pk_mul_f32 v[162:163], v[74:75], v[74:75]
v_pk_mul_f32 v[164:165], v[76:77], v[76:77]
v_pk_mul_f32 v[166:167], v[78:79], v[78:79]
v_pk_fma_f32 v[160:161], v[160:161], v[52:53], v[52:53] op_sel:[0,1,0] op_sel_hi:[1,1,0]
v_pk_fma_f32 v[162:163], v[162:163], v[52:53], v[52:53] op_sel:[0,1,0] op_sel_hi:[1,1,0]
v_pk_fma_f32 v[164:165], v[164:165], v[52:53], v[52:53] op_sel:[0,1,0] op_sel_hi:[1,1,0]
v_pk_fma_f32 v[166:167], v[166:167], v[52:53], v[52:53] op_sel:[0,1,0] op_sel_hi:[1,1,0]
v_pk_mul_f32 v[160:161], v[160:161], v[72:73]
v_pk_mul_f32 v[162:163], v[162:163], v[74:75]
v_pk_mul_f32 v[164:165], v[164:165], v[76:77]
v_pk_mul_f32 v[166:167], v[166:167], v[78:79]
v_exp_f32 v160, v160
v_exp_f32 v161, v161
v_exp_f32 v162, v162
v_exp_f32 v163, v163
v_exp_f32 v164, v164
v_exp_f32 v165, v165
v_exp_f32 v166, v166
v_exp_f32 v167, v167
v_pk_fma_f32 v[160:161], v[160:161], v[54:55], v[54:55]
v_pk_fma_f32 v[162:163], v[162:163], v[54:55], v[54:55]
v_pk_fma_f32 v[164:165], v[164:165], v[54:55], v[54:55]
v_pk_fma_f32 v[166:167], v[166:167], v[54:55], v[54:55]
v_rcp_f32 v160, v160
v_rcp_f32 v161, v161
v_rcp_f32 v162, v162
v_rcp_f32 v163, v163
v_rcp_f32 v164, v164
v_rcp_f32 v165, v165
v_rcp_f32 v166, v166
v_rcp_f32 v167, v167
v_pk_mul_f32 v[160:161], v[160:161], v[72:73]
v_pk_mul_f32 v[162:163], v[162:163], v[74:75]
v_pk_mul_f32 v[164:165], v[164:165], v[76:77]
v_pk_mul_f32 v[166:167], v[166:167], v[78:79]
v_cvt_pk_bf16_f32 v72, v160, v161
v_cvt_pk_bf16_f32 v73, v162, v163
v_cvt_pk_bf16_f32 v74, v164, v165
v_cvt_pk_bf16_f32 v75, v166, v167
buffer_store_dwordx4 v[72:75], v60, s[24:27], s100 offen offset:512 sc1
v_pk_mul_f32 v[160:161], v[80:81], v[80:81]
v_pk_mul_f32 v[162:163], v[82:83], v[82:83]
v_pk_mul_f32 v[164:165], v[84:85], v[84:85]
v_pk_mul_f32 v[166:167], v[86:87], v[86:87]
v_pk_fma_f32 v[160:161], v[160:161], v[56:57], v[56:57] op_sel:[0,1,0] op_sel_hi:[1,1,0]
v_pk_fma_f32 v[162:163], v[162:163], v[56:57], v[56:57] op_sel:[0,1,0] op_sel_hi:[1,1,0]
v_pk_fma_f32 v[164:165], v[164:165], v[56:57], v[56:57] op_sel:[0,1,0] op_sel_hi:[1,1,0]
v_pk_fma_f32 v[166:167], v[166:167], v[56:57], v[56:57] op_sel:[0,1,0] op_sel_hi:[1,1,0]
v_pk_mul_f32 v[160:161], v[160:161], v[80:81]
v_pk_mul_f32 v[162:163], v[162:163], v[82:83]
v_pk_mul_f32 v[164:165], v[164:165], v[84:85]
v_pk_mul_f32 v[166:167], v[166:167], v[86:87]
v_exp_f32 v160, v160
v_exp_f32 v161, v161
v_exp_f32 v162, v162
v_exp_f32 v163, v163
v_exp_f32 v164, v164
v_exp_f32 v165, v165
v_exp_f32 v166, v166
v_exp_f32 v167, v167
v_pk_fma_f32 v[160:161], v[160:161], v[58:59], v[58:59]
v_pk_fma_f32 v[162:163], v[162:163], v[58:59], v[58:59]
v_pk_fma_f32 v[164:165], v[164:165], v[58:59], v[58:59]
v_pk_fma_f32 v[166:167], v[166:167], v[58:59], v[58:59]
v_rcp_f32 v160, v160
v_rcp_f32 v161, v161
v_rcp_f32 v162, v162
v_rcp_f32 v163, v163
v_rcp_f32 v164, v164
v_rcp_f32 v165, v165
v_rcp_f32 v166, v166
v_rcp_f32 v167, v167
v_pk_mul_f32 v[160:161], v[160:161], v[80:81]
v_pk_mul_f32 v[162:163], v[162:163], v[82:83]
v_pk_mul_f32 v[164:165], v[164:165], v[84:85]
v_pk_mul_f32 v[166:167], v[166:167], v[86:87]
v_cvt_pk_bf16_f32 v80, v160, v161
v_cvt_pk_bf16_f32 v81, v162, v163
v_cvt_pk_bf16_f32 v82, v164, v165
v_cvt_pk_bf16_f32 v83, v166, v167
buffer_store_dwordx4 v[80:83], v60, s[24:27], s100 offen offset:2048 sc1
s_waitcnt vmcnt(4)
v_cmp_eq_u32 vcc, 0, v251
s_cbranch_vccnz L_slow_27
L_back_28:
v_lshlrev_b32 v4, 4, v0
s_add_u32 s6, s88, 0
s_lshl_b32 s6, s6, 12
s_add_u32 s6, s6, 1048576
s_add_u32 s36, s66, s6
s_addc_u32 s37, s67, 0
s_and_b32 s37, s37, 0xffff
s_mov_b32 s38, 4096
s_mov_b32 s39, 0x20000
buffer_load_dwordx4 v[32:35], v4, s[36:39], 0 offen
buffer_load_dword v36, v4, s[36:39], 0 offen offset:16
s_add_u32 s6, s88, 1
s_lshl_b32 s6, s6, 12
s_add_u32 s6, s6, 1048576
s_add_u32 s36, s66, s6
s_addc_u32 s37, s67, 0
s_and_b32 s37, s37, 0xffff
s_mov_b32 s38, 4096
s_mov_b32 s39, 0x20000
buffer_load_dwordx4 v[38:41], v4, s[36:39], 0 offen
buffer_load_dword v42, v4, s[36:39], 0 offen offset:16
s_add_u32 s6, s88, 2
s_lshl_b32 s6, s6, 12
s_add_u32 s6, s6, 1048576
s_add_u32 s36, s66, s6
s_addc_u32 s37, s67, 0
s_and_b32 s37, s37, 0xffff
s_mov_b32 s38, 4096
s_mov_b32 s39, 0x20000
buffer_load_dwordx4 v[44:47], v4, s[36:39], 0 offen
buffer_load_dword v48, v4, s[36:39], 0 offen offset:16
v_pk_mul_f32 v[160:161], v[88:89], v[88:89]
v_pk_mul_f32 v[162:163], v[90:91], v[90:91]
v_pk_mul_f32 v[164:165], v[92:93], v[92:93]
v_pk_mul_f32 v[166:167], v[94:95], v[94:95]
v_pk_fma_f32 v[160:161], v[160:161], v[56:57], v[56:57] op_sel:[0,1,0] op_sel_hi:[1,1,0]
v_pk_fma_f32 v[162:163], v[162:163], v[56:57], v[56:57] op_sel:[0,1,0] op_sel_hi:[1,1,0]
v_pk_fma_f32 v[164:165], v[164:165], v[56:57], v[56:57] op_sel:[0,1,0] op_sel_hi:[1,1,0]
v_pk_fma_f32 v[166:167], v[166:167], v[56:57], v[56:57] op_sel:[0,1,0] op_sel_hi:[1,1,0]
v_pk_mul_f32 v[160:161], v[160:161], v[88:89]
v_pk_mul_f32 v[162:163], v[162:163], v[90:91]
v_pk_mul_f32 v[164:165], v[164:165], v[92:93]
v_pk_mul_f32 v[166:167], v[166:167], v[94:95]
v_exp_f32 v160, v160
v_exp_f32 v161, v161
v_exp_f32 v162, v162
v_exp_f32 v163, v163
v_exp_f32 v164, v164
v_exp_f32 v165, v165
v_exp_f32 v166, v166
v_exp_f32 v167, v167
v_pk_fma_f32 v[160:161], v[160:161], v[58:59], v[58:59]
v_pk_fma_f32 v[162:163], v[162:163], v[58:59], v[58:59]
v_pk_fma_f32 v[164:165], v[164:165], v[58:59], v[58:59]
v_pk_fma_f32 v[166:167], v[166:167], v[58:59], v[58:59]
v_rcp_f32 v160, v160
v_rcp_f32 v161, v161
v_rcp_f32 v162, v162
v_rcp_f32 v163, v163
v_rcp_f32 v164, v164
v_rcp_f32 v165, v165
v_rcp_f32 v166, v166
v_rcp_f32 v167, v167
v_pk_mul_f32 v[160:161], v[160:161], v[88:89]
v_pk_mul_f32 v[162:163], v[162:163], v[90:91]
v_pk_mul_f32 v[164:165], v[164:165], v[92:93]
v_pk_mul_f32 v[166:167], v[166:167], v[94:95]
v_cvt_pk_bf16_f32 v88, v160, v161
v_cvt_pk_bf16_f32 v89, v162, v163
v_cvt_pk_bf16_f32 v90, v164, v165
v_cvt_pk_bf16_f32 v91, v166, v167
buffer_store_dwordx4 v[88:91], v60, s[24:27], s100 offen offset:2560 sc1
s_waitcnt vmcnt(10)
v_cmp_eq_u32 vcc, 0, v254
s_cbranch_vccnz L_slow_29
L_back_30:
v_pk_mul_f32 v[160:161], v[96:97], v[96:97]
v_pk_mul_f32 v[162:163], v[98:99], v[98:99]
v_pk_mul_f32 v[164:165], v[100:101], v[100:101]
v_pk_mul_f32 v[166:167], v[102:103], v[102:103]
buffer_load_dwordx4 a[0:3], v248, s[24:27], s97 offen offset:0
v_pk_fma_f32 v[160:161], v[160:161], v[52:53], v[52:53] op_sel:[0,1,0] op_sel_hi:[1,1,0]
v_pk_fma_f32 v[162:163], v[162:163], v[52:53], v[52:53] op_sel:[0,1,0] op_sel_hi:[1,1,0]
v_pk_fma_f32 v[164:165], v[164:165], v[52:53], v[52:53] op_sel:[0,1,0] op_sel_hi:[1,1,0]
v_pk_fma_f32 v[166:167], v[166:167], v[52:53], v[52:53] op_sel:[0,1,0] op_sel_hi:[1,1,0]
v_pk_mul_f32 v[160:161], v[160:161], v[96:97]
v_pk_mul_f32 v[162:163], v[162:163], v[98:99]
v_pk_mul_f32 v[164:165], v[164:165], v[100:101]
v_pk_mul_f32 v[166:167], v[166:167], v[102:103]
buffer_load_dwordx4 a[4:7], v248, s[24:27], s97 offen offset:1024
v_exp_f32 v160, v160
v_exp_f32 v161, v161
v_exp_f32 v162, v162
v_exp_f32 v163, v163
v_exp_f32 v164, v164
v_exp_f32 v165, v165
v_exp_f32 v166, v166
v_exp_f32 v167, v167
buffer_load_dwordx4 a[8:11], v248, s[24:27], s97 offen offset:2048
v_pk_fma_f32 v[160:161], v[160:161], v[54:55], v[54:55]
v_pk_fma_f32 v[162:163], v[162:163], v[54:55], v[54:55]
v_pk_fma_f32 v[164:165], v[164:165], v[54:55], v[54:55]
v_pk_fma_f32 v[166:167], v[166:167], v[54:55], v[54:55]
v_rcp_f32 v160, v160
v_rcp_f32 v161, v161
v_rcp_f32 v162, v162
v_rcp_f32 v163, v163
buffer_load_dwordx4 a[12:15], v248, s[24:27], s97 offen offset:3072
v_rcp_f32 v164, v164
v_rcp_f32 v165, v165
v_rcp_f32 v166, v166
v_rcp_f32 v167, v167
v_pk_mul_f32 v[160:161], v[160:161], v[96:97]
v_pk_mul_f32 v[162:163], v[162:163], v[98:99]
v_pk_mul_f32 v[164:165], v[164:165], v[100:101]
v_pk_mul_f32 v[166:167], v[166:167], v[102:103]
buffer_load_dwordx4 a[16:19], v248, s[24:27], s98 offen
s_add_u32 s97, s97, 5120
s_cmp_eq_u32 s97, s80
s_cselect_b32 s97, s79, s97
s_add_u32 s98, s97, 4096
v_cvt_pk_bf16_f32 v96, v160, v161
v_cvt_pk_bf16_f32 v97, v162, v163
v_cvt_pk_bf16_f32 v98, v164, v165
v_cvt_pk_bf16_f32 v99, v166, v167
buffer_store_dwordx4 v[96:99], v60, s[24:27], s101 offen offset:0 sc1
v_pk_mul_f32 v[160:161], v[104:105], v[104:105]
v_pk_mul_f32 v[162:163], v[106:107], v[106:107]
v_pk_mul_f32 v[164:165], v[108:109], v[108:109]
v_pk_mul_f32 v[166:167], v[110:111], v[110:111]
buffer_load_dwordx4 a[20:23], v248, s[24:27], s97 offen offset:0
v_pk_fma_f32 v[160:161], v[160:161], v[52:53], v[52:53] op_sel:[0,1,0] op_sel_hi:[1,1,0]
v_pk_fma_f32 v[162:163], v[162:163], v[52:53], v[52:53] op_sel:[0,1,0] op_sel_hi:[1,1,0]
v_pk_fma_f32 v[164:165], v[164:165], v[52:53], v[52:53] op_sel:[0,1,0] op_sel_hi:[1,1,0]
v_pk_fma_f32 v[166:167], v[166:167], v[52:53], v[52:53] op_sel:[0,1,0] op_sel_hi:[1,1,0]
v_pk_mul_f32 v[160:161], v[160:161], v[104:105]
v_pk_mul_f32 v[162:163], v[162:163], v[106:107]
v_pk_mul_f32 v[164:165], v[164:165], v[108:109]
v_pk_mul_f32 v[166:167], v[166:167], v[110:111]
buffer_load_dwordx4 a[24:27], v248, s[24:27], s97 offen offset:1024
v_exp_f32 v160, v160
v_exp_f32 v161, v161
v_exp_f32 v162, v162
v_exp_f32 v163, v163
v_exp_f32 v164, v164
v_exp_f32 v165, v165
v_exp_f32 v166, v166
v_exp_f32 v167, v167
buffer_load_dwordx4 a[28:31], v248, s[24:27], s97 offen offset:2048
v_pk_fma_f32 v[160:161], v[160:161], v[54:55], v[54:55]
v_pk_fma_f32 v[162:163], v[162:163], v[54:55], v[54:55]
v_pk_fma_f32 v[164:165], v[164:165], v[54:55], v[54:55]
v_pk_fma_f32 v[166:167], v[166:167], v[54:55], v[54:55]
v_rcp_f32 v160, v160
v_rcp_f32 v161, v161
v_rcp_f32 v162, v162
v_rcp_f32 v163, v163
buffer_load_dwordx4 a[32:35], v248, s[24:27], s97 offen offset:3072
v_rcp_f32 v164, v164
v_rcp_f32 v165, v165
v_rcp_f32 v166, v166
v_rcp_f32 v167, v167
v_pk_mul_f32 v[160:161], v[160:161], v[104:105]
v_pk_mul_f32 v[162:163], v[162:163], v[106:107]
v_pk_mul_f32 v[164:165], v[164:165], v[108:109]
v_pk_mul_f32 v[166:167], v[166:167], v[110:111]
buffer_load_dwordx4 a[36:39], v248, s[24:27], s98 offen
s_add_u32 s97, s97, 5120
s_cmp_eq_u32 s97, s80
s_cselect_b32 s97, s79, s97
s_add_u32 s98, s97, 4096
v_cvt_pk_bf16_f32 v104, v160, v161
v_cvt_pk_bf16_f32 v105, v162, v163
v_cvt_pk_bf16_f32 v106, v164, v165
v_cvt_pk_bf16_f32 v107, v166, v167
buffer_store_dwordx4 v[104:107], v60, s[24:27], s101 offen offset:512 sc1
v_pk_mul_f32 v[160:161], v[112:113], v[112:113]
v_pk_mul_f32 v[162:163], v[114:115], v[114:115]
v_lshrrev_b32 v4, 4, v0
v_mul_u32_u24 v4, 288, v4
v_and_b32 v5, 15, v0
v_lshl_add_u32 v4, v5, 4, v4
v_add_u32 v4, 83200, v4
v_add_u32 v6, 62464, v4
s_waitcnt vmcnt(13)
v_pk_mul_f32 v[164:165], v[116:117], v[116:117]
v_pk_mul_f32 v[166:167], v[118:119], v[118:119]
v_pk_fma_f32 v[160:161], v[160:161], v[56:57], v[56:57] op_sel:[0,1,0] op_sel_hi:[1,1,0]
v_pk_fma_f32 v[162:163], v[162:163], v[56:57], v[56:57] op_sel:[0,1,0] op_sel_hi:[1,1,0]
buffer_load_dwordx4 a[40:43], v248, s[24:27], s97 offen offset:0
v_pk_fma_f32 v[164:165], v[164:165], v[56:57], v[56:57] op_sel:[0,1,0] op_sel_hi:[1,1,0]
v_pk_fma_f32 v[166:167], v[166:167], v[56:57], v[56:57] op_sel:[0,1,0] op_sel_hi:[1,1,0]
v_pk_mul_f32 v[160:161], v[160:161], v[112:113]
v_pk_mul_f32 v[162:163], v[162:163], v[114:115]
ds_write_b128 v4, v[32:35] offset:6784
v_pk_mul_f32 v[164:165], v[164:165], v[116:117]
v_pk_mul_f32 v[166:167], v[166:167], v[118:119]
v_exp_f32 v160, v160
v_exp_f32 v161, v161
buffer_load_dwordx4 a[44:47], v248, s[24:27], s97 offen offset:1024
v_exp_f32 v162, v162
v_exp_f32 v163, v163
v_exp_f32 v164, v164
v_exp_f32 v165, v165
v_alignbit_b32 v12, v33, v32, 16
v_alignbit_b32 v13, v34, v33, 16
v_alignbit_b32 v14, v35, v34, 16
v_alignbit_b32 v15, v36, v35, 16
v_exp_f32 v166, v166
v_exp_f32 v167, v167
v_pk_fma_f32 v[160:161], v[160:161], v[58:59], v[58:59]
v_pk_fma_f32 v[162:163], v[162:163], v[58:59], v[58:59]
buffer_load_dwordx4 a[48:51], v248, s[24:27], s97 offen offset:2048
v_pk_fma_f32 v[164:165], v[164:165], v[58:59], v[58:59]
v_pk_fma_f32 v[166:167], v[166:167], v[58:59], v[58:59]
v_rcp_f32 v160, v160
v_rcp_f32 v161, v161
ds_write_b128 v4, v[12:15] offset:0
v_rcp_f32 v162, v162
v_rcp_f32 v163, v163
v_rcp_f32 v164, v164
v_rcp_f32 v165, v165
buffer_load_dwordx4 a[52:55], v248, s[24:27], s97 offen offset:3072
v_rcp_f32 v166, v166
v_rcp_f32 v167, v167
v_pk_mul_f32 v[160:161], v[160:161], v[112:113]
v_pk_mul_f32 v[162:163], v[162:163], v[114:115]
ds_write_b128 v4, v[38:41] offset:38016
v_pk_mul_f32 v[164:165], v[164:165], v[116:117]
v_pk_mul_f32 v[166:167], v[166:167], v[118:119]
v_cvt_pk_bf16_f32 v112, v160, v161
v_cvt_pk_bf16_f32 v113, v162, v163
buffer_load_dwordx4 a[56:59], v248, s[24:27], s98 offen
s_add_u32 s97, s97, 5120
s_cmp_eq_u32 s97, s80
s_cselect_b32 s97, s79, s97
s_add_u32 s98, s97, 4096
v_cvt_pk_bf16_f32 v114, v164, v165
v_cvt_pk_bf16_f32 v115, v166, v167
buffer_store_dwordx4 v[112:115], v60, s[24:27], s101 offen offset:2048 sc1
v_pk_mul_f32 v[160:161], v[120:121], v[120:121]
v_pk_mul_f32 v[162:163], v[122:123], v[122:123]
v_alignbit_b32 v12, v39, v38, 16
v_alignbit_b32 v13, v40, v39, 16
v_alignbit_b32 v14, v41, v40, 16
v_alignbit_b32 v15, v42, v41, 16
v_pk_mul_f32 v[164:165], v[124:125], v[124:125]
v_pk_mul_f32 v[166:167], v[126:127], v[126:127]
v_pk_fma_f32 v[160:161], v[160:161], v[56:57], v[56:57] op_sel:[0,1,0] op_sel_hi:[1,1,0]
v_pk_fma_f32 v[162:163], v[162:163], v[56:57], v[56:57] op_sel:[0,1,0] op_sel_hi:[1,1,0]
buffer_load_dwordx4 a[60:63], v248, s[24:27], s97 offen offset:0
v_pk_fma_f32 v[164:165], v[164:165], v[56:57], v[56:57] op_sel:[0,1,0] op_sel_hi:[1,1,0]
v_pk_fma_f32 v[166:167], v[166:167], v[56:57], v[56:57] op_sel:[0,1,0] op_sel_hi:[1,1,0]
v_pk_mul_f32 v[160:161], v[160:161], v[120:121]
v_pk_mul_f32 v[162:163], v[162:163], v[122:123]
ds_write_b128 v4, v[12:15] offset:31232
v_pk_mul_f32 v[164:165], v[164:165], v[124:125]
v_pk_mul_f32 v[166:167], v[166:167], v[126:127]
v_exp_f32 v160, v160
v_exp_f32 v161, v161
buffer_load_dwordx4 a[64:67], v248, s[24:27], s97 offen offset:1024
v_exp_f32 v162, v162
v_exp_f32 v163, v163
v_exp_f32 v164, v164
v_exp_f32 v165, v165
ds_write_b128 v6, v[44:47] offset:6784
v_exp_f32 v166, v166
v_exp_f32 v167, v167
v_pk_fma_f32 v[160:161], v[160:161], v[58:59], v[58:59]
v_pk_fma_f32 v[162:163], v[162:163], v[58:59], v[58:59]
buffer_load_dwordx4 a[68:71], v248, s[24:27], s97 offen offset:2048
v_pk_fma_f32 v[164:165], v[164:165], v[58:59], v[58:59]
v_pk_fma_f32 v[166:167], v[166:167], v[58:59], v[58:59]
v_rcp_f32 v160, v160
v_rcp_f32 v161, v161
v_alignbit_b32 v12, v45, v44, 16
v_alignbit_b32 v13, v46, v45, 16
v_alignbit_b32 v14, v47, v46, 16
v_alignbit_b32 v15, v48, v47, 16
v_rcp_f32 v162, v162
v_rcp_f32 v163, v163
v_rcp_f32 v164, v164
v_rcp_f32 v165, v165
buffer_load_dwordx4 a[72:75], v248, s[24:27], s97 offen offset:3072
v_rcp_f32 v166, v166
v_rcp_f32 v167, v167
v_pk_mul_f32 v[160:161], v[160:161], v[120:121]
v_pk_mul_f32 v[162:163], v[162:163], v[122:123]
ds_write_b128 v6, v[12:15] offset:0
v_pk_mul_f32 v[164:165], v[164:165], v[124:125]
v_pk_mul_f32 v[166:167], v[166:167], v[126:127]
v_cvt_pk_bf16_f32 v120, v160, v161
v_cvt_pk_bf16_f32 v121, v162, v163
buffer_load_dwordx4 a[76:79], v248, s[24:27], s98 offen
s_add_u32 s97, s97, 5120
s_cmp_eq_u32 s97, s80
s_cselect_b32 s97, s79, s97
s_add_u32 s98, s97, 4096
v_cvt_pk_bf16_f32 v122, v164, v165
v_cvt_pk_bf16_f32 v123, v166, v167
buffer_store_dwordx4 v[120:123], v60, s[24:27], s101 offen offset:2560 sc1
L_conv:
s_waitcnt lgkmcnt(0)
s_barrier
v_mov_b32 v2, 61440
v_mov_b32 v3, 0
ds_write_b32 v2, v3
ds_read_b128 v[140:143], v8 offset:192
ds_read_b128 v[160:163], v9 offset:0
ds_read_b128 v[144:147], v8 offset:256
ds_read_b128 v[164:167], v9 offset:64
ds_read_b128 v[148:151], v8 offset:320
ds_read_b128 v[168:171], v9 offset:128
ds_read_b128 v[152:155], v8 offset:384
ds_read_b128 v[156:159], v8 offset:448
s_waitcnt lgkmcnt(6)
v_mfma_f32_16x16x32_bf16 v[188:191], v[192:195], v[160:163], 0
ds_read_b128 v[128:131], v8 offset:512
v_mfma_f32_16x16x32_bf16 v[188:191], v[140:143], v[160:163], v[188:191]
ds_read_b128 v[172:175], v9 offset:192
s_waitcnt lgkmcnt(6)
v_mfma_f32_16x16x32_bf16 v[184:187], v[192:195], v[164:167], 0
ds_read_b128 v[132:135], v8 offset:576
v_mfma_f32_16x16x32_bf16 v[188:191], v[144:147], v[164:167], v[188:191]
ds_read_b128 v[160:163], v9 offset:288
v_mfma_f32_16x16x32_bf16 v[184:187], v[140:143], v[164:167], v[184:187]
buffer_load_dwordx4 a[80:83], v248, s[24:27], s97 offen offset:0
s_waitcnt lgkmcnt(6)
v_mfma_f32_16x16x32_bf16 v[180:183], v[192:195], v[168:171], 0
ds_read_b128 v[136:139], v8 offset:640
v_mfma_f32_16x16x32_bf16 v[184:187], v[144:147], v[168:171], v[184:187]
ds_read_b128 v[164:167], v9 offset:352
v_mfma_f32_16x16x32_bf16 v[188:191], v[148:151], v[168:171], v[188:191]
buffer_load_dwordx4 a[84:87], v248, s[24:27], s97 offen offset:1024
v_mfma_f32_16x16x32_bf16 v[180:183], v[140:143], v[168:171], v[180:183]
s_waitcnt lgkmcnt(4)
v_mfma_f32_16x16x32_bf16 v[176:179], v[192:195], v[172:175], 0
v_mfma_f32_16x16x32_bf16 v[180:183], v[144:147], v[172:175], v[180:183]
v_mfma_f32_16x16x32_bf16 v[176:179], v[140:143], v[172:175], v[176:179]
ds_read_b128 v[140:143], v8 offset:704
buffer_load_dwordx4 a[88:91], v248, s[24:27], s97 offen offset:2048
v_mfma_f32_16x16x32_bf16 v[184:187], v[148:151], v[172:175], v[184:187]
ds_read_b128 v[168:171], v9 offset:416
v_mfma_f32_16x16x32_bf16 v[188:191], v[152:155], v[172:175], v[188:191]
s_waitcnt lgkmcnt(4)
v_mfma_f32_16x16x32_bf16 v[176:179], v[144:147], v[160:163], v[176:179]
ds_read_b128 v[144:147], v8 offset:768
v_mfma_f32_16x16x32_bf16 v[180:183], v[148:151], v[160:163], v[180:183]
ds_read_b128 v[172:175], v9 offset:480
v_mfma_f32_16x16x32_bf16 v[184:187], v[152:155], v[160:163], v[184:187]
buffer_load_dwordx4 a[92:95], v248, s[24:27], s97 offen offset:3072
v_mfma_f32_16x16x32_bf16 v[188:191], v[156:159], v[160:163], v[188:191]
s_waitcnt lgkmcnt(4)
v_mfma_f32_16x16x32_bf16 v[176:179], v[148:151], v[164:167], v[176:179]
ds_read_b128 v[148:151], v8 offset:832
v_mfma_f32_16x16x32_bf16 v[180:183], v[152:155], v[164:167], v[180:183]
ds_read_b128 v[160:163], v9 offset:576
v_mfma_f32_16x16x32_bf16 v[184:187], v[156:159], v[164:167], v[184:187]
buffer_load_dwordx4 a[96:99], v248, s[24:27], s98 offen
v_mfma_f32_16x16x32_bf16 v[188:191], v[128:131], v[164:167], v[188:191]
s_add_u32 s97, s97, 5120
s_cmp_eq_u32 s97, s80
s_cselect_b32 s97, s79, s97
s_add_u32 s98, s97, 4096
s_waitcnt lgkmcnt(4)
v_mfma_f32_16x16x32_bf16 v[176:179], v[152:155], v[168:171], v[176:179]
ds_read_b128 v[152:155], v8 offset:896
v_mfma_f32_16x16x32_bf16 v[180:183], v[156:159], v[168:171], v[180:183]
ds_read_b128 v[164:167], v9 offset:640
v_mfma_f32_16x16x32_bf16 v[184:187], v[128:131], v[168:171], v[184:187]
buffer_load_dwordx4 a[100:103], v248, s[24:27], s97 offen offset:0
v_mfma_f32_16x16x32_bf16 v[188:191], v[132:135], v[168:171], v[188:191]
s_waitcnt lgkmcnt(4)
v_mfma_f32_16x16x32_bf16 v[176:179], v[156:159], v[172:175], v[176:179]
ds_read_b128 v[156:159], v8 offset:960
v_mfma_f32_16x16x32_bf16 v[180:183], v[128:131], v[172:175], v[180:183]
ds_read_b128 v[168:171], v9 offset:704
v_mfma_f32_16x16x32_bf16 v[184:187], v[132:135], v[172:175], v[184:187]
buffer_load_dwordx4 a[104:107], v248, s[24:27], s97 offen offset:1024
v_mfma_f32_16x16x32_bf16 v[188:191], v[136:139], v[172:175], v[188:191]
s_waitcnt lgkmcnt(4)
v_mfma_f32_16x16x32_bf16 v[176:179], v[128:131], v[160:163], v[176:179]
ds_read_b128 v[128:131], v8 offset:1024
v_mfma_f32_16x16x32_bf16 v[180:183], v[132:135], v[160:163], v[180:183]
ds_read_b128 v[172:175], v9 offset:768
v_mfma_f32_16x16x32_bf16 v[184:187], v[136:139], v[160:163], v[184:187]
buffer_load_dwordx4 a[108:111], v248, s[24:27], s97 offen offset:2048
v_mfma_f32_16x16x32_bf16 v[188:191], v[140:143], v[160:163], v[188:191]
s_waitcnt lgkmcnt(4)
v_mfma_f32_16x16x32_bf16 v[176:179], v[132:135], v[164:167], v[176:179]
ds_read_b128 v[132:135], v8 offset:1088
v_mfma_f32_16x16x32_bf16 v[180:183], v[136:139], v[164:167], v[180:183]
ds_read_b128 v[160:163], v9 offset:864
v_mfma_f32_16x16x32_bf16 v[184:187], v[140:143], v[164:167], v[184:187]
buffer_load_dwordx4 a[112:115], v248, s[24:27], s97 offen offset:3072
v_mfma_f32_16x16x32_bf16 v[188:191], v[144:147], v[164:167], v[188:191]
s_waitcnt lgkmcnt(4)
v_mfma_f32_16x16x32_bf16 v[176:179], v[136:139], v[168:171], v[176:179]
ds_read_b128 v[136:139], v8 offset:1152
v_mfma_f32_16x16x32_bf16 v[180:183], v[140:143], v[168:171], v[180:183]
ds_read_b128 v[164:167], v9 offset:928
v_mfma_f32_16x16x32_bf16 v[184:187], v[144:147], v[168:171], v[184:187]
buffer_load_dwordx4 a[116:119], v248, s[24:27], s98 offen
v_mfma_f32_16x16x32_bf16 v[188:191], v[148:151], v[168:171], v[188:191]
s_add_u32 s97, s97, 5120
s_cmp_eq_u32 s97, s80
s_cselect_b32 s97, s79, s97
s_add_u32 s98, s97, 4096
s_waitcnt lgkmcnt(4)
v_mfma_f32_16x16x32_bf16 v[176:179], v[140:143], v[172:175], v[176:179]
ds_read_b128 v[140:143], v8 offset:1216
v_mfma_f32_16x16x32_bf16 v[180:183], v[144:147], v[172:175], v[180:183]
ds_read_b128 v[168:171], v9 offset:992
v_mfma_f32_16x16x32_bf16 v[184:187], v[148:151], v[172:175], v[184:187]
buffer_load_dwordx4 a[120:123], v248, s[24:27], s97 offen offset:0
v_mfma_f32_16x16x32_bf16 v[188:191], v[152:155], v[172:175], v[188:191]
s_waitcnt lgkmcnt(4)
v_mfma_f32_16x16x32_bf16 v[176:179], v[144:147], v[160:163], v[176:179]
ds_read_b128 v[144:147], v8 offset:1280
v_mfma_f32_16x16x32_bf16 v[180:183], v[148:151], v[160:163], v[180:183]
ds_read_b128 v[172:175], v9 offset:1056
v_mfma_f32_16x16x32_bf16 v[184:187], v[152:155], v[160:163], v[184:187]
buffer_load_dwordx4 a[124:127], v248, s[24:27], s97 offen offset:1024
v_mfma_f32_16x16x32_bf16 v[188:191], v[156:159], v[160:163], v[188:191]
s_waitcnt lgkmcnt(4)
v_mfma_f32_16x16x32_bf16 v[176:179], v[148:151], v[164:167], v[176:179]
ds_read_b128 v[148:151], v8 offset:1344
v_mfma_f32_16x16x32_bf16 v[180:183], v[152:155], v[164:167], v[180:183]
ds_read_b128 v[160:163], v9 offset:1152
v_mfma_f32_16x16x32_bf16 v[184:187], v[156:159], v[164:167], v[184:187]
buffer_load_dwordx4 a[128:131], v248, s[24:27], s97 offen offset:2048
v_mfma_f32_16x16x32_bf16 v[188:191], v[128:131], v[164:167], v[188:191]
s_waitcnt vmcnt(13)
s_barrier
s_cmp_lg_u32 s5, 0
s_cbranch_scc1 L_fl_33
s_mov_b64 exec, 1
buffer_store_dword v253, v252, s[24:27], 0 offen offset:16 sc1
s_mov_b64 exec, -1
L_fl_33:
s_waitcnt lgkmcnt(4)
v_mfma_f32_16x16x32_bf16 v[176:179], v[152:155], v[168:171], v[176:179]
ds_read_b128 v[152:155], v8 offset:1408
v_mfma_f32_16x16x32_bf16 v[180:183], v[156:159], v[168:171], v[180:183]
ds_read_b128 v[164:167], v9 offset:1216
v_mfma_f32_16x16x32_bf16 v[184:187], v[128:131], v[168:171], v[184:187]
buffer_load_dwordx4 a[132:135], v248, s[24:27], s97 offen offset:3072
v_mfma_f32_16x16x32_bf16 v[188:191], v[132:135], v[168:171], v[188:191]
s_waitcnt lgkmcnt(4)
v_mfma_f32_16x16x32_bf16 v[176:179], v[156:159], v[172:175], v[176:179]
ds_read_b128 v[156:159], v8 offset:1472
v_mfma_f32_16x16x32_bf16 v[180:183], v[128:131], v[172:175], v[180:183]
ds_read_b128 v[168:171], v9 offset:1280
v_mfma_f32_16x16x32_bf16 v[184:187], v[132:135], v[172:175], v[184:187]
buffer_load_dwordx4 a[136:139], v248, s[24:27], s98 offen
v_mfma_f32_16x16x32_bf16 v[188:191], v[136:139], v[172:175], v[188:191]
s_add_u32 s97, s97, 5120
s_cmp_eq_u32 s97, s80
s_cselect_b32 s97, s79, s97
s_add_u32 s98, s97, 4096
s_waitcnt lgkmcnt(4)
v_mfma_f32_16x16x32_bf16 v[176:179], v[128:131], v[160:163], v[176:179]
ds_read_b128 v[128:131], v8 offset:1536
v_mfma_f32_16x16x32_bf16 v[180:183], v[132:135], v[160:163], v[180:183]
ds_read_b128 v[172:175], v9 offset:1344
v_mfma_f32_16x16x32_bf16 v[184:187], v[136:139], v[160:163], v[184:187]
buffer_load_dwordx4 a[140:143], v248, s[24:27], s97 offen offset:0
v_mfma_f32_16x16x32_bf16 v[188:191], v[140:143], v[160:163], v[188:191]
s_waitcnt lgkmcnt(4)
v_mfma_f32_16x16x32_bf16 v[176:179], v[132:135], v[164:167], v[176:179]
ds_read_b128 v[132:135], v8 offset:1600
v_mfma_f32_16x16x32_bf16 v[180:183], v[136:139], v[164:167], v[180:183]
ds_read_b128 v[160:163], v9 offset:1440
v_mfma_f32_16x16x32_bf16 v[184:187], v[140:143], v[164:167], v[184:187]
buffer_load_dwordx4 a[144:147], v248, s[24:27], s97 offen offset:1024
v_mfma_f32_16x16x32_bf16 v[188:191], v[144:147], v[164:167], v[188:191]
s_waitcnt lgkmcnt(4)
v_mfma_f32_16x16x32_bf16 v[176:179], v[136:139], v[168:171], v[176:179]
ds_read_b128 v[136:139], v8 offset:1664
v_mfma_f32_16x16x32_bf16 v[180:183], v[140:143], v[168:171], v[180:183]
ds_read_b128 v[164:167], v9 offset:1504
v_mfma_f32_16x16x32_bf16 v[184:187], v[144:147], v[168:171], v[184:187]
buffer_load_dwordx4 a[148:151], v248, s[24:27], s97 offen offset:2048
v_mfma_f32_16x16x32_bf16 v[188:191], v[148:151], v[168:171], v[188:191]
s_waitcnt lgkmcnt(4)
v_mfma_f32_16x16x32_bf16 v[176:179], v[140:143], v[172:175], v[176:179]
ds_read_b128 v[140:143], v8 offset:1728
v_mfma_f32_16x16x32_bf16 v[180:183], v[144:147], v[172:175], v[180:183]
ds_read_b128 v[168:171], v9 offset:1568
v_mfma_f32_16x16x32_bf16 v[184:187], v[148:151], v[172:175], v[184:187]
buffer_load_dwordx4 a[152:155], v248, s[24:27], s97 offen offset:3072
v_mfma_f32_16x16x32_bf16 v[188:191], v[152:155], v[172:175], v[188:191]
s_waitcnt lgkmcnt(4)
v_mfma_f32_16x16x32_bf16 v[176:179], v[144:147], v[160:163], v[176:179]
ds_read_b128 v[144:147], v8 offset:1792
v_mfma_f32_16x16x32_bf16 v[180:183], v[148:151], v[160:163], v[180:183]
ds_read_b128 v[172:175], v9 offset:1632
v_mfma_f32_16x16x32_bf16 v[184:187], v[152:155], v[160:163], v[184:187]
buffer_load_dwordx4 a[156:159], v248, s[24:27], s98 offen
v_mfma_f32_16x16x32_bf16 v[188:191], v[156:159], v[160:163], v[188:191]
s_add_u32 s97, s97, 5120
s_cmp_eq_u32 s97, s80
s_cselect_b32 s97, s79, s97
s_add_u32 s98, s97, 4096
s_mov_b32 s32, s60
s_and_b32 s33, s61, 0xffff
s_mov_b32 s34, 1280
s_mov_b32 s35, 0x20000
v_lshrrev_b32 v19, 4, v1
v_mul_u32_u24 v19, 40, v19
s_mul_i32 s6, s95, 160
v_add_u32 v19, s6, v19
buffer_load_dwordx4 a[240:243], v19, s[32:35], 0 offen
buffer_load_dwordx4 a[244:247], v19, s[32:35], 0 offen offset:16
buffer_load_dwordx2 a[248:249], v19, s[32:35], 0 offen offset:32
s_waitcnt lgkmcnt(4)
v_mfma_f32_16x16x32_bf16 v[176:179], v[148:151], v[164:167], v[176:179]
ds_read_b128 v[148:151], v8 offset:1856
v_mfma_f32_16x16x32_bf16 v[180:183], v[152:155], v[164:167], v[180:183]
ds_read_b128 v[160:163], v9 offset:1728
v_mfma_f32_16x16x32_bf16 v[184:187], v[156:159], v[164:167], v[184:187]
buffer_load_dwordx4 a[160:163], v248, s[24:27], s97 offen offset:0
v_mfma_f32_16x16x32_bf16 v[188:191], v[128:131], v[164:167], v[188:191]
s_waitcnt lgkmcnt(4)
v_mfma_f32_16x16x32_bf16 v[176:179], v[152:155], v[168:171], v[176:179]
ds_read_b128 v[152:155], v8 offset:1920
v_mfma_f32_16x16x32_bf16 v[180:183], v[156:159], v[168:171], v[180:183]
ds_read_b128 v[164:167], v9 offset:1792
v_mfma_f32_16x16x32_bf16 v[184:187], v[128:131], v[168:171], v[184:187]
buffer_load_dwordx4 a[164:167], v248, s[24:27], s97 offen offset:1024
v_mfma_f32_16x16x32_bf16 v[188:191], v[132:135], v[168:171], v[188:191]
s_waitcnt lgkmcnt(4)
v_mfma_f32_16x16x32_bf16 v[176:179], v[156:159], v[172:175], v[176:179]
ds_read_b128 v[156:159], v8 offset:1984
v_mfma_f32_16x16x32_bf16 v[180:183], v[128:131], v[172:175], v[180:183]
ds_read_b128 v[168:171], v9 offset:1856
v_mfma_f32_16x16x32_bf16 v[184:187], v[132:135], v[172:175], v[184:187]
buffer_load_dwordx4 a[168:171], v248, s[24:27], s97 offen offset:2048
v_mfma_f32_16x16x32_bf16 v[188:191], v[136:139], v[172:175], v[188:191]
s_waitcnt lgkmcnt(4)
v_mfma_f32_16x16x32_bf16 v[176:179], v[128:131], v[160:163], v[176:179]
ds_read_b128 v[128:131], v8 offset:2048
v_mfma_f32_16x16x32_bf16 v[180:183], v[132:135], v[160:163], v[180:183]
ds_read_b128 v[172:175], v9 offset:1920
v_mfma_f32_16x16x32_bf16 v[184:187], v[136:139], v[160:163], v[184:187]
buffer_load_dwordx4 a[172:175], v248, s[24:27], s97 offen offset:3072
v_mfma_f32_16x16x32_bf16 v[188:191], v[140:143], v[160:163], v[188:191]
s_waitcnt lgkmcnt(4)
v_mfma_f32_16x16x32_bf16 v[176:179], v[132:135], v[164:167], v[176:179]
ds_read_b128 v[132:135], v8 offset:2112
v_mfma_f32_16x16x32_bf16 v[180:183], v[136:139], v[164:167], v[180:183]
ds_read_b128 v[160:163], v9 offset:2016
v_mfma_f32_16x16x32_bf16 v[184:187], v[140:143], v[164:167], v[184:187]
buffer_load_dwordx4 a[176:179], v248, s[24:27], s98 offen
v_mfma_f32_16x16x32_bf16 v[188:191], v[144:147], v[164:167], v[188:191]
s_add_u32 s97, s97, 5120
s_cmp_eq_u32 s97, s80
s_cselect_b32 s97, s79, s97
s_add_u32 s98, s97, 4096
s_waitcnt lgkmcnt(4)
v_mfma_f32_16x16x32_bf16 v[176:179], v[136:139], v[168:171], v[176:179]
ds_read_b128 v[136:139], v8 offset:2176
v_mfma_f32_16x16x32_bf16 v[180:183], v[140:143], v[168:171], v[180:183]
ds_read_b128 v[164:167], v9 offset:2080
v_mfma_f32_16x16x32_bf16 v[184:187], v[144:147], v[168:171], v[184:187]
buffer_load_dwordx4 a[180:183], v248, s[24:27], s97 offen offset:0
v_mfma_f32_16x16x32_bf16 v[188:191], v[148:151], v[168:171], v[188:191]
s_cmp_lg_u32 s86, 0
s_cbranch_scc1 L_stay_35
s_cmp_eq_u32 s87, 3
s_cselect_b32 s85, s85, s87
s_mul_i32 s84, s85, 31232
s_add_u32 s84, s84, 63488
v_add_u32 v8, s84, v16
s_waitcnt lgkmcnt(4)
v_mfma_f32_16x16x32_bf16 v[176:179], v[140:143], v[172:175], v[176:179]
ds_read_b128 v[140:143], v8 offset:2240
v_mfma_f32_16x16x32_bf16 v[180:183], v[144:147], v[172:175], v[180:183]
ds_read_b128 v[168:171], v9 offset:2144
s_add_u32 s84, s84, 17408
s_add_u32 s91, s88, s85
v_mfma_f32_16x16x32_bf16 v[184:187], v[148:151], v[172:175], v[184:187]
buffer_load_dwordx4 a[184:187], v248, s[24:27], s97 offen offset:1024
v_mfma_f32_16x16x32_bf16 v[188:191], v[152:155], v[172:175], v[188:191]
s_waitcnt lgkmcnt(4)
v_mfma_f32_16x16x32_bf16 v[176:179], v[144:147], v[160:163], v[176:179]
ds_read_b128 v[144:147], v8 offset:2304
s_and_b32 s89, s88, 0xfffffffe
s_sub_u32 s89, s91, s89
s_cmp_ge_u32 s89, 2
s_cselect_b32 s90, s1, s0
v_mfma_f32_16x16x32_bf16 v[180:183], v[148:151], v[160:163], v[180:183]
ds_read_b128 v[172:175], v9 offset:2208
s_and_b32 s89, s89, 1
s_lshl_b32 s89, s89, 4
s_lshr_b32 s90, s90, s89
s_and_b32 s90, s90, 0xffff
v_mfma_f32_16x16x32_bf16 v[184:187], v[152:155], v[160:163], v[184:187]
buffer_load_dwordx4 a[188:191], v248, s[24:27], s97 offen offset:2048
v_mfma_f32_16x16x32_bf16 v[188:191], v[156:159], v[160:163], v[188:191]
v_add_u32 v9, s84, v17
s_waitcnt lgkmcnt(4)
v_mfma_f32_16x16x32_bf16 v[176:179], v[148:151], v[164:167], v[176:179]
ds_read_b128 v[148:151], v8 offset:2368
v_mov_b32 v3, s90
v_and_b32 v2, 15, v1
v_mfma_f32_16x16x32_bf16 v[180:183], v[152:155], v[164:167], v[180:183]
ds_read_b128 v[160:163], v9 offset:2304
v_lshl_add_u32 v2, v18, 2, v2
v_sub_u32 v2, 15, v2
v_mfma_f32_16x16x32_bf16 v[184:187], v[156:159], v[164:167], v[184:187]
buffer_load_dwordx4 a[192:195], v248, s[24:27], s97 offen offset:3072
v_mfma_f32_16x16x32_bf16 v[188:191], v[128:131], v[164:167], v[188:191]
s_waitcnt lgkmcnt(4)
v_mfma_f32_16x16x32_bf16 v[176:179], v[152:155], v[168:171], v[176:179]
ds_read_b128 v[152:155], v8 offset:2432
v_cmp_eq_u32 vcc, 0, v2
v_cndmask_b32 v192, 0, v3, vcc
v_mfma_f32_16x16x32_bf16 v[180:183], v[156:159], v[168:171], v[180:183]
ds_read_b128 v[164:167], v9 offset:2368
v_cmp_eq_u32 vcc, 1, v2
v_cndmask_b32 v193, 0, v3, vcc
v_mfma_f32_16x16x32_bf16 v[184:187], v[128:131], v[168:171], v[184:187]
v_cmp_eq_u32 vcc, 2, v2
v_cndmask_b32 v194, 0, v3, vcc
buffer_load_dwordx4 a[196:199], v248, s[24:27], s98 offen
v_mfma_f32_16x16x32_bf16 v[188:191], v[132:135], v[168:171], v[188:191]
v_cmp_eq_u32 vcc, 3, v2
v_cndmask_b32 v195, 0, v3, vcc
s_add_u32 s97, s97, 5120
s_cmp_eq_u32 s97, s80
s_cselect_b32 s97, s79, s97
s_add_u32 s98, s97, 4096
s_waitcnt lgkmcnt(4)
v_mfma_f32_16x16x32_bf16 v[188:191], v[136:139], v[172:175], v[188:191]
v_mfma_f32_16x16x32_bf16 v[184:187], v[132:135], v[172:175], v[184:187]
ds_read_b128 v[168:171], v9 offset:2432
v_mfma_f32_16x16x32_bf16 v[180:183], v[128:131], v[172:175], v[180:183]
v_mfma_f32_16x16x32_bf16 v[176:179], v[156:159], v[172:175], v[176:179]
ds_read_b128 v[156:159], v8 offset:2496
v_cvt_pk_bf16_f32 v26, v188, v189
v_cvt_pk_bf16_f32 v27, v190, v191
s_waitcnt lgkmcnt(4)
v_mfma_f32_16x16x32_bf16 v[188:191], v[192:195], v[160:163], 0
ds_read_b128 v[128:131], v8 offset:2560
v_cvt_pk_bf16_f32 v24, v184, v185
v_cvt_pk_bf16_f32 v25, v186, v187
v_mfma_f32_16x16x32_bf16 v[188:191], v[140:143], v[160:163], v[188:191]
ds_read_b128 v[172:175], v9 offset:2496
buffer_store_dwordx4 v[24:27], v11, s[24:27], s92 offen offset:128 sc1
buffer_load_dwordx4 a[200:203], v248, s[24:27], s97 offen offset:0
s_waitcnt lgkmcnt(4)
v_mfma_f32_16x16x32_bf16 v[184:187], v[192:195], v[164:167], 0
ds_read_b128 v[132:135], v8 offset:2624
v_cvt_pk_bf16_f32 v22, v180, v181
v_cvt_pk_bf16_f32 v23, v182, v183
v_mfma_f32_16x16x32_bf16 v[188:191], v[144:147], v[164:167], v[188:191]
ds_read_b128 v[160:163], v9 offset:2592
v_cvt_pk_bf16_f32 v20, v176, v177
v_cvt_pk_bf16_f32 v21, v178, v179
v_mfma_f32_16x16x32_bf16 v[184:187], v[140:143], v[164:167], v[184:187]
buffer_store_dwordx4 v[20:23], v11, s[24:27], s92 offen offset:0 sc1
buffer_load_dwordx4 a[204:207], v248, s[24:27], s97 offen offset:1024
s_waitcnt lgkmcnt(5)
v_mfma_f32_16x16x32_bf16 v[180:183], v[192:195], v[168:171], 0
ds_read_b128 v[136:139], v8 offset:2688
v_mfma_f32_16x16x32_bf16 v[184:187], v[144:147], v[168:171], v[184:187]
ds_read_b128 v[164:167], v9 offset:2656
s_lshl_b32 s92, s91, 12
s_add_u32 s92, s92, 4194304
s_cmp_eq_u32 s87, 3
s_cselect_b64 vcc, -1, 0
v_mfma_f32_16x16x32_bf16 v[188:191], v[148:151], v[168:171], v[188:191]
v_mov_b32 v2, 2147418112
v_cndmask_b32 v11, v11, v2, vcc
buffer_load_dwordx4 a[208:211], v248, s[24:27], s97 offen offset:2048
v_mfma_f32_16x16x32_bf16 v[180:183], v[140:143], v[168:171], v[180:183]
s_waitcnt lgkmcnt(4)
v_mfma_f32_16x16x32_bf16 v[176:179], v[192:195], v[172:175], 0
v_mfma_f32_16x16x32_bf16 v[180:183], v[144:147], v[172:175], v[180:183]
v_mfma_f32_16x16x32_bf16 v[176:179], v[140:143], v[172:175], v[176:179]
ds_read_b128 v[140:143], v8 offset:2752
buffer_load_dwordx4 a[212:215], v248, s[24:27], s97 offen offset:3072
v_mfma_f32_16x16x32_bf16 v[184:187], v[148:151], v[172:175], v[184:187]
ds_read_b128 v[168:171], v9 offset:2720
v_mfma_f32_16x16x32_bf16 v[188:191], v[152:155], v[172:175], v[188:191]
s_branch L_join_36
L_stay_35:
s_waitcnt lgkmcnt(4)
v_mfma_f32_16x16x32_bf16 v[176:179], v[140:143], v[172:175], v[176:179]
ds_read_b128 v[140:143], v8 offset:2240
v_mfma_f32_16x16x32_bf16 v[180:183], v[144:147], v[172:175], v[180:183]
ds_read_b128 v[168:171], v9 offset:2144
v_mfma_f32_16x16x32_bf16 v[184:187], v[148:151], v[172:175], v[184:187]
buffer_load_dwordx4 a[184:187], v248, s[24:27], s97 offen offset:1024
v_mfma_f32_16x16x32_bf16 v[188:191], v[152:155], v[172:175], v[188:191]
s_waitcnt lgkmcnt(4)
v_mfma_f32_16x16x32_bf16 v[176:179], v[144:147], v[160:163], v[176:179]
ds_read_b128 v[144:147], v8 offset:2304
v_mfma_f32_16x16x32_bf16 v[180:183], v[148:151], v[160:163], v[180:183]
ds_read_b128 v[172:175], v9 offset:2208
v_mfma_f32_16x16x32_bf16 v[184:187], v[152:155], v[160:163], v[184:187]
buffer_load_dwordx4 a[188:191], v248, s[24:27], s97 offen offset:2048
v_mfma_f32_16x16x32_bf16 v[188:191], v[156:159], v[160:163], v[188:191]
s_waitcnt lgkmcnt(4)
v_mfma_f32_16x16x32_bf16 v[176:179], v[148:151], v[164:167], v[176:179]
ds_read_b128 v[148:151], v8 offset:2368
v_mfma_f32_16x16x32_bf16 v[180:183], v[152:155], v[164:167], v[180:183]
ds_read_b128 v[160:163], v9 offset:2304
v_mfma_f32_16x16x32_bf16 v[184:187], v[156:159], v[164:167], v[184:187]
buffer_load_dwordx4 a[192:195], v248, s[24:27], s97 offen offset:3072
v_mfma_f32_16x16x32_bf16 v[188:191], v[128:131], v[164:167], v[188:191]
s_waitcnt lgkmcnt(4)
v_mfma_f32_16x16x32_bf16 v[176:179], v[152:155], v[168:171], v[176:179]
ds_read_b128 v[152:155], v8 offset:2432
v_mfma_f32_16x16x32_bf16 v[180:183], v[156:159], v[168:171], v[180:183]
ds_read_b128 v[164:167], v9 offset:2368
v_mfma_f32_16x16x32_bf16 v[184:187], v[128:131], v[168:171], v[184:187]
buffer_load_dwordx4 a[196:199], v248, s[24:27], s98 offen
v_mfma_f32_16x16x32_bf16 v[188:191], v[132:135], v[168:171], v[188:191]
s_add_u32 s97, s97, 5120
s_cmp_eq_u32 s97, s80
s_cselect_b32 s97, s79, s97
s_add_u32 s98, s97, 4096
s_waitcnt lgkmcnt(4)
v_mfma_f32_16x16x32_bf16 v[176:179], v[156:159], v[172:175], v[176:179]
ds_read_b128 v[156:159], v8 offset:2496
v_mfma_f32_16x16x32_bf16 v[180:183], v[128:131], v[172:175], v[180:183]
ds_read_b128 v[168:171], v9 offset:2432
v_mfma_f32_16x16x32_bf16 v[184:187], v[132:135], v[172:175], v[184:187]
v_mfma_f32_16x16x32_bf16 v[188:191], v[136:139], v[172:175], v[188:191]
s_waitcnt lgkmcnt(4)
v_mfma_f32_16x16x32_bf16 v[176:179], v[128:131], v[160:163], v[176:179]
ds_read_b128 v[128:131], v8 offset:2560
v_mfma_f32_16x16x32_bf16 v[180:183], v[132:135], v[160:163], v[180:183]
ds_read_b128 v[172:175], v9 offset:2496
v_mfma_f32_16x16x32_bf16 v[184:187], v[136:139], v[160:163], v[184:187]
buffer_load_dwordx4 a[200:203], v248, s[24:27], s97 offen offset:0
v_mfma_f32_16x16x32_bf16 v[188:191], v[140:143], v[160:163], v[188:191]
s_waitcnt lgkmcnt(4)
v_mfma_f32_16x16x32_bf16 v[176:179], v[132:135], v[164:167], v[176:179]
ds_read_b128 v[132:135], v8 offset:2624
v_mfma_f32_16x16x32_bf16 v[180:183], v[136:139], v[164:167], v[180:183]
ds_read_b128 v[160:163], v9 offset:2592
v_mfma_f32_16x16x32_bf16 v[184:187], v[140:143], v[164:167], v[184:187]
buffer_load_dwordx4 a[204:207], v248, s[24:27], s97 offen offset:1024
v_mfma_f32_16x16x32_bf16 v[188:191], v[144:147], v[164:167], v[188:191]
s_waitcnt lgkmcnt(4)
v_mfma_f32_16x16x32_bf16 v[176:179], v[136:139], v[168:171], v[176:179]
ds_read_b128 v[136:139], v8 offset:2688
v_mfma_f32_16x16x32_bf16 v[180:183], v[140:143], v[168:171], v[180:183]
ds_read_b128 v[164:167], v9 offset:2656
v_mfma_f32_16x16x32_bf16 v[184:187], v[144:147], v[168:171], v[184:187]
buffer_load_dwordx4 a[208:211], v248, s[24:27], s97 offen offset:2048
v_mfma_f32_16x16x32_bf16 v[188:191], v[148:151], v[168:171], v[188:191]
s_waitcnt lgkmcnt(4)
v_mfma_f32_16x16x32_bf16 v[176:179], v[140:143], v[172:175], v[176:179]
ds_read_b128 v[140:143], v8 offset:2752
v_mfma_f32_16x16x32_bf16 v[180:183], v[144:147], v[172:175], v[180:183]
ds_read_b128 v[168:171], v9 offset:2720
v_mfma_f32_16x16x32_bf16 v[184:187], v[148:151], v[172:175], v[184:187]
buffer_load_dwordx4 a[212:215], v248, s[24:27], s97 offen offset:3072
v_mfma_f32_16x16x32_bf16 v[188:191], v[152:155], v[172:175], v[188:191]
L_join_36:
s_waitcnt lgkmcnt(4)
v_mfma_f32_16x16x32_bf16 v[176:179], v[144:147], v[160:163], v[176:179]
ds_read_b128 v[144:147], v8 offset:2816
v_mfma_f32_16x16x32_bf16 v[180:183], v[148:151], v[160:163], v[180:183]
ds_read_b128 v[172:175], v9 offset:2784
v_mfma_f32_16x16x32_bf16 v[184:187], v[152:155], v[160:163], v[184:187]
buffer_load_dwordx4 a[216:219], v248, s[24:27], s98 offen
v_mfma_f32_16x16x32_bf16 v[188:191], v[156:159], v[160:163], v[188:191]
s_add_u32 s97, s97, 5120
s_cmp_eq_u32 s97, s80
s_cselect_b32 s97, s79, s97
s_add_u32 s98, s97, 4096
s_waitcnt lgkmcnt(4)
v_mfma_f32_16x16x32_bf16 v[176:179], v[148:151], v[164:167], v[176:179]
ds_read_b128 v[148:151], v8 offset:2880
v_mfma_f32_16x16x32_bf16 v[180:183], v[152:155], v[164:167], v[180:183]
ds_read_b128 v[160:163], v9 offset:2880
v_mfma_f32_16x16x32_bf16 v[184:187], v[156:159], v[164:167], v[184:187]
buffer_load_dwordx4 a[220:223], v248, s[24:27], s97 offen offset:0
v_mfma_f32_16x16x32_bf16 v[188:191], v[128:131], v[164:167], v[188:191]
s_waitcnt lgkmcnt(4)
v_mfma_f32_16x16x32_bf16 v[176:179], v[152:155], v[168:171], v[176:179]
ds_read_b128 v[152:155], v8 offset:2944
v_mfma_f32_16x16x32_bf16 v[180:183], v[156:159], v[168:171], v[180:183]
ds_read_b128 v[164:167], v9 offset:2944
v_mfma_f32_16x16x32_bf16 v[184:187], v[128:131], v[168:171], v[184:187]
buffer_load_dwordx4 a[224:227], v248, s[24:27], s97 offen offset:1024
v_mfma_f32_16x16x32_bf16 v[188:191], v[132:135], v[168:171], v[188:191]
s_waitcnt lgkmcnt(4)
v_mfma_f32_16x16x32_bf16 v[176:179], v[156:159], v[172:175], v[176:179]
ds_read_b128 v[156:159], v8 offset:3008
v_mfma_f32_16x16x32_bf16 v[180:183], v[128:131], v[172:175], v[180:183]
ds_read_b128 v[168:171], v9 offset:3008
v_mfma_f32_16x16x32_bf16 v[184:187], v[132:135], v[172:175], v[184:187]
buffer_load_dwordx4 a[228:231], v248, s[24:27], s97 offen offset:2048
v_mfma_f32_16x16x32_bf16 v[188:191], v[136:139], v[172:175], v[188:191]
s_waitcnt lgkmcnt(4)
v_mfma_f32_16x16x32_bf16 v[176:179], v[128:131], v[160:163], v[176:179]
ds_read_b128 v[128:131], v8 offset:3072
v_mfma_f32_16x16x32_bf16 v[180:183], v[132:135], v[160:163], v[180:183]
ds_read_b128 v[172:175], v9 offset:3072
v_mfma_f32_16x16x32_bf16 v[184:187], v[136:139], v[160:163], v[184:187]
buffer_load_dwordx4 a[232:235], v248, s[24:27], s97 offen offset:3072
v_mfma_f32_16x16x32_bf16 v[188:191], v[140:143], v[160:163], v[188:191]
s_waitcnt lgkmcnt(4)
v_mfma_f32_16x16x32_bf16 v[176:179], v[132:135], v[164:167], v[176:179]
ds_read_b128 v[132:135], v8 offset:3136
v_mfma_f32_16x16x32_bf16 v[180:183], v[136:139], v[164:167], v[180:183]
ds_read_b128 v[160:163], v9 offset:3168
v_mfma_f32_16x16x32_bf16 v[184:187], v[140:143], v[164:167], v[184:187]
buffer_load_dwordx4 a[236:239], v248, s[24:27], s98 offen
v_mfma_f32_16x16x32_bf16 v[188:191], v[144:147], v[164:167], v[188:191]
s_add_u32 s97, s97, 5120
s_cmp_eq_u32 s97, s80
s_cselect_b32 s97, s79, s97
s_add_u32 s98, s97, 4096
s_waitcnt lgkmcnt(4)
v_mfma_f32_16x16x32_bf16 v[176:179], v[136:139], v[168:171], v[176:179]
ds_read_b128 v[136:139], v8 offset:3200
v_mfma_f32_16x16x32_bf16 v[180:183], v[140:143], v[168:171], v[180:183]
ds_read_b128 v[164:167], v9 offset:3232
v_mfma_f32_16x16x32_bf16 v[184:187], v[144:147], v[168:171], v[184:187]
v_mfma_f32_16x16x32_bf16 v[188:191], v[148:151], v[168:171], v[188:191]
s_waitcnt lgkmcnt(4)
v_mfma_f32_16x16x32_bf16 v[176:179], v[140:143], v[172:175], v[176:179]
ds_read_b128 v[140:143], v8 offset:3264
v_mfma_f32_16x16x32_bf16 v[180:183], v[144:147], v[172:175], v[180:183]
ds_read_b128 v[168:171], v9 offset:3296
v_mfma_f32_16x16x32_bf16 v[184:187], v[148:151], v[172:175], v[184:187]
buffer_load_dwordx4 v[208:211], v248, s[24:27], s97 offen offset:0
v_mfma_f32_16x16x32_bf16 v[188:191], v[152:155], v[172:175], v[188:191]
buffer_load_dword v254, v249, s[24:27], 0 offen sc1
s_waitcnt lgkmcnt(4)
v_mfma_f32_16x16x32_bf16 v[176:179], v[144:147], v[160:163], v[176:179]
ds_read_b128 v[144:147], v8 offset:3328
v_mfma_f32_16x16x32_bf16 v[180:183], v[148:151], v[160:163], v[180:183]
ds_read_b128 v[172:175], v9 offset:3360
v_mfma_f32_16x16x32_bf16 v[184:187], v[152:155], v[160:163], v[184:187]
buffer_load_dwordx4 v[212:215], v248, s[24:27], s97 offen offset:1024
v_mfma_f32_16x16x32_bf16 v[188:191], v[156:159], v[160:163], v[188:191]
s_waitcnt lgkmcnt(4)
v_mfma_f32_16x16x32_bf16 v[176:179], v[148:151], v[164:167], v[176:179]
ds_read_b128 v[148:151], v8 offset:3392
v_mfma_f32_16x16x32_bf16 v[180:183], v[152:155], v[164:167], v[180:183]
ds_read_b128 v[160:163], v9 offset:3456
v_mfma_f32_16x16x32_bf16 v[184:187], v[156:159], v[164:167], v[184:187]
buffer_load_dwordx4 v[216:219], v248, s[24:27], s97 offen offset:2048
v_mfma_f32_16x16x32_bf16 v[188:191], v[128:131], v[164:167], v[188:191]
s_waitcnt lgkmcnt(4)
v_mfma_f32_16x16x32_bf16 v[176:179], v[152:155], v[168:171], v[176:179]
ds_read_b128 v[152:155], v8 offset:3456
v_mfma_f32_16x16x32_bf16 v[180:183], v[156:159], v[168:171], v[180:183]
ds_read_b128 v[164:167], v9 offset:3520
v_mfma_f32_16x16x32_bf16 v[184:187], v[128:131], v[168:171], v[184:187]
buffer_load_dwordx4 v[220:223], v248, s[24:27], s97 offen offset:3072
v_mfma_f32_16x16x32_bf16 v[188:191], v[132:135], v[168:171], v[188:191]
s_waitcnt lgkmcnt(4)
v_mfma_f32_16x16x32_bf16 v[176:179], v[156:159], v[172:175], v[176:179]
ds_read_b128 v[156:159], v8 offset:3520
v_mfma_f32_16x16x32_bf16 v[180:183], v[128:131], v[172:175], v[180:183]
ds_read_b128 v[168:171], v9 offset:3584
v_mfma_f32_16x16x32_bf16 v[184:187], v[132:135], v[172:175], v[184:187]
buffer_load_dwordx4 v[224:227], v248, s[24:27], s98 offen
v_mfma_f32_16x16x32_bf16 v[188:191], v[136:139], v[172:175], v[188:191]
s_add_u32 s97, s97, 5120
s_cmp_eq_u32 s97, s80
s_cselect_b32 s97, s79, s97
s_add_u32 s98, s97, 4096
s_waitcnt lgkmcnt(4)
v_mfma_f32_16x16x32_bf16 v[176:179], v[128:131], v[160:163], v[176:179]
ds_read_b128 v[128:131], v8 offset:3584
v_mfma_f32_16x16x32_bf16 v[180:183], v[132:135], v[160:163], v[180:183]
ds_read_b128 v[172:175], v9 offset:3648
v_mfma_f32_16x16x32_bf16 v[184:187], v[136:139], v[160:163], v[184:187]
buffer_load_dwordx4 v[228:231], v248, s[24:27], s97 offen offset:0
v_mfma_f32_16x16x32_bf16 v[188:191], v[140:143], v[160:163], v[188:191]
s_waitcnt lgkmcnt(4)
v_mfma_f32_16x16x32_bf16 v[176:179], v[132:135], v[164:167], v[176:179]
ds_read_b128 v[132:135], v8 offset:3648
v_mfma_f32_16x16x32_bf16 v[180:183], v[136:139], v[164:167], v[180:183]
ds_read_b128 v[160:163], v9 offset:3744
v_mfma_f32_16x16x32_bf16 v[184:187], v[140:143], v[164:167], v[184:187]
buffer_load_dwordx4 v[232:235], v248, s[24:27], s97 offen offset:1024
v_mfma_f32_16x16x32_bf16 v[188:191], v[144:147], v[164:167], v[188:191]
s_waitcnt lgkmcnt(4)
v_mfma_f32_16x16x32_bf16 v[176:179], v[136:139], v[168:171], v[176:179]
ds_read_b128 v[136:139], v8 offset:3712
v_mfma_f32_16x16x32_bf16 v[180:183], v[140:143], v[168:171], v[180:183]
ds_read_b128 v[164:167], v9 offset:3808
v_mfma_f32_16x16x32_bf16 v[184:187], v[144:147], v[168:171], v[184:187]
buffer_load_dwordx4 v[236:239], v248, s[24:27], s97 offen offset:2048
v_mfma_f32_16x16x32_bf16 v[188:191], v[148:151], v[168:171], v[188:191]
s_waitcnt lgkmcnt(4)
v_mfma_f32_16x16x32_bf16 v[176:179], v[140:143], v[172:175], v[176:179]
ds_read_b128 v[140:143], v8 offset:3776
v_mfma_f32_16x16x32_bf16 v[180:183], v[144:147], v[172:175], v[180:183]
ds_read_b128 v[168:171], v9 offset:3872
v_mfma_f32_16x16x32_bf16 v[184:187], v[148:151], v[172:175], v[184:187]
buffer_load_dwordx4 v[240:243], v248, s[24:27], s97 offen offset:3072
v_mfma_f32_16x16x32_bf16 v[188:191], v[152:155], v[172:175], v[188:191]
s_waitcnt lgkmcnt(4)
v_mfma_f32_16x16x32_bf16 v[176:179], v[144:147], v[160:163], v[176:179]
ds_read_b128 v[144:147], v8 offset:3840
v_mfma_f32_16x16x32_bf16 v[180:183], v[148:151], v[160:163], v[180:183]
ds_read_b128 v[172:175], v9 offset:3936
v_mfma_f32_16x16x32_bf16 v[184:187], v[152:155], v[160:163], v[184:187]
buffer_load_dwordx4 v[244:247], v248, s[24:27], s98 offen
v_mfma_f32_16x16x32_bf16 v[188:191], v[156:159], v[160:163], v[188:191]
s_add_u32 s97, s97, 5120
s_cmp_eq_u32 s97, s80
s_cselect_b32 s97, s79, s97
s_add_u32 s98, s97, 4096
s_waitcnt lgkmcnt(4)
v_mfma_f32_16x16x32_bf16 v[176:179], v[148:151], v[164:167], v[176:179]
ds_read_b128 v[148:151], v8 offset:3904
v_mfma_f32_16x16x32_bf16 v[180:183], v[152:155], v[164:167], v[180:183]
ds_read_b128 v[160:163], v9 offset:4032
v_mfma_f32_16x16x32_bf16 v[184:187], v[156:159], v[164:167], v[184:187]
v_mfma_f32_16x16x32_bf16 v[188:191], v[128:131], v[164:167], v[188:191]
s_waitcnt vmcnt(9)
v_cmp_eq_u32 vcc, 0, v254
s_cbranch_vccnz L_slow_37
L_back_38:
s_mul_i32 s6, s94, 54
s_add_u32 s6, s6, s96
s_lshl_b32 s81, s6, 12
s_add_u32 s81, s81, 10485760
s_cmp_ge_u32 s5, 2
s_cselect_b32 s7, 13, 14
s_lshl_b32 s7, s7, 12
s_add_u32 s82, s81, s7
s_lshl_b32 s7, s93, 12
s_add_u32 s99, s81, s7
s_cmp_eq_u32 s5, 2
s_mov_b32 s78, 4096
s_cselect_b32 s78, 4294856704, s78
s_cmp_eq_u32 s5, 3
s_cselect_b32 s78, 4294860800, s78
s_add_u32 s6, s5, 0
s_and_b32 s6, s6, 3
s_lshl_b32 s6, s6, 10
v_add_u32 v56, s6, v248
s_add_u32 s6, s5, 1
s_and_b32 s6, s6, 3
s_lshl_b32 s6, s6, 10
v_add_u32 v57, s6, v248
s_add_u32 s6, s5, 2
s_and_b32 s6, s6, 3
s_lshl_b32 s6, s6, 10
v_add_u32 v58, s6, v248
s_add_u32 s6, s5, 3
s_and_b32 s6, s6, 3
s_lshl_b32 s6, s6, 10
v_add_u32 v59, s6, v248
s_waitcnt lgkmcnt(4)
v_mfma_f32_16x16x32_bf16 v[176:179], v[152:155], v[168:171], v[176:179]
ds_read_b128 v[152:155], v8 offset:3968
v_mfma_f32_16x16x32_bf16 v[180:183], v[156:159], v[168:171], v[180:183]
ds_read_b128 v[164:167], v9 offset:4096
v_mfma_f32_16x16x32_bf16 v[184:187], v[128:131], v[168:171], v[184:187]
v_mfma_f32_16x16x32_bf16 v[188:191], v[132:135], v[168:171], v[188:191]
s_waitcnt lgkmcnt(4)
v_mfma_f32_16x16x32_bf16 v[176:179], v[156:159], v[172:175], v[176:179]
ds_read_b128 v[156:159], v8 offset:4032
v_mfma_f32_16x16x32_bf16 v[180:183], v[128:131], v[172:175], v[180:183]
ds_read_b128 v[168:171], v9 offset:4160
v_mfma_f32_16x16x32_bf16 v[184:187], v[132:135], v[172:175], v[184:187]
buffer_load_dwordx4 v[64:67], v57, s[24:27], s99 offen
s_add_u32 s99, s99, 4096
v_mfma_f32_16x16x32_bf16 v[188:191], v[136:139], v[172:175], v[188:191]
buffer_load_dwordx4 v[68:71], v57, s[24:27], s99 offen
s_add_u32 s99, s99, 4096
s_waitcnt lgkmcnt(4)
v_mfma_f32_16x16x32_bf16 v[176:179], v[128:131], v[160:163], v[176:179]
ds_read_b128 v[128:131], v8 offset:4096
v_mfma_f32_16x16x32_bf16 v[180:183], v[132:135], v[160:163], v[180:183]
ds_read_b128 v[172:175], v9 offset:4224
v_mfma_f32_16x16x32_bf16 v[184:187], v[136:139], v[160:163], v[184:187]
buffer_load_dwordx4 v[72:75], v57, s[24:27], s99 offen
s_add_u32 s99, s99, 4096
v_mfma_f32_16x16x32_bf16 v[188:191], v[140:143], v[160:163], v[188:191]
s_waitcnt lgkmcnt(4)
v_mfma_f32_16x16x32_bf16 v[176:179], v[132:135], v[164:167], v[176:179]
ds_read_b128 v[132:135], v8 offset:4160
v_mfma_f32_16x16x32_bf16 v[180:183], v[136:139], v[164:167], v[180:183]
ds_read_b128 v[160:163], v9 offset:4320
v_mfma_f32_16x16x32_bf16 v[184:187], v[140:143], v[164:167], v[184:187]
buffer_load_dwordx4 v[76:79], v57, s[24:27], s99 offen
s_add_u32 s99, s99, 4096
v_mfma_f32_16x16x32_bf16 v[188:191], v[144:147], v[164:167], v[188:191]
s_waitcnt lgkmcnt(4)
v_mfma_f32_16x16x32_bf16 v[176:179], v[136:139], v[168:171], v[176:179]
ds_read_b128 v[136:139], v8 offset:4224
v_mfma_f32_16x16x32_bf16 v[180:183], v[140:143], v[168:171], v[180:183]
ds_read_b128 v[164:167], v9 offset:4384
v_mfma_f32_16x16x32_bf16 v[184:187], v[144:147], v[168:171], v[184:187]
buffer_load_dwordx4 v[80:83], v57, s[24:27], s99 offen
s_add_u32 s99, s99, 4096
v_mfma_f32_16x16x32_bf16 v[188:191], v[148:151], v[168:171], v[188:191]
buffer_load_dwordx4 v[84:87], v57, s[24:27], s99 offen
s_add_u32 s99, s99, 4096
s_waitcnt lgkmcnt(4)
v_mfma_f32_16x16x32_bf16 v[176:179], v[140:143], v[172:175], v[176:179]
v_mfma_f32_16x16x32_bf16 v[180:183], v[144:147], v[172:175], v[180:183]
ds_read_b128 v[168:171], v9 offset:4448
v_mfma_f32_16x16x32_bf16 v[184:187], v[148:151], v[172:175], v[184:187]
buffer_load_dwordx4 v[88:91], v57, s[24:27], s99 offen
s_add_u32 s99, s99, 4096
v_mfma_f32_16x16x32_bf16 v[188:191], v[152:155], v[172:175], v[188:191]
s_waitcnt lgkmcnt(3)
v_mfma_f32_16x16x32_bf16 v[176:179], v[144:147], v[160:163], v[176:179]
v_mfma_f32_16x16x32_bf16 v[180:183], v[148:151], v[160:163], v[180:183]
ds_read_b128 v[172:175], v9 offset:4512
v_mfma_f32_16x16x32_bf16 v[184:187], v[152:155], v[160:163], v[184:187]
buffer_load_dwordx4 v[92:95], v57, s[24:27], s99 offen
s_add_u32 s99, s99, 4096
v_mfma_f32_16x16x32_bf16 v[188:191], v[156:159], v[160:163], v[188:191]
s_waitcnt lgkmcnt(2)
v_mfma_f32_16x16x32_bf16 v[176:179], v[148:151], v[164:167], v[176:179]
v_mfma_f32_16x16x32_bf16 v[180:183], v[152:155], v[164:167], v[180:183]
v_mfma_f32_16x16x32_bf16 v[184:187], v[156:159], v[164:167], v[184:187]
buffer_load_dwordx4 v[96:99], v57, s[24:27], s99 offen
s_add_u32 s99, s99, 4096
v_mfma_f32_16x16x32_bf16 v[188:191], v[128:131], v[164:167], v[188:191]
buffer_load_dwordx4 v[100:103], v57, s[24:27], s99 offen
s_add_u32 s99, s99, 4096
s_waitcnt lgkmcnt(1)
v_mfma_f32_16x16x32_bf16 v[176:179], v[152:155], v[168:171], v[176:179]
v_mfma_f32_16x16x32_bf16 v[180:183], v[156:159], v[168:171], v[180:183]
v_mfma_f32_16x16x32_bf16 v[184:187], v[128:131], v[168:171], v[184:187]
buffer_load_dwordx4 v[104:107], v57, s[24:27], s99 offen
s_add_u32 s99, s99, 4096
v_mfma_f32_16x16x32_bf16 v[188:191], v[132:135], v[168:171], v[188:191]
s_waitcnt lgkmcnt(0)
v_mfma_f32_16x16x32_bf16 v[176:179], v[156:159], v[172:175], v[176:179]
v_mfma_f32_16x16x32_bf16 v[180:183], v[128:131], v[172:175], v[180:183]
v_mfma_f32_16x16x32_bf16 v[184:187], v[132:135], v[172:175], v[184:187]
buffer_load_dwordx4 v[108:111], v57, s[24:27], s99 offen
s_add_u32 s99, s99, 4096
v_mfma_f32_16x16x32_bf16 v[188:191], v[136:139], v[172:175], v[188:191]
s_nop 3
v_cvt_pk_bf16_f32 v20, v176, v177
v_cvt_pk_bf16_f32 v21, v178, v179
v_cvt_pk_bf16_f32 v22, v180, v181
v_cvt_pk_bf16_f32 v23, v182, v183
buffer_store_dwordx4 v[20:23], v11, s[24:27], s92 offen offset:0 sc1
v_cvt_pk_bf16_f32 v24, v184, v185
v_cvt_pk_bf16_f32 v25, v186, v187
v_cvt_pk_bf16_f32 v26, v188, v189
v_cvt_pk_bf16_f32 v27, v190, v191
buffer_store_dwordx4 v[24:27], v11, s[24:27], s92 offen offset:128 sc1
L_gemm2:
s_waitcnt vmcnt(13)
v_mfma_f32_16x16x32_bf16 v[148:151], a[0:3], v[64:67], 0
buffer_load_dwordx4 v[112:115], v57, s[24:27], s99 offen
v_mfma_f32_16x16x32_bf16 v[152:155], a[4:7], v[64:67], 0
s_add_u32 s99, s99, s78
v_and_b32 v50, 15, v1
v_mfma_f32_16x16x32_bf16 v[156:159], a[8:11], v[64:67], 0
v_lshrrev_b32 v51, 3, v50
v_lshlrev_b32 v51, 3, v51
v_mfma_f32_16x16x32_bf16 v[160:163], a[12:15], v[64:67], 0
v_and_b32 v52, 3, v50
v_mfma_f32_16x16x32_bf16 v[164:167], a[16:19], v[64:67], 0
v_lshl_or_b32 v51, v52, 1, v51
v_bfe_u32 v52, v50, 2, 1
s_waitcnt vmcnt(13)
v_mfma_f32_16x16x32_bf16 v[148:151], a[20:23], v[68:71], v[148:151]
buffer_load_dwordx4 v[116:119], v57, s[24:27], s99 offen
v_mfma_f32_16x16x32_bf16 v[152:155], a[24:27], v[68:71], v[152:155]
s_mov_b32 s99, s81
v_mfma_f32_16x16x32_bf16 v[156:159], a[28:31], v[68:71], v[156:159]
v_or_b32 v51, v51, v52
v_mul_u32_u24 v51, 176, v51
v_mfma_f32_16x16x32_bf16 v[160:163], a[32:35], v[68:71], v[160:163]
v_lshrrev_b32 v53, 4, v1
v_mfma_f32_16x16x32_bf16 v[164:167], a[36:39], v[68:71], v[164:167]
v_mul_u32_u24 v52, 40, v53
s_mul_i32 s86, s5, 2816
s_waitcnt vmcnt(13)
v_mfma_f32_16x16x32_bf16 v[148:151], a[40:43], v[72:75], v[148:151]
buffer_load_dwordx4 v[120:123], v58, s[24:27], s99 offen
v_mfma_f32_16x16x32_bf16 v[152:155], a[44:47], v[72:75], v[152:155]
s_add_u32 s99, s99, 4096
s_add_u32 s86, s86, 73728
v_mfma_f32_16x16x32_bf16 v[156:159], a[48:51], v[72:75], v[156:159]
v_add_u32 v51, v51, v52
v_mfma_f32_16x16x32_bf16 v[160:163], a[52:55], v[72:75], v[160:163]
s_and_b32 s87, s95, 1
v_mfma_f32_16x16x32_bf16 v[164:167], a[56:59], v[72:75], v[164:167]
s_lshl_b32 s87, s87, 1
v_subrev_u32 v52, s87, v50
s_waitcnt vmcnt(13)
v_mfma_f32_16x16x32_bf16 v[148:151], a[60:63], v[76:79], v[148:151]
buffer_load_dwordx4 v[124:127], v58, s[24:27], s99 offen
v_mfma_f32_16x16x32_bf16 v[152:155], a[64:67], v[76:79], v[152:155]
s_add_u32 s99, s99, 4096
v_lshlrev_b32 v52, 4, v52
v_mfma_f32_16x16x32_bf16 v[156:159], a[68:71], v[76:79], v[156:159]
v_add_u32 v50, s86, v51
v_mfma_f32_16x16x32_bf16 v[160:163], a[72:75], v[76:79], v[160:163]
v_mul_u32_u24 v51, 176, v53
v_add_u32 v51, v51, v52
v_mfma_f32_16x16x32_bf16 v[164:167], a[76:79], v[76:79], v[164:167]
v_add_u32 v51, s86, v51
s_waitcnt vmcnt(13)
v_mfma_f32_16x16x32_bf16 v[148:151], a[80:83], v[80:83], v[148:151]
buffer_load_dwordx4 v[64:67], v58, s[24:27], s99 offen
v_mfma_f32_16x16x32_bf16 v[152:155], a[84:87], v[80:83], v[152:155]
s_add_u32 s99, s99, 4096
s_lshl_b32 s86, s94, 6
v_mfma_f32_16x16x32_bf16 v[156:159], a[88:91], v[80:83], v[156:159]
s_lshl_b32 s85, s5, 4
v_mfma_f32_16x16x32_bf16 v[160:163], a[92:95], v[80:83], v[160:163]
s_add_u32 s86, s86, s85
v_add_u32 v53, s86, v53
v_mfma_f32_16x16x32_bf16 v[164:167], a[96:99], v[80:83], v[164:167]
v_mul_u32_u24 v53, 1280, v53
s_waitcnt vmcnt(13)
v_mfma_f32_16x16x32_bf16 v[148:151], a[100:103], v[84:87], v[148:151]
buffer_load_dwordx4 v[68:71], v58, s[24:27], s99 offen
v_mfma_f32_16x16x32_bf16 v[152:155], a[104:107], v[84:87], v[152:155]
s_add_u32 s99, s99, 4096
s_mul_i32 s86, s95, 160
v_mfma_f32_16x16x32_bf16 v[156:159], a[108:111], v[84:87], v[156:159]
v_add_u32 v52, s86, v52
v_mfma_f32_16x16x32_bf16 v[160:163], a[112:115], v[84:87], v[160:163]
v_add_u32 v52, v52, v53
v_add_u32 v53, 5120, v52
v_mfma_f32_16x16x32_bf16 v[164:167], a[116:119], v[84:87], v[164:167]
v_add_u32 v54, 10240, v52
s_waitcnt vmcnt(13)
v_mfma_f32_16x16x32_bf16 v[148:151], a[120:123], v[88:91], v[148:151]
buffer_load_dwordx4 v[72:75], v58, s[24:27], s99 offen
v_mfma_f32_16x16x32_bf16 v[152:155], a[124:127], v[88:91], v[152:155]
s_add_u32 s99, s99, 4096
v_add_u32 v55, 15360, v52
v_mfma_f32_16x16x32_bf16 v[156:159], a[128:131], v[88:91], v[156:159]
s_lshl_b32 s86, 0x03ff03ff, s87
s_mov_b32 s87, s86
v_mfma_f32_16x16x32_bf16 v[160:163], a[132:135], v[88:91], v[160:163]
s_mul_i32 s83, s5, 15360
v_mfma_f32_16x16x32_bf16 v[164:167], a[136:139], v[88:91], v[164:167]
s_add_u32 s83, s83, 10240
s_waitcnt vmcnt(13)
v_mfma_f32_16x16x32_bf16 v[148:151], a[140:143], v[92:95], v[148:151]
buffer_load_dwordx4 v[76:79], v58, s[24:27], s99 offen
v_mfma_f32_16x16x32_bf16 v[152:155], a[144:147], v[92:95], v[152:155]
s_add_u32 s99, s99, 4096
v_and_b32 v2, 15, v1
v_mfma_f32_16x16x32_bf16 v[156:159], a[148:151], v[92:95], v[156:159]
v_lshrrev_b32 v4, 3, v2
v_lshlrev_b32 v4, 3, v4
v_mfma_f32_16x16x32_bf16 v[160:163], a[152:155], v[92:95], v[160:163]
s_add_u32 m0, s83, 0
s_mov_b64 exec, s[86:87]
buffer_load_dwordx4 v52, s[8:11], 0 offen lds
s_mov_b64 exec, -1
v_mfma_f32_16x16x32_bf16 v[164:167], a[156:159], v[92:95], v[164:167]
v_and_b32 v5, 3, v2
v_lshl_or_b32 v4, v5, 1, v4
s_waitcnt vmcnt(14)
v_mfma_f32_16x16x32_bf16 v[148:151], a[160:163], v[96:99], v[148:151]
buffer_load_dwordx4 v[80:83], v58, s[24:27], s99 offen
v_mfma_f32_16x16x32_bf16 v[152:155], a[164:167], v[96:99], v[152:155]
s_add_u32 s99, s99, 4096
v_bfe_u32 v5, v2, 2, 1
v_mfma_f32_16x16x32_bf16 v[156:159], a[168:171], v[96:99], v[156:159]
v_or_b32 v4, v4, v5
s_lshl_b32 s6, s94, 6
v_mfma_f32_16x16x32_bf16 v[160:163], a[172:175], v[96:99], v[160:163]
s_add_u32 m0, s83, 1088
s_mov_b64 exec, s[86:87]
buffer_load_dwordx4 v53, s[8:11], 0 offen lds
s_mov_b64 exec, -1
v_mfma_f32_16x16x32_bf16 v[164:167], a[176:179], v[96:99], v[164:167]
s_lshl_b32 s7, s5, 4
s_add_u32 s6, s6, s7
s_waitcnt vmcnt(15)
v_mfma_f32_16x16x32_bf16 v[148:151], a[180:183], v[100:103], v[148:151]
buffer_load_dwordx4 v[84:87], v58, s[24:27], s99 offen
v_mfma_f32_16x16x32_bf16 v[152:155], a[184:187], v[100:103], v[152:155]
s_add_u32 s99, s99, 4096
v_add_u32 v5, s6, v4
v_mfma_f32_16x16x32_bf16 v[156:159], a[188:191], v[100:103], v[156:159]
v_lshlrev_b32 v5, 4, v5
v_lshrrev_b32 v3, 2, v4
v_mfma_f32_16x16x32_bf16 v[160:163], a[192:195], v[100:103], v[160:163]
s_add_u32 m0, s83, 2176
s_mov_b64 exec, s[86:87]
buffer_load_dwordx4 v54, s[8:11], 0 offen lds
s_mov_b64 exec, -1
v_mfma_f32_16x16x32_bf16 v[164:167], a[196:199], v[100:103], v[164:167]
v_mul_u32_u24 v3, 1088, v3
v_and_b32 v4, 3, v4
s_waitcnt vmcnt(16)
v_mfma_f32_16x16x32_bf16 v[148:151], a[200:203], v[104:107], v[148:151]
buffer_load_dwordx4 v[88:91], v58, s[24:27], s99 offen
v_mfma_f32_16x16x32_bf16 v[152:155], a[204:207], v[104:107], v[152:155]
s_add_u32 s99, s99, 4096
v_lshl_add_u32 v3, v4, 8, v3
v_mfma_f32_16x16x32_bf16 v[156:159], a[208:211], v[104:107], v[156:159]
v_lshrrev_b32 v4, 4, v1
v_mul_u32_u24 v4, 40, v4
v_mfma_f32_16x16x32_bf16 v[160:163], a[212:215], v[104:107], v[160:163]
s_add_u32 m0, s83, 3264
s_mov_b64 exec, s[86:87]
buffer_load_dwordx4 v55, s[8:11], 0 offen lds
s_mov_b64 exec, -1
v_mfma_f32_16x16x32_bf16 v[164:167], a[216:219], v[104:107], v[164:167]
v_add_u32 v3, v3, v4
s_and_b32 s6, s95, 1
s_lshl_b32 s6, s6, 5
s_add_u32 s6, s6, s83
v_add_u32 v7, s6, v3
s_waitcnt vmcnt(17)
v_mfma_f32_16x16x32_bf16 v[148:151], a[220:223], v[108:111], v[148:151]
buffer_load_dwordx4 v[92:95], v58, s[24:27], s99 offen
v_mfma_f32_16x16x32_bf16 v[152:155], a[224:227], v[108:111], v[152:155]
s_add_u32 s99, s99, 4096
v_mfma_f32_16x16x32_bf16 v[156:159], a[228:231], v[108:111], v[156:159]
v_mfma_f32_16x16x32_bf16 v[160:163], a[232:235], v[108:111], v[160:163]
s_mov_b32 s7, 98304
buffer_load_dwordx2 v[18:19], v5, s[24:27], s7 offen
v_mfma_f32_16x16x32_bf16 v[164:167], a[236:239], v[108:111], v[164:167]
s_waitcnt vmcnt(17)
v_mov_b32 v61, 61440
s_mov_b64 exec, 1
ds_add_rtn_u32 v61, v61, v253
s_mov_b64 exec, -1
s_waitcnt vmcnt(16)
v_mfma_f32_16x16x32_bf16 v[148:151], v[208:211], v[112:115], v[148:151]
buffer_load_dwordx4 v[96:99], v58, s[24:27], s99 offen
v_mfma_f32_16x16x32_bf16 v[152:155], v[212:215], v[112:115], v[152:155]
s_add_u32 s99, s99, 4096
v_accvgpr_read_b32 v2, a240
v_mfma_f32_16x16x32_bf16 v[156:159], v[216:219], v[112:115], v[156:159]
v_lshlrev_b32 v128, 16, v2
v_mfma_f32_16x16x32_bf16 v[160:163], v[220:223], v[112:115], v[160:163]
v_and_b32 v129, 0xffff0000, v2
v_accvgpr_read_b32 v3, a241
v_mfma_f32_16x16x32_bf16 v[164:167], v[224:227], v[112:115], v[164:167]
v_lshlrev_b32 v130, 16, v3
s_waitcnt vmcnt(16)
v_mfma_f32_16x16x32_bf16 v[148:151], v[228:231], v[116:119], v[148:151]
v_mfma_f32_16x16x32_bf16 v[152:155], v[232:235], v[116:119], v[152:155]
v_mfma_f32_16x16x32_bf16 v[156:159], v[236:239], v[116:119], v[156:159]
v_mfma_f32_16x16x32_bf16 v[160:163], v[240:243], v[116:119], v[160:163]
v_mfma_f32_16x16x32_bf16 v[164:167], v[244:247], v[116:119], v[164:167]
s_waitcnt lgkmcnt(0)
v_readfirstlane_b32 s6, v61
s_cmp_lg_u32 s6, 3
s_cbranch_scc1 L_yfl_39
s_mov_b64 exec, 1
buffer_store_dword v253, v252, s[24:27], 0 offen offset:20 sc1
s_mov_b64 exec, -1
L_yfl_39:
s_waitcnt vmcnt(15)
v_mfma_f32_16x16x32_bf16 v[168:171], a[0:3], v[120:123], 0
buffer_load_dwordx4 v[100:103], v58, s[24:27], s99 offen
v_mfma_f32_16x16x32_bf16 v[172:175], a[4:7], v[120:123], 0
s_add_u32 s99, s99, 4096
s_add_u32 s84, s5, 1
s_and_b32 s84, s84, 3
s_mul_i32 s84, s84, 15360
v_mfma_f32_16x16x32_bf16 v[176:179], a[8:11], v[120:123], 0
buffer_load_dwordx4 v[104:107], v58, s[24:27], s99 offen
s_add_u32 s84, s84, 0
v_lshl_add_u32 v60, v1, 4, s84
v_mfma_f32_16x16x32_bf16 v[180:183], a[12:15], v[120:123], 0
s_add_u32 s99, s99, s78
v_mfma_f32_16x16x32_bf16 v[184:187], a[16:19], v[120:123], 0
v_and_b32 v131, 0xffff0000, v3
v_accvgpr_read_b32 v4, a242
s_waitcnt vmcnt(16)
v_mfma_f32_16x16x32_bf16 v[168:171], a[20:23], v[124:127], v[168:171]
buffer_load_dwordx4 v[108:111], v58, s[24:27], s99 offen
v_mfma_f32_16x16x32_bf16 v[172:175], a[24:27], v[124:127], v[172:175]
s_mov_b32 s99, s81
v_mfma_f32_16x16x32_bf16 v[176:179], a[28:31], v[124:127], v[176:179]
ds_write_b128 v60, v[148:151] offset:0
v_mfma_f32_16x16x32_bf16 v[180:183], a[32:35], v[124:127], v[180:183]
v_lshlrev_b32 v132, 16, v4
v_mfma_f32_16x16x32_bf16 v[184:187], a[36:39], v[124:127], v[184:187]
v_and_b32 v133, 0xffff0000, v4
v_accvgpr_read_b32 v5, a243
s_waitcnt vmcnt(16)
v_mfma_f32_16x16x32_bf16 v[168:171], a[40:43], v[64:67], v[168:171]
buffer_load_dwordx4 v[112:115], v59, s[24:27], s99 offen
v_mfma_f32_16x16x32_bf16 v[172:175], a[44:47], v[64:67], v[172:175]
s_add_u32 s99, s99, 4096
v_mfma_f32_16x16x32_bf16 v[176:179], a[48:51], v[64:67], v[176:179]
ds_write_b128 v60, v[152:155] offset:1024
v_mfma_f32_16x16x32_bf16 v[180:183], a[52:55], v[64:67], v[180:183]
v_lshlrev_b32 v134, 16, v5
v_and_b32 v135, 0xffff0000, v5
v_mfma_f32_16x16x32_bf16 v[184:187], a[56:59], v[64:67], v[184:187]
v_accvgpr_read_b32 v2, a244
s_waitcnt vmcnt(16)
v_mfma_f32_16x16x32_bf16 v[168:171], a[60:63], v[68:71], v[168:171]
buffer_load_dwordx4 v[116:119], v59, s[24:27], s99 offen
v_mfma_f32_16x16x32_bf16 v[172:175], a[64:67], v[68:71], v[172:175]
s_add_u32 s99, s99, 4096
v_mfma_f32_16x16x32_bf16 v[176:179], a[68:71], v[68:71], v[176:179]
v_lshlrev_b32 v136, 16, v2
v_and_b32 v137, 0xffff0000, v2
v_mfma_f32_16x16x32_bf16 v[180:183], a[72:75], v[68:71], v[180:183]
v_accvgpr_read_b32 v3, a245
v_mfma_f32_16x16x32_bf16 v[184:187], a[76:79], v[68:71], v[184:187]
ds_write_b128 v60, v[156:159] offset:2048
s_waitcnt vmcnt(16)
v_mfma_f32_16x16x32_bf16 v[168:171], a[80:83], v[72:75], v[168:171]
buffer_load_dwordx4 v[120:123], v59, s[24:27], s99 offen
v_mfma_f32_16x16x32_bf16 v[172:175], a[84:87], v[72:75], v[172:175]
s_add_u32 s99, s99, 4096
v_mfma_f32_16x16x32_bf16 v[176:179], a[88:91], v[72:75], v[176:179]
v_lshlrev_b32 v138, 16, v3
v_and_b32 v139, 0xffff0000, v3
v_mfma_f32_16x16x32_bf16 v[180:183], a[92:95], v[72:75], v[180:183]
v_accvgpr_read_b32 v4, a246
v_mfma_f32_16x16x32_bf16 v[184:187], a[96:99], v[72:75], v[184:187]
v_lshlrev_b32 v140, 16, v4
s_waitcnt vmcnt(16)
v_mfma_f32_16x16x32_bf16 v[168:171], a[100:103], v[76:79], v[168:171]
buffer_load_dwordx4 v[124:127], v59, s[24:27], s99 offen
v_mfma_f32_16x16x32_bf16 v[172:175], a[104:107], v[76:79], v[172:175]
s_add_u32 s99, s99, 4096
v_and_b32 v141, 0xffff0000, v4
v_mfma_f32_16x16x32_bf16 v[176:179], a[108:111], v[76:79], v[176:179]
ds_write_b128 v60, v[160:163] offset:3072
v_mfma_f32_16x16x32_bf16 v[180:183], a[112:115], v[76:79], v[180:183]
v_accvgpr_read_b32 v5, a247
v_mfma_f32_16x16x32_bf16 v[184:187], a[116:119], v[76:79], v[184:187]
v_lshlrev_b32 v142, 16, v5
s_waitcnt vmcnt(15)
v_mfma_f32_16x16x32_bf16 v[168:171], a[120:123], v[80:83], v[168:171]
buffer_load_dwordx4 v[64:67], v59, s[24:27], s99 offen
v_mfma_f32_16x16x32_bf16 v[172:175], a[124:127], v[80:83], v[172:175]
s_add_u32 s99, s99, 4096
v_and_b32 v143, 0xffff0000, v5
v_mfma_f32_16x16x32_bf16 v[176:179], a[128:131], v[80:83], v[176:179]
v_accvgpr_read_b32 v2, a248
v_mfma_f32_16x16x32_bf16 v[180:183], a[132:135], v[80:83], v[180:183]
ds_write_b128 v60, v[164:167] offset:4096
v_mfma_f32_16x16x32_bf16 v[184:187], a[136:139], v[80:83], v[184:187]
v_lshlrev_b32 v144, 16, v2
s_waitcnt vmcnt(14)
v_mfma_f32_16x16x32_bf16 v[168:171], a[140:143], v[84:87], v[168:171]
buffer_load_dwordx4 v[68:71], v59, s[24:27], s99 offen
v_mfma_f32_16x16x32_bf16 v[172:175], a[144:147], v[84:87], v[172:175]
s_add_u32 s99, s99, 4096
v_and_b32 v145, 0xffff0000, v2
v_mfma_f32_16x16x32_bf16 v[176:179], a[148:151], v[84:87], v[176:179]
v_accvgpr_read_b32 v3, a249
v_mfma_f32_16x16x32_bf16 v[180:183], a[152:155], v[84:87], v[180:183]
v_lshlrev_b32 v146, 16, v3
v_mfma_f32_16x16x32_bf16 v[184:187], a[156:159], v[84:87], v[184:187]
v_and_b32 v147, 0xffff0000, v3
s_waitcnt vmcnt(13)
v_mfma_f32_16x16x32_bf16 v[168:171], a[160:163], v[88:91], v[168:171]
buffer_load_dwordx4 v[72:75], v59, s[24:27], s99 offen
v_mfma_f32_16x16x32_bf16 v[172:175], a[164:167], v[88:91], v[172:175]
s_add_u32 s99, s99, 4096
s_mul_i32 s82, s5, 15360
v_mfma_f32_16x16x32_bf16 v[176:179], a[168:171], v[88:91], v[176:179]
s_add_u32 s82, s82, 0
v_mfma_f32_16x16x32_bf16 v[180:183], a[172:175], v[88:91], v[180:183]
v_lshl_add_u32 v62, v1, 4, s82
v_lshrrev_b32 v2, 4, v1
v_mfma_f32_16x16x32_bf16 v[184:187], a[176:179], v[88:91], v[184:187]
v_mul_u32_u24 v2, 20, v2
s_waitcnt vmcnt(12)
v_mfma_f32_16x16x32_bf16 v[168:171], a[180:183], v[92:95], v[168:171]
buffer_load_dwordx4 v[76:79], v59, s[24:27], s99 offen
v_mfma_f32_16x16x32_bf16 v[172:175], a[184:187], v[92:95], v[172:175]
s_add_u32 s99, s99, 4096
v_bfe_u32 v3, v1, 2, 2
v_mfma_f32_16x16x32_bf16 v[176:179], a[188:191], v[92:95], v[176:179]
v_add_u32 v2, v2, v3
v_mfma_f32_16x16x32_bf16 v[180:183], a[192:195], v[92:95], v[180:183]
v_lshlrev_b32 v2, 7, v2
v_mfma_f32_16x16x32_bf16 v[184:187], a[196:199], v[92:95], v[184:187]
v_and_b32 v3, 3, v1
s_waitcnt vmcnt(11)
v_mfma_f32_16x16x32_bf16 v[168:171], a[200:203], v[96:99], v[168:171]
buffer_load_dwordx4 v[80:83], v59, s[24:27], s99 offen
v_mfma_f32_16x16x32_bf16 v[172:175], a[204:207], v[96:99], v[172:175]
s_add_u32 s99, s99, 4096
v_lshl_add_u32 v2, v3, 4, v2
v_mfma_f32_16x16x32_bf16 v[176:179], a[208:211], v[96:99], v[176:179]
s_and_b32 s82, s5, 1
v_mfma_f32_16x16x32_bf16 v[180:183], a[212:215], v[96:99], v[180:183]
s_lshl_b32 s82, s82, 6
s_lshr_b32 s83, s5, 1
v_mfma_f32_16x16x32_bf16 v[184:187], a[216:219], v[96:99], v[184:187]
s_lshl_b32 s83, s83, 3
s_waitcnt vmcnt(11)
v_mfma_f32_16x16x32_bf16 v[168:171], a[220:223], v[100:103], v[168:171]
buffer_load_dwordx4 v[84:87], v59, s[24:27], s99 offen
v_mfma_f32_16x16x32_bf16 v[172:175], a[224:227], v[100:103], v[172:175]
s_add_u32 s99, s99, 4096
ds_read_b64 v[8:9], v7 offset:0
v_mfma_f32_16x16x32_bf16 v[176:179], a[228:231], v[100:103], v[176:179]
ds_read_b64 v[10:11], v7 offset:8
ds_read_b64 v[12:13], v7 offset:16
v_mfma_f32_16x16x32_bf16 v[180:183], a[232:235], v[100:103], v[180:183]
ds_read_b64 v[14:15], v7 offset:24
v_mfma_f32_16x16x32_bf16 v[184:187], a[236:239], v[100:103], v[184:187]
ds_read_b64 v[16:17], v7 offset:32
s_add_u32 s82, s82, s83
s_waitcnt vmcnt(11)
v_mfma_f32_16x16x32_bf16 v[168:171], v[208:211], v[104:107], v[168:171]
buffer_load_dwordx4 v[88:91], v59, s[24:27], s99 offen
v_mfma_f32_16x16x32_bf16 v[172:175], v[212:215], v[104:107], v[172:175]
s_add_u32 s99, s99, 4096
s_add_u32 s82, s82, 61440
v_mfma_f32_16x16x32_bf16 v[176:179], v[216:219], v[104:107], v[176:179]
v_add_u32 v63, s82, v2
v_mfma_f32_16x16x32_bf16 v[180:183], v[220:223], v[104:107], v[180:183]
v_mov_b32 v48, -1.4426950408889634
v_mfma_f32_16x16x32_bf16 v[184:187], v[224:227], v[104:107], v[184:187]
v_mov_b32 v49, 1.0
s_waitcnt vmcnt(11)
v_mfma_f32_16x16x32_bf16 v[168:171], v[228:231], v[108:111], v[168:171]
v_mfma_f32_16x16x32_bf16 v[172:175], v[232:235], v[108:111], v[172:175]
v_mfma_f32_16x16x32_bf16 v[176:179], v[236:239], v[108:111], v[176:179]
v_mfma_f32_16x16x32_bf16 v[180:183], v[240:243], v[108:111], v[180:183]
v_mfma_f32_16x16x32_bf16 v[184:187], v[244:247], v[108:111], v[184:187]
s_waitcnt lgkmcnt(0)
s_waitcnt vmcnt(10)
v_mfma_f32_16x16x32_bf16 v[188:191], a[0:3], v[112:115], 0
buffer_load_dwordx4 v[92:95], v59, s[24:27], s99 offen
v_mfma_f32_16x16x32_bf16 v[192:195], a[4:7], v[112:115], 0
s_add_u32 s99, s99, 4096
s_add_u32 s84, s5, 2
s_and_b32 s84, s84, 3
s_mul_i32 s84, s84, 15360
v_mfma_f32_16x16x32_bf16 v[196:199], a[8:11], v[112:115], 0
buffer_load_dwordx4 v[96:99], v59, s[24:27], s99 offen
s_add_u32 s84, s84, 5120
v_lshl_add_u32 v60, v1, 4, s84
v_mfma_f32_16x16x32_bf16 v[200:203], a[12:15], v[112:115], 0
s_mov_b32 s99, s81
v_mul_f32 v6, v18, v19
v_mfma_f32_16x16x32_bf16 v[204:207], a[16:19], v[112:115], 0
v_mov_b32 v7, v19
v_sub_f32 v6, 0, v6
s_waitcnt vmcnt(11)
v_mfma_f32_16x16x32_bf16 v[188:191], a[20:23], v[116:119], v[188:191]
v_lshlrev_b32 v40, 16, v8
v_mfma_f32_16x16x32_bf16 v[192:195], a[24:27], v[116:119], v[192:195]
ds_write_b128 v60, v[168:171] offset:0
v_mfma_f32_16x16x32_bf16 v[196:199], a[28:31], v[116:119], v[196:199]
v_and_b32 v41, 0xffff0000, v8
v_lshlrev_b32 v42, 16, v9
v_mfma_f32_16x16x32_bf16 v[200:203], a[32:35], v[116:119], v[200:203]
v_and_b32 v43, 0xffff0000, v9
v_mfma_f32_16x16x32_bf16 v[204:207], a[36:39], v[116:119], v[204:207]
v_lshlrev_b32 v44, 16, v10
v_and_b32 v45, 0xffff0000, v10
s_waitcnt vmcnt(10)
v_mfma_f32_16x16x32_bf16 v[188:191], a[40:43], v[120:123], v[188:191]
buffer_load_dwordx4 v[104:107], v56, s[24:27], s99 offen
v_mfma_f32_16x16x32_bf16 v[192:195], a[44:47], v[120:123], v[192:195]
s_add_u32 s99, s99, 4096
v_mfma_f32_16x16x32_bf16 v[196:199], a[48:51], v[120:123], v[196:199]
ds_write_b128 v60, v[172:175] offset:1024
v_mfma_f32_16x16x32_bf16 v[200:203], a[52:55], v[120:123], v[200:203]
v_lshlrev_b32 v46, 16, v11
v_and_b32 v47, 0xffff0000, v11
v_mfma_f32_16x16x32_bf16 v[204:207], a[56:59], v[120:123], v[204:207]
v_lshlrev_b32 v28, 16, v12
s_waitcnt vmcnt(10)
v_mfma_f32_16x16x32_bf16 v[188:191], a[60:63], v[124:127], v[188:191]
buffer_load_dwordx4 v[108:111], v56, s[24:27], s99 offen
v_mfma_f32_16x16x32_bf16 v[192:195], a[64:67], v[124:127], v[192:195]
s_add_u32 s99, s99, 4096
v_and_b32 v29, 0xffff0000, v12
v_mfma_f32_16x16x32_bf16 v[196:199], a[68:71], v[124:127], v[196:199]
v_lshlrev_b32 v30, 16, v13
v_mfma_f32_16x16x32_bf16 v[200:203], a[72:75], v[124:127], v[200:203]
v_and_b32 v31, 0xffff0000, v13
v_lshlrev_b32 v32, 16, v14
v_mfma_f32_16x16x32_bf16 v[204:207], a[76:79], v[124:127], v[204:207]
ds_write_b128 v60, v[176:179] offset:2048
s_waitcnt vmcnt(10)
v_mfma_f32_16x16x32_bf16 v[188:191], a[80:83], v[64:67], v[188:191]
buffer_load_dwordx4 v[112:115], v56, s[24:27], s99 offen
v_mfma_f32_16x16x32_bf16 v[192:195], a[84:87], v[64:67], v[192:195]
s_add_u32 s99, s99, 4096
v_and_b32 v33, 0xffff0000, v14
v_mfma_f32_16x16x32_bf16 v[196:199], a[88:91], v[64:67], v[196:199]
v_lshlrev_b32 v34, 16, v15
v_mfma_f32_16x16x32_bf16 v[200:203], a[92:95], v[64:67], v[200:203]
v_and_b32 v35, 0xffff0000, v15
v_mfma_f32_16x16x32_bf16 v[204:207], a[96:99], v[64:67], v[204:207]
v_lshlrev_b32 v36, 16, v16
v_and_b32 v37, 0xffff0000, v16
s_waitcnt vmcnt(10)
v_mfma_f32_16x16x32_bf16 v[188:191], a[100:103], v[68:71], v[188:191]
buffer_load_dwordx4 v[116:119], v56, s[24:27], s99 offen
v_mfma_f32_16x16x32_bf16 v[192:195], a[104:107], v[68:71], v[192:195]
s_add_u32 s99, s99, 4096
v_lshlrev_b32 v38, 16, v17
v_mfma_f32_16x16x32_bf16 v[196:199], a[108:111], v[68:71], v[196:199]
ds_write_b128 v60, v[180:183] offset:3072
v_mfma_f32_16x16x32_bf16 v[200:203], a[112:115], v[68:71], v[200:203]
v_and_b32 v39, 0xffff0000, v17
v_mfma_f32_16x16x32_bf16 v[204:207], a[116:119], v[68:71], v[204:207]
v_fma_f32 v20, v40, v7, v6
v_fma_f32 v21, v41, v7, v6
s_waitcnt vmcnt(10)
v_mfma_f32_16x16x32_bf16 v[188:191], a[120:123], v[72:75], v[188:191]
buffer_load_dwordx4 v[120:123], v56, s[24:27], s99 offen
v_mfma_f32_16x16x32_bf16 v[192:195], a[124:127], v[72:75], v[192:195]
s_add_u32 s99, s99, 4096
v_mfma_f32_16x16x32_bf16 v[196:199], a[128:131], v[72:75], v[196:199]
v_fma_f32 v22, v42, v7, v6
v_fma_f32 v23, v43, v7, v6
v_mfma_f32_16x16x32_bf16 v[200:203], a[132:135], v[72:75], v[200:203]
ds_write_b128 v60, v[184:187] offset:4096
v_mfma_f32_16x16x32_bf16 v[204:207], a[136:139], v[72:75], v[204:207]
v_fma_f32 v24, v44, v7, v6
s_cmp_lg_u32 s5, 0
s_cbranch_scc1 L_ypl_40
buffer_load_dword v254, v250, s[24:27], 0 offen sc1
L_ypl_40:
s_waitcnt vmcnt(10)
v_mfma_f32_16x16x32_bf16 v[188:191], a[140:143], v[76:79], v[188:191]
buffer_load_dwordx4 v[124:127], v56, s[24:27], s99 offen
v_mfma_f32_16x16x32_bf16 v[192:195], a[144:147], v[76:79], v[192:195]
s_add_u32 s99, s99, 4096
v_fma_f32 v25, v45, v7, v6
v_mfma_f32_16x16x32_bf16 v[196:199], a[148:151], v[76:79], v[196:199]
v_fma_f32 v26, v46, v7, v6
v_mfma_f32_16x16x32_bf16 v[200:203], a[152:155], v[76:79], v[200:203]
v_fma_f32 v27, v47, v7, v6
v_fma_f32 v28, v28, v7, v6
v_mfma_f32_16x16x32_bf16 v[204:207], a[156:159], v[76:79], v[204:207]
v_fma_f32 v29, v29, v7, v6
s_waitcnt vmcnt(10)
v_mfma_f32_16x16x32_bf16 v[188:191], a[160:163], v[80:83], v[188:191]
buffer_load_dwordx4 v[64:67], v56, s[24:27], s99 offen
v_mfma_f32_16x16x32_bf16 v[192:195], a[164:167], v[80:83], v[192:195]
s_add_u32 s99, s99, 4096
v_fma_f32 v30, v30, v7, v6
v_mfma_f32_16x16x32_bf16 v[196:199], a[168:171], v[80:83], v[196:199]
v_fma_f32 v31, v31, v7, v6
v_mfma_f32_16x16x32_bf16 v[200:203], a[172:175], v[80:83], v[200:203]
v_fma_f32 v32, v32, v7, v6
v_fma_f32 v33, v33, v7, v6
v_mfma_f32_16x16x32_bf16 v[204:207], a[176:179], v[80:83], v[204:207]
v_fma_f32 v34, v34, v7, v6
s_waitcnt vmcnt(10)
v_mfma_f32_16x16x32_bf16 v[188:191], a[180:183], v[84:87], v[188:191]
buffer_load_dwordx4 v[68:71], v56, s[24:27], s99 offen
v_mfma_f32_16x16x32_bf16 v[192:195], a[184:187], v[84:87], v[192:195]
s_add_u32 s99, s99, 4096
v_fma_f32 v35, v35, v7, v6
v_mfma_f32_16x16x32_bf16 v[196:199], a[188:191], v[84:87], v[196:199]
v_fma_f32 v36, v36, v7, v6
v_fma_f32 v37, v37, v7, v6
v_mfma_f32_16x16x32_bf16 v[200:203], a[192:195], v[84:87], v[200:203]
v_fma_f32 v38, v38, v7, v6
v_lshrrev_b32 v2, 3, v1
v_mfma_f32_16x16x32_bf16 v[204:207], a[196:199], v[84:87], v[204:207]
v_fma_f32 v39, v39, v7, v6
v_and_b32 v3, 7, v1
s_waitcnt vmcnt(10)
v_mfma_f32_16x16x32_bf16 v[188:191], a[200:203], v[88:91], v[188:191]
buffer_load_dwordx4 v[72:75], v56, s[24:27], s99 offen
v_mfma_f32_16x16x32_bf16 v[192:195], a[204:207], v[88:91], v[192:195]
s_add_u32 s99, s99, 4096
v_lshlrev_b32 v3, 4, v3
v_mfma_f32_16x16x32_bf16 v[196:199], a[208:211], v[88:91], v[196:199]
v_lshl_add_u32 v61, v2, 12, v3
v_mfma_f32_16x16x32_bf16 v[200:203], a[212:215], v[88:91], v[200:203]
s_mul_i32 s90, s95, 80
v_mfma_f32_16x16x32_bf16 v[204:207], a[216:219], v[88:91], v[204:207]
s_lshl_b32 s91, s5, 3
s_add_u32 s90, s90, s91
s_waitcnt vmcnt(10)
v_mfma_f32_16x16x32_bf16 v[188:191], a[220:223], v[92:95], v[188:191]
buffer_load_dwordx4 v[76:79], v56, s[24:27], s99 offen
v_mfma_f32_16x16x32_bf16 v[192:195], a[224:227], v[92:95], v[192:195]
s_add_u32 s99, s99, 4096
v_mfma_f32_16x16x32_bf16 v[196:199], a[228:231], v[92:95], v[196:199]
s_lshl_b32 s90, s90, 12
s_lshl_b32 s91, s94, 7
v_mfma_f32_16x16x32_bf16 v[200:203], a[232:235], v[92:95], v[200:203]
s_add_u32 s90, s90, s91
v_mfma_f32_16x16x32_bf16 v[204:207], a[236:239], v[92:95], v[204:207]
s_add_u32 s90, s90, 4194304
s_lshl_b32 s91, s5, 14
s_waitcnt vmcnt(10)
v_mfma_f32_16x16x32_bf16 v[188:191], v[208:211], v[96:99], v[188:191]
buffer_load_dwordx4 v[80:83], v56, s[24:27], s99 offen
v_mfma_f32_16x16x32_bf16 v[192:195], v[212:215], v[96:99], v[192:195]
s_add_u32 s99, s99, 4096
v_mfma_f32_16x16x32_bf16 v[196:199], v[216:219], v[96:99], v[196:199]
s_sub_u32 s88, s90, s91
s_add_u32 s88, s88, 262144
v_mfma_f32_16x16x32_bf16 v[200:203], v[220:223], v[96:99], v[200:203]
s_lshl_b32 s89, s5, 9
v_mfma_f32_16x16x32_bf16 v[204:207], v[224:227], v[96:99], v[204:207]
s_add_u32 s89, s89, 69632
s_waitcnt vmcnt(10)
v_mfma_f32_16x16x32_bf16 v[128:131], a[0:3], v[104:107], v[128:131]
buffer_load_dwordx4 v[84:87], v56, s[24:27], s99 offen
v_mfma_f32_16x16x32_bf16 v[132:135], a[4:7], v[104:107], v[132:135]
s_add_u32 s99, s99, 4096
s_add_u32 s84, s5, 3
s_and_b32 s84, s84, 3
s_mul_i32 s84, s84, 15360
v_mfma_f32_16x16x32_bf16 v[136:139], a[8:11], v[104:107], v[136:139]
buffer_load_dwordx4 v[88:91], v56, s[24:27], s99 offen
s_add_u32 s84, s84, 10240
v_lshl_add_u32 v60, v1, 4, s84
v_mfma_f32_16x16x32_bf16 v[140:143], a[12:15], v[104:107], v[140:143]
s_mov_b32 s99, s81
s_lshl_b32 s91, s5, 10
v_mfma_f32_16x16x32_bf16 v[144:147], a[16:19], v[104:107], v[144:147]
s_add_u32 s91, s91, 61440
s_barrier
s_waitcnt vmcnt(11)
v_mfma_f32_16x16x32_bf16 v[128:131], a[20:23], v[108:111], v[128:131]
v_mfma_f32_16x16x32_bf16 v[132:135], a[24:27], v[108:111], v[132:135]
ds_write_b128 v60, v[188:191] offset:0
v_mfma_f32_16x16x32_bf16 v[136:139], a[28:31], v[108:111], v[136:139]
v_mfma_f32_16x16x32_bf16 v[140:143], a[32:35], v[108:111], v[140:143]
v_mfma_f32_16x16x32_bf16 v[144:147], a[36:39], v[108:111], v[144:147]
ds_write_b128 v60, v[192:195] offset:1024
s_waitcnt vmcnt(10)
v_mfma_f32_16x16x32_bf16 v[128:131], a[40:43], v[112:115], v[128:131]
v_lshlrev_b32 v96, 16, v12
v_mfma_f32_16x16x32_bf16 v[132:135], a[44:47], v[112:115], v[132:135]
v_and_b32 v97, 0xffff0000, v12
v_mfma_f32_16x16x32_bf16 v[136:139], a[48:51], v[112:115], v[136:139]
v_lshlrev_b32 v98, 16, v13
v_mfma_f32_16x16x32_bf16 v[140:143], a[52:55], v[112:115], v[140:143]
ds_write_b128 v60, v[196:199] offset:2048
v_mfma_f32_16x16x32_bf16 v[144:147], a[56:59], v[112:115], v[144:147]
v_and_b32 v99, 0xffff0000, v13
s_waitcnt vmcnt(9)
v_mfma_f32_16x16x32_bf16 v[128:131], a[60:63], v[116:119], v[128:131]
v_lshlrev_b32 v100, 16, v14
v_mfma_f32_16x16x32_bf16 v[132:135], a[64:67], v[116:119], v[132:135]
v_and_b32 v101, 0xffff0000, v14
v_mfma_f32_16x16x32_bf16 v[136:139], a[68:71], v[116:119], v[136:139]
ds_write_b128 v60, v[200:203] offset:3072
v_mfma_f32_16x16x32_bf16 v[140:143], a[72:75], v[116:119], v[140:143]
v_lshlrev_b32 v102, 16, v15
v_mfma_f32_16x16x32_bf16 v[144:147], a[76:79], v[116:119], v[144:147]
v_and_b32 v103, 0xffff0000, v15
s_waitcnt vmcnt(8)
v_mfma_f32_16x16x32_bf16 v[128:131], a[80:83], v[120:123], v[128:131]
v_lshlrev_b32 v104, 16, v16
v_mfma_f32_16x16x32_bf16 v[132:135], a[84:87], v[120:123], v[132:135]
ds_write_b128 v60, v[204:207] offset:4096
v_mfma_f32_16x16x32_bf16 v[136:139], a[88:91], v[120:123], v[136:139]
v_and_b32 v105, 0xffff0000, v16
v_mfma_f32_16x16x32_bf16 v[140:143], a[92:95], v[120:123], v[140:143]
v_lshlrev_b32 v106, 16, v17
v_mfma_f32_16x16x32_bf16 v[144:147], a[96:99], v[120:123], v[144:147]
v_and_b32 v107, 0xffff0000, v17
s_cmp_lg_u32 s5, 0
s_cbranch_scc1 L_back_42
s_waitcnt vmcnt(8)
v_cmp_eq_u32 vcc, 0, v254
s_cbranch_vccnz L_slow_41
L_back_42:
s_waitcnt lgkmcnt(0)
s_barrier
s_mov_b32 m0, s91
s_add_u32 s91, s91, 4096
buffer_load_dwordx4 v61, s[24:27], s90 offen lds
s_add_u32 s90, s90, 131072
s_mov_b32 m0, s91
s_add_u32 s91, s91, 4096
buffer_load_dwordx4 v61, s[24:27], s90 offen lds
s_add_u32 s90, s90, 131072
s_mov_b32 m0, s89
s_mov_b32 exec_hi, 0
buffer_load_dwordx4 v61, s[24:27], s88 offen lds
s_mov_b32 exec_hi, -1
s_waitcnt vmcnt(10)
v_mfma_f32_16x16x32_bf16 v[128:131], a[100:103], v[124:127], v[128:131]
ds_read_b128 v[148:151], v62 offset:0
ds_read_b128 v[152:155], v62 offset:1024
v_mfma_f32_16x16x32_bf16 v[132:135], a[104:107], v[124:127], v[132:135]
ds_read_b128 v[156:159], v62 offset:2048
v_mfma_f32_16x16x32_bf16 v[136:139], a[108:111], v[124:127], v[136:139]
ds_read_b128 v[160:163], v62 offset:3072
ds_read_b128 v[164:167], v62 offset:4096
v_mfma_f32_16x16x32_bf16 v[140:143], a[112:115], v[124:127], v[140:143]
ds_read_b128 v[168:171], v62 offset:5120
v_mfma_f32_16x16x32_bf16 v[144:147], a[116:119], v[124:127], v[144:147]
ds_read_b128 v[172:175], v62 offset:6144
ds_read_b128 v[176:179], v62 offset:7168
s_waitcnt vmcnt(9)
v_mfma_f32_16x16x32_bf16 v[128:131], a[120:123], v[64:67], v[128:131]
ds_read_b128 v[180:183], v62 offset:8192
v_mfma_f32_16x16x32_bf16 v[132:135], a[124:127], v[64:67], v[132:135]
ds_read_b128 v[184:187], v62 offset:9216
ds_read_b128 v[188:191], v62 offset:10240
v_mfma_f32_16x16x32_bf16 v[136:139], a[128:131], v[64:67], v[136:139]
ds_read_b128 v[192:195], v62 offset:11264
v_mfma_f32_16x16x32_bf16 v[140:143], a[132:135], v[64:67], v[140:143]
ds_read_b128 v[196:199], v62 offset:12288
ds_read_b128 v[200:203], v62 offset:13312
v_mfma_f32_16x16x32_bf16 v[144:147], a[136:139], v[64:67], v[144:147]
ds_read_b128 v[204:207], v62 offset:14336
s_waitcnt vmcnt(8)
v_mfma_f32_16x16x32_bf16 v[128:131], a[140:143], v[68:71], v[128:131]
v_mfma_f32_16x16x32_bf16 v[132:135], a[144:147], v[68:71], v[132:135]
v_mfma_f32_16x16x32_bf16 v[136:139], a[148:151], v[68:71], v[136:139]
v_mfma_f32_16x16x32_bf16 v[140:143], a[152:155], v[68:71], v[140:143]
v_mfma_f32_16x16x32_bf16 v[144:147], a[156:159], v[68:71], v[144:147]
s_waitcnt lgkmcnt(5)
s_waitcnt vmcnt(7)
v_mfma_f32_16x16x32_bf16 v[128:131], a[160:163], v[72:75], v[128:131]
v_add_f32 v148, v148, v168
v_add_f32 v149, v149, v169
v_mfma_f32_16x16x32_bf16 v[132:135], a[164:167], v[72:75], v[132:135]
v_add_f32 v150, v150, v170
v_add_f32 v151, v151, v171
v_mfma_f32_16x16x32_bf16 v[136:139], a[168:171], v[72:75], v[136:139]
v_add_f32 v152, v152, v172
v_add_f32 v153, v153, v173
v_mfma_f32_16x16x32_bf16 v[140:143], a[172:175], v[72:75], v[140:143]
v_add_f32 v154, v154, v174
v_add_f32 v155, v155, v175
v_mfma_f32_16x16x32_bf16 v[144:147], a[176:179], v[72:75], v[144:147]
v_add_f32 v156, v156, v176
v_add_f32 v157, v157, v177
s_waitcnt vmcnt(6)
v_mfma_f32_16x16x32_bf16 v[128:131], a[180:183], v[76:79], v[128:131]
v_add_f32 v158, v158, v178
v_add_f32 v159, v159, v179
v_mfma_f32_16x16x32_bf16 v[132:135], a[184:187], v[76:79], v[132:135]
v_add_f32 v160, v160, v180
v_add_f32 v161, v161, v181
v_mfma_f32_16x16x32_bf16 v[136:139], a[188:191], v[76:79], v[136:139]
v_add_f32 v162, v162, v182
v_add_f32 v163, v163, v183
v_mfma_f32_16x16x32_bf16 v[140:143], a[192:195], v[76:79], v[140:143]
v_add_f32 v164, v164, v184
v_add_f32 v165, v165, v185
v_mfma_f32_16x16x32_bf16 v[144:147], a[196:199], v[76:79], v[144:147]
v_add_f32 v166, v166, v186
v_add_f32 v167, v167, v187
s_waitcnt lgkmcnt(0)
s_waitcnt vmcnt(5)
v_mfma_f32_16x16x32_bf16 v[128:131], a[200:203], v[80:83], v[128:131]
v_add_f32 v148, v148, v188
v_add_f32 v149, v149, v189
v_mfma_f32_16x16x32_bf16 v[132:135], a[204:207], v[80:83], v[132:135]
v_add_f32 v150, v150, v190
v_add_f32 v151, v151, v191
v_mfma_f32_16x16x32_bf16 v[136:139], a[208:211], v[80:83], v[136:139]
v_add_f32 v152, v152, v192
v_add_f32 v153, v153, v193
v_mfma_f32_16x16x32_bf16 v[140:143], a[212:215], v[80:83], v[140:143]
v_add_f32 v154, v154, v194
v_add_f32 v155, v155, v195
v_mfma_f32_16x16x32_bf16 v[144:147], a[216:219], v[80:83], v[144:147]
v_add_f32 v156, v156, v196
v_add_f32 v157, v157, v197
s_waitcnt vmcnt(4)
v_mfma_f32_16x16x32_bf16 v[128:131], a[220:223], v[84:87], v[128:131]
v_add_f32 v158, v158, v198
v_add_f32 v159, v159, v199
v_mfma_f32_16x16x32_bf16 v[132:135], a[224:227], v[84:87], v[132:135]
v_add_f32 v160, v160, v200
v_add_f32 v161, v161, v201
v_mfma_f32_16x16x32_bf16 v[136:139], a[228:231], v[84:87], v[136:139]
v_add_f32 v162, v162, v202
v_add_f32 v163, v163, v203
v_mfma_f32_16x16x32_bf16 v[140:143], a[232:235], v[84:87], v[140:143]
v_add_f32 v164, v164, v204
v_add_f32 v165, v165, v205
v_mfma_f32_16x16x32_bf16 v[144:147], a[236:239], v[84:87], v[144:147]
v_add_f32 v166, v166, v206
v_add_f32 v167, v167, v207
s_waitcnt vmcnt(3)
v_mfma_f32_16x16x32_bf16 v[128:131], v[208:211], v[88:91], v[128:131]
v_mfma_f32_16x16x32_bf16 v[132:135], v[212:215], v[88:91], v[132:135]
v_mfma_f32_16x16x32_bf16 v[136:139], v[216:219], v[88:91], v[136:139]
v_mfma_f32_16x16x32_bf16 v[140:143], v[220:223], v[88:91], v[140:143]
v_mfma_f32_16x16x32_bf16 v[144:147], v[224:227], v[88:91], v[144:147]
s_nop 7
v_pk_add_f32 v[128:129], v[128:129], v[148:149]
v_pk_add_f32 v[130:131], v[130:131], v[150:151]
v_pk_add_f32 v[132:133], v[132:133], v[152:153]
v_pk_add_f32 v[134:135], v[134:135], v[154:155]
v_pk_add_f32 v[136:137], v[136:137], v[156:157]
v_pk_add_f32 v[138:139], v[138:139], v[158:159]
v_pk_add_f32 v[140:141], v[140:141], v[160:161]
v_pk_add_f32 v[142:143], v[142:143], v[162:163]
v_pk_add_f32 v[144:145], v[144:145], v[164:165]
v_pk_add_f32 v[146:147], v[146:147], v[166:167]
v_pk_mul_f32 v[64:65], v[128:129], v[48:49] op_sel_hi:[1,0]
v_pk_mul_f32 v[66:67], v[130:131], v[48:49] op_sel_hi:[1,0]
v_pk_mul_f32 v[68:69], v[132:133], v[48:49] op_sel_hi:[1,0]
v_pk_mul_f32 v[70:71], v[134:135], v[48:49] op_sel_hi:[1,0]
v_pk_mul_f32 v[72:73], v[136:137], v[48:49] op_sel_hi:[1,0]
v_pk_mul_f32 v[74:75], v[138:139], v[48:49] op_sel_hi:[1,0]
v_pk_mul_f32 v[76:77], v[140:141], v[48:49] op_sel_hi:[1,0]
v_pk_mul_f32 v[78:79], v[142:143], v[48:49] op_sel_hi:[1,0]
v_pk_mul_f32 v[80:81], v[144:145], v[48:49] op_sel_hi:[1,0]
v_pk_mul_f32 v[82:83], v[146:147], v[48:49] op_sel_hi:[1,0]
v_exp_f32 v64, v64
v_exp_f32 v65, v65
v_exp_f32 v66, v66
v_exp_f32 v67, v67
v_exp_f32 v68, v68
v_exp_f32 v69, v69
v_exp_f32 v70, v70
v_exp_f32 v71, v71
v_exp_f32 v72, v72
v_exp_f32 v73, v73
v_exp_f32 v74, v74
v_exp_f32 v75, v75
v_exp_f32 v76, v76
v_exp_f32 v77, v77
v_exp_f32 v78, v78
v_exp_f32 v79, v79
v_exp_f32 v80, v80
v_exp_f32 v81, v81
v_exp_f32 v82, v82
v_exp_f32 v83, v83
s_waitcnt vmcnt(0) lgkmcnt(0)
s_barrier
ds_read_b64_tr_b16 v[188:189], v63 offset:0
ds_read_b64_tr_b16 v[190:191], v63 offset:512
ds_read_b64_tr_b16 v[192:193], v63 offset:1024
ds_read_b64_tr_b16 v[194:195], v63 offset:1536
ds_read_b64_tr_b16 v[196:197], v63 offset:2048
v_pk_add_f32 v[64:65], v[64:65], v[48:49] op_sel:[0,1] op_sel_hi:[1,1]
v_pk_add_f32 v[66:67], v[66:67], v[48:49] op_sel:[0,1] op_sel_hi:[1,1]
v_pk_add_f32 v[68:69], v[68:69], v[48:49] op_sel:[0,1] op_sel_hi:[1,1]
v_pk_add_f32 v[70:71], v[70:71], v[48:49] op_sel:[0,1] op_sel_hi:[1,1]
v_pk_add_f32 v[72:73], v[72:73], v[48:49] op_sel:[0,1] op_sel_hi:[1,1]
v_pk_add_f32 v[74:75], v[74:75], v[48:49] op_sel:[0,1] op_sel_hi:[1,1]
v_pk_add_f32 v[76:77], v[76:77], v[48:49] op_sel:[0,1] op_sel_hi:[1,1]
v_pk_add_f32 v[78:79], v[78:79], v[48:49] op_sel:[0,1] op_sel_hi:[1,1]
v_pk_add_f32 v[80:81], v[80:81], v[48:49] op_sel:[0,1] op_sel_hi:[1,1]
v_pk_add_f32 v[82:83], v[82:83], v[48:49] op_sel:[0,1] op_sel_hi:[1,1]
v_rcp_f32 v64, v64
v_rcp_f32 v65, v65
v_rcp_f32 v66, v66
v_rcp_f32 v67, v67
v_rcp_f32 v68, v68
v_rcp_f32 v69, v69
v_rcp_f32 v70, v70
v_rcp_f32 v71, v71
v_rcp_f32 v72, v72
v_rcp_f32 v73, v73
v_rcp_f32 v74, v74
v_rcp_f32 v75, v75
v_rcp_f32 v76, v76
v_rcp_f32 v77, v77
v_rcp_f32 v78, v78
v_rcp_f32 v79, v79
v_rcp_f32 v80, v80
v_rcp_f32 v81, v81
v_rcp_f32 v82, v82
v_rcp_f32 v83, v83
s_waitcnt lgkmcnt(0)
v_lshlrev_b32 v108, 16, v188
v_and_b32 v109, 0xffff0000, v188
v_lshlrev_b32 v110, 16, v189
v_and_b32 v111, 0xffff0000, v189
v_lshlrev_b32 v112, 16, v190
v_and_b32 v113, 0xffff0000, v190
v_lshlrev_b32 v114, 16, v191
v_and_b32 v115, 0xffff0000, v191
v_pk_mul_f32 v[64:65], v[64:65], v[128:129]
v_pk_mul_f32 v[66:67], v[66:67], v[130:131]
v_pk_mul_f32 v[68:69], v[68:69], v[132:133]
v_pk_mul_f32 v[70:71], v[70:71], v[134:135]
v_pk_mul_f32 v[108:109], v[108:109], v[20:21]
v_pk_mul_f32 v[110:111], v[110:111], v[22:23]
v_pk_mul_f32 v[112:113], v[112:113], v[24:25]
v_pk_mul_f32 v[114:115], v[114:115], v[26:27]
v_pk_fma_f32 v[108:109], v[108:109], v[64:65], v[40:41]
v_pk_fma_f32 v[110:111], v[110:111], v[66:67], v[42:43]
v_pk_fma_f32 v[112:113], v[112:113], v[68:69], v[44:45]
v_pk_fma_f32 v[114:115], v[114:115], v[70:71], v[46:47]
v_cvt_pk_bf16_f32 v188, v108, v109
v_cvt_pk_bf16_f32 v189, v110, v111
v_cvt_pk_bf16_f32 v190, v112, v113
v_cvt_pk_bf16_f32 v191, v114, v115
ds_write_b64 v50, v[188:189] offset:0
ds_write_b64 v50, v[190:191] offset:8
v_lshlrev_b32 v116, 16, v192
v_and_b32 v117, 0xffff0000, v192
v_lshlrev_b32 v118, 16, v193
v_and_b32 v119, 0xffff0000, v193
v_lshlrev_b32 v120, 16, v194
v_and_b32 v121, 0xffff0000, v194
v_lshlrev_b32 v122, 16, v195
v_and_b32 v123, 0xffff0000, v195
v_lshlrev_b32 v124, 16, v196
v_and_b32 v125, 0xffff0000, v196
v_lshlrev_b32 v126, 16, v197
v_and_b32 v127, 0xffff0000, v197
v_pk_mul_f32 v[72:73], v[72:73], v[136:137]
v_pk_mul_f32 v[74:75], v[74:75], v[138:139]
v_pk_mul_f32 v[76:77], v[76:77], v[140:141]
v_pk_mul_f32 v[78:79], v[78:79], v[142:143]
v_pk_mul_f32 v[80:81], v[80:81], v[144:145]
v_pk_mul_f32 v[82:83], v[82:83], v[146:147]
v_pk_mul_f32 v[116:117], v[116:117], v[28:29]
v_pk_mul_f32 v[118:119], v[118:119], v[30:31]
v_pk_mul_f32 v[120:121], v[120:121], v[32:33]
v_pk_mul_f32 v[122:123], v[122:123], v[34:35]
v_pk_mul_f32 v[124:125], v[124:125], v[36:37]
v_pk_mul_f32 v[126:127], v[126:127], v[38:39]
v_pk_fma_f32 v[116:117], v[116:117], v[72:73], v[96:97]
v_pk_fma_f32 v[118:119], v[118:119], v[74:75], v[98:99]
v_pk_fma_f32 v[120:121], v[120:121], v[76:77], v[100:101]
v_pk_fma_f32 v[122:123], v[122:123], v[78:79], v[102:103]
v_pk_fma_f32 v[124:125], v[124:125], v[80:81], v[104:105]
v_pk_fma_f32 v[126:127], v[126:127], v[82:83], v[106:107]
v_cvt_pk_bf16_f32 v192, v116, v117
v_cvt_pk_bf16_f32 v193, v118, v119
v_cvt_pk_bf16_f32 v194, v120, v121
v_cvt_pk_bf16_f32 v195, v122, v123
v_cvt_pk_bf16_f32 v196, v124, v125
v_cvt_pk_bf16_f32 v197, v126, v127
ds_write_b64 v50, v[192:193] offset:16
ds_write_b64 v50, v[194:195] offset:24
ds_write_b64 v50, v[196:197] offset:32
s_mov_b64 exec, s[86:87]
ds_read_b128 v[64:67], v51 offset:0
ds_read_b128 v[68:71], v51 offset:704
ds_read_b128 v[72:75], v51 offset:1408
ds_read_b128 v[76:79], v51 offset:2112
s_waitcnt lgkmcnt(3)
buffer_store_dwordx4 v[64:67], v52, s[28:31], 0 offen
s_waitcnt lgkmcnt(2)
buffer_store_dwordx4 v[68:71], v53, s[28:31], 0 offen
s_waitcnt lgkmcnt(1)
buffer_store_dwordx4 v[72:75], v54, s[28:31], 0 offen
s_waitcnt lgkmcnt(0)
buffer_store_dwordx4 v[76:79], v55, s[28:31], 0 offen
s_mov_b64 exec, -1
L_end:
s_endpgm
L_spare:
s_and_b32 s6, s3, 3
s_lshr_b32 s7, s3, 2
s_lshl_b32 s6, s6, 1
s_add_u32 s73, s6, s7
s_lshl_b32 s73, s73, 2
s_add_u32 s73, s73, s4
s_sub_u32 s73, s73, 28
s_and_b32 s6, s3, 3
s_lshl_b32 s6, s6, 2
s_and_b32 s7, s4, 3
s_add_u32 s77, s6, s7
s_lshr_b32 s6, s3, 2
s_mul_i32 s6, s6, 7
s_lshr_b32 s7, s4, 2
s_add_u32 s78, s6, s7
s_and_b32 s82, s5, 1
s_lshr_b32 s83, s5, 1
s_lshl_b32 s6, s3, 4
s_lshr_b32 s7, s4, 1
s_add_u32 s6, s6, s7
s_mul_i32 s6, s6, 5
s_and_b32 s89, s4, 1
s_lshl_b32 s7, s89, 1
s_add_u32 s88, s6, s7
s_and_b32 s6, s3, 3
s_lshl_b32 s6, s6, 3
s_and_b32 s7, s4, 7
s_add_u32 s94, s6, s7
s_lshr_b32 s6, s3, 2
s_xor_b32 s6, s6, 1
s_lshl_b32 s6, s6, 2
s_lshr_b32 s7, s4, 3
s_add_u32 s95, s6, s7
s_mul_i32 s96, s5, 14
s_cmp_eq_u32 s5, 3
s_cselect_b32 s6, 1, 0
s_sub_u32 s96, s96, s6
s_lshr_b32 s6, s4, 3
s_lshl_b32 s7, s3, 2
s_add_u32 s68, s6, s7
s_and_b32 s69, s4, 7
v_mul_u32_u24 v2, 26, v1
v_lshrrev_b32 v2, 8, v2
v_mul_u32_u24 v3, 10, v2
v_sub_u32 v3, v1, v3
s_lshl_b32 s6, s68, 6
s_lshl_b32 s7, s5, 4
s_add_u32 s6, s6, s7
s_mul_i32 s6, s6, 1280
s_mul_i32 s7, s69, 160
s_add_u32 s6, s6, s7
v_mul_u32_u24 v4, 5120, v2
v_lshl_add_u32 v4, v3, 4, v4
v_add_u32 v244, s6, v4
v_subrev_u32 v245, 3840, v244
s_mul_i32 s92, s69, 640
s_mul_i32 s7, s5, 2560
s_add_u32 s7, s7, 142592
s_mov_b32 m0, s7
v_lshl_add_u32 v247, v3, 6, s7
s_lshl_b32 s7, s5, 5
s_sub_u32 s7, 131192, s7
v_mul_u32_u24 v4, 1152, v3
v_lshlrev_b32 v2, 3, v2
v_sub_u32 v4, v4, v2
v_add_u32 v202, s7, v4
v_lshrrev_b32 v2, 3, v1
s_mul_i32 s6, s5, 20
v_add_u32 v2, s6, v2
v_and_b32 v3, 7, v1
v_lshlrev_b32 v3, 4, v3
v_mul_u32_u24 v4, 144, v2
v_add_u32 v4, v4, v3
v_add_u32 v203, 131072, v4
v_lshl_add_u32 v172, v2, 12, v3
s_mul_i32 s6, s69, 327680
s_lshl_b32 s7, s68, 7
s_sub_u32 s6, s6, s7
s_add_u32 s70, s6, 1052544
s_add_u32 s71, s70, 32768
s_add_u32 s72, s70, 65536
s_lshl_b32 s6, s73, 6
s_lshl_b32 s7, s5, 4
s_add_u32 s6, s6, s7
s_mul_i32 s75, s6, 1280
s_lshl_b32 s6, s73, 2
s_add_u32 s6, s6, s5
s_mul_i32 s76, s6, 20480
v_lshlrev_b32 v233, 7, v1
s_lshl_b32 s6, s73, 6
s_lshl_b32 s7, s5, 4
s_add_u32 s74, s6, s7
v_and_b32 v2, 15, v1
v_lshrrev_b32 v3, 4, v1
v_add_u32 v4, s74, v2
v_mul_u32_u24 v4, 1280, v4
v_lshl_add_u32 v211, v3, 4, v4
s_waitcnt lgkmcnt(0)
s_mov_b32 s24, s66
s_and_b32 s25, s67, 0xffff
s_mov_b32 s26, 17825792
s_mov_b32 s27, 0x20000
s_lshl_b32 s6, s88, 1
s_and_b32 s6, s6, 0xfffffffc
s_load_dwordx2 s[0:1], s[50:51], s6
s_cmp_lg_u32 s5, 0
s_cbranch_scc1 L_clr_43
v_lshl_add_u32 v2, v1, 2, v252
v_mov_b32 v3, 0
s_mov_b64 exec, 0xff
buffer_store_dword v3, v2, s[24:27], 0 offen sc1
s_mov_b64 exec, -1
L_clr_43:
s_mov_b32 s12, s42
s_and_b32 s13, s43, 0xffff
s_mov_b32 s14, 2621440
s_mov_b32 s15, 0x20000
s_mov_b32 s16, s44
s_and_b32 s17, s45, 0xffff
s_mov_b32 s18, 2621440
s_mov_b32 s19, 0x20000
s_mov_b32 s32, s46
s_and_b32 s33, s47, 0xffff
s_mov_b32 s34, 5120
s_mov_b32 s35, 0x20000
s_mov_b32 s8, s40
s_and_b32 s9, s41, 0xffff
s_mov_b32 s10, 2621440
s_mov_b32 s11, 0x20000
s_mov_b32 s28, s62
s_and_b32 s29, s63, 0xffff
s_mov_b32 s30, 2621440
s_mov_b32 s31, 0x20000
s_mov_b32 s52, s64
s_and_b32 s53, s65, 0xffff
s_mov_b32 s54, 256
s_mov_b32 s55, 0x20000
s_mov_b32 s42, 0
buffer_load_dwordx4 a[0:3], v211, s[8:11], 0 offen offset:0
buffer_load_dwordx4 a[4:7], v211, s[8:11], 0 offen offset:64
buffer_load_dwordx4 a[8:11], v211, s[8:11], 0 offen offset:128
buffer_load_dwordx4 a[12:15], v211, s[8:11], 0 offen offset:192
s_waitcnt vmcnt(4)
s_cmp_lg_u32 s5, 0
s_cbranch_scc1 L_arr_44
s_and_b32 s6, s2, 7
s_lshl_b32 s6, s6, 5
v_mov_b32 v2, s6
s_mov_b64 exec, 1
buffer_atomic_add v253, v2, s[52:55], 0 offen sc1
s_mov_b64 exec, -1
L_arr_44:
buffer_load_dwordx4 a[16:19], v211, s[8:11], 0 offen offset:256
buffer_load_dwordx4 a[20:23], v211, s[8:11], 0 offen offset:320
buffer_load_dwordx4 a[24:27], v211, s[8:11], 0 offen offset:384
buffer_load_dwordx4 a[28:31], v211, s[8:11], 0 offen offset:448
buffer_load_dwordx4 a[32:35], v211, s[8:11], 0 offen offset:512
buffer_load_dwordx4 a[36:39], v211, s[8:11], 0 offen offset:576
buffer_load_dwordx4 a[40:43], v211, s[8:11], 0 offen offset:640
buffer_load_dwordx4 a[44:47], v211, s[8:11], 0 offen offset:704
buffer_load_dwordx4 a[48:51], v211, s[8:11], 0 offen offset:768
buffer_load_dwordx4 a[52:55], v211, s[8:11], 0 offen offset:832
buffer_load_dwordx4 a[56:59], v211, s[8:11], 0 offen offset:896
buffer_load_dwordx4 a[60:63], v211, s[8:11], 0 offen offset:960
buffer_load_dwordx4 a[64:67], v211, s[8:11], 0 offen offset:1024
buffer_load_dwordx4 a[68:71], v211, s[8:11], 0 offen offset:1088
buffer_load_dwordx4 a[72:75], v211, s[8:11], 0 offen offset:1152
buffer_load_dwordx4 a[76:79], v211, s[8:11], 0 offen offset:1216
v_and_b32 v2, 15, v1
v_min_u32 v2, 13, v2
v_add_u32 v2, s96, v2
v_min_u32 v2, 53, v2
v_lshlrev_b32 v2, 2, v2
s_lshr_b32 s43, s95, 1
v_add_u32 v2, s43, v2
v_lshlrev_b32 v2, 7, v2
v_add_u32 v228, 12, v2
s_lshl_b32 s6, s77, 1
v_and_b32 v4, 1, v1
v_add_u32 v4, s6, v4
v_and_b32 v5, 3, v4
v_add_u32 v5, 28, v5
s_lshr_b32 s6, s77, 2
s_and_b32 s7, s77, 2
s_lshl_b32 s7, s7, 1
s_add_u32 s6, s6, s7
v_mov_b32 v4, s6
v_lshl_add_u32 v4, v5, 3, v4
v_lshlrev_b32 v4, 7, v4
v_add_u32 v231, 4, v4
v_and_b32 v2, 31, v1
v_and_b32 v3, 7, v2
v_lshrrev_b32 v2, 3, v2
v_lshlrev_b32 v2, 3, v2
v_add_u32 v2, s3, v2
v_lshl_add_u32 v2, v2, 3, v3
v_lshlrev_b32 v229, 7, v2
v_cmp_gt_u32 vcc, 14, v1
v_cndmask_b32 v2, 0, v1, vcc
v_cmp_lt_u32 vcc, 6, v2
v_cndmask_b32 v3, 0, 1, vcc
v_mul_u32_u24 v4, 7, v3
v_sub_u32 v2, v2, v4
s_lshr_b32 s6, s94, 1
s_and_b32 s7, s6, 3
s_lshr_b32 s6, s6, 2
v_lshlrev_b32 v3, 2, v3
v_lshlrev_b32 v2, 2, v2
v_add_u32 v2, s7, v2
v_add_u32 v3, s6, v3
v_lshl_add_u32 v2, v2, 3, v3
v_lshlrev_b32 v2, 7, v2
v_add_u32 v249, 16, v2
v_and_b32 v2, 31, v1
v_lshlrev_b32 v2, 3, v2
v_add_u32 v2, s95, v2
v_lshlrev_b32 v2, 7, v2
v_add_u32 v250, 20, v2
v_mov_b32 v2, 2147418112
s_cmp_lg_u32 s5, 0
s_cselect_b64 vcc, -1, 0
v_cndmask_b32 v231, v231, v2, vcc
v_cndmask_b32 v230, v230, v2, vcc
v_mov_b32 v214, 0x3f803f80
v_mov_b32 v215, 0x3f803f80
v_mov_b32 v216, 0x3f803f80
v_mov_b32 v217, 0x3f803f80
v_mov_b32 v218, 0
v_mov_b32 v219, 0
v_mov_b32 v220, 0
v_mov_b32 v221, 0
v_mov_b32 v222, 0
v_mov_b32 v223, 0
v_mov_b32 v224, 0
v_mov_b32 v225, 0
s_waitcnt vmcnt(19)
v_mfma_f32_16x16x32_bf16 v[218:221], a[0:3], a[0:3], v[218:221]
v_mfma_f32_16x16x32_bf16 v[222:225], a[0:3], v[214:217], v[222:225]
s_waitcnt vmcnt(18)
v_mfma_f32_16x16x32_bf16 v[218:221], a[4:7], a[4:7], v[218:221]
v_mfma_f32_16x16x32_bf16 v[222:225], a[4:7], v[214:217], v[222:225]
s_waitcnt vmcnt(17)
v_mfma_f32_16x16x32_bf16 v[218:221], a[8:11], a[8:11], v[218:221]
v_mfma_f32_16x16x32_bf16 v[222:225], a[8:11], v[214:217], v[222:225]
s_waitcnt vmcnt(16)
v_mfma_f32_16x16x32_bf16 v[218:221], a[12:15], a[12:15], v[218:221]
v_mfma_f32_16x16x32_bf16 v[222:225], a[12:15], v[214:217], v[222:225]
s_waitcnt vmcnt(15)
v_mfma_f32_16x16x32_bf16 v[218:221], a[16:19], a[16:19], v[218:221]
v_mfma_f32_16x16x32_bf16 v[222:225], a[16:19], v[214:217], v[222:225]
s_waitcnt vmcnt(14)
v_mfma_f32_16x16x32_bf16 v[218:221], a[20:23], a[20:23], v[218:221]
v_mfma_f32_16x16x32_bf16 v[222:225], a[20:23], v[214:217], v[222:225]
s_waitcnt vmcnt(13)
v_mfma_f32_16x16x32_bf16 v[218:221], a[24:27], a[24:27], v[218:221]
v_mfma_f32_16x16x32_bf16 v[222:225], a[24:27], v[214:217], v[222:225]
s_waitcnt vmcnt(12)
v_mfma_f32_16x16x32_bf16 v[218:221], a[28:31], a[28:31], v[218:221]
v_mfma_f32_16x16x32_bf16 v[222:225], a[28:31], v[214:217], v[222:225]
s_waitcnt vmcnt(11)
v_mfma_f32_16x16x32_bf16 v[218:221], a[32:35], a[32:35], v[218:221]
v_mfma_f32_16x16x32_bf16 v[222:225], a[32:35], v[214:217], v[222:225]
s_waitcnt vmcnt(10)
v_mfma_f32_16x16x32_bf16 v[218:221], a[36:39], a[36:39], v[218:221]
v_mfma_f32_16x16x32_bf16 v[222:225], a[36:39], v[214:217], v[222:225]
s_waitcnt vmcnt(9)
v_mfma_f32_16x16x32_bf16 v[218:221], a[40:43], a[40:43], v[218:221]
v_mfma_f32_16x16x32_bf16 v[222:225], a[40:43], v[214:217], v[222:225]
s_waitcnt vmcnt(8)
v_mfma_f32_16x16x32_bf16 v[218:221], a[44:47], a[44:47], v[218:221]
v_mfma_f32_16x16x32_bf16 v[222:225], a[44:47], v[214:217], v[222:225]
s_waitcnt vmcnt(7)
v_mfma_f32_16x16x32_bf16 v[218:221], a[48:51], a[48:51], v[218:221]
v_mfma_f32_16x16x32_bf16 v[222:225], a[48:51], v[214:217], v[222:225]
s_waitcnt vmcnt(6)
v_mfma_f32_16x16x32_bf16 v[218:221], a[52:55], a[52:55], v[218:221]
v_mfma_f32_16x16x32_bf16 v[222:225], a[52:55], v[214:217], v[222:225]
s_waitcnt vmcnt(5)
v_mfma_f32_16x16x32_bf16 v[218:221], a[56:59], a[56:59], v[218:221]
v_mfma_f32_16x16x32_bf16 v[222:225], a[56:59], v[214:217], v[222:225]
s_waitcnt vmcnt(4)
v_mfma_f32_16x16x32_bf16 v[218:221], a[60:63], a[60:63], v[218:221]
v_mfma_f32_16x16x32_bf16 v[222:225], a[60:63], v[214:217], v[222:225]
s_waitcnt vmcnt(3)
v_mfma_f32_16x16x32_bf16 v[218:221], a[64:67], a[64:67], v[218:221]
v_mfma_f32_16x16x32_bf16 v[222:225], a[64:67], v[214:217], v[222:225]
s_waitcnt vmcnt(2)
v_mfma_f32_16x16x32_bf16 v[218:221], a[68:71], a[68:71], v[218:221]
v_mfma_f32_16x16x32_bf16 v[222:225], a[68:71], v[214:217], v[222:225]
s_waitcnt vmcnt(1)
v_mfma_f32_16x16x32_bf16 v[218:221], a[72:75], a[72:75], v[218:221]
v_mfma_f32_16x16x32_bf16 v[222:225], a[72:75], v[214:217], v[222:225]
s_waitcnt vmcnt(0)
v_mfma_f32_16x16x32_bf16 v[218:221], a[76:79], a[76:79], v[218:221]
v_mfma_f32_16x16x32_bf16 v[222:225], a[76:79], v[214:217], v[222:225]
v_and_b32 v5, 1, v1
v_cmp_eq_u32 vcc, 1, v5
v_and_b32 v5, 2, v1
v_cmp_eq_u32 s[6:7], 2, v5
s_nop 7
v_cndmask_b32 v2, v218, v219, vcc
v_cndmask_b32 v3, v220, v221, vcc
v_cndmask_b32 v4, v222, v223, vcc
v_cndmask_b32 v5, v224, v225, vcc
v_cndmask_b32 v2, v2, v3, s[6:7]
v_cndmask_b32 v3, v4, v5, s[6:7]
v_mul_f32 v214, 0.0015625, v3
v_mul_f32 v2, 0.0015625, v2
v_fma_f32 v2, -v214, v214, v2
v_max_f32 v2, 0, v2
v_add_f32 v2, 0x3727c5ac, v2
v_sqrt_f32 v216, v2
s_nop 0
v_rcp_f32 v215, v216
v_mov_b32 v217, 0
v_sub_f32 v3, 0, v214
v_cvt_pk_bf16_f32 v4, v216, v3
v_lshlrev_b32 v5, 16, v4
v_and_b32 v6, 0xffff0000, v4
v_sub_f32 v5, v216, v5
v_sub_f32 v6, v3, v6
v_cvt_pk_bf16_f32 v5, v5, v6
s_mov_b32 s6, 0x05040100
s_mov_b32 s7, 0x07060302
v_perm_b32 v218, v5, v4, s6
v_perm_b32 v219, v5, v4, s7
v_mov_b32 v220, v219
v_mov_b32 v221, 0
v_lshrrev_b32 v3, 4, v1
v_and_b32 v5, 3, v1
v_lshl_add_u32 v5, v3, 2, v5
v_add_u32 v5, s74, v5
v_lshlrev_b32 v5, 4, v5
s_mov_b32 s6, 65536
s_mov_b32 s7, 98304
s_mov_b32 exec_lo, 0x00f0000f
s_mov_b32 exec_hi, 0xf0000f00
buffer_store_dwordx4 v[218:221], v5, s[24:27], s6 offen sc1
buffer_store_dwordx4 v[214:217], v5, s[24:27], s7 offen sc1
s_mov_b64 exec, -1
buffer_load_dword v254, v230, s[52:55], 0 offen sc1
s_mov_b32 exec_hi, 0xff
buffer_load_dwordx4 v[8:11], v245, s[12:15], 0 offen offset:0
buffer_load_dwordx4 v[12:15], v245, s[12:15], 0 offen offset:1280
buffer_load_dwordx4 v[16:19], v245, s[12:15], 0 offen offset:2560
buffer_load_dwordx4 v[20:23], v244, s[12:15], 0 offen offset:0
buffer_load_dwordx4 v[24:27], v244, s[12:15], 0 offen offset:1280
buffer_load_dwordx4 v[28:31], v244, s[12:15], 0 offen offset:2560
buffer_load_dwordx4 v[32:35], v244, s[12:15], 0 offen offset:3840
buffer_load_dwordx4 v248, s[32:35], s92 offen lds
buffer_load_dwordx4 v[174:177], v244, s[16:19], 0 offen offset:0
buffer_load_dwordx4 v[178:181], v244, s[16:19], 0 offen offset:1280
buffer_load_dwordx4 v[182:185], v244, s[16:19], 0 offen offset:2560
buffer_load_dwordx4 v[186:189], v244, s[16:19], 0 offen offset:3840
s_mov_b64 exec, -1
s_mov_b32 s36, s58
s_and_b32 s37, s59, 0xffff
s_mov_b32 s38, 2211840
s_mov_b32 s39, 0x20000
s_sub_u32 s6, s4, 28
s_lshl_b32 s6, s6, 2
s_add_u32 s6, s6, s5
s_mul_i32 s79, s6, 162
s_lshr_b32 s6, s3, 2
s_lshl_b32 s80, s6, 5
s_and_b32 s7, s3, 3
s_mul_i32 s7, s7, 320
s_and_b32 s81, s7, 0xffffff80
v_add_u32 v2, s79, v1
v_add_u32 v2, 0, v2
v_mul_u32_u24 v3, 2731, v2
v_lshrrev_b32 v3, 18, v3
v_mul_u32_u24 v4, 96, v3
v_sub_u32 v4, v2, v4
v_mul_u32_u24 v5, 86, v4
v_lshrrev_b32 v5, 8, v5
v_mul_u32_u24 v6, 3, v5
v_sub_u32 v6, v4, v6
v_lshlrev_b32 v3, 6, v3
v_add_u32 v3, v3, v5
v_add_u32 v3, s80, v3
v_mul_u32_u24 v3, 1280, v3
v_lshl_add_u32 v3, v6, 7, v3
v_add_u32 v128, s81, v3
v_add_u32 v2, s79, v1
v_add_u32 v2, 64, v2
v_mul_u32_u24 v3, 2731, v2
v_lshrrev_b32 v3, 18, v3
v_mul_u32_u24 v4, 96, v3
v_sub_u32 v4, v2, v4
v_mul_u32_u24 v5, 86, v4
v_lshrrev_b32 v5, 8, v5
v_mul_u32_u24 v6, 3, v5
v_sub_u32 v6, v4, v6
v_lshlrev_b32 v3, 6, v3
v_add_u32 v3, v3, v5
v_add_u32 v3, s80, v3
v_mul_u32_u24 v3, 1280, v3
v_lshl_add_u32 v3, v6, 7, v3
v_add_u32 v129, s81, v3
v_add_u32 v2, s79, v1
v_add_u32 v2, 128, v2
v_mul_u32_u24 v3, 2731, v2
v_lshrrev_b32 v3, 18, v3
v_mul_u32_u24 v4, 96, v3
v_sub_u32 v4, v2, v4
v_mul_u32_u24 v5, 86, v4
v_lshrrev_b32 v5, 8, v5
v_mul_u32_u24 v6, 3, v5
v_sub_u32 v6, v4, v6
v_lshlrev_b32 v3, 6, v3
v_add_u32 v3, v3, v5
v_add_u32 v3, s80, v3
v_mul_u32_u24 v3, 1280, v3
v_lshl_add_u32 v3, v6, 7, v3
v_add_u32 v130, s81, v3
buffer_load_dword v234, v128, s[36:39], 0 offen
buffer_load_dword v234, v129, s[36:39], 0 offen
s_mov_b32 exec_lo, 0xffffffff
s_mov_b32 exec_hi, 0x3
buffer_load_dword v234, v130, s[36:39], 0 offen
s_mov_b64 exec, -1
s_waitcnt vmcnt(16)
s_barrier
s_cmp_lg_u32 s5, 0
s_cbranch_scc1 L_fl_45
s_mov_b64 exec, 1
buffer_store_dword v253, v252, s[24:27], 0 offen offset:4 sc1
s_mov_b64 exec, -1
L_fl_45:
s_waitcnt vmcnt(15)
s_cmp_lg_u32 s5, 0
s_cbranch_scc1 L_back_47
v_cmp_gt_u32 vcc, 32, v254
s_cbranch_vccnz L_slow_46
L_back_47:
s_waitcnt vmcnt(3)
ds_read_b128 v[36:39], v247 offset:0
ds_read_b128 v[40:43], v247 offset:16
ds_read_b128 v[44:47], v247 offset:32
ds_read_b128 v[48:51], v247 offset:48
v_lshlrev_b32 v194, 16, v8
v_and_b32 v195, 0xffff0000, v8
v_lshlrev_b32 v196, 16, v12
v_and_b32 v197, 0xffff0000, v12
v_lshlrev_b32 v198, 16, v16
v_and_b32 v199, 0xffff0000, v16
v_lshlrev_b32 v236, 16, v20
v_and_b32 v237, 0xffff0000, v20
v_lshlrev_b32 v238, 16, v24
v_and_b32 v239, 0xffff0000, v24
v_lshlrev_b32 v240, 16, v28
v_and_b32 v241, 0xffff0000, v28
v_lshlrev_b32 v242, 16, v32
v_and_b32 v243, 0xffff0000, v32
s_waitcnt lgkmcnt(0)
v_lshlrev_b32 v52, 16, v36
v_lshlrev_b32 v53, 16, v38
v_and_b32 v54, 0xffff0000, v36
v_and_b32 v55, 0xffff0000, v38
v_lshlrev_b32 v56, 16, v37
v_lshlrev_b32 v57, 16, v39
v_and_b32 v58, 0xffff0000, v37
v_and_b32 v59, 0xffff0000, v39
v_pk_mul_f32 v[60:61], v[236:237], v[52:53]
v_pk_mul_f32 v[62:63], v[238:239], v[52:53]
v_pk_mul_f32 v[190:191], v[240:241], v[52:53]
v_pk_mul_f32 v[192:193], v[242:243], v[52:53]
v_pk_fma_f32 v[60:61], v[198:199], v[54:55], v[60:61]
v_pk_fma_f32 v[62:63], v[236:237], v[54:55], v[62:63]
v_pk_fma_f32 v[190:191], v[238:239], v[54:55], v[190:191]
v_pk_fma_f32 v[192:193], v[240:241], v[54:55], v[192:193]
v_pk_fma_f32 v[60:61], v[196:197], v[56:57], v[60:61]
v_pk_fma_f32 v[62:63], v[198:199], v[56:57], v[62:63]
v_pk_fma_f32 v[190:191], v[236:237], v[56:57], v[190:191]
v_pk_fma_f32 v[192:193], v[238:239], v[56:57], v[192:193]
v_pk_fma_f32 v[60:61], v[194:195], v[58:59], v[60:61]
v_pk_fma_f32 v[62:63], v[196:197], v[58:59], v[62:63]
v_pk_fma_f32 v[190:191], v[198:199], v[58:59], v[190:191]
v_pk_fma_f32 v[192:193], v[236:237], v[58:59], v[192:193]
v_lshlrev_b32 v194, 16, v174
v_and_b32 v195, 0xffff0000, v174
v_lshlrev_b32 v196, 16, v178
v_and_b32 v197, 0xffff0000, v178
v_lshlrev_b32 v198, 16, v182
v_and_b32 v199, 0xffff0000, v182
v_lshlrev_b32 v236, 16, v186
v_and_b32 v237, 0xffff0000, v186
v_pk_mul_f32 v[60:61], v[60:61], v[194:195]
v_pk_mul_f32 v[62:63], v[62:63], v[196:197]
v_pk_mul_f32 v[190:191], v[190:191], v[198:199]
v_pk_mul_f32 v[192:193], v[192:193], v[236:237]
s_mov_b32 exec_hi, 0xff
v_cvt_pk_bf16_f32 v238, v192, v190
v_cvt_pk_bf16_f32 v239, v62, v60
ds_write_b64 v202, v[238:239] offset:0
v_cvt_pk_bf16_f32 v240, v193, v191
v_cvt_pk_bf16_f32 v241, v63, v61
ds_write_b64 v202, v[240:241] offset:144
s_mov_b64 exec, -1
v_lshlrev_b32 v194, 16, v9
v_and_b32 v195, 0xffff0000, v9
v_lshlrev_b32 v196, 16, v13
v_and_b32 v197, 0xffff0000, v13
v_lshlrev_b32 v198, 16, v17
v_and_b32 v199, 0xffff0000, v17
v_lshlrev_b32 v236, 16, v21
v_and_b32 v237, 0xffff0000, v21
v_lshlrev_b32 v238, 16, v25
v_and_b32 v239, 0xffff0000, v25
v_lshlrev_b32 v240, 16, v29
v_and_b32 v241, 0xffff0000, v29
v_lshlrev_b32 v242, 16, v33
v_and_b32 v243, 0xffff0000, v33
v_lshlrev_b32 v52, 16, v40
v_lshlrev_b32 v53, 16, v42
v_and_b32 v54, 0xffff0000, v40
v_and_b32 v55, 0xffff0000, v42
v_lshlrev_b32 v56, 16, v41
v_lshlrev_b32 v57, 16, v43
v_and_b32 v58, 0xffff0000, v41
v_and_b32 v59, 0xffff0000, v43
v_pk_mul_f32 v[60:61], v[236:237], v[52:53]
v_pk_mul_f32 v[62:63], v[238:239], v[52:53]
v_pk_mul_f32 v[190:191], v[240:241], v[52:53]
v_pk_mul_f32 v[192:193], v[242:243], v[52:53]
v_pk_fma_f32 v[60:61], v[198:199], v[54:55], v[60:61]
v_pk_fma_f32 v[62:63], v[236:237], v[54:55], v[62:63]
v_pk_fma_f32 v[190:191], v[238:239], v[54:55], v[190:191]
v_pk_fma_f32 v[192:193], v[240:241], v[54:55], v[192:193]
v_pk_fma_f32 v[60:61], v[196:197], v[56:57], v[60:61]
v_pk_fma_f32 v[62:63], v[198:199], v[56:57], v[62:63]
v_pk_fma_f32 v[190:191], v[236:237], v[56:57], v[190:191]
v_pk_fma_f32 v[192:193], v[238:239], v[56:57], v[192:193]
v_pk_fma_f32 v[60:61], v[194:195], v[58:59], v[60:61]
v_pk_fma_f32 v[62:63], v[196:197], v[58:59], v[62:63]
v_pk_fma_f32 v[190:191], v[198:199], v[58:59], v[190:191]
v_pk_fma_f32 v[192:193], v[236:237], v[58:59], v[192:193]
v_lshlrev_b32 v194, 16, v175
v_and_b32 v195, 0xffff0000, v175
v_lshlrev_b32 v196, 16, v179
v_and_b32 v197, 0xffff0000, v179
v_lshlrev_b32 v198, 16, v183
v_and_b32 v199, 0xffff0000, v183
v_lshlrev_b32 v236, 16, v187
v_and_b32 v237, 0xffff0000, v187
v_pk_mul_f32 v[60:61], v[60:61], v[194:195]
v_pk_mul_f32 v[62:63], v[62:63], v[196:197]
v_pk_mul_f32 v[190:191], v[190:191], v[198:199]
v_pk_mul_f32 v[192:193], v[192:193], v[236:237]
s_mov_b32 exec_hi, 0xff
v_cvt_pk_bf16_f32 v238, v192, v190
v_cvt_pk_bf16_f32 v239, v62, v60
ds_write_b64 v202, v[238:239] offset:288
v_cvt_pk_bf16_f32 v240, v193, v191
v_cvt_pk_bf16_f32 v241, v63, v61
ds_write_b64 v202, v[240:241] offset:432
s_mov_b64 exec, -1
v_lshlrev_b32 v194, 16, v10
v_and_b32 v195, 0xffff0000, v10
v_lshlrev_b32 v196, 16, v14
v_and_b32 v197, 0xffff0000, v14
v_lshlrev_b32 v198, 16, v18
v_and_b32 v199, 0xffff0000, v18
v_lshlrev_b32 v236, 16, v22
v_and_b32 v237, 0xffff0000, v22
v_lshlrev_b32 v238, 16, v26
v_and_b32 v239, 0xffff0000, v26
v_lshlrev_b32 v240, 16, v30
v_and_b32 v241, 0xffff0000, v30
v_lshlrev_b32 v242, 16, v34
v_and_b32 v243, 0xffff0000, v34
v_lshlrev_b32 v52, 16, v44
v_lshlrev_b32 v53, 16, v46
v_and_b32 v54, 0xffff0000, v44
v_and_b32 v55, 0xffff0000, v46
v_lshlrev_b32 v56, 16, v45
v_lshlrev_b32 v57, 16, v47
v_and_b32 v58, 0xffff0000, v45
v_and_b32 v59, 0xffff0000, v47
v_pk_mul_f32 v[60:61], v[236:237], v[52:53]
v_pk_mul_f32 v[62:63], v[238:239], v[52:53]
v_pk_mul_f32 v[190:191], v[240:241], v[52:53]
v_pk_mul_f32 v[192:193], v[242:243], v[52:53]
v_pk_fma_f32 v[60:61], v[198:199], v[54:55], v[60:61]
v_pk_fma_f32 v[62:63], v[236:237], v[54:55], v[62:63]
v_pk_fma_f32 v[190:191], v[238:239], v[54:55], v[190:191]
v_pk_fma_f32 v[192:193], v[240:241], v[54:55], v[192:193]
v_pk_fma_f32 v[60:61], v[196:197], v[56:57], v[60:61]
v_pk_fma_f32 v[62:63], v[198:199], v[56:57], v[62:63]
v_pk_fma_f32 v[190:191], v[236:237], v[56:57], v[190:191]
v_pk_fma_f32 v[192:193], v[238:239], v[56:57], v[192:193]
v_pk_fma_f32 v[60:61], v[194:195], v[58:59], v[60:61]
v_pk_fma_f32 v[62:63], v[196:197], v[58:59], v[62:63]
v_pk_fma_f32 v[190:191], v[198:199], v[58:59], v[190:191]
v_pk_fma_f32 v[192:193], v[236:237], v[58:59], v[192:193]
v_lshlrev_b32 v194, 16, v176
v_and_b32 v195, 0xffff0000, v176
v_lshlrev_b32 v196, 16, v180
v_and_b32 v197, 0xffff0000, v180
v_lshlrev_b32 v198, 16, v184
v_and_b32 v199, 0xffff0000, v184
v_lshlrev_b32 v236, 16, v188
v_and_b32 v237, 0xffff0000, v188
v_pk_mul_f32 v[60:61], v[60:61], v[194:195]
v_pk_mul_f32 v[62:63], v[62:63], v[196:197]
v_pk_mul_f32 v[190:191], v[190:191], v[198:199]
v_pk_mul_f32 v[192:193], v[192:193], v[236:237]
s_mov_b32 exec_hi, 0xff
v_cvt_pk_bf16_f32 v238, v192, v190
v_cvt_pk_bf16_f32 v239, v62, v60
ds_write_b64 v202, v[238:239] offset:576
v_cvt_pk_bf16_f32 v240, v193, v191
v_cvt_pk_bf16_f32 v241, v63, v61
ds_write_b64 v202, v[240:241] offset:720
s_mov_b64 exec, -1
v_lshlrev_b32 v194, 16, v11
v_and_b32 v195, 0xffff0000, v11
v_lshlrev_b32 v196, 16, v15
v_and_b32 v197, 0xffff0000, v15
v_lshlrev_b32 v198, 16, v19
v_and_b32 v199, 0xffff0000, v19
v_lshlrev_b32 v236, 16, v23
v_and_b32 v237, 0xffff0000, v23
v_lshlrev_b32 v238, 16, v27
v_and_b32 v239, 0xffff0000, v27
v_lshlrev_b32 v240, 16, v31
v_and_b32 v241, 0xffff0000, v31
v_lshlrev_b32 v242, 16, v35
v_and_b32 v243, 0xffff0000, v35
v_lshlrev_b32 v52, 16, v48
v_lshlrev_b32 v53, 16, v50
v_and_b32 v54, 0xffff0000, v48
v_and_b32 v55, 0xffff0000, v50
v_lshlrev_b32 v56, 16, v49
v_lshlrev_b32 v57, 16, v51
v_and_b32 v58, 0xffff0000, v49
v_and_b32 v59, 0xffff0000, v51
v_pk_mul_f32 v[60:61], v[236:237], v[52:53]
v_pk_mul_f32 v[62:63], v[238:239], v[52:53]
v_pk_mul_f32 v[190:191], v[240:241], v[52:53]
v_pk_mul_f32 v[192:193], v[242:243], v[52:53]
v_pk_fma_f32 v[60:61], v[198:199], v[54:55], v[60:61]
v_pk_fma_f32 v[62:63], v[236:237], v[54:55], v[62:63]
v_pk_fma_f32 v[190:191], v[238:239], v[54:55], v[190:191]
v_pk_fma_f32 v[192:193], v[240:241], v[54:55], v[192:193]
v_pk_fma_f32 v[60:61], v[196:197], v[56:57], v[60:61]
v_pk_fma_f32 v[62:63], v[198:199], v[56:57], v[62:63]
v_pk_fma_f32 v[190:191], v[236:237], v[56:57], v[190:191]
v_pk_fma_f32 v[192:193], v[238:239], v[56:57], v[192:193]
v_pk_fma_f32 v[60:61], v[194:195], v[58:59], v[60:61]
v_pk_fma_f32 v[62:63], v[196:197], v[58:59], v[62:63]
v_pk_fma_f32 v[190:191], v[198:199], v[58:59], v[190:191]
v_pk_fma_f32 v[192:193], v[236:237], v[58:59], v[192:193]
v_lshlrev_b32 v194, 16, v177
v_and_b32 v195, 0xffff0000, v177
v_lshlrev_b32 v196, 16, v181
v_and_b32 v197, 0xffff0000, v181
v_lshlrev_b32 v198, 16, v185
v_and_b32 v199, 0xffff0000, v185
v_lshlrev_b32 v236, 16, v189
v_and_b32 v237, 0xffff0000, v189
v_pk_mul_f32 v[60:61], v[60:61], v[194:195]
v_pk_mul_f32 v[62:63], v[62:63], v[196:197]
v_pk_mul_f32 v[190:191], v[190:191], v[198:199]
v_pk_mul_f32 v[192:193], v[192:193], v[236:237]
s_mov_b32 exec_hi, 0xff
v_cvt_pk_bf16_f32 v238, v192, v190
v_cvt_pk_bf16_f32 v239, v62, v60
ds_write_b64 v202, v[238:239] offset:864
v_cvt_pk_bf16_f32 v240, v193, v191
v_cvt_pk_bf16_f32 v241, v63, v61
ds_write_b64 v202, v[240:241] offset:1008
s_mov_b64 exec, -1
s_waitcnt lgkmcnt(0)
s_barrier
ds_read_b128 v[8:11], v203 offset:0
ds_read_b128 v[12:15], v203 offset:1152
ds_read_b128 v[16:19], v203 offset:2304
s_waitcnt lgkmcnt(0)
buffer_store_dwordx4 v[8:11], v172, s[24:27], s70 offen sc1
buffer_store_dwordx4 v[12:15], v172, s[24:27], s71 offen sc1
s_mov_b32 exec_hi, 0
buffer_store_dwordx4 v[16:19], v172, s[24:27], s72 offen sc1
s_mov_b64 exec, -1
buffer_load_dword v254, v229, s[24:27], 0 offen sc1
s_waitcnt vmcnt(1)
s_barrier
s_cmp_lg_u32 s5, 0
s_cbranch_scc1 L_fl_48
s_mov_b64 exec, 1
buffer_store_dword v253, v252, s[24:27], 0 offen offset:0 sc1
s_mov_b64 exec, -1
L_fl_48:
s_waitcnt vmcnt(0)
v_cmp_eq_u32 vcc, 0, v254
s_cbranch_vccnz L_slow_49
L_back_50:
v_mov_b32 v60, 2147418112
s_mov_b32 s100, 0
s_mov_b32 s101, 0
s_lshl_b32 s6, s5, 2
v_lshlrev_b32 v202, 2, v1
v_add_u32 v202, s6, v202
v_subrev_u32 v202, 252, v202
v_add_u32 v203, s6, v248
v_add_u32 v203, 4, v203
s_mul_i32 s90, s5, 4416
s_add_u32 s6, s88, 0
s_lshl_b32 s6, s6, 12
s_add_u32 s32, s48, s6
s_addc_u32 s33, s49, 0
s_and_b32 s33, s33, 0xffff
s_mov_b32 s34, 4096
s_mov_b32 s35, 0x20000
s_add_u32 m0, s90, 65536
s_nop 0
buffer_load_dword v202, s[32:35], 0 offen lds
s_add_u32 m0, s90, 65792
s_nop 0
buffer_load_dwordx4 v203, s[32:35], 0 offen offset:0 lds
buffer_load_dwordx4 v203, s[32:35], 0 offen offset:1024 lds
buffer_load_dwordx4 v203, s[32:35], 0 offen offset:2048 lds
buffer_load_dwordx4 v203, s[32:35], 0 offen offset:3072 lds
s_add_u32 s6, s88, 1
s_lshl_b32 s6, s6, 12
s_add_u32 s32, s48, s6
s_addc_u32 s33, s49, 0
s_and_b32 s33, s33, 0xffff
s_mov_b32 s34, 4096
s_mov_b32 s35, 0x20000
s_add_u32 m0, s90, 96768
s_nop 0
buffer_load_dword v202, s[32:35], 0 offen lds
s_add_u32 m0, s90, 97024
s_nop 0
buffer_load_dwordx4 v203, s[32:35], 0 offen offset:0 lds
buffer_load_dwordx4 v203, s[32:35], 0 offen offset:1024 lds
buffer_load_dwordx4 v203, s[32:35], 0 offen offset:2048 lds
buffer_load_dwordx4 v203, s[32:35], 0 offen offset:3072 lds
s_add_u32 s6, s88, 2
s_lshl_b32 s6, s6, 12
s_add_u32 s32, s48, s6
s_addc_u32 s33, s49, 0
s_and_b32 s33, s33, 0xffff
s_mov_b32 s34, 4096
s_mov_b32 s35, 0x20000
s_add_u32 m0, s90, 128000
s_nop 0
buffer_load_dword v202, s[32:35], 0 offen lds
s_add_u32 m0, s90, 128256
s_nop 0
buffer_load_dwordx4 v203, s[32:35], 0 offen offset:0 lds
buffer_load_dwordx4 v203, s[32:35], 0 offen offset:1024 lds
buffer_load_dwordx4 v203, s[32:35], 0 offen offset:2048 lds
buffer_load_dwordx4 v203, s[32:35], 0 offen offset:3072 lds
v_lshlrev_b32 v4, 4, v0
s_add_u32 s6, s88, 0
s_lshl_b32 s6, s6, 12
s_add_u32 s6, s6, 1048576
s_add_u32 s36, s66, s6
s_addc_u32 s37, s67, 0
s_and_b32 s37, s37, 0xffff
s_mov_b32 s38, 4096
s_mov_b32 s39, 0x20000
buffer_load_dwordx4 v[32:35], v4, s[36:39], 0 offen
buffer_load_dword v36, v4, s[36:39], 0 offen offset:16
s_add_u32 s6, s88, 1
s_lshl_b32 s6, s6, 12
s_add_u32 s6, s6, 1048576
s_add_u32 s36, s66, s6
s_addc_u32 s37, s67, 0
s_and_b32 s37, s37, 0xffff
s_mov_b32 s38, 4096
s_mov_b32 s39, 0x20000
buffer_load_dwordx4 v[38:41], v4, s[36:39], 0 offen
buffer_load_dword v42, v4, s[36:39], 0 offen offset:16
s_add_u32 s6, s88, 2
s_lshl_b32 s6, s6, 12
s_add_u32 s6, s6, 1048576
s_add_u32 s36, s66, s6
s_addc_u32 s37, s67, 0
s_and_b32 s37, s37, 0xffff
s_mov_b32 s38, 4096
s_mov_b32 s39, 0x20000
buffer_load_dwordx4 v[44:47], v4, s[36:39], 0 offen
buffer_load_dword v48, v4, s[36:39], 0 offen offset:16
buffer_load_dword v254, v228, s[24:27], 0 offen sc1
v_lshlrev_b32 v5, 4, v0
v_add_u32 v5, 87808, v5
v_add_u32 v7, 62464, v5
v_mov_b32 v12, 0
v_mov_b32 v13, 0
v_mov_b32 v14, 0
v_mov_b32 v15, 0
v_cmp_gt_u32 vcc, 126, v0
s_and_saveexec_b64 s[6:7], vcc
ds_write_b128 v5, v[12:15] offset:0
ds_write_b128 v5, v[12:15] offset:6784
ds_write_b128 v5, v[12:15] offset:31232
ds_write_b128 v5, v[12:15] offset:38016
ds_write_b128 v7, v[12:15] offset:0
ds_write_b128 v7, v[12:15] offset:6784
s_mov_b64 exec, s[6:7]
v_lshrrev_b32 v4, 4, v0
v_mul_u32_u24 v4, 288, v4
v_and_b32 v5, 15, v0
v_lshl_add_u32 v4, v5, 4, v4
v_add_u32 v4, 83200, v4
v_add_u32 v6, 62464, v4
s_waitcnt vmcnt(1)
ds_write_b128 v4, v[32:35] offset:6784
v_alignbit_b32 v12, v33, v32, 16
v_alignbit_b32 v13, v34, v33, 16
v_alignbit_b32 v14, v35, v34, 16
v_alignbit_b32 v15, v36, v35, 16
ds_write_b128 v4, v[12:15] offset:0
ds_write_b128 v4, v[38:41] offset:38016
v_alignbit_b32 v12, v39, v38, 16
v_alignbit_b32 v13, v40, v39, 16
v_alignbit_b32 v14, v41, v40, 16
v_alignbit_b32 v15, v42, v41, 16
ds_write_b128 v4, v[12:15] offset:31232
ds_write_b128 v6, v[44:47] offset:6784
v_alignbit_b32 v12, v45, v44, 16
v_alignbit_b32 v13, v46, v45, 16
v_alignbit_b32 v14, v47, v46, 16
v_alignbit_b32 v15, v48, v47, 16
ds_write_b128 v6, v[12:15] offset:0
s_waitcnt vmcnt(0)
v_cmp_eq_u32 vcc, 0, v254
s_cbranch_vccnz L_slow_51
L_back_52:
s_lshr_b32 s6, s4, 3
s_mul_i32 s6, s6, 14
s_and_b32 s7, s4, 7
s_mul_i32 s7, s7, 7
s_add_u32 s6, s6, s7
s_lshr_b32 s6, s6, 2
s_cmp_ge_u32 s5, 2
s_cselect_b32 s43, 13, 14
s_cmp_ge_u32 s6, s43
s_cselect_b32 s7, s43, 0
s_sub_u32 s93, s6, s7
s_mov_b32 s93, 0
s_mul_i32 s6, s95, 54
s_add_u32 s6, s6, s96
s_mul_i32 s79, s6, 5120
s_add_u32 s79, s79, 7340032
s_mul_i32 s7, s43, 5120
s_add_u32 s80, s79, s7
s_mul_i32 s7, s93, 5120
s_add_u32 s97, s79, s7
s_add_u32 s98, s97, 4096
s_cmp_eq_u32 s5, 2
s_cselect_b32 s7, 4294890496, 0
s_cmp_eq_u32 s5, 3
s_cselect_b32 s7, 4294895616, s7
s_add_u32 s79, s79, s7
buffer_load_dwordx4 a[0:3], v248, s[24:27], s97 offen offset:0
buffer_load_dwordx4 a[4:7], v248, s[24:27], s97 offen offset:1024
buffer_load_dwordx4 a[8:11], v248, s[24:27], s97 offen offset:2048
buffer_load_dwordx4 a[12:15], v248, s[24:27], s97 offen offset:3072
buffer_load_dwordx4 a[16:19], v248, s[24:27], s98 offen
s_add_u32 s97, s97, 5120
s_cmp_eq_u32 s97, s80
s_cselect_b32 s97, s79, s97
s_add_u32 s98, s97, 4096
buffer_load_dwordx4 a[20:23], v248, s[24:27], s97 offen offset:0
buffer_load_dwordx4 a[24:27], v248, s[24:27], s97 offen offset:1024
buffer_load_dwordx4 a[28:31], v248, s[24:27], s97 offen offset:2048
buffer_load_dwordx4 a[32:35], v248, s[24:27], s97 offen offset:3072
buffer_load_dwordx4 a[36:39], v248, s[24:27], s98 offen
s_add_u32 s97, s97, 5120
s_cmp_eq_u32 s97, s80
s_cselect_b32 s97, s79, s97
s_add_u32 s98, s97, 4096
buffer_load_dwordx4 a[40:43], v248, s[24:27], s97 offen offset:0
buffer_load_dwordx4 a[44:47], v248, s[24:27], s97 offen offset:1024
buffer_load_dwordx4 a[48:51], v248, s[24:27], s97 offen offset:2048
buffer_load_dwordx4 a[52:55], v248, s[24:27], s97 offen offset:3072
buffer_load_dwordx4 a[56:59], v248, s[24:27], s98 offen
s_add_u32 s97, s97, 5120
s_cmp_eq_u32 s97, s80
s_cselect_b32 s97, s79, s97
s_add_u32 s98, s97, 4096
buffer_load_dwordx4 a[60:63], v248, s[24:27], s97 offen offset:0
buffer_load_dwordx4 a[64:67], v248, s[24:27], s97 offen offset:1024
buffer_load_dwordx4 a[68:71], v248, s[24:27], s97 offen offset:2048
buffer_load_dwordx4 a[72:75], v248, s[24:27], s97 offen offset:3072
buffer_load_dwordx4 a[76:79], v248, s[24:27], s98 offen
s_add_u32 s97, s97, 5120
s_cmp_eq_u32 s97, s80
s_cselect_b32 s97, s79, s97
s_add_u32 s98, s97, 4096
s_lshl_b32 s6, s89, 2
s_add_u32 s6, s6, s5
s_lshl_b32 s7, s6, 1
s_lshr_b32 s85, 6436, s7
s_and_b32 s85, s85, 3
s_lshr_b32 s86, 55, s6
s_and_b32 s86, s86, 1
s_lshr_b32 s87, 61311, s7
s_and_b32 s87, s87, 3
v_and_b32 v2, 3, v1
v_mul_u32_u24 v2, 4416, v2
v_bfe_u32 v3, v1, 2, 2
v_lshrrev_b32 v18, 4, v1
v_add_u32 v3, v3, v18
v_lshl_add_u32 v16, v3, 4, v2
v_and_b32 v2, 1, v1
v_mul_u32_u24 v2, 6784, v2
v_bfe_u32 v3, v1, 1, 3
s_lshl_b32 s6, s86, 3
s_sub_u32 s6, 15, s6
v_sub_u32 v5, s6, v3
v_mul_u32_u24 v5, 288, v5
v_add_u32 v2, v2, v5
v_lshl_add_u32 v17, v18, 4, v2
s_lshl_b32 s6, s86, 3
v_add_u32 v3, s6, v3
v_lshlrev_b32 v3, 8, v3
v_and_b32 v2, 1, v1
v_lshl_or_b32 v2, v18, 1, v2
v_lshl_or_b32 v11, v2, 4, v3
s_mul_i32 s6, s85, 31232
s_add_u32 s6, s6, 65536
v_add_u32 v8, s6, v16
s_add_u32 s6, s6, 17664
v_add_u32 v9, s6, v17
v_lshlrev_b32 v10, 5, v18
v_sub_u32 v10, v9, v10
v_add_u32 v10, 0, v10
s_add_u32 s91, s88, s85
s_and_b32 s46, s88, 0xfffffffe
s_sub_u32 s46, s91, s46
s_cmp_ge_u32 s46, 2
s_cselect_b32 s47, s1, s0
s_and_b32 s46, s46, 1
s_lshl_b32 s46, s46, 4
s_lshr_b32 s47, s47, s46
s_and_b32 s47, s47, 0xffff
v_mov_b32 v61, s47
v_and_b32 v19, 15, v1
v_lshl_add_u32 v19, v18, 2, v19
v_sub_u32 v19, 15, v19
v_cmp_eq_u32 vcc, 0, v19
v_cndmask_b32 v192, 0, v61, vcc
v_cmp_eq_u32 vcc, 1, v19
v_cndmask_b32 v193, 0, v61, vcc
v_cmp_eq_u32 vcc, 2, v19
v_cndmask_b32 v194, 0, v61, vcc
v_cmp_eq_u32 vcc, 3, v19
v_cndmask_b32 v195, 0, v61, vcc
s_lshl_b32 s92, s91, 12
s_add_u32 s92, s92, 4194304
s_branch L_conv
L_slow_11:
s_add_u32 s42, s42, 1
s_cmp_gt_u32 s42, 200000
s_cbranch_scc1 L_back_12
buffer_load_dword v254, v230, s[52:55], 0 offen sc1
s_waitcnt vmcnt(0)
v_cmp_gt_u32 vcc, 32, v254
s_cbranch_vccnz L_slow_11
s_branch L_back_12
L_slow_20:
s_add_u32 s42, s42, 1
s_cmp_gt_u32 s42, 200000
s_cbranch_scc1 L_back_21
buffer_load_dword v254, v231, s[24:27], 0 offen sc1
s_waitcnt vmcnt(0)
v_cmp_eq_u32 vcc, 0, v254
s_cbranch_vccnz L_slow_20
s_branch L_back_21
L_slow_27:
s_add_u32 s42, s42, 1
s_cmp_gt_u32 s42, 200000
s_cbranch_scc1 L_back_28
buffer_load_dword v251, v229, s[24:27], 0 offen sc1
s_waitcnt vmcnt(0)
v_cmp_eq_u32 vcc, 0, v251
s_cbranch_vccnz L_slow_27
s_branch L_back_28
L_slow_29:
s_add_u32 s42, s42, 1
s_cmp_gt_u32 s42, 200000
s_cbranch_scc1 L_back_30
buffer_load_dword v254, v228, s[24:27], 0 offen sc1
s_waitcnt vmcnt(0)
v_cmp_eq_u32 vcc, 0, v254
s_cbranch_vccnz L_slow_29
s_branch L_back_30
L_slow_37:
s_add_u32 s42, s42, 1
s_cmp_gt_u32 s42, 200000
s_cbranch_scc1 L_back_38
buffer_load_dword v254, v249, s[24:27], 0 offen sc1
s_waitcnt vmcnt(0)
v_cmp_eq_u32 vcc, 0, v254
s_cbranch_vccnz L_slow_37
s_branch L_back_38
L_slow_41:
s_add_u32 s42, s42, 1
s_cmp_gt_u32 s42, 200000
s_cbranch_scc1 L_back_42
buffer_load_dword v254, v250, s[24:27], 0 offen sc1
s_waitcnt vmcnt(0)
v_cmp_eq_u32 vcc, 0, v254
s_cbranch_vccnz L_slow_41
s_branch L_back_42
L_slow_46:
s_add_u32 s42, s42, 1
s_cmp_gt_u32 s42, 200000
s_cbranch_scc1 L_back_47
buffer_load_dword v254, v230, s[52:55], 0 offen sc1
s_waitcnt vmcnt(0)
v_cmp_gt_u32 vcc, 32, v254
s_cbranch_vccnz L_slow_46
s_branch L_back_47
L_slow_49:
s_add_u32 s42, s42, 1
s_cmp_gt_u32 s42, 200000
s_cbranch_scc1 L_back_50
buffer_load_dword v254, v229, s[24:27], 0 offen sc1
s_waitcnt vmcnt(0)
v_cmp_eq_u32 vcc, 0, v254
s_cbranch_vccnz L_slow_49
s_branch L_back_50
L_slow_51:
s_add_u32 s42, s42, 1
s_cmp_gt_u32 s42, 200000
s_cbranch_scc1 L_back_52
buffer_load_dword v254, v228, s[24:27], 0 offen sc1
s_waitcnt vmcnt(0)
v_cmp_eq_u32 vcc, 0, v254
s_cbranch_vccnz L_slow_51
s_branch L_back_52
L_code_end:
.section .rodata,"a"
.p2align 6
.amdhsa_kernel recurrent_scan__ssm_conv_h3__dense_activation_gelu__prompt_kernel
  .amdhsa_next_free_vgpr 512
  .amdhsa_next_free_sgpr 102
  .amdhsa_accum_offset 256
  .amdhsa_group_segment_fixed_size 0
  .amdhsa_kernarg_size 112
  .amdhsa_user_sgpr_count 2
  .amdhsa_user_sgpr_kernarg_segment_ptr 1
  .amdhsa_system_sgpr_workgroup_id_x 1
.end_amdhsa_kernel
```
